```python
import torch

def _softmax(x, axis=-1):
    return torch.softmax(x, dim=axis)
def _gelu(x):
    return torch.nn.functional.gelu(x, approximate="tanh")
def _silu(x):
    return torch.nn.functional.silu(x)
def _sigmoid(x):
    return torch.sigmoid(x)
def _layernorm(x, axis=-1, eps=1e-5):
    m = x.mean(dim=axis, keepdim=True)
    v = x.var(dim=axis, keepdim=True, unbiased=False)
    return (x - m) / torch.sqrt(v + eps)
def _scatter_add(tgt, idx, src, axis=0):
    return tgt.clone().index_add_(axis, idx, src)
def _segment_sum(src, seg, n):
    out = torch.zeros((n,) + src.shape[1:], dtype=src.dtype)
    return out.index_add_(0, seg, src)
def _pad(x, pw):
    flat = tuple(v for pair in reversed(pw) for v in pair)
    return torch.nn.functional.pad(x, flat)

kernel_name = 'concat_heads__sliding_block_cached__compressed_kv_cla__decode'

def setup_inputs():

    _w = (lambda a: (lambda t: t.to(torch.bfloat16) if t.is_floating_point() else t)(torch.as_tensor(a)))
    def _A_setup():
        B, Sq, D = 4, 1, 512
        Hq, Hkv, Sk, Dh = 32, 32, 4096, 128
        assert Hq % Hkv == 0, (Hq, Hkv)
        return {
            "x": _w((lambda *s: torch.randn(*s, dtype=torch.bfloat16) * 0.8)(B, Sq, D)),
            "k_cache": _w((lambda *s: torch.randn(*s, dtype=torch.bfloat16) * 0.8)(B, Hkv, Sk, Dh)),
            "v_cache": _w((lambda *s: torch.randn(*s, dtype=torch.bfloat16) * 0.05)(B, Hkv, Sk, Dh)),
            "wq": _w((lambda *s: torch.randn(*s, dtype=torch.bfloat16) * 0.8)(D, Hq * Dh) * (D ** -0.5)),
            "wo": _w((lambda *s: torch.randn(*s, dtype=torch.bfloat16) * 0.05)(Hq * Dh, D) * ((Hq * Dh) ** -0.5)),
        }
    _A_in = _A_setup()

    def _B_setup():
        B, H, Sq, Sk, D, M = 4, 32, 1, 4096, 128, 512
        Dc = 4 * D
        return {
            "x": _w((lambda *s: torch.randn(*s, dtype=torch.bfloat16) * 1.6)(B, Sq, M)),
            "c_kv": _w((lambda *s: torch.randn(*s, dtype=torch.bfloat16) * 0.1)(B, Sk, Dc)),
            "w_q": _w((lambda *s: torch.randn(*s, dtype=torch.bfloat16) * 3.2)(M, H, D) * (M ** -0.5)),
            "w_uk": _w((lambda *s: torch.randn(*s, dtype=torch.bfloat16) * 3.2)(Dc, H, D) * (Dc ** -0.5)),
            "w_uv": _w((lambda *s: torch.randn(*s, dtype=torch.bfloat16) * 0.1)(Dc, H, D) * (Dc ** -0.5)),
            "w_o": _w((lambda *s: torch.randn(*s, dtype=torch.bfloat16) * 0.1)(H, D, M) * ((H * D) ** -0.5)),
        }
    _B_in = _B_setup()

    return {
        "A_x": _A_in["x"],
        "A_k_cache": _A_in["k_cache"],
        "A_v_cache": _A_in["v_cache"],
        "A_wq": _A_in["wq"],
        "A_wo": _A_in["wo"],
        "B_x": _B_in["x"],
        "B_c_kv": _B_in["c_kv"],
        "B_w_q": _B_in["w_q"],
        "B_w_uk": _B_in["w_uk"],
        "B_w_uv": _B_in["w_uv"],
        "B_w_o": _B_in["w_o"],
    }

def reference(A_x, A_k_cache, A_v_cache, A_wq, A_wo, B_x, B_c_kv, B_w_q, B_w_uk, B_w_uv, B_w_o):
    def _A_ref(x, k_cache, v_cache, wq, wo):
        B, Sq, D = x.shape
        Hq, Dh = 32, 128
        Hkv, Sk = k_cache.shape[1], k_cache.shape[2]
        W = min(4096, max(256, Sk // 4))
        rep = Hq // Hkv
        q = (lambda x, *d: x.permute(*d))((x @ wq).reshape(B, Sq, Hq, Dh), 0, 2, 1, 3)
        k = (lambda x, n, axis: torch.repeat_interleave(x, n, dim=axis))(k_cache[:, :, Sk - W:, :], rep, axis=1)
        v = (lambda x, n, axis: torch.repeat_interleave(x, n, dim=axis))(v_cache[:, :, Sk - W:, :], rep, axis=1)
        scores = torch.einsum("bhqd,bhkd->bhqk", q, k) * (Dh ** -0.5)
        p = _softmax(scores, axis=-1)
        o = torch.einsum("bhqk,bhkd->bhqd", p, v)
        return (lambda x, *d: x.permute(*d))(o, 0, 2, 1, 3).reshape(B, Sq, Hq * Dh) @ wo

    def _B_ref(x, c_kv, w_q, w_uk, w_uv, w_o):
        B, Sq, M = x.shape[0], x.shape[1], x.shape[2]
        Sk = c_kv.shape[1]
        H, D = w_q.shape[1], w_q.shape[2]
        q = torch.einsum("bqm,mhd->bhqd", x, w_q)
        k = torch.einsum("bkc,chd->bhkd", c_kv, w_uk)
        v = torch.einsum("bkc,chd->bhkd", c_kv, w_uv)
        scores = torch.einsum("bhqd,bhkd->bhqk", q, k) * (D ** -0.5)
        off = Sk - Sq
        qi = torch.arange(Sq)[:, None]
        kj = torch.arange(Sk)[None, :]
        cmask = kj <= (qi + off)
        scores = torch.where(cmask[None, None], scores, -1e9)
        p = _softmax(scores, axis=-1)
        ctx = torch.einsum("bhqk,bhkd->bhqd", p, v)
        return torch.einsum("bhqd,hdm->bqm", ctx, w_o)

    a = _A_ref(A_x, A_k_cache, A_v_cache, A_wq, A_wo)
    b = _B_ref(B_x, B_c_kv, B_w_q, B_w_uk, B_w_uv, B_w_o)
    return torch.concatenate([a, b], axis=-1)
```

```asm
; @launch grid=(256,1,1) block=(768,1,1) lds=163840
.amdgcn_target "amdgcn-amd-amdhsa--gfx950"
.text
.globl concat_heads__sliding_block_cached__compressed_kv_cla__decode_kernel
.p2align 8
.type concat_heads__sliding_block_cached__compressed_kv_cla__decode_kernel,@function
concat_heads__sliding_block_cached__compressed_kv_cla__decode_kernel:
    s_cmp_ge_u32 s2, 256
    s_cbranch_scc1 L_END0
    s_load_dwordx16 s[8:23], s[0:1], 0
    s_load_dwordx8 s[24:31], s[0:1], 64
    s_load_dwordx4 s[32:35], s[0:1], 96
    v_lshrrev_b32 v1, 6, v0
    s_nop 0
    v_readfirstlane_b32 s3, v1
    v_and_b32 v1, 63, v0
    s_and_b32 s4, s2, 7
    s_lshr_b32 s5, s2, 3
    s_and_b32 s7, s5, 3
    s_lshl_b32 s6, s4, 2
    s_add_u32 s6, s6, s7
    s_cmp_lg_u32 s3, 11
    s_cbranch_scc1 Z_1
    v_lshlrev_b32 v2, 2, v1
    v_add_u32 v2, 0x24000, v2
    v_mov_b32 v3, 0
    ds_write_b32 v2, v3
Z_1:
    s_waitcnt lgkmcnt(0)
    s_mov_b32 s36, s34
    s_and_b32 s37, s35, 0xffff
    s_mov_b32 s38, 0x1000000
    s_mov_b32 s39, 0x20000
    s_mov_b32 s40, s32
    s_and_b32 s41, s33, 0xffff
    s_mov_b32 s42, 0x100
    s_mov_b32 s43, 0x20000
    s_cmp_lt_u32 s5, 8
    s_cbranch_scc1 L_W
    s_cmp_lt_u32 s5, 16
    s_cbranch_scc1 L_C
    s_cmp_eq_u32 s3, 11
    s_cbranch_scc1 L_ASVC
    s_mov_b32 s44, s10
    s_and_b32 s45, s11, 0xffff
    s_mov_b32 s46, 0x8000000
    s_mov_b32 s47, 0x20000
    s_mov_b32 s48, s12
    s_and_b32 s49, s13, 0xffff
    s_mov_b32 s50, 0x8000000
    s_mov_b32 s51, 0x20000
    s_lshr_b32 s7, s5, 2
    s_sub_u32 s7, s7, 4
    s_lshl_b32 s7, s7, 5
    s_add_u32 s7, s7, s6
    s_lshl_b32 s7, s7, 20
    s_add_u32 s7, s7, 0xC0000
    v_lshlrev_b32 v6, 4, v1
    v_add_u32 v6, s7, v6
    s_add_u32 s63, s3, 3
    s_cmp_ge_u32 s63, 11
    s_cselect_b32 s7, 11, 0
    s_sub_u32 s62, s63, s7
    s_mul_i32 s7, s2, 0
    s_add_u32 s7, s7, s62
    s_mul_i32 s7, s7, 1024
    s_and_b32 s60, s7, 0x3ffff
    s_mov_b32 s61, s60
    s_add_u32 s63, s60, 259072
    s_and_b32 s63, s63, 0x3ffff
    s_cmp_lt_u32 s62, 3
    s_cselect_b32 s63, s63, 0x40000000
    s_cselect_b32 s62, 0, 0xff800000
    s_mov_b32 s64, 0x3e0293ee
    s_cmp_ge_u32 s3, 8
    s_cbranch_scc1 AK_2
    s_cmp_lt_u32 s3, 4
    s_cselect_b32 s70, s18, s8
    s_cselect_b32 s71, s19, s9
    s_cselect_b32 s72, s22, s14
    s_cselect_b32 s73, s23, s15
    s_mov_b32 s52, s70
    s_and_b32 s53, s71, 0xffff
    s_mov_b32 s54, 0x1000
    s_mov_b32 s55, 0x20000
    s_mov_b32 s56, s72
    s_and_b32 s57, s73, 0xffff
    s_mov_b32 s58, 0x400000
    s_mov_b32 s59, 0x20000
    s_and_b32 s7, s5, 12
    s_and_b32 s66, s3, 3
    s_add_u32 s7, s7, s66
    v_lshrrev_b32 v2, 4, v1
    v_lshlrev_b32 v3, 16, v2
    v_and_b32 v4, 15, v1
    v_lshl_add_u32 v3, v4, 4, v3
    s_lshl_b32 s66, s7, 18
    s_lshl_b32 s67, s6, 8
    s_add_u32 s66, s66, s67
    s_cmp_lt_u32 s3, 4
    s_cbranch_scc1 AP_4
    s_barrier
    s_sleep 12
AP_4:
    buffer_load_dwordx4 v[128:131], v3, s[56:59], s66 offen nt
    s_add_u32 s66, s66, 8192
    buffer_load_dwordx4 v[132:135], v3, s[56:59], s66 offen nt
    s_add_u32 s66, s66, 8192
    buffer_load_dwordx4 v[136:139], v3, s[56:59], s66 offen nt
    s_add_u32 s66, s66, 8192
    buffer_load_dwordx4 v[140:143], v3, s[56:59], s66 offen nt
    s_add_u32 s66, s66, 8192
    buffer_load_dwordx4 v[144:147], v3, s[56:59], s66 offen nt
    s_add_u32 s66, s66, 8192
    buffer_load_dwordx4 v[148:151], v3, s[56:59], s66 offen nt
    s_add_u32 s66, s66, 8192
    buffer_load_dwordx4 v[152:155], v3, s[56:59], s66 offen nt
    s_add_u32 s66, s66, 8192
    buffer_load_dwordx4 v[156:159], v3, s[56:59], s66 offen nt
    s_add_u32 s66, s66, 8192
    v_bfe_u32 v4, v1, 2, 2
    v_lshlrev_b32 v4, 10, v4
    v_lshl_add_u32 v4, v2, 4, v4
    s_lshl_b32 s7, s7, 6
    buffer_load_dwordx4 v[160:163], v4, s[52:55], s7 offen
    s_cmp_ge_u32 s3, 4
    s_cbranch_scc1 AP_5
    s_barrier
AP_5:
    s_mov_b32 s92, 0x05040100
    s_mov_b32 s93, 0x07060302
    s_lshl_b32 s7, s3, 11
    s_add_u32 s7, s7, 0x0
    v_lshl_add_u32 v2, v1, 5, s7
    s_cmp_lt_u32 s3, 4
    s_cselect_b32 s7, 0x44, 0x40
    s_add_u32 s7, s7, 0x24000
    v_mov_b32 v3, s7
    v_mov_b32 v4, 1
    s_waitcnt vmcnt(0)
    v_perm_b32 v96, v132, v128, s92
    v_perm_b32 v97, v140, v136, s92
    v_perm_b32 v98, v148, v144, s92
    v_perm_b32 v99, v156, v152, s92
    v_perm_b32 v100, v132, v128, s93
    v_perm_b32 v101, v140, v136, s93
    v_perm_b32 v102, v148, v144, s93
    v_perm_b32 v103, v156, v152, s93
    v_perm_b32 v104, v133, v129, s92
    v_perm_b32 v105, v141, v137, s92
    v_perm_b32 v106, v149, v145, s92
    v_perm_b32 v107, v157, v153, s92
    v_perm_b32 v108, v133, v129, s93
    v_perm_b32 v109, v141, v137, s93
    v_perm_b32 v110, v149, v145, s93
    v_perm_b32 v111, v157, v153, s93
    v_perm_b32 v112, v134, v130, s92
    v_perm_b32 v113, v142, v138, s92
    v_perm_b32 v114, v150, v146, s92
    v_perm_b32 v115, v158, v154, s92
    v_perm_b32 v116, v134, v130, s93
    v_perm_b32 v117, v142, v138, s93
    v_perm_b32 v118, v150, v146, s93
    v_perm_b32 v119, v158, v154, s93
    v_perm_b32 v120, v135, v131, s92
    v_perm_b32 v121, v143, v139, s92
    v_perm_b32 v122, v151, v147, s92
    v_perm_b32 v123, v159, v155, s92
    v_perm_b32 v124, v135, v131, s93
    v_perm_b32 v125, v143, v139, s93
    v_perm_b32 v126, v151, v147, s93
    v_perm_b32 v127, v159, v155, s93
    v_mfma_f32_16x16x32_bf16 v[64:67], v[160:163], v[96:99], 0
    v_mfma_f32_16x16x32_bf16 v[68:71], v[160:163], v[100:103], 0
    v_mfma_f32_16x16x32_bf16 v[72:75], v[160:163], v[104:107], 0
    v_mfma_f32_16x16x32_bf16 v[76:79], v[160:163], v[108:111], 0
    v_mfma_f32_16x16x32_bf16 v[80:83], v[160:163], v[112:115], 0
    v_mfma_f32_16x16x32_bf16 v[84:87], v[160:163], v[116:119], 0
    v_mfma_f32_16x16x32_bf16 v[88:91], v[160:163], v[120:123], 0
    v_mfma_f32_16x16x32_bf16 v[92:95], v[160:163], v[124:127], 0
    s_nop 0
    v_mov_b32 v128, v64
    v_mov_b32 v129, v68
    v_mov_b32 v130, v72
    v_mov_b32 v131, v76
    v_mov_b32 v132, v80
    v_mov_b32 v133, v84
    v_mov_b32 v134, v88
    v_mov_b32 v135, v92
    ds_write_b128 v2, v[128:131]
    ds_write_b128 v2, v[132:135] offset:16
    s_waitcnt lgkmcnt(0)
    s_mov_b64 exec, 1
    ds_add_u32 v3, v4
    s_mov_b64 exec, -1
    s_branch AJ_3
AK_2:
    s_barrier
    s_sleep 12
AJ_3:
    buffer_load_dwordx4 v[32:35], v6, s[44:47], s60 offen offset:0 nt
    s_add_u32 s60, s60, 11264
    buffer_load_dwordx4 v[36:39], v6, s[44:47], s60 offen offset:0 nt
    s_add_u32 s60, s60, 11264
    buffer_load_dwordx4 v[40:43], v6, s[44:47], s60 offen offset:0 nt
    s_add_u32 s60, s60, 11264
    s_waitcnt vmcnt(2)
    buffer_load_dwordx4 v[44:47], v6, s[44:47], s60 offen offset:0 nt
    s_add_u32 s60, s60, 11264
    s_waitcnt vmcnt(2)
    buffer_load_dwordx4 v[48:51], v6, s[44:47], s60 offen offset:0 nt
    s_add_u32 s60, s60, 11264
    s_waitcnt vmcnt(2)
    buffer_load_dwordx4 v[52:55], v6, s[44:47], s60 offen offset:0 nt
    s_add_u32 s60, s60, 11264
    s_waitcnt vmcnt(2)
    buffer_load_dwordx4 v[56:59], v6, s[44:47], s60 offen offset:0 nt
    s_add_u32 s60, s60, 11264
    s_waitcnt vmcnt(2)
    buffer_load_dwordx4 v[60:63], v6, s[44:47], s60 offen offset:0 nt
    s_add_u32 s60, s60, 11264
    s_waitcnt vmcnt(2)
    buffer_load_dwordx4 v[64:67], v6, s[44:47], s60 offen offset:0 nt
    s_add_u32 s60, s60, 11264
    s_waitcnt vmcnt(2)
    buffer_load_dwordx4 v[68:71], v6, s[44:47], s60 offen offset:0 nt
    s_add_u32 s60, s60, 11264
    s_waitcnt vmcnt(2)
    buffer_load_dwordx4 v[72:75], v6, s[44:47], s60 offen offset:0 nt
    s_add_u32 s60, s60, 11264
    s_waitcnt vmcnt(2)
    buffer_load_dwordx4 v[76:79], v6, s[44:47], s60 offen offset:0 nt
    s_add_u32 s60, s60, 11264
    s_waitcnt vmcnt(2)
    buffer_load_dwordx4 v[80:83], v6, s[44:47], s60 offen offset:0 nt
    s_add_u32 s60, s60, 11264
    s_waitcnt vmcnt(2)
    buffer_load_dwordx4 v[84:87], v6, s[44:47], s60 offen offset:0 nt
    s_add_u32 s60, s60, 11264
    s_waitcnt vmcnt(2)
    buffer_load_dwordx4 v[88:91], v6, s[44:47], s60 offen offset:0 nt
    s_add_u32 s60, s60, 11264
    s_waitcnt vmcnt(2)
    buffer_load_dwordx4 v[92:95], v6, s[44:47], s60 offen offset:0 nt
    s_add_u32 s60, s60, 11264
    s_waitcnt vmcnt(2)
    buffer_load_dwordx4 v[96:99], v6, s[44:47], s60 offen offset:0 nt
    s_add_u32 s60, s60, 11264
    s_waitcnt vmcnt(2)
    buffer_load_dwordx4 v[100:103], v6, s[44:47], s60 offen offset:0 nt
    s_add_u32 s60, s60, 11264
    s_waitcnt vmcnt(2)
    buffer_load_dwordx4 v[104:107], v6, s[44:47], s60 offen offset:0 nt
    s_add_u32 s60, s60, 11264
    s_waitcnt vmcnt(2)
    buffer_load_dwordx4 v[108:111], v6, s[44:47], s60 offen offset:0 nt
    s_add_u32 s60, s60, 11264
    s_waitcnt vmcnt(2)
    buffer_load_dwordx4 v[112:115], v6, s[44:47], s60 offen offset:0 nt
    s_add_u32 s60, s60, 11264
    s_waitcnt vmcnt(2)
    buffer_load_dwordx4 v[116:119], v6, s[44:47], s60 offen offset:0 nt
    s_add_u32 s60, s60, 11264
    s_waitcnt vmcnt(2)
    buffer_load_dwordx4 v[120:123], v6, s[44:47], s60 offen offset:0 nt
    s_waitcnt vmcnt(2)
    buffer_load_dwordx4 v[124:127], v6, s[44:47], s63 offen offset:0 nt
    s_waitcnt vmcnt(2)
    buffer_load_dwordx4 v[128:131], v6, s[48:51], s61 offen offset:0 nt
    s_add_u32 s61, s61, 11264
    s_waitcnt vmcnt(2)
    buffer_load_dwordx4 v[132:135], v6, s[48:51], s61 offen offset:0 nt
    s_add_u32 s61, s61, 11264
    s_waitcnt vmcnt(2)
    buffer_load_dwordx4 v[136:139], v6, s[48:51], s61 offen offset:0 nt
    s_add_u32 s61, s61, 11264
    s_waitcnt vmcnt(2)
    buffer_load_dwordx4 v[140:143], v6, s[48:51], s61 offen offset:0 nt
    s_add_u32 s61, s61, 11264
    s_waitcnt vmcnt(2)
    buffer_load_dwordx4 v[144:147], v6, s[48:51], s61 offen offset:0 nt
    s_add_u32 s61, s61, 11264
    s_waitcnt vmcnt(2)
    buffer_load_dwordx4 v[148:151], v6, s[48:51], s61 offen offset:0 nt
    s_add_u32 s61, s61, 11264
    v_mov_b32 v160, 0x24004
    s_mov_b32 s80, 1600000
LW_6:
    ds_read_b32 v161, v160
    s_waitcnt lgkmcnt(0)
    v_readfirstlane_b32 s79, v161
    s_cmp_ge_u32 s79, 1
    s_cbranch_scc1 LWD_7
    s_sleep 4
    s_sub_u32 s80, s80, 1
    s_cmp_lg_u32 s80, 0
    s_cbranch_scc1 LW_6
LWD_7:
    v_and_b32 v160, 15, v1
    v_lshlrev_b32 v160, 4, v160
    v_add_u32 v160, 0x24100, v160
    ds_read_b128 v[2:5], v160
    s_waitcnt lgkmcnt(0)
    v_dot2_f32_bf16 v8, v32, v2, 0
    v_dot2_f32_bf16 v9, v36, v2, 0
    v_dot2_f32_bf16 v10, v40, v2, 0
    v_dot2_f32_bf16 v11, v44, v2, 0
    v_dot2_f32_bf16 v8, v33, v3, v8
    v_dot2_f32_bf16 v9, v37, v3, v9
    v_dot2_f32_bf16 v10, v41, v3, v10
    v_dot2_f32_bf16 v11, v45, v3, v11
    v_dot2_f32_bf16 v8, v34, v4, v8
    v_dot2_f32_bf16 v9, v38, v4, v9
    v_dot2_f32_bf16 v10, v42, v4, v10
    v_dot2_f32_bf16 v11, v46, v4, v11
    v_dot2_f32_bf16 v8, v35, v5, v8
    v_dot2_f32_bf16 v9, v39, v5, v9
    v_dot2_f32_bf16 v10, v43, v5, v10
    v_dot2_f32_bf16 v11, v47, v5, v11
    v_add_f32_dpp v8, v8, v8 row_ror:8 row_mask:0xf bank_mask:0xf
    v_add_f32_dpp v9, v9, v9 row_ror:8 row_mask:0xf bank_mask:0xf
    v_add_f32_dpp v10, v10, v10 row_ror:8 row_mask:0xf bank_mask:0xf
    v_add_f32_dpp v11, v11, v11 row_ror:8 row_mask:0xf bank_mask:0xf
    v_add_f32_dpp v8, v8, v8 row_ror:4 row_mask:0xf bank_mask:0xf
    v_add_f32_dpp v9, v9, v9 row_ror:4 row_mask:0xf bank_mask:0xf
    v_add_f32_dpp v10, v10, v10 row_ror:4 row_mask:0xf bank_mask:0xf
    v_add_f32_dpp v11, v11, v11 row_ror:4 row_mask:0xf bank_mask:0xf
    v_add_f32_dpp v8, v8, v8 row_ror:2 row_mask:0xf bank_mask:0xf
    v_add_f32_dpp v9, v9, v9 row_ror:2 row_mask:0xf bank_mask:0xf
    v_add_f32_dpp v10, v10, v10 row_ror:2 row_mask:0xf bank_mask:0xf
    v_add_f32_dpp v11, v11, v11 row_ror:2 row_mask:0xf bank_mask:0xf
    v_add_f32_dpp v8, v8, v8 row_ror:1 row_mask:0xf bank_mask:0xf
    v_add_f32_dpp v9, v9, v9 row_ror:1 row_mask:0xf bank_mask:0xf
    v_add_f32_dpp v10, v10, v10 row_ror:1 row_mask:0xf bank_mask:0xf
    v_add_f32_dpp v11, v11, v11 row_ror:1 row_mask:0xf bank_mask:0xf
    s_waitcnt vmcnt(2)
    buffer_load_dwordx4 v[32:35], v6, s[48:51], s61 offen offset:0 nt
    s_add_u32 s61, s61, 11264
    v_dot2_f32_bf16 v12, v48, v2, 0
    v_dot2_f32_bf16 v13, v52, v2, 0
    v_dot2_f32_bf16 v14, v56, v2, 0
    v_dot2_f32_bf16 v15, v60, v2, 0
    v_dot2_f32_bf16 v12, v49, v3, v12
    v_dot2_f32_bf16 v13, v53, v3, v13
    v_dot2_f32_bf16 v14, v57, v3, v14
    v_dot2_f32_bf16 v15, v61, v3, v15
    v_dot2_f32_bf16 v12, v50, v4, v12
    v_dot2_f32_bf16 v13, v54, v4, v13
    v_dot2_f32_bf16 v14, v58, v4, v14
    v_dot2_f32_bf16 v15, v62, v4, v15
    v_dot2_f32_bf16 v12, v51, v5, v12
    v_dot2_f32_bf16 v13, v55, v5, v13
    v_dot2_f32_bf16 v14, v59, v5, v14
    v_dot2_f32_bf16 v15, v63, v5, v15
    v_add_f32_dpp v12, v12, v12 row_ror:8 row_mask:0xf bank_mask:0xf
    v_add_f32_dpp v13, v13, v13 row_ror:8 row_mask:0xf bank_mask:0xf
    v_add_f32_dpp v14, v14, v14 row_ror:8 row_mask:0xf bank_mask:0xf
    v_add_f32_dpp v15, v15, v15 row_ror:8 row_mask:0xf bank_mask:0xf
    v_add_f32_dpp v12, v12, v12 row_ror:4 row_mask:0xf bank_mask:0xf
    v_add_f32_dpp v13, v13, v13 row_ror:4 row_mask:0xf bank_mask:0xf
    v_add_f32_dpp v14, v14, v14 row_ror:4 row_mask:0xf bank_mask:0xf
    v_add_f32_dpp v15, v15, v15 row_ror:4 row_mask:0xf bank_mask:0xf
    v_add_f32_dpp v12, v12, v12 row_ror:2 row_mask:0xf bank_mask:0xf
    v_add_f32_dpp v13, v13, v13 row_ror:2 row_mask:0xf bank_mask:0xf
    v_add_f32_dpp v14, v14, v14 row_ror:2 row_mask:0xf bank_mask:0xf
    v_add_f32_dpp v15, v15, v15 row_ror:2 row_mask:0xf bank_mask:0xf
    v_add_f32_dpp v12, v12, v12 row_ror:1 row_mask:0xf bank_mask:0xf
    v_add_f32_dpp v13, v13, v13 row_ror:1 row_mask:0xf bank_mask:0xf
    v_add_f32_dpp v14, v14, v14 row_ror:1 row_mask:0xf bank_mask:0xf
    v_add_f32_dpp v15, v15, v15 row_ror:1 row_mask:0xf bank_mask:0xf
    s_waitcnt vmcnt(2)
    buffer_load_dwordx4 v[36:39], v6, s[48:51], s61 offen offset:0 nt
    s_add_u32 s61, s61, 11264
    v_dot2_f32_bf16 v16, v64, v2, 0
    v_dot2_f32_bf16 v17, v68, v2, 0
    v_dot2_f32_bf16 v18, v72, v2, 0
    v_dot2_f32_bf16 v19, v76, v2, 0
    v_dot2_f32_bf16 v16, v65, v3, v16
    v_dot2_f32_bf16 v17, v69, v3, v17
    v_dot2_f32_bf16 v18, v73, v3, v18
    v_dot2_f32_bf16 v19, v77, v3, v19
    v_dot2_f32_bf16 v16, v66, v4, v16
    v_dot2_f32_bf16 v17, v70, v4, v17
    v_dot2_f32_bf16 v18, v74, v4, v18
    v_dot2_f32_bf16 v19, v78, v4, v19
    v_dot2_f32_bf16 v16, v67, v5, v16
    v_dot2_f32_bf16 v17, v71, v5, v17
    v_dot2_f32_bf16 v18, v75, v5, v18
    v_dot2_f32_bf16 v19, v79, v5, v19
    v_add_f32_dpp v16, v16, v16 row_ror:8 row_mask:0xf bank_mask:0xf
    v_add_f32_dpp v17, v17, v17 row_ror:8 row_mask:0xf bank_mask:0xf
    v_add_f32_dpp v18, v18, v18 row_ror:8 row_mask:0xf bank_mask:0xf
    v_add_f32_dpp v19, v19, v19 row_ror:8 row_mask:0xf bank_mask:0xf
    v_add_f32_dpp v16, v16, v16 row_ror:4 row_mask:0xf bank_mask:0xf
    v_add_f32_dpp v17, v17, v17 row_ror:4 row_mask:0xf bank_mask:0xf
    v_add_f32_dpp v18, v18, v18 row_ror:4 row_mask:0xf bank_mask:0xf
    v_add_f32_dpp v19, v19, v19 row_ror:4 row_mask:0xf bank_mask:0xf
    v_add_f32_dpp v16, v16, v16 row_ror:2 row_mask:0xf bank_mask:0xf
    v_add_f32_dpp v17, v17, v17 row_ror:2 row_mask:0xf bank_mask:0xf
    v_add_f32_dpp v18, v18, v18 row_ror:2 row_mask:0xf bank_mask:0xf
    v_add_f32_dpp v19, v19, v19 row_ror:2 row_mask:0xf bank_mask:0xf
    v_add_f32_dpp v16, v16, v16 row_ror:1 row_mask:0xf bank_mask:0xf
    v_add_f32_dpp v17, v17, v17 row_ror:1 row_mask:0xf bank_mask:0xf
    v_add_f32_dpp v18, v18, v18 row_ror:1 row_mask:0xf bank_mask:0xf
    v_add_f32_dpp v19, v19, v19 row_ror:1 row_mask:0xf bank_mask:0xf
    s_waitcnt vmcnt(2)
    buffer_load_dwordx4 v[40:43], v6, s[48:51], s61 offen offset:0 nt
    s_add_u32 s61, s61, 11264
    v_dot2_f32_bf16 v20, v80, v2, 0
    v_dot2_f32_bf16 v21, v84, v2, 0
    v_dot2_f32_bf16 v22, v88, v2, 0
    v_dot2_f32_bf16 v23, v92, v2, 0
    v_dot2_f32_bf16 v20, v81, v3, v20
    v_dot2_f32_bf16 v21, v85, v3, v21
    v_dot2_f32_bf16 v22, v89, v3, v22
    v_dot2_f32_bf16 v23, v93, v3, v23
    v_dot2_f32_bf16 v20, v82, v4, v20
    v_dot2_f32_bf16 v21, v86, v4, v21
    v_dot2_f32_bf16 v22, v90, v4, v22
    v_dot2_f32_bf16 v23, v94, v4, v23
    v_dot2_f32_bf16 v20, v83, v5, v20
    v_dot2_f32_bf16 v21, v87, v5, v21
    v_dot2_f32_bf16 v22, v91, v5, v22
    v_dot2_f32_bf16 v23, v95, v5, v23
    v_add_f32_dpp v20, v20, v20 row_ror:8 row_mask:0xf bank_mask:0xf
    v_add_f32_dpp v21, v21, v21 row_ror:8 row_mask:0xf bank_mask:0xf
    v_add_f32_dpp v22, v22, v22 row_ror:8 row_mask:0xf bank_mask:0xf
    v_add_f32_dpp v23, v23, v23 row_ror:8 row_mask:0xf bank_mask:0xf
    v_add_f32_dpp v20, v20, v20 row_ror:4 row_mask:0xf bank_mask:0xf
    v_add_f32_dpp v21, v21, v21 row_ror:4 row_mask:0xf bank_mask:0xf
    v_add_f32_dpp v22, v22, v22 row_ror:4 row_mask:0xf bank_mask:0xf
    v_add_f32_dpp v23, v23, v23 row_ror:4 row_mask:0xf bank_mask:0xf
    v_add_f32_dpp v20, v20, v20 row_ror:2 row_mask:0xf bank_mask:0xf
    v_add_f32_dpp v21, v21, v21 row_ror:2 row_mask:0xf bank_mask:0xf
    v_add_f32_dpp v22, v22, v22 row_ror:2 row_mask:0xf bank_mask:0xf
    v_add_f32_dpp v23, v23, v23 row_ror:2 row_mask:0xf bank_mask:0xf
    v_add_f32_dpp v20, v20, v20 row_ror:1 row_mask:0xf bank_mask:0xf
    v_add_f32_dpp v21, v21, v21 row_ror:1 row_mask:0xf bank_mask:0xf
    v_add_f32_dpp v22, v22, v22 row_ror:1 row_mask:0xf bank_mask:0xf
    v_add_f32_dpp v23, v23, v23 row_ror:1 row_mask:0xf bank_mask:0xf
    s_waitcnt vmcnt(2)
    buffer_load_dwordx4 v[44:47], v6, s[48:51], s61 offen offset:0 nt
    s_add_u32 s61, s61, 11264
    v_dot2_f32_bf16 v24, v96, v2, 0
    v_dot2_f32_bf16 v25, v100, v2, 0
    v_dot2_f32_bf16 v26, v104, v2, 0
    v_dot2_f32_bf16 v27, v108, v2, 0
    v_dot2_f32_bf16 v24, v97, v3, v24
    v_dot2_f32_bf16 v25, v101, v3, v25
    v_dot2_f32_bf16 v26, v105, v3, v26
    v_dot2_f32_bf16 v27, v109, v3, v27
    v_dot2_f32_bf16 v24, v98, v4, v24
    v_dot2_f32_bf16 v25, v102, v4, v25
    v_dot2_f32_bf16 v26, v106, v4, v26
    v_dot2_f32_bf16 v27, v110, v4, v27
    v_dot2_f32_bf16 v24, v99, v5, v24
    v_dot2_f32_bf16 v25, v103, v5, v25
    v_dot2_f32_bf16 v26, v107, v5, v26
    v_dot2_f32_bf16 v27, v111, v5, v27
    v_add_f32_dpp v24, v24, v24 row_ror:8 row_mask:0xf bank_mask:0xf
    v_add_f32_dpp v25, v25, v25 row_ror:8 row_mask:0xf bank_mask:0xf
    v_add_f32_dpp v26, v26, v26 row_ror:8 row_mask:0xf bank_mask:0xf
    v_add_f32_dpp v27, v27, v27 row_ror:8 row_mask:0xf bank_mask:0xf
    v_add_f32_dpp v24, v24, v24 row_ror:4 row_mask:0xf bank_mask:0xf
    v_add_f32_dpp v25, v25, v25 row_ror:4 row_mask:0xf bank_mask:0xf
    v_add_f32_dpp v26, v26, v26 row_ror:4 row_mask:0xf bank_mask:0xf
    v_add_f32_dpp v27, v27, v27 row_ror:4 row_mask:0xf bank_mask:0xf
    v_add_f32_dpp v24, v24, v24 row_ror:2 row_mask:0xf bank_mask:0xf
    v_add_f32_dpp v25, v25, v25 row_ror:2 row_mask:0xf bank_mask:0xf
    v_add_f32_dpp v26, v26, v26 row_ror:2 row_mask:0xf bank_mask:0xf
    v_add_f32_dpp v27, v27, v27 row_ror:2 row_mask:0xf bank_mask:0xf
    v_add_f32_dpp v24, v24, v24 row_ror:1 row_mask:0xf bank_mask:0xf
    v_add_f32_dpp v25, v25, v25 row_ror:1 row_mask:0xf bank_mask:0xf
    v_add_f32_dpp v26, v26, v26 row_ror:1 row_mask:0xf bank_mask:0xf
    v_add_f32_dpp v27, v27, v27 row_ror:1 row_mask:0xf bank_mask:0xf
    s_waitcnt vmcnt(2)
    buffer_load_dwordx4 v[48:51], v6, s[48:51], s61 offen offset:0 nt
    s_add_u32 s61, s61, 11264
    v_dot2_f32_bf16 v28, v112, v2, 0
    v_dot2_f32_bf16 v29, v116, v2, 0
    v_dot2_f32_bf16 v30, v120, v2, 0
    v_dot2_f32_bf16 v31, v124, v2, 0
    v_dot2_f32_bf16 v28, v113, v3, v28
    v_dot2_f32_bf16 v29, v117, v3, v29
    v_dot2_f32_bf16 v30, v121, v3, v30
    v_dot2_f32_bf16 v31, v125, v3, v31
    v_dot2_f32_bf16 v28, v114, v4, v28
    v_dot2_f32_bf16 v29, v118, v4, v29
    v_dot2_f32_bf16 v30, v122, v4, v30
    v_dot2_f32_bf16 v31, v126, v4, v31
    v_dot2_f32_bf16 v28, v115, v5, v28
    v_dot2_f32_bf16 v29, v119, v5, v29
    v_dot2_f32_bf16 v30, v123, v5, v30
    v_dot2_f32_bf16 v31, v127, v5, v31
    v_add_f32_dpp v28, v28, v28 row_ror:8 row_mask:0xf bank_mask:0xf
    v_add_f32_dpp v29, v29, v29 row_ror:8 row_mask:0xf bank_mask:0xf
    v_add_f32_dpp v30, v30, v30 row_ror:8 row_mask:0xf bank_mask:0xf
    v_add_f32_dpp v31, v31, v31 row_ror:8 row_mask:0xf bank_mask:0xf
    v_add_f32_dpp v28, v28, v28 row_ror:4 row_mask:0xf bank_mask:0xf
    v_add_f32_dpp v29, v29, v29 row_ror:4 row_mask:0xf bank_mask:0xf
    v_add_f32_dpp v30, v30, v30 row_ror:4 row_mask:0xf bank_mask:0xf
    v_add_f32_dpp v31, v31, v31 row_ror:4 row_mask:0xf bank_mask:0xf
    v_add_f32_dpp v28, v28, v28 row_ror:2 row_mask:0xf bank_mask:0xf
    v_add_f32_dpp v29, v29, v29 row_ror:2 row_mask:0xf bank_mask:0xf
    v_add_f32_dpp v30, v30, v30 row_ror:2 row_mask:0xf bank_mask:0xf
    v_add_f32_dpp v31, v31, v31 row_ror:2 row_mask:0xf bank_mask:0xf
    v_add_f32_dpp v28, v28, v28 row_ror:1 row_mask:0xf bank_mask:0xf
    v_add_f32_dpp v29, v29, v29 row_ror:1 row_mask:0xf bank_mask:0xf
    v_add_f32_dpp v30, v30, v30 row_ror:1 row_mask:0xf bank_mask:0xf
    v_add_f32_dpp v31, v31, v31 row_ror:1 row_mask:0xf bank_mask:0xf
    s_waitcnt vmcnt(2)
    buffer_load_dwordx4 v[52:55], v6, s[48:51], s61 offen offset:0 nt
    s_add_u32 s61, s61, 11264
    v_add_f32 v31, s62, v31
    v_max3_f32 v160, v8, v9, v10
    v_max3_f32 v160, v160, v11, v12
    v_max3_f32 v160, v160, v13, v14
    v_max3_f32 v160, v160, v15, v16
    v_max3_f32 v160, v160, v17, v18
    v_max3_f32 v160, v160, v19, v20
    v_max3_f32 v160, v160, v21, v22
    v_max3_f32 v160, v160, v23, v24
    v_max3_f32 v160, v160, v25, v26
    v_max3_f32 v160, v160, v27, v28
    v_max3_f32 v160, v160, v29, v30
    v_max_f32 v160, v160, v31
    v_mov_b32 v161, v160
    s_nop 1
    v_permlane32_swap_b32 v160, v161
    v_max_f32 v160, v160, v161
    v_mov_b32 v161, v160
    s_nop 1
    v_permlane16_swap_b32 v160, v161
    v_max_f32 v160, v160, v161
    v_mul_f32 v160, s64, v160
    v_fma_f32 v8, v8, s64, -v160
    v_fma_f32 v9, v9, s64, -v160
    v_fma_f32 v10, v10, s64, -v160
    v_fma_f32 v11, v11, s64, -v160
    v_fma_f32 v12, v12, s64, -v160
    v_fma_f32 v13, v13, s64, -v160
    v_fma_f32 v14, v14, s64, -v160
    v_fma_f32 v15, v15, s64, -v160
    v_fma_f32 v16, v16, s64, -v160
    v_fma_f32 v17, v17, s64, -v160
    v_fma_f32 v18, v18, s64, -v160
    v_fma_f32 v19, v19, s64, -v160
    v_fma_f32 v20, v20, s64, -v160
    v_fma_f32 v21, v21, s64, -v160
    v_fma_f32 v22, v22, s64, -v160
    v_fma_f32 v23, v23, s64, -v160
    v_fma_f32 v24, v24, s64, -v160
    v_fma_f32 v25, v25, s64, -v160
    v_fma_f32 v26, v26, s64, -v160
    v_fma_f32 v27, v27, s64, -v160
    v_fma_f32 v28, v28, s64, -v160
    v_fma_f32 v29, v29, s64, -v160
    v_fma_f32 v30, v30, s64, -v160
    v_fma_f32 v31, v31, s64, -v160
    v_exp_f32 v8, v8
    v_exp_f32 v9, v9
    v_exp_f32 v10, v10
    v_exp_f32 v11, v11
    v_exp_f32 v12, v12
    v_exp_f32 v13, v13
    v_exp_f32 v14, v14
    v_exp_f32 v15, v15
    v_exp_f32 v16, v16
    v_exp_f32 v17, v17
    v_exp_f32 v18, v18
    v_exp_f32 v19, v19
    v_exp_f32 v20, v20
    v_exp_f32 v21, v21
    v_exp_f32 v22, v22
    v_exp_f32 v23, v23
    v_exp_f32 v24, v24
    v_exp_f32 v25, v25
    v_exp_f32 v26, v26
    v_exp_f32 v27, v27
    v_exp_f32 v28, v28
    v_exp_f32 v29, v29
    v_exp_f32 v30, v30
    v_exp_f32 v31, v31
    s_waitcnt vmcnt(2)
    buffer_load_dwordx4 v[56:59], v6, s[48:51], s61 offen offset:0 nt
    s_add_u32 s61, s61, 11264
    v_add_f32 v162, v8, v9
    v_add_f32 v163, v10, v11
    v_add_f32 v162, v162, v12
    v_add_f32 v163, v163, v13
    v_add_f32 v162, v162, v14
    v_add_f32 v163, v163, v15
    v_add_f32 v162, v162, v16
    v_add_f32 v163, v163, v17
    v_add_f32 v162, v162, v18
    v_add_f32 v163, v163, v19
    v_add_f32 v162, v162, v20
    v_add_f32 v163, v163, v21
    v_add_f32 v162, v162, v22
    v_add_f32 v163, v163, v23
    v_add_f32 v162, v162, v24
    v_add_f32 v163, v163, v25
    v_add_f32 v162, v162, v26
    v_add_f32 v163, v163, v27
    v_add_f32 v162, v162, v28
    v_add_f32 v163, v163, v29
    v_add_f32 v162, v162, v30
    v_add_f32 v163, v163, v31
    v_add_f32 v162, v162, v163
    v_mov_b32 v163, v162
    s_nop 1
    v_permlane32_swap_b32 v162, v163
    v_add_f32 v162, v162, v163
    v_mov_b32 v163, v162
    s_nop 1
    v_permlane16_swap_b32 v162, v163
    v_add_f32 v161, v162, v163
    s_lshl_b32 s7, s3, 3
    s_add_u32 s7, s7, 0x24200
    v_mov_b32 v164, s7
    ds_write_b64 v164, v[160:161]
    v_mov_b32 v164, 0x24008
    v_mov_b32 v165, 1
    s_waitcnt lgkmcnt(0)
    s_mov_b64 exec, 1
    ds_add_u32 v164, v165
    s_mov_b64 exec, -1
    v_and_b32 v2, 15, v1
    v_lshlrev_b32 v2, 5, v2
    v_bfe_u32 v3, v1, 5, 1
    v_lshl_add_u32 v2, v3, 4, v2
    v_bfe_u32 v3, v1, 4, 1
    v_lshl_add_u32 v2, v3, 3, v2
    s_lshl_b32 s7, s3, 9
    s_add_u32 s7, s7, 0x10000
    v_add_u32 v2, s7, v2
    v_mov_b32 v3, 0x2400c
    v_mov_b32 v4, 1
    v_lshlrev_b32 v160, 16, v128
    v_and_b32 v161, 0xffff0000, v128
    v_lshlrev_b32 v162, 16, v129
    v_and_b32 v163, 0xffff0000, v129
    v_lshlrev_b32 v164, 16, v130
    v_and_b32 v165, 0xffff0000, v130
    v_lshlrev_b32 v166, 16, v131
    v_and_b32 v167, 0xffff0000, v131
    v_pk_mul_f32 v[152:153], v[160:161], v[8:9] op_sel_hi:[1,0]
    v_pk_mul_f32 v[154:155], v[162:163], v[8:9] op_sel_hi:[1,0]
    v_pk_mul_f32 v[156:157], v[164:165], v[8:9] op_sel_hi:[1,0]
    v_pk_mul_f32 v[158:159], v[166:167], v[8:9] op_sel_hi:[1,0]
    v_lshlrev_b32 v160, 16, v132
    v_and_b32 v161, 0xffff0000, v132
    v_lshlrev_b32 v162, 16, v133
    v_and_b32 v163, 0xffff0000, v133
    v_lshlrev_b32 v164, 16, v134
    v_and_b32 v165, 0xffff0000, v134
    v_lshlrev_b32 v166, 16, v135
    v_and_b32 v167, 0xffff0000, v135
    v_pk_fma_f32 v[152:153], v[160:161], v[8:9], v[152:153] op_sel:[0,1,0] op_sel_hi:[1,1,1]
    v_pk_fma_f32 v[154:155], v[162:163], v[8:9], v[154:155] op_sel:[0,1,0] op_sel_hi:[1,1,1]
    v_pk_fma_f32 v[156:157], v[164:165], v[8:9], v[156:157] op_sel:[0,1,0] op_sel_hi:[1,1,1]
    v_pk_fma_f32 v[158:159], v[166:167], v[8:9], v[158:159] op_sel:[0,1,0] op_sel_hi:[1,1,1]
    s_waitcnt vmcnt(2)
    buffer_load_dwordx4 v[60:63], v6, s[48:51], s61 offen offset:0 nt
    s_add_u32 s61, s61, 11264
    v_lshlrev_b32 v160, 16, v136
    v_and_b32 v161, 0xffff0000, v136
    v_lshlrev_b32 v162, 16, v137
    v_and_b32 v163, 0xffff0000, v137
    v_lshlrev_b32 v164, 16, v138
    v_and_b32 v165, 0xffff0000, v138
    v_lshlrev_b32 v166, 16, v139
    v_and_b32 v167, 0xffff0000, v139
    v_pk_fma_f32 v[152:153], v[160:161], v[10:11], v[152:153] op_sel_hi:[1,0,1]
    v_pk_fma_f32 v[154:155], v[162:163], v[10:11], v[154:155] op_sel_hi:[1,0,1]
    v_pk_fma_f32 v[156:157], v[164:165], v[10:11], v[156:157] op_sel_hi:[1,0,1]
    v_pk_fma_f32 v[158:159], v[166:167], v[10:11], v[158:159] op_sel_hi:[1,0,1]
    v_lshlrev_b32 v160, 16, v140
    v_and_b32 v161, 0xffff0000, v140
    v_lshlrev_b32 v162, 16, v141
    v_and_b32 v163, 0xffff0000, v141
    v_lshlrev_b32 v164, 16, v142
    v_and_b32 v165, 0xffff0000, v142
    v_lshlrev_b32 v166, 16, v143
    v_and_b32 v167, 0xffff0000, v143
    v_pk_fma_f32 v[152:153], v[160:161], v[10:11], v[152:153] op_sel:[0,1,0] op_sel_hi:[1,1,1]
    v_pk_fma_f32 v[154:155], v[162:163], v[10:11], v[154:155] op_sel:[0,1,0] op_sel_hi:[1,1,1]
    v_pk_fma_f32 v[156:157], v[164:165], v[10:11], v[156:157] op_sel:[0,1,0] op_sel_hi:[1,1,1]
    v_pk_fma_f32 v[158:159], v[166:167], v[10:11], v[158:159] op_sel:[0,1,0] op_sel_hi:[1,1,1]
    s_waitcnt vmcnt(2)
    buffer_load_dwordx4 v[64:67], v6, s[48:51], s61 offen offset:0 nt
    s_add_u32 s61, s61, 11264
    v_lshlrev_b32 v160, 16, v144
    v_and_b32 v161, 0xffff0000, v144
    v_lshlrev_b32 v162, 16, v145
    v_and_b32 v163, 0xffff0000, v145
    v_lshlrev_b32 v164, 16, v146
    v_and_b32 v165, 0xffff0000, v146
    v_lshlrev_b32 v166, 16, v147
    v_and_b32 v167, 0xffff0000, v147
    v_pk_fma_f32 v[152:153], v[160:161], v[12:13], v[152:153] op_sel_hi:[1,0,1]
    v_pk_fma_f32 v[154:155], v[162:163], v[12:13], v[154:155] op_sel_hi:[1,0,1]
    v_pk_fma_f32 v[156:157], v[164:165], v[12:13], v[156:157] op_sel_hi:[1,0,1]
    v_pk_fma_f32 v[158:159], v[166:167], v[12:13], v[158:159] op_sel_hi:[1,0,1]
    v_lshlrev_b32 v160, 16, v148
    v_and_b32 v161, 0xffff0000, v148
    v_lshlrev_b32 v162, 16, v149
    v_and_b32 v163, 0xffff0000, v149
    v_lshlrev_b32 v164, 16, v150
    v_and_b32 v165, 0xffff0000, v150
    v_lshlrev_b32 v166, 16, v151
    v_and_b32 v167, 0xffff0000, v151
    v_pk_fma_f32 v[152:153], v[160:161], v[12:13], v[152:153] op_sel:[0,1,0] op_sel_hi:[1,1,1]
    v_pk_fma_f32 v[154:155], v[162:163], v[12:13], v[154:155] op_sel:[0,1,0] op_sel_hi:[1,1,1]
    v_pk_fma_f32 v[156:157], v[164:165], v[12:13], v[156:157] op_sel:[0,1,0] op_sel_hi:[1,1,1]
    v_pk_fma_f32 v[158:159], v[166:167], v[12:13], v[158:159] op_sel:[0,1,0] op_sel_hi:[1,1,1]
    s_waitcnt vmcnt(2)
    buffer_load_dwordx4 v[68:71], v6, s[48:51], s61 offen offset:0 nt
    s_add_u32 s61, s61, 11264
    v_lshlrev_b32 v160, 16, v32
    v_and_b32 v161, 0xffff0000, v32
    v_lshlrev_b32 v162, 16, v33
    v_and_b32 v163, 0xffff0000, v33
    v_lshlrev_b32 v164, 16, v34
    v_and_b32 v165, 0xffff0000, v34
    v_lshlrev_b32 v166, 16, v35
    v_and_b32 v167, 0xffff0000, v35
    v_pk_fma_f32 v[152:153], v[160:161], v[14:15], v[152:153] op_sel_hi:[1,0,1]
    v_pk_fma_f32 v[154:155], v[162:163], v[14:15], v[154:155] op_sel_hi:[1,0,1]
    v_pk_fma_f32 v[156:157], v[164:165], v[14:15], v[156:157] op_sel_hi:[1,0,1]
    v_pk_fma_f32 v[158:159], v[166:167], v[14:15], v[158:159] op_sel_hi:[1,0,1]
    v_lshlrev_b32 v160, 16, v36
    v_and_b32 v161, 0xffff0000, v36
    v_lshlrev_b32 v162, 16, v37
    v_and_b32 v163, 0xffff0000, v37
    v_lshlrev_b32 v164, 16, v38
    v_and_b32 v165, 0xffff0000, v38
    v_lshlrev_b32 v166, 16, v39
    v_and_b32 v167, 0xffff0000, v39
    v_pk_fma_f32 v[152:153], v[160:161], v[14:15], v[152:153] op_sel:[0,1,0] op_sel_hi:[1,1,1]
    v_pk_fma_f32 v[154:155], v[162:163], v[14:15], v[154:155] op_sel:[0,1,0] op_sel_hi:[1,1,1]
    v_pk_fma_f32 v[156:157], v[164:165], v[14:15], v[156:157] op_sel:[0,1,0] op_sel_hi:[1,1,1]
    v_pk_fma_f32 v[158:159], v[166:167], v[14:15], v[158:159] op_sel:[0,1,0] op_sel_hi:[1,1,1]
    s_waitcnt vmcnt(2)
    buffer_load_dwordx4 v[72:75], v6, s[48:51], s61 offen offset:0 nt
    s_add_u32 s61, s61, 11264
    v_lshlrev_b32 v160, 16, v40
    v_and_b32 v161, 0xffff0000, v40
    v_lshlrev_b32 v162, 16, v41
    v_and_b32 v163, 0xffff0000, v41
    v_lshlrev_b32 v164, 16, v42
    v_and_b32 v165, 0xffff0000, v42
    v_lshlrev_b32 v166, 16, v43
    v_and_b32 v167, 0xffff0000, v43
    v_pk_fma_f32 v[152:153], v[160:161], v[16:17], v[152:153] op_sel_hi:[1,0,1]
    v_pk_fma_f32 v[154:155], v[162:163], v[16:17], v[154:155] op_sel_hi:[1,0,1]
    v_pk_fma_f32 v[156:157], v[164:165], v[16:17], v[156:157] op_sel_hi:[1,0,1]
    v_pk_fma_f32 v[158:159], v[166:167], v[16:17], v[158:159] op_sel_hi:[1,0,1]
    v_lshlrev_b32 v160, 16, v44
    v_and_b32 v161, 0xffff0000, v44
    v_lshlrev_b32 v162, 16, v45
    v_and_b32 v163, 0xffff0000, v45
    v_lshlrev_b32 v164, 16, v46
    v_and_b32 v165, 0xffff0000, v46
    v_lshlrev_b32 v166, 16, v47
    v_and_b32 v167, 0xffff0000, v47
    v_pk_fma_f32 v[152:153], v[160:161], v[16:17], v[152:153] op_sel:[0,1,0] op_sel_hi:[1,1,1]
    v_pk_fma_f32 v[154:155], v[162:163], v[16:17], v[154:155] op_sel:[0,1,0] op_sel_hi:[1,1,1]
    v_pk_fma_f32 v[156:157], v[164:165], v[16:17], v[156:157] op_sel:[0,1,0] op_sel_hi:[1,1,1]
    v_pk_fma_f32 v[158:159], v[166:167], v[16:17], v[158:159] op_sel:[0,1,0] op_sel_hi:[1,1,1]
    s_waitcnt vmcnt(2)
    buffer_load_dwordx4 v[76:79], v6, s[48:51], s61 offen offset:0 nt
    s_add_u32 s61, s61, 11264
    v_lshlrev_b32 v160, 16, v48
    v_and_b32 v161, 0xffff0000, v48
    v_lshlrev_b32 v162, 16, v49
    v_and_b32 v163, 0xffff0000, v49
    v_lshlrev_b32 v164, 16, v50
    v_and_b32 v165, 0xffff0000, v50
    v_lshlrev_b32 v166, 16, v51
    v_and_b32 v167, 0xffff0000, v51
    v_pk_fma_f32 v[152:153], v[160:161], v[18:19], v[152:153] op_sel_hi:[1,0,1]
    v_pk_fma_f32 v[154:155], v[162:163], v[18:19], v[154:155] op_sel_hi:[1,0,1]
    v_pk_fma_f32 v[156:157], v[164:165], v[18:19], v[156:157] op_sel_hi:[1,0,1]
    v_pk_fma_f32 v[158:159], v[166:167], v[18:19], v[158:159] op_sel_hi:[1,0,1]
    v_lshlrev_b32 v160, 16, v52
    v_and_b32 v161, 0xffff0000, v52
    v_lshlrev_b32 v162, 16, v53
    v_and_b32 v163, 0xffff0000, v53
    v_lshlrev_b32 v164, 16, v54
    v_and_b32 v165, 0xffff0000, v54
    v_lshlrev_b32 v166, 16, v55
    v_and_b32 v167, 0xffff0000, v55
    v_pk_fma_f32 v[152:153], v[160:161], v[18:19], v[152:153] op_sel:[0,1,0] op_sel_hi:[1,1,1]
    v_pk_fma_f32 v[154:155], v[162:163], v[18:19], v[154:155] op_sel:[0,1,0] op_sel_hi:[1,1,1]
    v_pk_fma_f32 v[156:157], v[164:165], v[18:19], v[156:157] op_sel:[0,1,0] op_sel_hi:[1,1,1]
    v_pk_fma_f32 v[158:159], v[166:167], v[18:19], v[158:159] op_sel:[0,1,0] op_sel_hi:[1,1,1]
    s_waitcnt vmcnt(2)
    buffer_load_dwordx4 v[80:83], v6, s[48:51], s61 offen offset:0 nt
    s_add_u32 s61, s61, 11264
    v_lshlrev_b32 v160, 16, v56
    v_and_b32 v161, 0xffff0000, v56
    v_lshlrev_b32 v162, 16, v57
    v_and_b32 v163, 0xffff0000, v57
    v_lshlrev_b32 v164, 16, v58
    v_and_b32 v165, 0xffff0000, v58
    v_lshlrev_b32 v166, 16, v59
    v_and_b32 v167, 0xffff0000, v59
    v_pk_fma_f32 v[152:153], v[160:161], v[20:21], v[152:153] op_sel_hi:[1,0,1]
    v_pk_fma_f32 v[154:155], v[162:163], v[20:21], v[154:155] op_sel_hi:[1,0,1]
    v_pk_fma_f32 v[156:157], v[164:165], v[20:21], v[156:157] op_sel_hi:[1,0,1]
    v_pk_fma_f32 v[158:159], v[166:167], v[20:21], v[158:159] op_sel_hi:[1,0,1]
    v_lshlrev_b32 v160, 16, v60
    v_and_b32 v161, 0xffff0000, v60
    v_lshlrev_b32 v162, 16, v61
    v_and_b32 v163, 0xffff0000, v61
    v_lshlrev_b32 v164, 16, v62
    v_and_b32 v165, 0xffff0000, v62
    v_lshlrev_b32 v166, 16, v63
    v_and_b32 v167, 0xffff0000, v63
    v_pk_fma_f32 v[152:153], v[160:161], v[20:21], v[152:153] op_sel:[0,1,0] op_sel_hi:[1,1,1]
    v_pk_fma_f32 v[154:155], v[162:163], v[20:21], v[154:155] op_sel:[0,1,0] op_sel_hi:[1,1,1]
    v_pk_fma_f32 v[156:157], v[164:165], v[20:21], v[156:157] op_sel:[0,1,0] op_sel_hi:[1,1,1]
    v_pk_fma_f32 v[158:159], v[166:167], v[20:21], v[158:159] op_sel:[0,1,0] op_sel_hi:[1,1,1]
    s_waitcnt vmcnt(2)
    buffer_load_dwordx4 v[84:87], v6, s[48:51], s61 offen offset:0 nt
    s_add_u32 s61, s61, 11264
    v_lshlrev_b32 v160, 16, v64
    v_and_b32 v161, 0xffff0000, v64
    v_lshlrev_b32 v162, 16, v65
    v_and_b32 v163, 0xffff0000, v65
    v_lshlrev_b32 v164, 16, v66
    v_and_b32 v165, 0xffff0000, v66
    v_lshlrev_b32 v166, 16, v67
    v_and_b32 v167, 0xffff0000, v67
    v_pk_fma_f32 v[152:153], v[160:161], v[22:23], v[152:153] op_sel_hi:[1,0,1]
    v_pk_fma_f32 v[154:155], v[162:163], v[22:23], v[154:155] op_sel_hi:[1,0,1]
    v_pk_fma_f32 v[156:157], v[164:165], v[22:23], v[156:157] op_sel_hi:[1,0,1]
    v_pk_fma_f32 v[158:159], v[166:167], v[22:23], v[158:159] op_sel_hi:[1,0,1]
    v_lshlrev_b32 v160, 16, v68
    v_and_b32 v161, 0xffff0000, v68
    v_lshlrev_b32 v162, 16, v69
    v_and_b32 v163, 0xffff0000, v69
    v_lshlrev_b32 v164, 16, v70
    v_and_b32 v165, 0xffff0000, v70
    v_lshlrev_b32 v166, 16, v71
    v_and_b32 v167, 0xffff0000, v71
    v_pk_fma_f32 v[152:153], v[160:161], v[22:23], v[152:153] op_sel:[0,1,0] op_sel_hi:[1,1,1]
    v_pk_fma_f32 v[154:155], v[162:163], v[22:23], v[154:155] op_sel:[0,1,0] op_sel_hi:[1,1,1]
    v_pk_fma_f32 v[156:157], v[164:165], v[22:23], v[156:157] op_sel:[0,1,0] op_sel_hi:[1,1,1]
    v_pk_fma_f32 v[158:159], v[166:167], v[22:23], v[158:159] op_sel:[0,1,0] op_sel_hi:[1,1,1]
    s_waitcnt vmcnt(2)
    buffer_load_dwordx4 v[88:91], v6, s[48:51], s61 offen offset:0 nt
    s_add_u32 s61, s61, 11264
    v_lshlrev_b32 v160, 16, v72
    v_and_b32 v161, 0xffff0000, v72
    v_lshlrev_b32 v162, 16, v73
    v_and_b32 v163, 0xffff0000, v73
    v_lshlrev_b32 v164, 16, v74
    v_and_b32 v165, 0xffff0000, v74
    v_lshlrev_b32 v166, 16, v75
    v_and_b32 v167, 0xffff0000, v75
    v_pk_fma_f32 v[152:153], v[160:161], v[24:25], v[152:153] op_sel_hi:[1,0,1]
    v_pk_fma_f32 v[154:155], v[162:163], v[24:25], v[154:155] op_sel_hi:[1,0,1]
    v_pk_fma_f32 v[156:157], v[164:165], v[24:25], v[156:157] op_sel_hi:[1,0,1]
    v_pk_fma_f32 v[158:159], v[166:167], v[24:25], v[158:159] op_sel_hi:[1,0,1]
    v_lshlrev_b32 v160, 16, v76
    v_and_b32 v161, 0xffff0000, v76
    v_lshlrev_b32 v162, 16, v77
    v_and_b32 v163, 0xffff0000, v77
    v_lshlrev_b32 v164, 16, v78
    v_and_b32 v165, 0xffff0000, v78
    v_lshlrev_b32 v166, 16, v79
    v_and_b32 v167, 0xffff0000, v79
    v_pk_fma_f32 v[152:153], v[160:161], v[24:25], v[152:153] op_sel:[0,1,0] op_sel_hi:[1,1,1]
    v_pk_fma_f32 v[154:155], v[162:163], v[24:25], v[154:155] op_sel:[0,1,0] op_sel_hi:[1,1,1]
    v_pk_fma_f32 v[156:157], v[164:165], v[24:25], v[156:157] op_sel:[0,1,0] op_sel_hi:[1,1,1]
    v_pk_fma_f32 v[158:159], v[166:167], v[24:25], v[158:159] op_sel:[0,1,0] op_sel_hi:[1,1,1]
    s_waitcnt vmcnt(2)
    buffer_load_dwordx4 v[92:95], v6, s[48:51], s61 offen offset:0 nt
    s_add_u32 s61, s61, 11264
    v_lshlrev_b32 v160, 16, v80
    v_and_b32 v161, 0xffff0000, v80
    v_lshlrev_b32 v162, 16, v81
    v_and_b32 v163, 0xffff0000, v81
    v_lshlrev_b32 v164, 16, v82
    v_and_b32 v165, 0xffff0000, v82
    v_lshlrev_b32 v166, 16, v83
    v_and_b32 v167, 0xffff0000, v83
    v_pk_fma_f32 v[152:153], v[160:161], v[26:27], v[152:153] op_sel_hi:[1,0,1]
    v_pk_fma_f32 v[154:155], v[162:163], v[26:27], v[154:155] op_sel_hi:[1,0,1]
    v_pk_fma_f32 v[156:157], v[164:165], v[26:27], v[156:157] op_sel_hi:[1,0,1]
    v_pk_fma_f32 v[158:159], v[166:167], v[26:27], v[158:159] op_sel_hi:[1,0,1]
    s_waitcnt vmcnt(2)
    v_lshlrev_b32 v160, 16, v84
    v_and_b32 v161, 0xffff0000, v84
    v_lshlrev_b32 v162, 16, v85
    v_and_b32 v163, 0xffff0000, v85
    v_lshlrev_b32 v164, 16, v86
    v_and_b32 v165, 0xffff0000, v86
    v_lshlrev_b32 v166, 16, v87
    v_and_b32 v167, 0xffff0000, v87
    v_pk_fma_f32 v[152:153], v[160:161], v[26:27], v[152:153] op_sel:[0,1,0] op_sel_hi:[1,1,1]
    v_pk_fma_f32 v[154:155], v[162:163], v[26:27], v[154:155] op_sel:[0,1,0] op_sel_hi:[1,1,1]
    v_pk_fma_f32 v[156:157], v[164:165], v[26:27], v[156:157] op_sel:[0,1,0] op_sel_hi:[1,1,1]
    v_pk_fma_f32 v[158:159], v[166:167], v[26:27], v[158:159] op_sel:[0,1,0] op_sel_hi:[1,1,1]
    buffer_load_dwordx4 v[96:99], v6, s[48:51], s61 offen offset:0 nt
    s_waitcnt vmcnt(2)
    v_lshlrev_b32 v160, 16, v88
    v_and_b32 v161, 0xffff0000, v88
    v_lshlrev_b32 v162, 16, v89
    v_and_b32 v163, 0xffff0000, v89
    v_lshlrev_b32 v164, 16, v90
    v_and_b32 v165, 0xffff0000, v90
    v_lshlrev_b32 v166, 16, v91
    v_and_b32 v167, 0xffff0000, v91
    v_pk_fma_f32 v[152:153], v[160:161], v[28:29], v[152:153] op_sel_hi:[1,0,1]
    v_pk_fma_f32 v[154:155], v[162:163], v[28:29], v[154:155] op_sel_hi:[1,0,1]
    v_pk_fma_f32 v[156:157], v[164:165], v[28:29], v[156:157] op_sel_hi:[1,0,1]
    v_pk_fma_f32 v[158:159], v[166:167], v[28:29], v[158:159] op_sel_hi:[1,0,1]
    buffer_load_dwordx4 v[100:103], v6, s[48:51], s63 offen offset:0 nt
    s_waitcnt vmcnt(2)
    v_lshlrev_b32 v160, 16, v92
    v_and_b32 v161, 0xffff0000, v92
    v_lshlrev_b32 v162, 16, v93
    v_and_b32 v163, 0xffff0000, v93
    v_lshlrev_b32 v164, 16, v94
    v_and_b32 v165, 0xffff0000, v94
    v_lshlrev_b32 v166, 16, v95
    v_and_b32 v167, 0xffff0000, v95
    v_pk_fma_f32 v[152:153], v[160:161], v[28:29], v[152:153] op_sel:[0,1,0] op_sel_hi:[1,1,1]
    v_pk_fma_f32 v[154:155], v[162:163], v[28:29], v[154:155] op_sel:[0,1,0] op_sel_hi:[1,1,1]
    v_pk_fma_f32 v[156:157], v[164:165], v[28:29], v[156:157] op_sel:[0,1,0] op_sel_hi:[1,1,1]
    v_pk_fma_f32 v[158:159], v[166:167], v[28:29], v[158:159] op_sel:[0,1,0] op_sel_hi:[1,1,1]
    s_waitcnt vmcnt(1)
    v_lshlrev_b32 v160, 16, v96
    v_and_b32 v161, 0xffff0000, v96
    v_lshlrev_b32 v162, 16, v97
    v_and_b32 v163, 0xffff0000, v97
    v_lshlrev_b32 v164, 16, v98
    v_and_b32 v165, 0xffff0000, v98
    v_lshlrev_b32 v166, 16, v99
    v_and_b32 v167, 0xffff0000, v99
    v_pk_fma_f32 v[152:153], v[160:161], v[30:31], v[152:153] op_sel_hi:[1,0,1]
    v_pk_fma_f32 v[154:155], v[162:163], v[30:31], v[154:155] op_sel_hi:[1,0,1]
    v_pk_fma_f32 v[156:157], v[164:165], v[30:31], v[156:157] op_sel_hi:[1,0,1]
    v_pk_fma_f32 v[158:159], v[166:167], v[30:31], v[158:159] op_sel_hi:[1,0,1]
    s_waitcnt vmcnt(0)
    v_lshlrev_b32 v160, 16, v100
    v_and_b32 v161, 0xffff0000, v100
    v_lshlrev_b32 v162, 16, v101
    v_and_b32 v163, 0xffff0000, v101
    v_lshlrev_b32 v164, 16, v102
    v_and_b32 v165, 0xffff0000, v102
    v_lshlrev_b32 v166, 16, v103
    v_and_b32 v167, 0xffff0000, v103
    v_pk_fma_f32 v[152:153], v[160:161], v[30:31], v[152:153] op_sel:[0,1,0] op_sel_hi:[1,1,1]
    v_pk_fma_f32 v[154:155], v[162:163], v[30:31], v[154:155] op_sel:[0,1,0] op_sel_hi:[1,1,1]
    v_pk_fma_f32 v[156:157], v[164:165], v[30:31], v[156:157] op_sel:[0,1,0] op_sel_hi:[1,1,1]
    v_pk_fma_f32 v[158:159], v[166:167], v[30:31], v[158:159] op_sel:[0,1,0] op_sel_hi:[1,1,1]
    s_nop 0
    v_permlane32_swap_b32 v152, v156
    v_permlane32_swap_b32 v153, v157
    v_permlane32_swap_b32 v154, v158
    v_permlane32_swap_b32 v155, v159
    v_add_f32 v152, v152, v156
    v_add_f32 v153, v153, v157
    v_add_f32 v154, v154, v158
    v_add_f32 v155, v155, v159
    s_nop 0
    v_permlane16_swap_b32 v152, v154
    v_permlane16_swap_b32 v153, v155
    v_add_f32 v152, v152, v154
    v_add_f32 v153, v153, v155
    ds_write_b64 v2, v[152:153]
    s_waitcnt lgkmcnt(0)
    s_mov_b64 exec, 1
    ds_add_u32 v3, v4
    s_mov_b64 exec, -1
    s_endpgm
L_ASVC:
    s_setprio 3
    s_lshr_b32 s60, s5, 2
    s_sub_u32 s60, s60, 4
    s_lshl_b32 s7, s6, 2
    s_add_u32 s7, s7, s60
    s_lshl_b32 s61, s7, 8
    s_add_u32 s61, s61, 0xa0000
    v_lshlrev_b32 v2, 2, v1
    v_add_u32 v2, s61, v2
    v_mov_b32 v8, -1
    v_mov_b32 v9, -1
    v_mov_b32 v10, -1
    v_mov_b32 v11, -1
    s_lshl_b32 s7, s7, 10
    v_lshl_add_u32 v3, v1, 4, s7
    v_add_u32 v5, 0x40000, v3
    v_add_u32 v3, 0x80000, v3
    buffer_store_dwordx4 v[8:11], v5, s[36:39], 0 offen sc1
    s_lshl_b32 s7, s6, 4
    s_add_u32 s7, s7, s60
    s_lshl_b32 s7, s7, 8
    s_add_u32 s7, s7, 0x80000
    v_lshrrev_b32 v6, 4, v1
    v_lshlrev_b32 v6, 10, v6
    v_and_b32 v100, 15, v1
    v_lshl_add_u32 v6, v100, 4, v6
    v_add_u32 v6, s7, v6
    buffer_store_dwordx4 v[8:11], v6, s[36:39], 0 offen sc1
    buffer_store_dword v8, v2, s[36:39], 0 offen sc1
    s_barrier
    s_sleep 8
    v_mov_b32 v100, 0
    s_mov_b32 s80, 200000
NG_8:
    s_mov_b64 exec, 1
    buffer_load_dwordx2 v[102:103], v100, s[40:43], 0 offen sc1
    s_mov_b64 exec, -1
    s_waitcnt vmcnt(0)
    v_readfirstlane_b32 s94, v102
    v_readfirstlane_b32 s95, v103
    s_cmp_lg_u32 s95, 0
    s_cbranch_scc1 NGD_9
    s_sleep 4
    s_sub_u32 s80, s80, 1
    s_cmp_lg_u32 s80, 0
    s_cbranch_scc1 NG_8
NGD_9:
    s_lshl_b32 s7, s4, 5
    s_add_u32 s7, s7, s5
    s_lshl_b32 s7, s7, 3
    s_add_u32 s7, s7, 0xc0000
    v_mov_b32 v100, s7
    v_mov_b32 v102, s94
    v_mov_b32 v103, s95
    s_mov_b64 exec, 1
    buffer_store_dwordx2 v[102:103], v100, s[36:39], 0 offen sc1
    s_mov_b64 exec, -1
    v_lshlrev_b32 v7, 5, v1
    v_mov_b32 v100, 0x24044
    s_mov_b32 s80, 1600000
LW_10:
    ds_read_b32 v101, v100
    s_waitcnt lgkmcnt(0)
    v_readfirstlane_b32 s79, v101
    s_cmp_ge_u32 s79, 4
    s_cbranch_scc1 LWD_11
    s_sub_u32 s80, s80, 1
    s_cmp_lg_u32 s80, 0
    s_cbranch_scc1 LW_10
LWD_11:
    ds_read_b128 v[16:19], v7 offset:0
    ds_read_b128 v[20:23], v7 offset:16
    ds_read_b128 v[24:27], v7 offset:2048
    ds_read_b128 v[28:31], v7 offset:2064
    ds_read_b128 v[32:35], v7 offset:4096
    ds_read_b128 v[36:39], v7 offset:4112
    ds_read_b128 v[40:43], v7 offset:6144
    ds_read_b128 v[44:47], v7 offset:6160
    s_waitcnt lgkmcnt(0)
    v_pk_add_f32 v[16:17], v[16:17], v[32:33]
    v_pk_add_f32 v[18:19], v[18:19], v[34:35]
    v_pk_add_f32 v[20:21], v[20:21], v[36:37]
    v_pk_add_f32 v[22:23], v[22:23], v[38:39]
    v_pk_add_f32 v[24:25], v[24:25], v[40:41]
    v_pk_add_f32 v[26:27], v[26:27], v[42:43]
    v_pk_add_f32 v[28:29], v[28:29], v[44:45]
    v_pk_add_f32 v[30:31], v[30:31], v[46:47]
    v_pk_add_f32 v[16:17], v[16:17], v[24:25]
    v_pk_add_f32 v[18:19], v[18:19], v[26:27]
    v_pk_add_f32 v[20:21], v[20:21], v[28:29]
    v_pk_add_f32 v[22:23], v[22:23], v[30:31]
    v_cvt_pk_bf16_f32 v8, v16, v17
    v_cvt_pk_bf16_f32 v9, v18, v19
    v_cvt_pk_bf16_f32 v10, v20, v21
    v_cvt_pk_bf16_f32 v11, v22, v23
    buffer_store_dwordx4 v[8:11], v5, s[36:39], 0 offen sc1
    v_mov_b32 v100, 0x24040
    s_mov_b32 s80, 1600000
LW_12:
    ds_read_b32 v101, v100
    s_waitcnt lgkmcnt(0)
    v_readfirstlane_b32 s79, v101
    s_cmp_ge_u32 s79, 4
    s_cbranch_scc1 LWD_13
    s_sub_u32 s80, s80, 1
    s_cmp_lg_u32 s80, 0
    s_cbranch_scc1 LW_12
LWD_13:
    ds_read_b128 v[16:19], v7 offset:8192
    ds_read_b128 v[20:23], v7 offset:8208
    ds_read_b128 v[24:27], v7 offset:10240
    ds_read_b128 v[28:31], v7 offset:10256
    ds_read_b128 v[32:35], v7 offset:12288
    ds_read_b128 v[36:39], v7 offset:12304
    ds_read_b128 v[40:43], v7 offset:14336
    ds_read_b128 v[44:47], v7 offset:14352
    s_waitcnt lgkmcnt(0)
    v_pk_add_f32 v[16:17], v[16:17], v[32:33]
    v_pk_add_f32 v[18:19], v[18:19], v[34:35]
    v_pk_add_f32 v[20:21], v[20:21], v[36:37]
    v_pk_add_f32 v[22:23], v[22:23], v[38:39]
    v_pk_add_f32 v[24:25], v[24:25], v[40:41]
    v_pk_add_f32 v[26:27], v[26:27], v[42:43]
    v_pk_add_f32 v[28:29], v[28:29], v[44:45]
    v_pk_add_f32 v[30:31], v[30:31], v[46:47]
    v_pk_add_f32 v[16:17], v[16:17], v[24:25]
    v_pk_add_f32 v[18:19], v[18:19], v[26:27]
    v_pk_add_f32 v[20:21], v[20:21], v[28:29]
    v_pk_add_f32 v[22:23], v[22:23], v[30:31]
    v_cvt_pk_bf16_f32 v12, v16, v17
    v_cvt_pk_bf16_f32 v13, v18, v19
    v_cvt_pk_bf16_f32 v14, v20, v21
    v_cvt_pk_bf16_f32 v15, v22, v23
    buffer_store_dwordx4 v[12:15], v6, s[36:39], 0 offen sc1
    v_and_b32 v100, 15, v1
    s_lshl_b32 s7, s4, 8
    s_add_u32 s7, s7, 0xc0080
    v_lshl_add_u32 v100, v100, 3, s7
    s_mov_b32 s80, 200000
FW_14:
    buffer_load_dwordx2 v[102:103], v100, s[36:39], 0 offen sc1
    s_waitcnt vmcnt(0)
    v_cmp_ne_u64 vcc, s[94:95], v[102:103]
    s_cbranch_vccz FWD_15
    s_sleep 8
    s_sub_u32 s80, s80, 1
    s_cmp_lg_u32 s80, 0
    s_cbranch_scc1 FW_14
FWD_15:
    s_mov_b32 s80, 200000
PO_16:
    buffer_load_dwordx4 v[8:11], v3, s[36:39], 0 offen sc1
PO2_17:
    s_waitcnt vmcnt(0)
    v_max_u32 v100, v8, v9
    v_max3_u32 v100, v100, v10, v11
    v_cmp_eq_u32 vcc, -1, v100
    s_cbranch_vccz POD_18
    s_sleep 8
    s_sub_u32 s80, s80, 1
    s_cmp_lg_u32 s80, 0
    s_cbranch_scc1 PO_16
POD_18:
    v_lshlrev_b32 v16, 16, v8
    v_and_b32 v17, 0xffff0000, v8
    v_lshlrev_b32 v18, 16, v9
    v_and_b32 v19, 0xffff0000, v9
    v_lshlrev_b32 v20, 16, v10
    v_and_b32 v21, 0xffff0000, v10
    v_lshlrev_b32 v22, 16, v11
    v_and_b32 v23, 0xffff0000, v11
    v_mov_b32 v24, v16
    v_mov_b32 v25, v17
    v_mov_b32 v26, v18
    v_mov_b32 v27, v19
    v_mov_b32 v28, v20
    v_mov_b32 v29, v21
    v_mov_b32 v30, v22
    v_mov_b32 v31, v23
    v_permlane32_swap_b32 v16, v24
    v_permlane32_swap_b32 v17, v25
    v_permlane32_swap_b32 v18, v26
    v_permlane32_swap_b32 v19, v27
    v_permlane32_swap_b32 v20, v28
    v_permlane32_swap_b32 v21, v29
    v_permlane32_swap_b32 v22, v30
    v_permlane32_swap_b32 v23, v31
    v_add_f32 v16, v16, v24
    v_add_f32 v17, v17, v25
    v_add_f32 v18, v18, v26
    v_add_f32 v19, v19, v27
    v_add_f32 v20, v20, v28
    v_add_f32 v21, v21, v29
    v_add_f32 v22, v22, v30
    v_add_f32 v23, v23, v31
    v_mov_b32 v24, v16
    v_mov_b32 v25, v17
    v_mov_b32 v26, v18
    v_mov_b32 v27, v19
    v_mov_b32 v28, v20
    v_mov_b32 v29, v21
    v_mov_b32 v30, v22
    v_mov_b32 v31, v23
    v_permlane16_swap_b32 v16, v24
    v_permlane16_swap_b32 v17, v25
    v_permlane16_swap_b32 v18, v26
    v_permlane16_swap_b32 v19, v27
    v_permlane16_swap_b32 v20, v28
    v_permlane16_swap_b32 v21, v29
    v_permlane16_swap_b32 v22, v30
    v_permlane16_swap_b32 v23, v31
    v_add_f32 v16, v16, v24
    v_add_f32 v17, v17, v25
    v_add_f32 v18, v18, v26
    v_add_f32 v19, v19, v27
    v_add_f32 v20, v20, v28
    v_add_f32 v21, v21, v29
    v_add_f32 v22, v22, v30
    v_add_f32 v23, v23, v31
    v_cvt_pk_bf16_f32 v8, v16, v17
    v_cvt_pk_bf16_f32 v9, v18, v19
    v_cvt_pk_bf16_f32 v10, v20, v21
    v_cvt_pk_bf16_f32 v11, v22, v23
    v_and_b32 v100, 15, v1
    v_lshlrev_b32 v100, 4, v100
    v_add_u32 v100, 0x24100, v100
    ds_write_b128 v100, v[8:11]
    v_mov_b32 v100, 0x24004
    v_mov_b32 v101, 1
    s_waitcnt lgkmcnt(0)
    s_mov_b64 exec, 1
    ds_add_u32 v100, v101
    s_mov_b64 exec, -1
    v_mov_b32 v100, 0x24008
    s_mov_b32 s80, 1600000
LW_19:
    ds_read_b32 v101, v100
    s_waitcnt lgkmcnt(0)
    v_readfirstlane_b32 s79, v101
    s_cmp_ge_u32 s79, 11
    s_cbranch_scc1 LWD_20
    s_sleep 8
    s_sub_u32 s80, s80, 1
    s_cmp_lg_u32 s80, 0
    s_cbranch_scc1 LW_19
LWD_20:
    v_mov_b32 v100, 0x24200
    ds_read_b128 v[8:11], v100 offset:0
    ds_read_b128 v[12:15], v100 offset:16
    ds_read_b128 v[16:19], v100 offset:32
    ds_read_b128 v[20:23], v100 offset:48
    ds_read_b128 v[24:27], v100 offset:64
    ds_read_b128 v[28:31], v100 offset:80
    s_waitcnt lgkmcnt(0)
    v_max3_f32 v100, v8, v10, v12
    v_max3_f32 v100, v100, v14, v16
    v_max3_f32 v100, v100, v18, v20
    v_max3_f32 v100, v100, v22, v24
    v_max3_f32 v100, v100, v26, v28
    v_sub_f32 v8, v8, v100
    v_sub_f32 v10, v10, v100
    v_sub_f32 v12, v12, v100
    v_sub_f32 v14, v14, v100
    v_sub_f32 v16, v16, v100
    v_sub_f32 v18, v18, v100
    v_sub_f32 v20, v20, v100
    v_sub_f32 v22, v22, v100
    v_sub_f32 v24, v24, v100
    v_sub_f32 v26, v26, v100
    v_sub_f32 v28, v28, v100
    v_exp_f32 v8, v8
    v_exp_f32 v10, v10
    v_exp_f32 v12, v12
    v_exp_f32 v14, v14
    v_exp_f32 v16, v16
    v_exp_f32 v18, v18
    v_exp_f32 v20, v20
    v_exp_f32 v22, v22
    v_exp_f32 v24, v24
    v_exp_f32 v26, v26
    v_exp_f32 v28, v28
    v_mul_f32 v101, v8, v9
    v_fmac_f32 v101, v10, v11
    v_fmac_f32 v101, v12, v13
    v_fmac_f32 v101, v14, v15
    v_fmac_f32 v101, v16, v17
    v_fmac_f32 v101, v18, v19
    v_fmac_f32 v101, v20, v21
    v_fmac_f32 v101, v22, v23
    v_fmac_f32 v101, v24, v25
    v_fmac_f32 v101, v26, v27
    v_fmac_f32 v101, v28, v29
    v_rcp_f32 v101, v101
    s_nop 0
    v_mul_f32 v8, v8, v101
    v_mul_f32 v10, v10, v101
    v_mul_f32 v12, v12, v101
    v_mul_f32 v14, v14, v101
    v_mul_f32 v16, v16, v101
    v_mul_f32 v18, v18, v101
    v_mul_f32 v20, v20, v101
    v_mul_f32 v22, v22, v101
    v_mul_f32 v24, v24, v101
    v_mul_f32 v26, v26, v101
    v_mul_f32 v28, v28, v101
    v_lshlrev_b32 v3, 3, v1
    v_add_u32 v3, 0x10000, v3
    v_mov_b32 v100, 0x2400c
    s_mov_b32 s80, 1600000
LW_21:
    ds_read_b32 v101, v100
    s_waitcnt lgkmcnt(0)
    v_readfirstlane_b32 s79, v101
    s_cmp_ge_u32 s79, 11
    s_cbranch_scc1 LWD_22
    s_sub_u32 s80, s80, 1
    s_cmp_lg_u32 s80, 0
    s_cbranch_scc1 LW_21
LWD_22:
    ds_read_b64 v[40:41], v3 offset:0
    ds_read_b64 v[42:43], v3 offset:512
    ds_read_b64 v[44:45], v3 offset:1024
    ds_read_b64 v[46:47], v3 offset:1536
    ds_read_b64 v[48:49], v3 offset:2048
    ds_read_b64 v[50:51], v3 offset:2560
    ds_read_b64 v[52:53], v3 offset:3072
    ds_read_b64 v[54:55], v3 offset:3584
    ds_read_b64 v[56:57], v3 offset:4096
    ds_read_b64 v[58:59], v3 offset:4608
    ds_read_b64 v[60:61], v3 offset:5120
    s_waitcnt lgkmcnt(10)
    v_pk_mul_f32 v[4:5], v[40:41], v[8:9] op_sel_hi:[1,0]
    s_waitcnt lgkmcnt(9)
    v_pk_mul_f32 v[6:7], v[42:43], v[10:11] op_sel_hi:[1,0]
    s_waitcnt lgkmcnt(8)
    v_pk_fma_f32 v[4:5], v[44:45], v[12:13], v[4:5] op_sel_hi:[1,0,1]
    s_waitcnt lgkmcnt(7)
    v_pk_fma_f32 v[6:7], v[46:47], v[14:15], v[6:7] op_sel_hi:[1,0,1]
    s_waitcnt lgkmcnt(6)
    v_pk_fma_f32 v[4:5], v[48:49], v[16:17], v[4:5] op_sel_hi:[1,0,1]
    s_waitcnt lgkmcnt(5)
    v_pk_fma_f32 v[6:7], v[50:51], v[18:19], v[6:7] op_sel_hi:[1,0,1]
    s_waitcnt lgkmcnt(4)
    v_pk_fma_f32 v[4:5], v[52:53], v[20:21], v[4:5] op_sel_hi:[1,0,1]
    s_waitcnt lgkmcnt(3)
    v_pk_fma_f32 v[6:7], v[54:55], v[22:23], v[6:7] op_sel_hi:[1,0,1]
    s_waitcnt lgkmcnt(2)
    v_pk_fma_f32 v[4:5], v[56:57], v[24:25], v[4:5] op_sel_hi:[1,0,1]
    s_waitcnt lgkmcnt(1)
    v_pk_fma_f32 v[6:7], v[58:59], v[26:27], v[6:7] op_sel_hi:[1,0,1]
    s_waitcnt lgkmcnt(0)
    v_pk_fma_f32 v[4:5], v[60:61], v[28:29], v[4:5] op_sel_hi:[1,0,1]
    v_add_f32 v4, v4, v6
    v_add_f32 v5, v5, v7
    v_cvt_pk_bf16_f32 v4, v4, v5
    buffer_store_dword v4, v2, s[36:39], 0 offen sc1
    s_endpgm
L_W:
    s_mov_b32 s92, 0x05040100
    s_mov_b32 s93, 0x07060302
    s_cmp_ge_u32 s3, 8
    s_cbranch_scc1 L_W2
    s_cmp_ge_u32 s3, 4
    s_cbranch_scc1 L_W1
    s_barrier
    s_cmp_ge_u32 s5, 4
    s_cbranch_scc1 L_END
    v_mov_b32 v160, 0x24048
    s_mov_b32 s80, 1600000
LW_23:
    ds_read_b32 v161, v160
    s_waitcnt lgkmcnt(0)
    v_readfirstlane_b32 s79, v161
    s_cmp_ge_u32 s79, 4
    s_cbranch_scc1 LWD_24
    s_sleep 4
    s_sub_u32 s80, s80, 1
    s_cmp_lg_u32 s80, 0
    s_cbranch_scc1 LW_23
LWD_24:
    s_branch L_U1
L_W1:
    s_setprio 3
    s_cmp_lg_u32 s3, 4
    s_cbranch_scc1 W4_25
    s_cmp_lg_u32 s2, 0
    s_cbranch_scc1 NM_26
    s_memrealtime s[94:95]
    v_mov_b32 v160, 0
    s_waitcnt lgkmcnt(0)
    s_or_b32 s95, s95, 0x80000000
    v_mov_b32 v162, s94
    v_mov_b32 v163, s95
    s_mov_b64 exec, 1
    buffer_store_dwordx2 v[162:163], v160, s[40:43], 0 offen sc1
    s_mov_b64 exec, -1
NM_26:
W4_25:
    s_sub_u32 s62, s3, 4
    s_lshl_b32 s61, s4, 2
    s_add_u32 s61, s61, s62
    v_mov_b32 v72, -1
    v_mov_b32 v73, -1
    v_mov_b32 v74, -1
    v_mov_b32 v75, -1
    v_and_b32 v2, 3, v1
    v_lshlrev_b32 v2, 15, v2
    v_bfe_u32 v161, v1, 2, 2
    v_lshl_add_u32 v2, v161, 5, v2
    v_lshrrev_b32 v162, 4, v1
    v_lshl_add_u32 v2, v162, 3, v2
    s_lshl_b32 s7, s61, 3
    s_add_u32 s7, s7, s5
    s_lshl_b32 s7, s7, 7
    s_add_u32 s7, s7, 0x0
    v_add_u32 v2, s7, v2
    buffer_store_dwordx2 v[72:73], v2, s[36:39], 0 offen sc1
    v_lshrrev_b32 v163, 4, v1
    v_lshlrev_b32 v163, 16, v163
    v_bfe_u32 v164, v1, 3, 1
    v_lshl_add_u32 v163, v164, 13, v163
    v_and_b32 v164, 7, v1
    v_lshl_add_u32 v163, v164, 4, v163
    s_cmp_lt_u32 s5, 4
    s_cselect_b32 s7, 0x800, 0x0
    s_add_u32 s7, s7, s6
    s_lshl_b32 s7, s7, 7
    s_add_u32 s7, s7, 0x100000
    v_add_u32 v163, s7, v163
    s_lshl_b32 s7, s62, 14
    v_add_u32 v163, s7, v163
    buffer_store_dwordx4 v[72:75], v163, s[36:39], 0 offen sc1
    s_mov_b32 s7, 4096
    buffer_store_dwordx4 v[72:75], v163, s[36:39], s7 offen sc1
    s_barrier
    v_and_b32 v3, 3, v1
    v_lshlrev_b32 v3, 8, v3
    v_lshl_add_u32 v3, v161, 6, v3
    v_lshl_add_u32 v3, v162, 4, v3
    s_lshl_b32 s7, s61, 12
    s_add_u32 s7, s7, 0x40000
    v_add_u32 v3, s7, v3
    v_and_b32 v4, 15, v1
    v_xor_b32 v5, v162, v4
    v_lshlrev_b32 v5, 4, v5
    v_lshl_add_u32 v4, v4, 10, v5
    s_lshl_b32 s7, s62, 8
    v_add_u32 v4, s7, v4
    v_cmp_eq_u32 s[86:87], 1, v161
    v_cmp_eq_u32 s[88:89], 2, v161
    v_cmp_eq_u32 s[90:91], 3, v161
    s_cmp_eq_u32 s3, 4
    s_cbranch_scc1 W4_28
    s_waitcnt vmcnt(0)
    v_mov_b32 v160, 0x24000
    v_mov_b32 v161, 1
    s_waitcnt lgkmcnt(0)
    s_mov_b64 exec, 1
    ds_add_u32 v160, v161
    s_mov_b64 exec, -1
    s_branch W4_27
W4_28:
    s_sleep 8
    v_mov_b32 v160, 0
    s_mov_b32 s80, 200000
NG_29:
    s_mov_b64 exec, 1
    buffer_load_dwordx2 v[162:163], v160, s[40:43], 0 offen sc1
    s_mov_b64 exec, -1
    s_waitcnt vmcnt(0)
    v_readfirstlane_b32 s94, v162
    v_readfirstlane_b32 s95, v163
    s_cmp_lg_u32 s95, 0
    s_cbranch_scc1 NGD_30
    s_sleep 4
    s_sub_u32 s80, s80, 1
    s_cmp_lg_u32 s80, 0
    s_cbranch_scc1 NG_29
NGD_30:
    s_sleep 4
    v_and_b32 v160, 15, v1
    s_lshl_b32 s7, s4, 8
    s_add_u32 s7, s7, 0xc0080
    v_lshl_add_u32 v160, v160, 3, s7
    s_mov_b32 s80, 200000
FW_31:
    buffer_load_dwordx2 v[162:163], v160, s[36:39], 0 offen sc1
    s_waitcnt vmcnt(0)
    v_cmp_ne_u64 vcc, s[94:95], v[162:163]
    s_cbranch_vccz FWD_32
    s_sleep 4
    s_sub_u32 s80, s80, 1
    s_cmp_lg_u32 s80, 0
    s_cbranch_scc1 FW_31
FWD_32:
    v_mov_b32 v160, 0x24018
    v_mov_b32 v161, 1
    s_waitcnt lgkmcnt(0)
    s_mov_b64 exec, 1
    ds_add_u32 v160, v161
    s_mov_b64 exec, -1
    v_mov_b32 v160, 0x24000
    s_mov_b32 s80, 1600000
LW_33:
    ds_read_b32 v161, v160
    s_waitcnt lgkmcnt(0)
    v_readfirstlane_b32 s79, v161
    s_cmp_ge_u32 s79, 3
    s_cbranch_scc1 LWD_34
    s_sub_u32 s80, s80, 1
    s_cmp_lg_u32 s80, 0
    s_cbranch_scc1 LW_33
LWD_34:
    s_lshl_b32 s7, s4, 5
    s_add_u32 s7, s7, s5
    s_lshl_b32 s7, s7, 3
    s_add_u32 s7, s7, 0xc0000
    v_mov_b32 v160, s7
    v_mov_b32 v162, s94
    v_mov_b32 v163, s95
    s_mov_b64 exec, 1
    buffer_store_dwordx2 v[162:163], v160, s[36:39], 0 offen sc1
    s_mov_b64 exec, -1
W4_27:
    v_mov_b32 v160, 0x24018
    s_mov_b32 s80, 1600000
LW_35:
    ds_read_b32 v161, v160
    s_waitcnt lgkmcnt(0)
    v_readfirstlane_b32 s79, v161
    s_cmp_ge_u32 s79, 1
    s_cbranch_scc1 LWD_36
    s_sleep 2
    s_sub_u32 s80, s80, 1
    s_cmp_lg_u32 s80, 0
    s_cbranch_scc1 LW_35
LWD_36:
    buffer_load_dwordx4 v[72:75], v3, s[36:39], 0 offen offset:0 sc1
    buffer_load_dwordx4 v[76:79], v3, s[36:39], 0 offen offset:1024 sc1
    buffer_load_dwordx4 v[80:83], v3, s[36:39], 0 offen offset:2048 sc1
    buffer_load_dwordx4 v[84:87], v3, s[36:39], 0 offen offset:3072 sc1
    v_mov_b32 v160, 0x24014
    s_mov_b32 s80, 1600000
LW_39:
    ds_read_b32 v161, v160
    s_waitcnt lgkmcnt(0)
    v_readfirstlane_b32 s79, v161
    s_cmp_ge_u32 s79, 4
    s_cbranch_scc1 LWD_40
    s_sleep 1
    s_sub_u32 s80, s80, 1
    s_cmp_lg_u32 s80, 0
    s_cbranch_scc1 LW_39
LWD_40:
    v_xor_b32 v160, 0x0, v4
    v_xor_b32 v161, 0x40, v4
    v_xor_b32 v162, 0x80, v4
    v_xor_b32 v163, 0xc0, v4
    ds_read_b128 v[8:11], v160 offset:0
    ds_read_b128 v[12:15], v161 offset:0
    ds_read_b128 v[16:19], v162 offset:0
    ds_read_b128 v[20:23], v163 offset:0
    ds_read_b128 v[24:27], v160 offset:16384
    ds_read_b128 v[28:31], v161 offset:16384
    ds_read_b128 v[32:35], v162 offset:16384
    ds_read_b128 v[36:39], v163 offset:16384
    ds_read_b128 v[40:43], v160 offset:32768
    ds_read_b128 v[44:47], v161 offset:32768
    ds_read_b128 v[48:51], v162 offset:32768
    ds_read_b128 v[52:55], v163 offset:32768
    ds_read_b128 v[56:59], v160 offset:49152
    ds_read_b128 v[60:63], v161 offset:49152
    ds_read_b128 v[64:67], v162 offset:49152
    ds_read_b128 v[68:71], v163 offset:49152
    s_mov_b32 s80, 200000
PS_37:
    s_waitcnt vmcnt(0)
    s_mov_b32 s78, 0
    v_max_u32 v164, v72, v73
    v_max3_u32 v164, v164, v74, v75
    v_cmp_eq_u32 vcc, -1, v164
    s_cbranch_vccz PSS_41
    buffer_load_dwordx4 v[72:75], v3, s[36:39], 0 offen offset:0 sc1
    s_mov_b32 s78, 1
PSS_41:
    v_max_u32 v164, v76, v77
    v_max3_u32 v164, v164, v78, v79
    v_cmp_eq_u32 vcc, -1, v164
    s_cbranch_vccz PSS_42
    buffer_load_dwordx4 v[76:79], v3, s[36:39], 0 offen offset:1024 sc1
    s_mov_b32 s78, 1
PSS_42:
    v_max_u32 v164, v80, v81
    v_max3_u32 v164, v164, v82, v83
    v_cmp_eq_u32 vcc, -1, v164
    s_cbranch_vccz PSS_43
    buffer_load_dwordx4 v[80:83], v3, s[36:39], 0 offen offset:2048 sc1
    s_mov_b32 s78, 1
PSS_43:
    v_max_u32 v164, v84, v85
    v_max3_u32 v164, v164, v86, v87
    v_cmp_eq_u32 vcc, -1, v164
    s_cbranch_vccz PSS_44
    buffer_load_dwordx4 v[84:87], v3, s[36:39], 0 offen offset:3072 sc1
    s_mov_b32 s78, 1
PSS_44:
    s_cmp_eq_u32 s78, 0
    s_cbranch_scc1 PSD_38
    s_sub_u32 s80, s80, 1
    s_cmp_lg_u32 s80, 0
    s_cbranch_scc1 PS_37
    s_waitcnt vmcnt(0)
PSD_38:
    v_lshlrev_b32 v104, 16, v72
    v_and_b32 v105, 0xffff0000, v72
    v_lshlrev_b32 v106, 16, v73
    v_and_b32 v107, 0xffff0000, v73
    v_lshlrev_b32 v108, 16, v74
    v_and_b32 v109, 0xffff0000, v74
    v_lshlrev_b32 v110, 16, v75
    v_and_b32 v111, 0xffff0000, v75
    v_lshlrev_b32 v120, 16, v76
    v_and_b32 v121, 0xffff0000, v76
    v_lshlrev_b32 v122, 16, v77
    v_and_b32 v123, 0xffff0000, v77
    v_lshlrev_b32 v124, 16, v78
    v_and_b32 v125, 0xffff0000, v78
    v_lshlrev_b32 v126, 16, v79
    v_and_b32 v127, 0xffff0000, v79
    v_pk_add_f32 v[104:105], v[104:105], v[120:121]
    v_pk_add_f32 v[106:107], v[106:107], v[122:123]
    v_pk_add_f32 v[108:109], v[108:109], v[124:125]
    v_pk_add_f32 v[110:111], v[110:111], v[126:127]
    v_lshlrev_b32 v112, 16, v80
    v_and_b32 v113, 0xffff0000, v80
    v_lshlrev_b32 v114, 16, v81
    v_and_b32 v115, 0xffff0000, v81
    v_lshlrev_b32 v116, 16, v82
    v_and_b32 v117, 0xffff0000, v82
    v_lshlrev_b32 v118, 16, v83
    v_and_b32 v119, 0xffff0000, v83
    v_pk_add_f32 v[104:105], v[104:105], v[112:113]
    v_pk_add_f32 v[106:107], v[106:107], v[114:115]
    v_pk_add_f32 v[108:109], v[108:109], v[116:117]
    v_pk_add_f32 v[110:111], v[110:111], v[118:119]
    v_lshlrev_b32 v120, 16, v84
    v_and_b32 v121, 0xffff0000, v84
    v_lshlrev_b32 v122, 16, v85
    v_and_b32 v123, 0xffff0000, v85
    v_lshlrev_b32 v124, 16, v86
    v_and_b32 v125, 0xffff0000, v86
    v_lshlrev_b32 v126, 16, v87
    v_and_b32 v127, 0xffff0000, v87
    v_pk_add_f32 v[104:105], v[104:105], v[120:121]
    v_pk_add_f32 v[106:107], v[106:107], v[122:123]
    v_pk_add_f32 v[108:109], v[108:109], v[124:125]
    v_pk_add_f32 v[110:111], v[110:111], v[126:127]
    v_cvt_pk_bf16_f32 v136, v104, v105
    v_cvt_pk_bf16_f32 v137, v106, v107
    v_cvt_pk_bf16_f32 v138, v108, v109
    v_cvt_pk_bf16_f32 v139, v110, v111
    v_mov_b32_dpp v140, v136 row_ror:4 row_mask:0xf bank_mask:0xf
    v_mov_b32_dpp v141, v137 row_ror:4 row_mask:0xf bank_mask:0xf
    v_mov_b32_dpp v142, v138 row_ror:4 row_mask:0xf bank_mask:0xf
    v_mov_b32_dpp v143, v139 row_ror:4 row_mask:0xf bank_mask:0xf
    v_mov_b32_dpp v144, v136 row_ror:8 row_mask:0xf bank_mask:0xf
    v_mov_b32_dpp v145, v137 row_ror:8 row_mask:0xf bank_mask:0xf
    v_mov_b32_dpp v146, v138 row_ror:8 row_mask:0xf bank_mask:0xf
    v_mov_b32_dpp v147, v139 row_ror:8 row_mask:0xf bank_mask:0xf
    v_mov_b32_dpp v148, v136 row_ror:12 row_mask:0xf bank_mask:0xf
    v_mov_b32_dpp v149, v137 row_ror:12 row_mask:0xf bank_mask:0xf
    v_mov_b32_dpp v150, v138 row_ror:12 row_mask:0xf bank_mask:0xf
    v_mov_b32_dpp v151, v139 row_ror:12 row_mask:0xf bank_mask:0xf
    s_waitcnt lgkmcnt(0)
    v_mfma_f32_16x16x32_bf16 v[104:107], v[8:11], v[136:139], 0
    v_mfma_f32_16x16x32_bf16 v[108:111], v[28:31], v[136:139], 0
    v_mfma_f32_16x16x32_bf16 v[112:115], v[48:51], v[136:139], 0
    v_mfma_f32_16x16x32_bf16 v[116:119], v[68:71], v[136:139], 0
    v_mfma_f32_16x16x32_bf16 v[104:107], v[20:23], v[140:143], v[104:107]
    v_mfma_f32_16x16x32_bf16 v[108:111], v[24:27], v[140:143], v[108:111]
    v_mfma_f32_16x16x32_bf16 v[112:115], v[44:47], v[140:143], v[112:115]
    v_mfma_f32_16x16x32_bf16 v[116:119], v[64:67], v[140:143], v[116:119]
    v_mfma_f32_16x16x32_bf16 v[104:107], v[16:19], v[144:147], v[104:107]
    v_mfma_f32_16x16x32_bf16 v[108:111], v[36:39], v[144:147], v[108:111]
    v_mfma_f32_16x16x32_bf16 v[112:115], v[40:43], v[144:147], v[112:115]
    v_mfma_f32_16x16x32_bf16 v[116:119], v[60:63], v[144:147], v[116:119]
    v_mfma_f32_16x16x32_bf16 v[104:107], v[12:15], v[148:151], v[104:107]
    v_mfma_f32_16x16x32_bf16 v[108:111], v[32:35], v[148:151], v[108:111]
    v_mfma_f32_16x16x32_bf16 v[112:115], v[52:55], v[148:151], v[112:115]
    v_mfma_f32_16x16x32_bf16 v[116:119], v[56:59], v[148:151], v[116:119]
    s_nop 5
    v_cndmask_b32 v104, v104, v108, s[86:87]
    v_cndmask_b32 v105, v105, v109, s[86:87]
    v_cndmask_b32 v106, v106, v110, s[86:87]
    v_cndmask_b32 v107, v107, v111, s[86:87]
    v_cndmask_b32 v104, v104, v112, s[88:89]
    v_cndmask_b32 v105, v105, v113, s[88:89]
    v_cndmask_b32 v106, v106, v114, s[88:89]
    v_cndmask_b32 v107, v107, v115, s[88:89]
    v_cndmask_b32 v104, v104, v116, s[90:91]
    v_cndmask_b32 v105, v105, v117, s[90:91]
    v_cndmask_b32 v106, v106, v118, s[90:91]
    v_cndmask_b32 v107, v107, v119, s[90:91]
    v_cvt_pk_bf16_f32 v104, v104, v105
    v_cvt_pk_bf16_f32 v105, v106, v107
    buffer_store_dwordx2 v[104:105], v2, s[36:39], 0 offen sc1
    v_mov_b32 v160, 0x24048
    v_mov_b32 v161, 1
    s_waitcnt lgkmcnt(0)
    s_mov_b64 exec, 1
    ds_add_u32 v160, v161
    s_mov_b64 exec, -1
    s_setprio 0
    s_cmp_ge_u32 s5, 4
    s_cbranch_scc1 L_END
L_U1:
    s_mov_b32 s48, s26
    s_and_b32 s49, s27, 0xffff
    s_mov_b32 s50, 0x400000
    s_mov_b32 s51, 0x20000
    v_lshrrev_b32 v162, 4, v1
    v_lshlrev_b32 v2, 16, v162
    v_and_b32 v160, 15, v1
    v_lshl_add_u32 v2, v160, 4, v2
    s_lshl_b32 s7, s6, 8
    v_add_u32 v2, s7, v2
    s_lshl_b32 s70, s3, 19
    s_waitcnt vmcnt(2)
    buffer_load_dwordx4 v[8:11], v2, s[48:51], s70 offen nt
    s_add_u32 s70, s70, 8192
    s_waitcnt vmcnt(2)
    buffer_load_dwordx4 v[12:15], v2, s[48:51], s70 offen nt
    s_add_u32 s70, s70, 8192
    s_waitcnt vmcnt(2)
    buffer_load_dwordx4 v[16:19], v2, s[48:51], s70 offen nt
    s_add_u32 s70, s70, 8192
    s_waitcnt vmcnt(2)
    buffer_load_dwordx4 v[20:23], v2, s[48:51], s70 offen nt
    s_add_u32 s70, s70, 8192
    s_waitcnt vmcnt(2)
    buffer_load_dwordx4 v[24:27], v2, s[48:51], s70 offen nt
    s_add_u32 s70, s70, 8192
    s_waitcnt vmcnt(2)
    buffer_load_dwordx4 v[28:31], v2, s[48:51], s70 offen nt
    s_add_u32 s70, s70, 8192
    s_waitcnt vmcnt(2)
    buffer_load_dwordx4 v[32:35], v2, s[48:51], s70 offen nt
    s_add_u32 s70, s70, 8192
    s_waitcnt vmcnt(2)
    buffer_load_dwordx4 v[36:39], v2, s[48:51], s70 offen nt
    s_add_u32 s70, s70, 204800
    s_waitcnt vmcnt(2)
    buffer_load_dwordx4 v[104:107], v2, s[48:51], s70 offen nt
    s_add_u32 s70, s70, 8192
    s_waitcnt vmcnt(2)
    buffer_load_dwordx4 v[108:111], v2, s[48:51], s70 offen nt
    s_add_u32 s70, s70, 8192
    s_waitcnt vmcnt(2)
    buffer_load_dwordx4 v[112:115], v2, s[48:51], s70 offen nt
    s_add_u32 s70, s70, 8192
    s_waitcnt vmcnt(2)
    buffer_load_dwordx4 v[116:119], v2, s[48:51], s70 offen nt
    s_add_u32 s70, s70, 8192
    s_waitcnt vmcnt(2)
    buffer_load_dwordx4 v[120:123], v2, s[48:51], s70 offen nt
    s_add_u32 s70, s70, 8192
    s_waitcnt vmcnt(2)
    buffer_load_dwordx4 v[124:127], v2, s[48:51], s70 offen nt
    s_add_u32 s70, s70, 8192
    s_waitcnt vmcnt(2)
    buffer_load_dwordx4 v[128:131], v2, s[48:51], s70 offen nt
    s_add_u32 s70, s70, 8192
    s_waitcnt vmcnt(2)
    buffer_load_dwordx4 v[132:135], v2, s[48:51], s70 offen nt
    s_add_u32 s70, s70, 204800
    v_lshlrev_b32 v3, 2, v160
    v_add_u32 v3, v3, v162
    v_lshlrev_b32 v3, 8, v3
    s_lshl_b32 s7, s6, 3
    s_add_u32 s7, s7, 0xb0000
    v_add_u32 v3, s7, v3
    v_lshrrev_b32 v4, 1, v160
    v_lshlrev_b32 v4, 13, v4
    v_lshl_add_u32 v4, v162, 4, v4
    v_and_b32 v163, 1, v1
    v_lshl_add_u32 v4, v163, 6, v4
    v_cmp_eq_u32 s[86:87], 1, v163
    s_lshl_b32 s7, s6, 9
    s_add_u32 s7, s7, s3
    s_lshl_b32 s7, s7, 7
    s_add_u32 s7, s7, 0x500000
    v_add_u32 v4, s7, v4
    s_lshl_b32 s7, s3, 11
    s_add_u32 s7, s7, 0x10000
    v_lshl_add_u32 v5, v1, 5, s7
    v_perm_b32 v40, v12, v8, s92
    v_perm_b32 v41, v20, v16, s92
    v_perm_b32 v42, v28, v24, s92
    v_perm_b32 v43, v36, v32, s92
    v_perm_b32 v44, v12, v8, s93
    v_perm_b32 v45, v20, v16, s93
    v_perm_b32 v46, v28, v24, s93
    v_perm_b32 v47, v36, v32, s93
    v_perm_b32 v48, v13, v9, s92
    v_perm_b32 v49, v21, v17, s92
    v_perm_b32 v50, v29, v25, s92
    v_perm_b32 v51, v37, v33, s92
    v_perm_b32 v52, v13, v9, s93
    v_perm_b32 v53, v21, v17, s93
    v_perm_b32 v54, v29, v25, s93
    v_perm_b32 v55, v37, v33, s93
    v_perm_b32 v56, v14, v10, s92
    v_perm_b32 v57, v22, v18, s92
    v_perm_b32 v58, v30, v26, s92
    v_perm_b32 v59, v38, v34, s92
    v_perm_b32 v60, v14, v10, s93
    v_perm_b32 v61, v22, v18, s93
    v_perm_b32 v62, v30, v26, s93
    v_perm_b32 v63, v38, v34, s93
    v_perm_b32 v64, v15, v11, s92
    v_perm_b32 v65, v23, v19, s92
    v_perm_b32 v66, v31, v27, s92
    v_perm_b32 v67, v39, v35, s92
    v_perm_b32 v68, v15, v11, s93
    v_perm_b32 v69, v23, v19, s93
    v_perm_b32 v70, v31, v27, s93
    v_perm_b32 v71, v39, v35, s93
    s_waitcnt vmcnt(0)
    v_perm_b32 v72, v108, v104, s92
    v_perm_b32 v73, v116, v112, s92
    v_perm_b32 v74, v124, v120, s92
    v_perm_b32 v75, v132, v128, s92
    v_perm_b32 v76, v108, v104, s93
    v_perm_b32 v77, v116, v112, s93
    v_perm_b32 v78, v124, v120, s93
    v_perm_b32 v79, v132, v128, s93
    v_perm_b32 v80, v109, v105, s92
    v_perm_b32 v81, v117, v113, s92
    v_perm_b32 v82, v125, v121, s92
    v_perm_b32 v83, v133, v129, s92
    v_perm_b32 v84, v109, v105, s93
    v_perm_b32 v85, v117, v113, s93
    v_perm_b32 v86, v125, v121, s93
    v_perm_b32 v87, v133, v129, s93
    v_perm_b32 v88, v110, v106, s92
    v_perm_b32 v89, v118, v114, s92
    v_perm_b32 v90, v126, v122, s92
    v_perm_b32 v91, v134, v130, s92
    v_perm_b32 v92, v110, v106, s93
    v_perm_b32 v93, v118, v114, s93
    v_perm_b32 v94, v126, v122, s93
    v_perm_b32 v95, v134, v130, s93
    v_perm_b32 v96, v111, v107, s92
    v_perm_b32 v97, v119, v115, s92
    v_perm_b32 v98, v127, v123, s92
    v_perm_b32 v99, v135, v131, s92
    v_perm_b32 v100, v111, v107, s93
    v_perm_b32 v101, v119, v115, s93
    v_perm_b32 v102, v127, v123, s93
    v_perm_b32 v103, v135, v131, s93
    s_cmp_lg_u32 s3, 4
    s_cbranch_scc1 U0_45
    v_lshrrev_b32 v160, 3, v1
    v_lshlrev_b32 v160, 8, v160
    v_and_b32 v161, 7, v1
    v_lshl_add_u32 v160, v161, 3, v160
    v_add_u32 v160, 0xc0040, v160
    s_mov_b32 s80, 200000
FW_46:
    buffer_load_dwordx2 v[162:163], v160, s[36:39], 0 offen sc1
    s_waitcnt vmcnt(0)
    v_cmp_ne_u64 vcc, s[94:95], v[162:163]
    s_cbranch_vccz FWD_47
    s_sleep 8
    s_sub_u32 s80, s80, 1
    s_cmp_lg_u32 s80, 0
    s_cbranch_scc1 FW_46
FWD_47:
    s_mov_b32 s80, 200000
PO_48:
    buffer_load_dwordx2 v[136:137], v3, s[36:39], 0 offen sc1
PO2_49:
    s_waitcnt vmcnt(0)
    v_max_u32 v160, v136, v137
    v_cmp_eq_u32 vcc, -1, v160
    s_cmp_lg_u64 vcc, -1
    s_cbranch_scc1 POD_50
    s_sleep 8
    s_sub_u32 s80, s80, 1
    s_cmp_lg_u32 s80, 0
    s_cbranch_scc1 PO_48
POD_50:
    v_mov_b32 v160, 0x2401c
    v_mov_b32 v161, 1
    s_waitcnt lgkmcnt(0)
    s_mov_b64 exec, 1
    ds_add_u32 v160, v161
    s_mov_b64 exec, -1
U0_45:
    v_mov_b32 v160, 0x2401c
    s_mov_b32 s80, 1600000
LW_51:
    ds_read_b32 v161, v160
    s_waitcnt lgkmcnt(0)
    v_readfirstlane_b32 s79, v161
    s_cmp_ge_u32 s79, 1
    s_cbranch_scc1 LWD_52
    s_sleep 4
    s_sub_u32 s80, s80, 1
    s_cmp_lg_u32 s80, 0
    s_cbranch_scc1 LW_51
LWD_52:
    s_setprio 3
    s_mov_b32 s80, 200000
PO_53:
    buffer_load_dwordx2 v[136:137], v3, s[36:39], 0 offen sc1
PO2_54:
    s_waitcnt vmcnt(0)
    v_max_u32 v160, v136, v137
    v_cmp_eq_u32 vcc, -1, v160
    s_cbranch_vccz POD_55
    s_sleep 2
    s_sub_u32 s80, s80, 1
    s_cmp_lg_u32 s80, 0
    s_cbranch_scc1 PO_53
POD_55:
    s_mov_b32 s70, 4096
    buffer_load_dwordx4 v[8:11], v4, s[36:39], 0 offen offset:0 sc1
    buffer_load_dwordx4 v[12:15], v4, s[36:39], 0 offen offset:1024 sc1
    buffer_load_dwordx4 v[16:19], v4, s[36:39], 0 offen offset:2048 sc1
    buffer_load_dwordx4 v[20:23], v4, s[36:39], 0 offen offset:3072 sc1
    buffer_load_dwordx4 v[24:27], v4, s[36:39], s70 offen offset:0 sc1
    buffer_load_dwordx4 v[28:31], v4, s[36:39], s70 offen offset:1024 sc1
    buffer_load_dwordx4 v[32:35], v4, s[36:39], s70 offen offset:2048 sc1
    buffer_load_dwordx4 v[36:39], v4, s[36:39], s70 offen offset:3072 sc1
    v_max_f32_dpp v138, v136, v136 quad_perm:[1,0,3,2] row_mask:0xf bank_mask:0xf
    s_nop 1
    v_max_f32_dpp v138, v138, v138 quad_perm:[2,3,0,1] row_mask:0xf bank_mask:0xf
    v_mov_b32 v139, v138
    s_nop 1
    v_permlane32_swap_b32 v138, v139
    v_max_f32 v138, v138, v139
    v_mov_b32 v139, v138
    s_nop 1
    v_permlane16_swap_b32 v138, v139
    v_max_f32 v138, v138, v139
    v_sub_f32 v136, v136, v138
    v_exp_f32 v136, v136
    s_nop 0
    v_mul_f32 v137, v137, v136
    s_nop 1
    v_add_f32_dpp v137, v137, v137 quad_perm:[1,0,3,2] row_mask:0xf bank_mask:0xf
    s_nop 1
    v_add_f32_dpp v137, v137, v137 quad_perm:[2,3,0,1] row_mask:0xf bank_mask:0xf
    v_mov_b32 v138, v137
    s_nop 1
    v_permlane32_swap_b32 v137, v138
    v_add_f32 v137, v137, v138
    v_mov_b32 v138, v137
    s_nop 1
    v_permlane16_swap_b32 v137, v138
    v_add_f32 v137, v137, v138
    v_rcp_f32 v137, v137
    s_nop 0
    v_mul_f32 v136, v136, v137
    v_mov_b32 v137, v136
    s_nop 1
    v_permlane16_swap_b32 v136, v137
    v_mov_b32 v138, v136
    v_mov_b32 v139, v137
    s_nop 0
    v_permlane32_swap_b32 v136, v138
    v_permlane32_swap_b32 v137, v139
    s_nop 0
    v_mov_b32_dpp v148, v136 quad_perm:[0,0,2,2] row_mask:0xf bank_mask:0xf
    v_mov_b32_dpp v149, v137 quad_perm:[0,0,2,2] row_mask:0xf bank_mask:0xf
    v_mov_b32_dpp v150, v138 quad_perm:[0,0,2,2] row_mask:0xf bank_mask:0xf
    v_mov_b32_dpp v151, v139 quad_perm:[0,0,2,2] row_mask:0xf bank_mask:0xf
    v_mov_b32_dpp v152, v136 quad_perm:[1,1,3,3] row_mask:0xf bank_mask:0xf
    v_mov_b32_dpp v153, v137 quad_perm:[1,1,3,3] row_mask:0xf bank_mask:0xf
    v_mov_b32_dpp v154, v138 quad_perm:[1,1,3,3] row_mask:0xf bank_mask:0xf
    v_mov_b32_dpp v155, v139 quad_perm:[1,1,3,3] row_mask:0xf bank_mask:0xf
    s_mov_b32 s80, 200000
PS_56:
    s_waitcnt vmcnt(0)
    s_mov_b32 s78, 0
    v_max_u32 v160, v8, v9
    v_max3_u32 v160, v160, v10, v11
    v_cmp_eq_u32 vcc, -1, v160
    s_cbranch_vccz PSS_58
    buffer_load_dwordx4 v[8:11], v4, s[36:39], 0 offen offset:0 sc1
    s_mov_b32 s78, 1
PSS_58:
    v_max_u32 v160, v12, v13
    v_max3_u32 v160, v160, v14, v15
    v_cmp_eq_u32 vcc, -1, v160
    s_cbranch_vccz PSS_59
    buffer_load_dwordx4 v[12:15], v4, s[36:39], 0 offen offset:1024 sc1
    s_mov_b32 s78, 1
PSS_59:
    v_max_u32 v160, v16, v17
    v_max3_u32 v160, v160, v18, v19
    v_cmp_eq_u32 vcc, -1, v160
    s_cbranch_vccz PSS_60
    buffer_load_dwordx4 v[16:19], v4, s[36:39], 0 offen offset:2048 sc1
    s_mov_b32 s78, 1
PSS_60:
    v_max_u32 v160, v20, v21
    v_max3_u32 v160, v160, v22, v23
    v_cmp_eq_u32 vcc, -1, v160
    s_cbranch_vccz PSS_61
    buffer_load_dwordx4 v[20:23], v4, s[36:39], 0 offen offset:3072 sc1
    s_mov_b32 s78, 1
PSS_61:
    v_max_u32 v160, v24, v25
    v_max3_u32 v160, v160, v26, v27
    v_cmp_eq_u32 vcc, -1, v160
    s_cbranch_vccz PSS_62
    buffer_load_dwordx4 v[24:27], v4, s[36:39], s70 offen offset:0 sc1
    s_mov_b32 s78, 1
PSS_62:
    v_max_u32 v160, v28, v29
    v_max3_u32 v160, v160, v30, v31
    v_cmp_eq_u32 vcc, -1, v160
    s_cbranch_vccz PSS_63
    buffer_load_dwordx4 v[28:31], v4, s[36:39], s70 offen offset:1024 sc1
    s_mov_b32 s78, 1
PSS_63:
    v_max_u32 v160, v32, v33
    v_max3_u32 v160, v160, v34, v35
    v_cmp_eq_u32 vcc, -1, v160
    s_cbranch_vccz PSS_64
    buffer_load_dwordx4 v[32:35], v4, s[36:39], s70 offen offset:2048 sc1
    s_mov_b32 s78, 1
PSS_64:
    v_max_u32 v160, v36, v37
    v_max3_u32 v160, v160, v38, v39
    v_cmp_eq_u32 vcc, -1, v160
    s_cbranch_vccz PSS_65
    buffer_load_dwordx4 v[36:39], v4, s[36:39], s70 offen offset:3072 sc1
    s_mov_b32 s78, 1
PSS_65:
    s_cmp_eq_u32 s78, 0
    s_cbranch_scc1 PSD_57
    s_sub_u32 s80, s80, 1
    s_cmp_lg_u32 s80, 0
    s_cbranch_scc1 PS_56
    s_waitcnt vmcnt(0)
PSD_57:
    v_lshlrev_b32 v104, 16, v8
    v_and_b32 v105, 0xffff0000, v8
    v_lshlrev_b32 v106, 16, v9
    v_and_b32 v107, 0xffff0000, v9
    v_lshlrev_b32 v108, 16, v10
    v_and_b32 v109, 0xffff0000, v10
    v_lshlrev_b32 v110, 16, v11
    v_and_b32 v111, 0xffff0000, v11
    v_pk_mul_f32 v[120:121], v[104:105], v[148:149] op_sel_hi:[1,0]
    v_pk_mul_f32 v[122:123], v[106:107], v[148:149] op_sel_hi:[1,0]
    v_pk_mul_f32 v[124:125], v[108:109], v[148:149] op_sel_hi:[1,0]
    v_pk_mul_f32 v[126:127], v[110:111], v[148:149] op_sel_hi:[1,0]
    v_lshlrev_b32 v112, 16, v12
    v_and_b32 v113, 0xffff0000, v12
    v_lshlrev_b32 v114, 16, v13
    v_and_b32 v115, 0xffff0000, v13
    v_lshlrev_b32 v116, 16, v14
    v_and_b32 v117, 0xffff0000, v14
    v_lshlrev_b32 v118, 16, v15
    v_and_b32 v119, 0xffff0000, v15
    v_pk_mul_f32 v[128:129], v[112:113], v[148:149] op_sel:[0,1] op_sel_hi:[1,1]
    v_pk_mul_f32 v[130:131], v[114:115], v[148:149] op_sel:[0,1] op_sel_hi:[1,1]
    v_pk_mul_f32 v[132:133], v[116:117], v[148:149] op_sel:[0,1] op_sel_hi:[1,1]
    v_pk_mul_f32 v[134:135], v[118:119], v[148:149] op_sel:[0,1] op_sel_hi:[1,1]
    v_lshlrev_b32 v104, 16, v16
    v_and_b32 v105, 0xffff0000, v16
    v_lshlrev_b32 v106, 16, v17
    v_and_b32 v107, 0xffff0000, v17
    v_lshlrev_b32 v108, 16, v18
    v_and_b32 v109, 0xffff0000, v18
    v_lshlrev_b32 v110, 16, v19
    v_and_b32 v111, 0xffff0000, v19
    v_pk_fma_f32 v[120:121], v[104:105], v[150:151], v[120:121] op_sel_hi:[1,0,1]
    v_pk_fma_f32 v[122:123], v[106:107], v[150:151], v[122:123] op_sel_hi:[1,0,1]
    v_pk_fma_f32 v[124:125], v[108:109], v[150:151], v[124:125] op_sel_hi:[1,0,1]
    v_pk_fma_f32 v[126:127], v[110:111], v[150:151], v[126:127] op_sel_hi:[1,0,1]
    v_lshlrev_b32 v112, 16, v20
    v_and_b32 v113, 0xffff0000, v20
    v_lshlrev_b32 v114, 16, v21
    v_and_b32 v115, 0xffff0000, v21
    v_lshlrev_b32 v116, 16, v22
    v_and_b32 v117, 0xffff0000, v22
    v_lshlrev_b32 v118, 16, v23
    v_and_b32 v119, 0xffff0000, v23
    v_pk_fma_f32 v[128:129], v[112:113], v[150:151], v[128:129] op_sel:[0,1,0] op_sel_hi:[1,1,1]
    v_pk_fma_f32 v[130:131], v[114:115], v[150:151], v[130:131] op_sel:[0,1,0] op_sel_hi:[1,1,1]
    v_pk_fma_f32 v[132:133], v[116:117], v[150:151], v[132:133] op_sel:[0,1,0] op_sel_hi:[1,1,1]
    v_pk_fma_f32 v[134:135], v[118:119], v[150:151], v[134:135] op_sel:[0,1,0] op_sel_hi:[1,1,1]
    v_lshlrev_b32 v104, 16, v24
    v_and_b32 v105, 0xffff0000, v24
    v_lshlrev_b32 v106, 16, v25
    v_and_b32 v107, 0xffff0000, v25
    v_lshlrev_b32 v108, 16, v26
    v_and_b32 v109, 0xffff0000, v26
    v_lshlrev_b32 v110, 16, v27
    v_and_b32 v111, 0xffff0000, v27
    v_pk_fma_f32 v[120:121], v[104:105], v[152:153], v[120:121] op_sel_hi:[1,0,1]
    v_pk_fma_f32 v[122:123], v[106:107], v[152:153], v[122:123] op_sel_hi:[1,0,1]
    v_pk_fma_f32 v[124:125], v[108:109], v[152:153], v[124:125] op_sel_hi:[1,0,1]
    v_pk_fma_f32 v[126:127], v[110:111], v[152:153], v[126:127] op_sel_hi:[1,0,1]
    v_lshlrev_b32 v112, 16, v28
    v_and_b32 v113, 0xffff0000, v28
    v_lshlrev_b32 v114, 16, v29
    v_and_b32 v115, 0xffff0000, v29
    v_lshlrev_b32 v116, 16, v30
    v_and_b32 v117, 0xffff0000, v30
    v_lshlrev_b32 v118, 16, v31
    v_and_b32 v119, 0xffff0000, v31
    v_pk_fma_f32 v[128:129], v[112:113], v[152:153], v[128:129] op_sel:[0,1,0] op_sel_hi:[1,1,1]
    v_pk_fma_f32 v[130:131], v[114:115], v[152:153], v[130:131] op_sel:[0,1,0] op_sel_hi:[1,1,1]
    v_pk_fma_f32 v[132:133], v[116:117], v[152:153], v[132:133] op_sel:[0,1,0] op_sel_hi:[1,1,1]
    v_pk_fma_f32 v[134:135], v[118:119], v[152:153], v[134:135] op_sel:[0,1,0] op_sel_hi:[1,1,1]
    v_lshlrev_b32 v104, 16, v32
    v_and_b32 v105, 0xffff0000, v32
    v_lshlrev_b32 v106, 16, v33
    v_and_b32 v107, 0xffff0000, v33
    v_lshlrev_b32 v108, 16, v34
    v_and_b32 v109, 0xffff0000, v34
    v_lshlrev_b32 v110, 16, v35
    v_and_b32 v111, 0xffff0000, v35
    v_pk_fma_f32 v[120:121], v[104:105], v[154:155], v[120:121] op_sel_hi:[1,0,1]
    v_pk_fma_f32 v[122:123], v[106:107], v[154:155], v[122:123] op_sel_hi:[1,0,1]
    v_pk_fma_f32 v[124:125], v[108:109], v[154:155], v[124:125] op_sel_hi:[1,0,1]
    v_pk_fma_f32 v[126:127], v[110:111], v[154:155], v[126:127] op_sel_hi:[1,0,1]
    v_lshlrev_b32 v112, 16, v36
    v_and_b32 v113, 0xffff0000, v36
    v_lshlrev_b32 v114, 16, v37
    v_and_b32 v115, 0xffff0000, v37
    v_lshlrev_b32 v116, 16, v38
    v_and_b32 v117, 0xffff0000, v38
    v_lshlrev_b32 v118, 16, v39
    v_and_b32 v119, 0xffff0000, v39
    v_pk_fma_f32 v[128:129], v[112:113], v[154:155], v[128:129] op_sel:[0,1,0] op_sel_hi:[1,1,1]
    v_pk_fma_f32 v[130:131], v[114:115], v[154:155], v[130:131] op_sel:[0,1,0] op_sel_hi:[1,1,1]
    v_pk_fma_f32 v[132:133], v[116:117], v[154:155], v[132:133] op_sel:[0,1,0] op_sel_hi:[1,1,1]
    v_pk_fma_f32 v[134:135], v[118:119], v[154:155], v[134:135] op_sel:[0,1,0] op_sel_hi:[1,1,1]
    v_pk_add_f32 v[120:121], v[120:121], v[128:129]
    v_pk_add_f32 v[122:123], v[122:123], v[130:131]
    v_pk_add_f32 v[124:125], v[124:125], v[132:133]
    v_pk_add_f32 v[126:127], v[126:127], v[134:135]
    v_cvt_pk_bf16_f32 v128, v120, v121
    v_cvt_pk_bf16_f32 v129, v122, v123
    v_cvt_pk_bf16_f32 v130, v124, v125
    v_cvt_pk_bf16_f32 v131, v126, v127
    v_cndmask_b32 v140, v128, 0, s[86:87]
    v_cndmask_b32 v144, 0, v128, s[86:87]
    v_cndmask_b32 v141, v129, 0, s[86:87]
    v_cndmask_b32 v145, 0, v129, s[86:87]
    v_cndmask_b32 v142, v130, 0, s[86:87]
    v_cndmask_b32 v146, 0, v130, s[86:87]
    v_cndmask_b32 v143, v131, 0, s[86:87]
    v_cndmask_b32 v147, 0, v131, s[86:87]
    s_nop 0
    v_mfma_f32_16x16x32_bf16 v[8:11], v[140:143], v[40:43], 0
    v_mfma_f32_16x16x32_bf16 v[12:15], v[140:143], v[44:47], 0
    v_mfma_f32_16x16x32_bf16 v[16:19], v[140:143], v[48:51], 0
    v_mfma_f32_16x16x32_bf16 v[20:23], v[140:143], v[52:55], 0
    v_mfma_f32_16x16x32_bf16 v[24:27], v[140:143], v[56:59], 0
    v_mfma_f32_16x16x32_bf16 v[28:31], v[140:143], v[60:63], 0
    v_mfma_f32_16x16x32_bf16 v[32:35], v[140:143], v[64:67], 0
    v_mfma_f32_16x16x32_bf16 v[36:39], v[140:143], v[68:71], 0
    v_mfma_f32_16x16x32_bf16 v[8:11], v[144:147], v[72:75], v[8:11]
    v_mfma_f32_16x16x32_bf16 v[12:15], v[144:147], v[76:79], v[12:15]
    v_mfma_f32_16x16x32_bf16 v[16:19], v[144:147], v[80:83], v[16:19]
    v_mfma_f32_16x16x32_bf16 v[20:23], v[144:147], v[84:87], v[20:23]
    v_mfma_f32_16x16x32_bf16 v[24:27], v[144:147], v[88:91], v[24:27]
    v_mfma_f32_16x16x32_bf16 v[28:31], v[144:147], v[92:95], v[28:31]
    v_mfma_f32_16x16x32_bf16 v[32:35], v[144:147], v[96:99], v[32:35]
    v_mfma_f32_16x16x32_bf16 v[36:39], v[144:147], v[100:103], v[36:39]
    s_nop 0
    v_pk_add_f32 v[8:9], v[8:9], v[10:11]
    v_pk_add_f32 v[12:13], v[12:13], v[14:15]
    v_pk_add_f32 v[16:17], v[16:17], v[18:19]
    v_pk_add_f32 v[20:21], v[20:21], v[22:23]
    v_pk_add_f32 v[24:25], v[24:25], v[26:27]
    v_pk_add_f32 v[28:29], v[28:29], v[30:31]
    v_pk_add_f32 v[32:33], v[32:33], v[34:35]
    v_pk_add_f32 v[36:37], v[36:37], v[38:39]
    v_add_f32 v104, v8, v9
    v_add_f32 v105, v12, v13
    v_add_f32 v106, v16, v17
    v_add_f32 v107, v20, v21
    v_add_f32 v108, v24, v25
    v_add_f32 v109, v28, v29
    v_add_f32 v110, v32, v33
    v_add_f32 v111, v36, v37
    ds_write_b128 v5, v[104:107]
    ds_write_b128 v5, v[108:111] offset:16
    v_mov_b32 v160, 0x2400c
    v_mov_b32 v161, 1
    s_waitcnt lgkmcnt(0)
    s_mov_b64 exec, 1
    ds_add_u32 v160, v161
    s_mov_b64 exec, -1
    v_and_b32 v160, 31, v1
    s_lshl_b32 s7, s3, 8
    s_add_u32 s7, s7, 0x10000
    v_lshl_add_u32 v5, v160, 3, s7
    s_lshl_b32 s7, s3, 7
    s_add_u32 s7, s7, 0x24400
    v_lshl_add_u32 v4, v160, 2, s7
    v_mov_b32 v160, 0x2400c
    s_mov_b32 s80, 1600000
LW_66:
    ds_read_b32 v161, v160
    s_waitcnt lgkmcnt(0)
    v_readfirstlane_b32 s79, v161
    s_cmp_ge_u32 s79, 8
    s_cbranch_scc1 LWD_67
    s_sub_u32 s80, s80, 1
    s_cmp_lg_u32 s80, 0
    s_cbranch_scc1 LW_66
LWD_67:
    ds_read_b64 v[8:9], v5 offset:0
    ds_read_b64 v[10:11], v5 offset:2048
    ds_read_b64 v[12:13], v5 offset:4096
    ds_read_b64 v[14:15], v5 offset:6144
    ds_read_b64 v[16:17], v5 offset:8192
    ds_read_b64 v[18:19], v5 offset:10240
    ds_read_b64 v[20:21], v5 offset:12288
    ds_read_b64 v[22:23], v5 offset:14336
    s_waitcnt lgkmcnt(0)
    v_pk_add_f32 v[8:9], v[8:9], v[16:17]
    v_pk_add_f32 v[10:11], v[10:11], v[18:19]
    v_pk_add_f32 v[12:13], v[12:13], v[20:21]
    v_pk_add_f32 v[14:15], v[14:15], v[22:23]
    v_pk_add_f32 v[8:9], v[8:9], v[12:13]
    v_pk_add_f32 v[10:11], v[10:11], v[14:15]
    v_pk_add_f32 v[8:9], v[8:9], v[10:11]
    v_cvt_pk_bf16_f32 v8, v8, v9
    ds_write_b32 v4, v8
    v_mov_b32 v160, 0x24020
    v_mov_b32 v161, 1
    s_waitcnt lgkmcnt(0)
    s_mov_b64 exec, 1
    ds_add_u32 v160, v161
    s_mov_b64 exec, -1
    s_endpgm
L_W2:
    s_mov_b32 s52, s24
    s_and_b32 s53, s25, 0xffff
    s_mov_b32 s54, 0x400000
    s_mov_b32 s55, 0x20000
    s_sub_u32 s62, s3, 8
    s_lshl_b32 s7, s5, 2
    s_add_u32 s7, s7, s62
    s_lshl_b32 s7, s7, 17
    s_lshl_b32 s70, s4, 10
    s_add_u32 s70, s70, s7
    s_lshl_b32 s71, s62, 14
    v_lshlrev_b32 v2, 4, v1
    s_barrier
    v_xor_b32 v4, 0x0, v2
    s_mov_b32 m0, s71
    s_nop 0
    buffer_load_dwordx4 v4, s[52:55], s70 offen nt lds
    s_add_u32 s70, s70, 8192
    s_add_u32 s71, s71, 1024
    v_xor_b32 v5, 0x10, v2
    s_mov_b32 m0, s71
    s_nop 0
    buffer_load_dwordx4 v5, s[52:55], s70 offen nt lds
    s_add_u32 s70, s70, 8192
    s_add_u32 s71, s71, 1024
    v_xor_b32 v4, 0x20, v2
    s_mov_b32 m0, s71
    s_nop 0
    buffer_load_dwordx4 v4, s[52:55], s70 offen nt lds
    s_add_u32 s70, s70, 8192
    s_add_u32 s71, s71, 1024
    v_xor_b32 v5, 0x30, v2
    s_mov_b32 m0, s71
    s_nop 0
    buffer_load_dwordx4 v5, s[52:55], s70 offen nt lds
    s_add_u32 s70, s70, 8192
    s_add_u32 s71, s71, 1024
    v_xor_b32 v4, 0x40, v2
    s_mov_b32 m0, s71
    s_nop 0
    buffer_load_dwordx4 v4, s[52:55], s70 offen nt lds
    s_add_u32 s70, s70, 8192
    s_add_u32 s71, s71, 1024
    v_xor_b32 v5, 0x50, v2
    s_mov_b32 m0, s71
    s_nop 0
    buffer_load_dwordx4 v5, s[52:55], s70 offen nt lds
    s_add_u32 s70, s70, 8192
    s_add_u32 s71, s71, 1024
    v_xor_b32 v4, 0x60, v2
    s_mov_b32 m0, s71
    s_nop 0
    buffer_load_dwordx4 v4, s[52:55], s70 offen nt lds
    s_add_u32 s70, s70, 8192
    s_add_u32 s71, s71, 1024
    v_xor_b32 v5, 0x70, v2
    s_mov_b32 m0, s71
    s_nop 0
    buffer_load_dwordx4 v5, s[52:55], s70 offen nt lds
    s_add_u32 s70, s70, 8192
    s_add_u32 s71, s71, 1024
    v_xor_b32 v4, 0x80, v2
    s_mov_b32 m0, s71
    s_waitcnt vmcnt(7)
    buffer_load_dwordx4 v4, s[52:55], s70 offen nt lds
    s_add_u32 s70, s70, 8192
    s_add_u32 s71, s71, 1024
    v_xor_b32 v5, 0x90, v2
    s_mov_b32 m0, s71
    s_waitcnt vmcnt(7)
    buffer_load_dwordx4 v5, s[52:55], s70 offen nt lds
    s_add_u32 s70, s70, 8192
    s_add_u32 s71, s71, 1024
    v_xor_b32 v4, 0xa0, v2
    s_mov_b32 m0, s71
    s_waitcnt vmcnt(7)
    buffer_load_dwordx4 v4, s[52:55], s70 offen nt lds
    s_add_u32 s70, s70, 8192
    s_add_u32 s71, s71, 1024
    v_xor_b32 v5, 0xb0, v2
    s_mov_b32 m0, s71
    s_waitcnt vmcnt(7)
    buffer_load_dwordx4 v5, s[52:55], s70 offen nt lds
    s_add_u32 s70, s70, 8192
    s_add_u32 s71, s71, 1024
    v_xor_b32 v4, 0xc0, v2
    s_mov_b32 m0, s71
    s_waitcnt vmcnt(7)
    buffer_load_dwordx4 v4, s[52:55], s70 offen nt lds
    s_add_u32 s70, s70, 8192
    s_add_u32 s71, s71, 1024
    v_xor_b32 v5, 0xd0, v2
    s_mov_b32 m0, s71
    s_waitcnt vmcnt(7)
    buffer_load_dwordx4 v5, s[52:55], s70 offen nt lds
    s_add_u32 s70, s70, 8192
    s_add_u32 s71, s71, 1024
    v_xor_b32 v4, 0xe0, v2
    s_mov_b32 m0, s71
    s_waitcnt vmcnt(7)
    buffer_load_dwordx4 v4, s[52:55], s70 offen nt lds
    s_add_u32 s70, s70, 8192
    s_add_u32 s71, s71, 1024
    v_xor_b32 v5, 0xf0, v2
    s_mov_b32 m0, s71
    s_waitcnt vmcnt(7)
    buffer_load_dwordx4 v5, s[52:55], s70 offen nt lds
    s_add_u32 s70, s70, 8192
    s_add_u32 s71, s71, 1024
    s_cmp_lt_u32 s5, 4
    s_cselect_b32 s72, s28, s16
    s_cselect_b32 s73, s29, s17
    s_mov_b32 s56, s72
    s_and_b32 s57, s73, 0xffff
    s_mov_b32 s58, 0x400000
    s_mov_b32 s59, 0x20000
    v_lshrrev_b32 v4, 4, v1
    v_lshlrev_b32 v2, 13, v4
    v_and_b32 v4, 15, v1
    v_lshl_add_u32 v2, v4, 4, v2
    s_lshl_b32 s7, s6, 17
    s_lshl_b32 s70, s62, 8
    s_add_u32 s7, s7, s70
    v_add_u32 v2, s7, v2
    v_lshrrev_b32 v3, 4, v1
    v_lshlrev_b32 v3, 16, v3
    v_bfe_u32 v4, v1, 3, 1
    v_lshl_add_u32 v3, v4, 13, v3
    v_and_b32 v4, 7, v1
    v_lshl_add_u32 v3, v4, 4, v3
    s_cmp_lt_u32 s5, 4
    s_cselect_b32 s7, 0x800, 0x0
    s_add_u32 s7, s7, s6
    s_lshl_b32 s7, s7, 7
    s_add_u32 s7, s7, 0x100000
    v_add_u32 v3, s7, v3
    s_lshl_b32 s7, s62, 14
    v_add_u32 v3, s7, v3
    s_waitcnt vmcnt(0)
    v_mov_b32 v4, 0x24014
    v_mov_b32 v5, 1
    s_waitcnt lgkmcnt(0)
    s_mov_b64 exec, 1
    ds_add_u32 v4, v5
    s_mov_b64 exec, -1
    s_mov_b32 s70, 0
    v_mov_b32 v4, 0x24048
    s_mov_b32 s80, 1600000
LW_70:
    ds_read_b32 v5, v4
    s_waitcnt lgkmcnt(0)
    v_readfirstlane_b32 s79, v5
    s_cmp_ge_u32 s79, 4
    s_cbranch_scc1 LWD_71
    s_sleep 4
    s_sub_u32 s80, s80, 1
    s_cmp_lg_u32 s80, 0
    s_cbranch_scc1 LW_70
LWD_71:
    s_cmp_lt_u32 s5, 4
    s_cbranch_scc1 S2U_68
    buffer_load_dwordx4 v[40:43], v2, s[56:59], s70 offen offset:0 nt
    buffer_load_dwordx4 v[44:47], v2, s[56:59], s70 offen offset:1024 nt
    buffer_load_dwordx4 v[48:51], v2, s[56:59], s70 offen offset:2048 nt
    buffer_load_dwordx4 v[52:55], v2, s[56:59], s70 offen offset:3072 nt
    s_add_u32 s70, s70, 4096
    s_waitcnt vmcnt(0)
    buffer_load_dwordx4 v[56:59], v2, s[56:59], s70 offen offset:0 nt
    buffer_load_dwordx4 v[60:63], v2, s[56:59], s70 offen offset:1024 nt
    buffer_load_dwordx4 v[64:67], v2, s[56:59], s70 offen offset:2048 nt
    buffer_load_dwordx4 v[68:71], v2, s[56:59], s70 offen offset:3072 nt
    s_add_u32 s70, s70, 28672
    s_waitcnt vmcnt(0)
    buffer_load_dwordx4 v[72:75], v2, s[56:59], s70 offen offset:0 nt
    buffer_load_dwordx4 v[76:79], v2, s[56:59], s70 offen offset:1024 nt
    buffer_load_dwordx4 v[80:83], v2, s[56:59], s70 offen offset:2048 nt
    buffer_load_dwordx4 v[84:87], v2, s[56:59], s70 offen offset:3072 nt
    s_add_u32 s70, s70, 4096
    s_waitcnt vmcnt(0)
    buffer_load_dwordx4 v[88:91], v2, s[56:59], s70 offen offset:0 nt
    buffer_load_dwordx4 v[92:95], v2, s[56:59], s70 offen offset:1024 nt
    buffer_load_dwordx4 v[96:99], v2, s[56:59], s70 offen offset:2048 nt
    buffer_load_dwordx4 v[100:103], v2, s[56:59], s70 offen offset:3072 nt
    s_add_u32 s70, s70, 28672
    s_waitcnt vmcnt(0)
    buffer_load_dwordx4 v[104:107], v2, s[56:59], s70 offen offset:0 nt
    buffer_load_dwordx4 v[108:111], v2, s[56:59], s70 offen offset:1024 nt
    buffer_load_dwordx4 v[112:115], v2, s[56:59], s70 offen offset:2048 nt
    buffer_load_dwordx4 v[116:119], v2, s[56:59], s70 offen offset:3072 nt
    s_add_u32 s70, s70, 4096
    s_waitcnt vmcnt(0)
    buffer_load_dwordx4 v[120:123], v2, s[56:59], s70 offen offset:0 nt
    buffer_load_dwordx4 v[124:127], v2, s[56:59], s70 offen offset:1024 nt
    buffer_load_dwordx4 v[128:131], v2, s[56:59], s70 offen offset:2048 nt
    buffer_load_dwordx4 v[132:135], v2, s[56:59], s70 offen offset:3072 nt
    s_add_u32 s70, s70, 28672
    s_waitcnt vmcnt(0)
    buffer_load_dwordx4 v[136:139], v2, s[56:59], s70 offen offset:0 nt
    buffer_load_dwordx4 v[140:143], v2, s[56:59], s70 offen offset:1024 nt
    buffer_load_dwordx4 v[144:147], v2, s[56:59], s70 offen offset:2048 nt
    buffer_load_dwordx4 v[148:151], v2, s[56:59], s70 offen offset:3072 nt
    s_add_u32 s70, s70, 4096
    s_waitcnt vmcnt(0)
    buffer_load_dwordx4 v[152:155], v2, s[56:59], s70 offen offset:0 nt
    buffer_load_dwordx4 v[156:159], v2, s[56:59], s70 offen offset:1024 nt
    buffer_load_dwordx4 v[160:163], v2, s[56:59], s70 offen offset:2048 nt
    buffer_load_dwordx4 v[164:167], v2, s[56:59], s70 offen offset:3072 nt
    s_add_u32 s70, s70, 28672
    s_waitcnt vmcnt(0)
    s_branch S2J_69
S2U_68:
    buffer_load_dwordx4 v[40:43], v2, s[56:59], s70 offen offset:0 nt
    buffer_load_dwordx4 v[44:47], v2, s[56:59], s70 offen offset:1024 nt
    buffer_load_dwordx4 v[48:51], v2, s[56:59], s70 offen offset:2048 nt
    buffer_load_dwordx4 v[52:55], v2, s[56:59], s70 offen offset:3072 nt
    s_add_u32 s70, s70, 4096
    s_waitcnt vmcnt(2)
    buffer_load_dwordx4 v[56:59], v2, s[56:59], s70 offen offset:0 nt
    buffer_load_dwordx4 v[60:63], v2, s[56:59], s70 offen offset:1024 nt
    buffer_load_dwordx4 v[64:67], v2, s[56:59], s70 offen offset:2048 nt
    buffer_load_dwordx4 v[68:71], v2, s[56:59], s70 offen offset:3072 nt
    s_add_u32 s70, s70, 28672
    s_waitcnt vmcnt(2)
    buffer_load_dwordx4 v[72:75], v2, s[56:59], s70 offen offset:0 nt
    buffer_load_dwordx4 v[76:79], v2, s[56:59], s70 offen offset:1024 nt
    buffer_load_dwordx4 v[80:83], v2, s[56:59], s70 offen offset:2048 nt
    buffer_load_dwordx4 v[84:87], v2, s[56:59], s70 offen offset:3072 nt
    s_add_u32 s70, s70, 4096
    s_waitcnt vmcnt(2)
    buffer_load_dwordx4 v[88:91], v2, s[56:59], s70 offen offset:0 nt
    buffer_load_dwordx4 v[92:95], v2, s[56:59], s70 offen offset:1024 nt
    buffer_load_dwordx4 v[96:99], v2, s[56:59], s70 offen offset:2048 nt
    buffer_load_dwordx4 v[100:103], v2, s[56:59], s70 offen offset:3072 nt
    s_add_u32 s70, s70, 28672
    s_waitcnt vmcnt(2)
    buffer_load_dwordx4 v[104:107], v2, s[56:59], s70 offen offset:0 nt
    buffer_load_dwordx4 v[108:111], v2, s[56:59], s70 offen offset:1024 nt
    buffer_load_dwordx4 v[112:115], v2, s[56:59], s70 offen offset:2048 nt
    buffer_load_dwordx4 v[116:119], v2, s[56:59], s70 offen offset:3072 nt
    s_add_u32 s70, s70, 4096
    s_waitcnt vmcnt(2)
    buffer_load_dwordx4 v[120:123], v2, s[56:59], s70 offen offset:0 nt
    buffer_load_dwordx4 v[124:127], v2, s[56:59], s70 offen offset:1024 nt
    buffer_load_dwordx4 v[128:131], v2, s[56:59], s70 offen offset:2048 nt
    buffer_load_dwordx4 v[132:135], v2, s[56:59], s70 offen offset:3072 nt
    s_add_u32 s70, s70, 28672
    s_waitcnt vmcnt(2)
    buffer_load_dwordx4 v[136:139], v2, s[56:59], s70 offen offset:0 nt
    buffer_load_dwordx4 v[140:143], v2, s[56:59], s70 offen offset:1024 nt
    buffer_load_dwordx4 v[144:147], v2, s[56:59], s70 offen offset:2048 nt
    buffer_load_dwordx4 v[148:151], v2, s[56:59], s70 offen offset:3072 nt
    s_add_u32 s70, s70, 4096
    s_waitcnt vmcnt(2)
    buffer_load_dwordx4 v[152:155], v2, s[56:59], s70 offen offset:0 nt
    buffer_load_dwordx4 v[156:159], v2, s[56:59], s70 offen offset:1024 nt
    buffer_load_dwordx4 v[160:163], v2, s[56:59], s70 offen offset:2048 nt
    buffer_load_dwordx4 v[164:167], v2, s[56:59], s70 offen offset:3072 nt
    s_add_u32 s70, s70, 28672
    s_waitcnt vmcnt(0)
S2J_69:
    v_perm_b32 v8, v44, v40, s92
    v_perm_b32 v9, v52, v48, s92
    v_perm_b32 v10, v60, v56, s92
    v_perm_b32 v11, v68, v64, s92
    v_perm_b32 v12, v44, v40, s93
    v_perm_b32 v13, v52, v48, s93
    v_perm_b32 v14, v60, v56, s93
    v_perm_b32 v15, v68, v64, s93
    v_perm_b32 v16, v45, v41, s92
    v_perm_b32 v17, v53, v49, s92
    v_perm_b32 v18, v61, v57, s92
    v_perm_b32 v19, v69, v65, s92
    v_perm_b32 v20, v45, v41, s93
    v_perm_b32 v21, v53, v49, s93
    v_perm_b32 v22, v61, v57, s93
    v_perm_b32 v23, v69, v65, s93
    v_perm_b32 v24, v46, v42, s92
    v_perm_b32 v25, v54, v50, s92
    v_perm_b32 v26, v62, v58, s92
    v_perm_b32 v27, v70, v66, s92
    v_perm_b32 v28, v46, v42, s93
    v_perm_b32 v29, v54, v50, s93
    v_perm_b32 v30, v62, v58, s93
    v_perm_b32 v31, v70, v66, s93
    v_perm_b32 v32, v47, v43, s92
    v_perm_b32 v33, v55, v51, s92
    v_perm_b32 v34, v63, v59, s92
    v_perm_b32 v35, v71, v67, s92
    v_perm_b32 v36, v47, v43, s93
    v_perm_b32 v37, v55, v51, s93
    v_perm_b32 v38, v63, v59, s93
    v_perm_b32 v39, v71, v67, s93
    v_perm_b32 v40, v76, v72, s92
    v_perm_b32 v41, v84, v80, s92
    v_perm_b32 v42, v92, v88, s92
    v_perm_b32 v43, v100, v96, s92
    v_perm_b32 v44, v76, v72, s93
    v_perm_b32 v45, v84, v80, s93
    v_perm_b32 v46, v92, v88, s93
    v_perm_b32 v47, v100, v96, s93
    v_perm_b32 v48, v77, v73, s92
    v_perm_b32 v49, v85, v81, s92
    v_perm_b32 v50, v93, v89, s92
    v_perm_b32 v51, v101, v97, s92
    v_perm_b32 v52, v77, v73, s93
    v_perm_b32 v53, v85, v81, s93
    v_perm_b32 v54, v93, v89, s93
    v_perm_b32 v55, v101, v97, s93
    v_perm_b32 v56, v78, v74, s92
    v_perm_b32 v57, v86, v82, s92
    v_perm_b32 v58, v94, v90, s92
    v_perm_b32 v59, v102, v98, s92
    v_perm_b32 v60, v78, v74, s93
    v_perm_b32 v61, v86, v82, s93
    v_perm_b32 v62, v94, v90, s93
    v_perm_b32 v63, v102, v98, s93
    v_perm_b32 v64, v79, v75, s92
    v_perm_b32 v65, v87, v83, s92
    v_perm_b32 v66, v95, v91, s92
    v_perm_b32 v67, v103, v99, s92
    v_perm_b32 v68, v79, v75, s93
    v_perm_b32 v69, v87, v83, s93
    v_perm_b32 v70, v95, v91, s93
    v_perm_b32 v71, v103, v99, s93
    v_perm_b32 v72, v108, v104, s92
    v_perm_b32 v73, v116, v112, s92
    v_perm_b32 v74, v124, v120, s92
    v_perm_b32 v75, v132, v128, s92
    v_perm_b32 v76, v108, v104, s93
    v_perm_b32 v77, v116, v112, s93
    v_perm_b32 v78, v124, v120, s93
    v_perm_b32 v79, v132, v128, s93
    v_perm_b32 v80, v109, v105, s92
    v_perm_b32 v81, v117, v113, s92
    v_perm_b32 v82, v125, v121, s92
    v_perm_b32 v83, v133, v129, s92
    v_perm_b32 v84, v109, v105, s93
    v_perm_b32 v85, v117, v113, s93
    v_perm_b32 v86, v125, v121, s93
    v_perm_b32 v87, v133, v129, s93
    v_perm_b32 v88, v110, v106, s92
    v_perm_b32 v89, v118, v114, s92
    v_perm_b32 v90, v126, v122, s92
    v_perm_b32 v91, v134, v130, s92
    v_perm_b32 v92, v110, v106, s93
    v_perm_b32 v93, v118, v114, s93
    v_perm_b32 v94, v126, v122, s93
    v_perm_b32 v95, v134, v130, s93
    v_perm_b32 v96, v111, v107, s92
    v_perm_b32 v97, v119, v115, s92
    v_perm_b32 v98, v127, v123, s92
    v_perm_b32 v99, v135, v131, s92
    v_perm_b32 v100, v111, v107, s93
    v_perm_b32 v101, v119, v115, s93
    v_perm_b32 v102, v127, v123, s93
    v_perm_b32 v103, v135, v131, s93
    v_perm_b32 v104, v140, v136, s92
    v_perm_b32 v105, v148, v144, s92
    v_perm_b32 v106, v156, v152, s92
    v_perm_b32 v107, v164, v160, s92
    v_perm_b32 v108, v140, v136, s93
    v_perm_b32 v109, v148, v144, s93
    v_perm_b32 v110, v156, v152, s93
    v_perm_b32 v111, v164, v160, s93
    v_perm_b32 v112, v141, v137, s92
    v_perm_b32 v113, v149, v145, s92
    v_perm_b32 v114, v157, v153, s92
    v_perm_b32 v115, v165, v161, s92
    v_perm_b32 v116, v141, v137, s93
    v_perm_b32 v117, v149, v145, s93
    v_perm_b32 v118, v157, v153, s93
    v_perm_b32 v119, v165, v161, s93
    v_perm_b32 v120, v142, v138, s92
    v_perm_b32 v121, v150, v146, s92
    v_perm_b32 v122, v158, v154, s92
    v_perm_b32 v123, v166, v162, s92
    v_perm_b32 v124, v142, v138, s93
    v_perm_b32 v125, v150, v146, s93
    v_perm_b32 v126, v158, v154, s93
    v_perm_b32 v127, v166, v162, s93
    v_perm_b32 v128, v143, v139, s92
    v_perm_b32 v129, v151, v147, s92
    v_perm_b32 v130, v159, v155, s92
    v_perm_b32 v131, v167, v163, s92
    v_perm_b32 v132, v143, v139, s93
    v_perm_b32 v133, v151, v147, s93
    v_perm_b32 v134, v159, v155, s93
    v_perm_b32 v135, v167, v163, s93
    v_bfe_u32 v4, v1, 2, 2
    v_lshlrev_b32 v4, 8, v4
    v_lshrrev_b32 v160, 4, v1
    v_lshl_add_u32 v4, v160, 4, v4
    s_mov_b32 s70, 4096
    s_cmp_ge_u32 s5, 4
    s_cbranch_scc1 S2X_72
    v_add_u32 v4, 0x24400, v4
    v_mov_b32 v160, 0x24020
    s_mov_b32 s80, 1600000
LW_74:
    ds_read_b32 v161, v160
    s_waitcnt lgkmcnt(0)
    v_readfirstlane_b32 s79, v161
    s_cmp_ge_u32 s79, 8
    s_cbranch_scc1 LWD_75
    s_sleep 1
    s_sub_u32 s80, s80, 1
    s_cmp_lg_u32 s80, 0
    s_cbranch_scc1 LW_74
LWD_75:
    s_setprio 3
    ds_read_b128 v[136:139], v4 offset:0
    ds_read_b128 v[140:143], v4 offset:64
    ds_read_b128 v[144:147], v4 offset:128
    ds_read_b128 v[148:151], v4 offset:192
    s_waitcnt lgkmcnt(0)
    s_branch S2M_73
S2X_72:
    v_and_b32 v160, 3, v1
    v_lshl_add_u32 v4, v160, 6, v4
    s_lshl_b32 s7, s6, 10
    s_add_u32 s7, s7, 0xa0000
    v_add_u32 v4, s7, v4
    v_mov_b32 v160, 0x24018
    s_mov_b32 s80, 1600000
LW_76:
    ds_read_b32 v161, v160
    s_waitcnt lgkmcnt(0)
    v_readfirstlane_b32 s79, v161
    s_cmp_ge_u32 s79, 1
    s_cbranch_scc1 LWD_77
    s_sleep 4
    s_sub_u32 s80, s80, 1
    s_cmp_lg_u32 s80, 0
    s_cbranch_scc1 LW_76
LWD_77:
    s_mov_b32 s80, 200000
PO_78:
    buffer_load_dwordx4 v[152:155], v4, s[36:39], 0 offen sc1
PO2_79:
    s_waitcnt vmcnt(0)
    v_max_u32 v160, v152, v153
    v_max3_u32 v160, v160, v154, v155
    v_cmp_eq_u32 vcc, -1, v160
    s_cmp_lg_u64 vcc, -1
    s_cbranch_scc1 POD_80
    s_sleep 8
    s_sub_u32 s80, s80, 1
    s_cmp_lg_u32 s80, 0
    s_cbranch_scc1 PO_78
POD_80:
    s_setprio 3
    s_mov_b32 s80, 200000
PO_81:
    buffer_load_dwordx4 v[152:155], v4, s[36:39], 0 offen sc1
PO2_82:
    s_waitcnt vmcnt(0)
    v_max_u32 v160, v152, v153
    v_max3_u32 v160, v160, v154, v155
    v_cmp_eq_u32 vcc, -1, v160
    s_cbranch_vccz POD_83
    s_sub_u32 s80, s80, 1
    s_cmp_lg_u32 s80, 0
    s_cbranch_scc1 PO_81
POD_83:
    v_mov_b32_dpp v136, v152 quad_perm:[0,0,0,0] row_mask:0xf bank_mask:0xf
    v_mov_b32_dpp v137, v153 quad_perm:[0,0,0,0] row_mask:0xf bank_mask:0xf
    v_mov_b32_dpp v138, v154 quad_perm:[0,0,0,0] row_mask:0xf bank_mask:0xf
    v_mov_b32_dpp v139, v155 quad_perm:[0,0,0,0] row_mask:0xf bank_mask:0xf
    v_mov_b32_dpp v140, v152 quad_perm:[1,1,1,1] row_mask:0xf bank_mask:0xf
    v_mov_b32_dpp v141, v153 quad_perm:[1,1,1,1] row_mask:0xf bank_mask:0xf
    v_mov_b32_dpp v142, v154 quad_perm:[1,1,1,1] row_mask:0xf bank_mask:0xf
    v_mov_b32_dpp v143, v155 quad_perm:[1,1,1,1] row_mask:0xf bank_mask:0xf
    v_mov_b32_dpp v144, v152 quad_perm:[2,2,2,2] row_mask:0xf bank_mask:0xf
    v_mov_b32_dpp v145, v153 quad_perm:[2,2,2,2] row_mask:0xf bank_mask:0xf
    v_mov_b32_dpp v146, v154 quad_perm:[2,2,2,2] row_mask:0xf bank_mask:0xf
    v_mov_b32_dpp v147, v155 quad_perm:[2,2,2,2] row_mask:0xf bank_mask:0xf
    v_mov_b32_dpp v148, v152 quad_perm:[3,3,3,3] row_mask:0xf bank_mask:0xf
    v_mov_b32_dpp v149, v153 quad_perm:[3,3,3,3] row_mask:0xf bank_mask:0xf
    v_mov_b32_dpp v150, v154 quad_perm:[3,3,3,3] row_mask:0xf bank_mask:0xf
    v_mov_b32_dpp v151, v155 quad_perm:[3,3,3,3] row_mask:0xf bank_mask:0xf
S2M_73:
    s_nop 1
    v_mfma_f32_16x16x32_bf16 v[152:155], v[136:139], v[8:11], 0
    v_mfma_f32_16x16x32_bf16 v[156:159], v[136:139], v[12:15], 0
    v_mfma_f32_16x16x32_bf16 v[152:155], v[140:143], v[40:43], v[152:155]
    v_mfma_f32_16x16x32_bf16 v[156:159], v[140:143], v[44:47], v[156:159]
    v_mfma_f32_16x16x32_bf16 v[152:155], v[144:147], v[72:75], v[152:155]
    v_mfma_f32_16x16x32_bf16 v[156:159], v[144:147], v[76:79], v[156:159]
    v_mfma_f32_16x16x32_bf16 v[152:155], v[148:151], v[104:107], v[152:155]
    v_mfma_f32_16x16x32_bf16 v[156:159], v[148:151], v[108:111], v[156:159]
    v_mfma_f32_16x16x32_bf16 v[8:11], v[136:139], v[16:19], 0
    v_mfma_f32_16x16x32_bf16 v[12:15], v[136:139], v[20:23], 0
    v_mfma_f32_16x16x32_bf16 v[8:11], v[140:143], v[48:51], v[8:11]
    v_mfma_f32_16x16x32_bf16 v[12:15], v[140:143], v[52:55], v[12:15]
    v_mfma_f32_16x16x32_bf16 v[8:11], v[144:147], v[80:83], v[8:11]
    v_mfma_f32_16x16x32_bf16 v[12:15], v[144:147], v[84:87], v[12:15]
    v_mfma_f32_16x16x32_bf16 v[8:11], v[148:151], v[112:115], v[8:11]
    v_mfma_f32_16x16x32_bf16 v[12:15], v[148:151], v[116:119], v[12:15]
    v_mfma_f32_16x16x32_bf16 v[16:19], v[136:139], v[24:27], 0
    v_mfma_f32_16x16x32_bf16 v[20:23], v[136:139], v[28:31], 0
    v_mfma_f32_16x16x32_bf16 v[16:19], v[140:143], v[56:59], v[16:19]
    v_mfma_f32_16x16x32_bf16 v[20:23], v[140:143], v[60:63], v[20:23]
    v_mfma_f32_16x16x32_bf16 v[16:19], v[144:147], v[88:91], v[16:19]
    v_mfma_f32_16x16x32_bf16 v[20:23], v[144:147], v[92:95], v[20:23]
    v_mfma_f32_16x16x32_bf16 v[16:19], v[148:151], v[120:123], v[16:19]
    v_mfma_f32_16x16x32_bf16 v[20:23], v[148:151], v[124:127], v[20:23]
    v_mfma_f32_16x16x32_bf16 v[24:27], v[136:139], v[32:35], 0
    v_mfma_f32_16x16x32_bf16 v[28:31], v[136:139], v[36:39], 0
    v_mfma_f32_16x16x32_bf16 v[24:27], v[140:143], v[64:67], v[24:27]
    v_mfma_f32_16x16x32_bf16 v[28:31], v[140:143], v[68:71], v[28:31]
    v_mfma_f32_16x16x32_bf16 v[24:27], v[144:147], v[96:99], v[24:27]
    v_mfma_f32_16x16x32_bf16 v[28:31], v[144:147], v[100:103], v[28:31]
    v_mfma_f32_16x16x32_bf16 v[24:27], v[148:151], v[128:131], v[24:27]
    v_mfma_f32_16x16x32_bf16 v[28:31], v[148:151], v[132:135], v[28:31]
    v_mov_b32 v40, v152
    v_mov_b32 v41, v156
    v_mov_b32 v42, v8
    v_mov_b32 v43, v12
    buffer_store_dwordx4 v[40:43], v3, s[36:39], 0 offen sc1
    v_mov_b32 v44, v16
    v_mov_b32 v45, v20
    v_mov_b32 v46, v24
    v_mov_b32 v47, v28
    buffer_store_dwordx4 v[44:47], v3, s[36:39], s70 offen sc1
    s_endpgm
L_C:
    s_cmp_ge_u32 s3, 8
    s_cbranch_scc1 L_CSVC
    s_mov_b32 s44, s20
    s_and_b32 s45, s21, 0xffff
    s_mov_b32 s46, 0x1000000
    s_mov_b32 s47, 0x20000
    s_lshl_b32 s60, s4, 3
    s_add_u32 s60, s60, s5
    s_sub_u32 s60, s60, 8
    s_lshr_b32 s64, s3, 1
    s_and_b32 s65, s3, 1
    s_mov_b32 s67, 0x3e0293ee
    v_lshlrev_b32 v160, 4, v1
    s_and_b32 s7, s3, 3
    s_lshl_b32 s7, s7, 2
    s_lshr_b32 s66, s3, 2
    s_or_b32 s7, s7, s66
    s_lshl_b32 s7, s7, 4
    v_xor_b32 v2, s7, v160
    v_xor_b32 v3, 32, v2
    s_lshl_b32 s70, s60, 18
    s_lshl_b32 s68, s3, 10
    s_add_u32 s66, s70, s68
    s_mov_b32 m0, s68
    s_nop 0
    buffer_load_dwordx4 v2, s[44:47], s66 offen nt lds
    s_add_u32 s68, s68, 8192
    s_add_u32 s66, s66, 8192
    s_mov_b32 m0, s68
    s_nop 0
    buffer_load_dwordx4 v3, s[44:47], s66 offen nt lds
    s_add_u32 s68, s68, 8192
    s_add_u32 s66, s66, 8192
    s_mov_b32 m0, s68
    s_nop 0
    buffer_load_dwordx4 v2, s[44:47], s66 offen nt lds
    s_add_u32 s68, s68, 8192
    s_barrier
    s_add_u32 s66, s66, 8192
    s_mov_b32 m0, s68
    s_nop 0
    buffer_load_dwordx4 v3, s[44:47], s66 offen nt lds
    s_add_u32 s68, s68, 8192
    s_add_u32 s66, s66, 8192
    s_mov_b32 m0, s68
    s_nop 0
    buffer_load_dwordx4 v2, s[44:47], s66 offen nt lds
    s_add_u32 s68, s68, 8192
    s_add_u32 s66, s66, 8192
    s_mov_b32 m0, s68
    s_waitcnt vmcnt(4)
    buffer_load_dwordx4 v3, s[44:47], s66 offen nt lds
    s_add_u32 s68, s68, 8192
    s_add_u32 s66, s66, 8192
    s_mov_b32 m0, s68
    s_waitcnt vmcnt(4)
    buffer_load_dwordx4 v2, s[44:47], s66 offen nt lds
    s_add_u32 s68, s68, 8192
    s_add_u32 s66, s66, 8192
    s_mov_b32 m0, s68
    s_waitcnt vmcnt(4)
    buffer_load_dwordx4 v3, s[44:47], s66 offen nt lds
    s_add_u32 s68, s68, 8192
    s_add_u32 s66, s66, 8192
    s_mov_b32 m0, s68
    s_waitcnt vmcnt(4)
    buffer_load_dwordx4 v2, s[44:47], s66 offen nt lds
    s_add_u32 s68, s68, 8192
    s_add_u32 s66, s66, 8192
    s_mov_b32 m0, s68
    s_waitcnt vmcnt(4)
    buffer_load_dwordx4 v3, s[44:47], s66 offen nt lds
    s_add_u32 s68, s68, 8192
    s_add_u32 s66, s66, 8192
    s_mov_b32 m0, s68
    s_waitcnt vmcnt(4)
    buffer_load_dwordx4 v2, s[44:47], s66 offen nt lds
    s_add_u32 s68, s68, 8192
    s_add_u32 s66, s66, 8192
    s_mov_b32 m0, s68
    s_waitcnt vmcnt(4)
    buffer_load_dwordx4 v3, s[44:47], s66 offen nt lds
    s_add_u32 s68, s68, 8192
    s_add_u32 s66, s66, 8192
    s_waitcnt vmcnt(4)
    buffer_load_dwordx4 v[128:131], v2, s[44:47], s66 offen nt
    s_add_u32 s66, s66, 8192
    s_waitcnt vmcnt(4)
    buffer_load_dwordx4 v[132:135], v3, s[44:47], s66 offen nt
    s_add_u32 s66, s66, 8192
    s_waitcnt vmcnt(4)
    buffer_load_dwordx4 v[136:139], v2, s[44:47], s66 offen nt
    s_add_u32 s66, s66, 8192
    s_waitcnt vmcnt(4)
    buffer_load_dwordx4 v[140:143], v3, s[44:47], s66 offen nt
    s_add_u32 s66, s66, 8192
    s_waitcnt vmcnt(4)
    buffer_load_dwordx4 v[96:99], v2, s[44:47], s66 offen nt
    s_add_u32 s66, s66, 8192
    s_waitcnt vmcnt(4)
    buffer_load_dwordx4 v[100:103], v3, s[44:47], s66 offen nt
    s_add_u32 s66, s66, 8192
    s_waitcnt vmcnt(4)
    buffer_load_dwordx4 v[104:107], v2, s[44:47], s66 offen nt
    s_add_u32 s66, s66, 8192
    s_waitcnt vmcnt(4)
    buffer_load_dwordx4 v[108:111], v3, s[44:47], s66 offen nt
    s_add_u32 s66, s66, 8192
    s_waitcnt vmcnt(4)
    buffer_load_dwordx4 v[112:115], v2, s[44:47], s66 offen nt
    s_add_u32 s66, s66, 8192
    s_waitcnt vmcnt(4)
    buffer_load_dwordx4 v[116:119], v3, s[44:47], s66 offen nt
    s_add_u32 s66, s66, 8192
    s_waitcnt vmcnt(4)
    buffer_load_dwordx4 v[120:123], v2, s[44:47], s66 offen nt
    s_add_u32 s66, s66, 8192
    s_waitcnt vmcnt(4)
    buffer_load_dwordx4 v[124:127], v3, s[44:47], s66 offen nt
    s_add_u32 s66, s66, 8192
    v_and_b32 v160, 15, v1
    v_lshlrev_b32 v4, 10, v160
    v_lshrrev_b32 v161, 4, v1
    v_lshl_add_u32 v4, v161, 8, v4
    v_lshl_add_u32 v3, v160, 4, v4
    s_lshl_b32 s7, s65, 14
    s_add_u32 s7, s7, 0x18000
    v_add_u32 v3, s7, v3
    v_and_b32 v162, 3, v1
    v_lshl_add_u32 v4, v162, 6, v4
    v_bfe_u32 v162, v1, 2, 2
    v_lshl_add_u32 v4, v162, 4, v4
    s_lshl_b32 s7, s64, 14
    v_add_u32 v4, s7, v4
    v_add_u32 v2, 0x10000, v4
    s_lshl_b32 s7, s65, 6
    s_add_u32 s7, s7, 0x27200
    v_lshl_add_u32 v5, v160, 2, s7
    s_lshl_b32 s7, s64, 10
    s_lshl_b32 s66, s65, 9
    s_add_u32 s7, s7, s66
    s_add_u32 s7, s7, 0x25200
    v_lshl_add_u32 v6, v160, 5, s7
    v_lshl_add_u32 v6, v161, 3, v6
    v_and_b32 v162, 31, v1
    v_lshlrev_b32 v7, 5, v162
    v_lshrrev_b32 v163, 5, v1
    v_lshl_add_u32 v7, v163, 4, v7
    v_add_u32 v7, 0x25200, v7
    v_lshlrev_b32 v8, 2, v162
    v_add_u32 v8, 0x27e00, v8
    v_bfe_u32 v162, v1, 2, 2
    v_lshl_add_u32 v164, v163, 3, v162
    v_lshlrev_b32 v164, 10, v164
    v_and_b32 v165, 1, v1
    v_lshl_add_u32 v164, v165, 3, v164
    s_lshl_b32 s7, s64, 8
    v_add_u32 v164, s7, v164
    v_bfe_u32 v165, v1, 4, 1
    v_lshlrev_b32 v165, 1, v165
    v_bfe_u32 v160, v1, 1, 1
    v_or_b32 v165, v165, v160
    s_lshl_b32 s7, s65, 3
    v_or_b32 v165, s7, v165
    v_lshlrev_b32 v162, 2, v162
    v_xor_b32 v165, v165, v162
    v_lshlrev_b32 v163, 1, v163
    v_xor_b32 v165, v165, v163
    v_xor_b32 v160, 0, v165
    v_lshl_add_u32 v9, v160, 4, v164
    v_xor_b32 v160, 4, v165
    v_lshl_add_u32 v10, v160, 4, v164
    v_xor_b32 v160, 1, v165
    v_lshl_add_u32 v11, v160, 4, v164
    v_add_u32 v11, 0x1000, v11
    v_xor_b32 v160, 5, v165
    v_lshl_add_u32 v12, v160, 4, v164
    v_add_u32 v12, 0x1000, v12
    v_mov_b32 v13, 0xff800000
    v_mov_b32 v14, 0
    v_cmp_gt_u32 s[86:87], 16, v1
    s_cmp_eq_u32 s64, 0
    s_cselect_b32 s88, 0xffff, 0
    s_mov_b32 s89, 0
    v_mov_b32 v160, 0x24028
    s_mov_b32 s80, 1600000
LW_84:
    ds_read_b32 v161, v160
    s_waitcnt lgkmcnt(0)
    v_readfirstlane_b32 s79, v161
    s_cmp_ge_u32 s79, 4
    s_cbranch_scc1 LWD_85
    s_sleep 1
    s_sub_u32 s80, s80, 1
    s_cmp_lg_u32 s80, 0
    s_cbranch_scc1 LW_84
LWD_85:
    v_xor_b32 v160, 0x0, v3
    ds_read_b128 v[32:35], v160
    v_xor_b32 v161, 0x10, v3
    ds_read_b128 v[36:39], v161
    v_xor_b32 v160, 0x20, v3
    ds_read_b128 v[40:43], v160
    v_xor_b32 v161, 0x30, v3
    ds_read_b128 v[44:47], v161
    v_xor_b32 v160, 0x40, v3
    ds_read_b128 v[48:51], v160
    v_xor_b32 v161, 0x50, v3
    ds_read_b128 v[52:55], v161
    v_xor_b32 v160, 0x60, v3
    ds_read_b128 v[56:59], v160
    v_xor_b32 v161, 0x70, v3
    ds_read_b128 v[60:63], v161
    v_xor_b32 v160, 0x80, v3
    ds_read_b128 v[64:67], v160
    v_xor_b32 v161, 0x90, v3
    ds_read_b128 v[68:71], v161
    v_xor_b32 v160, 0xa0, v3
    ds_read_b128 v[72:75], v160
    v_xor_b32 v161, 0xb0, v3
    ds_read_b128 v[76:79], v161
    v_xor_b32 v160, 0xc0, v3
    ds_read_b128 v[80:83], v160
    v_xor_b32 v161, 0xd0, v3
    ds_read_b128 v[84:87], v161
    v_xor_b32 v160, 0xe0, v3
    ds_read_b128 v[88:91], v160
    v_xor_b32 v161, 0xf0, v3
    ds_read_b128 v[92:95], v161
    s_lshl_b32 s7, s3, 10
    s_add_u32 s7, s7, 0x18000
    v_lshl_add_u32 v3, v1, 4, s7
    v_mov_b32 v166, 0x24010
    v_mov_b32 v167, 1
    s_waitcnt lgkmcnt(0)
    s_mov_b64 exec, 1
    ds_add_u32 v166, v167
    s_mov_b64 exec, -1
    v_mov_b32 v166, 0x24010
    s_mov_b32 s80, 1600000
LW_86:
    ds_read_b32 v167, v166
    s_waitcnt lgkmcnt(0)
    v_readfirstlane_b32 s79, v167
    s_cmp_ge_u32 s79, 8
    s_cbranch_scc1 LWD_87
    s_sub_u32 s80, s80, 1
    s_cmp_lg_u32 s80, 0
    s_cbranch_scc1 LW_86
LWD_87:
    ds_write_b128 v3, v[128:131] offset:0
    ds_write_b128 v3, v[132:135] offset:8192
    ds_write_b128 v3, v[136:139] offset:16384
    ds_write_b128 v3, v[140:143] offset:24576
    v_mov_b32 v166, 0x24034
    v_mov_b32 v167, 1
    s_waitcnt lgkmcnt(0)
    s_mov_b64 exec, 1
    ds_add_u32 v166, v167
    s_mov_b64 exec, -1
    s_setprio 0
    v_xor_b32 v160, 0x0, v4
    ds_read_b128 v[24:27], v160
    v_xor_b32 v161, 0x10, v4
    ds_read_b128 v[28:31], v161
    v_xor_b32 v162, 0x20, v4
    ds_read_b128 v[164:167], v162
    s_waitcnt lgkmcnt(2)
    v_mfma_f32_16x16x32_bf16 v[16:19], v[24:27], v[32:35], 0
    v_xor_b32 v160, 0x30, v4
    ds_read_b128 v[24:27], v160
    s_waitcnt lgkmcnt(2)
    v_mfma_f32_16x16x32_bf16 v[16:19], v[28:31], v[36:39], v[16:19]
    v_xor_b32 v161, 0x40, v4
    ds_read_b128 v[28:31], v161
    s_waitcnt lgkmcnt(2)
    v_mfma_f32_16x16x32_bf16 v[16:19], v[164:167], v[40:43], v[16:19]
    v_xor_b32 v162, 0x50, v4
    ds_read_b128 v[164:167], v162
    s_waitcnt lgkmcnt(2)
    v_mfma_f32_16x16x32_bf16 v[16:19], v[24:27], v[44:47], v[16:19]
    v_xor_b32 v160, 0x60, v4
    ds_read_b128 v[24:27], v160
    s_waitcnt lgkmcnt(2)
    v_mfma_f32_16x16x32_bf16 v[16:19], v[28:31], v[48:51], v[16:19]
    v_xor_b32 v161, 0x70, v4
    ds_read_b128 v[28:31], v161
    s_waitcnt lgkmcnt(2)
    v_mfma_f32_16x16x32_bf16 v[16:19], v[164:167], v[52:55], v[16:19]
    v_xor_b32 v162, 0x80, v4
    ds_read_b128 v[164:167], v162
    s_waitcnt lgkmcnt(2)
    v_mfma_f32_16x16x32_bf16 v[16:19], v[24:27], v[56:59], v[16:19]
    v_xor_b32 v160, 0x90, v4
    ds_read_b128 v[24:27], v160
    s_waitcnt lgkmcnt(2)
    v_mfma_f32_16x16x32_bf16 v[16:19], v[28:31], v[60:63], v[16:19]
    v_xor_b32 v161, 0xa0, v4
    ds_read_b128 v[28:31], v161
    s_waitcnt lgkmcnt(2)
    v_mfma_f32_16x16x32_bf16 v[16:19], v[164:167], v[64:67], v[16:19]
    v_xor_b32 v162, 0xb0, v4
    ds_read_b128 v[164:167], v162
    s_waitcnt lgkmcnt(2)
    v_mfma_f32_16x16x32_bf16 v[16:19], v[24:27], v[68:71], v[16:19]
    v_xor_b32 v160, 0xc0, v4
    ds_read_b128 v[24:27], v160
    s_waitcnt lgkmcnt(2)
    v_mfma_f32_16x16x32_bf16 v[16:19], v[28:31], v[72:75], v[16:19]
    v_xor_b32 v161, 0xd0, v4
    ds_read_b128 v[28:31], v161
    s_waitcnt lgkmcnt(2)
    v_mfma_f32_16x16x32_bf16 v[16:19], v[164:167], v[76:79], v[16:19]
    v_xor_b32 v162, 0xe0, v4
    ds_read_b128 v[164:167], v162
    s_waitcnt lgkmcnt(2)
    v_mfma_f32_16x16x32_bf16 v[16:19], v[24:27], v[80:83], v[16:19]
    v_xor_b32 v160, 0xf0, v4
    ds_read_b128 v[24:27], v160
    s_waitcnt lgkmcnt(2)
    v_mfma_f32_16x16x32_bf16 v[16:19], v[28:31], v[84:87], v[16:19]
    s_waitcnt lgkmcnt(1)
    v_mfma_f32_16x16x32_bf16 v[16:19], v[164:167], v[88:91], v[16:19]
    s_waitcnt lgkmcnt(0)
    v_mfma_f32_16x16x32_bf16 v[16:19], v[24:27], v[92:95], v[16:19]
    v_mov_b32 v162, 0x24034
    s_mov_b32 s80, 1600000
LW_88:
    ds_read_b32 v163, v162
    s_waitcnt lgkmcnt(0)
    v_readfirstlane_b32 s79, v163
    s_cmp_ge_u32 s79, 8
    s_cbranch_scc1 LWD_89
    s_sub_u32 s80, s80, 1
    s_cmp_lg_u32 s80, 0
    s_cbranch_scc1 LW_88
LWD_89:
    v_xor_b32 v160, 0x0, v2
    ds_read_b128 v[24:27], v160
    v_xor_b32 v161, 0x10, v2
    ds_read_b128 v[28:31], v161
    v_xor_b32 v162, 0x20, v2
    ds_read_b128 v[164:167], v162
    s_waitcnt lgkmcnt(2)
    v_mfma_f32_16x16x32_bf16 v[20:23], v[24:27], v[32:35], 0
    v_xor_b32 v160, 0x30, v2
    ds_read_b128 v[24:27], v160
    s_waitcnt lgkmcnt(2)
    v_mfma_f32_16x16x32_bf16 v[20:23], v[28:31], v[36:39], v[20:23]
    v_xor_b32 v161, 0x40, v2
    ds_read_b128 v[28:31], v161
    s_waitcnt lgkmcnt(2)
    v_mfma_f32_16x16x32_bf16 v[20:23], v[164:167], v[40:43], v[20:23]
    v_xor_b32 v162, 0x50, v2
    ds_read_b128 v[164:167], v162
    s_waitcnt lgkmcnt(2)
    v_mfma_f32_16x16x32_bf16 v[20:23], v[24:27], v[44:47], v[20:23]
    v_xor_b32 v160, 0x60, v2
    ds_read_b128 v[24:27], v160
    s_waitcnt lgkmcnt(2)
    v_mfma_f32_16x16x32_bf16 v[20:23], v[28:31], v[48:51], v[20:23]
    v_xor_b32 v161, 0x70, v2
    ds_read_b128 v[28:31], v161
    s_waitcnt lgkmcnt(2)
    v_mfma_f32_16x16x32_bf16 v[20:23], v[164:167], v[52:55], v[20:23]
    v_xor_b32 v162, 0x80, v2
    ds_read_b128 v[164:167], v162
    s_waitcnt lgkmcnt(2)
    v_mfma_f32_16x16x32_bf16 v[20:23], v[24:27], v[56:59], v[20:23]
    v_xor_b32 v160, 0x90, v2
    ds_read_b128 v[24:27], v160
    s_waitcnt lgkmcnt(2)
    v_mfma_f32_16x16x32_bf16 v[20:23], v[28:31], v[60:63], v[20:23]
    v_xor_b32 v161, 0xa0, v2
    ds_read_b128 v[28:31], v161
    s_waitcnt lgkmcnt(2)
    v_mfma_f32_16x16x32_bf16 v[20:23], v[164:167], v[64:67], v[20:23]
    v_xor_b32 v162, 0xb0, v2
    ds_read_b128 v[164:167], v162
    s_waitcnt lgkmcnt(2)
    v_mfma_f32_16x16x32_bf16 v[20:23], v[24:27], v[68:71], v[20:23]
    v_xor_b32 v160, 0xc0, v2
    ds_read_b128 v[24:27], v160
    s_waitcnt lgkmcnt(2)
    v_mfma_f32_16x16x32_bf16 v[20:23], v[28:31], v[72:75], v[20:23]
    v_xor_b32 v161, 0xd0, v2
    ds_read_b128 v[28:31], v161
    s_waitcnt lgkmcnt(2)
    v_mfma_f32_16x16x32_bf16 v[20:23], v[164:167], v[76:79], v[20:23]
    v_xor_b32 v162, 0xe0, v2
    ds_read_b128 v[164:167], v162
    s_waitcnt lgkmcnt(2)
    v_mfma_f32_16x16x32_bf16 v[20:23], v[24:27], v[80:83], v[20:23]
    v_xor_b32 v160, 0xf0, v2
    ds_read_b128 v[24:27], v160
    s_waitcnt lgkmcnt(2)
    v_mfma_f32_16x16x32_bf16 v[20:23], v[28:31], v[84:87], v[20:23]
    s_waitcnt lgkmcnt(1)
    v_mfma_f32_16x16x32_bf16 v[20:23], v[164:167], v[88:91], v[20:23]
    s_waitcnt lgkmcnt(0)
    v_mfma_f32_16x16x32_bf16 v[20:23], v[24:27], v[92:95], v[20:23]
    v_max3_f32 v160, v16, v17, v18
    s_nop 6
    v_max3_f32 v160, v160, v19, v20
    v_max3_f32 v160, v160, v21, v22
    v_max_f32 v160, v160, v23
    v_mov_b32 v161, v160
    s_nop 1
    v_permlane32_swap_b32 v160, v161
    v_max_f32 v160, v160, v161
    v_mov_b32 v161, v160
    s_nop 1
    v_permlane16_swap_b32 v160, v161
    v_max_f32 v160, v160, v161
    s_lshl_b32 s7, s64, 7
    v_add_u32 v161, s7, v5
    s_mov_b64 exec, s[86:87]
    ds_write_b32 v161, v160
    s_mov_b64 exec, -1
    v_mov_b32 v166, 0x24010
    v_mov_b32 v167, 1
    s_waitcnt lgkmcnt(0)
    s_mov_b64 exec, 1
    ds_add_u32 v166, v167
    s_mov_b64 exec, -1
    v_mov_b32 v166, 0x24010
    s_mov_b32 s80, 1600000
LW_90:
    ds_read_b32 v167, v166
    s_waitcnt lgkmcnt(0)
    v_readfirstlane_b32 s79, v167
    s_cmp_ge_u32 s79, 16
    s_cbranch_scc1 LWD_91
    s_sub_u32 s80, s80, 1
    s_cmp_lg_u32 s80, 0
    s_cbranch_scc1 LW_90
LWD_91:
    ds_read_b32 v160, v5 offset:0
    ds_read_b32 v161, v5 offset:128
    ds_read_b32 v162, v5 offset:256
    ds_read_b32 v163, v5 offset:384
    s_waitcnt lgkmcnt(0)
    v_max3_f32 v160, v160, v161, v162
    v_max_f32 v160, v160, v163
    v_mul_f32 v160, s67, v160
    v_max_f32 v160, v160, v13
    v_sub_f32 v161, v13, v160
    v_exp_f32 v161, v161
    v_mov_b32 v13, v160
    v_fma_f32 v16, v16, s67, -v160
    v_fma_f32 v17, v17, s67, -v160
    v_fma_f32 v18, v18, s67, -v160
    v_fma_f32 v19, v19, s67, -v160
    v_fma_f32 v20, v20, s67, -v160
    v_fma_f32 v21, v21, s67, -v160
    v_fma_f32 v22, v22, s67, -v160
    v_fma_f32 v23, v23, s67, -v160
    v_exp_f32 v16, v16
    v_exp_f32 v17, v17
    v_exp_f32 v18, v18
    v_exp_f32 v19, v19
    v_exp_f32 v20, v20
    v_exp_f32 v21, v21
    v_exp_f32 v22, v22
    v_exp_f32 v23, v23
    v_cvt_pk_bf16_f32 v24, v16, v17
    v_cvt_pk_bf16_f32 v25, v18, v19
    v_cvt_pk_bf16_f32 v26, v20, v21
    v_cvt_pk_bf16_f32 v27, v22, v23
    ds_write_b64 v6, v[24:25]
    ds_write_b64 v6, v[26:27] offset:4096
    v_add_u32 v162, 0xc00, v5
    s_mov_b64 exec, s[88:89]
    ds_write_b32 v162, v161
    s_mov_b64 exec, -1
    v_mul_f32 v14, v14, v161
    v_add_f32 v16, v16, v20
    v_add_f32 v17, v17, v21
    v_add_f32 v18, v18, v22
    v_add_f32 v19, v19, v23
    v_add_f32 v16, v16, v18
    v_add_f32 v17, v17, v19
    v_add_f32 v16, v16, v17
    v_add_f32 v14, v14, v16
    v_mov_b32 v166, 0x24010
    v_mov_b32 v167, 1
    s_waitcnt lgkmcnt(0)
    s_mov_b64 exec, 1
    ds_add_u32 v166, v167
    s_mov_b64 exec, -1
    v_mov_b32 v166, 0x24010
    s_mov_b32 s80, 1600000
LW_92:
    ds_read_b32 v167, v166
    s_waitcnt lgkmcnt(0)
    v_readfirstlane_b32 s79, v167
    s_cmp_ge_u32 s79, 24
    s_cbranch_scc1 LWD_93
    s_sub_u32 s80, s80, 1
    s_cmp_lg_u32 s80, 0
    s_cbranch_scc1 LW_92
LWD_93:
    ds_read_b128 v[16:19], v7 offset:0
    ds_read_b64_tr_b16 v[24:25], v9 offset:0
    ds_read_b64_tr_b16 v[26:27], v11 offset:0
    ds_read_b64_tr_b16 v[28:29], v10 offset:0
    ds_read_b64_tr_b16 v[30:31], v12 offset:0
    ds_read_b128 v[20:23], v7 offset:1024
    ds_read_b64_tr_b16 v[160:161], v9 offset:16384
    ds_read_b64_tr_b16 v[162:163], v11 offset:16384
    ds_read_b64_tr_b16 v[164:165], v10 offset:16384
    ds_read_b64_tr_b16 v[166:167], v12 offset:16384
    s_waitcnt lgkmcnt(7)
    v_mfma_f32_32x32x16_bf16 v[128:143], v[24:27], v[16:19], 0
    s_waitcnt lgkmcnt(5)
    v_mfma_f32_32x32x16_bf16 v[144:159], v[28:31], v[16:19], 0
    ds_read_b128 v[16:19], v7 offset:2048
    ds_read_b64_tr_b16 v[24:25], v9 offset:32768
    ds_read_b64_tr_b16 v[26:27], v11 offset:32768
    ds_read_b64_tr_b16 v[28:29], v10 offset:32768
    ds_read_b64_tr_b16 v[30:31], v12 offset:32768
    s_waitcnt lgkmcnt(7)
    v_mfma_f32_32x32x16_bf16 v[128:143], v[160:163], v[20:23], v[128:143]
    s_waitcnt lgkmcnt(5)
    v_mfma_f32_32x32x16_bf16 v[144:159], v[164:167], v[20:23], v[144:159]
    ds_read_b128 v[20:23], v7 offset:3072
    ds_read_b64_tr_b16 v[160:161], v9 offset:49152
    ds_read_b64_tr_b16 v[162:163], v11 offset:49152
    ds_read_b64_tr_b16 v[164:165], v10 offset:49152
    ds_read_b64_tr_b16 v[166:167], v12 offset:49152
    s_waitcnt lgkmcnt(7)
    v_mfma_f32_32x32x16_bf16 v[128:143], v[24:27], v[16:19], v[128:143]
    s_waitcnt lgkmcnt(5)
    v_mfma_f32_32x32x16_bf16 v[144:159], v[28:31], v[16:19], v[144:159]
    v_add_u32 v9, 0x10000, v9
    v_add_u32 v10, 0x10000, v10
    v_add_u32 v11, 0x10000, v11
    v_add_u32 v12, 0x10000, v12
    ds_read_b128 v[16:19], v7 offset:4096
    ds_read_b64_tr_b16 v[24:25], v9 offset:0
    ds_read_b64_tr_b16 v[26:27], v11 offset:0
    ds_read_b64_tr_b16 v[28:29], v10 offset:0
    ds_read_b64_tr_b16 v[30:31], v12 offset:0
    s_waitcnt lgkmcnt(7)
    v_mfma_f32_32x32x16_bf16 v[128:143], v[160:163], v[20:23], v[128:143]
    s_waitcnt lgkmcnt(5)
    v_mfma_f32_32x32x16_bf16 v[144:159], v[164:167], v[20:23], v[144:159]
    ds_read_b128 v[20:23], v7 offset:5120
    ds_read_b64_tr_b16 v[160:161], v9 offset:16384
    ds_read_b64_tr_b16 v[162:163], v11 offset:16384
    ds_read_b64_tr_b16 v[164:165], v10 offset:16384
    ds_read_b64_tr_b16 v[166:167], v12 offset:16384
    s_waitcnt lgkmcnt(7)
    v_mfma_f32_32x32x16_bf16 v[128:143], v[24:27], v[16:19], v[128:143]
    s_waitcnt lgkmcnt(5)
    v_mfma_f32_32x32x16_bf16 v[144:159], v[28:31], v[16:19], v[144:159]
    v_mov_b32 v3, 0x24038
    v_mov_b32 v15, 1
    s_mov_b64 exec, 1
    ds_add_u32 v3, v15
    s_mov_b64 exec, -1
    ds_read_b128 v[16:19], v7 offset:6144
    ds_read_b64_tr_b16 v[24:25], v9 offset:32768
    ds_read_b64_tr_b16 v[26:27], v11 offset:32768
    ds_read_b64_tr_b16 v[28:29], v10 offset:32768
    ds_read_b64_tr_b16 v[30:31], v12 offset:32768
    s_waitcnt lgkmcnt(7)
    v_mfma_f32_32x32x16_bf16 v[128:143], v[160:163], v[20:23], v[128:143]
    s_waitcnt lgkmcnt(5)
    v_mfma_f32_32x32x16_bf16 v[144:159], v[164:167], v[20:23], v[144:159]
    ds_read_b128 v[20:23], v7 offset:7168
    ds_read_b64_tr_b16 v[160:161], v9 offset:49152
    ds_read_b64_tr_b16 v[162:163], v11 offset:49152
    ds_read_b64_tr_b16 v[164:165], v10 offset:49152
    ds_read_b64_tr_b16 v[166:167], v12 offset:49152
    s_waitcnt lgkmcnt(7)
    v_mfma_f32_32x32x16_bf16 v[128:143], v[24:27], v[16:19], v[128:143]
    s_waitcnt lgkmcnt(5)
    v_mfma_f32_32x32x16_bf16 v[144:159], v[28:31], v[16:19], v[144:159]
    s_waitcnt lgkmcnt(2)
    v_mfma_f32_32x32x16_bf16 v[128:143], v[160:163], v[20:23], v[128:143]
    s_waitcnt lgkmcnt(0)
    v_mfma_f32_32x32x16_bf16 v[144:159], v[164:167], v[20:23], v[144:159]
    v_add_u32 v9, 0xffff0000, v9
    v_add_u32 v10, 0xffff0000, v10
    v_add_u32 v11, 0xffff0000, v11
    v_add_u32 v12, 0xffff0000, v12
    v_mov_b32 v162, 0x2402c
    v_mov_b32 v163, 1
    s_waitcnt lgkmcnt(0)
    s_mov_b64 exec, 1
    ds_add_u32 v162, v163
    s_mov_b64 exec, -1
    s_waitcnt vmcnt(0)
    v_mov_b32 v162, 0x24038
    s_mov_b32 s80, 1600000
LW_94:
    ds_read_b32 v163, v162
    s_waitcnt lgkmcnt(0)
    v_readfirstlane_b32 s79, v163
    s_cmp_ge_u32 s79, 8
    s_cbranch_scc1 LWD_95
    s_sub_u32 s80, s80, 1
    s_cmp_lg_u32 s80, 0
    s_cbranch_scc1 LW_94
LWD_95:
    s_lshl_b32 s7, s3, 10
    v_lshl_add_u32 v160, v1, 4, s7
    ds_write_b128 v160, v[96:99] offset:0
    ds_write_b128 v160, v[100:103] offset:8192
    ds_write_b128 v160, v[104:107] offset:16384
    ds_write_b128 v160, v[108:111] offset:24576
    ds_write_b128 v160, v[112:115] offset:32768
    ds_write_b128 v160, v[116:119] offset:40960
    ds_write_b128 v160, v[120:123] offset:49152
    ds_write_b128 v160, v[124:127] offset:57344
    v_mov_b32 v162, 0x2403c
    v_mov_b32 v163, 1
    s_waitcnt lgkmcnt(0)
    s_mov_b64 exec, 1
    ds_add_u32 v162, v163
    s_mov_b64 exec, -1
    v_mov_b32 v162, 0x2403c
    s_mov_b32 s80, 1600000
LW_96:
    ds_read_b32 v163, v162
    s_waitcnt lgkmcnt(0)
    v_readfirstlane_b32 s79, v163
    s_cmp_ge_u32 s79, 8
    s_cbranch_scc1 LWD_97
    s_sub_u32 s80, s80, 1
    s_cmp_lg_u32 s80, 0
    s_cbranch_scc1 LW_96
LWD_97:
    v_xor_b32 v160, 0x0, v4
    ds_read_b128 v[24:27], v160
    v_xor_b32 v161, 0x10, v4
    ds_read_b128 v[28:31], v161
    v_xor_b32 v162, 0x20, v4
    ds_read_b128 v[164:167], v162
    s_waitcnt lgkmcnt(2)
    v_mfma_f32_16x16x32_bf16 v[16:19], v[24:27], v[32:35], 0
    v_xor_b32 v160, 0x30, v4
    ds_read_b128 v[24:27], v160
    s_waitcnt lgkmcnt(2)
    v_mfma_f32_16x16x32_bf16 v[16:19], v[28:31], v[36:39], v[16:19]
    v_xor_b32 v161, 0x40, v4
    ds_read_b128 v[28:31], v161
    s_waitcnt lgkmcnt(2)
    v_mfma_f32_16x16x32_bf16 v[16:19], v[164:167], v[40:43], v[16:19]
    v_xor_b32 v162, 0x50, v4
    ds_read_b128 v[164:167], v162
    s_waitcnt lgkmcnt(2)
    v_mfma_f32_16x16x32_bf16 v[16:19], v[24:27], v[44:47], v[16:19]
    v_xor_b32 v160, 0x60, v4
    ds_read_b128 v[24:27], v160
    s_waitcnt lgkmcnt(2)
    v_mfma_f32_16x16x32_bf16 v[16:19], v[28:31], v[48:51], v[16:19]
    v_xor_b32 v161, 0x70, v4
    ds_read_b128 v[28:31], v161
    s_waitcnt lgkmcnt(2)
    v_mfma_f32_16x16x32_bf16 v[16:19], v[164:167], v[52:55], v[16:19]
    v_xor_b32 v162, 0x80, v4
    ds_read_b128 v[164:167], v162
    s_waitcnt lgkmcnt(2)
    v_mfma_f32_16x16x32_bf16 v[16:19], v[24:27], v[56:59], v[16:19]
    v_xor_b32 v160, 0x90, v4
    ds_read_b128 v[24:27], v160
    s_waitcnt lgkmcnt(2)
    v_mfma_f32_16x16x32_bf16 v[16:19], v[28:31], v[60:63], v[16:19]
    v_xor_b32 v161, 0xa0, v4
    ds_read_b128 v[28:31], v161
    s_waitcnt lgkmcnt(2)
    v_mfma_f32_16x16x32_bf16 v[16:19], v[164:167], v[64:67], v[16:19]
    v_xor_b32 v162, 0xb0, v4
    ds_read_b128 v[164:167], v162
    s_waitcnt lgkmcnt(2)
    v_mfma_f32_16x16x32_bf16 v[16:19], v[24:27], v[68:71], v[16:19]
    v_xor_b32 v160, 0xc0, v4
    ds_read_b128 v[24:27], v160
    s_waitcnt lgkmcnt(2)
    v_mfma_f32_16x16x32_bf16 v[16:19], v[28:31], v[72:75], v[16:19]
    v_xor_b32 v161, 0xd0, v4
    ds_read_b128 v[28:31], v161
    s_waitcnt lgkmcnt(2)
    v_mfma_f32_16x16x32_bf16 v[16:19], v[164:167], v[76:79], v[16:19]
    v_xor_b32 v162, 0xe0, v4
    ds_read_b128 v[164:167], v162
    s_waitcnt lgkmcnt(2)
    v_mfma_f32_16x16x32_bf16 v[16:19], v[24:27], v[80:83], v[16:19]
    v_xor_b32 v160, 0xf0, v4
    ds_read_b128 v[24:27], v160
    s_waitcnt lgkmcnt(2)
    v_mfma_f32_16x16x32_bf16 v[16:19], v[28:31], v[84:87], v[16:19]
    s_waitcnt lgkmcnt(1)
    v_mfma_f32_16x16x32_bf16 v[16:19], v[164:167], v[88:91], v[16:19]
    s_waitcnt lgkmcnt(0)
    v_mfma_f32_16x16x32_bf16 v[16:19], v[24:27], v[92:95], v[16:19]
    v_mov_b32 v162, 0x24030
    s_mov_b32 s80, 1600000
LW_98:
    ds_read_b32 v163, v162
    s_waitcnt lgkmcnt(0)
    v_readfirstlane_b32 s79, v163
    s_cmp_ge_u32 s79, 4
    s_cbranch_scc1 LWD_99
    s_sub_u32 s80, s80, 1
    s_cmp_lg_u32 s80, 0
    s_cbranch_scc1 LW_98
LWD_99:
    v_xor_b32 v160, 0x0, v2
    ds_read_b128 v[24:27], v160
    v_xor_b32 v161, 0x10, v2
    ds_read_b128 v[28:31], v161
    v_xor_b32 v162, 0x20, v2
    ds_read_b128 v[164:167], v162
    s_waitcnt lgkmcnt(2)
    v_mfma_f32_16x16x32_bf16 v[20:23], v[24:27], v[32:35], 0
    v_xor_b32 v160, 0x30, v2
    ds_read_b128 v[24:27], v160
    s_waitcnt lgkmcnt(2)
    v_mfma_f32_16x16x32_bf16 v[20:23], v[28:31], v[36:39], v[20:23]
    v_xor_b32 v161, 0x40, v2
    ds_read_b128 v[28:31], v161
    s_waitcnt lgkmcnt(2)
    v_mfma_f32_16x16x32_bf16 v[20:23], v[164:167], v[40:43], v[20:23]
    v_xor_b32 v162, 0x50, v2
    ds_read_b128 v[164:167], v162
    s_waitcnt lgkmcnt(2)
    v_mfma_f32_16x16x32_bf16 v[20:23], v[24:27], v[44:47], v[20:23]
    v_xor_b32 v160, 0x60, v2
    ds_read_b128 v[24:27], v160
    s_waitcnt lgkmcnt(2)
    v_mfma_f32_16x16x32_bf16 v[20:23], v[28:31], v[48:51], v[20:23]
    v_xor_b32 v161, 0x70, v2
    ds_read_b128 v[28:31], v161
    s_waitcnt lgkmcnt(2)
    v_mfma_f32_16x16x32_bf16 v[20:23], v[164:167], v[52:55], v[20:23]
    v_xor_b32 v162, 0x80, v2
    ds_read_b128 v[164:167], v162
    s_waitcnt lgkmcnt(2)
    v_mfma_f32_16x16x32_bf16 v[20:23], v[24:27], v[56:59], v[20:23]
    v_xor_b32 v160, 0x90, v2
    ds_read_b128 v[24:27], v160
    s_waitcnt lgkmcnt(2)
    v_mfma_f32_16x16x32_bf16 v[20:23], v[28:31], v[60:63], v[20:23]
    v_xor_b32 v161, 0xa0, v2
    ds_read_b128 v[28:31], v161
    s_waitcnt lgkmcnt(2)
    v_mfma_f32_16x16x32_bf16 v[20:23], v[164:167], v[64:67], v[20:23]
    v_xor_b32 v162, 0xb0, v2
    ds_read_b128 v[164:167], v162
    s_waitcnt lgkmcnt(2)
    v_mfma_f32_16x16x32_bf16 v[20:23], v[24:27], v[68:71], v[20:23]
    v_xor_b32 v160, 0xc0, v2
    ds_read_b128 v[24:27], v160
    s_waitcnt lgkmcnt(2)
    v_mfma_f32_16x16x32_bf16 v[20:23], v[28:31], v[72:75], v[20:23]
    v_xor_b32 v161, 0xd0, v2
    ds_read_b128 v[28:31], v161
    s_waitcnt lgkmcnt(2)
    v_mfma_f32_16x16x32_bf16 v[20:23], v[164:167], v[76:79], v[20:23]
    v_xor_b32 v162, 0xe0, v2
    ds_read_b128 v[164:167], v162
    s_waitcnt lgkmcnt(2)
    v_mfma_f32_16x16x32_bf16 v[20:23], v[24:27], v[80:83], v[20:23]
    v_xor_b32 v160, 0xf0, v2
    ds_read_b128 v[24:27], v160
    s_waitcnt lgkmcnt(2)
    v_mfma_f32_16x16x32_bf16 v[20:23], v[28:31], v[84:87], v[20:23]
    s_waitcnt lgkmcnt(1)
    v_mfma_f32_16x16x32_bf16 v[20:23], v[164:167], v[88:91], v[20:23]
    s_waitcnt lgkmcnt(0)
    v_mfma_f32_16x16x32_bf16 v[20:23], v[24:27], v[92:95], v[20:23]
    v_max3_f32 v160, v16, v17, v18
    s_nop 6
    v_max3_f32 v160, v160, v19, v20
    v_max3_f32 v160, v160, v21, v22
    v_max_f32 v160, v160, v23
    v_mov_b32 v161, v160
    s_nop 1
    v_permlane32_swap_b32 v160, v161
    v_max_f32 v160, v160, v161
    v_mov_b32 v161, v160
    s_nop 1
    v_permlane16_swap_b32 v160, v161
    v_max_f32 v160, v160, v161
    s_lshl_b32 s7, s64, 7
    v_add_u32 v161, s7, v5
    s_mov_b64 exec, s[86:87]
    ds_write_b32 v161, v160
    s_mov_b64 exec, -1
    v_mov_b32 v166, 0x24010
    v_mov_b32 v167, 1
    s_waitcnt lgkmcnt(0)
    s_mov_b64 exec, 1
    ds_add_u32 v166, v167
    s_mov_b64 exec, -1
    v_mov_b32 v166, 0x24010
    s_mov_b32 s80, 1600000
LW_100:
    ds_read_b32 v167, v166
    s_waitcnt lgkmcnt(0)
    v_readfirstlane_b32 s79, v167
    s_cmp_ge_u32 s79, 32
    s_cbranch_scc1 LWD_101
    s_sub_u32 s80, s80, 1
    s_cmp_lg_u32 s80, 0
    s_cbranch_scc1 LW_100
LWD_101:
    ds_read_b32 v160, v5 offset:0
    ds_read_b32 v161, v5 offset:128
    ds_read_b32 v162, v5 offset:256
    ds_read_b32 v163, v5 offset:384
    s_waitcnt lgkmcnt(0)
    v_max3_f32 v160, v160, v161, v162
    v_max_f32 v160, v160, v163
    v_mul_f32 v160, s67, v160
    v_max_f32 v160, v160, v13
    v_sub_f32 v161, v13, v160
    v_exp_f32 v161, v161
    v_mov_b32 v13, v160
    v_fma_f32 v16, v16, s67, -v160
    v_fma_f32 v17, v17, s67, -v160
    v_fma_f32 v18, v18, s67, -v160
    v_fma_f32 v19, v19, s67, -v160
    v_fma_f32 v20, v20, s67, -v160
    v_fma_f32 v21, v21, s67, -v160
    v_fma_f32 v22, v22, s67, -v160
    v_fma_f32 v23, v23, s67, -v160
    v_exp_f32 v16, v16
    v_exp_f32 v17, v17
    v_exp_f32 v18, v18
    v_exp_f32 v19, v19
    v_exp_f32 v20, v20
    v_exp_f32 v21, v21
    v_exp_f32 v22, v22
    v_exp_f32 v23, v23
    v_cvt_pk_bf16_f32 v24, v16, v17
    v_cvt_pk_bf16_f32 v25, v18, v19
    v_cvt_pk_bf16_f32 v26, v20, v21
    v_cvt_pk_bf16_f32 v27, v22, v23
    ds_write_b64 v6, v[24:25]
    ds_write_b64 v6, v[26:27] offset:4096
    v_add_u32 v162, 0xc00, v5
    s_mov_b64 exec, s[88:89]
    ds_write_b32 v162, v161
    s_mov_b64 exec, -1
    v_mul_f32 v14, v14, v161
    v_add_f32 v16, v16, v20
    v_add_f32 v17, v17, v21
    v_add_f32 v18, v18, v22
    v_add_f32 v19, v19, v23
    v_add_f32 v16, v16, v18
    v_add_f32 v17, v17, v19
    v_add_f32 v16, v16, v17
    v_add_f32 v14, v14, v16
    v_mov_b32 v160, v14
    s_nop 1
    v_permlane32_swap_b32 v14, v160
    v_add_f32 v14, v14, v160
    v_mov_b32 v160, v14
    s_nop 1
    v_permlane16_swap_b32 v14, v160
    v_add_f32 v14, v14, v160
    s_lshl_b32 s7, s64, 7
    s_add_u32 s7, s7, 0x200
    v_add_u32 v161, s7, v5
    v_add_u32 v162, 0xc80, v5
    s_mov_b64 exec, s[86:87]
    ds_write_b32 v161, v14
    s_mov_b64 exec, s[88:89]
    ds_write_b32 v162, v13
    s_mov_b64 exec, -1
    v_mov_b32 v166, 0x24010
    v_mov_b32 v167, 1
    s_waitcnt lgkmcnt(0)
    s_mov_b64 exec, 1
    ds_add_u32 v166, v167
    s_mov_b64 exec, -1
    v_mov_b32 v166, 0x24010
    s_mov_b32 s80, 1600000
LW_102:
    ds_read_b32 v167, v166
    s_waitcnt lgkmcnt(0)
    v_readfirstlane_b32 s79, v167
    s_cmp_ge_u32 s79, 40
    s_cbranch_scc1 LWD_103
    s_sub_u32 s80, s80, 1
    s_cmp_lg_u32 s80, 0
    s_cbranch_scc1 LW_102
LWD_103:
    s_cmp_lg_u32 s3, 7
    s_cbranch_scc1 BML_104
    v_and_b32 v160, 31, v1
    v_lshlrev_b32 v161, 2, v160
    v_add_u32 v161, 0x27400, v161
    ds_read_b32 v16, v161 offset:0
    ds_read_b32 v17, v161 offset:128
    ds_read_b32 v18, v161 offset:256
    ds_read_b32 v19, v161 offset:384
    ds_read_b32 v20, v161 offset:2688
    s_waitcnt lgkmcnt(0)
    v_add_f32 v16, v16, v17
    v_add_f32 v18, v18, v19
    v_add_f32 v21, v16, v18
    s_lshl_b32 s7, s60, 8
    s_add_u32 s7, s7, 0xb0000
    v_and_b32 v160, 31, v1
    v_lshl_add_u32 v160, v160, 3, s7
    s_mov_b64 exec, 0xffffffff
    buffer_store_dwordx2 v[20:21], v160, s[36:39], 0 offen sc1
    s_mov_b64 exec, -1
BML_104:
    v_and_b32 v160, 31, v1
    v_lshlrev_b32 v98, 10, v160
    v_lshrrev_b32 v161, 5, v1
    v_and_b32 v160, 7, v1
    v_xor_b32 v160, v160, v161
    v_lshl_add_u32 v98, v160, 4, v98
    s_lshl_b32 s7, s3, 7
    v_add_u32 v98, s7, v98
    s_lshl_b32 s7, s3, 12
    v_lshl_add_u32 v99, v1, 4, s7
    s_and_b32 s7, s3, 1
    s_lshl_b32 s7, s7, 6
    v_lshlrev_b32 v100, 4, v1
    v_xor_b32 v100, s7, v100
    s_lshl_b32 s69, s3, 18
    s_lshl_b32 s7, s60, 10
    s_add_u32 s69, s69, s7
    s_add_u32 s69, s69, 0x500000
    ds_read_b32 v15, v8
    ds_read_b128 v[16:19], v7 offset:0
    ds_read_b64_tr_b16 v[24:25], v9 offset:0
    ds_read_b64_tr_b16 v[26:27], v11 offset:0
    ds_read_b64_tr_b16 v[28:29], v10 offset:0
    ds_read_b64_tr_b16 v[30:31], v12 offset:0
    s_waitcnt lgkmcnt(5)
    v_mul_f32 v128, v15, v128
    v_mul_f32 v129, v15, v129
    v_mul_f32 v130, v15, v130
    v_mul_f32 v131, v15, v131
    v_mul_f32 v132, v15, v132
    v_mul_f32 v133, v15, v133
    v_mul_f32 v134, v15, v134
    v_mul_f32 v135, v15, v135
    v_mul_f32 v136, v15, v136
    v_mul_f32 v137, v15, v137
    v_mul_f32 v138, v15, v138
    v_mul_f32 v139, v15, v139
    v_mul_f32 v140, v15, v140
    v_mul_f32 v141, v15, v141
    v_mul_f32 v142, v15, v142
    v_mul_f32 v143, v15, v143
    v_mul_f32 v144, v15, v144
    v_mul_f32 v145, v15, v145
    v_mul_f32 v146, v15, v146
    v_mul_f32 v147, v15, v147
    v_mul_f32 v148, v15, v148
    v_mul_f32 v149, v15, v149
    v_mul_f32 v150, v15, v150
    v_mul_f32 v151, v15, v151
    v_mul_f32 v152, v15, v152
    v_mul_f32 v153, v15, v153
    v_mul_f32 v154, v15, v154
    v_mul_f32 v155, v15, v155
    v_mul_f32 v156, v15, v156
    v_mul_f32 v157, v15, v157
    v_mul_f32 v158, v15, v158
    v_mul_f32 v159, v15, v159
    ds_read_b128 v[20:23], v7 offset:1024
    ds_read_b64_tr_b16 v[160:161], v9 offset:16384
    ds_read_b64_tr_b16 v[162:163], v11 offset:16384
    ds_read_b64_tr_b16 v[164:165], v10 offset:16384
    ds_read_b64_tr_b16 v[166:167], v12 offset:16384
    s_waitcnt lgkmcnt(7)
    v_mfma_f32_32x32x16_bf16 v[128:143], v[24:27], v[16:19], v[128:143]
    s_waitcnt lgkmcnt(5)
    v_mfma_f32_32x32x16_bf16 v[144:159], v[28:31], v[16:19], v[144:159]
    ds_read_b128 v[16:19], v7 offset:2048
    ds_read_b64_tr_b16 v[24:25], v9 offset:32768
    ds_read_b64_tr_b16 v[26:27], v11 offset:32768
    ds_read_b64_tr_b16 v[28:29], v10 offset:32768
    ds_read_b64_tr_b16 v[30:31], v12 offset:32768
    s_waitcnt lgkmcnt(7)
    v_mfma_f32_32x32x16_bf16 v[128:143], v[160:163], v[20:23], v[128:143]
    s_waitcnt lgkmcnt(5)
    v_mfma_f32_32x32x16_bf16 v[144:159], v[164:167], v[20:23], v[144:159]
    ds_read_b128 v[20:23], v7 offset:3072
    ds_read_b64_tr_b16 v[160:161], v9 offset:49152
    ds_read_b64_tr_b16 v[162:163], v11 offset:49152
    ds_read_b64_tr_b16 v[164:165], v10 offset:49152
    ds_read_b64_tr_b16 v[166:167], v12 offset:49152
    s_waitcnt lgkmcnt(7)
    v_mfma_f32_32x32x16_bf16 v[128:143], v[24:27], v[16:19], v[128:143]
    s_waitcnt lgkmcnt(5)
    v_mfma_f32_32x32x16_bf16 v[144:159], v[28:31], v[16:19], v[144:159]
    v_add_u32 v9, 0x10000, v9
    v_add_u32 v10, 0x10000, v10
    v_add_u32 v11, 0x10000, v11
    v_add_u32 v12, 0x10000, v12
    ds_read_b128 v[16:19], v7 offset:4096
    ds_read_b64_tr_b16 v[24:25], v9 offset:0
    ds_read_b64_tr_b16 v[26:27], v11 offset:0
    ds_read_b64_tr_b16 v[28:29], v10 offset:0
    ds_read_b64_tr_b16 v[30:31], v12 offset:0
    s_waitcnt lgkmcnt(7)
    v_mfma_f32_32x32x16_bf16 v[128:143], v[160:163], v[20:23], v[128:143]
    s_waitcnt lgkmcnt(5)
    v_mfma_f32_32x32x16_bf16 v[144:159], v[164:167], v[20:23], v[144:159]
    ds_read_b128 v[20:23], v7 offset:5120
    ds_read_b64_tr_b16 v[160:161], v9 offset:16384
    ds_read_b64_tr_b16 v[162:163], v11 offset:16384
    ds_read_b64_tr_b16 v[164:165], v10 offset:16384
    ds_read_b64_tr_b16 v[166:167], v12 offset:16384
    s_waitcnt lgkmcnt(7)
    v_mfma_f32_32x32x16_bf16 v[128:143], v[24:27], v[16:19], v[128:143]
    s_waitcnt lgkmcnt(5)
    v_mfma_f32_32x32x16_bf16 v[144:159], v[28:31], v[16:19], v[144:159]
    v_mov_b32 v3, 0x24024
    v_mov_b32 v15, 1
    s_mov_b64 exec, 1
    ds_add_u32 v3, v15
    s_mov_b64 exec, -1
    ds_read_b128 v[16:19], v7 offset:6144
    ds_read_b64_tr_b16 v[24:25], v9 offset:32768
    ds_read_b64_tr_b16 v[26:27], v11 offset:32768
    ds_read_b64_tr_b16 v[28:29], v10 offset:32768
    ds_read_b64_tr_b16 v[30:31], v12 offset:32768
    s_waitcnt lgkmcnt(7)
    v_mfma_f32_32x32x16_bf16 v[128:143], v[160:163], v[20:23], v[128:143]
    s_waitcnt lgkmcnt(5)
    v_mfma_f32_32x32x16_bf16 v[144:159], v[164:167], v[20:23], v[144:159]
    ds_read_b128 v[20:23], v7 offset:7168
    ds_read_b64_tr_b16 v[160:161], v9 offset:49152
    ds_read_b64_tr_b16 v[162:163], v11 offset:49152
    ds_read_b64_tr_b16 v[164:165], v10 offset:49152
    ds_read_b64_tr_b16 v[166:167], v12 offset:49152
    s_waitcnt lgkmcnt(7)
    v_mfma_f32_32x32x16_bf16 v[128:143], v[24:27], v[16:19], v[128:143]
    s_waitcnt lgkmcnt(5)
    v_mfma_f32_32x32x16_bf16 v[144:159], v[28:31], v[16:19], v[144:159]
    s_waitcnt lgkmcnt(2)
    v_mfma_f32_32x32x16_bf16 v[128:143], v[160:163], v[20:23], v[128:143]
    s_waitcnt lgkmcnt(0)
    v_mfma_f32_32x32x16_bf16 v[144:159], v[164:167], v[20:23], v[144:159]
    s_nop 9
    v_permlane32_swap_b32 v128, v132
    v_permlane32_swap_b32 v129, v133
    v_permlane32_swap_b32 v130, v134
    v_permlane32_swap_b32 v131, v135
    v_cvt_pk_bf16_f32 v16, v128, v129
    v_cvt_pk_bf16_f32 v17, v130, v131
    v_cvt_pk_bf16_f32 v18, v132, v133
    v_cvt_pk_bf16_f32 v19, v134, v135
    v_permlane32_swap_b32 v136, v140
    v_permlane32_swap_b32 v137, v141
    v_permlane32_swap_b32 v138, v142
    v_permlane32_swap_b32 v139, v143
    v_cvt_pk_bf16_f32 v20, v136, v137
    v_cvt_pk_bf16_f32 v21, v138, v139
    v_cvt_pk_bf16_f32 v22, v140, v141
    v_cvt_pk_bf16_f32 v23, v142, v143
    v_permlane32_swap_b32 v144, v148
    v_permlane32_swap_b32 v145, v149
    v_permlane32_swap_b32 v146, v150
    v_permlane32_swap_b32 v147, v151
    v_cvt_pk_bf16_f32 v24, v144, v145
    v_cvt_pk_bf16_f32 v25, v146, v147
    v_cvt_pk_bf16_f32 v26, v148, v149
    v_cvt_pk_bf16_f32 v27, v150, v151
    v_permlane32_swap_b32 v152, v156
    v_permlane32_swap_b32 v153, v157
    v_permlane32_swap_b32 v154, v158
    v_permlane32_swap_b32 v155, v159
    v_cvt_pk_bf16_f32 v28, v152, v153
    v_cvt_pk_bf16_f32 v29, v154, v155
    v_cvt_pk_bf16_f32 v30, v156, v157
    v_cvt_pk_bf16_f32 v31, v158, v159
    v_mov_b32 v166, 0x24024
    s_mov_b32 s80, 1600000
LW_105:
    ds_read_b32 v167, v166
    s_waitcnt lgkmcnt(0)
    v_readfirstlane_b32 s79, v167
    s_cmp_ge_u32 s79, 8
    s_cbranch_scc1 LWD_106
    s_sub_u32 s80, s80, 1
    s_cmp_lg_u32 s80, 0
    s_cbranch_scc1 LW_105
LWD_106:
    v_xor_b32 v160, 0x0, v98
    ds_write_b128 v160, v[16:19]
    v_xor_b32 v161, 0x20, v98
    ds_write_b128 v161, v[20:23]
    v_xor_b32 v160, 0x40, v98
    ds_write_b128 v160, v[24:27]
    v_xor_b32 v161, 0x60, v98
    ds_write_b128 v161, v[28:31]
    v_mov_b32 v166, 0x24010
    v_mov_b32 v167, 1
    s_waitcnt lgkmcnt(0)
    s_mov_b64 exec, 1
    ds_add_u32 v166, v167
    s_mov_b64 exec, -1
    v_mov_b32 v166, 0x24010
    s_mov_b32 s80, 1600000
LW_107:
    ds_read_b32 v167, v166
    s_waitcnt lgkmcnt(0)
    v_readfirstlane_b32 s79, v167
    s_cmp_ge_u32 s79, 48
    s_cbranch_scc1 LWD_108
    s_sub_u32 s80, s80, 1
    s_cmp_lg_u32 s80, 0
    s_cbranch_scc1 LW_107
LWD_108:
    ds_read_b128 v[16:19], v99 offset:0
    ds_read_b128 v[20:23], v99 offset:1024
    ds_read_b128 v[24:27], v99 offset:2048
    ds_read_b128 v[28:31], v99 offset:3072
    v_xor_b32 v160, 0x0, v100
    s_waitcnt lgkmcnt(3)
    buffer_store_dwordx4 v[16:19], v160, s[36:39], s69 offen sc1
    s_add_u32 s69, s69, 65536
    v_xor_b32 v161, 0x10, v100
    s_waitcnt lgkmcnt(2)
    buffer_store_dwordx4 v[20:23], v161, s[36:39], s69 offen sc1
    s_add_u32 s69, s69, 65536
    v_xor_b32 v160, 0x20, v100
    s_waitcnt lgkmcnt(1)
    buffer_store_dwordx4 v[24:27], v160, s[36:39], s69 offen sc1
    s_add_u32 s69, s69, 65536
    v_xor_b32 v161, 0x30, v100
    s_waitcnt lgkmcnt(0)
    buffer_store_dwordx4 v[28:31], v161, s[36:39], s69 offen sc1
    s_add_u32 s69, s69, 65536
    s_endpgm
L_CSVC:
    s_setprio 3
    s_sub_u32 s60, s3, 8
    s_mov_b32 s44, s20
    s_and_b32 s45, s21, 0xffff
    s_mov_b32 s46, 0x1000000
    s_mov_b32 s47, 0x20000
    s_mov_b32 s52, s30
    s_and_b32 s53, s31, 0xffff
    s_mov_b32 s54, 0x2000
    s_mov_b32 s55, 0x20000
    s_lshl_b32 s64, s4, 3
    s_add_u32 s64, s64, s5
    s_sub_u32 s64, s64, 8
    v_lshlrev_b32 v2, 4, v1
    v_mov_b32 v8, -1
    v_mov_b32 v9, -1
    v_mov_b32 v10, -1
    v_mov_b32 v11, -1
    s_lshl_b32 s63, s60, 19
    s_lshl_b32 s7, s64, 10
    s_add_u32 s63, s63, s7
    s_add_u32 s63, s63, 0x500000
    s_barrier
    buffer_store_dwordx4 v[8:11], v2, s[36:39], s63 offen sc1
    s_add_u32 s63, s63, 65536
    buffer_store_dwordx4 v[8:11], v2, s[36:39], s63 offen sc1
    s_add_u32 s63, s63, 65536
    buffer_store_dwordx4 v[8:11], v2, s[36:39], s63 offen sc1
    s_add_u32 s63, s63, 65536
    buffer_store_dwordx4 v[8:11], v2, s[36:39], s63 offen sc1
    s_add_u32 s63, s63, 65536
    buffer_store_dwordx4 v[8:11], v2, s[36:39], s63 offen sc1
    s_add_u32 s63, s63, 65536
    buffer_store_dwordx4 v[8:11], v2, s[36:39], s63 offen sc1
    s_add_u32 s63, s63, 65536
    buffer_store_dwordx4 v[8:11], v2, s[36:39], s63 offen sc1
    s_add_u32 s63, s63, 65536
    buffer_store_dwordx4 v[8:11], v2, s[36:39], s63 offen sc1
    s_add_u32 s63, s63, 65536
    s_lshl_b32 s7, s64, 8
    s_add_u32 s7, s7, 0xb0000
    s_cmp_eq_u32 s60, 0
    s_cselect_b32 s7, s7, 0x40000000
    v_lshlrev_b32 v6, 2, v1
    buffer_store_dword v8, v6, s[36:39], s7 offen sc1
    s_lshr_b32 s7, s64, 4
    s_lshl_b32 s7, s7, 15
    s_lshl_b32 s63, s60, 13
    s_add_u32 s7, s7, s63
    s_add_u32 s7, s7, 0x0
    v_lshl_add_u32 v4, v1, 4, s7
    s_and_b32 s7, s60, 1
    s_lshl_b32 s7, s7, 7
    v_xor_b32 v3, s7, v2
    s_lshl_b32 s7, s60, 13
    s_add_u32 s7, s7, 0x18000
    v_add_u32 v3, s7, v3
    s_cmp_eq_u32 s60, 0
    s_cbranch_scc1 C8_110
    s_waitcnt vmcnt(0)
    v_mov_b32 v160, 0x24000
    v_mov_b32 v161, 1
    s_waitcnt lgkmcnt(0)
    s_mov_b64 exec, 1
    ds_add_u32 v160, v161
    s_mov_b64 exec, -1
    s_branch C8_109
C8_110:
    s_sleep 24
    v_mov_b32 v160, 0
    s_mov_b32 s80, 200000
NG_111:
    s_mov_b64 exec, 1
    buffer_load_dwordx2 v[162:163], v160, s[40:43], 0 offen sc1
    s_mov_b64 exec, -1
    s_waitcnt vmcnt(0)
    v_readfirstlane_b32 s94, v162
    v_readfirstlane_b32 s95, v163
    s_cmp_lg_u32 s95, 0
    s_cbranch_scc1 NGD_112
    s_sleep 4
    s_sub_u32 s80, s80, 1
    s_cmp_lg_u32 s80, 0
    s_cbranch_scc1 NG_111
NGD_112:
    v_mov_b32 v160, 0x24000
    s_mov_b32 s80, 1600000
LW_113:
    ds_read_b32 v161, v160
    s_waitcnt lgkmcnt(0)
    v_readfirstlane_b32 s79, v161
    s_cmp_ge_u32 s79, 3
    s_cbranch_scc1 LWD_114
    s_sleep 1
    s_sub_u32 s80, s80, 1
    s_cmp_lg_u32 s80, 0
    s_cbranch_scc1 LW_113
LWD_114:
    s_lshl_b32 s7, s4, 5
    s_add_u32 s7, s7, s5
    s_lshl_b32 s7, s7, 3
    s_add_u32 s7, s7, 0xc0000
    v_mov_b32 v160, s7
    v_mov_b32 v162, s94
    v_mov_b32 v163, s95
    s_mov_b64 exec, 1
    buffer_store_dwordx2 v[162:163], v160, s[36:39], 0 offen sc1
    s_mov_b64 exec, -1
    v_lshrrev_b32 v160, 3, v1
    v_lshlrev_b32 v160, 8, v160
    v_and_b32 v161, 7, v1
    v_lshl_add_u32 v160, v161, 3, v160
    v_add_u32 v160, 0xc0000, v160
    s_mov_b32 s80, 200000
FW_115:
    buffer_load_dwordx2 v[162:163], v160, s[36:39], 0 offen sc1
    s_waitcnt vmcnt(0)
    v_cmp_ne_u64 vcc, s[94:95], v[162:163]
    s_cbranch_vccz FWD_116
    s_sleep 2
    s_sub_u32 s80, s80, 1
    s_cmp_lg_u32 s80, 0
    s_cbranch_scc1 FW_115
FWD_116:
    v_mov_b32 v160, 0x24018
    v_mov_b32 v161, 1
    s_waitcnt lgkmcnt(0)
    s_mov_b64 exec, 1
    ds_add_u32 v160, v161
    s_mov_b64 exec, -1
C8_109:
    v_mov_b32 v160, 0x24018
    s_mov_b32 s80, 1600000
LW_117:
    ds_read_b32 v161, v160
    s_waitcnt lgkmcnt(0)
    v_readfirstlane_b32 s79, v161
    s_cmp_ge_u32 s79, 1
    s_cbranch_scc1 LWD_118
    s_sleep 1
    s_sub_u32 s80, s80, 1
    s_cmp_lg_u32 s80, 0
    s_cbranch_scc1 LW_117
LWD_118:
    s_mov_b32 s63, 4096
    buffer_load_dwordx4 v[32:35], v4, s[36:39], 0 offen offset:0 sc1
    buffer_load_dwordx4 v[36:39], v4, s[36:39], 0 offen offset:1024 sc1
    buffer_load_dwordx4 v[40:43], v4, s[36:39], 0 offen offset:2048 sc1
    buffer_load_dwordx4 v[44:47], v4, s[36:39], 0 offen offset:3072 sc1
    buffer_load_dwordx4 v[48:51], v4, s[36:39], s63 offen offset:0 sc1
    buffer_load_dwordx4 v[52:55], v4, s[36:39], s63 offen offset:1024 sc1
    buffer_load_dwordx4 v[56:59], v4, s[36:39], s63 offen offset:2048 sc1
    buffer_load_dwordx4 v[60:63], v4, s[36:39], s63 offen offset:3072 sc1
    s_mov_b32 s80, 200000
PS_119:
    s_waitcnt vmcnt(0)
    s_mov_b32 s78, 0
    v_max_u32 v160, v32, v33
    v_max3_u32 v160, v160, v34, v35
    v_cmp_eq_u32 vcc, -1, v160
    s_cbranch_vccz PSS_121
    buffer_load_dwordx4 v[32:35], v4, s[36:39], 0 offen offset:0 sc1
    s_mov_b32 s78, 1
PSS_121:
    v_max_u32 v160, v36, v37
    v_max3_u32 v160, v160, v38, v39
    v_cmp_eq_u32 vcc, -1, v160
    s_cbranch_vccz PSS_122
    buffer_load_dwordx4 v[36:39], v4, s[36:39], 0 offen offset:1024 sc1
    s_mov_b32 s78, 1
PSS_122:
    v_max_u32 v160, v40, v41
    v_max3_u32 v160, v160, v42, v43
    v_cmp_eq_u32 vcc, -1, v160
    s_cbranch_vccz PSS_123
    buffer_load_dwordx4 v[40:43], v4, s[36:39], 0 offen offset:2048 sc1
    s_mov_b32 s78, 1
PSS_123:
    v_max_u32 v160, v44, v45
    v_max3_u32 v160, v160, v46, v47
    v_cmp_eq_u32 vcc, -1, v160
    s_cbranch_vccz PSS_124
    buffer_load_dwordx4 v[44:47], v4, s[36:39], 0 offen offset:3072 sc1
    s_mov_b32 s78, 1
PSS_124:
    v_max_u32 v160, v48, v49
    v_max3_u32 v160, v160, v50, v51
    v_cmp_eq_u32 vcc, -1, v160
    s_cbranch_vccz PSS_125
    buffer_load_dwordx4 v[48:51], v4, s[36:39], s63 offen offset:0 sc1
    s_mov_b32 s78, 1
PSS_125:
    v_max_u32 v160, v52, v53
    v_max3_u32 v160, v160, v54, v55
    v_cmp_eq_u32 vcc, -1, v160
    s_cbranch_vccz PSS_126
    buffer_load_dwordx4 v[52:55], v4, s[36:39], s63 offen offset:1024 sc1
    s_mov_b32 s78, 1
PSS_126:
    v_max_u32 v160, v56, v57
    v_max3_u32 v160, v160, v58, v59
    v_cmp_eq_u32 vcc, -1, v160
    s_cbranch_vccz PSS_127
    buffer_load_dwordx4 v[56:59], v4, s[36:39], s63 offen offset:2048 sc1
    s_mov_b32 s78, 1
PSS_127:
    v_max_u32 v160, v60, v61
    v_max3_u32 v160, v160, v62, v63
    v_cmp_eq_u32 vcc, -1, v160
    s_cbranch_vccz PSS_128
    buffer_load_dwordx4 v[60:63], v4, s[36:39], s63 offen offset:3072 sc1
    s_mov_b32 s78, 1
PSS_128:
    s_cmp_eq_u32 s78, 0
    s_cbranch_scc1 PSD_120
    s_sub_u32 s80, s80, 1
    s_cmp_lg_u32 s80, 0
    s_cbranch_scc1 PS_119
    s_waitcnt vmcnt(0)
PSD_120:
    v_xor_b32 v6, 0x0, v3
    ds_write_b128 v6, v[32:35] offset:0
    v_xor_b32 v7, 0x10, v3
    ds_write_b128 v7, v[36:39] offset:1024
    v_xor_b32 v6, 0x20, v3
    ds_write_b128 v6, v[40:43] offset:2048
    v_xor_b32 v7, 0x30, v3
    ds_write_b128 v7, v[44:47] offset:3072
    v_xor_b32 v6, 0x40, v3
    ds_write_b128 v6, v[48:51] offset:4096
    v_xor_b32 v7, 0x50, v3
    ds_write_b128 v7, v[52:55] offset:5120
    v_xor_b32 v6, 0x60, v3
    ds_write_b128 v6, v[56:59] offset:6144
    v_xor_b32 v7, 0x70, v3
    ds_write_b128 v7, v[60:63] offset:7168
    v_mov_b32 v160, 0x24028
    v_mov_b32 v161, 1
    s_waitcnt lgkmcnt(0)
    s_mov_b64 exec, 1
    ds_add_u32 v160, v161
    s_mov_b64 exec, -1
    s_lshl_b32 s7, s64, 18
    s_lshl_b32 s63, s60, 10
    s_add_u32 s63, s63, s7
    s_add_u32 s63, s63, 196608
    s_lshl_b32 s7, s60, 6
    v_xor_b32 v12, s7, v2
    v_xor_b32 v13, 16, v12
    v_xor_b32 v14, 32, v12
    v_xor_b32 v15, 48, v12
    buffer_load_dwordx4 v[32:35], v12, s[44:47], s63 offen nt
    s_add_u32 s63, s63, 4096
    buffer_load_dwordx4 v[36:39], v13, s[44:47], s63 offen nt
    s_add_u32 s63, s63, 4096
    buffer_load_dwordx4 v[40:43], v14, s[44:47], s63 offen nt
    s_add_u32 s63, s63, 4096
    buffer_load_dwordx4 v[44:47], v15, s[44:47], s63 offen nt
    s_add_u32 s63, s63, 4096
    buffer_load_dwordx4 v[48:51], v12, s[44:47], s63 offen nt
    s_add_u32 s63, s63, 4096
    buffer_load_dwordx4 v[52:55], v13, s[44:47], s63 offen nt
    s_add_u32 s63, s63, 4096
    buffer_load_dwordx4 v[56:59], v14, s[44:47], s63 offen nt
    s_add_u32 s63, s63, 4096
    buffer_load_dwordx4 v[60:63], v15, s[44:47], s63 offen nt
    s_add_u32 s63, s63, 4096
    s_waitcnt vmcnt(7)
    buffer_load_dwordx4 v[64:67], v12, s[44:47], s63 offen nt
    s_add_u32 s63, s63, 4096
    s_waitcnt vmcnt(7)
    buffer_load_dwordx4 v[68:71], v13, s[44:47], s63 offen nt
    s_add_u32 s63, s63, 4096
    s_waitcnt vmcnt(7)
    buffer_load_dwordx4 v[72:75], v14, s[44:47], s63 offen nt
    s_add_u32 s63, s63, 4096
    s_waitcnt vmcnt(7)
    buffer_load_dwordx4 v[76:79], v15, s[44:47], s63 offen nt
    s_add_u32 s63, s63, 4096
    s_waitcnt vmcnt(7)
    buffer_load_dwordx4 v[80:83], v12, s[44:47], s63 offen nt
    s_add_u32 s63, s63, 4096
    s_waitcnt vmcnt(7)
    buffer_load_dwordx4 v[84:87], v13, s[44:47], s63 offen nt
    s_add_u32 s63, s63, 4096
    s_waitcnt vmcnt(7)
    buffer_load_dwordx4 v[88:91], v14, s[44:47], s63 offen nt
    s_add_u32 s63, s63, 4096
    s_waitcnt vmcnt(7)
    buffer_load_dwordx4 v[92:95], v15, s[44:47], s63 offen nt
    s_add_u32 s63, s63, 4096
    v_mov_b32 v160, 0x2402c
    s_mov_b32 s80, 1600000
LW_129:
    ds_read_b32 v161, v160
    s_waitcnt lgkmcnt(0)
    v_readfirstlane_b32 s79, v161
    s_cmp_ge_u32 s79, 8
    s_cbranch_scc1 LWD_130
    s_sleep 1
    s_sub_u32 s80, s80, 1
    s_cmp_lg_u32 s80, 0
    s_cbranch_scc1 LW_129
LWD_130:
    s_waitcnt vmcnt(0)
    s_lshl_b32 s7, s60, 10
    s_add_u32 s7, s7, 0x10000
    v_add_u32 v3, s7, v2
    ds_write_b128 v3, v[32:35] offset:0
    ds_write_b128 v3, v[36:39] offset:4096
    ds_write_b128 v3, v[40:43] offset:8192
    ds_write_b128 v3, v[44:47] offset:12288
    ds_write_b128 v3, v[48:51] offset:16384
    ds_write_b128 v3, v[52:55] offset:20480
    ds_write_b128 v3, v[56:59] offset:24576
    ds_write_b128 v3, v[60:63] offset:28672
    ds_write_b128 v3, v[64:67] offset:32768
    ds_write_b128 v3, v[68:71] offset:36864
    ds_write_b128 v3, v[72:75] offset:40960
    ds_write_b128 v3, v[76:79] offset:45056
    ds_write_b128 v3, v[80:83] offset:49152
    ds_write_b128 v3, v[84:87] offset:53248
    ds_write_b128 v3, v[88:91] offset:57344
    ds_write_b128 v3, v[92:95] offset:61440
    v_mov_b32 v160, 0x24030
    v_mov_b32 v161, 1
    s_waitcnt lgkmcnt(0)
    s_mov_b64 exec, 1
    ds_add_u32 v160, v161
    s_mov_b64 exec, -1
    s_cmp_lg_u32 s60, 0
    s_cbranch_scc1 L_END
    s_lshl_b32 s7, s64, 13
    s_add_u32 s7, s7, 0x100000
    v_add_u32 v4, s7, v2
    s_bfe_u32 s7, s64, 0x20003
    s_lshl_b32 s7, s7, 11
    s_lshr_b32 s63, s64, 5
    s_lshl_b32 s63, s63, 10
    s_add_u32 s7, s7, s63
    s_and_b32 s63, s64, 7
    s_lshl_b32 s63, s63, 7
    s_add_u32 s7, s7, s63
    v_add_u32 v5, s7, v2
    s_mov_b32 s63, 4096
    s_mov_b32 s80, 200000
PO_131:
    buffer_load_dwordx4 v[32:35], v4, s[36:39], 0 offen offset:0 sc1
PO2_132:
    s_waitcnt vmcnt(0)
    v_max_u32 v160, v32, v33
    v_max3_u32 v160, v160, v34, v35
    v_cmp_eq_u32 vcc, -1, v160
    s_cmp_lg_u64 vcc, -1
    s_cbranch_scc1 POD_133
    s_sleep 20
    s_sub_u32 s80, s80, 1
    s_cmp_lg_u32 s80, 0
    s_cbranch_scc1 PO_131
POD_133:
    buffer_load_dwordx4 v[32:35], v4, s[36:39], 0 offen offset:0 sc1
    buffer_load_dwordx4 v[36:39], v4, s[36:39], 0 offen offset:1024 sc1
    buffer_load_dwordx4 v[40:43], v4, s[36:39], 0 offen offset:2048 sc1
    buffer_load_dwordx4 v[44:47], v4, s[36:39], 0 offen offset:3072 sc1
    buffer_load_dwordx4 v[48:51], v4, s[36:39], s63 offen offset:0 sc1
    buffer_load_dwordx4 v[52:55], v4, s[36:39], s63 offen offset:1024 sc1
    buffer_load_dwordx4 v[56:59], v4, s[36:39], s63 offen offset:2048 sc1
    buffer_load_dwordx4 v[60:63], v4, s[36:39], s63 offen offset:3072 sc1
    s_mov_b32 s80, 200000
PS_134:
    s_waitcnt vmcnt(0)
    s_mov_b32 s78, 0
    v_max_u32 v160, v32, v33
    v_max3_u32 v160, v160, v34, v35
    v_cmp_eq_u32 vcc, -1, v160
    s_cbranch_vccz PSS_136
    buffer_load_dwordx4 v[32:35], v4, s[36:39], 0 offen offset:0 sc1
    s_mov_b32 s78, 1
PSS_136:
    v_max_u32 v160, v36, v37
    v_max3_u32 v160, v160, v38, v39
    v_cmp_eq_u32 vcc, -1, v160
    s_cbranch_vccz PSS_137
    buffer_load_dwordx4 v[36:39], v4, s[36:39], 0 offen offset:1024 sc1
    s_mov_b32 s78, 1
PSS_137:
    v_max_u32 v160, v40, v41
    v_max3_u32 v160, v160, v42, v43
    v_cmp_eq_u32 vcc, -1, v160
    s_cbranch_vccz PSS_138
    buffer_load_dwordx4 v[40:43], v4, s[36:39], 0 offen offset:2048 sc1
    s_mov_b32 s78, 1
PSS_138:
    v_max_u32 v160, v44, v45
    v_max3_u32 v160, v160, v46, v47
    v_cmp_eq_u32 vcc, -1, v160
    s_cbranch_vccz PSS_139
    buffer_load_dwordx4 v[44:47], v4, s[36:39], 0 offen offset:3072 sc1
    s_mov_b32 s78, 1
PSS_139:
    v_max_u32 v160, v48, v49
    v_max3_u32 v160, v160, v50, v51
    v_cmp_eq_u32 vcc, -1, v160
    s_cbranch_vccz PSS_140
    buffer_load_dwordx4 v[48:51], v4, s[36:39], s63 offen offset:0 sc1
    s_mov_b32 s78, 1
PSS_140:
    v_max_u32 v160, v52, v53
    v_max3_u32 v160, v160, v54, v55
    v_cmp_eq_u32 vcc, -1, v160
    s_cbranch_vccz PSS_141
    buffer_load_dwordx4 v[52:55], v4, s[36:39], s63 offen offset:1024 sc1
    s_mov_b32 s78, 1
PSS_141:
    v_max_u32 v160, v56, v57
    v_max3_u32 v160, v160, v58, v59
    v_cmp_eq_u32 vcc, -1, v160
    s_cbranch_vccz PSS_142
    buffer_load_dwordx4 v[56:59], v4, s[36:39], s63 offen offset:2048 sc1
    s_mov_b32 s78, 1
PSS_142:
    v_max_u32 v160, v60, v61
    v_max3_u32 v160, v160, v62, v63
    v_cmp_eq_u32 vcc, -1, v160
    s_cbranch_vccz PSS_143
    buffer_load_dwordx4 v[60:63], v4, s[36:39], s63 offen offset:3072 sc1
    s_mov_b32 s78, 1
PSS_143:
    s_cmp_eq_u32 s78, 0
    s_cbranch_scc1 PSD_135
    s_sub_u32 s80, s80, 1
    s_cmp_lg_u32 s80, 0
    s_cbranch_scc1 PS_134
    s_waitcnt vmcnt(0)
PSD_135:
    v_pk_add_f32 v[32:33], v[32:33], v[40:41]
    v_pk_add_f32 v[34:35], v[34:35], v[42:43]
    v_pk_add_f32 v[36:37], v[36:37], v[44:45]
    v_pk_add_f32 v[38:39], v[38:39], v[46:47]
    v_pk_add_f32 v[32:33], v[32:33], v[36:37]
    v_pk_add_f32 v[34:35], v[34:35], v[38:39]
    v_pk_add_f32 v[48:49], v[48:49], v[56:57]
    v_pk_add_f32 v[50:51], v[50:51], v[58:59]
    v_pk_add_f32 v[52:53], v[52:53], v[60:61]
    v_pk_add_f32 v[54:55], v[54:55], v[62:63]
    v_pk_add_f32 v[48:49], v[48:49], v[52:53]
    v_pk_add_f32 v[50:51], v[50:51], v[54:55]
    v_add_f32_dpp v32, v32, v32 row_ror:8 row_mask:0xf bank_mask:0xf
    v_add_f32_dpp v33, v33, v33 row_ror:8 row_mask:0xf bank_mask:0xf
    v_add_f32_dpp v34, v34, v34 row_ror:8 row_mask:0xf bank_mask:0xf
    v_add_f32_dpp v35, v35, v35 row_ror:8 row_mask:0xf bank_mask:0xf
    v_add_f32_dpp v48, v48, v48 row_ror:8 row_mask:0xf bank_mask:0xf
    v_add_f32_dpp v49, v49, v49 row_ror:8 row_mask:0xf bank_mask:0xf
    v_add_f32_dpp v50, v50, v50 row_ror:8 row_mask:0xf bank_mask:0xf
    v_add_f32_dpp v51, v51, v51 row_ror:8 row_mask:0xf bank_mask:0xf
    v_mov_b32 v12, v32
    v_mov_b32 v13, v33
    v_mov_b32 v14, v34
    v_mov_b32 v15, v35
    v_mov_b32 v16, v48
    v_mov_b32 v17, v49
    v_mov_b32 v18, v50
    v_mov_b32 v19, v51
    v_permlane32_swap_b32 v32, v12
    v_permlane32_swap_b32 v33, v13
    v_permlane32_swap_b32 v34, v14
    v_permlane32_swap_b32 v35, v15
    v_permlane32_swap_b32 v48, v16
    v_permlane32_swap_b32 v49, v17
    v_permlane32_swap_b32 v50, v18
    v_permlane32_swap_b32 v51, v19
    v_add_f32 v32, v32, v12
    v_add_f32 v33, v33, v13
    v_add_f32 v34, v34, v14
    v_add_f32 v35, v35, v15
    v_add_f32 v48, v48, v16
    v_add_f32 v49, v49, v17
    v_add_f32 v50, v50, v18
    v_add_f32 v51, v51, v19
    v_mov_b32 v12, v32
    v_mov_b32 v13, v33
    v_mov_b32 v14, v34
    v_mov_b32 v15, v35
    v_mov_b32 v16, v48
    v_mov_b32 v17, v49
    v_mov_b32 v18, v50
    v_mov_b32 v19, v51
    v_permlane16_swap_b32 v32, v12
    v_permlane16_swap_b32 v33, v13
    v_permlane16_swap_b32 v34, v14
    v_permlane16_swap_b32 v35, v15
    v_permlane16_swap_b32 v48, v16
    v_permlane16_swap_b32 v49, v17
    v_permlane16_swap_b32 v50, v18
    v_permlane16_swap_b32 v51, v19
    v_add_f32 v32, v32, v12
    v_add_f32 v33, v33, v13
    v_add_f32 v34, v34, v14
    v_add_f32 v35, v35, v15
    v_add_f32 v48, v48, v16
    v_add_f32 v49, v49, v17
    v_add_f32 v50, v50, v18
    v_add_f32 v51, v51, v19
    v_cvt_pk_bf16_f32 v8, v32, v33
    v_cvt_pk_bf16_f32 v9, v34, v35
    v_cvt_pk_bf16_f32 v10, v48, v49
    v_cvt_pk_bf16_f32 v11, v50, v51
    s_mov_b64 exec, 0xff
    buffer_store_dwordx4 v[8:11], v5, s[52:55], 0 offen
    s_mov_b64 exec, -1
    s_endpgm
L_END:
    s_endpgm
L_END0:
    s_endpgm
.section .rodata,"a"
.p2align 6
.amdhsa_kernel concat_heads__sliding_block_cached__compressed_kv_cla__decode_kernel
  .amdhsa_next_free_vgpr 168
  .amdhsa_next_free_sgpr 102
  .amdhsa_accum_offset 168
  .amdhsa_group_segment_fixed_size 0
  .amdhsa_kernarg_size 112
  .amdhsa_user_sgpr_count 2
  .amdhsa_user_sgpr_kernarg_segment_ptr 1
  .amdhsa_system_sgpr_workgroup_id_x 1
  .amdhsa_float_denorm_mode_32 3
.end_amdhsa_kernel
```

```asm
; @launch grid=(256,1,1) block=(768,1,1) lds=163840
.amdgcn_target "amdgcn-amd-amdhsa--gfx950"
.text
.globl concat_heads__sliding_block_cached__compressed_kv_cla__decode_kernel
.p2align 8
.type concat_heads__sliding_block_cached__compressed_kv_cla__decode_kernel,@function
concat_heads__sliding_block_cached__compressed_kv_cla__decode_kernel:
    s_cmp_ge_u32 s2, 256
    s_cbranch_scc1 L_END0
    s_load_dwordx16 s[8:23], s[0:1], 0
    s_load_dwordx8 s[24:31], s[0:1], 64
    s_load_dwordx4 s[32:35], s[0:1], 96
    v_lshrrev_b32 v1, 6, v0
    s_nop 0
    v_readfirstlane_b32 s3, v1
    v_and_b32 v1, 63, v0
    s_and_b32 s4, s2, 7
    s_lshr_b32 s5, s2, 3
    s_and_b32 s7, s5, 3
    s_lshl_b32 s6, s4, 2
    s_add_u32 s6, s6, s7
    s_cmp_lg_u32 s3, 11
    s_cbranch_scc1 Z_1
    v_lshlrev_b32 v2, 2, v1
    v_add_u32 v2, 0x24000, v2
    v_mov_b32 v3, 0
    ds_write_b32 v2, v3
Z_1:
    s_waitcnt lgkmcnt(0)
    s_mov_b32 s36, s34
    s_and_b32 s37, s35, 0xffff
    s_mov_b32 s38, 0x1000000
    s_mov_b32 s39, 0x20000
    s_mov_b32 s40, s32
    s_and_b32 s41, s33, 0xffff
    s_mov_b32 s42, 0x100
    s_mov_b32 s43, 0x20000
    s_cmp_lt_u32 s5, 8
    s_cbranch_scc1 L_W
    s_cmp_lt_u32 s5, 16
    s_cbranch_scc1 L_C
    s_cmp_eq_u32 s3, 11
    s_cbranch_scc1 L_ASVC
    s_mov_b32 s44, s10
    s_and_b32 s45, s11, 0xffff
    s_mov_b32 s46, 0x8000000
    s_mov_b32 s47, 0x20000
    s_mov_b32 s48, s12
    s_and_b32 s49, s13, 0xffff
    s_mov_b32 s50, 0x8000000
    s_mov_b32 s51, 0x20000
    s_lshr_b32 s7, s5, 2
    s_sub_u32 s7, s7, 4
    s_lshl_b32 s7, s7, 5
    s_add_u32 s7, s7, s6
    s_lshl_b32 s7, s7, 20
    s_add_u32 s7, s7, 0xC0000
    v_lshlrev_b32 v6, 4, v1
    v_add_u32 v6, s7, v6
    s_add_u32 s63, s3, 3
    s_cmp_ge_u32 s63, 11
    s_cselect_b32 s7, 11, 0
    s_sub_u32 s62, s63, s7
    s_mul_i32 s7, s2, 0
    s_add_u32 s7, s7, s62
    s_mul_i32 s7, s7, 1024
    s_and_b32 s60, s7, 0x3ffff
    s_mov_b32 s61, s60
    s_add_u32 s63, s60, 259072
    s_and_b32 s63, s63, 0x3ffff
    s_cmp_lt_u32 s62, 3
    s_cselect_b32 s63, s63, 0x40000000
    s_cselect_b32 s62, 0, 0xff800000
    s_mov_b32 s64, 0x3e0293ee
    s_cmp_ge_u32 s3, 8
    s_cbranch_scc1 AK_2
    s_cmp_lt_u32 s3, 4
    s_cselect_b32 s70, s18, s8
    s_cselect_b32 s71, s19, s9
    s_cselect_b32 s72, s22, s14
    s_cselect_b32 s73, s23, s15
    s_mov_b32 s52, s70
    s_and_b32 s53, s71, 0xffff
    s_mov_b32 s54, 0x1000
    s_mov_b32 s55, 0x20000
    s_mov_b32 s56, s72
    s_and_b32 s57, s73, 0xffff
    s_mov_b32 s58, 0x400000
    s_mov_b32 s59, 0x20000
    s_and_b32 s7, s5, 12
    s_and_b32 s66, s3, 3
    s_add_u32 s7, s7, s66
    v_lshrrev_b32 v2, 4, v1
    v_lshlrev_b32 v3, 16, v2
    v_and_b32 v4, 15, v1
    v_lshl_add_u32 v3, v4, 4, v3
    s_lshl_b32 s66, s7, 18
    s_lshl_b32 s67, s6, 8
    s_add_u32 s66, s66, s67
    s_cmp_lt_u32 s3, 4
    s_cbranch_scc1 AP_4
    s_barrier
    s_sleep 26
AP_4:
    buffer_load_dwordx4 v[128:131], v3, s[56:59], s66 offen nt
    s_add_u32 s66, s66, 8192
    buffer_load_dwordx4 v[132:135], v3, s[56:59], s66 offen nt
    s_add_u32 s66, s66, 8192
    buffer_load_dwordx4 v[136:139], v3, s[56:59], s66 offen nt
    s_add_u32 s66, s66, 8192
    buffer_load_dwordx4 v[140:143], v3, s[56:59], s66 offen nt
    s_add_u32 s66, s66, 8192
    buffer_load_dwordx4 v[144:147], v3, s[56:59], s66 offen nt
    s_add_u32 s66, s66, 8192
    buffer_load_dwordx4 v[148:151], v3, s[56:59], s66 offen nt
    s_add_u32 s66, s66, 8192
    buffer_load_dwordx4 v[152:155], v3, s[56:59], s66 offen nt
    s_add_u32 s66, s66, 8192
    buffer_load_dwordx4 v[156:159], v3, s[56:59], s66 offen nt
    s_add_u32 s66, s66, 8192
    v_bfe_u32 v4, v1, 2, 2
    v_lshlrev_b32 v4, 10, v4
    v_lshl_add_u32 v4, v2, 4, v4
    s_lshl_b32 s7, s7, 6
    buffer_load_dwordx4 v[160:163], v4, s[52:55], s7 offen
    s_cmp_ge_u32 s3, 4
    s_cbranch_scc1 AP_5
    s_barrier
AP_5:
    s_mov_b32 s92, 0x05040100
    s_mov_b32 s93, 0x07060302
    s_lshl_b32 s7, s3, 11
    s_add_u32 s7, s7, 0x0
    v_lshl_add_u32 v2, v1, 5, s7
    s_cmp_lt_u32 s3, 4
    s_cselect_b32 s7, 0x44, 0x40
    s_add_u32 s7, s7, 0x24000
    v_mov_b32 v3, s7
    v_mov_b32 v4, 1
    s_waitcnt vmcnt(0)
    v_perm_b32 v96, v132, v128, s92
    v_perm_b32 v97, v140, v136, s92
    v_perm_b32 v98, v148, v144, s92
    v_perm_b32 v99, v156, v152, s92
    v_perm_b32 v100, v132, v128, s93
    v_perm_b32 v101, v140, v136, s93
    v_perm_b32 v102, v148, v144, s93
    v_perm_b32 v103, v156, v152, s93
    v_perm_b32 v104, v133, v129, s92
    v_perm_b32 v105, v141, v137, s92
    v_perm_b32 v106, v149, v145, s92
    v_perm_b32 v107, v157, v153, s92
    v_perm_b32 v108, v133, v129, s93
    v_perm_b32 v109, v141, v137, s93
    v_perm_b32 v110, v149, v145, s93
    v_perm_b32 v111, v157, v153, s93
    v_perm_b32 v112, v134, v130, s92
    v_perm_b32 v113, v142, v138, s92
    v_perm_b32 v114, v150, v146, s92
    v_perm_b32 v115, v158, v154, s92
    v_perm_b32 v116, v134, v130, s93
    v_perm_b32 v117, v142, v138, s93
    v_perm_b32 v118, v150, v146, s93
    v_perm_b32 v119, v158, v154, s93
    v_perm_b32 v120, v135, v131, s92
    v_perm_b32 v121, v143, v139, s92
    v_perm_b32 v122, v151, v147, s92
    v_perm_b32 v123, v159, v155, s92
    v_perm_b32 v124, v135, v131, s93
    v_perm_b32 v125, v143, v139, s93
    v_perm_b32 v126, v151, v147, s93
    v_perm_b32 v127, v159, v155, s93
    v_mfma_f32_16x16x32_bf16 v[64:67], v[160:163], v[96:99], 0
    v_mfma_f32_16x16x32_bf16 v[68:71], v[160:163], v[100:103], 0
    v_mfma_f32_16x16x32_bf16 v[72:75], v[160:163], v[104:107], 0
    v_mfma_f32_16x16x32_bf16 v[76:79], v[160:163], v[108:111], 0
    v_mfma_f32_16x16x32_bf16 v[80:83], v[160:163], v[112:115], 0
    v_mfma_f32_16x16x32_bf16 v[84:87], v[160:163], v[116:119], 0
    v_mfma_f32_16x16x32_bf16 v[88:91], v[160:163], v[120:123], 0
    v_mfma_f32_16x16x32_bf16 v[92:95], v[160:163], v[124:127], 0
    s_nop 0
    v_mov_b32 v128, v64
    v_mov_b32 v129, v68
    v_mov_b32 v130, v72
    v_mov_b32 v131, v76
    v_mov_b32 v132, v80
    v_mov_b32 v133, v84
    v_mov_b32 v134, v88
    v_mov_b32 v135, v92
    ds_write_b128 v2, v[128:131]
    ds_write_b128 v2, v[132:135] offset:16
    s_waitcnt lgkmcnt(0)
    s_mov_b64 exec, 1
    ds_add_u32 v3, v4
    s_mov_b64 exec, -1
    s_branch AJ_3
AK_2:
    s_barrier
    s_sleep 26
AJ_3:
    buffer_load_dwordx4 v[32:35], v6, s[44:47], s60 offen offset:0 nt
    s_add_u32 s60, s60, 11264
    buffer_load_dwordx4 v[36:39], v6, s[44:47], s60 offen offset:0 nt
    s_add_u32 s60, s60, 11264
    buffer_load_dwordx4 v[40:43], v6, s[44:47], s60 offen offset:0 nt
    s_add_u32 s60, s60, 11264
    buffer_load_dwordx4 v[44:47], v6, s[44:47], s60 offen offset:0 nt
    s_add_u32 s60, s60, 11264
    s_waitcnt vmcnt(3)
    buffer_load_dwordx4 v[48:51], v6, s[44:47], s60 offen offset:0 nt
    s_add_u32 s60, s60, 11264
    s_waitcnt vmcnt(3)
    buffer_load_dwordx4 v[52:55], v6, s[44:47], s60 offen offset:0 nt
    s_add_u32 s60, s60, 11264
    s_waitcnt vmcnt(3)
    buffer_load_dwordx4 v[56:59], v6, s[44:47], s60 offen offset:0 nt
    s_add_u32 s60, s60, 11264
    s_waitcnt vmcnt(3)
    buffer_load_dwordx4 v[60:63], v6, s[44:47], s60 offen offset:0 nt
    s_add_u32 s60, s60, 11264
    s_waitcnt vmcnt(3)
    buffer_load_dwordx4 v[64:67], v6, s[44:47], s60 offen offset:0 nt
    s_add_u32 s60, s60, 11264
    s_waitcnt vmcnt(3)
    buffer_load_dwordx4 v[68:71], v6, s[44:47], s60 offen offset:0 nt
    s_add_u32 s60, s60, 11264
    s_waitcnt vmcnt(3)
    buffer_load_dwordx4 v[72:75], v6, s[44:47], s60 offen offset:0 nt
    s_add_u32 s60, s60, 11264
    s_waitcnt vmcnt(3)
    buffer_load_dwordx4 v[76:79], v6, s[44:47], s60 offen offset:0 nt
    s_add_u32 s60, s60, 11264
    s_waitcnt vmcnt(3)
    buffer_load_dwordx4 v[80:83], v6, s[44:47], s60 offen offset:0 nt
    s_add_u32 s60, s60, 11264
    s_waitcnt vmcnt(3)
    buffer_load_dwordx4 v[84:87], v6, s[44:47], s60 offen offset:0 nt
    s_add_u32 s60, s60, 11264
    s_waitcnt vmcnt(3)
    buffer_load_dwordx4 v[88:91], v6, s[44:47], s60 offen offset:0 nt
    s_add_u32 s60, s60, 11264
    s_waitcnt vmcnt(3)
    buffer_load_dwordx4 v[92:95], v6, s[44:47], s60 offen offset:0 nt
    s_add_u32 s60, s60, 11264
    v_mov_b32 v160, 0x24004
    s_mov_b32 s80, 1600000
LW_6:
    ds_read_b32 v161, v160
    s_waitcnt lgkmcnt(0)
    v_readfirstlane_b32 s79, v161
    s_cmp_ge_u32 s79, 1
    s_cbranch_scc1 LWD_7
    s_sleep 4
    s_sub_u32 s80, s80, 1
    s_cmp_lg_u32 s80, 0
    s_cbranch_scc1 LW_6
LWD_7:
    v_and_b32 v160, 15, v1
    v_lshlrev_b32 v160, 4, v160
    v_add_u32 v160, 0x24100, v160
    ds_read_b128 v[2:5], v160
    s_waitcnt lgkmcnt(0)
    v_dot2_f32_bf16 v8, v32, v2, 0
    v_dot2_f32_bf16 v9, v36, v2, 0
    v_dot2_f32_bf16 v10, v40, v2, 0
    v_dot2_f32_bf16 v11, v44, v2, 0
    v_dot2_f32_bf16 v8, v33, v3, v8
    v_dot2_f32_bf16 v9, v37, v3, v9
    v_dot2_f32_bf16 v10, v41, v3, v10
    v_dot2_f32_bf16 v11, v45, v3, v11
    v_dot2_f32_bf16 v8, v34, v4, v8
    v_dot2_f32_bf16 v9, v38, v4, v9
    v_dot2_f32_bf16 v10, v42, v4, v10
    v_dot2_f32_bf16 v11, v46, v4, v11
    v_dot2_f32_bf16 v8, v35, v5, v8
    v_dot2_f32_bf16 v9, v39, v5, v9
    v_dot2_f32_bf16 v10, v43, v5, v10
    v_dot2_f32_bf16 v11, v47, v5, v11
    v_add_f32_dpp v8, v8, v8 row_ror:8 row_mask:0xf bank_mask:0xf
    v_add_f32_dpp v9, v9, v9 row_ror:8 row_mask:0xf bank_mask:0xf
    v_add_f32_dpp v10, v10, v10 row_ror:8 row_mask:0xf bank_mask:0xf
    v_add_f32_dpp v11, v11, v11 row_ror:8 row_mask:0xf bank_mask:0xf
    v_add_f32_dpp v8, v8, v8 row_ror:4 row_mask:0xf bank_mask:0xf
    v_add_f32_dpp v9, v9, v9 row_ror:4 row_mask:0xf bank_mask:0xf
    v_add_f32_dpp v10, v10, v10 row_ror:4 row_mask:0xf bank_mask:0xf
    v_add_f32_dpp v11, v11, v11 row_ror:4 row_mask:0xf bank_mask:0xf
    v_add_f32_dpp v8, v8, v8 row_ror:2 row_mask:0xf bank_mask:0xf
    v_add_f32_dpp v9, v9, v9 row_ror:2 row_mask:0xf bank_mask:0xf
    v_add_f32_dpp v10, v10, v10 row_ror:2 row_mask:0xf bank_mask:0xf
    v_add_f32_dpp v11, v11, v11 row_ror:2 row_mask:0xf bank_mask:0xf
    v_add_f32_dpp v8, v8, v8 row_ror:1 row_mask:0xf bank_mask:0xf
    v_add_f32_dpp v9, v9, v9 row_ror:1 row_mask:0xf bank_mask:0xf
    v_add_f32_dpp v10, v10, v10 row_ror:1 row_mask:0xf bank_mask:0xf
    v_add_f32_dpp v11, v11, v11 row_ror:1 row_mask:0xf bank_mask:0xf
    s_waitcnt vmcnt(3)
    buffer_load_dwordx4 v[96:99], v6, s[44:47], s60 offen offset:0 nt
    s_add_u32 s60, s60, 11264
    s_waitcnt vmcnt(3)
    buffer_load_dwordx4 v[100:103], v6, s[44:47], s60 offen offset:0 nt
    s_add_u32 s60, s60, 11264
    v_dot2_f32_bf16 v12, v48, v2, 0
    v_dot2_f32_bf16 v13, v52, v2, 0
    v_dot2_f32_bf16 v14, v56, v2, 0
    v_dot2_f32_bf16 v15, v60, v2, 0
    v_dot2_f32_bf16 v12, v49, v3, v12
    v_dot2_f32_bf16 v13, v53, v3, v13
    v_dot2_f32_bf16 v14, v57, v3, v14
    v_dot2_f32_bf16 v15, v61, v3, v15
    v_dot2_f32_bf16 v12, v50, v4, v12
    v_dot2_f32_bf16 v13, v54, v4, v13
    v_dot2_f32_bf16 v14, v58, v4, v14
    v_dot2_f32_bf16 v15, v62, v4, v15
    v_dot2_f32_bf16 v12, v51, v5, v12
    v_dot2_f32_bf16 v13, v55, v5, v13
    v_dot2_f32_bf16 v14, v59, v5, v14
    v_dot2_f32_bf16 v15, v63, v5, v15
    v_add_f32_dpp v12, v12, v12 row_ror:8 row_mask:0xf bank_mask:0xf
    v_add_f32_dpp v13, v13, v13 row_ror:8 row_mask:0xf bank_mask:0xf
    v_add_f32_dpp v14, v14, v14 row_ror:8 row_mask:0xf bank_mask:0xf
    v_add_f32_dpp v15, v15, v15 row_ror:8 row_mask:0xf bank_mask:0xf
    v_add_f32_dpp v12, v12, v12 row_ror:4 row_mask:0xf bank_mask:0xf
    v_add_f32_dpp v13, v13, v13 row_ror:4 row_mask:0xf bank_mask:0xf
    v_add_f32_dpp v14, v14, v14 row_ror:4 row_mask:0xf bank_mask:0xf
    v_add_f32_dpp v15, v15, v15 row_ror:4 row_mask:0xf bank_mask:0xf
    v_add_f32_dpp v12, v12, v12 row_ror:2 row_mask:0xf bank_mask:0xf
    v_add_f32_dpp v13, v13, v13 row_ror:2 row_mask:0xf bank_mask:0xf
    v_add_f32_dpp v14, v14, v14 row_ror:2 row_mask:0xf bank_mask:0xf
    v_add_f32_dpp v15, v15, v15 row_ror:2 row_mask:0xf bank_mask:0xf
    v_add_f32_dpp v12, v12, v12 row_ror:1 row_mask:0xf bank_mask:0xf
    v_add_f32_dpp v13, v13, v13 row_ror:1 row_mask:0xf bank_mask:0xf
    v_add_f32_dpp v14, v14, v14 row_ror:1 row_mask:0xf bank_mask:0xf
    v_add_f32_dpp v15, v15, v15 row_ror:1 row_mask:0xf bank_mask:0xf
    s_waitcnt vmcnt(3)
    buffer_load_dwordx4 v[104:107], v6, s[44:47], s60 offen offset:0 nt
    s_add_u32 s60, s60, 11264
    s_waitcnt vmcnt(3)
    buffer_load_dwordx4 v[108:111], v6, s[44:47], s60 offen offset:0 nt
    s_add_u32 s60, s60, 11264
    v_dot2_f32_bf16 v16, v64, v2, 0
    v_dot2_f32_bf16 v17, v68, v2, 0
    v_dot2_f32_bf16 v18, v72, v2, 0
    v_dot2_f32_bf16 v19, v76, v2, 0
    v_dot2_f32_bf16 v16, v65, v3, v16
    v_dot2_f32_bf16 v17, v69, v3, v17
    v_dot2_f32_bf16 v18, v73, v3, v18
    v_dot2_f32_bf16 v19, v77, v3, v19
    v_dot2_f32_bf16 v16, v66, v4, v16
    v_dot2_f32_bf16 v17, v70, v4, v17
    v_dot2_f32_bf16 v18, v74, v4, v18
    v_dot2_f32_bf16 v19, v78, v4, v19
    v_dot2_f32_bf16 v16, v67, v5, v16
    v_dot2_f32_bf16 v17, v71, v5, v17
    v_dot2_f32_bf16 v18, v75, v5, v18
    v_dot2_f32_bf16 v19, v79, v5, v19
    v_add_f32_dpp v16, v16, v16 row_ror:8 row_mask:0xf bank_mask:0xf
    v_add_f32_dpp v17, v17, v17 row_ror:8 row_mask:0xf bank_mask:0xf
    v_add_f32_dpp v18, v18, v18 row_ror:8 row_mask:0xf bank_mask:0xf
    v_add_f32_dpp v19, v19, v19 row_ror:8 row_mask:0xf bank_mask:0xf
    v_add_f32_dpp v16, v16, v16 row_ror:4 row_mask:0xf bank_mask:0xf
    v_add_f32_dpp v17, v17, v17 row_ror:4 row_mask:0xf bank_mask:0xf
    v_add_f32_dpp v18, v18, v18 row_ror:4 row_mask:0xf bank_mask:0xf
    v_add_f32_dpp v19, v19, v19 row_ror:4 row_mask:0xf bank_mask:0xf
    v_add_f32_dpp v16, v16, v16 row_ror:2 row_mask:0xf bank_mask:0xf
    v_add_f32_dpp v17, v17, v17 row_ror:2 row_mask:0xf bank_mask:0xf
    v_add_f32_dpp v18, v18, v18 row_ror:2 row_mask:0xf bank_mask:0xf
    v_add_f32_dpp v19, v19, v19 row_ror:2 row_mask:0xf bank_mask:0xf
    v_add_f32_dpp v16, v16, v16 row_ror:1 row_mask:0xf bank_mask:0xf
    v_add_f32_dpp v17, v17, v17 row_ror:1 row_mask:0xf bank_mask:0xf
    v_add_f32_dpp v18, v18, v18 row_ror:1 row_mask:0xf bank_mask:0xf
    v_add_f32_dpp v19, v19, v19 row_ror:1 row_mask:0xf bank_mask:0xf
    s_waitcnt vmcnt(3)
    buffer_load_dwordx4 v[112:115], v6, s[44:47], s60 offen offset:0 nt
    s_add_u32 s60, s60, 11264
    s_waitcnt vmcnt(3)
    buffer_load_dwordx4 v[116:119], v6, s[44:47], s60 offen offset:0 nt
    s_add_u32 s60, s60, 11264
    v_dot2_f32_bf16 v20, v80, v2, 0
    v_dot2_f32_bf16 v21, v84, v2, 0
    v_dot2_f32_bf16 v22, v88, v2, 0
    v_dot2_f32_bf16 v23, v92, v2, 0
    v_dot2_f32_bf16 v20, v81, v3, v20
    v_dot2_f32_bf16 v21, v85, v3, v21
    v_dot2_f32_bf16 v22, v89, v3, v22
    v_dot2_f32_bf16 v23, v93, v3, v23
    v_dot2_f32_bf16 v20, v82, v4, v20
    v_dot2_f32_bf16 v21, v86, v4, v21
    v_dot2_f32_bf16 v22, v90, v4, v22
    v_dot2_f32_bf16 v23, v94, v4, v23
    v_dot2_f32_bf16 v20, v83, v5, v20
    v_dot2_f32_bf16 v21, v87, v5, v21
    v_dot2_f32_bf16 v22, v91, v5, v22
    v_dot2_f32_bf16 v23, v95, v5, v23
    v_add_f32_dpp v20, v20, v20 row_ror:8 row_mask:0xf bank_mask:0xf
    v_add_f32_dpp v21, v21, v21 row_ror:8 row_mask:0xf bank_mask:0xf
    v_add_f32_dpp v22, v22, v22 row_ror:8 row_mask:0xf bank_mask:0xf
    v_add_f32_dpp v23, v23, v23 row_ror:8 row_mask:0xf bank_mask:0xf
    v_add_f32_dpp v20, v20, v20 row_ror:4 row_mask:0xf bank_mask:0xf
    v_add_f32_dpp v21, v21, v21 row_ror:4 row_mask:0xf bank_mask:0xf
    v_add_f32_dpp v22, v22, v22 row_ror:4 row_mask:0xf bank_mask:0xf
    v_add_f32_dpp v23, v23, v23 row_ror:4 row_mask:0xf bank_mask:0xf
    v_add_f32_dpp v20, v20, v20 row_ror:2 row_mask:0xf bank_mask:0xf
    v_add_f32_dpp v21, v21, v21 row_ror:2 row_mask:0xf bank_mask:0xf
    v_add_f32_dpp v22, v22, v22 row_ror:2 row_mask:0xf bank_mask:0xf
    v_add_f32_dpp v23, v23, v23 row_ror:2 row_mask:0xf bank_mask:0xf
    v_add_f32_dpp v20, v20, v20 row_ror:1 row_mask:0xf bank_mask:0xf
    v_add_f32_dpp v21, v21, v21 row_ror:1 row_mask:0xf bank_mask:0xf
    v_add_f32_dpp v22, v22, v22 row_ror:1 row_mask:0xf bank_mask:0xf
    v_add_f32_dpp v23, v23, v23 row_ror:1 row_mask:0xf bank_mask:0xf
    s_waitcnt vmcnt(3)
    buffer_load_dwordx4 v[120:123], v6, s[44:47], s60 offen offset:0 nt
    s_waitcnt vmcnt(3)
    buffer_load_dwordx4 v[124:127], v6, s[44:47], s63 offen offset:0 nt
    v_dot2_f32_bf16 v24, v96, v2, 0
    v_dot2_f32_bf16 v25, v100, v2, 0
    v_dot2_f32_bf16 v26, v104, v2, 0
    v_dot2_f32_bf16 v27, v108, v2, 0
    v_dot2_f32_bf16 v24, v97, v3, v24
    v_dot2_f32_bf16 v25, v101, v3, v25
    v_dot2_f32_bf16 v26, v105, v3, v26
    v_dot2_f32_bf16 v27, v109, v3, v27
    v_dot2_f32_bf16 v24, v98, v4, v24
    v_dot2_f32_bf16 v25, v102, v4, v25
    v_dot2_f32_bf16 v26, v106, v4, v26
    v_dot2_f32_bf16 v27, v110, v4, v27
    v_dot2_f32_bf16 v24, v99, v5, v24
    v_dot2_f32_bf16 v25, v103, v5, v25
    v_dot2_f32_bf16 v26, v107, v5, v26
    v_dot2_f32_bf16 v27, v111, v5, v27
    v_add_f32_dpp v24, v24, v24 row_ror:8 row_mask:0xf bank_mask:0xf
    v_add_f32_dpp v25, v25, v25 row_ror:8 row_mask:0xf bank_mask:0xf
    v_add_f32_dpp v26, v26, v26 row_ror:8 row_mask:0xf bank_mask:0xf
    v_add_f32_dpp v27, v27, v27 row_ror:8 row_mask:0xf bank_mask:0xf
    v_add_f32_dpp v24, v24, v24 row_ror:4 row_mask:0xf bank_mask:0xf
    v_add_f32_dpp v25, v25, v25 row_ror:4 row_mask:0xf bank_mask:0xf
    v_add_f32_dpp v26, v26, v26 row_ror:4 row_mask:0xf bank_mask:0xf
    v_add_f32_dpp v27, v27, v27 row_ror:4 row_mask:0xf bank_mask:0xf
    v_add_f32_dpp v24, v24, v24 row_ror:2 row_mask:0xf bank_mask:0xf
    v_add_f32_dpp v25, v25, v25 row_ror:2 row_mask:0xf bank_mask:0xf
    v_add_f32_dpp v26, v26, v26 row_ror:2 row_mask:0xf bank_mask:0xf
    v_add_f32_dpp v27, v27, v27 row_ror:2 row_mask:0xf bank_mask:0xf
    v_add_f32_dpp v24, v24, v24 row_ror:1 row_mask:0xf bank_mask:0xf
    v_add_f32_dpp v25, v25, v25 row_ror:1 row_mask:0xf bank_mask:0xf
    v_add_f32_dpp v26, v26, v26 row_ror:1 row_mask:0xf bank_mask:0xf
    v_add_f32_dpp v27, v27, v27 row_ror:1 row_mask:0xf bank_mask:0xf
    s_waitcnt vmcnt(3)
    buffer_load_dwordx4 v[128:131], v6, s[48:51], s61 offen offset:0 nt
    s_add_u32 s61, s61, 11264
    s_waitcnt vmcnt(3)
    buffer_load_dwordx4 v[132:135], v6, s[48:51], s61 offen offset:0 nt
    s_add_u32 s61, s61, 11264
    s_waitcnt vmcnt(3)
    buffer_load_dwordx4 v[136:139], v6, s[48:51], s61 offen offset:0 nt
    s_add_u32 s61, s61, 11264
    s_waitcnt vmcnt(3)
    buffer_load_dwordx4 v[140:143], v6, s[48:51], s61 offen offset:0 nt
    s_add_u32 s61, s61, 11264
    v_dot2_f32_bf16 v28, v112, v2, 0
    v_dot2_f32_bf16 v29, v116, v2, 0
    v_dot2_f32_bf16 v30, v120, v2, 0
    v_dot2_f32_bf16 v31, v124, v2, 0
    v_dot2_f32_bf16 v28, v113, v3, v28
    v_dot2_f32_bf16 v29, v117, v3, v29
    v_dot2_f32_bf16 v30, v121, v3, v30
    v_dot2_f32_bf16 v31, v125, v3, v31
    v_dot2_f32_bf16 v28, v114, v4, v28
    v_dot2_f32_bf16 v29, v118, v4, v29
    v_dot2_f32_bf16 v30, v122, v4, v30
    v_dot2_f32_bf16 v31, v126, v4, v31
    v_dot2_f32_bf16 v28, v115, v5, v28
    v_dot2_f32_bf16 v29, v119, v5, v29
    v_dot2_f32_bf16 v30, v123, v5, v30
    v_dot2_f32_bf16 v31, v127, v5, v31
    v_add_f32_dpp v28, v28, v28 row_ror:8 row_mask:0xf bank_mask:0xf
    v_add_f32_dpp v29, v29, v29 row_ror:8 row_mask:0xf bank_mask:0xf
    v_add_f32_dpp v30, v30, v30 row_ror:8 row_mask:0xf bank_mask:0xf
    v_add_f32_dpp v31, v31, v31 row_ror:8 row_mask:0xf bank_mask:0xf
    v_add_f32_dpp v28, v28, v28 row_ror:4 row_mask:0xf bank_mask:0xf
    v_add_f32_dpp v29, v29, v29 row_ror:4 row_mask:0xf bank_mask:0xf
    v_add_f32_dpp v30, v30, v30 row_ror:4 row_mask:0xf bank_mask:0xf
    v_add_f32_dpp v31, v31, v31 row_ror:4 row_mask:0xf bank_mask:0xf
    v_add_f32_dpp v28, v28, v28 row_ror:2 row_mask:0xf bank_mask:0xf
    v_add_f32_dpp v29, v29, v29 row_ror:2 row_mask:0xf bank_mask:0xf
    v_add_f32_dpp v30, v30, v30 row_ror:2 row_mask:0xf bank_mask:0xf
    v_add_f32_dpp v31, v31, v31 row_ror:2 row_mask:0xf bank_mask:0xf
    v_add_f32_dpp v28, v28, v28 row_ror:1 row_mask:0xf bank_mask:0xf
    v_add_f32_dpp v29, v29, v29 row_ror:1 row_mask:0xf bank_mask:0xf
    v_add_f32_dpp v30, v30, v30 row_ror:1 row_mask:0xf bank_mask:0xf
    v_add_f32_dpp v31, v31, v31 row_ror:1 row_mask:0xf bank_mask:0xf
    s_waitcnt vmcnt(3)
    buffer_load_dwordx4 v[144:147], v6, s[48:51], s61 offen offset:0 nt
    s_add_u32 s61, s61, 11264
    s_waitcnt vmcnt(3)
    buffer_load_dwordx4 v[148:151], v6, s[48:51], s61 offen offset:0 nt
    s_add_u32 s61, s61, 11264
    v_add_f32 v31, s62, v31
    v_max3_f32 v160, v8, v9, v10
    v_max3_f32 v160, v160, v11, v12
    v_max3_f32 v160, v160, v13, v14
    v_max3_f32 v160, v160, v15, v16
    v_max3_f32 v160, v160, v17, v18
    v_max3_f32 v160, v160, v19, v20
    v_max3_f32 v160, v160, v21, v22
    v_max3_f32 v160, v160, v23, v24
    v_max3_f32 v160, v160, v25, v26
    v_max3_f32 v160, v160, v27, v28
    v_max3_f32 v160, v160, v29, v30
    v_max_f32 v160, v160, v31
    v_mov_b32 v161, v160
    s_nop 1
    v_permlane32_swap_b32 v160, v161
    v_max_f32 v160, v160, v161
    v_mov_b32 v161, v160
    s_nop 1
    v_permlane16_swap_b32 v160, v161
    v_max_f32 v160, v160, v161
    v_mul_f32 v160, s64, v160
    v_fma_f32 v8, v8, s64, -v160
    v_fma_f32 v9, v9, s64, -v160
    v_fma_f32 v10, v10, s64, -v160
    v_fma_f32 v11, v11, s64, -v160
    v_fma_f32 v12, v12, s64, -v160
    v_fma_f32 v13, v13, s64, -v160
    v_fma_f32 v14, v14, s64, -v160
    v_fma_f32 v15, v15, s64, -v160
    v_fma_f32 v16, v16, s64, -v160
    v_fma_f32 v17, v17, s64, -v160
    v_fma_f32 v18, v18, s64, -v160
    v_fma_f32 v19, v19, s64, -v160
    v_fma_f32 v20, v20, s64, -v160
    v_fma_f32 v21, v21, s64, -v160
    v_fma_f32 v22, v22, s64, -v160
    v_fma_f32 v23, v23, s64, -v160
    v_fma_f32 v24, v24, s64, -v160
    v_fma_f32 v25, v25, s64, -v160
    v_fma_f32 v26, v26, s64, -v160
    v_fma_f32 v27, v27, s64, -v160
    v_fma_f32 v28, v28, s64, -v160
    v_fma_f32 v29, v29, s64, -v160
    v_fma_f32 v30, v30, s64, -v160
    v_fma_f32 v31, v31, s64, -v160
    v_exp_f32 v8, v8
    v_exp_f32 v9, v9
    v_exp_f32 v10, v10
    v_exp_f32 v11, v11
    v_exp_f32 v12, v12
    v_exp_f32 v13, v13
    v_exp_f32 v14, v14
    v_exp_f32 v15, v15
    v_exp_f32 v16, v16
    v_exp_f32 v17, v17
    v_exp_f32 v18, v18
    v_exp_f32 v19, v19
    v_exp_f32 v20, v20
    v_exp_f32 v21, v21
    v_exp_f32 v22, v22
    v_exp_f32 v23, v23
    v_exp_f32 v24, v24
    v_exp_f32 v25, v25
    v_exp_f32 v26, v26
    v_exp_f32 v27, v27
    v_exp_f32 v28, v28
    v_exp_f32 v29, v29
    v_exp_f32 v30, v30
    v_exp_f32 v31, v31
    s_waitcnt vmcnt(3)
    buffer_load_dwordx4 v[32:35], v6, s[48:51], s61 offen offset:0 nt
    s_add_u32 s61, s61, 11264
    v_add_f32 v162, v8, v9
    v_add_f32 v163, v10, v11
    v_add_f32 v162, v162, v12
    v_add_f32 v163, v163, v13
    v_add_f32 v162, v162, v14
    v_add_f32 v163, v163, v15
    v_add_f32 v162, v162, v16
    v_add_f32 v163, v163, v17
    v_add_f32 v162, v162, v18
    v_add_f32 v163, v163, v19
    v_add_f32 v162, v162, v20
    v_add_f32 v163, v163, v21
    v_add_f32 v162, v162, v22
    v_add_f32 v163, v163, v23
    v_add_f32 v162, v162, v24
    v_add_f32 v163, v163, v25
    v_add_f32 v162, v162, v26
    v_add_f32 v163, v163, v27
    v_add_f32 v162, v162, v28
    v_add_f32 v163, v163, v29
    v_add_f32 v162, v162, v30
    v_add_f32 v163, v163, v31
    v_add_f32 v162, v162, v163
    v_mov_b32 v163, v162
    s_nop 1
    v_permlane32_swap_b32 v162, v163
    v_add_f32 v162, v162, v163
    v_mov_b32 v163, v162
    s_nop 1
    v_permlane16_swap_b32 v162, v163
    v_add_f32 v161, v162, v163
    s_lshl_b32 s7, s3, 3
    s_add_u32 s7, s7, 0x24200
    v_mov_b32 v164, s7
    ds_write_b64 v164, v[160:161]
    v_mov_b32 v164, 0x24008
    v_mov_b32 v165, 1
    s_waitcnt lgkmcnt(0)
    s_mov_b64 exec, 1
    ds_add_u32 v164, v165
    s_mov_b64 exec, -1
    v_and_b32 v2, 15, v1
    v_lshlrev_b32 v2, 5, v2
    v_bfe_u32 v3, v1, 5, 1
    v_lshl_add_u32 v2, v3, 4, v2
    v_bfe_u32 v3, v1, 4, 1
    v_lshl_add_u32 v2, v3, 3, v2
    s_lshl_b32 s7, s3, 9
    s_add_u32 s7, s7, 0x10000
    v_add_u32 v2, s7, v2
    v_mov_b32 v3, 0x2400c
    v_mov_b32 v4, 1
    s_waitcnt vmcnt(3)
    buffer_load_dwordx4 v[36:39], v6, s[48:51], s61 offen offset:0 nt
    s_add_u32 s61, s61, 11264
    v_lshlrev_b32 v160, 16, v128
    v_and_b32 v161, 0xffff0000, v128
    v_lshlrev_b32 v162, 16, v129
    v_and_b32 v163, 0xffff0000, v129
    v_lshlrev_b32 v164, 16, v130
    v_and_b32 v165, 0xffff0000, v130
    v_lshlrev_b32 v166, 16, v131
    v_and_b32 v167, 0xffff0000, v131
    v_pk_mul_f32 v[152:153], v[160:161], v[8:9] op_sel_hi:[1,0]
    v_pk_mul_f32 v[154:155], v[162:163], v[8:9] op_sel_hi:[1,0]
    v_pk_mul_f32 v[156:157], v[164:165], v[8:9] op_sel_hi:[1,0]
    v_pk_mul_f32 v[158:159], v[166:167], v[8:9] op_sel_hi:[1,0]
    v_lshlrev_b32 v160, 16, v132
    v_and_b32 v161, 0xffff0000, v132
    v_lshlrev_b32 v162, 16, v133
    v_and_b32 v163, 0xffff0000, v133
    v_lshlrev_b32 v164, 16, v134
    v_and_b32 v165, 0xffff0000, v134
    v_lshlrev_b32 v166, 16, v135
    v_and_b32 v167, 0xffff0000, v135
    v_pk_fma_f32 v[152:153], v[160:161], v[8:9], v[152:153] op_sel:[0,1,0] op_sel_hi:[1,1,1]
    v_pk_fma_f32 v[154:155], v[162:163], v[8:9], v[154:155] op_sel:[0,1,0] op_sel_hi:[1,1,1]
    v_pk_fma_f32 v[156:157], v[164:165], v[8:9], v[156:157] op_sel:[0,1,0] op_sel_hi:[1,1,1]
    v_pk_fma_f32 v[158:159], v[166:167], v[8:9], v[158:159] op_sel:[0,1,0] op_sel_hi:[1,1,1]
    s_waitcnt vmcnt(3)
    buffer_load_dwordx4 v[40:43], v6, s[48:51], s61 offen offset:0 nt
    s_add_u32 s61, s61, 11264
    v_lshlrev_b32 v160, 16, v136
    v_and_b32 v161, 0xffff0000, v136
    v_lshlrev_b32 v162, 16, v137
    v_and_b32 v163, 0xffff0000, v137
    v_lshlrev_b32 v164, 16, v138
    v_and_b32 v165, 0xffff0000, v138
    v_lshlrev_b32 v166, 16, v139
    v_and_b32 v167, 0xffff0000, v139
    v_pk_fma_f32 v[152:153], v[160:161], v[10:11], v[152:153] op_sel_hi:[1,0,1]
    v_pk_fma_f32 v[154:155], v[162:163], v[10:11], v[154:155] op_sel_hi:[1,0,1]
    v_pk_fma_f32 v[156:157], v[164:165], v[10:11], v[156:157] op_sel_hi:[1,0,1]
    v_pk_fma_f32 v[158:159], v[166:167], v[10:11], v[158:159] op_sel_hi:[1,0,1]
    v_lshlrev_b32 v160, 16, v140
    v_and_b32 v161, 0xffff0000, v140
    v_lshlrev_b32 v162, 16, v141
    v_and_b32 v163, 0xffff0000, v141
    v_lshlrev_b32 v164, 16, v142
    v_and_b32 v165, 0xffff0000, v142
    v_lshlrev_b32 v166, 16, v143
    v_and_b32 v167, 0xffff0000, v143
    v_pk_fma_f32 v[152:153], v[160:161], v[10:11], v[152:153] op_sel:[0,1,0] op_sel_hi:[1,1,1]
    v_pk_fma_f32 v[154:155], v[162:163], v[10:11], v[154:155] op_sel:[0,1,0] op_sel_hi:[1,1,1]
    v_pk_fma_f32 v[156:157], v[164:165], v[10:11], v[156:157] op_sel:[0,1,0] op_sel_hi:[1,1,1]
    v_pk_fma_f32 v[158:159], v[166:167], v[10:11], v[158:159] op_sel:[0,1,0] op_sel_hi:[1,1,1]
    s_waitcnt vmcnt(3)
    buffer_load_dwordx4 v[44:47], v6, s[48:51], s61 offen offset:0 nt
    s_add_u32 s61, s61, 11264
    v_lshlrev_b32 v160, 16, v144
    v_and_b32 v161, 0xffff0000, v144
    v_lshlrev_b32 v162, 16, v145
    v_and_b32 v163, 0xffff0000, v145
    v_lshlrev_b32 v164, 16, v146
    v_and_b32 v165, 0xffff0000, v146
    v_lshlrev_b32 v166, 16, v147
    v_and_b32 v167, 0xffff0000, v147
    v_pk_fma_f32 v[152:153], v[160:161], v[12:13], v[152:153] op_sel_hi:[1,0,1]
    v_pk_fma_f32 v[154:155], v[162:163], v[12:13], v[154:155] op_sel_hi:[1,0,1]
    v_pk_fma_f32 v[156:157], v[164:165], v[12:13], v[156:157] op_sel_hi:[1,0,1]
    v_pk_fma_f32 v[158:159], v[166:167], v[12:13], v[158:159] op_sel_hi:[1,0,1]
    v_lshlrev_b32 v160, 16, v148
    v_and_b32 v161, 0xffff0000, v148
    v_lshlrev_b32 v162, 16, v149
    v_and_b32 v163, 0xffff0000, v149
    v_lshlrev_b32 v164, 16, v150
    v_and_b32 v165, 0xffff0000, v150
    v_lshlrev_b32 v166, 16, v151
    v_and_b32 v167, 0xffff0000, v151
    v_pk_fma_f32 v[152:153], v[160:161], v[12:13], v[152:153] op_sel:[0,1,0] op_sel_hi:[1,1,1]
    v_pk_fma_f32 v[154:155], v[162:163], v[12:13], v[154:155] op_sel:[0,1,0] op_sel_hi:[1,1,1]
    v_pk_fma_f32 v[156:157], v[164:165], v[12:13], v[156:157] op_sel:[0,1,0] op_sel_hi:[1,1,1]
    v_pk_fma_f32 v[158:159], v[166:167], v[12:13], v[158:159] op_sel:[0,1,0] op_sel_hi:[1,1,1]
    s_waitcnt vmcnt(3)
    buffer_load_dwordx4 v[48:51], v6, s[48:51], s61 offen offset:0 nt
    s_add_u32 s61, s61, 11264
    v_lshlrev_b32 v160, 16, v32
    v_and_b32 v161, 0xffff0000, v32
    v_lshlrev_b32 v162, 16, v33
    v_and_b32 v163, 0xffff0000, v33
    v_lshlrev_b32 v164, 16, v34
    v_and_b32 v165, 0xffff0000, v34
    v_lshlrev_b32 v166, 16, v35
    v_and_b32 v167, 0xffff0000, v35
    v_pk_fma_f32 v[152:153], v[160:161], v[14:15], v[152:153] op_sel_hi:[1,0,1]
    v_pk_fma_f32 v[154:155], v[162:163], v[14:15], v[154:155] op_sel_hi:[1,0,1]
    v_pk_fma_f32 v[156:157], v[164:165], v[14:15], v[156:157] op_sel_hi:[1,0,1]
    v_pk_fma_f32 v[158:159], v[166:167], v[14:15], v[158:159] op_sel_hi:[1,0,1]
    s_waitcnt vmcnt(3)
    buffer_load_dwordx4 v[52:55], v6, s[48:51], s61 offen offset:0 nt
    s_add_u32 s61, s61, 11264
    v_lshlrev_b32 v160, 16, v36
    v_and_b32 v161, 0xffff0000, v36
    v_lshlrev_b32 v162, 16, v37
    v_and_b32 v163, 0xffff0000, v37
    v_lshlrev_b32 v164, 16, v38
    v_and_b32 v165, 0xffff0000, v38
    v_lshlrev_b32 v166, 16, v39
    v_and_b32 v167, 0xffff0000, v39
    v_pk_fma_f32 v[152:153], v[160:161], v[14:15], v[152:153] op_sel:[0,1,0] op_sel_hi:[1,1,1]
    v_pk_fma_f32 v[154:155], v[162:163], v[14:15], v[154:155] op_sel:[0,1,0] op_sel_hi:[1,1,1]
    v_pk_fma_f32 v[156:157], v[164:165], v[14:15], v[156:157] op_sel:[0,1,0] op_sel_hi:[1,1,1]
    v_pk_fma_f32 v[158:159], v[166:167], v[14:15], v[158:159] op_sel:[0,1,0] op_sel_hi:[1,1,1]
    s_waitcnt vmcnt(3)
    buffer_load_dwordx4 v[56:59], v6, s[48:51], s61 offen offset:0 nt
    s_add_u32 s61, s61, 11264
    v_lshlrev_b32 v160, 16, v40
    v_and_b32 v161, 0xffff0000, v40
    v_lshlrev_b32 v162, 16, v41
    v_and_b32 v163, 0xffff0000, v41
    v_lshlrev_b32 v164, 16, v42
    v_and_b32 v165, 0xffff0000, v42
    v_lshlrev_b32 v166, 16, v43
    v_and_b32 v167, 0xffff0000, v43
    v_pk_fma_f32 v[152:153], v[160:161], v[16:17], v[152:153] op_sel_hi:[1,0,1]
    v_pk_fma_f32 v[154:155], v[162:163], v[16:17], v[154:155] op_sel_hi:[1,0,1]
    v_pk_fma_f32 v[156:157], v[164:165], v[16:17], v[156:157] op_sel_hi:[1,0,1]
    v_pk_fma_f32 v[158:159], v[166:167], v[16:17], v[158:159] op_sel_hi:[1,0,1]
    s_waitcnt vmcnt(3)
    buffer_load_dwordx4 v[60:63], v6, s[48:51], s61 offen offset:0 nt
    s_add_u32 s61, s61, 11264
    v_lshlrev_b32 v160, 16, v44
    v_and_b32 v161, 0xffff0000, v44
    v_lshlrev_b32 v162, 16, v45
    v_and_b32 v163, 0xffff0000, v45
    v_lshlrev_b32 v164, 16, v46
    v_and_b32 v165, 0xffff0000, v46
    v_lshlrev_b32 v166, 16, v47
    v_and_b32 v167, 0xffff0000, v47
    v_pk_fma_f32 v[152:153], v[160:161], v[16:17], v[152:153] op_sel:[0,1,0] op_sel_hi:[1,1,1]
    v_pk_fma_f32 v[154:155], v[162:163], v[16:17], v[154:155] op_sel:[0,1,0] op_sel_hi:[1,1,1]
    v_pk_fma_f32 v[156:157], v[164:165], v[16:17], v[156:157] op_sel:[0,1,0] op_sel_hi:[1,1,1]
    v_pk_fma_f32 v[158:159], v[166:167], v[16:17], v[158:159] op_sel:[0,1,0] op_sel_hi:[1,1,1]
    s_waitcnt vmcnt(3)
    buffer_load_dwordx4 v[64:67], v6, s[48:51], s61 offen offset:0 nt
    s_add_u32 s61, s61, 11264
    v_lshlrev_b32 v160, 16, v48
    v_and_b32 v161, 0xffff0000, v48
    v_lshlrev_b32 v162, 16, v49
    v_and_b32 v163, 0xffff0000, v49
    v_lshlrev_b32 v164, 16, v50
    v_and_b32 v165, 0xffff0000, v50
    v_lshlrev_b32 v166, 16, v51
    v_and_b32 v167, 0xffff0000, v51
    v_pk_fma_f32 v[152:153], v[160:161], v[18:19], v[152:153] op_sel_hi:[1,0,1]
    v_pk_fma_f32 v[154:155], v[162:163], v[18:19], v[154:155] op_sel_hi:[1,0,1]
    v_pk_fma_f32 v[156:157], v[164:165], v[18:19], v[156:157] op_sel_hi:[1,0,1]
    v_pk_fma_f32 v[158:159], v[166:167], v[18:19], v[158:159] op_sel_hi:[1,0,1]
    s_waitcnt vmcnt(3)
    buffer_load_dwordx4 v[68:71], v6, s[48:51], s61 offen offset:0 nt
    s_add_u32 s61, s61, 11264
    v_lshlrev_b32 v160, 16, v52
    v_and_b32 v161, 0xffff0000, v52
    v_lshlrev_b32 v162, 16, v53
    v_and_b32 v163, 0xffff0000, v53
    v_lshlrev_b32 v164, 16, v54
    v_and_b32 v165, 0xffff0000, v54
    v_lshlrev_b32 v166, 16, v55
    v_and_b32 v167, 0xffff0000, v55
    v_pk_fma_f32 v[152:153], v[160:161], v[18:19], v[152:153] op_sel:[0,1,0] op_sel_hi:[1,1,1]
    v_pk_fma_f32 v[154:155], v[162:163], v[18:19], v[154:155] op_sel:[0,1,0] op_sel_hi:[1,1,1]
    v_pk_fma_f32 v[156:157], v[164:165], v[18:19], v[156:157] op_sel:[0,1,0] op_sel_hi:[1,1,1]
    v_pk_fma_f32 v[158:159], v[166:167], v[18:19], v[158:159] op_sel:[0,1,0] op_sel_hi:[1,1,1]
    s_waitcnt vmcnt(3)
    buffer_load_dwordx4 v[72:75], v6, s[48:51], s61 offen offset:0 nt
    s_add_u32 s61, s61, 11264
    v_lshlrev_b32 v160, 16, v56
    v_and_b32 v161, 0xffff0000, v56
    v_lshlrev_b32 v162, 16, v57
    v_and_b32 v163, 0xffff0000, v57
    v_lshlrev_b32 v164, 16, v58
    v_and_b32 v165, 0xffff0000, v58
    v_lshlrev_b32 v166, 16, v59
    v_and_b32 v167, 0xffff0000, v59
    v_pk_fma_f32 v[152:153], v[160:161], v[20:21], v[152:153] op_sel_hi:[1,0,1]
    v_pk_fma_f32 v[154:155], v[162:163], v[20:21], v[154:155] op_sel_hi:[1,0,1]
    v_pk_fma_f32 v[156:157], v[164:165], v[20:21], v[156:157] op_sel_hi:[1,0,1]
    v_pk_fma_f32 v[158:159], v[166:167], v[20:21], v[158:159] op_sel_hi:[1,0,1]
    s_waitcnt vmcnt(3)
    buffer_load_dwordx4 v[76:79], v6, s[48:51], s61 offen offset:0 nt
    s_add_u32 s61, s61, 11264
    v_lshlrev_b32 v160, 16, v60
    v_and_b32 v161, 0xffff0000, v60
    v_lshlrev_b32 v162, 16, v61
    v_and_b32 v163, 0xffff0000, v61
    v_lshlrev_b32 v164, 16, v62
    v_and_b32 v165, 0xffff0000, v62
    v_lshlrev_b32 v166, 16, v63
    v_and_b32 v167, 0xffff0000, v63
    v_pk_fma_f32 v[152:153], v[160:161], v[20:21], v[152:153] op_sel:[0,1,0] op_sel_hi:[1,1,1]
    v_pk_fma_f32 v[154:155], v[162:163], v[20:21], v[154:155] op_sel:[0,1,0] op_sel_hi:[1,1,1]
    v_pk_fma_f32 v[156:157], v[164:165], v[20:21], v[156:157] op_sel:[0,1,0] op_sel_hi:[1,1,1]
    v_pk_fma_f32 v[158:159], v[166:167], v[20:21], v[158:159] op_sel:[0,1,0] op_sel_hi:[1,1,1]
    s_waitcnt vmcnt(3)
    buffer_load_dwordx4 v[80:83], v6, s[48:51], s61 offen offset:0 nt
    s_add_u32 s61, s61, 11264
    v_lshlrev_b32 v160, 16, v64
    v_and_b32 v161, 0xffff0000, v64
    v_lshlrev_b32 v162, 16, v65
    v_and_b32 v163, 0xffff0000, v65
    v_lshlrev_b32 v164, 16, v66
    v_and_b32 v165, 0xffff0000, v66
    v_lshlrev_b32 v166, 16, v67
    v_and_b32 v167, 0xffff0000, v67
    v_pk_fma_f32 v[152:153], v[160:161], v[22:23], v[152:153] op_sel_hi:[1,0,1]
    v_pk_fma_f32 v[154:155], v[162:163], v[22:23], v[154:155] op_sel_hi:[1,0,1]
    v_pk_fma_f32 v[156:157], v[164:165], v[22:23], v[156:157] op_sel_hi:[1,0,1]
    v_pk_fma_f32 v[158:159], v[166:167], v[22:23], v[158:159] op_sel_hi:[1,0,1]
    s_waitcnt vmcnt(3)
    buffer_load_dwordx4 v[84:87], v6, s[48:51], s61 offen offset:0 nt
    s_add_u32 s61, s61, 11264
    v_lshlrev_b32 v160, 16, v68
    v_and_b32 v161, 0xffff0000, v68
    v_lshlrev_b32 v162, 16, v69
    v_and_b32 v163, 0xffff0000, v69
    v_lshlrev_b32 v164, 16, v70
    v_and_b32 v165, 0xffff0000, v70
    v_lshlrev_b32 v166, 16, v71
    v_and_b32 v167, 0xffff0000, v71
    v_pk_fma_f32 v[152:153], v[160:161], v[22:23], v[152:153] op_sel:[0,1,0] op_sel_hi:[1,1,1]
    v_pk_fma_f32 v[154:155], v[162:163], v[22:23], v[154:155] op_sel:[0,1,0] op_sel_hi:[1,1,1]
    v_pk_fma_f32 v[156:157], v[164:165], v[22:23], v[156:157] op_sel:[0,1,0] op_sel_hi:[1,1,1]
    v_pk_fma_f32 v[158:159], v[166:167], v[22:23], v[158:159] op_sel:[0,1,0] op_sel_hi:[1,1,1]
    s_waitcnt vmcnt(3)
    buffer_load_dwordx4 v[88:91], v6, s[48:51], s61 offen offset:0 nt
    s_add_u32 s61, s61, 11264
    v_lshlrev_b32 v160, 16, v72
    v_and_b32 v161, 0xffff0000, v72
    v_lshlrev_b32 v162, 16, v73
    v_and_b32 v163, 0xffff0000, v73
    v_lshlrev_b32 v164, 16, v74
    v_and_b32 v165, 0xffff0000, v74
    v_lshlrev_b32 v166, 16, v75
    v_and_b32 v167, 0xffff0000, v75
    v_pk_fma_f32 v[152:153], v[160:161], v[24:25], v[152:153] op_sel_hi:[1,0,1]
    v_pk_fma_f32 v[154:155], v[162:163], v[24:25], v[154:155] op_sel_hi:[1,0,1]
    v_pk_fma_f32 v[156:157], v[164:165], v[24:25], v[156:157] op_sel_hi:[1,0,1]
    v_pk_fma_f32 v[158:159], v[166:167], v[24:25], v[158:159] op_sel_hi:[1,0,1]
    s_waitcnt vmcnt(3)
    buffer_load_dwordx4 v[92:95], v6, s[48:51], s61 offen offset:0 nt
    s_add_u32 s61, s61, 11264
    v_lshlrev_b32 v160, 16, v76
    v_and_b32 v161, 0xffff0000, v76
    v_lshlrev_b32 v162, 16, v77
    v_and_b32 v163, 0xffff0000, v77
    v_lshlrev_b32 v164, 16, v78
    v_and_b32 v165, 0xffff0000, v78
    v_lshlrev_b32 v166, 16, v79
    v_and_b32 v167, 0xffff0000, v79
    v_pk_fma_f32 v[152:153], v[160:161], v[24:25], v[152:153] op_sel:[0,1,0] op_sel_hi:[1,1,1]
    v_pk_fma_f32 v[154:155], v[162:163], v[24:25], v[154:155] op_sel:[0,1,0] op_sel_hi:[1,1,1]
    v_pk_fma_f32 v[156:157], v[164:165], v[24:25], v[156:157] op_sel:[0,1,0] op_sel_hi:[1,1,1]
    v_pk_fma_f32 v[158:159], v[166:167], v[24:25], v[158:159] op_sel:[0,1,0] op_sel_hi:[1,1,1]
    s_waitcnt vmcnt(3)
    buffer_load_dwordx4 v[96:99], v6, s[48:51], s61 offen offset:0 nt
    v_lshlrev_b32 v160, 16, v80
    v_and_b32 v161, 0xffff0000, v80
    v_lshlrev_b32 v162, 16, v81
    v_and_b32 v163, 0xffff0000, v81
    v_lshlrev_b32 v164, 16, v82
    v_and_b32 v165, 0xffff0000, v82
    v_lshlrev_b32 v166, 16, v83
    v_and_b32 v167, 0xffff0000, v83
    v_pk_fma_f32 v[152:153], v[160:161], v[26:27], v[152:153] op_sel_hi:[1,0,1]
    v_pk_fma_f32 v[154:155], v[162:163], v[26:27], v[154:155] op_sel_hi:[1,0,1]
    v_pk_fma_f32 v[156:157], v[164:165], v[26:27], v[156:157] op_sel_hi:[1,0,1]
    v_pk_fma_f32 v[158:159], v[166:167], v[26:27], v[158:159] op_sel_hi:[1,0,1]
    s_waitcnt vmcnt(3)
    buffer_load_dwordx4 v[100:103], v6, s[48:51], s63 offen offset:0 nt
    v_lshlrev_b32 v160, 16, v84
    v_and_b32 v161, 0xffff0000, v84
    v_lshlrev_b32 v162, 16, v85
    v_and_b32 v163, 0xffff0000, v85
    v_lshlrev_b32 v164, 16, v86
    v_and_b32 v165, 0xffff0000, v86
    v_lshlrev_b32 v166, 16, v87
    v_and_b32 v167, 0xffff0000, v87
    v_pk_fma_f32 v[152:153], v[160:161], v[26:27], v[152:153] op_sel:[0,1,0] op_sel_hi:[1,1,1]
    v_pk_fma_f32 v[154:155], v[162:163], v[26:27], v[154:155] op_sel:[0,1,0] op_sel_hi:[1,1,1]
    v_pk_fma_f32 v[156:157], v[164:165], v[26:27], v[156:157] op_sel:[0,1,0] op_sel_hi:[1,1,1]
    v_pk_fma_f32 v[158:159], v[166:167], v[26:27], v[158:159] op_sel:[0,1,0] op_sel_hi:[1,1,1]
    s_waitcnt vmcnt(3)
    v_lshlrev_b32 v160, 16, v88
    v_and_b32 v161, 0xffff0000, v88
    v_lshlrev_b32 v162, 16, v89
    v_and_b32 v163, 0xffff0000, v89
    v_lshlrev_b32 v164, 16, v90
    v_and_b32 v165, 0xffff0000, v90
    v_lshlrev_b32 v166, 16, v91
    v_and_b32 v167, 0xffff0000, v91
    v_pk_fma_f32 v[152:153], v[160:161], v[28:29], v[152:153] op_sel_hi:[1,0,1]
    v_pk_fma_f32 v[154:155], v[162:163], v[28:29], v[154:155] op_sel_hi:[1,0,1]
    v_pk_fma_f32 v[156:157], v[164:165], v[28:29], v[156:157] op_sel_hi:[1,0,1]
    v_pk_fma_f32 v[158:159], v[166:167], v[28:29], v[158:159] op_sel_hi:[1,0,1]
    s_waitcnt vmcnt(2)
    v_lshlrev_b32 v160, 16, v92
    v_and_b32 v161, 0xffff0000, v92
    v_lshlrev_b32 v162, 16, v93
    v_and_b32 v163, 0xffff0000, v93
    v_lshlrev_b32 v164, 16, v94
    v_and_b32 v165, 0xffff0000, v94
    v_lshlrev_b32 v166, 16, v95
    v_and_b32 v167, 0xffff0000, v95
    v_pk_fma_f32 v[152:153], v[160:161], v[28:29], v[152:153] op_sel:[0,1,0] op_sel_hi:[1,1,1]
    v_pk_fma_f32 v[154:155], v[162:163], v[28:29], v[154:155] op_sel:[0,1,0] op_sel_hi:[1,1,1]
    v_pk_fma_f32 v[156:157], v[164:165], v[28:29], v[156:157] op_sel:[0,1,0] op_sel_hi:[1,1,1]
    v_pk_fma_f32 v[158:159], v[166:167], v[28:29], v[158:159] op_sel:[0,1,0] op_sel_hi:[1,1,1]
    s_waitcnt vmcnt(1)
    v_lshlrev_b32 v160, 16, v96
    v_and_b32 v161, 0xffff0000, v96
    v_lshlrev_b32 v162, 16, v97
    v_and_b32 v163, 0xffff0000, v97
    v_lshlrev_b32 v164, 16, v98
    v_and_b32 v165, 0xffff0000, v98
    v_lshlrev_b32 v166, 16, v99
    v_and_b32 v167, 0xffff0000, v99
    v_pk_fma_f32 v[152:153], v[160:161], v[30:31], v[152:153] op_sel_hi:[1,0,1]
    v_pk_fma_f32 v[154:155], v[162:163], v[30:31], v[154:155] op_sel_hi:[1,0,1]
    v_pk_fma_f32 v[156:157], v[164:165], v[30:31], v[156:157] op_sel_hi:[1,0,1]
    v_pk_fma_f32 v[158:159], v[166:167], v[30:31], v[158:159] op_sel_hi:[1,0,1]
    s_waitcnt vmcnt(0)
    v_lshlrev_b32 v160, 16, v100
    v_and_b32 v161, 0xffff0000, v100
    v_lshlrev_b32 v162, 16, v101
    v_and_b32 v163, 0xffff0000, v101
    v_lshlrev_b32 v164, 16, v102
    v_and_b32 v165, 0xffff0000, v102
    v_lshlrev_b32 v166, 16, v103
    v_and_b32 v167, 0xffff0000, v103
    v_pk_fma_f32 v[152:153], v[160:161], v[30:31], v[152:153] op_sel:[0,1,0] op_sel_hi:[1,1,1]
    v_pk_fma_f32 v[154:155], v[162:163], v[30:31], v[154:155] op_sel:[0,1,0] op_sel_hi:[1,1,1]
    v_pk_fma_f32 v[156:157], v[164:165], v[30:31], v[156:157] op_sel:[0,1,0] op_sel_hi:[1,1,1]
    v_pk_fma_f32 v[158:159], v[166:167], v[30:31], v[158:159] op_sel:[0,1,0] op_sel_hi:[1,1,1]
    s_nop 0
    v_permlane32_swap_b32 v152, v156
    v_permlane32_swap_b32 v153, v157
    v_permlane32_swap_b32 v154, v158
    v_permlane32_swap_b32 v155, v159
    v_add_f32 v152, v152, v156
    v_add_f32 v153, v153, v157
    v_add_f32 v154, v154, v158
    v_add_f32 v155, v155, v159
    s_nop 0
    v_permlane16_swap_b32 v152, v154
    v_permlane16_swap_b32 v153, v155
    v_add_f32 v152, v152, v154
    v_add_f32 v153, v153, v155
    ds_write_b64 v2, v[152:153]
    s_waitcnt lgkmcnt(0)
    s_mov_b64 exec, 1
    ds_add_u32 v3, v4
    s_mov_b64 exec, -1
    s_endpgm
L_ASVC:
    s_setprio 3
    s_lshr_b32 s60, s5, 2
    s_sub_u32 s60, s60, 4
    s_barrier
    s_lshl_b32 s7, s6, 2
    s_add_u32 s7, s7, s60
    s_lshl_b32 s7, s7, 11
    v_lshl_add_u32 v3, v1, 4, s7
    v_add_u32 v5, 0x40000, v3
    v_add_u32 v3, 0x80000, v3
    s_lshl_b32 s7, s6, 5
    s_add_u32 s7, s7, s60
    s_lshl_b32 s7, s7, 8
    s_add_u32 s7, s7, 0x80000
    v_lshrrev_b32 v6, 4, v1
    v_lshlrev_b32 v6, 11, v6
    v_and_b32 v100, 15, v1
    v_lshl_add_u32 v6, v100, 4, v6
    v_add_u32 v6, s7, v6
    s_sleep 8
    v_mov_b32 v90, 0
    s_mov_b32 s80, 200000
    s_mov_b64 exec, 1
    buffer_load_dwordx2 v[94:95], v90, s[40:43], 0 offen sc1
    s_sleep 16
    buffer_load_dwordx2 v[92:93], v90, s[40:43], 0 offen sc1
    s_mov_b64 exec, -1
    s_waitcnt vmcnt(1)
    v_readfirstlane_b32 s94, v94
    v_readfirstlane_b32 s95, v95
    s_cmp_lg_u32 s95, 0
    s_cbranch_scc1 NGD_9
    s_branch NG2_10
NG_8:
    s_mov_b64 exec, 1
    buffer_load_dwordx2 v[92:93], v90, s[40:43], 0 offen sc1
    s_mov_b64 exec, -1
NG2_10:
    s_waitcnt vmcnt(0)
    v_readfirstlane_b32 s94, v92
    v_readfirstlane_b32 s95, v93
    s_cmp_lg_u32 s95, 0
    s_cbranch_scc1 NGD_9
    s_sleep 4
    s_sub_u32 s80, s80, 1
    s_cmp_lg_u32 s80, 0
    s_cbranch_scc1 NG_8
NGD_9:
    v_lshlrev_b32 v7, 5, v1
    v_mov_b32 v114, s94
    v_mov_b32 v115, s95
    v_mov_b32 v118, s94
    v_mov_b32 v119, s95
    v_mov_b32 v122, s94
    v_mov_b32 v123, s95
    v_mov_b32 v126, s94
    v_mov_b32 v127, s95
    v_mov_b32 v100, 0x24044
    s_mov_b32 s80, 1600000
LW_11:
    ds_read_b32 v101, v100
    s_waitcnt lgkmcnt(0)
    v_readfirstlane_b32 s79, v101
    s_cmp_ge_u32 s79, 4
    s_cbranch_scc1 LWD_12
    s_sub_u32 s80, s80, 1
    s_cmp_lg_u32 s80, 0
    s_cbranch_scc1 LW_11
LWD_12:
    ds_read_b128 v[16:19], v7 offset:0
    ds_read_b128 v[20:23], v7 offset:16
    ds_read_b128 v[24:27], v7 offset:2048
    ds_read_b128 v[28:31], v7 offset:2064
    ds_read_b128 v[32:35], v7 offset:4096
    ds_read_b128 v[36:39], v7 offset:4112
    ds_read_b128 v[40:43], v7 offset:6144
    ds_read_b128 v[44:47], v7 offset:6160
    s_waitcnt lgkmcnt(0)
    v_pk_add_f32 v[16:17], v[16:17], v[32:33]
    v_pk_add_f32 v[18:19], v[18:19], v[34:35]
    v_pk_add_f32 v[20:21], v[20:21], v[36:37]
    v_pk_add_f32 v[22:23], v[22:23], v[38:39]
    v_pk_add_f32 v[24:25], v[24:25], v[40:41]
    v_pk_add_f32 v[26:27], v[26:27], v[42:43]
    v_pk_add_f32 v[28:29], v[28:29], v[44:45]
    v_pk_add_f32 v[30:31], v[30:31], v[46:47]
    v_pk_add_f32 v[16:17], v[16:17], v[24:25]
    v_pk_add_f32 v[18:19], v[18:19], v[26:27]
    v_pk_add_f32 v[20:21], v[20:21], v[28:29]
    v_pk_add_f32 v[22:23], v[22:23], v[30:31]
    v_cvt_pk_bf16_f32 v112, v16, v17
    v_cvt_pk_bf16_f32 v113, v18, v19
    v_cvt_pk_bf16_f32 v116, v20, v21
    v_cvt_pk_bf16_f32 v117, v22, v23
    buffer_store_dwordx4 v[112:115], v5, s[36:39], 0 offen offset:0
    buffer_store_dwordx4 v[116:119], v5, s[36:39], 0 offen offset:1024
    v_mov_b32 v100, 0x24018
    v_mov_b32 v101, 1
    s_waitcnt lgkmcnt(0)
    s_mov_b64 exec, 1
    ds_add_u32 v100, v101
    s_mov_b64 exec, -1
    v_mov_b32 v100, 0x24040
    s_mov_b32 s80, 1600000
LW_13:
    ds_read_b32 v101, v100
    s_waitcnt lgkmcnt(0)
    v_readfirstlane_b32 s79, v101
    s_cmp_ge_u32 s79, 4
    s_cbranch_scc1 LWD_14
    s_sub_u32 s80, s80, 1
    s_cmp_lg_u32 s80, 0
    s_cbranch_scc1 LW_13
LWD_14:
    ds_read_b128 v[16:19], v7 offset:8192
    ds_read_b128 v[20:23], v7 offset:8208
    ds_read_b128 v[24:27], v7 offset:10240
    ds_read_b128 v[28:31], v7 offset:10256
    ds_read_b128 v[32:35], v7 offset:12288
    ds_read_b128 v[36:39], v7 offset:12304
    ds_read_b128 v[40:43], v7 offset:14336
    ds_read_b128 v[44:47], v7 offset:14352
    s_waitcnt lgkmcnt(0)
    v_pk_add_f32 v[16:17], v[16:17], v[32:33]
    v_pk_add_f32 v[18:19], v[18:19], v[34:35]
    v_pk_add_f32 v[20:21], v[20:21], v[36:37]
    v_pk_add_f32 v[22:23], v[22:23], v[38:39]
    v_pk_add_f32 v[24:25], v[24:25], v[40:41]
    v_pk_add_f32 v[26:27], v[26:27], v[42:43]
    v_pk_add_f32 v[28:29], v[28:29], v[44:45]
    v_pk_add_f32 v[30:31], v[30:31], v[46:47]
    v_pk_add_f32 v[16:17], v[16:17], v[24:25]
    v_pk_add_f32 v[18:19], v[18:19], v[26:27]
    v_pk_add_f32 v[20:21], v[20:21], v[28:29]
    v_pk_add_f32 v[22:23], v[22:23], v[30:31]
    v_cvt_pk_bf16_f32 v120, v16, v17
    v_cvt_pk_bf16_f32 v121, v18, v19
    v_cvt_pk_bf16_f32 v124, v20, v21
    v_cvt_pk_bf16_f32 v125, v22, v23
    buffer_store_dwordx4 v[120:123], v6, s[36:39], 0 offen offset:0
    buffer_store_dwordx4 v[124:127], v6, s[36:39], 0 offen offset:1024
    v_mov_b32 v110, v5
    v_mov_b32 v111, v6
    s_getreg_b32 s96, hwreg(HW_REG_XCC_ID, 0, 4)
    s_lshl_b32 s7, s4, 5
    s_add_u32 s7, s7, s5
    s_lshl_b32 s7, s7, 4
    s_add_u32 s7, s7, 0xc0000
    v_mov_b32 v100, s7
    v_mov_b32 v102, s96
    v_mov_b32 v103, 0
    v_mov_b32 v104, s94
    v_mov_b32 v105, s95
    s_mov_b64 exec, 1
    buffer_store_dwordx4 v[102:105], v100, s[36:39], 0 offen
    s_mov_b64 exec, -1
    s_sleep 16
    buffer_load_dwordx4 v[32:35], v3, s[36:39], 0 offen offset:0 sc1
    buffer_load_dwordx4 v[36:39], v3, s[36:39], 0 offen offset:1024 sc1
    s_mov_b32 s80, 200000
PS_15:
    s_waitcnt vmcnt(0)
    s_mov_b32 s78, 0
    v_cmp_ne_u64 vcc, s[94:95], v[34:35]
    s_cbranch_vccz PSS_17
    buffer_load_dwordx4 v[32:35], v3, s[36:39], 0 offen offset:0 sc1
    s_mov_b32 s78, 1
PSS_17:
    v_cmp_ne_u64 vcc, s[94:95], v[38:39]
    s_cbranch_vccz PSS_18
    buffer_load_dwordx4 v[36:39], v3, s[36:39], 0 offen offset:1024 sc1
    s_mov_b32 s78, 1
PSS_18:
    s_cmp_eq_u32 s78, 0
    s_cbranch_scc1 PSD_16
    s_sleep 8
    s_cmp_lg_u32 s80, 199984
    s_cbranch_scc1 PSL_19
    buffer_store_dwordx4 v[112:115], v110, s[36:39], 0 offen offset:0 sc1
    buffer_store_dwordx4 v[116:119], v110, s[36:39], 0 offen offset:1024 sc1
    buffer_store_dwordx4 v[120:123], v111, s[36:39], 0 offen offset:0 sc1
    buffer_store_dwordx4 v[124:127], v111, s[36:39], 0 offen offset:1024 sc1
PSL_19:
    s_sub_u32 s80, s80, 1
    s_cmp_lg_u32 s80, 0
    s_cbranch_scc1 PS_15
    s_waitcnt vmcnt(0)
PSD_16:
    v_lshlrev_b32 v16, 16, v32
    v_and_b32 v17, 0xffff0000, v32
    v_lshlrev_b32 v18, 16, v33
    v_and_b32 v19, 0xffff0000, v33
    v_lshlrev_b32 v20, 16, v36
    v_and_b32 v21, 0xffff0000, v36
    v_lshlrev_b32 v22, 16, v37
    v_and_b32 v23, 0xffff0000, v37
    v_mov_b32 v24, v16
    v_mov_b32 v25, v17
    v_mov_b32 v26, v18
    v_mov_b32 v27, v19
    v_mov_b32 v28, v20
    v_mov_b32 v29, v21
    v_mov_b32 v30, v22
    v_mov_b32 v31, v23
    v_permlane32_swap_b32 v16, v24
    v_permlane32_swap_b32 v17, v25
    v_permlane32_swap_b32 v18, v26
    v_permlane32_swap_b32 v19, v27
    v_permlane32_swap_b32 v20, v28
    v_permlane32_swap_b32 v21, v29
    v_permlane32_swap_b32 v22, v30
    v_permlane32_swap_b32 v23, v31
    v_add_f32 v16, v16, v24
    v_add_f32 v17, v17, v25
    v_add_f32 v18, v18, v26
    v_add_f32 v19, v19, v27
    v_add_f32 v20, v20, v28
    v_add_f32 v21, v21, v29
    v_add_f32 v22, v22, v30
    v_add_f32 v23, v23, v31
    v_mov_b32 v24, v16
    v_mov_b32 v25, v17
    v_mov_b32 v26, v18
    v_mov_b32 v27, v19
    v_mov_b32 v28, v20
    v_mov_b32 v29, v21
    v_mov_b32 v30, v22
    v_mov_b32 v31, v23
    v_permlane16_swap_b32 v16, v24
    v_permlane16_swap_b32 v17, v25
    v_permlane16_swap_b32 v18, v26
    v_permlane16_swap_b32 v19, v27
    v_permlane16_swap_b32 v20, v28
    v_permlane16_swap_b32 v21, v29
    v_permlane16_swap_b32 v22, v30
    v_permlane16_swap_b32 v23, v31
    v_add_f32 v16, v16, v24
    v_add_f32 v17, v17, v25
    v_add_f32 v18, v18, v26
    v_add_f32 v19, v19, v27
    v_add_f32 v20, v20, v28
    v_add_f32 v21, v21, v29
    v_add_f32 v22, v22, v30
    v_add_f32 v23, v23, v31
    v_cvt_pk_bf16_f32 v8, v16, v17
    v_cvt_pk_bf16_f32 v9, v18, v19
    v_cvt_pk_bf16_f32 v10, v20, v21
    v_cvt_pk_bf16_f32 v11, v22, v23
    v_and_b32 v100, 15, v1
    v_lshlrev_b32 v100, 4, v100
    v_add_u32 v100, 0x24100, v100
    ds_write_b128 v100, v[8:11]
L_ACUT:
    v_mov_b32 v100, 0x24004
    v_mov_b32 v101, 1
    s_waitcnt lgkmcnt(0)
    s_mov_b64 exec, 1
    ds_add_u32 v100, v101
    s_mov_b64 exec, -1
    v_mov_b32 v100, 0x24008
    s_mov_b32 s80, 1600000
LW_20:
    ds_read_b32 v101, v100
    s_waitcnt lgkmcnt(0)
    v_readfirstlane_b32 s79, v101
    s_cmp_ge_u32 s79, 11
    s_cbranch_scc1 LWD_21
    s_sleep 8
    s_sub_u32 s80, s80, 1
    s_cmp_lg_u32 s80, 0
    s_cbranch_scc1 LW_20
LWD_21:
    v_and_b32 v100, 31, v1
    s_lshl_b32 s7, s4, 9
    s_add_u32 s7, s7, 0xc0000
    v_lshl_add_u32 v100, v100, 4, s7
    buffer_load_dwordx4 v[32:35], v100, s[36:39], 0 offen sc1
    s_waitcnt vmcnt(0)
    v_cmp_ne_u64 vcc, s[94:95], v[34:35]
    v_cmp_ne_u32 s[86:87], s96, v32
    s_or_b32 s97, vcc_lo, s86
    s_and_b32 s97, s97, 0xffff00ff
    s_cbranch_scc0 AF_22
    buffer_store_dwordx4 v[112:115], v110, s[36:39], 0 offen offset:0 sc1
    buffer_store_dwordx4 v[116:119], v110, s[36:39], 0 offen offset:1024 sc1
    buffer_store_dwordx4 v[120:123], v111, s[36:39], 0 offen offset:0 sc1
    buffer_store_dwordx4 v[124:127], v111, s[36:39], 0 offen offset:1024 sc1
AF_22:
    v_mov_b32 v100, 0x24200
    ds_read_b128 v[8:11], v100 offset:0
    ds_read_b128 v[12:15], v100 offset:16
    ds_read_b128 v[16:19], v100 offset:32
    ds_read_b128 v[20:23], v100 offset:48
    ds_read_b128 v[24:27], v100 offset:64
    ds_read_b128 v[28:31], v100 offset:80
    s_waitcnt lgkmcnt(0)
    v_max3_f32 v100, v8, v10, v12
    v_max3_f32 v100, v100, v14, v16
    v_max3_f32 v100, v100, v18, v20
    v_max3_f32 v100, v100, v22, v24
    v_max3_f32 v100, v100, v26, v28
    v_sub_f32 v8, v8, v100
    v_sub_f32 v10, v10, v100
    v_sub_f32 v12, v12, v100
    v_sub_f32 v14, v14, v100
    v_sub_f32 v16, v16, v100
    v_sub_f32 v18, v18, v100
    v_sub_f32 v20, v20, v100
    v_sub_f32 v22, v22, v100
    v_sub_f32 v24, v24, v100
    v_sub_f32 v26, v26, v100
    v_sub_f32 v28, v28, v100
    v_exp_f32 v8, v8
    v_exp_f32 v10, v10
    v_exp_f32 v12, v12
    v_exp_f32 v14, v14
    v_exp_f32 v16, v16
    v_exp_f32 v18, v18
    v_exp_f32 v20, v20
    v_exp_f32 v22, v22
    v_exp_f32 v24, v24
    v_exp_f32 v26, v26
    v_exp_f32 v28, v28
    v_mul_f32 v101, v8, v9
    v_fmac_f32 v101, v10, v11
    v_fmac_f32 v101, v12, v13
    v_fmac_f32 v101, v14, v15
    v_fmac_f32 v101, v16, v17
    v_fmac_f32 v101, v18, v19
    v_fmac_f32 v101, v20, v21
    v_fmac_f32 v101, v22, v23
    v_fmac_f32 v101, v24, v25
    v_fmac_f32 v101, v26, v27
    v_fmac_f32 v101, v28, v29
    v_rcp_f32 v101, v101
    s_nop 0
    v_mul_f32 v8, v8, v101
    v_mul_f32 v10, v10, v101
    v_mul_f32 v12, v12, v101
    v_mul_f32 v14, v14, v101
    v_mul_f32 v16, v16, v101
    v_mul_f32 v18, v18, v101
    v_mul_f32 v20, v20, v101
    v_mul_f32 v22, v22, v101
    v_mul_f32 v24, v24, v101
    v_mul_f32 v26, v26, v101
    v_mul_f32 v28, v28, v101
    v_and_b32 v100, 15, v1
    v_bfe_u32 v101, v1, 4, 1
    v_lshlrev_b32 v3, 5, v100
    v_lshl_add_u32 v3, v101, 4, v3
    v_add_u32 v3, 0x10000, v3
    s_lshl_b32 s7, s6, 3
    s_add_u32 s7, s7, s60
    s_lshl_b32 s7, s7, 8
    s_add_u32 s7, s7, 0xd0000
    v_lshlrev_b32 v2, 4, v100
    v_lshl_add_u32 v2, v101, 10, v2
    v_add_u32 v2, s7, v2
    v_mov_b32 v6, s94
    v_mov_b32 v7, s95
    v_mov_b32 v100, 0x2400c
    s_mov_b32 s80, 1600000
LW_23:
    ds_read_b32 v101, v100
    s_waitcnt lgkmcnt(0)
    v_readfirstlane_b32 s79, v101
    s_cmp_ge_u32 s79, 11
    s_cbranch_scc1 LWD_24
    s_sub_u32 s80, s80, 1
    s_cmp_lg_u32 s80, 0
    s_cbranch_scc1 LW_23
LWD_24:
    ds_read_b128 v[40:43], v3 offset:0
    ds_read_b128 v[44:47], v3 offset:512
    ds_read_b128 v[48:51], v3 offset:1024
    ds_read_b128 v[52:55], v3 offset:1536
    ds_read_b128 v[56:59], v3 offset:2048
    ds_read_b128 v[60:63], v3 offset:2560
    ds_read_b128 v[64:67], v3 offset:3072
    ds_read_b128 v[68:71], v3 offset:3584
    ds_read_b128 v[72:75], v3 offset:4096
    ds_read_b128 v[76:79], v3 offset:4608
    ds_read_b128 v[80:83], v3 offset:5120
    s_waitcnt lgkmcnt(10)
    v_pk_mul_f32 v[32:33], v[40:41], v[8:9] op_sel_hi:[1,0]
    v_pk_mul_f32 v[34:35], v[42:43], v[8:9] op_sel_hi:[1,0]
    s_waitcnt lgkmcnt(9)
    v_pk_mul_f32 v[36:37], v[44:45], v[10:11] op_sel_hi:[1,0]
    v_pk_mul_f32 v[38:39], v[46:47], v[10:11] op_sel_hi:[1,0]
    s_waitcnt lgkmcnt(8)
    v_pk_fma_f32 v[32:33], v[48:49], v[12:13], v[32:33] op_sel_hi:[1,0,1]
    v_pk_fma_f32 v[34:35], v[50:51], v[12:13], v[34:35] op_sel_hi:[1,0,1]
    s_waitcnt lgkmcnt(7)
    v_pk_fma_f32 v[36:37], v[52:53], v[14:15], v[36:37] op_sel_hi:[1,0,1]
    v_pk_fma_f32 v[38:39], v[54:55], v[14:15], v[38:39] op_sel_hi:[1,0,1]
    s_waitcnt lgkmcnt(6)
    v_pk_fma_f32 v[32:33], v[56:57], v[16:17], v[32:33] op_sel_hi:[1,0,1]
    v_pk_fma_f32 v[34:35], v[58:59], v[16:17], v[34:35] op_sel_hi:[1,0,1]
    s_waitcnt lgkmcnt(5)
    v_pk_fma_f32 v[36:37], v[60:61], v[18:19], v[36:37] op_sel_hi:[1,0,1]
    v_pk_fma_f32 v[38:39], v[62:63], v[18:19], v[38:39] op_sel_hi:[1,0,1]
    s_waitcnt lgkmcnt(4)
    v_pk_fma_f32 v[32:33], v[64:65], v[20:21], v[32:33] op_sel_hi:[1,0,1]
    v_pk_fma_f32 v[34:35], v[66:67], v[20:21], v[34:35] op_sel_hi:[1,0,1]
    s_waitcnt lgkmcnt(3)
    v_pk_fma_f32 v[36:37], v[68:69], v[22:23], v[36:37] op_sel_hi:[1,0,1]
    v_pk_fma_f32 v[38:39], v[70:71], v[22:23], v[38:39] op_sel_hi:[1,0,1]
    s_waitcnt lgkmcnt(2)
    v_pk_fma_f32 v[32:33], v[72:73], v[24:25], v[32:33] op_sel_hi:[1,0,1]
    v_pk_fma_f32 v[34:35], v[74:75], v[24:25], v[34:35] op_sel_hi:[1,0,1]
    s_waitcnt lgkmcnt(1)
    v_pk_fma_f32 v[36:37], v[76:77], v[26:27], v[36:37] op_sel_hi:[1,0,1]
    v_pk_fma_f32 v[38:39], v[78:79], v[26:27], v[38:39] op_sel_hi:[1,0,1]
    s_waitcnt lgkmcnt(0)
    v_pk_fma_f32 v[32:33], v[80:81], v[28:29], v[32:33] op_sel_hi:[1,0,1]
    v_pk_fma_f32 v[34:35], v[82:83], v[28:29], v[34:35] op_sel_hi:[1,0,1]
    v_pk_add_f32 v[32:33], v[32:33], v[36:37]
    v_pk_add_f32 v[34:35], v[34:35], v[38:39]
    v_cvt_pk_bf16_f32 v4, v32, v33
    v_cvt_pk_bf16_f32 v5, v34, v35
    s_mov_b64 exec, 0xffffffff
    buffer_store_dwordx4 v[4:7], v2, s[36:39], 0 offen
    s_cmp_eq_u32 s97, 0
    s_cbranch_scc1 AF_25
    buffer_store_dwordx4 v[4:7], v2, s[36:39], 0 offen sc1
AF_25:
    s_mov_b64 exec, -1
    s_endpgm
L_W:
    s_mov_b32 s92, 0x05040100
    s_mov_b32 s93, 0x07060302
    s_cmp_ge_u32 s3, 8
    s_cbranch_scc1 L_W2
    s_cmp_ge_u32 s3, 4
    s_cbranch_scc1 L_W1
    s_barrier
    s_cmp_ge_u32 s5, 4
    s_cbranch_scc1 L_PF
    v_mov_b32 v160, 0x24048
    s_mov_b32 s80, 1600000
LW_26:
    ds_read_b32 v161, v160
    s_waitcnt lgkmcnt(0)
    v_readfirstlane_b32 s79, v161
    s_cmp_ge_u32 s79, 4
    s_cbranch_scc1 LWD_27
    s_sleep 4
    s_sub_u32 s80, s80, 1
    s_cmp_lg_u32 s80, 0
    s_cbranch_scc1 LW_26
LWD_27:
    s_branch L_U1
L_PF:
    s_mov_b32 s44, s20
    s_and_b32 s45, s21, 0xffff
    s_mov_b32 s46, 0x1000000
    s_mov_b32 s47, 0x20000
    s_lshl_b32 s7, s4, 2
    s_add_u32 s7, s7, s5
    s_sub_u32 s7, s7, 4
    s_lshl_b32 s7, s7, 19
    s_lshl_b32 s60, s3, 10
    s_add_u32 s60, s60, s7
    s_add_u32 s60, s60, 196608
    s_add_u32 s61, s60, 0x40000
    v_lshlrev_b32 v2, 4, v1
    v_mov_b32 v160, 0x24048
    s_mov_b32 s80, 1600000
LW_28:
    ds_read_b32 v161, v160
    s_waitcnt lgkmcnt(0)
    v_readfirstlane_b32 s79, v161
    s_cmp_ge_u32 s79, 4
    s_cbranch_scc1 LWD_29
    s_sleep 4
    s_sub_u32 s80, s80, 1
    s_cmp_lg_u32 s80, 0
    s_cbranch_scc1 LW_28
LWD_29:
    s_mov_b32 s62, 16
PF_30:
    s_waitcnt vmcnt(7)
    buffer_load_dwordx4 v[4:7], v2, s[44:47], s60 offen
    s_add_u32 s60, s60, 4096
    s_waitcnt vmcnt(7)
    buffer_load_dwordx4 v[4:7], v2, s[44:47], s61 offen
    s_add_u32 s61, s61, 4096
    s_sub_u32 s62, s62, 1
    s_cmp_lg_u32 s62, 0
    s_cbranch_scc1 PF_30
    v_mov_b32 v160, 0x2405c
    v_mov_b32 v161, 1
    s_waitcnt lgkmcnt(0)
    s_mov_b64 exec, 1
    ds_add_u32 v160, v161
    s_mov_b64 exec, -1
    s_waitcnt vmcnt(0)
    s_branch L_END
L_W1:
    s_setprio 3
    s_cmp_lg_u32 s3, 4
    s_cbranch_scc1 W4_31
    s_cmp_lg_u32 s2, 0
    s_cbranch_scc1 NM_32
    s_memrealtime s[94:95]
    v_mov_b32 v160, 0
    s_waitcnt lgkmcnt(0)
    s_or_b32 s95, s95, 0x80000000
    v_mov_b32 v162, s94
    v_mov_b32 v163, s95
    s_mov_b64 exec, 1
    buffer_store_dwordx2 v[162:163], v160, s[40:43], 0 offen sc1
    s_mov_b64 exec, -1
NM_32:
W4_31:
    s_barrier
    s_cmp_lg_u32 s3, 4
    s_cbranch_scc1 W4_33
    s_sleep 8
    v_mov_b32 v152, 0
    s_mov_b32 s80, 200000
    s_mov_b64 exec, 1
    buffer_load_dwordx2 v[156:157], v152, s[40:43], 0 offen sc1
    s_sleep 16
    buffer_load_dwordx2 v[154:155], v152, s[40:43], 0 offen sc1
    s_mov_b64 exec, -1
    s_waitcnt vmcnt(1)
    v_readfirstlane_b32 s94, v156
    v_readfirstlane_b32 s95, v157
    s_cmp_lg_u32 s95, 0
    s_cbranch_scc1 NGD_35
    s_branch NG2_36
NG_34:
    s_mov_b64 exec, 1
    buffer_load_dwordx2 v[154:155], v152, s[40:43], 0 offen sc1
    s_mov_b64 exec, -1
NG2_36:
    s_waitcnt vmcnt(0)
    v_readfirstlane_b32 s94, v154
    v_readfirstlane_b32 s95, v155
    s_cmp_lg_u32 s95, 0
    s_cbranch_scc1 NGD_35
    s_sleep 4
    s_sub_u32 s80, s80, 1
    s_cmp_lg_u32 s80, 0
    s_cbranch_scc1 NG_34
NGD_35:
    v_mov_b32 v160, 0x24050
    v_mov_b32 v162, s94
    v_mov_b32 v163, s95
    ds_write_b64 v160, v[162:163]
    v_mov_b32 v160, 0x2404c
    v_mov_b32 v161, 1
    s_waitcnt lgkmcnt(0)
    s_mov_b64 exec, 1
    ds_add_u32 v160, v161
    s_mov_b64 exec, -1
    s_getreg_b32 s96, hwreg(HW_REG_XCC_ID, 0, 4)
    s_lshl_b32 s7, s4, 5
    s_add_u32 s7, s7, s5
    s_lshl_b32 s7, s7, 4
    s_add_u32 s7, s7, 0xc0000
    v_mov_b32 v160, s7
    v_mov_b32 v162, s96
    v_mov_b32 v163, 0
    v_mov_b32 v164, s94
    v_mov_b32 v165, s95
    s_mov_b64 exec, 1
    buffer_store_dwordx4 v[162:165], v160, s[36:39], 0 offen
    s_mov_b64 exec, -1
W4_33:
    s_sub_u32 s62, s3, 4
    s_lshl_b32 s61, s4, 2
    s_add_u32 s61, s61, s62
    v_lshrrev_b32 v162, 4, v1
    v_and_b32 v161, 15, v1
    v_lshlrev_b32 v2, 16, v162
    v_lshl_add_u32 v2, v161, 4, v2
    s_lshl_b32 s7, s61, 3
    s_add_u32 s7, s7, s5
    s_lshl_b32 s7, s7, 8
    s_add_u32 s7, s7, 0x0
    v_add_u32 v2, s7, v2
    v_lshlrev_b32 v3, 6, v161
    v_lshl_add_u32 v3, v162, 4, v3
    s_lshl_b32 s7, s61, 13
    s_add_u32 s7, s7, 0x40000
    v_add_u32 v3, s7, v3
    v_xor_b32 v5, v162, v161
    v_lshlrev_b32 v5, 4, v5
    v_lshl_add_u32 v4, v161, 12, v5
    s_lshl_b32 s7, s62, 8
    v_add_u32 v4, s7, v4
    v_mov_b32 v160, 0x2404c
    s_mov_b32 s80, 1600000
LW_37:
    ds_read_b32 v161, v160
    s_waitcnt lgkmcnt(0)
    v_readfirstlane_b32 s79, v161
    s_cmp_ge_u32 s79, 1
    s_cbranch_scc1 LWD_38
    s_sleep 2
    s_sub_u32 s80, s80, 1
    s_cmp_lg_u32 s80, 0
    s_cbranch_scc1 LW_37
LWD_38:
    v_mov_b32 v160, 0x24050
    ds_read_b64 v[162:163], v160
    s_waitcnt lgkmcnt(0)
    v_readfirstlane_b32 s94, v162
    v_readfirstlane_b32 s95, v163
    s_sleep 4
    s_mov_b32 s63, 4096
    buffer_load_dwordx4 v[72:75], v3, s[36:39], 0 offen offset:0 sc1
    buffer_load_dwordx4 v[76:79], v3, s[36:39], 0 offen offset:1024 sc1
    buffer_load_dwordx4 v[80:83], v3, s[36:39], 0 offen offset:2048 sc1
    buffer_load_dwordx4 v[84:87], v3, s[36:39], 0 offen offset:3072 sc1
    buffer_load_dwordx4 v[88:91], v3, s[36:39], s63 offen offset:0 sc1
    buffer_load_dwordx4 v[92:95], v3, s[36:39], s63 offen offset:1024 sc1
    buffer_load_dwordx4 v[96:99], v3, s[36:39], s63 offen offset:2048 sc1
    buffer_load_dwordx4 v[100:103], v3, s[36:39], s63 offen offset:3072 sc1
    v_mov_b32 v160, 0x24014
    s_mov_b32 s80, 1600000
LW_41:
    ds_read_b32 v161, v160
    s_waitcnt lgkmcnt(0)
    v_readfirstlane_b32 s79, v161
    s_cmp_ge_u32 s79, 4
    s_cbranch_scc1 LWD_42
    s_sleep 1
    s_sub_u32 s80, s80, 1
    s_cmp_lg_u32 s80, 0
    s_cbranch_scc1 LW_41
LWD_42:
    v_xor_b32 v160, 0x0, v4
    v_xor_b32 v161, 0x40, v4
    v_xor_b32 v162, 0x80, v4
    v_xor_b32 v163, 0xc0, v4
    ds_read_b128 v[8:11], v160 offset:0
    ds_read_b128 v[12:15], v161 offset:0
    ds_read_b128 v[16:19], v162 offset:0
    ds_read_b128 v[20:23], v163 offset:0
    ds_read_b128 v[24:27], v160 offset:1024
    ds_read_b128 v[28:31], v161 offset:1024
    ds_read_b128 v[32:35], v162 offset:1024
    ds_read_b128 v[36:39], v163 offset:1024
    ds_read_b128 v[40:43], v160 offset:2048
    ds_read_b128 v[44:47], v161 offset:2048
    ds_read_b128 v[48:51], v162 offset:2048
    ds_read_b128 v[52:55], v163 offset:2048
    ds_read_b128 v[56:59], v160 offset:3072
    ds_read_b128 v[60:63], v161 offset:3072
    ds_read_b128 v[64:67], v162 offset:3072
    ds_read_b128 v[68:71], v163 offset:3072
    s_mov_b32 s80, 200000
PS_39:
    s_waitcnt vmcnt(0)
    s_mov_b32 s78, 0
    v_cmp_ne_u64 vcc, s[94:95], v[74:75]
    s_cbranch_vccz PSS_43
    buffer_load_dwordx4 v[72:75], v3, s[36:39], 0 offen offset:0 sc1
    s_mov_b32 s78, 1
PSS_43:
    v_cmp_ne_u64 vcc, s[94:95], v[78:79]
    s_cbranch_vccz PSS_44
    buffer_load_dwordx4 v[76:79], v3, s[36:39], 0 offen offset:1024 sc1
    s_mov_b32 s78, 1
PSS_44:
    v_cmp_ne_u64 vcc, s[94:95], v[82:83]
    s_cbranch_vccz PSS_45
    buffer_load_dwordx4 v[80:83], v3, s[36:39], 0 offen offset:2048 sc1
    s_mov_b32 s78, 1
PSS_45:
    v_cmp_ne_u64 vcc, s[94:95], v[86:87]
    s_cbranch_vccz PSS_46
    buffer_load_dwordx4 v[84:87], v3, s[36:39], 0 offen offset:3072 sc1
    s_mov_b32 s78, 1
PSS_46:
    v_cmp_ne_u64 vcc, s[94:95], v[90:91]
    s_cbranch_vccz PSS_47
    buffer_load_dwordx4 v[88:91], v3, s[36:39], s63 offen offset:0 sc1
    s_mov_b32 s78, 1
PSS_47:
    v_cmp_ne_u64 vcc, s[94:95], v[94:95]
    s_cbranch_vccz PSS_48
    buffer_load_dwordx4 v[92:95], v3, s[36:39], s63 offen offset:1024 sc1
    s_mov_b32 s78, 1
PSS_48:
    v_cmp_ne_u64 vcc, s[94:95], v[98:99]
    s_cbranch_vccz PSS_49
    buffer_load_dwordx4 v[96:99], v3, s[36:39], s63 offen offset:2048 sc1
    s_mov_b32 s78, 1
PSS_49:
    v_cmp_ne_u64 vcc, s[94:95], v[102:103]
    s_cbranch_vccz PSS_50
    buffer_load_dwordx4 v[100:103], v3, s[36:39], s63 offen offset:3072 sc1
    s_mov_b32 s78, 1
PSS_50:
    s_cmp_eq_u32 s78, 0
    s_cbranch_scc1 PSD_40
    s_sub_u32 s80, s80, 1
    s_cmp_lg_u32 s80, 0
    s_cbranch_scc1 PS_39
    s_waitcnt vmcnt(0)
PSD_40:
    v_lshlrev_b32 v104, 16, v72
    v_and_b32 v105, 0xffff0000, v72
    v_lshlrev_b32 v106, 16, v73
    v_and_b32 v107, 0xffff0000, v73
    v_lshlrev_b32 v108, 16, v76
    v_and_b32 v109, 0xffff0000, v76
    v_lshlrev_b32 v110, 16, v77
    v_and_b32 v111, 0xffff0000, v77
    v_lshlrev_b32 v120, 16, v80
    v_and_b32 v121, 0xffff0000, v80
    v_lshlrev_b32 v122, 16, v81
    v_and_b32 v123, 0xffff0000, v81
    v_lshlrev_b32 v124, 16, v84
    v_and_b32 v125, 0xffff0000, v84
    v_lshlrev_b32 v126, 16, v85
    v_and_b32 v127, 0xffff0000, v85
    v_pk_add_f32 v[104:105], v[104:105], v[120:121]
    v_pk_add_f32 v[106:107], v[106:107], v[122:123]
    v_pk_add_f32 v[108:109], v[108:109], v[124:125]
    v_pk_add_f32 v[110:111], v[110:111], v[126:127]
    v_lshlrev_b32 v112, 16, v88
    v_and_b32 v113, 0xffff0000, v88
    v_lshlrev_b32 v114, 16, v89
    v_and_b32 v115, 0xffff0000, v89
    v_lshlrev_b32 v116, 16, v92
    v_and_b32 v117, 0xffff0000, v92
    v_lshlrev_b32 v118, 16, v93
    v_and_b32 v119, 0xffff0000, v93
    v_pk_add_f32 v[104:105], v[104:105], v[112:113]
    v_pk_add_f32 v[106:107], v[106:107], v[114:115]
    v_pk_add_f32 v[108:109], v[108:109], v[116:117]
    v_pk_add_f32 v[110:111], v[110:111], v[118:119]
    v_lshlrev_b32 v120, 16, v96
    v_and_b32 v121, 0xffff0000, v96
    v_lshlrev_b32 v122, 16, v97
    v_and_b32 v123, 0xffff0000, v97
    v_lshlrev_b32 v124, 16, v100
    v_and_b32 v125, 0xffff0000, v100
    v_lshlrev_b32 v126, 16, v101
    v_and_b32 v127, 0xffff0000, v101
    v_pk_add_f32 v[104:105], v[104:105], v[120:121]
    v_pk_add_f32 v[106:107], v[106:107], v[122:123]
    v_pk_add_f32 v[108:109], v[108:109], v[124:125]
    v_pk_add_f32 v[110:111], v[110:111], v[126:127]
    v_cvt_pk_bf16_f32 v136, v104, v105
    v_cvt_pk_bf16_f32 v137, v106, v107
    v_cvt_pk_bf16_f32 v138, v108, v109
    v_cvt_pk_bf16_f32 v139, v110, v111
    v_mov_b32_dpp v140, v136 quad_perm:[1,2,3,0] row_mask:0xf bank_mask:0xf
    v_mov_b32_dpp v141, v137 quad_perm:[1,2,3,0] row_mask:0xf bank_mask:0xf
    v_mov_b32_dpp v142, v138 quad_perm:[1,2,3,0] row_mask:0xf bank_mask:0xf
    v_mov_b32_dpp v143, v139 quad_perm:[1,2,3,0] row_mask:0xf bank_mask:0xf
    v_mov_b32_dpp v144, v136 quad_perm:[2,3,0,1] row_mask:0xf bank_mask:0xf
    v_mov_b32_dpp v145, v137 quad_perm:[2,3,0,1] row_mask:0xf bank_mask:0xf
    v_mov_b32_dpp v146, v138 quad_perm:[2,3,0,1] row_mask:0xf bank_mask:0xf
    v_mov_b32_dpp v147, v139 quad_perm:[2,3,0,1] row_mask:0xf bank_mask:0xf
    v_mov_b32_dpp v148, v136 quad_perm:[3,0,1,2] row_mask:0xf bank_mask:0xf
    v_mov_b32_dpp v149, v137 quad_perm:[3,0,1,2] row_mask:0xf bank_mask:0xf
    v_mov_b32_dpp v150, v138 quad_perm:[3,0,1,2] row_mask:0xf bank_mask:0xf
    v_mov_b32_dpp v151, v139 quad_perm:[3,0,1,2] row_mask:0xf bank_mask:0xf
    v_mov_b32 v74, s94
    v_mov_b32 v75, s95
    s_waitcnt lgkmcnt(0)
    v_mfma_f32_16x16x32_bf16 v[104:107], v[136:139], v[8:11], 0
    v_mfma_f32_16x16x32_bf16 v[108:111], v[136:139], v[28:31], 0
    v_mfma_f32_16x16x32_bf16 v[112:115], v[136:139], v[48:51], 0
    v_mfma_f32_16x16x32_bf16 v[116:119], v[136:139], v[68:71], 0
    v_mfma_f32_16x16x32_bf16 v[104:107], v[140:143], v[12:15], v[104:107]
    v_mfma_f32_16x16x32_bf16 v[108:111], v[140:143], v[32:35], v[108:111]
    v_mfma_f32_16x16x32_bf16 v[112:115], v[140:143], v[52:55], v[112:115]
    v_mfma_f32_16x16x32_bf16 v[116:119], v[140:143], v[56:59], v[116:119]
    v_mfma_f32_16x16x32_bf16 v[104:107], v[144:147], v[16:19], v[104:107]
    v_mfma_f32_16x16x32_bf16 v[108:111], v[144:147], v[36:39], v[108:111]
    v_mfma_f32_16x16x32_bf16 v[112:115], v[144:147], v[40:43], v[112:115]
    v_mfma_f32_16x16x32_bf16 v[116:119], v[144:147], v[60:63], v[116:119]
    v_mfma_f32_16x16x32_bf16 v[104:107], v[148:151], v[20:23], v[104:107]
    v_mfma_f32_16x16x32_bf16 v[108:111], v[148:151], v[24:27], v[108:111]
    v_mfma_f32_16x16x32_bf16 v[112:115], v[148:151], v[44:47], v[112:115]
    v_mfma_f32_16x16x32_bf16 v[116:119], v[148:151], v[64:67], v[116:119]
    s_nop 5
    v_cvt_pk_bf16_f32 v72, v104, v109
    s_nop 0
    v_cvt_pk_bf16_f32 v73, v114, v119
    buffer_store_dwordx4 v[72:75], v2, s[36:39], 0 offen sc1
    v_mov_b32 v160, 0x24048
    v_mov_b32 v161, 1
    s_waitcnt lgkmcnt(0)
    s_mov_b64 exec, 1
    ds_add_u32 v160, v161
    s_mov_b64 exec, -1
    s_setprio 0
    s_cmp_ge_u32 s5, 4
    s_cbranch_scc1 L_END
L_U1:
    s_mov_b32 s48, s26
    s_and_b32 s49, s27, 0xffff
    s_mov_b32 s50, 0x400000
    s_mov_b32 s51, 0x20000
    v_lshrrev_b32 v162, 4, v1
    v_lshlrev_b32 v2, 16, v162
    v_and_b32 v160, 15, v1
    v_lshl_add_u32 v2, v160, 4, v2
    s_lshl_b32 s7, s6, 8
    v_add_u32 v2, s7, v2
    s_lshl_b32 s70, s3, 19
    s_waitcnt vmcnt(2)
    buffer_load_dwordx4 v[8:11], v2, s[48:51], s70 offen nt
    s_add_u32 s70, s70, 8192
    s_waitcnt vmcnt(2)
    buffer_load_dwordx4 v[12:15], v2, s[48:51], s70 offen nt
    s_add_u32 s70, s70, 8192
    s_waitcnt vmcnt(2)
    buffer_load_dwordx4 v[16:19], v2, s[48:51], s70 offen nt
    s_add_u32 s70, s70, 8192
    s_waitcnt vmcnt(2)
    buffer_load_dwordx4 v[20:23], v2, s[48:51], s70 offen nt
    s_add_u32 s70, s70, 8192
    s_waitcnt vmcnt(2)
    buffer_load_dwordx4 v[24:27], v2, s[48:51], s70 offen nt
    s_add_u32 s70, s70, 8192
    s_waitcnt vmcnt(2)
    buffer_load_dwordx4 v[28:31], v2, s[48:51], s70 offen nt
    s_add_u32 s70, s70, 8192
    s_waitcnt vmcnt(2)
    buffer_load_dwordx4 v[32:35], v2, s[48:51], s70 offen nt
    s_add_u32 s70, s70, 8192
    s_waitcnt vmcnt(2)
    buffer_load_dwordx4 v[36:39], v2, s[48:51], s70 offen nt
    s_add_u32 s70, s70, 204800
    s_waitcnt vmcnt(2)
    buffer_load_dwordx4 v[104:107], v2, s[48:51], s70 offen nt
    s_add_u32 s70, s70, 8192
    s_waitcnt vmcnt(2)
    buffer_load_dwordx4 v[108:111], v2, s[48:51], s70 offen nt
    s_add_u32 s70, s70, 8192
    s_waitcnt vmcnt(2)
    buffer_load_dwordx4 v[112:115], v2, s[48:51], s70 offen nt
    s_add_u32 s70, s70, 8192
    s_waitcnt vmcnt(2)
    buffer_load_dwordx4 v[116:119], v2, s[48:51], s70 offen nt
    s_add_u32 s70, s70, 8192
    s_waitcnt vmcnt(2)
    buffer_load_dwordx4 v[120:123], v2, s[48:51], s70 offen nt
    s_add_u32 s70, s70, 8192
    s_waitcnt vmcnt(2)
    buffer_load_dwordx4 v[124:127], v2, s[48:51], s70 offen nt
    s_add_u32 s70, s70, 8192
    s_waitcnt vmcnt(2)
    buffer_load_dwordx4 v[128:131], v2, s[48:51], s70 offen nt
    s_add_u32 s70, s70, 8192
    s_waitcnt vmcnt(2)
    buffer_load_dwordx4 v[132:135], v2, s[48:51], s70 offen nt
    s_add_u32 s70, s70, 204800
    v_lshlrev_b32 v3, 4, v1
    v_add_u32 v3, 0x24800, v3
    v_lshrrev_b32 v4, 1, v160
    v_lshlrev_b32 v4, 18, v4
    v_lshl_add_u32 v4, v162, 4, v4
    v_and_b32 v163, 1, v1
    v_lshl_add_u32 v4, v163, 6, v4
    v_cmp_eq_u32 s[86:87], 1, v163
    s_lshl_b32 s7, s3, 5
    s_add_u32 s7, s7, s6
    s_lshl_b32 s7, s7, 7
    s_add_u32 s7, s7, 0x500000
    v_add_u32 v4, s7, v4
    s_lshl_b32 s7, s3, 11
    s_add_u32 s7, s7, 0x10000
    v_lshl_add_u32 v5, v1, 5, s7
    v_perm_b32 v40, v12, v8, s92
    v_perm_b32 v41, v20, v16, s92
    v_perm_b32 v42, v28, v24, s92
    v_perm_b32 v43, v36, v32, s92
    v_perm_b32 v44, v12, v8, s93
    v_perm_b32 v45, v20, v16, s93
    v_perm_b32 v46, v28, v24, s93
    v_perm_b32 v47, v36, v32, s93
    v_perm_b32 v48, v13, v9, s92
    v_perm_b32 v49, v21, v17, s92
    v_perm_b32 v50, v29, v25, s92
    v_perm_b32 v51, v37, v33, s92
    v_perm_b32 v52, v13, v9, s93
    v_perm_b32 v53, v21, v17, s93
    v_perm_b32 v54, v29, v25, s93
    v_perm_b32 v55, v37, v33, s93
    v_perm_b32 v56, v14, v10, s92
    v_perm_b32 v57, v22, v18, s92
    v_perm_b32 v58, v30, v26, s92
    v_perm_b32 v59, v38, v34, s92
    v_perm_b32 v60, v14, v10, s93
    v_perm_b32 v61, v22, v18, s93
    v_perm_b32 v62, v30, v26, s93
    v_perm_b32 v63, v38, v34, s93
    v_perm_b32 v64, v15, v11, s92
    v_perm_b32 v65, v23, v19, s92
    v_perm_b32 v66, v31, v27, s92
    v_perm_b32 v67, v39, v35, s92
    v_perm_b32 v68, v15, v11, s93
    v_perm_b32 v69, v23, v19, s93
    v_perm_b32 v70, v31, v27, s93
    v_perm_b32 v71, v39, v35, s93
    s_waitcnt vmcnt(0)
    v_perm_b32 v72, v108, v104, s92
    v_perm_b32 v73, v116, v112, s92
    v_perm_b32 v74, v124, v120, s92
    v_perm_b32 v75, v132, v128, s92
    v_perm_b32 v76, v108, v104, s93
    v_perm_b32 v77, v116, v112, s93
    v_perm_b32 v78, v124, v120, s93
    v_perm_b32 v79, v132, v128, s93
    v_perm_b32 v80, v109, v105, s92
    v_perm_b32 v81, v117, v113, s92
    v_perm_b32 v82, v125, v121, s92
    v_perm_b32 v83, v133, v129, s92
    v_perm_b32 v84, v109, v105, s93
    v_perm_b32 v85, v117, v113, s93
    v_perm_b32 v86, v125, v121, s93
    v_perm_b32 v87, v133, v129, s93
    v_perm_b32 v88, v110, v106, s92
    v_perm_b32 v89, v118, v114, s92
    v_perm_b32 v90, v126, v122, s92
    v_perm_b32 v91, v134, v130, s92
    v_perm_b32 v92, v110, v106, s93
    v_perm_b32 v93, v118, v114, s93
    v_perm_b32 v94, v126, v122, s93
    v_perm_b32 v95, v134, v130, s93
    v_perm_b32 v96, v111, v107, s92
    v_perm_b32 v97, v119, v115, s92
    v_perm_b32 v98, v127, v123, s92
    v_perm_b32 v99, v135, v131, s92
    v_perm_b32 v100, v111, v107, s93
    v_perm_b32 v101, v119, v115, s93
    v_perm_b32 v102, v127, v123, s93
    v_perm_b32 v103, v135, v131, s93
    v_mov_b32 v160, 0x2404c
    s_mov_b32 s80, 1600000
LW_51:
    ds_read_b32 v161, v160
    s_waitcnt lgkmcnt(0)
    v_readfirstlane_b32 s79, v161
    s_cmp_ge_u32 s79, 1
    s_cbranch_scc1 LWD_52
    s_sleep 2
    s_sub_u32 s80, s80, 1
    s_cmp_lg_u32 s80, 0
    s_cbranch_scc1 LW_51
LWD_52:
    v_mov_b32 v160, 0x24050
    ds_read_b64 v[162:163], v160
    s_waitcnt lgkmcnt(0)
    v_readfirstlane_b32 s94, v162
    v_readfirstlane_b32 s95, v163
    v_mov_b32 v160, 0x2401c
    s_mov_b32 s80, 1600000
LW_53:
    ds_read_b32 v161, v160
    s_waitcnt lgkmcnt(0)
    v_readfirstlane_b32 s79, v161
    s_cmp_ge_u32 s79, 1
    s_cbranch_scc1 LWD_54
    s_sleep 4
    s_sub_u32 s80, s80, 1
    s_cmp_lg_u32 s80, 0
    s_cbranch_scc1 LW_53
LWD_54:
    s_setprio 3
    s_mov_b64 s[88:89], 0
    s_mov_b32 s80, 1600000
UM_55:
    ds_read_b128 v[136:139], v3
    s_waitcnt lgkmcnt(0)
    v_cmp_ne_u64 vcc, s[94:95], v[138:139]
    s_or_b64 s[90:91], vcc, s[88:89]
    s_and_b32 s7, s90, 0x5555
    s_cbranch_scc1 UMS_57
    s_mov_b32 s70, 0
    buffer_load_dwordx4 v[8:11], v4, s[36:39], s70 offen sc1
    s_or_b32 s88, s88, 0x5555
UMS_57:
    s_and_b32 s7, s90, 0x55550000
    s_cbranch_scc1 UMS_58
    s_mov_b32 s70, 32768
    buffer_load_dwordx4 v[12:15], v4, s[36:39], s70 offen sc1
    s_or_b32 s88, s88, 0x55550000
UMS_58:
    s_and_b32 s7, s91, 0x5555
    s_cbranch_scc1 UMS_59
    s_mov_b32 s70, 65536
    buffer_load_dwordx4 v[16:19], v4, s[36:39], s70 offen sc1
    s_or_b32 s89, s89, 0x5555
UMS_59:
    s_and_b32 s7, s91, 0x55550000
    s_cbranch_scc1 UMS_60
    s_mov_b32 s70, 98304
    buffer_load_dwordx4 v[20:23], v4, s[36:39], s70 offen sc1
    s_or_b32 s89, s89, 0x55550000
UMS_60:
    s_and_b32 s7, s90, 0xaaaa
    s_cbranch_scc1 UMS_61
    s_mov_b32 s70, 131072
    buffer_load_dwordx4 v[24:27], v4, s[36:39], s70 offen sc1
    s_or_b32 s88, s88, 0xaaaa
UMS_61:
    s_and_b32 s7, s90, 0xaaaa0000
    s_cbranch_scc1 UMS_62
    s_mov_b32 s70, 163840
    buffer_load_dwordx4 v[28:31], v4, s[36:39], s70 offen sc1
    s_or_b32 s88, s88, 0xaaaa0000
UMS_62:
    s_and_b32 s7, s91, 0xaaaa
    s_cbranch_scc1 UMS_63
    s_mov_b32 s70, 196608
    buffer_load_dwordx4 v[32:35], v4, s[36:39], s70 offen sc1
    s_or_b32 s89, s89, 0xaaaa
UMS_63:
    s_and_b32 s7, s91, 0xaaaa0000
    s_cbranch_scc1 UMS_64
    s_mov_b32 s70, 229376
    buffer_load_dwordx4 v[36:39], v4, s[36:39], s70 offen sc1
    s_or_b32 s89, s89, 0xaaaa0000
UMS_64:
    s_cbranch_vccz UMD_56
    s_sleep 1
    s_sub_u32 s80, s80, 1
    s_cmp_lg_u32 s80, 0
    s_cbranch_scc1 UM_55
UMD_56:
    v_max_f32_dpp v138, v136, v136 quad_perm:[1,0,3,2] row_mask:0xf bank_mask:0xf
    s_nop 1
    v_max_f32_dpp v138, v138, v138 quad_perm:[2,3,0,1] row_mask:0xf bank_mask:0xf
    v_mov_b32 v139, v138
    s_nop 1
    v_permlane32_swap_b32 v138, v139
    v_max_f32 v138, v138, v139
    v_mov_b32 v139, v138
    s_nop 1
    v_permlane16_swap_b32 v138, v139
    v_max_f32 v138, v138, v139
    v_sub_f32 v136, v136, v138
    v_exp_f32 v136, v136
    s_nop 0
    v_mul_f32 v137, v137, v136
    s_nop 1
    v_add_f32_dpp v137, v137, v137 quad_perm:[1,0,3,2] row_mask:0xf bank_mask:0xf
    s_nop 1
    v_add_f32_dpp v137, v137, v137 quad_perm:[2,3,0,1] row_mask:0xf bank_mask:0xf
    v_mov_b32 v138, v137
    s_nop 1
    v_permlane32_swap_b32 v137, v138
    v_add_f32 v137, v137, v138
    v_mov_b32 v138, v137
    s_nop 1
    v_permlane16_swap_b32 v137, v138
    v_add_f32 v137, v137, v138
    v_rcp_f32 v137, v137
    s_nop 0
    v_mul_f32 v136, v136, v137
    v_mov_b32 v137, v136
    s_nop 1
    v_permlane16_swap_b32 v136, v137
    v_mov_b32 v138, v136
    v_mov_b32 v139, v137
    s_nop 0
    v_permlane32_swap_b32 v136, v138
    v_permlane32_swap_b32 v137, v139
    s_nop 0
    v_mov_b32_dpp v148, v136 quad_perm:[0,0,2,2] row_mask:0xf bank_mask:0xf
    v_mov_b32_dpp v149, v137 quad_perm:[0,0,2,2] row_mask:0xf bank_mask:0xf
    v_mov_b32_dpp v150, v138 quad_perm:[0,0,2,2] row_mask:0xf bank_mask:0xf
    v_mov_b32_dpp v151, v139 quad_perm:[0,0,2,2] row_mask:0xf bank_mask:0xf
    v_mov_b32_dpp v152, v136 quad_perm:[1,1,3,3] row_mask:0xf bank_mask:0xf
    v_mov_b32_dpp v153, v137 quad_perm:[1,1,3,3] row_mask:0xf bank_mask:0xf
    v_mov_b32_dpp v154, v138 quad_perm:[1,1,3,3] row_mask:0xf bank_mask:0xf
    v_mov_b32_dpp v155, v139 quad_perm:[1,1,3,3] row_mask:0xf bank_mask:0xf
    s_waitcnt vmcnt(0)
    v_lshlrev_b32 v104, 16, v8
    v_and_b32 v105, 0xffff0000, v8
    v_lshlrev_b32 v106, 16, v9
    v_and_b32 v107, 0xffff0000, v9
    v_lshlrev_b32 v108, 16, v10
    v_and_b32 v109, 0xffff0000, v10
    v_lshlrev_b32 v110, 16, v11
    v_and_b32 v111, 0xffff0000, v11
    v_pk_mul_f32 v[120:121], v[104:105], v[148:149] op_sel_hi:[1,0]
    v_pk_mul_f32 v[122:123], v[106:107], v[148:149] op_sel_hi:[1,0]
    v_pk_mul_f32 v[124:125], v[108:109], v[148:149] op_sel_hi:[1,0]
    v_pk_mul_f32 v[126:127], v[110:111], v[148:149] op_sel_hi:[1,0]
    v_lshlrev_b32 v112, 16, v12
    v_and_b32 v113, 0xffff0000, v12
    v_lshlrev_b32 v114, 16, v13
    v_and_b32 v115, 0xffff0000, v13
    v_lshlrev_b32 v116, 16, v14
    v_and_b32 v117, 0xffff0000, v14
    v_lshlrev_b32 v118, 16, v15
    v_and_b32 v119, 0xffff0000, v15
    v_pk_mul_f32 v[128:129], v[112:113], v[148:149] op_sel:[0,1] op_sel_hi:[1,1]
    v_pk_mul_f32 v[130:131], v[114:115], v[148:149] op_sel:[0,1] op_sel_hi:[1,1]
    v_pk_mul_f32 v[132:133], v[116:117], v[148:149] op_sel:[0,1] op_sel_hi:[1,1]
    v_pk_mul_f32 v[134:135], v[118:119], v[148:149] op_sel:[0,1] op_sel_hi:[1,1]
    v_lshlrev_b32 v104, 16, v16
    v_and_b32 v105, 0xffff0000, v16
    v_lshlrev_b32 v106, 16, v17
    v_and_b32 v107, 0xffff0000, v17
    v_lshlrev_b32 v108, 16, v18
    v_and_b32 v109, 0xffff0000, v18
    v_lshlrev_b32 v110, 16, v19
    v_and_b32 v111, 0xffff0000, v19
    v_pk_fma_f32 v[120:121], v[104:105], v[150:151], v[120:121] op_sel_hi:[1,0,1]
    v_pk_fma_f32 v[122:123], v[106:107], v[150:151], v[122:123] op_sel_hi:[1,0,1]
    v_pk_fma_f32 v[124:125], v[108:109], v[150:151], v[124:125] op_sel_hi:[1,0,1]
    v_pk_fma_f32 v[126:127], v[110:111], v[150:151], v[126:127] op_sel_hi:[1,0,1]
    v_lshlrev_b32 v112, 16, v20
    v_and_b32 v113, 0xffff0000, v20
    v_lshlrev_b32 v114, 16, v21
    v_and_b32 v115, 0xffff0000, v21
    v_lshlrev_b32 v116, 16, v22
    v_and_b32 v117, 0xffff0000, v22
    v_lshlrev_b32 v118, 16, v23
    v_and_b32 v119, 0xffff0000, v23
    v_pk_fma_f32 v[128:129], v[112:113], v[150:151], v[128:129] op_sel:[0,1,0] op_sel_hi:[1,1,1]
    v_pk_fma_f32 v[130:131], v[114:115], v[150:151], v[130:131] op_sel:[0,1,0] op_sel_hi:[1,1,1]
    v_pk_fma_f32 v[132:133], v[116:117], v[150:151], v[132:133] op_sel:[0,1,0] op_sel_hi:[1,1,1]
    v_pk_fma_f32 v[134:135], v[118:119], v[150:151], v[134:135] op_sel:[0,1,0] op_sel_hi:[1,1,1]
    v_lshlrev_b32 v104, 16, v24
    v_and_b32 v105, 0xffff0000, v24
    v_lshlrev_b32 v106, 16, v25
    v_and_b32 v107, 0xffff0000, v25
    v_lshlrev_b32 v108, 16, v26
    v_and_b32 v109, 0xffff0000, v26
    v_lshlrev_b32 v110, 16, v27
    v_and_b32 v111, 0xffff0000, v27
    v_pk_fma_f32 v[120:121], v[104:105], v[152:153], v[120:121] op_sel_hi:[1,0,1]
    v_pk_fma_f32 v[122:123], v[106:107], v[152:153], v[122:123] op_sel_hi:[1,0,1]
    v_pk_fma_f32 v[124:125], v[108:109], v[152:153], v[124:125] op_sel_hi:[1,0,1]
    v_pk_fma_f32 v[126:127], v[110:111], v[152:153], v[126:127] op_sel_hi:[1,0,1]
    v_lshlrev_b32 v112, 16, v28
    v_and_b32 v113, 0xffff0000, v28
    v_lshlrev_b32 v114, 16, v29
    v_and_b32 v115, 0xffff0000, v29
    v_lshlrev_b32 v116, 16, v30
    v_and_b32 v117, 0xffff0000, v30
    v_lshlrev_b32 v118, 16, v31
    v_and_b32 v119, 0xffff0000, v31
    v_pk_fma_f32 v[128:129], v[112:113], v[152:153], v[128:129] op_sel:[0,1,0] op_sel_hi:[1,1,1]
    v_pk_fma_f32 v[130:131], v[114:115], v[152:153], v[130:131] op_sel:[0,1,0] op_sel_hi:[1,1,1]
    v_pk_fma_f32 v[132:133], v[116:117], v[152:153], v[132:133] op_sel:[0,1,0] op_sel_hi:[1,1,1]
    v_pk_fma_f32 v[134:135], v[118:119], v[152:153], v[134:135] op_sel:[0,1,0] op_sel_hi:[1,1,1]
    v_lshlrev_b32 v104, 16, v32
    v_and_b32 v105, 0xffff0000, v32
    v_lshlrev_b32 v106, 16, v33
    v_and_b32 v107, 0xffff0000, v33
    v_lshlrev_b32 v108, 16, v34
    v_and_b32 v109, 0xffff0000, v34
    v_lshlrev_b32 v110, 16, v35
    v_and_b32 v111, 0xffff0000, v35
    v_pk_fma_f32 v[120:121], v[104:105], v[154:155], v[120:121] op_sel_hi:[1,0,1]
    v_pk_fma_f32 v[122:123], v[106:107], v[154:155], v[122:123] op_sel_hi:[1,0,1]
    v_pk_fma_f32 v[124:125], v[108:109], v[154:155], v[124:125] op_sel_hi:[1,0,1]
    v_pk_fma_f32 v[126:127], v[110:111], v[154:155], v[126:127] op_sel_hi:[1,0,1]
    v_lshlrev_b32 v112, 16, v36
    v_and_b32 v113, 0xffff0000, v36
    v_lshlrev_b32 v114, 16, v37
    v_and_b32 v115, 0xffff0000, v37
    v_lshlrev_b32 v116, 16, v38
    v_and_b32 v117, 0xffff0000, v38
    v_lshlrev_b32 v118, 16, v39
    v_and_b32 v119, 0xffff0000, v39
    v_pk_fma_f32 v[128:129], v[112:113], v[154:155], v[128:129] op_sel:[0,1,0] op_sel_hi:[1,1,1]
    v_pk_fma_f32 v[130:131], v[114:115], v[154:155], v[130:131] op_sel:[0,1,0] op_sel_hi:[1,1,1]
    v_pk_fma_f32 v[132:133], v[116:117], v[154:155], v[132:133] op_sel:[0,1,0] op_sel_hi:[1,1,1]
    v_pk_fma_f32 v[134:135], v[118:119], v[154:155], v[134:135] op_sel:[0,1,0] op_sel_hi:[1,1,1]
    v_pk_add_f32 v[120:121], v[120:121], v[128:129]
    v_pk_add_f32 v[122:123], v[122:123], v[130:131]
    v_pk_add_f32 v[124:125], v[124:125], v[132:133]
    v_pk_add_f32 v[126:127], v[126:127], v[134:135]
    v_cvt_pk_bf16_f32 v128, v120, v121
    v_cvt_pk_bf16_f32 v129, v122, v123
    v_cvt_pk_bf16_f32 v130, v124, v125
    v_cvt_pk_bf16_f32 v131, v126, v127
    v_cndmask_b32 v140, v128, 0, s[86:87]
    v_cndmask_b32 v144, 0, v128, s[86:87]
    v_cndmask_b32 v141, v129, 0, s[86:87]
    v_cndmask_b32 v145, 0, v129, s[86:87]
    v_cndmask_b32 v142, v130, 0, s[86:87]
    v_cndmask_b32 v146, 0, v130, s[86:87]
    v_cndmask_b32 v143, v131, 0, s[86:87]
    v_cndmask_b32 v147, 0, v131, s[86:87]
    s_nop 0
    v_mfma_f32_16x16x32_bf16 v[8:11], v[140:143], v[40:43], 0
    v_mfma_f32_16x16x32_bf16 v[12:15], v[140:143], v[44:47], 0
    v_mfma_f32_16x16x32_bf16 v[16:19], v[140:143], v[48:51], 0
    v_mfma_f32_16x16x32_bf16 v[20:23], v[140:143], v[52:55], 0
    v_mfma_f32_16x16x32_bf16 v[24:27], v[140:143], v[56:59], 0
    v_mfma_f32_16x16x32_bf16 v[28:31], v[140:143], v[60:63], 0
    v_mfma_f32_16x16x32_bf16 v[32:35], v[140:143], v[64:67], 0
    v_mfma_f32_16x16x32_bf16 v[36:39], v[140:143], v[68:71], 0
    v_mfma_f32_16x16x32_bf16 v[8:11], v[144:147], v[72:75], v[8:11]
    v_mfma_f32_16x16x32_bf16 v[12:15], v[144:147], v[76:79], v[12:15]
    v_mfma_f32_16x16x32_bf16 v[16:19], v[144:147], v[80:83], v[16:19]
    v_mfma_f32_16x16x32_bf16 v[20:23], v[144:147], v[84:87], v[20:23]
    v_mfma_f32_16x16x32_bf16 v[24:27], v[144:147], v[88:91], v[24:27]
    v_mfma_f32_16x16x32_bf16 v[28:31], v[144:147], v[92:95], v[28:31]
    v_mfma_f32_16x16x32_bf16 v[32:35], v[144:147], v[96:99], v[32:35]
    v_mfma_f32_16x16x32_bf16 v[36:39], v[144:147], v[100:103], v[36:39]
    s_nop 0
    v_pk_add_f32 v[8:9], v[8:9], v[10:11]
    v_pk_add_f32 v[12:13], v[12:13], v[14:15]
    v_pk_add_f32 v[16:17], v[16:17], v[18:19]
    v_pk_add_f32 v[20:21], v[20:21], v[22:23]
    v_pk_add_f32 v[24:25], v[24:25], v[26:27]
    v_pk_add_f32 v[28:29], v[28:29], v[30:31]
    v_pk_add_f32 v[32:33], v[32:33], v[34:35]
    v_pk_add_f32 v[36:37], v[36:37], v[38:39]
    v_add_f32 v104, v8, v9
    v_add_f32 v105, v12, v13
    v_add_f32 v106, v16, v17
    v_add_f32 v107, v20, v21
    v_add_f32 v108, v24, v25
    v_add_f32 v109, v28, v29
    v_add_f32 v110, v32, v33
    v_add_f32 v111, v36, v37
    ds_write_b128 v5, v[104:107]
    ds_write_b128 v5, v[108:111] offset:16
    v_mov_b32 v160, 0x2400c
    v_mov_b32 v161, 1
    s_waitcnt lgkmcnt(0)
    s_mov_b64 exec, 1
    ds_add_u32 v160, v161
    s_mov_b64 exec, -1
    v_and_b32 v160, 31, v1
    s_lshl_b32 s7, s3, 8
    s_add_u32 s7, s7, 0x10000
    v_lshl_add_u32 v5, v160, 3, s7
    s_lshl_b32 s7, s3, 7
    s_add_u32 s7, s7, 0x24400
    v_lshl_add_u32 v4, v160, 2, s7
    v_mov_b32 v160, 0x2400c
    s_mov_b32 s80, 1600000
LW_65:
    ds_read_b32 v161, v160
    s_waitcnt lgkmcnt(0)
    v_readfirstlane_b32 s79, v161
    s_cmp_ge_u32 s79, 8
    s_cbranch_scc1 LWD_66
    s_sub_u32 s80, s80, 1
    s_cmp_lg_u32 s80, 0
    s_cbranch_scc1 LW_65
LWD_66:
    ds_read_b64 v[8:9], v5 offset:0
    ds_read_b64 v[10:11], v5 offset:2048
    ds_read_b64 v[12:13], v5 offset:4096
    ds_read_b64 v[14:15], v5 offset:6144
    ds_read_b64 v[16:17], v5 offset:8192
    ds_read_b64 v[18:19], v5 offset:10240
    ds_read_b64 v[20:21], v5 offset:12288
    ds_read_b64 v[22:23], v5 offset:14336
    s_waitcnt lgkmcnt(0)
    v_pk_add_f32 v[8:9], v[8:9], v[16:17]
    v_pk_add_f32 v[10:11], v[10:11], v[18:19]
    v_pk_add_f32 v[12:13], v[12:13], v[20:21]
    v_pk_add_f32 v[14:15], v[14:15], v[22:23]
    v_pk_add_f32 v[8:9], v[8:9], v[12:13]
    v_pk_add_f32 v[10:11], v[10:11], v[14:15]
    v_pk_add_f32 v[8:9], v[8:9], v[10:11]
    v_cvt_pk_bf16_f32 v8, v8, v9
    ds_write_b32 v4, v8
    v_mov_b32 v160, 0x24020
    v_mov_b32 v161, 1
    s_waitcnt lgkmcnt(0)
    s_mov_b64 exec, 1
    ds_add_u32 v160, v161
    s_mov_b64 exec, -1
    s_endpgm
L_W2:
    s_mov_b32 s52, s24
    s_and_b32 s53, s25, 0xffff
    s_mov_b32 s54, 0x400000
    s_mov_b32 s55, 0x20000
    s_sub_u32 s62, s3, 8
    s_lshl_b32 s7, s5, 2
    s_add_u32 s7, s7, s62
    s_lshl_b32 s7, s7, 17
    s_lshl_b32 s70, s4, 10
    s_add_u32 s70, s70, s7
    s_lshl_b32 s71, s62, 14
    v_lshlrev_b32 v2, 4, v1
    s_lshl_b32 s7, s62, 6
    v_xor_b32 v4, s7, v2
    v_xor_b32 v5, 16, v4
    v_xor_b32 v6, 32, v4
    v_xor_b32 v7, 48, v4
    s_mov_b32 m0, s71
    s_nop 0
    buffer_load_dwordx4 v4, s[52:55], s70 offen nt lds
    s_add_u32 s70, s70, 8192
    s_add_u32 s71, s71, 1024
    s_mov_b32 m0, s71
    s_nop 0
    buffer_load_dwordx4 v4, s[52:55], s70 offen nt lds
    s_add_u32 s70, s70, 8192
    s_add_u32 s71, s71, 1024
    s_barrier
    s_mov_b32 m0, s71
    s_nop 0
    buffer_load_dwordx4 v4, s[52:55], s70 offen nt lds
    s_add_u32 s70, s70, 8192
    s_add_u32 s71, s71, 1024
    s_mov_b32 m0, s71
    s_nop 0
    buffer_load_dwordx4 v4, s[52:55], s70 offen nt lds
    s_add_u32 s70, s70, 8192
    s_add_u32 s71, s71, 1024
    s_mov_b32 m0, s71
    s_nop 0
    buffer_load_dwordx4 v5, s[52:55], s70 offen nt lds
    s_add_u32 s70, s70, 8192
    s_add_u32 s71, s71, 1024
    s_mov_b32 m0, s71
    s_nop 0
    buffer_load_dwordx4 v5, s[52:55], s70 offen nt lds
    s_add_u32 s70, s70, 8192
    s_add_u32 s71, s71, 1024
    s_mov_b32 m0, s71
    s_nop 0
    buffer_load_dwordx4 v5, s[52:55], s70 offen nt lds
    s_add_u32 s70, s70, 8192
    s_add_u32 s71, s71, 1024
    s_mov_b32 m0, s71
    s_nop 0
    buffer_load_dwordx4 v5, s[52:55], s70 offen nt lds
    s_add_u32 s70, s70, 8192
    s_add_u32 s71, s71, 1024
    s_mov_b32 m0, s71
    s_waitcnt vmcnt(7)
    buffer_load_dwordx4 v6, s[52:55], s70 offen nt lds
    s_add_u32 s70, s70, 8192
    s_add_u32 s71, s71, 1024
    s_mov_b32 m0, s71
    s_waitcnt vmcnt(7)
    buffer_load_dwordx4 v6, s[52:55], s70 offen nt lds
    s_add_u32 s70, s70, 8192
    s_add_u32 s71, s71, 1024
    s_mov_b32 m0, s71
    s_waitcnt vmcnt(7)
    buffer_load_dwordx4 v6, s[52:55], s70 offen nt lds
    s_add_u32 s70, s70, 8192
    s_add_u32 s71, s71, 1024
    s_mov_b32 m0, s71
    s_waitcnt vmcnt(7)
    buffer_load_dwordx4 v6, s[52:55], s70 offen nt lds
    s_add_u32 s70, s70, 8192
    s_add_u32 s71, s71, 1024
    s_mov_b32 m0, s71
    s_waitcnt vmcnt(7)
    buffer_load_dwordx4 v7, s[52:55], s70 offen nt lds
    s_add_u32 s70, s70, 8192
    s_add_u32 s71, s71, 1024
    s_mov_b32 m0, s71
    s_waitcnt vmcnt(7)
    buffer_load_dwordx4 v7, s[52:55], s70 offen nt lds
    s_add_u32 s70, s70, 8192
    s_add_u32 s71, s71, 1024
    s_mov_b32 m0, s71
    s_waitcnt vmcnt(7)
    buffer_load_dwordx4 v7, s[52:55], s70 offen nt lds
    s_add_u32 s70, s70, 8192
    s_add_u32 s71, s71, 1024
    s_mov_b32 m0, s71
    s_waitcnt vmcnt(7)
    buffer_load_dwordx4 v7, s[52:55], s70 offen nt lds
    s_add_u32 s70, s70, 8192
    s_add_u32 s71, s71, 1024
    s_cmp_lt_u32 s5, 4
    s_cselect_b32 s72, s28, s16
    s_cselect_b32 s73, s29, s17
    s_mov_b32 s56, s72
    s_and_b32 s57, s73, 0xffff
    s_mov_b32 s58, 0x400000
    s_mov_b32 s59, 0x20000
    v_lshrrev_b32 v4, 4, v1
    v_lshlrev_b32 v2, 13, v4
    v_and_b32 v4, 15, v1
    v_lshl_add_u32 v2, v4, 4, v2
    s_lshl_b32 s7, s6, 17
    s_lshl_b32 s70, s62, 8
    s_add_u32 s7, s7, s70
    v_add_u32 v2, s7, v2
    v_lshrrev_b32 v3, 4, v1
    v_lshlrev_b32 v3, 16, v3
    v_bfe_u32 v4, v1, 3, 1
    v_lshl_add_u32 v3, v4, 13, v3
    v_and_b32 v4, 7, v1
    v_lshl_add_u32 v3, v4, 4, v3
    s_cmp_lt_u32 s5, 4
    s_cselect_b32 s7, 0x800, 0x0
    s_add_u32 s7, s7, s6
    s_lshl_b32 s7, s7, 7
    s_add_u32 s7, s7, 0x100000
    v_add_u32 v3, s7, v3
    s_lshl_b32 s7, s62, 14
    v_add_u32 v3, s7, v3
    s_waitcnt vmcnt(0)
    v_mov_b32 v4, 0x24014
    v_mov_b32 v5, 1
    s_waitcnt lgkmcnt(0)
    s_mov_b64 exec, 1
    ds_add_u32 v4, v5
    s_mov_b64 exec, -1
    s_mov_b32 s70, 0
    v_mov_b32 v4, 0x24048
    s_mov_b32 s80, 1600000
LW_69:
    ds_read_b32 v5, v4
    s_waitcnt lgkmcnt(0)
    v_readfirstlane_b32 s79, v5
    s_cmp_ge_u32 s79, 4
    s_cbranch_scc1 LWD_70
    s_sleep 4
    s_sub_u32 s80, s80, 1
    s_cmp_lg_u32 s80, 0
    s_cbranch_scc1 LW_69
LWD_70:
    s_cmp_lt_u32 s5, 4
    s_cbranch_scc1 S2U_67
    v_mov_b32 v4, 0x2405c
    s_mov_b32 s80, 1600000
LW_71:
    ds_read_b32 v5, v4
    s_waitcnt lgkmcnt(0)
    v_readfirstlane_b32 s79, v5
    s_cmp_ge_u32 s79, 4
    s_cbranch_scc1 LWD_72
    s_sleep 8
    s_sub_u32 s80, s80, 1
    s_cmp_lg_u32 s80, 0
    s_cbranch_scc1 LW_71
LWD_72:
    buffer_load_dwordx4 v[40:43], v2, s[56:59], s70 offen offset:0 nt
    buffer_load_dwordx4 v[44:47], v2, s[56:59], s70 offen offset:1024 nt
    buffer_load_dwordx4 v[48:51], v2, s[56:59], s70 offen offset:2048 nt
    buffer_load_dwordx4 v[52:55], v2, s[56:59], s70 offen offset:3072 nt
    s_add_u32 s70, s70, 4096
    s_waitcnt vmcnt(2)
    buffer_load_dwordx4 v[56:59], v2, s[56:59], s70 offen offset:0 nt
    buffer_load_dwordx4 v[60:63], v2, s[56:59], s70 offen offset:1024 nt
    buffer_load_dwordx4 v[64:67], v2, s[56:59], s70 offen offset:2048 nt
    buffer_load_dwordx4 v[68:71], v2, s[56:59], s70 offen offset:3072 nt
    s_add_u32 s70, s70, 28672
    s_waitcnt vmcnt(2)
    buffer_load_dwordx4 v[72:75], v2, s[56:59], s70 offen offset:0 nt
    buffer_load_dwordx4 v[76:79], v2, s[56:59], s70 offen offset:1024 nt
    buffer_load_dwordx4 v[80:83], v2, s[56:59], s70 offen offset:2048 nt
    buffer_load_dwordx4 v[84:87], v2, s[56:59], s70 offen offset:3072 nt
    s_add_u32 s70, s70, 4096
    s_waitcnt vmcnt(2)
    buffer_load_dwordx4 v[88:91], v2, s[56:59], s70 offen offset:0 nt
    buffer_load_dwordx4 v[92:95], v2, s[56:59], s70 offen offset:1024 nt
    buffer_load_dwordx4 v[96:99], v2, s[56:59], s70 offen offset:2048 nt
    buffer_load_dwordx4 v[100:103], v2, s[56:59], s70 offen offset:3072 nt
    s_add_u32 s70, s70, 28672
    s_waitcnt vmcnt(2)
    buffer_load_dwordx4 v[104:107], v2, s[56:59], s70 offen offset:0 nt
    buffer_load_dwordx4 v[108:111], v2, s[56:59], s70 offen offset:1024 nt
    buffer_load_dwordx4 v[112:115], v2, s[56:59], s70 offen offset:2048 nt
    buffer_load_dwordx4 v[116:119], v2, s[56:59], s70 offen offset:3072 nt
    s_add_u32 s70, s70, 4096
    s_waitcnt vmcnt(2)
    buffer_load_dwordx4 v[120:123], v2, s[56:59], s70 offen offset:0 nt
    buffer_load_dwordx4 v[124:127], v2, s[56:59], s70 offen offset:1024 nt
    buffer_load_dwordx4 v[128:131], v2, s[56:59], s70 offen offset:2048 nt
    buffer_load_dwordx4 v[132:135], v2, s[56:59], s70 offen offset:3072 nt
    s_add_u32 s70, s70, 28672
    s_waitcnt vmcnt(2)
    buffer_load_dwordx4 v[136:139], v2, s[56:59], s70 offen offset:0 nt
    buffer_load_dwordx4 v[140:143], v2, s[56:59], s70 offen offset:1024 nt
    buffer_load_dwordx4 v[144:147], v2, s[56:59], s70 offen offset:2048 nt
    buffer_load_dwordx4 v[148:151], v2, s[56:59], s70 offen offset:3072 nt
    s_add_u32 s70, s70, 4096
    s_waitcnt vmcnt(2)
    buffer_load_dwordx4 v[152:155], v2, s[56:59], s70 offen offset:0 nt
    buffer_load_dwordx4 v[156:159], v2, s[56:59], s70 offen offset:1024 nt
    buffer_load_dwordx4 v[160:163], v2, s[56:59], s70 offen offset:2048 nt
    buffer_load_dwordx4 v[164:167], v2, s[56:59], s70 offen offset:3072 nt
    s_add_u32 s70, s70, 28672
    s_waitcnt vmcnt(0)
    s_branch S2J_68
S2U_67:
    buffer_load_dwordx4 v[40:43], v2, s[56:59], s70 offen offset:0 nt
    buffer_load_dwordx4 v[44:47], v2, s[56:59], s70 offen offset:1024 nt
    buffer_load_dwordx4 v[48:51], v2, s[56:59], s70 offen offset:2048 nt
    buffer_load_dwordx4 v[52:55], v2, s[56:59], s70 offen offset:3072 nt
    s_add_u32 s70, s70, 4096
    s_waitcnt vmcnt(2)
    buffer_load_dwordx4 v[56:59], v2, s[56:59], s70 offen offset:0 nt
    buffer_load_dwordx4 v[60:63], v2, s[56:59], s70 offen offset:1024 nt
    buffer_load_dwordx4 v[64:67], v2, s[56:59], s70 offen offset:2048 nt
    buffer_load_dwordx4 v[68:71], v2, s[56:59], s70 offen offset:3072 nt
    s_add_u32 s70, s70, 28672
    s_waitcnt vmcnt(2)
    buffer_load_dwordx4 v[72:75], v2, s[56:59], s70 offen offset:0 nt
    buffer_load_dwordx4 v[76:79], v2, s[56:59], s70 offen offset:1024 nt
    buffer_load_dwordx4 v[80:83], v2, s[56:59], s70 offen offset:2048 nt
    buffer_load_dwordx4 v[84:87], v2, s[56:59], s70 offen offset:3072 nt
    s_add_u32 s70, s70, 4096
    s_waitcnt vmcnt(2)
    buffer_load_dwordx4 v[88:91], v2, s[56:59], s70 offen offset:0 nt
    buffer_load_dwordx4 v[92:95], v2, s[56:59], s70 offen offset:1024 nt
    buffer_load_dwordx4 v[96:99], v2, s[56:59], s70 offen offset:2048 nt
    buffer_load_dwordx4 v[100:103], v2, s[56:59], s70 offen offset:3072 nt
    s_add_u32 s70, s70, 28672
    s_waitcnt vmcnt(2)
    buffer_load_dwordx4 v[104:107], v2, s[56:59], s70 offen offset:0 nt
    buffer_load_dwordx4 v[108:111], v2, s[56:59], s70 offen offset:1024 nt
    buffer_load_dwordx4 v[112:115], v2, s[56:59], s70 offen offset:2048 nt
    buffer_load_dwordx4 v[116:119], v2, s[56:59], s70 offen offset:3072 nt
    s_add_u32 s70, s70, 4096
    s_waitcnt vmcnt(2)
    buffer_load_dwordx4 v[120:123], v2, s[56:59], s70 offen offset:0 nt
    buffer_load_dwordx4 v[124:127], v2, s[56:59], s70 offen offset:1024 nt
    buffer_load_dwordx4 v[128:131], v2, s[56:59], s70 offen offset:2048 nt
    buffer_load_dwordx4 v[132:135], v2, s[56:59], s70 offen offset:3072 nt
    s_add_u32 s70, s70, 28672
    s_waitcnt vmcnt(2)
    buffer_load_dwordx4 v[136:139], v2, s[56:59], s70 offen offset:0 nt
    buffer_load_dwordx4 v[140:143], v2, s[56:59], s70 offen offset:1024 nt
    buffer_load_dwordx4 v[144:147], v2, s[56:59], s70 offen offset:2048 nt
    buffer_load_dwordx4 v[148:151], v2, s[56:59], s70 offen offset:3072 nt
    s_add_u32 s70, s70, 4096
    s_waitcnt vmcnt(2)
    buffer_load_dwordx4 v[152:155], v2, s[56:59], s70 offen offset:0 nt
    buffer_load_dwordx4 v[156:159], v2, s[56:59], s70 offen offset:1024 nt
    buffer_load_dwordx4 v[160:163], v2, s[56:59], s70 offen offset:2048 nt
    buffer_load_dwordx4 v[164:167], v2, s[56:59], s70 offen offset:3072 nt
    s_add_u32 s70, s70, 28672
    s_waitcnt vmcnt(0)
S2J_68:
    v_perm_b32 v8, v44, v40, s92
    v_perm_b32 v9, v52, v48, s92
    v_perm_b32 v10, v60, v56, s92
    v_perm_b32 v11, v68, v64, s92
    v_perm_b32 v12, v44, v40, s93
    v_perm_b32 v13, v52, v48, s93
    v_perm_b32 v14, v60, v56, s93
    v_perm_b32 v15, v68, v64, s93
    v_perm_b32 v16, v45, v41, s92
    v_perm_b32 v17, v53, v49, s92
    v_perm_b32 v18, v61, v57, s92
    v_perm_b32 v19, v69, v65, s92
    v_perm_b32 v20, v45, v41, s93
    v_perm_b32 v21, v53, v49, s93
    v_perm_b32 v22, v61, v57, s93
    v_perm_b32 v23, v69, v65, s93
    v_perm_b32 v24, v46, v42, s92
    v_perm_b32 v25, v54, v50, s92
    v_perm_b32 v26, v62, v58, s92
    v_perm_b32 v27, v70, v66, s92
    v_perm_b32 v28, v46, v42, s93
    v_perm_b32 v29, v54, v50, s93
    v_perm_b32 v30, v62, v58, s93
    v_perm_b32 v31, v70, v66, s93
    v_perm_b32 v32, v47, v43, s92
    v_perm_b32 v33, v55, v51, s92
    v_perm_b32 v34, v63, v59, s92
    v_perm_b32 v35, v71, v67, s92
    v_perm_b32 v36, v47, v43, s93
    v_perm_b32 v37, v55, v51, s93
    v_perm_b32 v38, v63, v59, s93
    v_perm_b32 v39, v71, v67, s93
    v_perm_b32 v40, v76, v72, s92
    v_perm_b32 v41, v84, v80, s92
    v_perm_b32 v42, v92, v88, s92
    v_perm_b32 v43, v100, v96, s92
    v_perm_b32 v44, v76, v72, s93
    v_perm_b32 v45, v84, v80, s93
    v_perm_b32 v46, v92, v88, s93
    v_perm_b32 v47, v100, v96, s93
    v_perm_b32 v48, v77, v73, s92
    v_perm_b32 v49, v85, v81, s92
    v_perm_b32 v50, v93, v89, s92
    v_perm_b32 v51, v101, v97, s92
    v_perm_b32 v52, v77, v73, s93
    v_perm_b32 v53, v85, v81, s93
    v_perm_b32 v54, v93, v89, s93
    v_perm_b32 v55, v101, v97, s93
    v_perm_b32 v56, v78, v74, s92
    v_perm_b32 v57, v86, v82, s92
    v_perm_b32 v58, v94, v90, s92
    v_perm_b32 v59, v102, v98, s92
    v_perm_b32 v60, v78, v74, s93
    v_perm_b32 v61, v86, v82, s93
    v_perm_b32 v62, v94, v90, s93
    v_perm_b32 v63, v102, v98, s93
    v_perm_b32 v64, v79, v75, s92
    v_perm_b32 v65, v87, v83, s92
    v_perm_b32 v66, v95, v91, s92
    v_perm_b32 v67, v103, v99, s92
    v_perm_b32 v68, v79, v75, s93
    v_perm_b32 v69, v87, v83, s93
    v_perm_b32 v70, v95, v91, s93
    v_perm_b32 v71, v103, v99, s93
    v_perm_b32 v72, v108, v104, s92
    v_perm_b32 v73, v116, v112, s92
    v_perm_b32 v74, v124, v120, s92
    v_perm_b32 v75, v132, v128, s92
    v_perm_b32 v76, v108, v104, s93
    v_perm_b32 v77, v116, v112, s93
    v_perm_b32 v78, v124, v120, s93
    v_perm_b32 v79, v132, v128, s93
    v_perm_b32 v80, v109, v105, s92
    v_perm_b32 v81, v117, v113, s92
    v_perm_b32 v82, v125, v121, s92
    v_perm_b32 v83, v133, v129, s92
    v_perm_b32 v84, v109, v105, s93
    v_perm_b32 v85, v117, v113, s93
    v_perm_b32 v86, v125, v121, s93
    v_perm_b32 v87, v133, v129, s93
    v_perm_b32 v88, v110, v106, s92
    v_perm_b32 v89, v118, v114, s92
    v_perm_b32 v90, v126, v122, s92
    v_perm_b32 v91, v134, v130, s92
    v_perm_b32 v92, v110, v106, s93
    v_perm_b32 v93, v118, v114, s93
    v_perm_b32 v94, v126, v122, s93
    v_perm_b32 v95, v134, v130, s93
    v_perm_b32 v96, v111, v107, s92
    v_perm_b32 v97, v119, v115, s92
    v_perm_b32 v98, v127, v123, s92
    v_perm_b32 v99, v135, v131, s92
    v_perm_b32 v100, v111, v107, s93
    v_perm_b32 v101, v119, v115, s93
    v_perm_b32 v102, v127, v123, s93
    v_perm_b32 v103, v135, v131, s93
    v_perm_b32 v104, v140, v136, s92
    v_perm_b32 v105, v148, v144, s92
    v_perm_b32 v106, v156, v152, s92
    v_perm_b32 v107, v164, v160, s92
    v_perm_b32 v108, v140, v136, s93
    v_perm_b32 v109, v148, v144, s93
    v_perm_b32 v110, v156, v152, s93
    v_perm_b32 v111, v164, v160, s93
    v_perm_b32 v112, v141, v137, s92
    v_perm_b32 v113, v149, v145, s92
    v_perm_b32 v114, v157, v153, s92
    v_perm_b32 v115, v165, v161, s92
    v_perm_b32 v116, v141, v137, s93
    v_perm_b32 v117, v149, v145, s93
    v_perm_b32 v118, v157, v153, s93
    v_perm_b32 v119, v165, v161, s93
    v_perm_b32 v120, v142, v138, s92
    v_perm_b32 v121, v150, v146, s92
    v_perm_b32 v122, v158, v154, s92
    v_perm_b32 v123, v166, v162, s92
    v_perm_b32 v124, v142, v138, s93
    v_perm_b32 v125, v150, v146, s93
    v_perm_b32 v126, v158, v154, s93
    v_perm_b32 v127, v166, v162, s93
    v_perm_b32 v128, v143, v139, s92
    v_perm_b32 v129, v151, v147, s92
    v_perm_b32 v130, v159, v155, s92
    v_perm_b32 v131, v167, v163, s92
    v_perm_b32 v132, v143, v139, s93
    v_perm_b32 v133, v151, v147, s93
    v_perm_b32 v134, v159, v155, s93
    v_perm_b32 v135, v167, v163, s93
    v_mov_b32 v160, 0x2404c
    s_mov_b32 s80, 1600000
LW_73:
    ds_read_b32 v161, v160
    s_waitcnt lgkmcnt(0)
    v_readfirstlane_b32 s79, v161
    s_cmp_ge_u32 s79, 1
    s_cbranch_scc1 LWD_74
    s_sleep 2
    s_sub_u32 s80, s80, 1
    s_cmp_lg_u32 s80, 0
    s_cbranch_scc1 LW_73
LWD_74:
    v_mov_b32 v160, 0x24050
    ds_read_b64 v[162:163], v160
    s_waitcnt lgkmcnt(0)
    v_readfirstlane_b32 s94, v162
    v_readfirstlane_b32 s95, v163
    v_bfe_u32 v4, v1, 2, 2
    v_lshlrev_b32 v4, 8, v4
    v_lshrrev_b32 v160, 4, v1
    v_lshl_add_u32 v4, v160, 4, v4
    s_mov_b32 s70, 4096
    s_cmp_ge_u32 s5, 4
    s_cbranch_scc1 S2X_75
    v_add_u32 v4, 0x24400, v4
    s_cmp_lg_u32 s3, 8
    s_cbranch_scc1 U8_77
    v_and_b32 v5, 15, v1
    v_lshl_add_u32 v5, v5, 2, v160
    s_lshl_b32 s7, s6, 4
    s_add_u32 s7, s7, 0xe0000
    v_lshl_add_u32 v5, v5, 9, s7
    v_lshlrev_b32 v6, 4, v1
    v_add_u32 v6, 0x24800, v6
    s_mov_b32 s80, 200000
PO_78:
    buffer_load_dwordx4 v[136:139], v5, s[36:39], 0 offen sc1
PO2_79:
    s_waitcnt vmcnt(0)
    v_cmp_ne_u64 vcc, s[94:95], v[138:139]
    s_cmp_lg_u64 vcc, -1
    s_cbranch_scc1 POD_80
    s_sleep 16
    s_sub_u32 s80, s80, 1
    s_cmp_lg_u32 s80, 0
    s_cbranch_scc1 PO_78
POD_80:
    s_setprio 3
    ds_write_b128 v6, v[136:139]
    v_mov_b32 v160, 0x2401c
    v_mov_b32 v161, 1
    s_waitcnt lgkmcnt(0)
    s_mov_b64 exec, 1
    ds_add_u32 v160, v161
    s_mov_b64 exec, -1
    s_cbranch_vccz U8D_82
    buffer_load_dwordx4 v[136:139], v5, s[36:39], 0 offen sc1
    s_sleep 4
    buffer_load_dwordx4 v[140:143], v5, s[36:39], 0 offen sc1
    s_sleep 4
    s_mov_b32 s80, 200000
U8P_81:
    s_waitcnt vmcnt(1)
    ds_write_b128 v6, v[136:139]
    v_cmp_ne_u64 vcc, s[94:95], v[138:139]
    s_cbranch_vccz U8D_82
    s_waitcnt lgkmcnt(0)
    buffer_load_dwordx4 v[136:139], v5, s[36:39], 0 offen sc1
    s_waitcnt vmcnt(1)
    ds_write_b128 v6, v[140:143]
    v_cmp_ne_u64 vcc, s[94:95], v[142:143]
    s_cbranch_vccz U8D_82
    s_waitcnt lgkmcnt(0)
    buffer_load_dwordx4 v[140:143], v5, s[36:39], 0 offen sc1
    s_sub_u32 s80, s80, 1
    s_cmp_lg_u32 s80, 0
    s_cbranch_scc1 U8P_81
U8D_82:
    s_waitcnt vmcnt(0)
U8_77:
    v_mov_b32 v160, 0x24020
    s_mov_b32 s80, 1600000
LW_83:
    ds_read_b32 v161, v160
    s_waitcnt lgkmcnt(0)
    v_readfirstlane_b32 s79, v161
    s_cmp_ge_u32 s79, 8
    s_cbranch_scc1 LWD_84
    s_sleep 1
    s_sub_u32 s80, s80, 1
    s_cmp_lg_u32 s80, 0
    s_cbranch_scc1 LW_83
LWD_84:
    s_setprio 3
    ds_read_b128 v[136:139], v4 offset:0
    ds_read_b128 v[140:143], v4 offset:64
    ds_read_b128 v[144:147], v4 offset:128
    ds_read_b128 v[148:151], v4 offset:192
    s_waitcnt lgkmcnt(0)
    s_branch S2M_76
S2X_75:
    v_and_b32 v160, 3, v1
    v_lshl_add_u32 v4, v160, 6, v4
    s_lshl_b32 s7, s6, 11
    s_add_u32 s7, s7, 0xd0000
    v_add_u32 v4, s7, v4
    s_mov_b32 s80, 200000
PO_85:
    buffer_load_dwordx4 v[152:155], v4, s[36:39], 0 offen offset:0 sc1
PO2_86:
    s_waitcnt vmcnt(0)
    v_cmp_ne_u64 vcc, s[94:95], v[154:155]
    s_cmp_lg_u64 vcc, -1
    s_cbranch_scc1 POD_87
    s_sleep 8
    s_sub_u32 s80, s80, 1
    s_cmp_lg_u32 s80, 0
    s_cbranch_scc1 PO_85
POD_87:
    s_setprio 3
    buffer_load_dwordx4 v[152:155], v4, s[36:39], 0 offen offset:0 sc1
    buffer_load_dwordx4 v[156:159], v4, s[36:39], 0 offen offset:1024 sc1
    s_sleep 4
    buffer_load_dwordx4 v[160:163], v4, s[36:39], 0 offen offset:0 sc1
    buffer_load_dwordx4 v[164:167], v4, s[36:39], 0 offen offset:1024 sc1
    s_sleep 4
    s_mov_b32 s80, 200000
PP_88:
    s_waitcnt vmcnt(2)
    v_cmp_ne_u64 vcc, s[94:95], v[154:155]
    v_cmp_ne_u64 s[84:85], s[94:95], v[158:159]
    s_or_b64 vcc, vcc, s[84:85]
    s_cmp_eq_u64 vcc, 0
    s_cbranch_scc1 PPO_90
    buffer_load_dwordx4 v[152:155], v4, s[36:39], 0 offen offset:0 sc1
    buffer_load_dwordx4 v[156:159], v4, s[36:39], 0 offen offset:1024 sc1
    s_waitcnt vmcnt(2)
    v_cmp_ne_u64 vcc, s[94:95], v[162:163]
    v_cmp_ne_u64 s[84:85], s[94:95], v[166:167]
    s_or_b64 vcc, vcc, s[84:85]
    s_cmp_eq_u64 vcc, 0
    s_cbranch_scc1 PPO_91
    buffer_load_dwordx4 v[160:163], v4, s[36:39], 0 offen offset:0 sc1
    buffer_load_dwordx4 v[164:167], v4, s[36:39], 0 offen offset:1024 sc1
    s_sub_u32 s80, s80, 1
    s_cmp_lg_u32 s80, 0
    s_cbranch_scc1 PP_88
PPO_90:
    v_mov_b32_dpp v136, v152 quad_perm:[0,0,0,0] row_mask:0xf bank_mask:0xf
    v_mov_b32_dpp v137, v153 quad_perm:[0,0,0,0] row_mask:0xf bank_mask:0xf
    v_mov_b32_dpp v138, v156 quad_perm:[0,0,0,0] row_mask:0xf bank_mask:0xf
    v_mov_b32_dpp v139, v157 quad_perm:[0,0,0,0] row_mask:0xf bank_mask:0xf
    v_mov_b32_dpp v140, v152 quad_perm:[1,1,1,1] row_mask:0xf bank_mask:0xf
    v_mov_b32_dpp v141, v153 quad_perm:[1,1,1,1] row_mask:0xf bank_mask:0xf
    v_mov_b32_dpp v142, v156 quad_perm:[1,1,1,1] row_mask:0xf bank_mask:0xf
    v_mov_b32_dpp v143, v157 quad_perm:[1,1,1,1] row_mask:0xf bank_mask:0xf
    v_mov_b32_dpp v144, v152 quad_perm:[2,2,2,2] row_mask:0xf bank_mask:0xf
    v_mov_b32_dpp v145, v153 quad_perm:[2,2,2,2] row_mask:0xf bank_mask:0xf
    v_mov_b32_dpp v146, v156 quad_perm:[2,2,2,2] row_mask:0xf bank_mask:0xf
    v_mov_b32_dpp v147, v157 quad_perm:[2,2,2,2] row_mask:0xf bank_mask:0xf
    v_mov_b32_dpp v148, v152 quad_perm:[3,3,3,3] row_mask:0xf bank_mask:0xf
    v_mov_b32_dpp v149, v153 quad_perm:[3,3,3,3] row_mask:0xf bank_mask:0xf
    v_mov_b32_dpp v150, v156 quad_perm:[3,3,3,3] row_mask:0xf bank_mask:0xf
    v_mov_b32_dpp v151, v157 quad_perm:[3,3,3,3] row_mask:0xf bank_mask:0xf
    s_branch PPD_89
PPO_91:
    v_mov_b32_dpp v136, v160 quad_perm:[0,0,0,0] row_mask:0xf bank_mask:0xf
    v_mov_b32_dpp v137, v161 quad_perm:[0,0,0,0] row_mask:0xf bank_mask:0xf
    v_mov_b32_dpp v138, v164 quad_perm:[0,0,0,0] row_mask:0xf bank_mask:0xf
    v_mov_b32_dpp v139, v165 quad_perm:[0,0,0,0] row_mask:0xf bank_mask:0xf
    v_mov_b32_dpp v140, v160 quad_perm:[1,1,1,1] row_mask:0xf bank_mask:0xf
    v_mov_b32_dpp v141, v161 quad_perm:[1,1,1,1] row_mask:0xf bank_mask:0xf
    v_mov_b32_dpp v142, v164 quad_perm:[1,1,1,1] row_mask:0xf bank_mask:0xf
    v_mov_b32_dpp v143, v165 quad_perm:[1,1,1,1] row_mask:0xf bank_mask:0xf
    v_mov_b32_dpp v144, v160 quad_perm:[2,2,2,2] row_mask:0xf bank_mask:0xf
    v_mov_b32_dpp v145, v161 quad_perm:[2,2,2,2] row_mask:0xf bank_mask:0xf
    v_mov_b32_dpp v146, v164 quad_perm:[2,2,2,2] row_mask:0xf bank_mask:0xf
    v_mov_b32_dpp v147, v165 quad_perm:[2,2,2,2] row_mask:0xf bank_mask:0xf
    v_mov_b32_dpp v148, v160 quad_perm:[3,3,3,3] row_mask:0xf bank_mask:0xf
    v_mov_b32_dpp v149, v161 quad_perm:[3,3,3,3] row_mask:0xf bank_mask:0xf
    v_mov_b32_dpp v150, v164 quad_perm:[3,3,3,3] row_mask:0xf bank_mask:0xf
    v_mov_b32_dpp v151, v165 quad_perm:[3,3,3,3] row_mask:0xf bank_mask:0xf
PPD_89:
S2M_76:
    s_nop 1
    v_mfma_f32_16x16x32_bf16 v[4:7], v[136:139], v[8:11], 0
    v_mfma_f32_16x16x32_bf16 v[4:7], v[140:143], v[40:43], v[4:7]
    v_mfma_f32_16x16x32_bf16 v[4:7], v[144:147], v[72:75], v[4:7]
    v_mfma_f32_16x16x32_bf16 v[4:7], v[148:151], v[104:107], v[4:7]
    v_mfma_f32_16x16x32_bf16 v[8:11], v[136:139], v[12:15], 0
    v_mfma_f32_16x16x32_bf16 v[8:11], v[140:143], v[44:47], v[8:11]
    v_mfma_f32_16x16x32_bf16 v[8:11], v[144:147], v[76:79], v[8:11]
    v_mfma_f32_16x16x32_bf16 v[8:11], v[148:151], v[108:111], v[8:11]
    v_mfma_f32_16x16x32_bf16 v[12:15], v[136:139], v[16:19], 0
    v_mfma_f32_16x16x32_bf16 v[12:15], v[140:143], v[48:51], v[12:15]
    v_mfma_f32_16x16x32_bf16 v[12:15], v[144:147], v[80:83], v[12:15]
    v_mfma_f32_16x16x32_bf16 v[12:15], v[148:151], v[112:115], v[12:15]
    v_mfma_f32_16x16x32_bf16 v[16:19], v[136:139], v[20:23], 0
    v_mfma_f32_16x16x32_bf16 v[16:19], v[140:143], v[52:55], v[16:19]
    v_mfma_f32_16x16x32_bf16 v[16:19], v[144:147], v[84:87], v[16:19]
    v_mfma_f32_16x16x32_bf16 v[16:19], v[148:151], v[116:119], v[16:19]
    v_mfma_f32_16x16x32_bf16 v[20:23], v[136:139], v[24:27], 0
    v_mfma_f32_16x16x32_bf16 v[20:23], v[140:143], v[56:59], v[20:23]
    v_mfma_f32_16x16x32_bf16 v[20:23], v[144:147], v[88:91], v[20:23]
    v_mfma_f32_16x16x32_bf16 v[20:23], v[148:151], v[120:123], v[20:23]
    v_mfma_f32_16x16x32_bf16 v[24:27], v[136:139], v[28:31], 0
    v_mfma_f32_16x16x32_bf16 v[24:27], v[140:143], v[60:63], v[24:27]
    v_mfma_f32_16x16x32_bf16 v[24:27], v[144:147], v[92:95], v[24:27]
    v_mfma_f32_16x16x32_bf16 v[24:27], v[148:151], v[124:127], v[24:27]
    v_mfma_f32_16x16x32_bf16 v[28:31], v[136:139], v[32:35], 0
    v_mfma_f32_16x16x32_bf16 v[28:31], v[140:143], v[64:67], v[28:31]
    v_mfma_f32_16x16x32_bf16 v[28:31], v[144:147], v[96:99], v[28:31]
    v_mfma_f32_16x16x32_bf16 v[28:31], v[148:151], v[128:131], v[28:31]
    v_mfma_f32_16x16x32_bf16 v[32:35], v[136:139], v[36:39], 0
    v_mfma_f32_16x16x32_bf16 v[32:35], v[140:143], v[68:71], v[32:35]
    v_mfma_f32_16x16x32_bf16 v[32:35], v[144:147], v[100:103], v[32:35]
    v_mfma_f32_16x16x32_bf16 v[32:35], v[148:151], v[132:135], v[32:35]
    v_mov_b32 v42, s94
    v_mov_b32 v43, s95
    v_cvt_pk_bf16_f32 v40, v4, v8
    v_cvt_pk_bf16_f32 v41, v12, v16
    buffer_store_dwordx4 v[40:43], v3, s[36:39], 0 offen sc1
    v_mov_b32 v46, s94
    v_mov_b32 v47, s95
    v_cvt_pk_bf16_f32 v44, v20, v24
    v_cvt_pk_bf16_f32 v45, v28, v32
    buffer_store_dwordx4 v[44:47], v3, s[36:39], s70 offen sc1
    s_endpgm
L_C:
    s_cmp_ge_u32 s3, 8
    s_cbranch_scc1 L_CSVC
    s_mov_b32 s44, s20
    s_and_b32 s45, s21, 0xffff
    s_mov_b32 s46, 0x1000000
    s_mov_b32 s47, 0x20000
    s_lshl_b32 s60, s4, 3
    s_add_u32 s60, s60, s5
    s_sub_u32 s60, s60, 8
    s_lshr_b32 s64, s3, 1
    s_and_b32 s65, s3, 1
    s_mov_b32 s67, 0x3e0293ee
    v_lshlrev_b32 v160, 4, v1
    s_and_b32 s7, s3, 3
    s_lshl_b32 s7, s7, 2
    s_lshr_b32 s66, s3, 2
    s_or_b32 s7, s7, s66
    s_lshl_b32 s7, s7, 4
    v_xor_b32 v2, s7, v160
    v_xor_b32 v3, 32, v2
    s_lshl_b32 s70, s60, 18
    s_lshl_b32 s68, s3, 10
    s_add_u32 s61, s70, s68
    s_mov_b32 m0, s68
    s_nop 0
    buffer_load_dwordx4 v2, s[44:47], s61 offen nt lds
    s_add_u32 s68, s68, 8192
    s_add_u32 s61, s61, 8192
    s_mov_b32 m0, s68
    s_nop 0
    buffer_load_dwordx4 v3, s[44:47], s61 offen nt lds
    s_add_u32 s68, s68, 8192
    s_add_u32 s61, s61, 8192
    s_mov_b32 m0, s68
    s_nop 0
    buffer_load_dwordx4 v2, s[44:47], s61 offen nt lds
    s_add_u32 s68, s68, 8192
    s_barrier
    s_add_u32 s61, s61, 8192
    s_mov_b32 m0, s68
    s_nop 0
    buffer_load_dwordx4 v3, s[44:47], s61 offen nt lds
    s_add_u32 s68, s68, 8192
    s_add_u32 s61, s61, 8192
    s_mov_b32 m0, s68
    s_waitcnt vmcnt(3)
    buffer_load_dwordx4 v2, s[44:47], s61 offen nt lds
    s_add_u32 s68, s68, 8192
    s_add_u32 s61, s61, 8192
    s_mov_b32 m0, s68
    s_waitcnt vmcnt(3)
    buffer_load_dwordx4 v3, s[44:47], s61 offen nt lds
    s_add_u32 s68, s68, 8192
    s_add_u32 s61, s61, 8192
    s_mov_b32 m0, s68
    s_waitcnt vmcnt(3)
    buffer_load_dwordx4 v2, s[44:47], s61 offen nt lds
    s_add_u32 s68, s68, 8192
    s_add_u32 s61, s61, 8192
    s_mov_b32 m0, s68
    s_waitcnt vmcnt(3)
    buffer_load_dwordx4 v3, s[44:47], s61 offen nt lds
    s_add_u32 s68, s68, 8192
    s_add_u32 s61, s61, 8192
    s_mov_b32 m0, s68
    s_waitcnt vmcnt(3)
    buffer_load_dwordx4 v2, s[44:47], s61 offen nt lds
    s_add_u32 s68, s68, 8192
    s_add_u32 s61, s61, 8192
    s_mov_b32 m0, s68
    s_waitcnt vmcnt(3)
    buffer_load_dwordx4 v3, s[44:47], s61 offen nt lds
    s_add_u32 s68, s68, 8192
    s_add_u32 s61, s61, 8192
    s_mov_b32 m0, s68
    s_waitcnt vmcnt(3)
    buffer_load_dwordx4 v2, s[44:47], s61 offen nt lds
    s_add_u32 s68, s68, 8192
    s_add_u32 s61, s61, 8192
    s_mov_b32 m0, s68
    s_waitcnt vmcnt(3)
    buffer_load_dwordx4 v3, s[44:47], s61 offen nt lds
    s_add_u32 s68, s68, 8192
    s_add_u32 s61, s61, 8192
    s_waitcnt vmcnt(3)
    buffer_load_dwordx4 v[128:131], v2, s[44:47], s61 offen nt
    s_add_u32 s61, s61, 8192
    s_waitcnt vmcnt(3)
    buffer_load_dwordx4 v[132:135], v3, s[44:47], s61 offen nt
    s_add_u32 s61, s61, 8192
    s_waitcnt vmcnt(3)
    buffer_load_dwordx4 v[136:139], v2, s[44:47], s61 offen nt
    s_add_u32 s61, s61, 8192
    s_waitcnt vmcnt(3)
    buffer_load_dwordx4 v[140:143], v3, s[44:47], s61 offen nt
    s_add_u32 s61, s61, 8192
    s_waitcnt vmcnt(3)
    buffer_load_dwordx4 v[96:99], v2, s[44:47], s61 offen nt
    s_add_u32 s61, s61, 8192
    s_waitcnt vmcnt(3)
    buffer_load_dwordx4 v[100:103], v3, s[44:47], s61 offen nt
    s_add_u32 s61, s61, 8192
    s_waitcnt vmcnt(3)
    buffer_load_dwordx4 v[104:107], v2, s[44:47], s61 offen nt
    s_add_u32 s61, s61, 8192
    s_waitcnt vmcnt(3)
    buffer_load_dwordx4 v[108:111], v3, s[44:47], s61 offen nt
    s_add_u32 s61, s61, 8192
    s_waitcnt vmcnt(3)
    buffer_load_dwordx4 v[112:115], v2, s[44:47], s61 offen nt
    s_add_u32 s61, s61, 8192
    s_waitcnt vmcnt(3)
    buffer_load_dwordx4 v[116:119], v3, s[44:47], s61 offen nt
    s_add_u32 s61, s61, 8192
    v_mov_b32 v160, 0x24018
    v_mov_b32 v161, 1
    s_waitcnt lgkmcnt(0)
    s_mov_b64 exec, 1
    ds_add_u32 v160, v161
    s_mov_b64 exec, -1
    s_waitcnt vmcnt(3)
    buffer_load_dwordx4 v[120:123], v2, s[44:47], s61 offen nt
    s_add_u32 s61, s61, 8192
    s_waitcnt vmcnt(3)
    buffer_load_dwordx4 v[124:127], v3, s[44:47], s61 offen nt
    s_add_u32 s61, s61, 8192
    v_and_b32 v160, 15, v1
    v_lshlrev_b32 v4, 10, v160
    v_lshrrev_b32 v161, 4, v1
    v_lshl_add_u32 v4, v161, 8, v4
    v_lshl_add_u32 v3, v160, 4, v4
    s_lshl_b32 s7, s65, 14
    s_add_u32 s7, s7, 0x18000
    v_add_u32 v3, s7, v3
    v_and_b32 v162, 3, v1
    v_lshl_add_u32 v4, v162, 6, v4
    v_bfe_u32 v162, v1, 2, 2
    v_lshl_add_u32 v4, v162, 4, v4
    s_lshl_b32 s7, s64, 14
    v_add_u32 v4, s7, v4
    v_add_u32 v2, 0x10000, v4
    s_lshl_b32 s7, s65, 6
    s_add_u32 s7, s7, 0x27200
    v_lshl_add_u32 v5, v160, 2, s7
    s_lshl_b32 s7, s64, 10
    s_lshl_b32 s66, s65, 9
    s_add_u32 s7, s7, s66
    s_add_u32 s7, s7, 0x25200
    v_lshl_add_u32 v6, v160, 5, s7
    v_lshl_add_u32 v6, v161, 3, v6
    v_and_b32 v162, 31, v1
    v_lshlrev_b32 v7, 5, v162
    v_lshrrev_b32 v163, 5, v1
    v_lshl_add_u32 v7, v163, 4, v7
    v_add_u32 v7, 0x25200, v7
    v_lshlrev_b32 v8, 2, v162
    v_add_u32 v8, 0x27e00, v8
    v_bfe_u32 v162, v1, 2, 2
    v_lshl_add_u32 v164, v163, 3, v162
    v_lshlrev_b32 v164, 10, v164
    v_and_b32 v165, 1, v1
    v_lshl_add_u32 v164, v165, 3, v164
    s_lshl_b32 s7, s64, 8
    v_add_u32 v164, s7, v164
    v_bfe_u32 v165, v1, 4, 1
    v_lshlrev_b32 v165, 1, v165
    v_bfe_u32 v160, v1, 1, 1
    v_or_b32 v165, v165, v160
    s_lshl_b32 s7, s65, 3
    v_or_b32 v165, s7, v165
    v_lshlrev_b32 v162, 2, v162
    v_xor_b32 v165, v165, v162
    v_lshlrev_b32 v163, 1, v163
    v_xor_b32 v165, v165, v163
    v_xor_b32 v160, 0, v165
    v_lshl_add_u32 v9, v160, 4, v164
    v_xor_b32 v160, 4, v165
    v_lshl_add_u32 v10, v160, 4, v164
    v_xor_b32 v160, 1, v165
    v_lshl_add_u32 v11, v160, 4, v164
    v_add_u32 v11, 0x1000, v11
    v_xor_b32 v160, 5, v165
    v_lshl_add_u32 v12, v160, 4, v164
    v_add_u32 v12, 0x1000, v12
    v_mov_b32 v13, 0xff800000
    v_mov_b32 v14, 0
    v_cmp_gt_u32 s[86:87], 16, v1
    s_cmp_eq_u32 s64, 0
    s_cselect_b32 s88, 0xffff, 0
    s_mov_b32 s89, 0
    v_mov_b32 v160, 0x24028
    s_mov_b32 s80, 1600000
LW_92:
    ds_read_b32 v161, v160
    s_waitcnt lgkmcnt(0)
    v_readfirstlane_b32 s79, v161
    s_cmp_ge_u32 s79, 4
    s_cbranch_scc1 LWD_93
    s_sleep 1
    s_sub_u32 s80, s80, 1
    s_cmp_lg_u32 s80, 0
    s_cbranch_scc1 LW_92
LWD_93:
    v_xor_b32 v160, 0x0, v3
    ds_read_b128 v[32:35], v160
    v_xor_b32 v161, 0x10, v3
    ds_read_b128 v[36:39], v161
    v_xor_b32 v160, 0x20, v3
    ds_read_b128 v[40:43], v160
    v_xor_b32 v161, 0x30, v3
    ds_read_b128 v[44:47], v161
    v_xor_b32 v160, 0x40, v3
    ds_read_b128 v[48:51], v160
    v_xor_b32 v161, 0x50, v3
    ds_read_b128 v[52:55], v161
    v_xor_b32 v160, 0x60, v3
    ds_read_b128 v[56:59], v160
    v_xor_b32 v161, 0x70, v3
    ds_read_b128 v[60:63], v161
    v_xor_b32 v160, 0x80, v3
    ds_read_b128 v[64:67], v160
    v_xor_b32 v161, 0x90, v3
    ds_read_b128 v[68:71], v161
    v_xor_b32 v160, 0xa0, v3
    ds_read_b128 v[72:75], v160
    v_xor_b32 v161, 0xb0, v3
    ds_read_b128 v[76:79], v161
    v_xor_b32 v160, 0xc0, v3
    ds_read_b128 v[80:83], v160
    v_xor_b32 v161, 0xd0, v3
    ds_read_b128 v[84:87], v161
    v_xor_b32 v160, 0xe0, v3
    ds_read_b128 v[88:91], v160
    v_xor_b32 v161, 0xf0, v3
    ds_read_b128 v[92:95], v161
    s_lshl_b32 s7, s3, 10
    s_add_u32 s7, s7, 0x18000
    v_lshl_add_u32 v3, v1, 4, s7
    v_mov_b32 v166, 0x24010
    v_mov_b32 v167, 1
    s_waitcnt lgkmcnt(0)
    s_mov_b64 exec, 1
    ds_add_u32 v166, v167
    s_mov_b64 exec, -1
    v_mov_b32 v166, 0x24010
    s_mov_b32 s80, 1600000
LW_94:
    ds_read_b32 v167, v166
    s_waitcnt lgkmcnt(0)
    v_readfirstlane_b32 s79, v167
    s_cmp_ge_u32 s79, 8
    s_cbranch_scc1 LWD_95
    s_sub_u32 s80, s80, 1
    s_cmp_lg_u32 s80, 0
    s_cbranch_scc1 LW_94
LWD_95:
    ds_write_b128 v3, v[128:131] offset:0
    ds_write_b128 v3, v[132:135] offset:8192
    ds_write_b128 v3, v[136:139] offset:16384
    ds_write_b128 v3, v[140:143] offset:24576
    v_mov_b32 v166, 0x24034
    v_mov_b32 v167, 1
    s_waitcnt lgkmcnt(0)
    s_mov_b64 exec, 1
    ds_add_u32 v166, v167
    s_mov_b64 exec, -1
    s_setprio 0
    v_xor_b32 v160, 0x0, v4
    ds_read_b128 v[24:27], v160
    v_xor_b32 v161, 0x10, v4
    ds_read_b128 v[28:31], v161
    v_xor_b32 v162, 0x20, v4
    ds_read_b128 v[164:167], v162
    v_xor_b32 v160, 0x30, v4
    ds_read_b128 v[128:131], v160
    v_xor_b32 v161, 0x40, v4
    ds_read_b128 v[132:135], v161
    v_xor_b32 v162, 0x50, v4
    ds_read_b128 v[136:139], v162
    v_xor_b32 v160, 0x60, v4
    ds_read_b128 v[140:143], v160
    s_waitcnt lgkmcnt(6)
    v_mfma_f32_16x16x32_bf16 v[16:19], v[24:27], v[32:35], 0
    v_xor_b32 v161, 0x70, v4
    ds_read_b128 v[24:27], v161
    s_waitcnt lgkmcnt(6)
    v_mfma_f32_16x16x32_bf16 v[16:19], v[28:31], v[36:39], v[16:19]
    v_xor_b32 v162, 0x80, v4
    ds_read_b128 v[28:31], v162
    s_waitcnt lgkmcnt(6)
    v_mfma_f32_16x16x32_bf16 v[16:19], v[164:167], v[40:43], v[16:19]
    v_xor_b32 v160, 0x90, v4
    ds_read_b128 v[164:167], v160
    s_waitcnt lgkmcnt(6)
    v_mfma_f32_16x16x32_bf16 v[16:19], v[128:131], v[44:47], v[16:19]
    v_xor_b32 v161, 0xa0, v4
    ds_read_b128 v[128:131], v161
    s_waitcnt lgkmcnt(6)
    v_mfma_f32_16x16x32_bf16 v[16:19], v[132:135], v[48:51], v[16:19]
    v_xor_b32 v162, 0xb0, v4
    ds_read_b128 v[132:135], v162
    s_waitcnt lgkmcnt(6)
    v_mfma_f32_16x16x32_bf16 v[16:19], v[136:139], v[52:55], v[16:19]
    v_xor_b32 v160, 0xc0, v4
    ds_read_b128 v[136:139], v160
    s_waitcnt lgkmcnt(6)
    v_mfma_f32_16x16x32_bf16 v[16:19], v[140:143], v[56:59], v[16:19]
    v_xor_b32 v161, 0xd0, v4
    ds_read_b128 v[140:143], v161
    s_waitcnt lgkmcnt(6)
    v_mfma_f32_16x16x32_bf16 v[16:19], v[24:27], v[60:63], v[16:19]
    v_xor_b32 v162, 0xe0, v4
    ds_read_b128 v[24:27], v162
    s_waitcnt lgkmcnt(6)
    v_mfma_f32_16x16x32_bf16 v[16:19], v[28:31], v[64:67], v[16:19]
    v_xor_b32 v160, 0xf0, v4
    ds_read_b128 v[28:31], v160
    s_waitcnt lgkmcnt(6)
    v_mfma_f32_16x16x32_bf16 v[16:19], v[164:167], v[68:71], v[16:19]
    s_waitcnt lgkmcnt(5)
    v_mfma_f32_16x16x32_bf16 v[16:19], v[128:131], v[72:75], v[16:19]
    s_waitcnt lgkmcnt(4)
    v_mfma_f32_16x16x32_bf16 v[16:19], v[132:135], v[76:79], v[16:19]
    s_waitcnt lgkmcnt(3)
    v_mfma_f32_16x16x32_bf16 v[16:19], v[136:139], v[80:83], v[16:19]
    s_waitcnt lgkmcnt(2)
    v_mfma_f32_16x16x32_bf16 v[16:19], v[140:143], v[84:87], v[16:19]
    s_waitcnt lgkmcnt(1)
    v_mfma_f32_16x16x32_bf16 v[16:19], v[24:27], v[88:91], v[16:19]
    s_waitcnt lgkmcnt(0)
    v_mfma_f32_16x16x32_bf16 v[16:19], v[28:31], v[92:95], v[16:19]
    v_mov_b32 v162, 0x24034
    s_mov_b32 s80, 1600000
LW_96:
    ds_read_b32 v163, v162
    s_waitcnt lgkmcnt(0)
    v_readfirstlane_b32 s79, v163
    s_cmp_ge_u32 s79, 8
    s_cbranch_scc1 LWD_97
    s_sub_u32 s80, s80, 1
    s_cmp_lg_u32 s80, 0
    s_cbranch_scc1 LW_96
LWD_97:
    v_xor_b32 v160, 0x0, v2
    ds_read_b128 v[24:27], v160
    v_xor_b32 v161, 0x10, v2
    ds_read_b128 v[28:31], v161
    v_xor_b32 v162, 0x20, v2
    ds_read_b128 v[164:167], v162
    v_xor_b32 v160, 0x30, v2
    ds_read_b128 v[128:131], v160
    v_xor_b32 v161, 0x40, v2
    ds_read_b128 v[132:135], v161
    v_xor_b32 v162, 0x50, v2
    ds_read_b128 v[136:139], v162
    v_xor_b32 v160, 0x60, v2
    ds_read_b128 v[140:143], v160
    s_waitcnt lgkmcnt(6)
    v_mfma_f32_16x16x32_bf16 v[20:23], v[24:27], v[32:35], 0
    v_xor_b32 v161, 0x70, v2
    ds_read_b128 v[24:27], v161
    s_waitcnt lgkmcnt(6)
    v_mfma_f32_16x16x32_bf16 v[20:23], v[28:31], v[36:39], v[20:23]
    v_xor_b32 v162, 0x80, v2
    ds_read_b128 v[28:31], v162
    s_waitcnt lgkmcnt(6)
    v_mfma_f32_16x16x32_bf16 v[20:23], v[164:167], v[40:43], v[20:23]
    v_xor_b32 v160, 0x90, v2
    ds_read_b128 v[164:167], v160
    s_waitcnt lgkmcnt(6)
    v_mfma_f32_16x16x32_bf16 v[20:23], v[128:131], v[44:47], v[20:23]
    v_xor_b32 v161, 0xa0, v2
    ds_read_b128 v[128:131], v161
    s_waitcnt lgkmcnt(6)
    v_mfma_f32_16x16x32_bf16 v[20:23], v[132:135], v[48:51], v[20:23]
    v_xor_b32 v162, 0xb0, v2
    ds_read_b128 v[132:135], v162
    s_waitcnt lgkmcnt(6)
    v_mfma_f32_16x16x32_bf16 v[20:23], v[136:139], v[52:55], v[20:23]
    v_xor_b32 v160, 0xc0, v2
    ds_read_b128 v[136:139], v160
    s_waitcnt lgkmcnt(6)
    v_mfma_f32_16x16x32_bf16 v[20:23], v[140:143], v[56:59], v[20:23]
    v_xor_b32 v161, 0xd0, v2
    ds_read_b128 v[140:143], v161
    s_waitcnt lgkmcnt(6)
    v_mfma_f32_16x16x32_bf16 v[20:23], v[24:27], v[60:63], v[20:23]
    v_xor_b32 v162, 0xe0, v2
    ds_read_b128 v[24:27], v162
    s_waitcnt lgkmcnt(6)
    v_mfma_f32_16x16x32_bf16 v[20:23], v[28:31], v[64:67], v[20:23]
    v_xor_b32 v160, 0xf0, v2
    ds_read_b128 v[28:31], v160
    s_waitcnt lgkmcnt(6)
    v_mfma_f32_16x16x32_bf16 v[20:23], v[164:167], v[68:71], v[20:23]
    s_waitcnt lgkmcnt(5)
    v_mfma_f32_16x16x32_bf16 v[20:23], v[128:131], v[72:75], v[20:23]
    s_waitcnt lgkmcnt(4)
    v_mfma_f32_16x16x32_bf16 v[20:23], v[132:135], v[76:79], v[20:23]
    s_waitcnt lgkmcnt(3)
    v_mfma_f32_16x16x32_bf16 v[20:23], v[136:139], v[80:83], v[20:23]
    s_waitcnt lgkmcnt(2)
    v_mfma_f32_16x16x32_bf16 v[20:23], v[140:143], v[84:87], v[20:23]
    s_waitcnt lgkmcnt(1)
    v_mfma_f32_16x16x32_bf16 v[20:23], v[24:27], v[88:91], v[20:23]
    s_waitcnt lgkmcnt(0)
    v_mfma_f32_16x16x32_bf16 v[20:23], v[28:31], v[92:95], v[20:23]
    v_max3_f32 v160, v16, v17, v18
    s_nop 6
    v_max3_f32 v160, v160, v19, v20
    v_max3_f32 v160, v160, v21, v22
    v_max_f32 v160, v160, v23
    v_mov_b32 v161, v160
    s_nop 1
    v_permlane32_swap_b32 v160, v161
    v_max_f32 v160, v160, v161
    v_mov_b32 v161, v160
    s_nop 1
    v_permlane16_swap_b32 v160, v161
    v_max_f32 v160, v160, v161
    s_lshl_b32 s7, s64, 7
    v_add_u32 v161, s7, v5
    s_mov_b64 exec, s[86:87]
    ds_write_b32 v161, v160
    s_mov_b64 exec, -1
    v_mov_b32 v166, 0x24010
    v_mov_b32 v167, 1
    s_waitcnt lgkmcnt(0)
    s_mov_b64 exec, 1
    ds_add_u32 v166, v167
    s_mov_b64 exec, -1
    v_mov_b32 v166, 0x24010
    s_mov_b32 s80, 1600000
LW_98:
    ds_read_b32 v167, v166
    s_waitcnt lgkmcnt(0)
    v_readfirstlane_b32 s79, v167
    s_cmp_ge_u32 s79, 16
    s_cbranch_scc1 LWD_99
    s_sub_u32 s80, s80, 1
    s_cmp_lg_u32 s80, 0
    s_cbranch_scc1 LW_98
LWD_99:
    ds_read_b32 v160, v5 offset:0
    ds_read_b32 v161, v5 offset:128
    ds_read_b32 v162, v5 offset:256
    ds_read_b32 v163, v5 offset:384
    s_waitcnt lgkmcnt(0)
    v_max3_f32 v160, v160, v161, v162
    v_max_f32 v160, v160, v163
    v_mul_f32 v160, s67, v160
    v_max_f32 v160, v160, v13
    v_sub_f32 v161, v13, v160
    v_exp_f32 v161, v161
    v_mov_b32 v13, v160
    v_fma_f32 v16, v16, s67, -v160
    v_fma_f32 v17, v17, s67, -v160
    v_fma_f32 v18, v18, s67, -v160
    v_fma_f32 v19, v19, s67, -v160
    v_fma_f32 v20, v20, s67, -v160
    v_fma_f32 v21, v21, s67, -v160
    v_fma_f32 v22, v22, s67, -v160
    v_fma_f32 v23, v23, s67, -v160
    v_exp_f32 v16, v16
    v_exp_f32 v17, v17
    v_exp_f32 v18, v18
    v_exp_f32 v19, v19
    v_exp_f32 v20, v20
    v_exp_f32 v21, v21
    v_exp_f32 v22, v22
    v_exp_f32 v23, v23
    v_cvt_pk_bf16_f32 v24, v16, v17
    v_cvt_pk_bf16_f32 v25, v18, v19
    v_cvt_pk_bf16_f32 v26, v20, v21
    v_cvt_pk_bf16_f32 v27, v22, v23
    ds_write_b64 v6, v[24:25]
    ds_write_b64 v6, v[26:27] offset:4096
    v_add_u32 v162, 0xc00, v5
    s_mov_b64 exec, s[88:89]
    ds_write_b32 v162, v161
    s_mov_b64 exec, -1
    v_mul_f32 v14, v14, v161
    v_add_f32 v16, v16, v20
    v_add_f32 v17, v17, v21
    v_add_f32 v18, v18, v22
    v_add_f32 v19, v19, v23
    v_add_f32 v16, v16, v18
    v_add_f32 v17, v17, v19
    v_add_f32 v16, v16, v17
    v_add_f32 v14, v14, v16
    v_mov_b32 v166, 0x24010
    v_mov_b32 v167, 1
    s_waitcnt lgkmcnt(0)
    s_mov_b64 exec, 1
    ds_add_u32 v166, v167
    s_mov_b64 exec, -1
    v_mov_b32 v166, 0x24010
    s_mov_b32 s80, 1600000
LW_100:
    ds_read_b32 v167, v166
    s_waitcnt lgkmcnt(0)
    v_readfirstlane_b32 s79, v167
    s_cmp_ge_u32 s79, 24
    s_cbranch_scc1 LWD_101
    s_sub_u32 s80, s80, 1
    s_cmp_lg_u32 s80, 0
    s_cbranch_scc1 LW_100
LWD_101:
    ds_read_b128 v[16:19], v7 offset:0
    ds_read_b64_tr_b16 v[24:25], v9 offset:0
    ds_read_b64_tr_b16 v[26:27], v11 offset:0
    ds_read_b64_tr_b16 v[28:29], v10 offset:0
    ds_read_b64_tr_b16 v[30:31], v12 offset:0
    ds_read_b128 v[20:23], v7 offset:1024
    ds_read_b64_tr_b16 v[160:161], v9 offset:16384
    ds_read_b64_tr_b16 v[162:163], v11 offset:16384
    ds_read_b64_tr_b16 v[164:165], v10 offset:16384
    ds_read_b64_tr_b16 v[166:167], v12 offset:16384
    s_waitcnt lgkmcnt(7)
    v_mfma_f32_32x32x16_bf16 v[128:143], v[24:27], v[16:19], 0
    s_waitcnt lgkmcnt(5)
    v_mfma_f32_32x32x16_bf16 v[144:159], v[28:31], v[16:19], 0
    ds_read_b128 v[16:19], v7 offset:2048
    ds_read_b64_tr_b16 v[24:25], v9 offset:32768
    ds_read_b64_tr_b16 v[26:27], v11 offset:32768
    ds_read_b64_tr_b16 v[28:29], v10 offset:32768
    ds_read_b64_tr_b16 v[30:31], v12 offset:32768
    s_waitcnt lgkmcnt(7)
    v_mfma_f32_32x32x16_bf16 v[128:143], v[160:163], v[20:23], v[128:143]
    s_waitcnt lgkmcnt(5)
    v_mfma_f32_32x32x16_bf16 v[144:159], v[164:167], v[20:23], v[144:159]
    ds_read_b128 v[20:23], v7 offset:3072
    ds_read_b64_tr_b16 v[160:161], v9 offset:49152
    ds_read_b64_tr_b16 v[162:163], v11 offset:49152
    ds_read_b64_tr_b16 v[164:165], v10 offset:49152
    ds_read_b64_tr_b16 v[166:167], v12 offset:49152
    s_waitcnt lgkmcnt(7)
    v_mfma_f32_32x32x16_bf16 v[128:143], v[24:27], v[16:19], v[128:143]
    s_waitcnt lgkmcnt(5)
    v_mfma_f32_32x32x16_bf16 v[144:159], v[28:31], v[16:19], v[144:159]
    v_add_u32 v9, 0x10000, v9
    v_add_u32 v10, 0x10000, v10
    v_add_u32 v11, 0x10000, v11
    v_add_u32 v12, 0x10000, v12
    ds_read_b128 v[16:19], v7 offset:4096
    ds_read_b64_tr_b16 v[24:25], v9 offset:0
    ds_read_b64_tr_b16 v[26:27], v11 offset:0
    ds_read_b64_tr_b16 v[28:29], v10 offset:0
    ds_read_b64_tr_b16 v[30:31], v12 offset:0
    s_waitcnt lgkmcnt(7)
    v_mfma_f32_32x32x16_bf16 v[128:143], v[160:163], v[20:23], v[128:143]
    s_waitcnt lgkmcnt(5)
    v_mfma_f32_32x32x16_bf16 v[144:159], v[164:167], v[20:23], v[144:159]
    ds_read_b128 v[20:23], v7 offset:5120
    ds_read_b64_tr_b16 v[160:161], v9 offset:16384
    ds_read_b64_tr_b16 v[162:163], v11 offset:16384
    ds_read_b64_tr_b16 v[164:165], v10 offset:16384
    ds_read_b64_tr_b16 v[166:167], v12 offset:16384
    s_waitcnt lgkmcnt(7)
    v_mfma_f32_32x32x16_bf16 v[128:143], v[24:27], v[16:19], v[128:143]
    s_waitcnt lgkmcnt(5)
    v_mfma_f32_32x32x16_bf16 v[144:159], v[28:31], v[16:19], v[144:159]
    v_mov_b32 v3, 0x24038
    v_mov_b32 v15, 1
    s_mov_b64 exec, 1
    ds_add_u32 v3, v15
    s_mov_b64 exec, -1
    ds_read_b128 v[16:19], v7 offset:6144
    ds_read_b64_tr_b16 v[24:25], v9 offset:32768
    ds_read_b64_tr_b16 v[26:27], v11 offset:32768
    ds_read_b64_tr_b16 v[28:29], v10 offset:32768
    ds_read_b64_tr_b16 v[30:31], v12 offset:32768
    s_waitcnt lgkmcnt(7)
    v_mfma_f32_32x32x16_bf16 v[128:143], v[160:163], v[20:23], v[128:143]
    s_waitcnt lgkmcnt(5)
    v_mfma_f32_32x32x16_bf16 v[144:159], v[164:167], v[20:23], v[144:159]
    ds_read_b128 v[20:23], v7 offset:7168
    ds_read_b64_tr_b16 v[160:161], v9 offset:49152
    ds_read_b64_tr_b16 v[162:163], v11 offset:49152
    ds_read_b64_tr_b16 v[164:165], v10 offset:49152
    ds_read_b64_tr_b16 v[166:167], v12 offset:49152
    s_waitcnt lgkmcnt(7)
    v_mfma_f32_32x32x16_bf16 v[128:143], v[24:27], v[16:19], v[128:143]
    s_waitcnt lgkmcnt(5)
    v_mfma_f32_32x32x16_bf16 v[144:159], v[28:31], v[16:19], v[144:159]
    s_waitcnt lgkmcnt(2)
    v_mfma_f32_32x32x16_bf16 v[128:143], v[160:163], v[20:23], v[128:143]
    s_waitcnt lgkmcnt(0)
    v_mfma_f32_32x32x16_bf16 v[144:159], v[164:167], v[20:23], v[144:159]
    v_add_u32 v9, 0xffff0000, v9
    v_add_u32 v10, 0xffff0000, v10
    v_add_u32 v11, 0xffff0000, v11
    v_add_u32 v12, 0xffff0000, v12
    v_mov_b32 v162, 0x2402c
    v_mov_b32 v163, 1
    s_waitcnt lgkmcnt(0)
    s_mov_b64 exec, 1
    ds_add_u32 v162, v163
    s_mov_b64 exec, -1
    s_lshl_b32 s7, s3, 10
    s_add_u32 s7, s7, 0x10000
    v_lshl_add_u32 v160, v1, 4, s7
    s_waitcnt vmcnt(0)
    v_mov_b32 v162, 0x2402c
    s_mov_b32 s80, 1600000
LW_102:
    ds_read_b32 v163, v162
    s_waitcnt lgkmcnt(0)
    v_readfirstlane_b32 s79, v163
    s_cmp_ge_u32 s79, 8
    s_cbranch_scc1 LWD_103
    s_sub_u32 s80, s80, 1
    s_cmp_lg_u32 s80, 0
    s_cbranch_scc1 LW_102
LWD_103:
    ds_write_b128 v160, v[96:99] offset:0
    ds_write_b128 v160, v[100:103] offset:8192
    ds_write_b128 v160, v[104:107] offset:16384
    ds_write_b128 v160, v[108:111] offset:24576
    ds_write_b128 v160, v[112:115] offset:32768
    ds_write_b128 v160, v[116:119] offset:40960
    ds_write_b128 v160, v[120:123] offset:49152
    ds_write_b128 v160, v[124:127] offset:57344
    v_mov_b32 v162, 0x2403c
    v_mov_b32 v163, 1
    s_waitcnt lgkmcnt(0)
    s_mov_b64 exec, 1
    ds_add_u32 v162, v163
    s_mov_b64 exec, -1
    v_mov_b32 v162, 0x24030
    s_mov_b32 s80, 1600000
LW_104:
    ds_read_b32 v163, v162
    s_waitcnt lgkmcnt(0)
    v_readfirstlane_b32 s79, v163
    s_cmp_ge_u32 s79, 4
    s_cbranch_scc1 LWD_105
    s_sub_u32 s80, s80, 1
    s_cmp_lg_u32 s80, 0
    s_cbranch_scc1 LW_104
LWD_105:
    v_xor_b32 v160, 0x0, v4
    ds_read_b128 v[24:27], v160
    v_xor_b32 v161, 0x10, v4
    ds_read_b128 v[28:31], v161
    v_xor_b32 v162, 0x20, v4
    ds_read_b128 v[164:167], v162
    v_xor_b32 v160, 0x30, v4
    ds_read_b128 v[96:99], v160
    v_xor_b32 v161, 0x40, v4
    ds_read_b128 v[100:103], v161
    v_xor_b32 v162, 0x50, v4
    ds_read_b128 v[104:107], v162
    v_xor_b32 v160, 0x60, v4
    ds_read_b128 v[108:111], v160
    s_waitcnt lgkmcnt(6)
    v_mfma_f32_16x16x32_bf16 v[16:19], v[24:27], v[32:35], 0
    v_xor_b32 v161, 0x70, v4
    ds_read_b128 v[24:27], v161
    s_waitcnt lgkmcnt(6)
    v_mfma_f32_16x16x32_bf16 v[16:19], v[28:31], v[36:39], v[16:19]
    v_xor_b32 v162, 0x80, v4
    ds_read_b128 v[28:31], v162
    s_waitcnt lgkmcnt(6)
    v_mfma_f32_16x16x32_bf16 v[16:19], v[164:167], v[40:43], v[16:19]
    v_xor_b32 v160, 0x90, v4
    ds_read_b128 v[164:167], v160
    s_waitcnt lgkmcnt(6)
    v_mfma_f32_16x16x32_bf16 v[16:19], v[96:99], v[44:47], v[16:19]
    v_xor_b32 v161, 0xa0, v4
    ds_read_b128 v[96:99], v161
    s_waitcnt lgkmcnt(6)
    v_mfma_f32_16x16x32_bf16 v[16:19], v[100:103], v[48:51], v[16:19]
    v_xor_b32 v162, 0xb0, v4
    ds_read_b128 v[100:103], v162
    s_waitcnt lgkmcnt(6)
    v_mfma_f32_16x16x32_bf16 v[16:19], v[104:107], v[52:55], v[16:19]
    v_xor_b32 v160, 0xc0, v4
    ds_read_b128 v[104:107], v160
    s_waitcnt lgkmcnt(6)
    v_mfma_f32_16x16x32_bf16 v[16:19], v[108:111], v[56:59], v[16:19]
    v_xor_b32 v161, 0xd0, v4
    ds_read_b128 v[108:111], v161
    s_waitcnt lgkmcnt(6)
    v_mfma_f32_16x16x32_bf16 v[16:19], v[24:27], v[60:63], v[16:19]
    v_xor_b32 v162, 0xe0, v4
    ds_read_b128 v[24:27], v162
    s_waitcnt lgkmcnt(6)
    v_mfma_f32_16x16x32_bf16 v[16:19], v[28:31], v[64:67], v[16:19]
    v_xor_b32 v160, 0xf0, v4
    ds_read_b128 v[28:31], v160
    s_waitcnt lgkmcnt(6)
    v_mfma_f32_16x16x32_bf16 v[16:19], v[164:167], v[68:71], v[16:19]
    s_waitcnt lgkmcnt(5)
    v_mfma_f32_16x16x32_bf16 v[16:19], v[96:99], v[72:75], v[16:19]
    s_waitcnt lgkmcnt(4)
    v_mfma_f32_16x16x32_bf16 v[16:19], v[100:103], v[76:79], v[16:19]
    s_waitcnt lgkmcnt(3)
    v_mfma_f32_16x16x32_bf16 v[16:19], v[104:107], v[80:83], v[16:19]
    s_waitcnt lgkmcnt(2)
    v_mfma_f32_16x16x32_bf16 v[16:19], v[108:111], v[84:87], v[16:19]
    s_waitcnt lgkmcnt(1)
    v_mfma_f32_16x16x32_bf16 v[16:19], v[24:27], v[88:91], v[16:19]
    s_waitcnt lgkmcnt(0)
    v_mfma_f32_16x16x32_bf16 v[16:19], v[28:31], v[92:95], v[16:19]
    v_mov_b32 v162, 0x2403c
    s_mov_b32 s80, 1600000
LW_106:
    ds_read_b32 v163, v162
    s_waitcnt lgkmcnt(0)
    v_readfirstlane_b32 s79, v163
    s_cmp_ge_u32 s79, 8
    s_cbranch_scc1 LWD_107
    s_sub_u32 s80, s80, 1
    s_cmp_lg_u32 s80, 0
    s_cbranch_scc1 LW_106
LWD_107:
    v_xor_b32 v160, 0x0, v2
    ds_read_b128 v[24:27], v160
    v_xor_b32 v161, 0x10, v2
    ds_read_b128 v[28:31], v161
    v_xor_b32 v162, 0x20, v2
    ds_read_b128 v[164:167], v162
    v_xor_b32 v160, 0x30, v2
    ds_read_b128 v[96:99], v160
    v_xor_b32 v161, 0x40, v2
    ds_read_b128 v[100:103], v161
    v_xor_b32 v162, 0x50, v2
    ds_read_b128 v[104:107], v162
    v_xor_b32 v160, 0x60, v2
    ds_read_b128 v[108:111], v160
    s_waitcnt lgkmcnt(6)
    v_mfma_f32_16x16x32_bf16 v[20:23], v[24:27], v[32:35], 0
    v_xor_b32 v161, 0x70, v2
    ds_read_b128 v[24:27], v161
    s_waitcnt lgkmcnt(6)
    v_mfma_f32_16x16x32_bf16 v[20:23], v[28:31], v[36:39], v[20:23]
    v_xor_b32 v162, 0x80, v2
    ds_read_b128 v[28:31], v162
    s_waitcnt lgkmcnt(6)
    v_mfma_f32_16x16x32_bf16 v[20:23], v[164:167], v[40:43], v[20:23]
    v_xor_b32 v160, 0x90, v2
    ds_read_b128 v[164:167], v160
    s_waitcnt lgkmcnt(6)
    v_mfma_f32_16x16x32_bf16 v[20:23], v[96:99], v[44:47], v[20:23]
    v_xor_b32 v161, 0xa0, v2
    ds_read_b128 v[96:99], v161
    s_waitcnt lgkmcnt(6)
    v_mfma_f32_16x16x32_bf16 v[20:23], v[100:103], v[48:51], v[20:23]
    v_xor_b32 v162, 0xb0, v2
    ds_read_b128 v[100:103], v162
    s_waitcnt lgkmcnt(6)
    v_mfma_f32_16x16x32_bf16 v[20:23], v[104:107], v[52:55], v[20:23]
    v_xor_b32 v160, 0xc0, v2
    ds_read_b128 v[104:107], v160
    s_waitcnt lgkmcnt(6)
    v_mfma_f32_16x16x32_bf16 v[20:23], v[108:111], v[56:59], v[20:23]
    v_xor_b32 v161, 0xd0, v2
    ds_read_b128 v[108:111], v161
    s_waitcnt lgkmcnt(6)
    v_mfma_f32_16x16x32_bf16 v[20:23], v[24:27], v[60:63], v[20:23]
    v_xor_b32 v162, 0xe0, v2
    ds_read_b128 v[24:27], v162
    s_waitcnt lgkmcnt(6)
    v_mfma_f32_16x16x32_bf16 v[20:23], v[28:31], v[64:67], v[20:23]
    v_xor_b32 v160, 0xf0, v2
    ds_read_b128 v[28:31], v160
    s_waitcnt lgkmcnt(6)
    v_mfma_f32_16x16x32_bf16 v[20:23], v[164:167], v[68:71], v[20:23]
    s_waitcnt lgkmcnt(5)
    v_mfma_f32_16x16x32_bf16 v[20:23], v[96:99], v[72:75], v[20:23]
    s_waitcnt lgkmcnt(4)
    v_mfma_f32_16x16x32_bf16 v[20:23], v[100:103], v[76:79], v[20:23]
    s_waitcnt lgkmcnt(3)
    v_mfma_f32_16x16x32_bf16 v[20:23], v[104:107], v[80:83], v[20:23]
    s_waitcnt lgkmcnt(2)
    v_mfma_f32_16x16x32_bf16 v[20:23], v[108:111], v[84:87], v[20:23]
    s_waitcnt lgkmcnt(1)
    v_mfma_f32_16x16x32_bf16 v[20:23], v[24:27], v[88:91], v[20:23]
    s_waitcnt lgkmcnt(0)
    v_mfma_f32_16x16x32_bf16 v[20:23], v[28:31], v[92:95], v[20:23]
    v_max3_f32 v160, v16, v17, v18
    s_nop 6
    v_max3_f32 v160, v160, v19, v20
    v_max3_f32 v160, v160, v21, v22
    v_max_f32 v160, v160, v23
    v_mov_b32 v161, v160
    s_nop 1
    v_permlane32_swap_b32 v160, v161
    v_max_f32 v160, v160, v161
    v_mov_b32 v161, v160
    s_nop 1
    v_permlane16_swap_b32 v160, v161
    v_max_f32 v160, v160, v161
    s_lshl_b32 s7, s64, 7
    v_add_u32 v161, s7, v5
    s_mov_b64 exec, s[86:87]
    ds_write_b32 v161, v160
    s_mov_b64 exec, -1
    v_mov_b32 v166, 0x24010
    v_mov_b32 v167, 1
    s_waitcnt lgkmcnt(0)
    s_mov_b64 exec, 1
    ds_add_u32 v166, v167
    s_mov_b64 exec, -1
    v_mov_b32 v166, 0x24010
    s_mov_b32 s80, 1600000
LW_108:
    ds_read_b32 v167, v166
    s_waitcnt lgkmcnt(0)
    v_readfirstlane_b32 s79, v167
    s_cmp_ge_u32 s79, 32
    s_cbranch_scc1 LWD_109
    s_sub_u32 s80, s80, 1
    s_cmp_lg_u32 s80, 0
    s_cbranch_scc1 LW_108
LWD_109:
    ds_read_b32 v160, v5 offset:0
    ds_read_b32 v161, v5 offset:128
    ds_read_b32 v162, v5 offset:256
    ds_read_b32 v163, v5 offset:384
    s_waitcnt lgkmcnt(0)
    v_max3_f32 v160, v160, v161, v162
    v_max_f32 v160, v160, v163
    v_mul_f32 v160, s67, v160
    v_max_f32 v160, v160, v13
    v_sub_f32 v161, v13, v160
    v_exp_f32 v161, v161
    v_mov_b32 v13, v160
    v_fma_f32 v16, v16, s67, -v160
    v_fma_f32 v17, v17, s67, -v160
    v_fma_f32 v18, v18, s67, -v160
    v_fma_f32 v19, v19, s67, -v160
    v_fma_f32 v20, v20, s67, -v160
    v_fma_f32 v21, v21, s67, -v160
    v_fma_f32 v22, v22, s67, -v160
    v_fma_f32 v23, v23, s67, -v160
    v_exp_f32 v16, v16
    v_exp_f32 v17, v17
    v_exp_f32 v18, v18
    v_exp_f32 v19, v19
    v_exp_f32 v20, v20
    v_exp_f32 v21, v21
    v_exp_f32 v22, v22
    v_exp_f32 v23, v23
    v_cvt_pk_bf16_f32 v24, v16, v17
    v_cvt_pk_bf16_f32 v25, v18, v19
    v_cvt_pk_bf16_f32 v26, v20, v21
    v_cvt_pk_bf16_f32 v27, v22, v23
    ds_write_b64 v6, v[24:25]
    ds_write_b64 v6, v[26:27] offset:4096
    v_add_u32 v162, 0xc00, v5
    s_mov_b64 exec, s[88:89]
    ds_write_b32 v162, v161
    s_mov_b64 exec, -1
    v_mul_f32 v14, v14, v161
    v_add_f32 v16, v16, v20
    v_add_f32 v17, v17, v21
    v_add_f32 v18, v18, v22
    v_add_f32 v19, v19, v23
    v_add_f32 v16, v16, v18
    v_add_f32 v17, v17, v19
    v_add_f32 v16, v16, v17
    v_add_f32 v14, v14, v16
    v_mov_b32 v160, v14
    s_nop 1
    v_permlane32_swap_b32 v14, v160
    v_add_f32 v14, v14, v160
    v_mov_b32 v160, v14
    s_nop 1
    v_permlane16_swap_b32 v14, v160
    v_add_f32 v14, v14, v160
    s_lshl_b32 s7, s64, 7
    s_add_u32 s7, s7, 0x200
    v_add_u32 v161, s7, v5
    v_add_u32 v162, 0xc80, v5
    s_mov_b64 exec, s[86:87]
    ds_write_b32 v161, v14
    s_mov_b64 exec, s[88:89]
    ds_write_b32 v162, v13
    s_mov_b64 exec, -1
    v_and_b32 v160, 31, v1
    v_lshlrev_b32 v98, 7, v160
    v_lshrrev_b32 v161, 5, v1
    v_and_b32 v160, 7, v1
    v_xor_b32 v161, v160, v161
    v_lshl_add_u32 v98, v161, 4, v98
    s_lshl_b32 s7, s3, 12
    v_add_u32 v98, s7, v98
    v_lshl_add_u32 v99, v1, 4, s7
    v_lshrrev_b32 v161, 3, v1
    v_xor_b32 v160, v160, v161
    v_lshlrev_b32 v100, 7, v161
    v_lshl_add_u32 v100, v160, 4, v100
    s_lshl_b32 s69, s60, 15
    s_add_u32 s69, s69, s7
    s_add_u32 s69, s69, 0x500000
    v_mov_b32 v166, 0x24010
    v_mov_b32 v167, 1
    s_waitcnt lgkmcnt(0)
    s_mov_b64 exec, 1
    ds_add_u32 v166, v167
    s_mov_b64 exec, -1
    v_mov_b32 v166, 0x24010
    s_mov_b32 s80, 1600000
LW_110:
    ds_read_b32 v167, v166
    s_waitcnt lgkmcnt(0)
    v_readfirstlane_b32 s79, v167
    s_cmp_ge_u32 s79, 40
    s_cbranch_scc1 LWD_111
    s_sub_u32 s80, s80, 1
    s_cmp_lg_u32 s80, 0
    s_cbranch_scc1 LW_110
LWD_111:
    ds_read_b32 v15, v8
    ds_read_b128 v[16:19], v7 offset:0
    ds_read_b64_tr_b16 v[24:25], v9 offset:0
    ds_read_b64_tr_b16 v[26:27], v11 offset:0
    ds_read_b64_tr_b16 v[28:29], v10 offset:0
    ds_read_b64_tr_b16 v[30:31], v12 offset:0
    s_waitcnt lgkmcnt(5)
    v_mul_f32 v128, v15, v128
    v_mul_f32 v129, v15, v129
    v_mul_f32 v130, v15, v130
    v_mul_f32 v131, v15, v131
    v_mul_f32 v132, v15, v132
    v_mul_f32 v133, v15, v133
    v_mul_f32 v134, v15, v134
    v_mul_f32 v135, v15, v135
    v_mul_f32 v136, v15, v136
    v_mul_f32 v137, v15, v137
    v_mul_f32 v138, v15, v138
    v_mul_f32 v139, v15, v139
    v_mul_f32 v140, v15, v140
    v_mul_f32 v141, v15, v141
    v_mul_f32 v142, v15, v142
    v_mul_f32 v143, v15, v143
    v_mul_f32 v144, v15, v144
    v_mul_f32 v145, v15, v145
    v_mul_f32 v146, v15, v146
    v_mul_f32 v147, v15, v147
    v_mul_f32 v148, v15, v148
    v_mul_f32 v149, v15, v149
    v_mul_f32 v150, v15, v150
    v_mul_f32 v151, v15, v151
    v_mul_f32 v152, v15, v152
    v_mul_f32 v153, v15, v153
    v_mul_f32 v154, v15, v154
    v_mul_f32 v155, v15, v155
    v_mul_f32 v156, v15, v156
    v_mul_f32 v157, v15, v157
    v_mul_f32 v158, v15, v158
    v_mul_f32 v159, v15, v159
    ds_read_b128 v[20:23], v7 offset:1024
    ds_read_b64_tr_b16 v[160:161], v9 offset:16384
    ds_read_b64_tr_b16 v[162:163], v11 offset:16384
    ds_read_b64_tr_b16 v[164:165], v10 offset:16384
    ds_read_b64_tr_b16 v[166:167], v12 offset:16384
    s_waitcnt lgkmcnt(7)
    v_mfma_f32_32x32x16_bf16 v[128:143], v[24:27], v[16:19], v[128:143]
    s_waitcnt lgkmcnt(5)
    v_mfma_f32_32x32x16_bf16 v[144:159], v[28:31], v[16:19], v[144:159]
    ds_read_b128 v[16:19], v7 offset:2048
    ds_read_b64_tr_b16 v[24:25], v9 offset:32768
    ds_read_b64_tr_b16 v[26:27], v11 offset:32768
    ds_read_b64_tr_b16 v[28:29], v10 offset:32768
    ds_read_b64_tr_b16 v[30:31], v12 offset:32768
    s_waitcnt lgkmcnt(7)
    v_mfma_f32_32x32x16_bf16 v[128:143], v[160:163], v[20:23], v[128:143]
    s_waitcnt lgkmcnt(5)
    v_mfma_f32_32x32x16_bf16 v[144:159], v[164:167], v[20:23], v[144:159]
    ds_read_b128 v[20:23], v7 offset:3072
    ds_read_b64_tr_b16 v[160:161], v9 offset:49152
    ds_read_b64_tr_b16 v[162:163], v11 offset:49152
    ds_read_b64_tr_b16 v[164:165], v10 offset:49152
    ds_read_b64_tr_b16 v[166:167], v12 offset:49152
    s_waitcnt lgkmcnt(7)
    v_mfma_f32_32x32x16_bf16 v[128:143], v[24:27], v[16:19], v[128:143]
    s_waitcnt lgkmcnt(5)
    v_mfma_f32_32x32x16_bf16 v[144:159], v[28:31], v[16:19], v[144:159]
    v_add_u32 v9, 0x10000, v9
    v_add_u32 v10, 0x10000, v10
    v_add_u32 v11, 0x10000, v11
    v_add_u32 v12, 0x10000, v12
    ds_read_b128 v[16:19], v7 offset:4096
    ds_read_b64_tr_b16 v[24:25], v9 offset:0
    ds_read_b64_tr_b16 v[26:27], v11 offset:0
    ds_read_b64_tr_b16 v[28:29], v10 offset:0
    ds_read_b64_tr_b16 v[30:31], v12 offset:0
    s_waitcnt lgkmcnt(7)
    v_mfma_f32_32x32x16_bf16 v[128:143], v[160:163], v[20:23], v[128:143]
    s_waitcnt lgkmcnt(5)
    v_mfma_f32_32x32x16_bf16 v[144:159], v[164:167], v[20:23], v[144:159]
    ds_read_b128 v[20:23], v7 offset:5120
    ds_read_b64_tr_b16 v[160:161], v9 offset:16384
    ds_read_b64_tr_b16 v[162:163], v11 offset:16384
    ds_read_b64_tr_b16 v[164:165], v10 offset:16384
    ds_read_b64_tr_b16 v[166:167], v12 offset:16384
    s_waitcnt lgkmcnt(7)
    v_mfma_f32_32x32x16_bf16 v[128:143], v[24:27], v[16:19], v[128:143]
    s_waitcnt lgkmcnt(5)
    v_mfma_f32_32x32x16_bf16 v[144:159], v[28:31], v[16:19], v[144:159]
    v_mov_b32 v3, 0x24024
    v_mov_b32 v15, 1
    s_mov_b64 exec, 1
    ds_add_u32 v3, v15
    s_mov_b64 exec, -1
    ds_read_b128 v[16:19], v7 offset:6144
    ds_read_b64_tr_b16 v[24:25], v9 offset:32768
    ds_read_b64_tr_b16 v[26:27], v11 offset:32768
    ds_read_b64_tr_b16 v[28:29], v10 offset:32768
    ds_read_b64_tr_b16 v[30:31], v12 offset:32768
    s_waitcnt lgkmcnt(7)
    v_mfma_f32_32x32x16_bf16 v[128:143], v[160:163], v[20:23], v[128:143]
    s_waitcnt lgkmcnt(5)
    v_mfma_f32_32x32x16_bf16 v[144:159], v[164:167], v[20:23], v[144:159]
    ds_read_b128 v[20:23], v7 offset:7168
    ds_read_b64_tr_b16 v[160:161], v9 offset:49152
    ds_read_b64_tr_b16 v[162:163], v11 offset:49152
    ds_read_b64_tr_b16 v[164:165], v10 offset:49152
    ds_read_b64_tr_b16 v[166:167], v12 offset:49152
    s_waitcnt lgkmcnt(7)
    v_mfma_f32_32x32x16_bf16 v[128:143], v[24:27], v[16:19], v[128:143]
    s_waitcnt lgkmcnt(5)
    v_mfma_f32_32x32x16_bf16 v[144:159], v[28:31], v[16:19], v[144:159]
    s_waitcnt lgkmcnt(2)
    v_mfma_f32_32x32x16_bf16 v[128:143], v[160:163], v[20:23], v[128:143]
    s_waitcnt lgkmcnt(0)
    v_mfma_f32_32x32x16_bf16 v[144:159], v[164:167], v[20:23], v[144:159]
    v_mov_b32 v166, 0x24024
    s_mov_b32 s80, 1600000
LW_112:
    ds_read_b32 v167, v166
    s_waitcnt lgkmcnt(0)
    v_readfirstlane_b32 s79, v167
    s_cmp_ge_u32 s79, 8
    s_cbranch_scc1 LWD_113
    s_sub_u32 s80, s80, 1
    s_cmp_lg_u32 s80, 0
    s_cbranch_scc1 LW_112
LWD_113:
    v_permlane32_swap_b32 v128, v132
    v_permlane32_swap_b32 v129, v133
    v_permlane32_swap_b32 v130, v134
    v_permlane32_swap_b32 v131, v135
    v_cvt_pk_bf16_f32 v16, v128, v129
    v_cvt_pk_bf16_f32 v17, v130, v131
    v_cvt_pk_bf16_f32 v18, v132, v133
    v_cvt_pk_bf16_f32 v19, v134, v135
    v_xor_b32 v160, 0x0, v98
    ds_write_b128 v160, v[16:19]
    v_permlane32_swap_b32 v136, v140
    v_permlane32_swap_b32 v137, v141
    v_permlane32_swap_b32 v138, v142
    v_permlane32_swap_b32 v139, v143
    v_cvt_pk_bf16_f32 v20, v136, v137
    v_cvt_pk_bf16_f32 v21, v138, v139
    v_cvt_pk_bf16_f32 v22, v140, v141
    v_cvt_pk_bf16_f32 v23, v142, v143
    v_xor_b32 v161, 0x20, v98
    ds_write_b128 v161, v[20:23]
    v_permlane32_swap_b32 v144, v148
    v_permlane32_swap_b32 v145, v149
    v_permlane32_swap_b32 v146, v150
    v_permlane32_swap_b32 v147, v151
    v_cvt_pk_bf16_f32 v24, v144, v145
    v_cvt_pk_bf16_f32 v25, v146, v147
    v_cvt_pk_bf16_f32 v26, v148, v149
    v_cvt_pk_bf16_f32 v27, v150, v151
    v_xor_b32 v160, 0x40, v98
    ds_write_b128 v160, v[24:27]
    v_permlane32_swap_b32 v152, v156
    v_permlane32_swap_b32 v153, v157
    v_permlane32_swap_b32 v154, v158
    v_permlane32_swap_b32 v155, v159
    v_cvt_pk_bf16_f32 v28, v152, v153
    v_cvt_pk_bf16_f32 v29, v154, v155
    v_cvt_pk_bf16_f32 v30, v156, v157
    v_cvt_pk_bf16_f32 v31, v158, v159
    v_xor_b32 v161, 0x60, v98
    ds_write_b128 v161, v[28:31]
    ds_read_b128 v[32:35], v99 offset:0
    ds_read_b128 v[36:39], v99 offset:1024
    ds_read_b128 v[40:43], v99 offset:2048
    ds_read_b128 v[44:47], v99 offset:3072
    s_waitcnt lgkmcnt(3)
    buffer_store_dwordx4 v[32:35], v100, s[36:39], s69 offen offset:0 sc1
    s_waitcnt lgkmcnt(2)
    buffer_store_dwordx4 v[36:39], v100, s[36:39], s69 offen offset:1024 sc1
    s_waitcnt lgkmcnt(1)
    buffer_store_dwordx4 v[40:43], v100, s[36:39], s69 offen offset:2048 sc1
    s_waitcnt lgkmcnt(0)
    buffer_store_dwordx4 v[44:47], v100, s[36:39], s69 offen offset:3072 sc1
    s_waitcnt vmcnt(0)
    v_mov_b32 v160, 0x24058
    v_mov_b32 v161, 1
    s_waitcnt lgkmcnt(0)
    s_mov_b64 exec, 1
    ds_add_u32 v160, v161
    s_mov_b64 exec, -1
    s_endpgm
L_CSVC:
    s_setprio 3
    s_sub_u32 s60, s3, 8
    s_mov_b32 s44, s20
    s_and_b32 s45, s21, 0xffff
    s_mov_b32 s46, 0x1000000
    s_mov_b32 s47, 0x20000
    s_mov_b32 s52, s30
    s_and_b32 s53, s31, 0xffff
    s_mov_b32 s54, 0x2000
    s_mov_b32 s55, 0x20000
    s_lshl_b32 s64, s4, 3
    s_add_u32 s64, s64, s5
    s_sub_u32 s64, s64, 8
    v_lshlrev_b32 v2, 4, v1
    s_lshl_b32 s7, s64, 18
    s_lshl_b32 s65, s60, 10
    s_add_u32 s65, s65, s7
    s_add_u32 s65, s65, 196608
    s_lshl_b32 s7, s60, 6
    v_xor_b32 v12, s7, v2
    v_xor_b32 v13, 16, v12
    v_xor_b32 v14, 32, v12
    v_xor_b32 v15, 48, v12
    s_barrier
    s_cmp_lg_u32 s60, 0
    s_cbranch_scc1 C8_114
    s_sleep 24
    v_mov_b32 v160, 0
    s_mov_b32 s80, 200000
NG_115:
    s_mov_b64 exec, 1
    buffer_load_dwordx2 v[162:163], v160, s[40:43], 0 offen sc1
    s_mov_b64 exec, -1
    s_waitcnt vmcnt(0)
    v_readfirstlane_b32 s94, v162
    v_readfirstlane_b32 s95, v163
    s_cmp_lg_u32 s95, 0
    s_cbranch_scc1 NGD_116
    s_sleep 4
    s_sub_u32 s80, s80, 1
    s_cmp_lg_u32 s80, 0
    s_cbranch_scc1 NG_115
NGD_116:
    v_mov_b32 v160, 0x24050
    v_mov_b32 v162, s94
    v_mov_b32 v163, s95
    ds_write_b64 v160, v[162:163]
    v_mov_b32 v160, 0x2404c
    v_mov_b32 v161, 1
    s_waitcnt lgkmcnt(0)
    s_mov_b64 exec, 1
    ds_add_u32 v160, v161
    s_mov_b64 exec, -1
C8_114:
    s_lshr_b32 s7, s64, 4
    s_lshl_b32 s7, s7, 16
    s_lshl_b32 s63, s60, 14
    s_add_u32 s7, s7, s63
    s_add_u32 s7, s7, 0x0
    v_lshl_add_u32 v4, v1, 4, s7
    s_and_b32 s7, s60, 1
    s_lshl_b32 s7, s7, 7
    v_lshlrev_b32 v3, 3, v1
    v_xor_b32 v3, s7, v3
    s_lshl_b32 s7, s60, 13
    s_add_u32 s7, s7, 0x18000
    v_add_u32 v3, s7, v3
    v_mov_b32 v160, 0x2404c
    s_mov_b32 s80, 1600000
LW_117:
    ds_read_b32 v161, v160
    s_waitcnt lgkmcnt(0)
    v_readfirstlane_b32 s79, v161
    s_cmp_ge_u32 s79, 1
    s_cbranch_scc1 LWD_118
    s_sleep 4
    s_sub_u32 s80, s80, 1
    s_cmp_lg_u32 s80, 0
    s_cbranch_scc1 LW_117
LWD_118:
    v_mov_b32 v160, 0x24050
    ds_read_b64 v[162:163], v160
    s_waitcnt lgkmcnt(0)
    v_readfirstlane_b32 s94, v162
    v_readfirstlane_b32 s95, v163
    v_mov_b32 v160, 0x24018
    s_mov_b32 s80, 1600000
LW_119:
    ds_read_b32 v161, v160
    s_waitcnt lgkmcnt(0)
    v_readfirstlane_b32 s79, v161
    s_cmp_ge_u32 s79, 8
    s_cbranch_scc1 LWD_120
    s_sleep 2
    s_sub_u32 s80, s80, 1
    s_cmp_lg_u32 s80, 0
    s_cbranch_scc1 LW_119
LWD_120:
    s_sleep 1
    s_mov_b32 s67, 4096
    s_mov_b32 s68, 8192
    s_mov_b32 s69, 12288
    buffer_load_dwordx4 v[96:99], v4, s[36:39], 0 offen offset:0 sc1
    buffer_load_dwordx4 v[100:103], v4, s[36:39], 0 offen offset:1024 sc1
    buffer_load_dwordx4 v[104:107], v4, s[36:39], 0 offen offset:2048 sc1
    buffer_load_dwordx4 v[108:111], v4, s[36:39], 0 offen offset:3072 sc1
    buffer_load_dwordx4 v[112:115], v4, s[36:39], s67 offen offset:0 sc1
    buffer_load_dwordx4 v[116:119], v4, s[36:39], s67 offen offset:1024 sc1
    buffer_load_dwordx4 v[120:123], v4, s[36:39], s67 offen offset:2048 sc1
    buffer_load_dwordx4 v[124:127], v4, s[36:39], s67 offen offset:3072 sc1
    buffer_load_dwordx4 v[128:131], v4, s[36:39], s68 offen offset:0 sc1
    buffer_load_dwordx4 v[132:135], v4, s[36:39], s68 offen offset:1024 sc1
    buffer_load_dwordx4 v[136:139], v4, s[36:39], s68 offen offset:2048 sc1
    buffer_load_dwordx4 v[140:143], v4, s[36:39], s68 offen offset:3072 sc1
    buffer_load_dwordx4 v[144:147], v4, s[36:39], s69 offen offset:0 sc1
    buffer_load_dwordx4 v[148:151], v4, s[36:39], s69 offen offset:1024 sc1
    buffer_load_dwordx4 v[152:155], v4, s[36:39], s69 offen offset:2048 sc1
    buffer_load_dwordx4 v[156:159], v4, s[36:39], s69 offen offset:3072 sc1
    s_mov_b32 s80, 200000
PS_121:
    s_waitcnt vmcnt(0)
    s_mov_b32 s78, 0
    v_cmp_ne_u64 vcc, s[94:95], v[98:99]
    s_cbranch_vccz PSS_123
    buffer_load_dwordx4 v[96:99], v4, s[36:39], 0 offen offset:0 sc1
    s_mov_b32 s78, 1
PSS_123:
    v_cmp_ne_u64 vcc, s[94:95], v[102:103]
    s_cbranch_vccz PSS_124
    buffer_load_dwordx4 v[100:103], v4, s[36:39], 0 offen offset:1024 sc1
    s_mov_b32 s78, 1
PSS_124:
    v_cmp_ne_u64 vcc, s[94:95], v[106:107]
    s_cbranch_vccz PSS_125
    buffer_load_dwordx4 v[104:107], v4, s[36:39], 0 offen offset:2048 sc1
    s_mov_b32 s78, 1
PSS_125:
    v_cmp_ne_u64 vcc, s[94:95], v[110:111]
    s_cbranch_vccz PSS_126
    buffer_load_dwordx4 v[108:111], v4, s[36:39], 0 offen offset:3072 sc1
    s_mov_b32 s78, 1
PSS_126:
    v_cmp_ne_u64 vcc, s[94:95], v[114:115]
    s_cbranch_vccz PSS_127
    buffer_load_dwordx4 v[112:115], v4, s[36:39], s67 offen offset:0 sc1
    s_mov_b32 s78, 1
PSS_127:
    v_cmp_ne_u64 vcc, s[94:95], v[118:119]
    s_cbranch_vccz PSS_128
    buffer_load_dwordx4 v[116:119], v4, s[36:39], s67 offen offset:1024 sc1
    s_mov_b32 s78, 1
PSS_128:
    v_cmp_ne_u64 vcc, s[94:95], v[122:123]
    s_cbranch_vccz PSS_129
    buffer_load_dwordx4 v[120:123], v4, s[36:39], s67 offen offset:2048 sc1
    s_mov_b32 s78, 1
PSS_129:
    v_cmp_ne_u64 vcc, s[94:95], v[126:127]
    s_cbranch_vccz PSS_130
    buffer_load_dwordx4 v[124:127], v4, s[36:39], s67 offen offset:3072 sc1
    s_mov_b32 s78, 1
PSS_130:
    v_cmp_ne_u64 vcc, s[94:95], v[130:131]
    s_cbranch_vccz PSS_131
    buffer_load_dwordx4 v[128:131], v4, s[36:39], s68 offen offset:0 sc1
    s_mov_b32 s78, 1
PSS_131:
    v_cmp_ne_u64 vcc, s[94:95], v[134:135]
    s_cbranch_vccz PSS_132
    buffer_load_dwordx4 v[132:135], v4, s[36:39], s68 offen offset:1024 sc1
    s_mov_b32 s78, 1
PSS_132:
    v_cmp_ne_u64 vcc, s[94:95], v[138:139]
    s_cbranch_vccz PSS_133
    buffer_load_dwordx4 v[136:139], v4, s[36:39], s68 offen offset:2048 sc1
    s_mov_b32 s78, 1
PSS_133:
    v_cmp_ne_u64 vcc, s[94:95], v[142:143]
    s_cbranch_vccz PSS_134
    buffer_load_dwordx4 v[140:143], v4, s[36:39], s68 offen offset:3072 sc1
    s_mov_b32 s78, 1
PSS_134:
    v_cmp_ne_u64 vcc, s[94:95], v[146:147]
    s_cbranch_vccz PSS_135
    buffer_load_dwordx4 v[144:147], v4, s[36:39], s69 offen offset:0 sc1
    s_mov_b32 s78, 1
PSS_135:
    v_cmp_ne_u64 vcc, s[94:95], v[150:151]
    s_cbranch_vccz PSS_136
    buffer_load_dwordx4 v[148:151], v4, s[36:39], s69 offen offset:1024 sc1
    s_mov_b32 s78, 1
PSS_136:
    v_cmp_ne_u64 vcc, s[94:95], v[154:155]
    s_cbranch_vccz PSS_137
    buffer_load_dwordx4 v[152:155], v4, s[36:39], s69 offen offset:2048 sc1
    s_mov_b32 s78, 1
PSS_137:
    v_cmp_ne_u64 vcc, s[94:95], v[158:159]
    s_cbranch_vccz PSS_138
    buffer_load_dwordx4 v[156:159], v4, s[36:39], s69 offen offset:3072 sc1
    s_mov_b32 s78, 1
PSS_138:
    s_cmp_eq_u32 s78, 0
    s_cbranch_scc1 PSD_122
    s_sub_u32 s80, s80, 1
    s_cmp_lg_u32 s80, 0
    s_cbranch_scc1 PS_121
    s_waitcnt vmcnt(0)
PSD_122:
    buffer_load_dwordx4 v[32:35], v12, s[44:47], s65 offen nt
    s_add_u32 s65, s65, 4096
    buffer_load_dwordx4 v[36:39], v13, s[44:47], s65 offen nt
    s_add_u32 s65, s65, 4096
    buffer_load_dwordx4 v[40:43], v14, s[44:47], s65 offen nt
    s_add_u32 s65, s65, 4096
    buffer_load_dwordx4 v[44:47], v15, s[44:47], s65 offen nt
    s_add_u32 s65, s65, 4096
    buffer_load_dwordx4 v[48:51], v12, s[44:47], s65 offen nt
    s_add_u32 s65, s65, 4096
    buffer_load_dwordx4 v[52:55], v13, s[44:47], s65 offen nt
    s_add_u32 s65, s65, 4096
    buffer_load_dwordx4 v[56:59], v14, s[44:47], s65 offen nt
    s_add_u32 s65, s65, 4096
    buffer_load_dwordx4 v[60:63], v15, s[44:47], s65 offen nt
    s_add_u32 s65, s65, 4096
    v_xor_b32 v6, 0x0, v3
    ds_write_b64 v6, v[96:97] offset:0
    ds_write_b64 v6, v[100:101] offset:512
    v_xor_b32 v7, 0x10, v3
    ds_write_b64 v7, v[104:105] offset:1024
    ds_write_b64 v7, v[108:109] offset:1536
    v_xor_b32 v6, 0x20, v3
    ds_write_b64 v6, v[112:113] offset:2048
    ds_write_b64 v6, v[116:117] offset:2560
    v_xor_b32 v7, 0x30, v3
    ds_write_b64 v7, v[120:121] offset:3072
    ds_write_b64 v7, v[124:125] offset:3584
    v_xor_b32 v6, 0x40, v3
    ds_write_b64 v6, v[128:129] offset:4096
    ds_write_b64 v6, v[132:133] offset:4608
    v_xor_b32 v7, 0x50, v3
    ds_write_b64 v7, v[136:137] offset:5120
    ds_write_b64 v7, v[140:141] offset:5632
    v_xor_b32 v6, 0x60, v3
    ds_write_b64 v6, v[144:145] offset:6144
    ds_write_b64 v6, v[148:149] offset:6656
    v_xor_b32 v7, 0x70, v3
    ds_write_b64 v7, v[152:153] offset:7168
    ds_write_b64 v7, v[156:157] offset:7680
    v_mov_b32 v160, 0x24028
    v_mov_b32 v161, 1
    s_waitcnt lgkmcnt(0)
    s_mov_b64 exec, 1
    ds_add_u32 v160, v161
    s_mov_b64 exec, -1
L_CCUT:
    s_waitcnt vmcnt(7)
    buffer_load_dwordx4 v[64:67], v12, s[44:47], s65 offen nt
    s_add_u32 s65, s65, 4096
    s_waitcnt vmcnt(7)
    buffer_load_dwordx4 v[68:71], v13, s[44:47], s65 offen nt
    s_add_u32 s65, s65, 4096
    s_waitcnt vmcnt(7)
    buffer_load_dwordx4 v[72:75], v14, s[44:47], s65 offen nt
    s_add_u32 s65, s65, 4096
    s_waitcnt vmcnt(7)
    buffer_load_dwordx4 v[76:79], v15, s[44:47], s65 offen nt
    s_add_u32 s65, s65, 4096
    s_waitcnt vmcnt(7)
    buffer_load_dwordx4 v[80:83], v12, s[44:47], s65 offen nt
    s_add_u32 s65, s65, 4096
    s_waitcnt vmcnt(7)
    buffer_load_dwordx4 v[84:87], v13, s[44:47], s65 offen nt
    s_add_u32 s65, s65, 4096
    s_waitcnt vmcnt(7)
    buffer_load_dwordx4 v[88:91], v14, s[44:47], s65 offen nt
    s_add_u32 s65, s65, 4096
    s_waitcnt vmcnt(7)
    buffer_load_dwordx4 v[92:95], v15, s[44:47], s65 offen nt
    s_add_u32 s65, s65, 4096
    s_setprio 0
    s_lshl_b32 s7, s60, 10
    v_add_u32 v3, s7, v2
    s_waitcnt vmcnt(0)
    v_mov_b32 v160, 0x24038
    s_mov_b32 s80, 1600000
LW_139:
    ds_read_b32 v161, v160
    s_waitcnt lgkmcnt(0)
    v_readfirstlane_b32 s79, v161
    s_cmp_ge_u32 s79, 8
    s_cbranch_scc1 LWD_140
    s_sleep 1
    s_sub_u32 s80, s80, 1
    s_cmp_lg_u32 s80, 0
    s_cbranch_scc1 LW_139
LWD_140:
    s_setprio 3
    ds_write_b128 v3, v[32:35] offset:0
    ds_write_b128 v3, v[36:39] offset:4096
    ds_write_b128 v3, v[40:43] offset:8192
    ds_write_b128 v3, v[44:47] offset:12288
    ds_write_b128 v3, v[48:51] offset:16384
    ds_write_b128 v3, v[52:55] offset:20480
    ds_write_b128 v3, v[56:59] offset:24576
    ds_write_b128 v3, v[60:63] offset:28672
    ds_write_b128 v3, v[64:67] offset:32768
    ds_write_b128 v3, v[68:71] offset:36864
    ds_write_b128 v3, v[72:75] offset:40960
    ds_write_b128 v3, v[76:79] offset:45056
    ds_write_b128 v3, v[80:83] offset:49152
    ds_write_b128 v3, v[84:87] offset:53248
    ds_write_b128 v3, v[88:91] offset:57344
    ds_write_b128 v3, v[92:95] offset:61440
    v_mov_b32 v160, 0x24030
    v_mov_b32 v161, 1
    s_waitcnt lgkmcnt(0)
    s_mov_b64 exec, 1
    ds_add_u32 v160, v161
    s_mov_b64 exec, -1
    s_setprio 0
    s_cmp_lg_u32 s60, 0
    s_cbranch_scc1 L_END
    v_and_b32 v160, 31, v1
    v_lshlrev_b32 v3, 2, v160
    v_add_u32 v3, 0x27400, v3
    s_lshl_b32 s7, s64, 9
    s_add_u32 s7, s7, 0xe0000
    v_lshl_add_u32 v4, v160, 4, s7
    v_mov_b32 v22, s94
    v_mov_b32 v23, s95
    v_mov_b32 v160, 0x24024
    s_mov_b32 s80, 1600000
LW_141:
    ds_read_b32 v161, v160
    s_waitcnt lgkmcnt(0)
    v_readfirstlane_b32 s79, v161
    s_cmp_ge_u32 s79, 8
    s_cbranch_scc1 LWD_142
    s_sleep 2
    s_sub_u32 s80, s80, 1
    s_cmp_lg_u32 s80, 0
    s_cbranch_scc1 LW_141
LWD_142:
    ds_read_b32 v16, v3 offset:0
    ds_read_b32 v17, v3 offset:128
    ds_read_b32 v18, v3 offset:256
    ds_read_b32 v19, v3 offset:384
    ds_read_b32 v20, v3 offset:2688
    s_waitcnt lgkmcnt(0)
    v_add_f32 v16, v16, v17
    v_add_f32 v18, v18, v19
    v_add_f32 v21, v16, v18
    s_setprio 3
    v_mov_b32 v160, 0x24058
    s_mov_b32 s80, 1600000
LW_143:
    ds_read_b32 v161, v160
    s_waitcnt lgkmcnt(0)
    v_readfirstlane_b32 s79, v161
    s_cmp_ge_u32 s79, 8
    s_cbranch_scc1 LWD_144
    s_sub_u32 s80, s80, 1
    s_cmp_lg_u32 s80, 0
    s_cbranch_scc1 LW_143
LWD_144:
    s_mov_b64 exec, 0xffffffff
    buffer_store_dwordx4 v[20:23], v4, s[36:39], 0 offen sc1
    s_mov_b64 exec, -1
    s_lshl_b32 s7, s64, 13
    s_add_u32 s7, s7, 0x100000
    v_add_u32 v4, s7, v2
    s_bfe_u32 s7, s64, 0x20003
    s_lshl_b32 s7, s7, 11
    s_lshr_b32 s63, s64, 5
    s_lshl_b32 s63, s63, 10
    s_add_u32 s7, s7, s63
    s_and_b32 s63, s64, 7
    s_lshl_b32 s63, s63, 7
    s_add_u32 s7, s7, s63
    v_add_u32 v5, s7, v2
    s_mov_b32 s63, 4096
    s_mov_b32 s80, 200000
PO_145:
    buffer_load_dwordx4 v[32:35], v4, s[36:39], 0 offen offset:0 sc1
PO2_146:
    s_waitcnt vmcnt(0)
    v_cmp_ne_u64 vcc, s[94:95], v[34:35]
    s_cmp_lg_u64 vcc, -1
    s_cbranch_scc1 POD_147
    s_sleep 20
    s_sub_u32 s80, s80, 1
    s_cmp_lg_u32 s80, 0
    s_cbranch_scc1 PO_145
POD_147:
    buffer_load_dwordx4 v[32:35], v4, s[36:39], 0 offen offset:0 sc1
    buffer_load_dwordx4 v[36:39], v4, s[36:39], 0 offen offset:1024 sc1
    buffer_load_dwordx4 v[40:43], v4, s[36:39], 0 offen offset:2048 sc1
    buffer_load_dwordx4 v[44:47], v4, s[36:39], 0 offen offset:3072 sc1
    buffer_load_dwordx4 v[48:51], v4, s[36:39], s63 offen offset:0 sc1
    buffer_load_dwordx4 v[52:55], v4, s[36:39], s63 offen offset:1024 sc1
    buffer_load_dwordx4 v[56:59], v4, s[36:39], s63 offen offset:2048 sc1
    buffer_load_dwordx4 v[60:63], v4, s[36:39], s63 offen offset:3072 sc1
    s_sleep 4
    buffer_load_dwordx4 v[96:99], v4, s[36:39], 0 offen offset:0 sc1
    buffer_load_dwordx4 v[100:103], v4, s[36:39], 0 offen offset:1024 sc1
    buffer_load_dwordx4 v[104:107], v4, s[36:39], 0 offen offset:2048 sc1
    buffer_load_dwordx4 v[108:111], v4, s[36:39], 0 offen offset:3072 sc1
    buffer_load_dwordx4 v[112:115], v4, s[36:39], s63 offen offset:0 sc1
    buffer_load_dwordx4 v[116:119], v4, s[36:39], s63 offen offset:1024 sc1
    buffer_load_dwordx4 v[120:123], v4, s[36:39], s63 offen offset:2048 sc1
    buffer_load_dwordx4 v[124:127], v4, s[36:39], s63 offen offset:3072 sc1
    s_sleep 4
    buffer_load_dwordx4 v[128:131], v4, s[36:39], 0 offen offset:0 sc1
    buffer_load_dwordx4 v[132:135], v4, s[36:39], 0 offen offset:1024 sc1
    buffer_load_dwordx4 v[136:139], v4, s[36:39], 0 offen offset:2048 sc1
    buffer_load_dwordx4 v[140:143], v4, s[36:39], 0 offen offset:3072 sc1
    buffer_load_dwordx4 v[144:147], v4, s[36:39], s63 offen offset:0 sc1
    buffer_load_dwordx4 v[148:151], v4, s[36:39], s63 offen offset:1024 sc1
    buffer_load_dwordx4 v[152:155], v4, s[36:39], s63 offen offset:2048 sc1
    buffer_load_dwordx4 v[156:159], v4, s[36:39], s63 offen offset:3072 sc1
    s_sleep 4
    s_mov_b32 s80, 200000
PP_148:
    s_waitcnt vmcnt(16)
    v_cmp_ne_u64 vcc, s[94:95], v[34:35]
    v_cmp_ne_u64 s[84:85], s[94:95], v[38:39]
    s_or_b64 vcc, vcc, s[84:85]
    v_cmp_ne_u64 s[84:85], s[94:95], v[42:43]
    s_or_b64 vcc, vcc, s[84:85]
    v_cmp_ne_u64 s[84:85], s[94:95], v[46:47]
    s_or_b64 vcc, vcc, s[84:85]
    v_cmp_ne_u64 s[84:85], s[94:95], v[50:51]
    s_or_b64 vcc, vcc, s[84:85]
    v_cmp_ne_u64 s[84:85], s[94:95], v[54:55]
    s_or_b64 vcc, vcc, s[84:85]
    v_cmp_ne_u64 s[84:85], s[94:95], v[58:59]
    s_or_b64 vcc, vcc, s[84:85]
    v_cmp_ne_u64 s[84:85], s[94:95], v[62:63]
    s_or_b64 vcc, vcc, s[84:85]
    s_cmp_eq_u64 vcc, 0
    s_cbranch_scc1 PPO_150
    buffer_load_dwordx4 v[32:35], v4, s[36:39], 0 offen offset:0 sc1
    buffer_load_dwordx4 v[36:39], v4, s[36:39], 0 offen offset:1024 sc1
    buffer_load_dwordx4 v[40:43], v4, s[36:39], 0 offen offset:2048 sc1
    buffer_load_dwordx4 v[44:47], v4, s[36:39], 0 offen offset:3072 sc1
    buffer_load_dwordx4 v[48:51], v4, s[36:39], s63 offen offset:0 sc1
    buffer_load_dwordx4 v[52:55], v4, s[36:39], s63 offen offset:1024 sc1
    buffer_load_dwordx4 v[56:59], v4, s[36:39], s63 offen offset:2048 sc1
    buffer_load_dwordx4 v[60:63], v4, s[36:39], s63 offen offset:3072 sc1
    s_waitcnt vmcnt(16)
    v_cmp_ne_u64 vcc, s[94:95], v[98:99]
    v_cmp_ne_u64 s[84:85], s[94:95], v[102:103]
    s_or_b64 vcc, vcc, s[84:85]
    v_cmp_ne_u64 s[84:85], s[94:95], v[106:107]
    s_or_b64 vcc, vcc, s[84:85]
    v_cmp_ne_u64 s[84:85], s[94:95], v[110:111]
    s_or_b64 vcc, vcc, s[84:85]
    v_cmp_ne_u64 s[84:85], s[94:95], v[114:115]
    s_or_b64 vcc, vcc, s[84:85]
    v_cmp_ne_u64 s[84:85], s[94:95], v[118:119]
    s_or_b64 vcc, vcc, s[84:85]
    v_cmp_ne_u64 s[84:85], s[94:95], v[122:123]
    s_or_b64 vcc, vcc, s[84:85]
    v_cmp_ne_u64 s[84:85], s[94:95], v[126:127]
    s_or_b64 vcc, vcc, s[84:85]
    s_cmp_eq_u64 vcc, 0
    s_cbranch_scc1 PPO_151
    buffer_load_dwordx4 v[96:99], v4, s[36:39], 0 offen offset:0 sc1
    buffer_load_dwordx4 v[100:103], v4, s[36:39], 0 offen offset:1024 sc1
    buffer_load_dwordx4 v[104:107], v4, s[36:39], 0 offen offset:2048 sc1
    buffer_load_dwordx4 v[108:111], v4, s[36:39], 0 offen offset:3072 sc1
    buffer_load_dwordx4 v[112:115], v4, s[36:39], s63 offen offset:0 sc1
    buffer_load_dwordx4 v[116:119], v4, s[36:39], s63 offen offset:1024 sc1
    buffer_load_dwordx4 v[120:123], v4, s[36:39], s63 offen offset:2048 sc1
    buffer_load_dwordx4 v[124:127], v4, s[36:39], s63 offen offset:3072 sc1
    s_waitcnt vmcnt(16)
    v_cmp_ne_u64 vcc, s[94:95], v[130:131]
    v_cmp_ne_u64 s[84:85], s[94:95], v[134:135]
    s_or_b64 vcc, vcc, s[84:85]
    v_cmp_ne_u64 s[84:85], s[94:95], v[138:139]
    s_or_b64 vcc, vcc, s[84:85]
    v_cmp_ne_u64 s[84:85], s[94:95], v[142:143]
    s_or_b64 vcc, vcc, s[84:85]
    v_cmp_ne_u64 s[84:85], s[94:95], v[146:147]
    s_or_b64 vcc, vcc, s[84:85]
    v_cmp_ne_u64 s[84:85], s[94:95], v[150:151]
    s_or_b64 vcc, vcc, s[84:85]
    v_cmp_ne_u64 s[84:85], s[94:95], v[154:155]
    s_or_b64 vcc, vcc, s[84:85]
    v_cmp_ne_u64 s[84:85], s[94:95], v[158:159]
    s_or_b64 vcc, vcc, s[84:85]
    s_cmp_eq_u64 vcc, 0
    s_cbranch_scc1 PPO_152
    buffer_load_dwordx4 v[128:131], v4, s[36:39], 0 offen offset:0 sc1
    buffer_load_dwordx4 v[132:135], v4, s[36:39], 0 offen offset:1024 sc1
    buffer_load_dwordx4 v[136:139], v4, s[36:39], 0 offen offset:2048 sc1
    buffer_load_dwordx4 v[140:143], v4, s[36:39], 0 offen offset:3072 sc1
    buffer_load_dwordx4 v[144:147], v4, s[36:39], s63 offen offset:0 sc1
    buffer_load_dwordx4 v[148:151], v4, s[36:39], s63 offen offset:1024 sc1
    buffer_load_dwordx4 v[152:155], v4, s[36:39], s63 offen offset:2048 sc1
    buffer_load_dwordx4 v[156:159], v4, s[36:39], s63 offen offset:3072 sc1
    s_sub_u32 s80, s80, 1
    s_cmp_lg_u32 s80, 0
    s_cbranch_scc1 PP_148
PPO_150:
    v_lshlrev_b32 v64, 16, v32
    v_and_b32 v65, 0xffff0000, v32
    v_lshlrev_b32 v66, 16, v33
    v_and_b32 v67, 0xffff0000, v33
    v_lshlrev_b32 v68, 16, v36
    v_and_b32 v69, 0xffff0000, v36
    v_lshlrev_b32 v70, 16, v37
    v_and_b32 v71, 0xffff0000, v37
    v_lshlrev_b32 v72, 16, v40
    v_and_b32 v73, 0xffff0000, v40
    v_lshlrev_b32 v74, 16, v41
    v_and_b32 v75, 0xffff0000, v41
    v_lshlrev_b32 v76, 16, v44
    v_and_b32 v77, 0xffff0000, v44
    v_lshlrev_b32 v78, 16, v45
    v_and_b32 v79, 0xffff0000, v45
    v_lshlrev_b32 v80, 16, v48
    v_and_b32 v81, 0xffff0000, v48
    v_lshlrev_b32 v82, 16, v49
    v_and_b32 v83, 0xffff0000, v49
    v_lshlrev_b32 v84, 16, v52
    v_and_b32 v85, 0xffff0000, v52
    v_lshlrev_b32 v86, 16, v53
    v_and_b32 v87, 0xffff0000, v53
    v_lshlrev_b32 v88, 16, v56
    v_and_b32 v89, 0xffff0000, v56
    v_lshlrev_b32 v90, 16, v57
    v_and_b32 v91, 0xffff0000, v57
    v_lshlrev_b32 v92, 16, v60
    v_and_b32 v93, 0xffff0000, v60
    v_lshlrev_b32 v94, 16, v61
    v_and_b32 v95, 0xffff0000, v61
    s_branch PPD_149
PPO_151:
    v_lshlrev_b32 v64, 16, v96
    v_and_b32 v65, 0xffff0000, v96
    v_lshlrev_b32 v66, 16, v97
    v_and_b32 v67, 0xffff0000, v97
    v_lshlrev_b32 v68, 16, v100
    v_and_b32 v69, 0xffff0000, v100
    v_lshlrev_b32 v70, 16, v101
    v_and_b32 v71, 0xffff0000, v101
    v_lshlrev_b32 v72, 16, v104
    v_and_b32 v73, 0xffff0000, v104
    v_lshlrev_b32 v74, 16, v105
    v_and_b32 v75, 0xffff0000, v105
    v_lshlrev_b32 v76, 16, v108
    v_and_b32 v77, 0xffff0000, v108
    v_lshlrev_b32 v78, 16, v109
    v_and_b32 v79, 0xffff0000, v109
    v_lshlrev_b32 v80, 16, v112
    v_and_b32 v81, 0xffff0000, v112
    v_lshlrev_b32 v82, 16, v113
    v_and_b32 v83, 0xffff0000, v113
    v_lshlrev_b32 v84, 16, v116
    v_and_b32 v85, 0xffff0000, v116
    v_lshlrev_b32 v86, 16, v117
    v_and_b32 v87, 0xffff0000, v117
    v_lshlrev_b32 v88, 16, v120
    v_and_b32 v89, 0xffff0000, v120
    v_lshlrev_b32 v90, 16, v121
    v_and_b32 v91, 0xffff0000, v121
    v_lshlrev_b32 v92, 16, v124
    v_and_b32 v93, 0xffff0000, v124
    v_lshlrev_b32 v94, 16, v125
    v_and_b32 v95, 0xffff0000, v125
    s_branch PPD_149
PPO_152:
    v_lshlrev_b32 v64, 16, v128
    v_and_b32 v65, 0xffff0000, v128
    v_lshlrev_b32 v66, 16, v129
    v_and_b32 v67, 0xffff0000, v129
    v_lshlrev_b32 v68, 16, v132
    v_and_b32 v69, 0xffff0000, v132
    v_lshlrev_b32 v70, 16, v133
    v_and_b32 v71, 0xffff0000, v133
    v_lshlrev_b32 v72, 16, v136
    v_and_b32 v73, 0xffff0000, v136
    v_lshlrev_b32 v74, 16, v137
    v_and_b32 v75, 0xffff0000, v137
    v_lshlrev_b32 v76, 16, v140
    v_and_b32 v77, 0xffff0000, v140
    v_lshlrev_b32 v78, 16, v141
    v_and_b32 v79, 0xffff0000, v141
    v_lshlrev_b32 v80, 16, v144
    v_and_b32 v81, 0xffff0000, v144
    v_lshlrev_b32 v82, 16, v145
    v_and_b32 v83, 0xffff0000, v145
    v_lshlrev_b32 v84, 16, v148
    v_and_b32 v85, 0xffff0000, v148
    v_lshlrev_b32 v86, 16, v149
    v_and_b32 v87, 0xffff0000, v149
    v_lshlrev_b32 v88, 16, v152
    v_and_b32 v89, 0xffff0000, v152
    v_lshlrev_b32 v90, 16, v153
    v_and_b32 v91, 0xffff0000, v153
    v_lshlrev_b32 v92, 16, v156
    v_and_b32 v93, 0xffff0000, v156
    v_lshlrev_b32 v94, 16, v157
    v_and_b32 v95, 0xffff0000, v157
PPD_149:
    v_pk_add_f32 v[64:65], v[64:65], v[72:73]
    v_pk_add_f32 v[66:67], v[66:67], v[74:75]
    v_pk_add_f32 v[68:69], v[68:69], v[76:77]
    v_pk_add_f32 v[70:71], v[70:71], v[78:79]
    v_pk_add_f32 v[64:65], v[64:65], v[68:69]
    v_pk_add_f32 v[66:67], v[66:67], v[70:71]
    v_pk_add_f32 v[80:81], v[80:81], v[88:89]
    v_pk_add_f32 v[82:83], v[82:83], v[90:91]
    v_pk_add_f32 v[84:85], v[84:85], v[92:93]
    v_pk_add_f32 v[86:87], v[86:87], v[94:95]
    v_pk_add_f32 v[80:81], v[80:81], v[84:85]
    v_pk_add_f32 v[82:83], v[82:83], v[86:87]
    v_add_f32_dpp v64, v64, v64 row_ror:8 row_mask:0xf bank_mask:0xf
    v_add_f32_dpp v65, v65, v65 row_ror:8 row_mask:0xf bank_mask:0xf
    v_add_f32_dpp v66, v66, v66 row_ror:8 row_mask:0xf bank_mask:0xf
    v_add_f32_dpp v67, v67, v67 row_ror:8 row_mask:0xf bank_mask:0xf
    v_add_f32_dpp v80, v80, v80 row_ror:8 row_mask:0xf bank_mask:0xf
    v_add_f32_dpp v81, v81, v81 row_ror:8 row_mask:0xf bank_mask:0xf
    v_add_f32_dpp v82, v82, v82 row_ror:8 row_mask:0xf bank_mask:0xf
    v_add_f32_dpp v83, v83, v83 row_ror:8 row_mask:0xf bank_mask:0xf
    v_mov_b32 v12, v64
    v_mov_b32 v13, v65
    v_mov_b32 v14, v66
    v_mov_b32 v15, v67
    v_mov_b32 v16, v80
    v_mov_b32 v17, v81
    v_mov_b32 v18, v82
    v_mov_b32 v19, v83
    v_permlane32_swap_b32 v64, v12
    v_permlane32_swap_b32 v65, v13
    v_permlane32_swap_b32 v66, v14
    v_permlane32_swap_b32 v67, v15
    v_permlane32_swap_b32 v80, v16
    v_permlane32_swap_b32 v81, v17
    v_permlane32_swap_b32 v82, v18
    v_permlane32_swap_b32 v83, v19
    v_add_f32 v64, v64, v12
    v_add_f32 v65, v65, v13
    v_add_f32 v66, v66, v14
    v_add_f32 v67, v67, v15
    v_add_f32 v80, v80, v16
    v_add_f32 v81, v81, v17
    v_add_f32 v82, v82, v18
    v_add_f32 v83, v83, v19
    v_mov_b32 v12, v64
    v_mov_b32 v13, v65
    v_mov_b32 v14, v66
    v_mov_b32 v15, v67
    v_mov_b32 v16, v80
    v_mov_b32 v17, v81
    v_mov_b32 v18, v82
    v_mov_b32 v19, v83
    v_permlane16_swap_b32 v64, v12
    v_permlane16_swap_b32 v65, v13
    v_permlane16_swap_b32 v66, v14
    v_permlane16_swap_b32 v67, v15
    v_permlane16_swap_b32 v80, v16
    v_permlane16_swap_b32 v81, v17
    v_permlane16_swap_b32 v82, v18
    v_permlane16_swap_b32 v83, v19
    v_add_f32 v64, v64, v12
    v_add_f32 v65, v65, v13
    v_add_f32 v66, v66, v14
    v_add_f32 v67, v67, v15
    v_add_f32 v80, v80, v16
    v_add_f32 v81, v81, v17
    v_add_f32 v82, v82, v18
    v_add_f32 v83, v83, v19
    v_cvt_pk_bf16_f32 v8, v64, v65
    v_cvt_pk_bf16_f32 v9, v66, v67
    v_cvt_pk_bf16_f32 v10, v80, v81
    v_cvt_pk_bf16_f32 v11, v82, v83
    s_mov_b64 exec, 0xff
    buffer_store_dwordx4 v[8:11], v5, s[52:55], 0 offen
    s_mov_b64 exec, -1
    s_endpgm
L_END:
    s_endpgm
L_END0:
    s_endpgm
.section .rodata,"a"
.p2align 6
.amdhsa_kernel concat_heads__sliding_block_cached__compressed_kv_cla__decode_kernel
  .amdhsa_next_free_vgpr 168
  .amdhsa_next_free_sgpr 102
  .amdhsa_accum_offset 168
  .amdhsa_group_segment_fixed_size 0
  .amdhsa_kernarg_size 112
  .amdhsa_user_sgpr_count 2
  .amdhsa_user_sgpr_kernarg_segment_ptr 1
  .amdhsa_system_sgpr_workgroup_id_x 1
  .amdhsa_float_denorm_mode_32 3
.end_amdhsa_kernel
```

```asm
; @launch grid=(256,1,1) block=(768,1,1) lds=163840
.amdgcn_target "amdgcn-amd-amdhsa--gfx950"
.text
.globl concat_heads__sliding_block_cached__compressed_kv_cla__decode_kernel
.p2align 8
.type concat_heads__sliding_block_cached__compressed_kv_cla__decode_kernel,@function
concat_heads__sliding_block_cached__compressed_kv_cla__decode_kernel:
    s_cmp_ge_u32 s2, 256
    s_cbranch_scc1 L_END0
    s_load_dwordx16 s[8:23], s[0:1], 0
    s_load_dwordx8 s[24:31], s[0:1], 64
    s_load_dwordx4 s[32:35], s[0:1], 96
    v_lshrrev_b32 v1, 6, v0
    s_nop 0
    v_readfirstlane_b32 s3, v1
    v_and_b32 v1, 63, v0
    s_and_b32 s4, s2, 7
    s_lshr_b32 s5, s2, 3
    s_and_b32 s7, s5, 3
    s_lshl_b32 s6, s4, 2
    s_add_u32 s6, s6, s7
    s_cmp_lg_u32 s3, 11
    s_cbranch_scc1 Z_1
    v_lshlrev_b32 v2, 2, v1
    v_add_u32 v2, 0x24000, v2
    v_mov_b32 v3, 0
    ds_write_b32 v2, v3
Z_1:
    s_waitcnt lgkmcnt(0)
    s_mov_b32 s36, s34
    s_and_b32 s37, s35, 0xffff
    s_mov_b32 s38, 0x1000000
    s_mov_b32 s39, 0x20000
    s_mov_b32 s40, s32
    s_and_b32 s41, s33, 0xffff
    s_mov_b32 s42, 0x100
    s_mov_b32 s43, 0x20000
    s_cmp_lt_u32 s5, 8
    s_cbranch_scc1 L_W
    s_cmp_lt_u32 s5, 16
    s_cbranch_scc1 L_C
    s_cmp_eq_u32 s3, 11
    s_cbranch_scc1 L_ASVC
    s_mov_b32 s44, s10
    s_and_b32 s45, s11, 0xffff
    s_mov_b32 s46, 0x8000000
    s_mov_b32 s47, 0x20000
    s_mov_b32 s48, s12
    s_and_b32 s49, s13, 0xffff
    s_mov_b32 s50, 0x8000000
    s_mov_b32 s51, 0x20000
    s_lshr_b32 s7, s5, 2
    s_sub_u32 s7, s7, 4
    s_lshl_b32 s7, s7, 5
    s_add_u32 s7, s7, s6
    s_lshl_b32 s7, s7, 20
    s_add_u32 s7, s7, 0xC0000
    v_lshlrev_b32 v6, 4, v1
    v_add_u32 v6, s7, v6
    s_add_u32 s63, s3, 3
    s_cmp_ge_u32 s63, 11
    s_cselect_b32 s7, 11, 0
    s_sub_u32 s62, s63, s7
    s_mul_i32 s7, s2, 0
    s_add_u32 s7, s7, s62
    s_mul_i32 s7, s7, 1024
    s_and_b32 s60, s7, 0x3ffff
    s_mov_b32 s61, s60
    s_add_u32 s63, s60, 259072
    s_and_b32 s63, s63, 0x3ffff
    s_cmp_lt_u32 s62, 3
    s_cselect_b32 s63, s63, 0x40000000
    s_cselect_b32 s62, 0, 0xff800000
    s_mov_b32 s64, 0x3e0293ee
    s_cmp_ge_u32 s3, 8
    s_cbranch_scc1 AK_2
    s_cmp_lt_u32 s3, 4
    s_cselect_b32 s70, s18, s8
    s_cselect_b32 s71, s19, s9
    s_cselect_b32 s72, s22, s14
    s_cselect_b32 s73, s23, s15
    s_mov_b32 s52, s70
    s_and_b32 s53, s71, 0xffff
    s_mov_b32 s54, 0x1000
    s_mov_b32 s55, 0x20000
    s_mov_b32 s56, s72
    s_and_b32 s57, s73, 0xffff
    s_mov_b32 s58, 0x400000
    s_mov_b32 s59, 0x20000
    s_and_b32 s7, s5, 12
    s_and_b32 s66, s3, 3
    s_add_u32 s7, s7, s66
    v_lshrrev_b32 v2, 4, v1
    v_lshlrev_b32 v3, 16, v2
    v_and_b32 v4, 15, v1
    v_lshl_add_u32 v3, v4, 4, v3
    s_lshl_b32 s66, s7, 18
    s_lshl_b32 s67, s6, 8
    s_add_u32 s66, s66, s67
    s_cmp_lt_u32 s3, 4
    s_cbranch_scc1 AP_4
    s_barrier
    s_sleep 26
AP_4:
    buffer_load_dwordx4 v[128:131], v3, s[56:59], s66 offen nt
    s_add_u32 s66, s66, 8192
    buffer_load_dwordx4 v[132:135], v3, s[56:59], s66 offen nt
    s_add_u32 s66, s66, 8192
    buffer_load_dwordx4 v[136:139], v3, s[56:59], s66 offen nt
    s_add_u32 s66, s66, 8192
    buffer_load_dwordx4 v[140:143], v3, s[56:59], s66 offen nt
    s_add_u32 s66, s66, 8192
    buffer_load_dwordx4 v[144:147], v3, s[56:59], s66 offen nt
    s_add_u32 s66, s66, 8192
    buffer_load_dwordx4 v[148:151], v3, s[56:59], s66 offen nt
    s_add_u32 s66, s66, 8192
    buffer_load_dwordx4 v[152:155], v3, s[56:59], s66 offen nt
    s_add_u32 s66, s66, 8192
    buffer_load_dwordx4 v[156:159], v3, s[56:59], s66 offen nt
    s_add_u32 s66, s66, 8192
    v_bfe_u32 v4, v1, 2, 2
    v_lshlrev_b32 v4, 10, v4
    v_lshl_add_u32 v4, v2, 4, v4
    s_lshl_b32 s7, s7, 6
    buffer_load_dwordx4 v[160:163], v4, s[52:55], s7 offen
    s_cmp_ge_u32 s3, 4
    s_cbranch_scc1 AP_5
    s_barrier
AP_5:
    s_mov_b32 s92, 0x05040100
    s_mov_b32 s93, 0x07060302
    s_lshl_b32 s7, s3, 11
    s_add_u32 s7, s7, 0x0
    v_lshl_add_u32 v2, v1, 5, s7
    s_cmp_lt_u32 s3, 4
    s_cselect_b32 s7, 0x44, 0x40
    s_add_u32 s7, s7, 0x24000
    v_mov_b32 v3, s7
    v_mov_b32 v4, 1
    s_waitcnt vmcnt(0)
    v_perm_b32 v96, v132, v128, s92
    v_perm_b32 v97, v140, v136, s92
    v_perm_b32 v98, v148, v144, s92
    v_perm_b32 v99, v156, v152, s92
    v_perm_b32 v100, v132, v128, s93
    v_perm_b32 v101, v140, v136, s93
    v_perm_b32 v102, v148, v144, s93
    v_perm_b32 v103, v156, v152, s93
    v_perm_b32 v104, v133, v129, s92
    v_perm_b32 v105, v141, v137, s92
    v_perm_b32 v106, v149, v145, s92
    v_perm_b32 v107, v157, v153, s92
    v_perm_b32 v108, v133, v129, s93
    v_perm_b32 v109, v141, v137, s93
    v_perm_b32 v110, v149, v145, s93
    v_perm_b32 v111, v157, v153, s93
    v_perm_b32 v112, v134, v130, s92
    v_perm_b32 v113, v142, v138, s92
    v_perm_b32 v114, v150, v146, s92
    v_perm_b32 v115, v158, v154, s92
    v_perm_b32 v116, v134, v130, s93
    v_perm_b32 v117, v142, v138, s93
    v_perm_b32 v118, v150, v146, s93
    v_perm_b32 v119, v158, v154, s93
    v_perm_b32 v120, v135, v131, s92
    v_perm_b32 v121, v143, v139, s92
    v_perm_b32 v122, v151, v147, s92
    v_perm_b32 v123, v159, v155, s92
    v_perm_b32 v124, v135, v131, s93
    v_perm_b32 v125, v143, v139, s93
    v_perm_b32 v126, v151, v147, s93
    v_perm_b32 v127, v159, v155, s93
    v_mfma_f32_16x16x32_bf16 v[64:67], v[160:163], v[96:99], 0
    v_mfma_f32_16x16x32_bf16 v[68:71], v[160:163], v[100:103], 0
    v_mfma_f32_16x16x32_bf16 v[72:75], v[160:163], v[104:107], 0
    v_mfma_f32_16x16x32_bf16 v[76:79], v[160:163], v[108:111], 0
    v_mfma_f32_16x16x32_bf16 v[80:83], v[160:163], v[112:115], 0
    v_mfma_f32_16x16x32_bf16 v[84:87], v[160:163], v[116:119], 0
    v_mfma_f32_16x16x32_bf16 v[88:91], v[160:163], v[120:123], 0
    v_mfma_f32_16x16x32_bf16 v[92:95], v[160:163], v[124:127], 0
    s_nop 0
    v_mov_b32 v128, v64
    v_mov_b32 v129, v68
    v_mov_b32 v130, v72
    v_mov_b32 v131, v76
    v_mov_b32 v132, v80
    v_mov_b32 v133, v84
    v_mov_b32 v134, v88
    v_mov_b32 v135, v92
    ds_write_b128 v2, v[128:131]
    ds_write_b128 v2, v[132:135] offset:16
    s_waitcnt lgkmcnt(0)
    s_mov_b64 exec, 1
    ds_add_u32 v3, v4
    s_mov_b64 exec, -1
    s_branch AJ_3
AK_2:
    s_barrier
    s_sleep 26
AJ_3:
    buffer_load_dwordx4 v[32:35], v6, s[44:47], s60 offen offset:0 nt
    s_add_u32 s60, s60, 11264
    buffer_load_dwordx4 v[36:39], v6, s[44:47], s60 offen offset:0 nt
    s_add_u32 s60, s60, 11264
    buffer_load_dwordx4 v[40:43], v6, s[44:47], s60 offen offset:0 nt
    s_add_u32 s60, s60, 11264
    s_waitcnt vmcnt(2)
    buffer_load_dwordx4 v[44:47], v6, s[44:47], s60 offen offset:0 nt
    s_add_u32 s60, s60, 11264
    s_waitcnt vmcnt(2)
    buffer_load_dwordx4 v[48:51], v6, s[44:47], s60 offen offset:0 nt
    s_add_u32 s60, s60, 11264
    s_waitcnt vmcnt(2)
    buffer_load_dwordx4 v[52:55], v6, s[44:47], s60 offen offset:0 nt
    s_add_u32 s60, s60, 11264
    s_waitcnt vmcnt(2)
    buffer_load_dwordx4 v[56:59], v6, s[44:47], s60 offen offset:0 nt
    s_add_u32 s60, s60, 11264
    s_waitcnt vmcnt(2)
    buffer_load_dwordx4 v[60:63], v6, s[44:47], s60 offen offset:0 nt
    s_add_u32 s60, s60, 11264
    s_waitcnt vmcnt(2)
    buffer_load_dwordx4 v[64:67], v6, s[44:47], s60 offen offset:0 nt
    s_add_u32 s60, s60, 11264
    s_waitcnt vmcnt(2)
    buffer_load_dwordx4 v[68:71], v6, s[44:47], s60 offen offset:0 nt
    s_add_u32 s60, s60, 11264
    s_waitcnt vmcnt(2)
    buffer_load_dwordx4 v[72:75], v6, s[44:47], s60 offen offset:0 nt
    s_add_u32 s60, s60, 11264
    s_waitcnt vmcnt(2)
    buffer_load_dwordx4 v[76:79], v6, s[44:47], s60 offen offset:0 nt
    s_add_u32 s60, s60, 11264
    s_waitcnt vmcnt(2)
    buffer_load_dwordx4 v[80:83], v6, s[44:47], s60 offen offset:0 nt
    s_add_u32 s60, s60, 11264
    s_waitcnt vmcnt(2)
    buffer_load_dwordx4 v[84:87], v6, s[44:47], s60 offen offset:0 nt
    s_add_u32 s60, s60, 11264
    s_waitcnt vmcnt(2)
    buffer_load_dwordx4 v[88:91], v6, s[44:47], s60 offen offset:0 nt
    s_add_u32 s60, s60, 11264
    s_waitcnt vmcnt(2)
    buffer_load_dwordx4 v[92:95], v6, s[44:47], s60 offen offset:0 nt
    s_add_u32 s60, s60, 11264
    v_mov_b32 v160, 0x24004
    s_mov_b32 s80, 1600000
LW_6:
    ds_read_b32 v161, v160
    s_waitcnt lgkmcnt(0)
    v_readfirstlane_b32 s79, v161
    s_cmp_ge_u32 s79, 1
    s_cbranch_scc1 LWD_7
    s_sleep 4
    s_sub_u32 s80, s80, 1
    s_cmp_lg_u32 s80, 0
    s_cbranch_scc1 LW_6
LWD_7:
    v_and_b32 v160, 15, v1
    v_lshlrev_b32 v160, 4, v160
    v_add_u32 v160, 0x24100, v160
    ds_read_b128 v[2:5], v160
    s_waitcnt lgkmcnt(0)
    v_dot2_f32_bf16 v8, v32, v2, 0
    v_dot2_f32_bf16 v9, v36, v2, 0
    v_dot2_f32_bf16 v10, v40, v2, 0
    v_dot2_f32_bf16 v11, v44, v2, 0
    v_dot2_f32_bf16 v8, v33, v3, v8
    v_dot2_f32_bf16 v9, v37, v3, v9
    v_dot2_f32_bf16 v10, v41, v3, v10
    v_dot2_f32_bf16 v11, v45, v3, v11
    v_dot2_f32_bf16 v8, v34, v4, v8
    v_dot2_f32_bf16 v9, v38, v4, v9
    v_dot2_f32_bf16 v10, v42, v4, v10
    v_dot2_f32_bf16 v11, v46, v4, v11
    v_dot2_f32_bf16 v8, v35, v5, v8
    v_dot2_f32_bf16 v9, v39, v5, v9
    v_dot2_f32_bf16 v10, v43, v5, v10
    v_dot2_f32_bf16 v11, v47, v5, v11
    v_add_f32_dpp v8, v8, v8 row_ror:8 row_mask:0xf bank_mask:0xf
    v_add_f32_dpp v9, v9, v9 row_ror:8 row_mask:0xf bank_mask:0xf
    v_add_f32_dpp v10, v10, v10 row_ror:8 row_mask:0xf bank_mask:0xf
    v_add_f32_dpp v11, v11, v11 row_ror:8 row_mask:0xf bank_mask:0xf
    v_add_f32_dpp v8, v8, v8 row_ror:4 row_mask:0xf bank_mask:0xf
    v_add_f32_dpp v9, v9, v9 row_ror:4 row_mask:0xf bank_mask:0xf
    v_add_f32_dpp v10, v10, v10 row_ror:4 row_mask:0xf bank_mask:0xf
    v_add_f32_dpp v11, v11, v11 row_ror:4 row_mask:0xf bank_mask:0xf
    v_add_f32_dpp v8, v8, v8 row_ror:2 row_mask:0xf bank_mask:0xf
    v_add_f32_dpp v9, v9, v9 row_ror:2 row_mask:0xf bank_mask:0xf
    v_add_f32_dpp v10, v10, v10 row_ror:2 row_mask:0xf bank_mask:0xf
    v_add_f32_dpp v11, v11, v11 row_ror:2 row_mask:0xf bank_mask:0xf
    v_add_f32_dpp v8, v8, v8 row_ror:1 row_mask:0xf bank_mask:0xf
    v_add_f32_dpp v9, v9, v9 row_ror:1 row_mask:0xf bank_mask:0xf
    v_add_f32_dpp v10, v10, v10 row_ror:1 row_mask:0xf bank_mask:0xf
    v_add_f32_dpp v11, v11, v11 row_ror:1 row_mask:0xf bank_mask:0xf
    s_waitcnt vmcnt(2)
    buffer_load_dwordx4 v[96:99], v6, s[44:47], s60 offen offset:0 nt
    s_add_u32 s60, s60, 11264
    s_waitcnt vmcnt(2)
    buffer_load_dwordx4 v[100:103], v6, s[44:47], s60 offen offset:0 nt
    s_add_u32 s60, s60, 11264
    v_dot2_f32_bf16 v12, v48, v2, 0
    v_dot2_f32_bf16 v13, v52, v2, 0
    v_dot2_f32_bf16 v14, v56, v2, 0
    v_dot2_f32_bf16 v15, v60, v2, 0
    v_dot2_f32_bf16 v12, v49, v3, v12
    v_dot2_f32_bf16 v13, v53, v3, v13
    v_dot2_f32_bf16 v14, v57, v3, v14
    v_dot2_f32_bf16 v15, v61, v3, v15
    v_dot2_f32_bf16 v12, v50, v4, v12
    v_dot2_f32_bf16 v13, v54, v4, v13
    v_dot2_f32_bf16 v14, v58, v4, v14
    v_dot2_f32_bf16 v15, v62, v4, v15
    v_dot2_f32_bf16 v12, v51, v5, v12
    v_dot2_f32_bf16 v13, v55, v5, v13
    v_dot2_f32_bf16 v14, v59, v5, v14
    v_dot2_f32_bf16 v15, v63, v5, v15
    v_add_f32_dpp v12, v12, v12 row_ror:8 row_mask:0xf bank_mask:0xf
    v_add_f32_dpp v13, v13, v13 row_ror:8 row_mask:0xf bank_mask:0xf
    v_add_f32_dpp v14, v14, v14 row_ror:8 row_mask:0xf bank_mask:0xf
    v_add_f32_dpp v15, v15, v15 row_ror:8 row_mask:0xf bank_mask:0xf
    v_add_f32_dpp v12, v12, v12 row_ror:4 row_mask:0xf bank_mask:0xf
    v_add_f32_dpp v13, v13, v13 row_ror:4 row_mask:0xf bank_mask:0xf
    v_add_f32_dpp v14, v14, v14 row_ror:4 row_mask:0xf bank_mask:0xf
    v_add_f32_dpp v15, v15, v15 row_ror:4 row_mask:0xf bank_mask:0xf
    v_add_f32_dpp v12, v12, v12 row_ror:2 row_mask:0xf bank_mask:0xf
    v_add_f32_dpp v13, v13, v13 row_ror:2 row_mask:0xf bank_mask:0xf
    v_add_f32_dpp v14, v14, v14 row_ror:2 row_mask:0xf bank_mask:0xf
    v_add_f32_dpp v15, v15, v15 row_ror:2 row_mask:0xf bank_mask:0xf
    v_add_f32_dpp v12, v12, v12 row_ror:1 row_mask:0xf bank_mask:0xf
    v_add_f32_dpp v13, v13, v13 row_ror:1 row_mask:0xf bank_mask:0xf
    v_add_f32_dpp v14, v14, v14 row_ror:1 row_mask:0xf bank_mask:0xf
    v_add_f32_dpp v15, v15, v15 row_ror:1 row_mask:0xf bank_mask:0xf
    s_waitcnt vmcnt(2)
    buffer_load_dwordx4 v[104:107], v6, s[44:47], s60 offen offset:0 nt
    s_add_u32 s60, s60, 11264
    s_waitcnt vmcnt(2)
    buffer_load_dwordx4 v[108:111], v6, s[44:47], s60 offen offset:0 nt
    s_add_u32 s60, s60, 11264
    v_dot2_f32_bf16 v16, v64, v2, 0
    v_dot2_f32_bf16 v17, v68, v2, 0
    v_dot2_f32_bf16 v18, v72, v2, 0
    v_dot2_f32_bf16 v19, v76, v2, 0
    v_dot2_f32_bf16 v16, v65, v3, v16
    v_dot2_f32_bf16 v17, v69, v3, v17
    v_dot2_f32_bf16 v18, v73, v3, v18
    v_dot2_f32_bf16 v19, v77, v3, v19
    v_dot2_f32_bf16 v16, v66, v4, v16
    v_dot2_f32_bf16 v17, v70, v4, v17
    v_dot2_f32_bf16 v18, v74, v4, v18
    v_dot2_f32_bf16 v19, v78, v4, v19
    v_dot2_f32_bf16 v16, v67, v5, v16
    v_dot2_f32_bf16 v17, v71, v5, v17
    v_dot2_f32_bf16 v18, v75, v5, v18
    v_dot2_f32_bf16 v19, v79, v5, v19
    v_add_f32_dpp v16, v16, v16 row_ror:8 row_mask:0xf bank_mask:0xf
    v_add_f32_dpp v17, v17, v17 row_ror:8 row_mask:0xf bank_mask:0xf
    v_add_f32_dpp v18, v18, v18 row_ror:8 row_mask:0xf bank_mask:0xf
    v_add_f32_dpp v19, v19, v19 row_ror:8 row_mask:0xf bank_mask:0xf
    v_add_f32_dpp v16, v16, v16 row_ror:4 row_mask:0xf bank_mask:0xf
    v_add_f32_dpp v17, v17, v17 row_ror:4 row_mask:0xf bank_mask:0xf
    v_add_f32_dpp v18, v18, v18 row_ror:4 row_mask:0xf bank_mask:0xf
    v_add_f32_dpp v19, v19, v19 row_ror:4 row_mask:0xf bank_mask:0xf
    v_add_f32_dpp v16, v16, v16 row_ror:2 row_mask:0xf bank_mask:0xf
    v_add_f32_dpp v17, v17, v17 row_ror:2 row_mask:0xf bank_mask:0xf
    v_add_f32_dpp v18, v18, v18 row_ror:2 row_mask:0xf bank_mask:0xf
    v_add_f32_dpp v19, v19, v19 row_ror:2 row_mask:0xf bank_mask:0xf
    v_add_f32_dpp v16, v16, v16 row_ror:1 row_mask:0xf bank_mask:0xf
    v_add_f32_dpp v17, v17, v17 row_ror:1 row_mask:0xf bank_mask:0xf
    v_add_f32_dpp v18, v18, v18 row_ror:1 row_mask:0xf bank_mask:0xf
    v_add_f32_dpp v19, v19, v19 row_ror:1 row_mask:0xf bank_mask:0xf
    s_waitcnt vmcnt(2)
    buffer_load_dwordx4 v[112:115], v6, s[44:47], s60 offen offset:0 nt
    s_add_u32 s60, s60, 11264
    s_waitcnt vmcnt(2)
    buffer_load_dwordx4 v[116:119], v6, s[44:47], s60 offen offset:0 nt
    s_add_u32 s60, s60, 11264
    v_dot2_f32_bf16 v20, v80, v2, 0
    v_dot2_f32_bf16 v21, v84, v2, 0
    v_dot2_f32_bf16 v22, v88, v2, 0
    v_dot2_f32_bf16 v23, v92, v2, 0
    v_dot2_f32_bf16 v20, v81, v3, v20
    v_dot2_f32_bf16 v21, v85, v3, v21
    v_dot2_f32_bf16 v22, v89, v3, v22
    v_dot2_f32_bf16 v23, v93, v3, v23
    v_dot2_f32_bf16 v20, v82, v4, v20
    v_dot2_f32_bf16 v21, v86, v4, v21
    v_dot2_f32_bf16 v22, v90, v4, v22
    v_dot2_f32_bf16 v23, v94, v4, v23
    v_dot2_f32_bf16 v20, v83, v5, v20
    v_dot2_f32_bf16 v21, v87, v5, v21
    v_dot2_f32_bf16 v22, v91, v5, v22
    v_dot2_f32_bf16 v23, v95, v5, v23
    v_add_f32_dpp v20, v20, v20 row_ror:8 row_mask:0xf bank_mask:0xf
    v_add_f32_dpp v21, v21, v21 row_ror:8 row_mask:0xf bank_mask:0xf
    v_add_f32_dpp v22, v22, v22 row_ror:8 row_mask:0xf bank_mask:0xf
    v_add_f32_dpp v23, v23, v23 row_ror:8 row_mask:0xf bank_mask:0xf
    v_add_f32_dpp v20, v20, v20 row_ror:4 row_mask:0xf bank_mask:0xf
    v_add_f32_dpp v21, v21, v21 row_ror:4 row_mask:0xf bank_mask:0xf
    v_add_f32_dpp v22, v22, v22 row_ror:4 row_mask:0xf bank_mask:0xf
    v_add_f32_dpp v23, v23, v23 row_ror:4 row_mask:0xf bank_mask:0xf
    v_add_f32_dpp v20, v20, v20 row_ror:2 row_mask:0xf bank_mask:0xf
    v_add_f32_dpp v21, v21, v21 row_ror:2 row_mask:0xf bank_mask:0xf
    v_add_f32_dpp v22, v22, v22 row_ror:2 row_mask:0xf bank_mask:0xf
    v_add_f32_dpp v23, v23, v23 row_ror:2 row_mask:0xf bank_mask:0xf
    v_add_f32_dpp v20, v20, v20 row_ror:1 row_mask:0xf bank_mask:0xf
    v_add_f32_dpp v21, v21, v21 row_ror:1 row_mask:0xf bank_mask:0xf
    v_add_f32_dpp v22, v22, v22 row_ror:1 row_mask:0xf bank_mask:0xf
    v_add_f32_dpp v23, v23, v23 row_ror:1 row_mask:0xf bank_mask:0xf
    s_waitcnt vmcnt(2)
    buffer_load_dwordx4 v[120:123], v6, s[44:47], s60 offen offset:0 nt
    s_waitcnt vmcnt(2)
    buffer_load_dwordx4 v[124:127], v6, s[44:47], s63 offen offset:0 nt
    v_dot2_f32_bf16 v24, v96, v2, 0
    v_dot2_f32_bf16 v25, v100, v2, 0
    v_dot2_f32_bf16 v26, v104, v2, 0
    v_dot2_f32_bf16 v27, v108, v2, 0
    v_dot2_f32_bf16 v24, v97, v3, v24
    v_dot2_f32_bf16 v25, v101, v3, v25
    v_dot2_f32_bf16 v26, v105, v3, v26
    v_dot2_f32_bf16 v27, v109, v3, v27
    v_dot2_f32_bf16 v24, v98, v4, v24
    v_dot2_f32_bf16 v25, v102, v4, v25
    v_dot2_f32_bf16 v26, v106, v4, v26
    v_dot2_f32_bf16 v27, v110, v4, v27
    v_dot2_f32_bf16 v24, v99, v5, v24
    v_dot2_f32_bf16 v25, v103, v5, v25
    v_dot2_f32_bf16 v26, v107, v5, v26
    v_dot2_f32_bf16 v27, v111, v5, v27
    v_add_f32_dpp v24, v24, v24 row_ror:8 row_mask:0xf bank_mask:0xf
    v_add_f32_dpp v25, v25, v25 row_ror:8 row_mask:0xf bank_mask:0xf
    v_add_f32_dpp v26, v26, v26 row_ror:8 row_mask:0xf bank_mask:0xf
    v_add_f32_dpp v27, v27, v27 row_ror:8 row_mask:0xf bank_mask:0xf
    v_add_f32_dpp v24, v24, v24 row_ror:4 row_mask:0xf bank_mask:0xf
    v_add_f32_dpp v25, v25, v25 row_ror:4 row_mask:0xf bank_mask:0xf
    v_add_f32_dpp v26, v26, v26 row_ror:4 row_mask:0xf bank_mask:0xf
    v_add_f32_dpp v27, v27, v27 row_ror:4 row_mask:0xf bank_mask:0xf
    v_add_f32_dpp v24, v24, v24 row_ror:2 row_mask:0xf bank_mask:0xf
    v_add_f32_dpp v25, v25, v25 row_ror:2 row_mask:0xf bank_mask:0xf
    v_add_f32_dpp v26, v26, v26 row_ror:2 row_mask:0xf bank_mask:0xf
    v_add_f32_dpp v27, v27, v27 row_ror:2 row_mask:0xf bank_mask:0xf
    v_add_f32_dpp v24, v24, v24 row_ror:1 row_mask:0xf bank_mask:0xf
    v_add_f32_dpp v25, v25, v25 row_ror:1 row_mask:0xf bank_mask:0xf
    v_add_f32_dpp v26, v26, v26 row_ror:1 row_mask:0xf bank_mask:0xf
    v_add_f32_dpp v27, v27, v27 row_ror:1 row_mask:0xf bank_mask:0xf
    s_waitcnt vmcnt(2)
    buffer_load_dwordx4 v[128:131], v6, s[48:51], s61 offen offset:0 nt
    s_add_u32 s61, s61, 11264
    s_waitcnt vmcnt(2)
    buffer_load_dwordx4 v[132:135], v6, s[48:51], s61 offen offset:0 nt
    s_add_u32 s61, s61, 11264
    s_waitcnt vmcnt(2)
    buffer_load_dwordx4 v[136:139], v6, s[48:51], s61 offen offset:0 nt
    s_add_u32 s61, s61, 11264
    v_dot2_f32_bf16 v28, v112, v2, 0
    v_dot2_f32_bf16 v29, v116, v2, 0
    v_dot2_f32_bf16 v30, v120, v2, 0
    v_dot2_f32_bf16 v31, v124, v2, 0
    v_dot2_f32_bf16 v28, v113, v3, v28
    v_dot2_f32_bf16 v29, v117, v3, v29
    v_dot2_f32_bf16 v30, v121, v3, v30
    v_dot2_f32_bf16 v31, v125, v3, v31
    v_dot2_f32_bf16 v28, v114, v4, v28
    v_dot2_f32_bf16 v29, v118, v4, v29
    v_dot2_f32_bf16 v30, v122, v4, v30
    v_dot2_f32_bf16 v31, v126, v4, v31
    v_dot2_f32_bf16 v28, v115, v5, v28
    v_dot2_f32_bf16 v29, v119, v5, v29
    v_dot2_f32_bf16 v30, v123, v5, v30
    v_dot2_f32_bf16 v31, v127, v5, v31
    v_add_f32_dpp v28, v28, v28 row_ror:8 row_mask:0xf bank_mask:0xf
    v_add_f32_dpp v29, v29, v29 row_ror:8 row_mask:0xf bank_mask:0xf
    v_add_f32_dpp v30, v30, v30 row_ror:8 row_mask:0xf bank_mask:0xf
    v_add_f32_dpp v31, v31, v31 row_ror:8 row_mask:0xf bank_mask:0xf
    v_add_f32_dpp v28, v28, v28 row_ror:4 row_mask:0xf bank_mask:0xf
    v_add_f32_dpp v29, v29, v29 row_ror:4 row_mask:0xf bank_mask:0xf
    v_add_f32_dpp v30, v30, v30 row_ror:4 row_mask:0xf bank_mask:0xf
    v_add_f32_dpp v31, v31, v31 row_ror:4 row_mask:0xf bank_mask:0xf
    v_add_f32_dpp v28, v28, v28 row_ror:2 row_mask:0xf bank_mask:0xf
    v_add_f32_dpp v29, v29, v29 row_ror:2 row_mask:0xf bank_mask:0xf
    v_add_f32_dpp v30, v30, v30 row_ror:2 row_mask:0xf bank_mask:0xf
    v_add_f32_dpp v31, v31, v31 row_ror:2 row_mask:0xf bank_mask:0xf
    v_add_f32_dpp v28, v28, v28 row_ror:1 row_mask:0xf bank_mask:0xf
    v_add_f32_dpp v29, v29, v29 row_ror:1 row_mask:0xf bank_mask:0xf
    v_add_f32_dpp v30, v30, v30 row_ror:1 row_mask:0xf bank_mask:0xf
    v_add_f32_dpp v31, v31, v31 row_ror:1 row_mask:0xf bank_mask:0xf
    s_waitcnt vmcnt(2)
    buffer_load_dwordx4 v[140:143], v6, s[48:51], s61 offen offset:0 nt
    s_add_u32 s61, s61, 11264
    s_waitcnt vmcnt(2)
    buffer_load_dwordx4 v[144:147], v6, s[48:51], s61 offen offset:0 nt
    s_add_u32 s61, s61, 11264
    v_add_f32 v31, s62, v31
    v_max3_f32 v160, v8, v9, v10
    v_max3_f32 v160, v160, v11, v12
    v_max3_f32 v160, v160, v13, v14
    v_max3_f32 v160, v160, v15, v16
    v_max3_f32 v160, v160, v17, v18
    v_max3_f32 v160, v160, v19, v20
    v_max3_f32 v160, v160, v21, v22
    v_max3_f32 v160, v160, v23, v24
    v_max3_f32 v160, v160, v25, v26
    v_max3_f32 v160, v160, v27, v28
    v_max3_f32 v160, v160, v29, v30
    v_max_f32 v160, v160, v31
    v_mov_b32 v161, v160
    s_nop 1
    v_permlane32_swap_b32 v160, v161
    v_max_f32 v160, v160, v161
    v_mov_b32 v161, v160
    s_nop 1
    v_permlane16_swap_b32 v160, v161
    v_max_f32 v160, v160, v161
    v_mul_f32 v160, s64, v160
    v_fma_f32 v8, v8, s64, -v160
    v_fma_f32 v9, v9, s64, -v160
    v_fma_f32 v10, v10, s64, -v160
    v_fma_f32 v11, v11, s64, -v160
    v_fma_f32 v12, v12, s64, -v160
    v_fma_f32 v13, v13, s64, -v160
    v_fma_f32 v14, v14, s64, -v160
    v_fma_f32 v15, v15, s64, -v160
    v_fma_f32 v16, v16, s64, -v160
    v_fma_f32 v17, v17, s64, -v160
    v_fma_f32 v18, v18, s64, -v160
    v_fma_f32 v19, v19, s64, -v160
    v_fma_f32 v20, v20, s64, -v160
    v_fma_f32 v21, v21, s64, -v160
    v_fma_f32 v22, v22, s64, -v160
    v_fma_f32 v23, v23, s64, -v160
    v_fma_f32 v24, v24, s64, -v160
    v_fma_f32 v25, v25, s64, -v160
    v_fma_f32 v26, v26, s64, -v160
    v_fma_f32 v27, v27, s64, -v160
    v_fma_f32 v28, v28, s64, -v160
    v_fma_f32 v29, v29, s64, -v160
    v_fma_f32 v30, v30, s64, -v160
    v_fma_f32 v31, v31, s64, -v160
    v_exp_f32 v8, v8
    v_exp_f32 v9, v9
    v_exp_f32 v10, v10
    v_exp_f32 v11, v11
    v_exp_f32 v12, v12
    v_exp_f32 v13, v13
    v_exp_f32 v14, v14
    v_exp_f32 v15, v15
    v_exp_f32 v16, v16
    v_exp_f32 v17, v17
    v_exp_f32 v18, v18
    v_exp_f32 v19, v19
    v_exp_f32 v20, v20
    v_exp_f32 v21, v21
    v_exp_f32 v22, v22
    v_exp_f32 v23, v23
    v_exp_f32 v24, v24
    v_exp_f32 v25, v25
    v_exp_f32 v26, v26
    v_exp_f32 v27, v27
    v_exp_f32 v28, v28
    v_exp_f32 v29, v29
    v_exp_f32 v30, v30
    v_exp_f32 v31, v31
    s_waitcnt vmcnt(2)
    buffer_load_dwordx4 v[148:151], v6, s[48:51], s61 offen offset:0 nt
    s_add_u32 s61, s61, 11264
    v_add_f32 v162, v8, v9
    v_add_f32 v163, v10, v11
    v_add_f32 v162, v162, v12
    v_add_f32 v163, v163, v13
    v_add_f32 v162, v162, v14
    v_add_f32 v163, v163, v15
    v_add_f32 v162, v162, v16
    v_add_f32 v163, v163, v17
    v_add_f32 v162, v162, v18
    v_add_f32 v163, v163, v19
    v_add_f32 v162, v162, v20
    v_add_f32 v163, v163, v21
    v_add_f32 v162, v162, v22
    v_add_f32 v163, v163, v23
    v_add_f32 v162, v162, v24
    v_add_f32 v163, v163, v25
    v_add_f32 v162, v162, v26
    v_add_f32 v163, v163, v27
    v_add_f32 v162, v162, v28
    v_add_f32 v163, v163, v29
    v_add_f32 v162, v162, v30
    v_add_f32 v163, v163, v31
    v_add_f32 v162, v162, v163
    v_mov_b32 v163, v162
    s_nop 1
    v_permlane32_swap_b32 v162, v163
    v_add_f32 v162, v162, v163
    v_mov_b32 v163, v162
    s_nop 1
    v_permlane16_swap_b32 v162, v163
    v_add_f32 v161, v162, v163
    s_lshl_b32 s7, s3, 3
    s_add_u32 s7, s7, 0x24200
    v_mov_b32 v164, s7
    ds_write_b64 v164, v[160:161]
    v_mov_b32 v164, 0x24008
    v_mov_b32 v165, 1
    s_waitcnt lgkmcnt(0)
    s_mov_b64 exec, 1
    ds_add_u32 v164, v165
    s_mov_b64 exec, -1
    v_and_b32 v2, 15, v1
    v_lshlrev_b32 v2, 5, v2
    v_bfe_u32 v3, v1, 5, 1
    v_lshl_add_u32 v2, v3, 4, v2
    v_bfe_u32 v3, v1, 4, 1
    v_lshl_add_u32 v2, v3, 3, v2
    s_lshl_b32 s7, s3, 9
    s_add_u32 s7, s7, 0x10000
    v_add_u32 v2, s7, v2
    v_mov_b32 v3, 0x2400c
    v_mov_b32 v4, 1
    s_waitcnt vmcnt(2)
    buffer_load_dwordx4 v[32:35], v6, s[48:51], s61 offen offset:0 nt
    s_add_u32 s61, s61, 11264
    v_lshlrev_b32 v160, 16, v128
    v_and_b32 v161, 0xffff0000, v128
    v_lshlrev_b32 v162, 16, v129
    v_and_b32 v163, 0xffff0000, v129
    v_lshlrev_b32 v164, 16, v130
    v_and_b32 v165, 0xffff0000, v130
    v_lshlrev_b32 v166, 16, v131
    v_and_b32 v167, 0xffff0000, v131
    v_pk_mul_f32 v[152:153], v[160:161], v[8:9] op_sel_hi:[1,0]
    v_pk_mul_f32 v[154:155], v[162:163], v[8:9] op_sel_hi:[1,0]
    v_pk_mul_f32 v[156:157], v[164:165], v[8:9] op_sel_hi:[1,0]
    v_pk_mul_f32 v[158:159], v[166:167], v[8:9] op_sel_hi:[1,0]
    v_lshlrev_b32 v160, 16, v132
    v_and_b32 v161, 0xffff0000, v132
    v_lshlrev_b32 v162, 16, v133
    v_and_b32 v163, 0xffff0000, v133
    v_lshlrev_b32 v164, 16, v134
    v_and_b32 v165, 0xffff0000, v134
    v_lshlrev_b32 v166, 16, v135
    v_and_b32 v167, 0xffff0000, v135
    v_pk_fma_f32 v[152:153], v[160:161], v[8:9], v[152:153] op_sel:[0,1,0] op_sel_hi:[1,1,1]
    v_pk_fma_f32 v[154:155], v[162:163], v[8:9], v[154:155] op_sel:[0,1,0] op_sel_hi:[1,1,1]
    v_pk_fma_f32 v[156:157], v[164:165], v[8:9], v[156:157] op_sel:[0,1,0] op_sel_hi:[1,1,1]
    v_pk_fma_f32 v[158:159], v[166:167], v[8:9], v[158:159] op_sel:[0,1,0] op_sel_hi:[1,1,1]
    s_waitcnt vmcnt(2)
    buffer_load_dwordx4 v[36:39], v6, s[48:51], s61 offen offset:0 nt
    s_add_u32 s61, s61, 11264
    v_lshlrev_b32 v160, 16, v136
    v_and_b32 v161, 0xffff0000, v136
    v_lshlrev_b32 v162, 16, v137
    v_and_b32 v163, 0xffff0000, v137
    v_lshlrev_b32 v164, 16, v138
    v_and_b32 v165, 0xffff0000, v138
    v_lshlrev_b32 v166, 16, v139
    v_and_b32 v167, 0xffff0000, v139
    v_pk_fma_f32 v[152:153], v[160:161], v[10:11], v[152:153] op_sel_hi:[1,0,1]
    v_pk_fma_f32 v[154:155], v[162:163], v[10:11], v[154:155] op_sel_hi:[1,0,1]
    v_pk_fma_f32 v[156:157], v[164:165], v[10:11], v[156:157] op_sel_hi:[1,0,1]
    v_pk_fma_f32 v[158:159], v[166:167], v[10:11], v[158:159] op_sel_hi:[1,0,1]
    v_lshlrev_b32 v160, 16, v140
    v_and_b32 v161, 0xffff0000, v140
    v_lshlrev_b32 v162, 16, v141
    v_and_b32 v163, 0xffff0000, v141
    v_lshlrev_b32 v164, 16, v142
    v_and_b32 v165, 0xffff0000, v142
    v_lshlrev_b32 v166, 16, v143
    v_and_b32 v167, 0xffff0000, v143
    v_pk_fma_f32 v[152:153], v[160:161], v[10:11], v[152:153] op_sel:[0,1,0] op_sel_hi:[1,1,1]
    v_pk_fma_f32 v[154:155], v[162:163], v[10:11], v[154:155] op_sel:[0,1,0] op_sel_hi:[1,1,1]
    v_pk_fma_f32 v[156:157], v[164:165], v[10:11], v[156:157] op_sel:[0,1,0] op_sel_hi:[1,1,1]
    v_pk_fma_f32 v[158:159], v[166:167], v[10:11], v[158:159] op_sel:[0,1,0] op_sel_hi:[1,1,1]
    s_waitcnt vmcnt(2)
    buffer_load_dwordx4 v[40:43], v6, s[48:51], s61 offen offset:0 nt
    s_add_u32 s61, s61, 11264
    v_lshlrev_b32 v160, 16, v144
    v_and_b32 v161, 0xffff0000, v144
    v_lshlrev_b32 v162, 16, v145
    v_and_b32 v163, 0xffff0000, v145
    v_lshlrev_b32 v164, 16, v146
    v_and_b32 v165, 0xffff0000, v146
    v_lshlrev_b32 v166, 16, v147
    v_and_b32 v167, 0xffff0000, v147
    v_pk_fma_f32 v[152:153], v[160:161], v[12:13], v[152:153] op_sel_hi:[1,0,1]
    v_pk_fma_f32 v[154:155], v[162:163], v[12:13], v[154:155] op_sel_hi:[1,0,1]
    v_pk_fma_f32 v[156:157], v[164:165], v[12:13], v[156:157] op_sel_hi:[1,0,1]
    v_pk_fma_f32 v[158:159], v[166:167], v[12:13], v[158:159] op_sel_hi:[1,0,1]
    v_lshlrev_b32 v160, 16, v148
    v_and_b32 v161, 0xffff0000, v148
    v_lshlrev_b32 v162, 16, v149
    v_and_b32 v163, 0xffff0000, v149
    v_lshlrev_b32 v164, 16, v150
    v_and_b32 v165, 0xffff0000, v150
    v_lshlrev_b32 v166, 16, v151
    v_and_b32 v167, 0xffff0000, v151
    v_pk_fma_f32 v[152:153], v[160:161], v[12:13], v[152:153] op_sel:[0,1,0] op_sel_hi:[1,1,1]
    v_pk_fma_f32 v[154:155], v[162:163], v[12:13], v[154:155] op_sel:[0,1,0] op_sel_hi:[1,1,1]
    v_pk_fma_f32 v[156:157], v[164:165], v[12:13], v[156:157] op_sel:[0,1,0] op_sel_hi:[1,1,1]
    v_pk_fma_f32 v[158:159], v[166:167], v[12:13], v[158:159] op_sel:[0,1,0] op_sel_hi:[1,1,1]
    s_waitcnt vmcnt(2)
    buffer_load_dwordx4 v[44:47], v6, s[48:51], s61 offen offset:0 nt
    s_add_u32 s61, s61, 11264
    v_lshlrev_b32 v160, 16, v32
    v_and_b32 v161, 0xffff0000, v32
    v_lshlrev_b32 v162, 16, v33
    v_and_b32 v163, 0xffff0000, v33
    v_lshlrev_b32 v164, 16, v34
    v_and_b32 v165, 0xffff0000, v34
    v_lshlrev_b32 v166, 16, v35
    v_and_b32 v167, 0xffff0000, v35
    v_pk_fma_f32 v[152:153], v[160:161], v[14:15], v[152:153] op_sel_hi:[1,0,1]
    v_pk_fma_f32 v[154:155], v[162:163], v[14:15], v[154:155] op_sel_hi:[1,0,1]
    v_pk_fma_f32 v[156:157], v[164:165], v[14:15], v[156:157] op_sel_hi:[1,0,1]
    v_pk_fma_f32 v[158:159], v[166:167], v[14:15], v[158:159] op_sel_hi:[1,0,1]
    s_waitcnt vmcnt(2)
    buffer_load_dwordx4 v[48:51], v6, s[48:51], s61 offen offset:0 nt
    s_add_u32 s61, s61, 11264
    v_lshlrev_b32 v160, 16, v36
    v_and_b32 v161, 0xffff0000, v36
    v_lshlrev_b32 v162, 16, v37
    v_and_b32 v163, 0xffff0000, v37
    v_lshlrev_b32 v164, 16, v38
    v_and_b32 v165, 0xffff0000, v38
    v_lshlrev_b32 v166, 16, v39
    v_and_b32 v167, 0xffff0000, v39
    v_pk_fma_f32 v[152:153], v[160:161], v[14:15], v[152:153] op_sel:[0,1,0] op_sel_hi:[1,1,1]
    v_pk_fma_f32 v[154:155], v[162:163], v[14:15], v[154:155] op_sel:[0,1,0] op_sel_hi:[1,1,1]
    v_pk_fma_f32 v[156:157], v[164:165], v[14:15], v[156:157] op_sel:[0,1,0] op_sel_hi:[1,1,1]
    v_pk_fma_f32 v[158:159], v[166:167], v[14:15], v[158:159] op_sel:[0,1,0] op_sel_hi:[1,1,1]
    s_waitcnt vmcnt(2)
    buffer_load_dwordx4 v[52:55], v6, s[48:51], s61 offen offset:0 nt
    s_add_u32 s61, s61, 11264
    v_lshlrev_b32 v160, 16, v40
    v_and_b32 v161, 0xffff0000, v40
    v_lshlrev_b32 v162, 16, v41
    v_and_b32 v163, 0xffff0000, v41
    v_lshlrev_b32 v164, 16, v42
    v_and_b32 v165, 0xffff0000, v42
    v_lshlrev_b32 v166, 16, v43
    v_and_b32 v167, 0xffff0000, v43
    v_pk_fma_f32 v[152:153], v[160:161], v[16:17], v[152:153] op_sel_hi:[1,0,1]
    v_pk_fma_f32 v[154:155], v[162:163], v[16:17], v[154:155] op_sel_hi:[1,0,1]
    v_pk_fma_f32 v[156:157], v[164:165], v[16:17], v[156:157] op_sel_hi:[1,0,1]
    v_pk_fma_f32 v[158:159], v[166:167], v[16:17], v[158:159] op_sel_hi:[1,0,1]
    s_waitcnt vmcnt(2)
    buffer_load_dwordx4 v[56:59], v6, s[48:51], s61 offen offset:0 nt
    s_add_u32 s61, s61, 11264
    v_lshlrev_b32 v160, 16, v44
    v_and_b32 v161, 0xffff0000, v44
    v_lshlrev_b32 v162, 16, v45
    v_and_b32 v163, 0xffff0000, v45
    v_lshlrev_b32 v164, 16, v46
    v_and_b32 v165, 0xffff0000, v46
    v_lshlrev_b32 v166, 16, v47
    v_and_b32 v167, 0xffff0000, v47
    v_pk_fma_f32 v[152:153], v[160:161], v[16:17], v[152:153] op_sel:[0,1,0] op_sel_hi:[1,1,1]
    v_pk_fma_f32 v[154:155], v[162:163], v[16:17], v[154:155] op_sel:[0,1,0] op_sel_hi:[1,1,1]
    v_pk_fma_f32 v[156:157], v[164:165], v[16:17], v[156:157] op_sel:[0,1,0] op_sel_hi:[1,1,1]
    v_pk_fma_f32 v[158:159], v[166:167], v[16:17], v[158:159] op_sel:[0,1,0] op_sel_hi:[1,1,1]
    s_waitcnt vmcnt(2)
    buffer_load_dwordx4 v[60:63], v6, s[48:51], s61 offen offset:0 nt
    s_add_u32 s61, s61, 11264
    v_lshlrev_b32 v160, 16, v48
    v_and_b32 v161, 0xffff0000, v48
    v_lshlrev_b32 v162, 16, v49
    v_and_b32 v163, 0xffff0000, v49
    v_lshlrev_b32 v164, 16, v50
    v_and_b32 v165, 0xffff0000, v50
    v_lshlrev_b32 v166, 16, v51
    v_and_b32 v167, 0xffff0000, v51
    v_pk_fma_f32 v[152:153], v[160:161], v[18:19], v[152:153] op_sel_hi:[1,0,1]
    v_pk_fma_f32 v[154:155], v[162:163], v[18:19], v[154:155] op_sel_hi:[1,0,1]
    v_pk_fma_f32 v[156:157], v[164:165], v[18:19], v[156:157] op_sel_hi:[1,0,1]
    v_pk_fma_f32 v[158:159], v[166:167], v[18:19], v[158:159] op_sel_hi:[1,0,1]
    s_waitcnt vmcnt(2)
    buffer_load_dwordx4 v[64:67], v6, s[48:51], s61 offen offset:0 nt
    s_add_u32 s61, s61, 11264
    v_lshlrev_b32 v160, 16, v52
    v_and_b32 v161, 0xffff0000, v52
    v_lshlrev_b32 v162, 16, v53
    v_and_b32 v163, 0xffff0000, v53
    v_lshlrev_b32 v164, 16, v54
    v_and_b32 v165, 0xffff0000, v54
    v_lshlrev_b32 v166, 16, v55
    v_and_b32 v167, 0xffff0000, v55
    v_pk_fma_f32 v[152:153], v[160:161], v[18:19], v[152:153] op_sel:[0,1,0] op_sel_hi:[1,1,1]
    v_pk_fma_f32 v[154:155], v[162:163], v[18:19], v[154:155] op_sel:[0,1,0] op_sel_hi:[1,1,1]
    v_pk_fma_f32 v[156:157], v[164:165], v[18:19], v[156:157] op_sel:[0,1,0] op_sel_hi:[1,1,1]
    v_pk_fma_f32 v[158:159], v[166:167], v[18:19], v[158:159] op_sel:[0,1,0] op_sel_hi:[1,1,1]
    s_waitcnt vmcnt(2)
    buffer_load_dwordx4 v[68:71], v6, s[48:51], s61 offen offset:0 nt
    s_add_u32 s61, s61, 11264
    v_lshlrev_b32 v160, 16, v56
    v_and_b32 v161, 0xffff0000, v56
    v_lshlrev_b32 v162, 16, v57
    v_and_b32 v163, 0xffff0000, v57
    v_lshlrev_b32 v164, 16, v58
    v_and_b32 v165, 0xffff0000, v58
    v_lshlrev_b32 v166, 16, v59
    v_and_b32 v167, 0xffff0000, v59
    v_pk_fma_f32 v[152:153], v[160:161], v[20:21], v[152:153] op_sel_hi:[1,0,1]
    v_pk_fma_f32 v[154:155], v[162:163], v[20:21], v[154:155] op_sel_hi:[1,0,1]
    v_pk_fma_f32 v[156:157], v[164:165], v[20:21], v[156:157] op_sel_hi:[1,0,1]
    v_pk_fma_f32 v[158:159], v[166:167], v[20:21], v[158:159] op_sel_hi:[1,0,1]
    s_waitcnt vmcnt(2)
    buffer_load_dwordx4 v[72:75], v6, s[48:51], s61 offen offset:0 nt
    s_add_u32 s61, s61, 11264
    v_lshlrev_b32 v160, 16, v60
    v_and_b32 v161, 0xffff0000, v60
    v_lshlrev_b32 v162, 16, v61
    v_and_b32 v163, 0xffff0000, v61
    v_lshlrev_b32 v164, 16, v62
    v_and_b32 v165, 0xffff0000, v62
    v_lshlrev_b32 v166, 16, v63
    v_and_b32 v167, 0xffff0000, v63
    v_pk_fma_f32 v[152:153], v[160:161], v[20:21], v[152:153] op_sel:[0,1,0] op_sel_hi:[1,1,1]
    v_pk_fma_f32 v[154:155], v[162:163], v[20:21], v[154:155] op_sel:[0,1,0] op_sel_hi:[1,1,1]
    v_pk_fma_f32 v[156:157], v[164:165], v[20:21], v[156:157] op_sel:[0,1,0] op_sel_hi:[1,1,1]
    v_pk_fma_f32 v[158:159], v[166:167], v[20:21], v[158:159] op_sel:[0,1,0] op_sel_hi:[1,1,1]
    s_waitcnt vmcnt(2)
    buffer_load_dwordx4 v[76:79], v6, s[48:51], s61 offen offset:0 nt
    s_add_u32 s61, s61, 11264
    v_lshlrev_b32 v160, 16, v64
    v_and_b32 v161, 0xffff0000, v64
    v_lshlrev_b32 v162, 16, v65
    v_and_b32 v163, 0xffff0000, v65
    v_lshlrev_b32 v164, 16, v66
    v_and_b32 v165, 0xffff0000, v66
    v_lshlrev_b32 v166, 16, v67
    v_and_b32 v167, 0xffff0000, v67
    v_pk_fma_f32 v[152:153], v[160:161], v[22:23], v[152:153] op_sel_hi:[1,0,1]
    v_pk_fma_f32 v[154:155], v[162:163], v[22:23], v[154:155] op_sel_hi:[1,0,1]
    v_pk_fma_f32 v[156:157], v[164:165], v[22:23], v[156:157] op_sel_hi:[1,0,1]
    v_pk_fma_f32 v[158:159], v[166:167], v[22:23], v[158:159] op_sel_hi:[1,0,1]
    s_waitcnt vmcnt(2)
    buffer_load_dwordx4 v[80:83], v6, s[48:51], s61 offen offset:0 nt
    s_add_u32 s61, s61, 11264
    v_lshlrev_b32 v160, 16, v68
    v_and_b32 v161, 0xffff0000, v68
    v_lshlrev_b32 v162, 16, v69
    v_and_b32 v163, 0xffff0000, v69
    v_lshlrev_b32 v164, 16, v70
    v_and_b32 v165, 0xffff0000, v70
    v_lshlrev_b32 v166, 16, v71
    v_and_b32 v167, 0xffff0000, v71
    v_pk_fma_f32 v[152:153], v[160:161], v[22:23], v[152:153] op_sel:[0,1,0] op_sel_hi:[1,1,1]
    v_pk_fma_f32 v[154:155], v[162:163], v[22:23], v[154:155] op_sel:[0,1,0] op_sel_hi:[1,1,1]
    v_pk_fma_f32 v[156:157], v[164:165], v[22:23], v[156:157] op_sel:[0,1,0] op_sel_hi:[1,1,1]
    v_pk_fma_f32 v[158:159], v[166:167], v[22:23], v[158:159] op_sel:[0,1,0] op_sel_hi:[1,1,1]
    s_waitcnt vmcnt(2)
    buffer_load_dwordx4 v[84:87], v6, s[48:51], s61 offen offset:0 nt
    s_add_u32 s61, s61, 11264
    v_lshlrev_b32 v160, 16, v72
    v_and_b32 v161, 0xffff0000, v72
    v_lshlrev_b32 v162, 16, v73
    v_and_b32 v163, 0xffff0000, v73
    v_lshlrev_b32 v164, 16, v74
    v_and_b32 v165, 0xffff0000, v74
    v_lshlrev_b32 v166, 16, v75
    v_and_b32 v167, 0xffff0000, v75
    v_pk_fma_f32 v[152:153], v[160:161], v[24:25], v[152:153] op_sel_hi:[1,0,1]
    v_pk_fma_f32 v[154:155], v[162:163], v[24:25], v[154:155] op_sel_hi:[1,0,1]
    v_pk_fma_f32 v[156:157], v[164:165], v[24:25], v[156:157] op_sel_hi:[1,0,1]
    v_pk_fma_f32 v[158:159], v[166:167], v[24:25], v[158:159] op_sel_hi:[1,0,1]
    s_waitcnt vmcnt(2)
    buffer_load_dwordx4 v[88:91], v6, s[48:51], s61 offen offset:0 nt
    s_add_u32 s61, s61, 11264
    v_lshlrev_b32 v160, 16, v76
    v_and_b32 v161, 0xffff0000, v76
    v_lshlrev_b32 v162, 16, v77
    v_and_b32 v163, 0xffff0000, v77
    v_lshlrev_b32 v164, 16, v78
    v_and_b32 v165, 0xffff0000, v78
    v_lshlrev_b32 v166, 16, v79
    v_and_b32 v167, 0xffff0000, v79
    v_pk_fma_f32 v[152:153], v[160:161], v[24:25], v[152:153] op_sel:[0,1,0] op_sel_hi:[1,1,1]
    v_pk_fma_f32 v[154:155], v[162:163], v[24:25], v[154:155] op_sel:[0,1,0] op_sel_hi:[1,1,1]
    v_pk_fma_f32 v[156:157], v[164:165], v[24:25], v[156:157] op_sel:[0,1,0] op_sel_hi:[1,1,1]
    v_pk_fma_f32 v[158:159], v[166:167], v[24:25], v[158:159] op_sel:[0,1,0] op_sel_hi:[1,1,1]
    s_waitcnt vmcnt(2)
    buffer_load_dwordx4 v[92:95], v6, s[48:51], s61 offen offset:0 nt
    s_add_u32 s61, s61, 11264
    v_lshlrev_b32 v160, 16, v80
    v_and_b32 v161, 0xffff0000, v80
    v_lshlrev_b32 v162, 16, v81
    v_and_b32 v163, 0xffff0000, v81
    v_lshlrev_b32 v164, 16, v82
    v_and_b32 v165, 0xffff0000, v82
    v_lshlrev_b32 v166, 16, v83
    v_and_b32 v167, 0xffff0000, v83
    v_pk_fma_f32 v[152:153], v[160:161], v[26:27], v[152:153] op_sel_hi:[1,0,1]
    v_pk_fma_f32 v[154:155], v[162:163], v[26:27], v[154:155] op_sel_hi:[1,0,1]
    v_pk_fma_f32 v[156:157], v[164:165], v[26:27], v[156:157] op_sel_hi:[1,0,1]
    v_pk_fma_f32 v[158:159], v[166:167], v[26:27], v[158:159] op_sel_hi:[1,0,1]
    s_waitcnt vmcnt(2)
    buffer_load_dwordx4 v[96:99], v6, s[48:51], s61 offen offset:0 nt
    v_lshlrev_b32 v160, 16, v84
    v_and_b32 v161, 0xffff0000, v84
    v_lshlrev_b32 v162, 16, v85
    v_and_b32 v163, 0xffff0000, v85
    v_lshlrev_b32 v164, 16, v86
    v_and_b32 v165, 0xffff0000, v86
    v_lshlrev_b32 v166, 16, v87
    v_and_b32 v167, 0xffff0000, v87
    v_pk_fma_f32 v[152:153], v[160:161], v[26:27], v[152:153] op_sel:[0,1,0] op_sel_hi:[1,1,1]
    v_pk_fma_f32 v[154:155], v[162:163], v[26:27], v[154:155] op_sel:[0,1,0] op_sel_hi:[1,1,1]
    v_pk_fma_f32 v[156:157], v[164:165], v[26:27], v[156:157] op_sel:[0,1,0] op_sel_hi:[1,1,1]
    v_pk_fma_f32 v[158:159], v[166:167], v[26:27], v[158:159] op_sel:[0,1,0] op_sel_hi:[1,1,1]
    s_waitcnt vmcnt(2)
    buffer_load_dwordx4 v[100:103], v6, s[48:51], s63 offen offset:0 nt
    v_lshlrev_b32 v160, 16, v88
    v_and_b32 v161, 0xffff0000, v88
    v_lshlrev_b32 v162, 16, v89
    v_and_b32 v163, 0xffff0000, v89
    v_lshlrev_b32 v164, 16, v90
    v_and_b32 v165, 0xffff0000, v90
    v_lshlrev_b32 v166, 16, v91
    v_and_b32 v167, 0xffff0000, v91
    v_pk_fma_f32 v[152:153], v[160:161], v[28:29], v[152:153] op_sel_hi:[1,0,1]
    v_pk_fma_f32 v[154:155], v[162:163], v[28:29], v[154:155] op_sel_hi:[1,0,1]
    v_pk_fma_f32 v[156:157], v[164:165], v[28:29], v[156:157] op_sel_hi:[1,0,1]
    v_pk_fma_f32 v[158:159], v[166:167], v[28:29], v[158:159] op_sel_hi:[1,0,1]
    s_waitcnt vmcnt(2)
    v_lshlrev_b32 v160, 16, v92
    v_and_b32 v161, 0xffff0000, v92
    v_lshlrev_b32 v162, 16, v93
    v_and_b32 v163, 0xffff0000, v93
    v_lshlrev_b32 v164, 16, v94
    v_and_b32 v165, 0xffff0000, v94
    v_lshlrev_b32 v166, 16, v95
    v_and_b32 v167, 0xffff0000, v95
    v_pk_fma_f32 v[152:153], v[160:161], v[28:29], v[152:153] op_sel:[0,1,0] op_sel_hi:[1,1,1]
    v_pk_fma_f32 v[154:155], v[162:163], v[28:29], v[154:155] op_sel:[0,1,0] op_sel_hi:[1,1,1]
    v_pk_fma_f32 v[156:157], v[164:165], v[28:29], v[156:157] op_sel:[0,1,0] op_sel_hi:[1,1,1]
    v_pk_fma_f32 v[158:159], v[166:167], v[28:29], v[158:159] op_sel:[0,1,0] op_sel_hi:[1,1,1]
    s_waitcnt vmcnt(1)
    v_lshlrev_b32 v160, 16, v96
    v_and_b32 v161, 0xffff0000, v96
    v_lshlrev_b32 v162, 16, v97
    v_and_b32 v163, 0xffff0000, v97
    v_lshlrev_b32 v164, 16, v98
    v_and_b32 v165, 0xffff0000, v98
    v_lshlrev_b32 v166, 16, v99
    v_and_b32 v167, 0xffff0000, v99
    v_pk_fma_f32 v[152:153], v[160:161], v[30:31], v[152:153] op_sel_hi:[1,0,1]
    v_pk_fma_f32 v[154:155], v[162:163], v[30:31], v[154:155] op_sel_hi:[1,0,1]
    v_pk_fma_f32 v[156:157], v[164:165], v[30:31], v[156:157] op_sel_hi:[1,0,1]
    v_pk_fma_f32 v[158:159], v[166:167], v[30:31], v[158:159] op_sel_hi:[1,0,1]
    s_waitcnt vmcnt(0)
    v_lshlrev_b32 v160, 16, v100
    v_and_b32 v161, 0xffff0000, v100
    v_lshlrev_b32 v162, 16, v101
    v_and_b32 v163, 0xffff0000, v101
    v_lshlrev_b32 v164, 16, v102
    v_and_b32 v165, 0xffff0000, v102
    v_lshlrev_b32 v166, 16, v103
    v_and_b32 v167, 0xffff0000, v103
    v_pk_fma_f32 v[152:153], v[160:161], v[30:31], v[152:153] op_sel:[0,1,0] op_sel_hi:[1,1,1]
    v_pk_fma_f32 v[154:155], v[162:163], v[30:31], v[154:155] op_sel:[0,1,0] op_sel_hi:[1,1,1]
    v_pk_fma_f32 v[156:157], v[164:165], v[30:31], v[156:157] op_sel:[0,1,0] op_sel_hi:[1,1,1]
    v_pk_fma_f32 v[158:159], v[166:167], v[30:31], v[158:159] op_sel:[0,1,0] op_sel_hi:[1,1,1]
    s_nop 0
    v_permlane32_swap_b32 v152, v156
    v_permlane32_swap_b32 v153, v157
    v_permlane32_swap_b32 v154, v158
    v_permlane32_swap_b32 v155, v159
    v_add_f32 v152, v152, v156
    v_add_f32 v153, v153, v157
    v_add_f32 v154, v154, v158
    v_add_f32 v155, v155, v159
    s_nop 0
    v_permlane16_swap_b32 v152, v154
    v_permlane16_swap_b32 v153, v155
    v_add_f32 v152, v152, v154
    v_add_f32 v153, v153, v155
    ds_write_b64 v2, v[152:153]
    s_waitcnt lgkmcnt(0)
    s_mov_b64 exec, 1
    ds_add_u32 v3, v4
    s_mov_b64 exec, -1
    s_endpgm
L_ASVC:
    s_setprio 3
    s_lshr_b32 s60, s5, 2
    s_sub_u32 s60, s60, 4
    s_barrier
    s_lshl_b32 s7, s6, 2
    s_add_u32 s7, s7, s60
    s_lshl_b32 s7, s7, 11
    v_lshl_add_u32 v3, v1, 4, s7
    v_add_u32 v5, 0x40000, v3
    v_add_u32 v3, 0x80000, v3
    s_lshl_b32 s7, s6, 5
    s_add_u32 s7, s7, s60
    s_lshl_b32 s7, s7, 8
    s_add_u32 s7, s7, 0x80000
    v_lshrrev_b32 v6, 4, v1
    v_lshlrev_b32 v6, 11, v6
    v_and_b32 v100, 15, v1
    v_lshl_add_u32 v6, v100, 4, v6
    v_add_u32 v6, s7, v6
    s_sleep 8
    v_mov_b32 v90, 0
    s_mov_b32 s80, 200000
    s_mov_b64 exec, 1
    buffer_load_dwordx2 v[94:95], v90, s[40:43], 0 offen sc1
    s_sleep 16
    buffer_load_dwordx2 v[92:93], v90, s[40:43], 0 offen sc1
    s_mov_b64 exec, -1
    s_waitcnt vmcnt(1)
    v_readfirstlane_b32 s94, v94
    v_readfirstlane_b32 s95, v95
    s_cmp_lg_u32 s95, 0
    s_cbranch_scc1 NGD_9
    s_branch NG2_10
NG_8:
    s_mov_b64 exec, 1
    buffer_load_dwordx2 v[92:93], v90, s[40:43], 0 offen sc1
    s_mov_b64 exec, -1
NG2_10:
    s_waitcnt vmcnt(0)
    v_readfirstlane_b32 s94, v92
    v_readfirstlane_b32 s95, v93
    s_cmp_lg_u32 s95, 0
    s_cbranch_scc1 NGD_9
    s_sleep 4
    s_sub_u32 s80, s80, 1
    s_cmp_lg_u32 s80, 0
    s_cbranch_scc1 NG_8
NGD_9:
    v_lshlrev_b32 v7, 5, v1
    v_mov_b32 v114, s94
    v_mov_b32 v115, s95
    v_mov_b32 v118, s94
    v_mov_b32 v119, s95
    v_mov_b32 v122, s94
    v_mov_b32 v123, s95
    v_mov_b32 v126, s94
    v_mov_b32 v127, s95
    v_mov_b32 v100, 0x24044
    s_mov_b32 s80, 1600000
LW_11:
    ds_read_b32 v101, v100
    s_waitcnt lgkmcnt(0)
    v_readfirstlane_b32 s79, v101
    s_cmp_ge_u32 s79, 4
    s_cbranch_scc1 LWD_12
    s_sub_u32 s80, s80, 1
    s_cmp_lg_u32 s80, 0
    s_cbranch_scc1 LW_11
LWD_12:
    ds_read_b128 v[16:19], v7 offset:0
    ds_read_b128 v[20:23], v7 offset:16
    ds_read_b128 v[24:27], v7 offset:2048
    ds_read_b128 v[28:31], v7 offset:2064
    ds_read_b128 v[32:35], v7 offset:4096
    ds_read_b128 v[36:39], v7 offset:4112
    ds_read_b128 v[40:43], v7 offset:6144
    ds_read_b128 v[44:47], v7 offset:6160
    s_waitcnt lgkmcnt(0)
    v_pk_add_f32 v[16:17], v[16:17], v[32:33]
    v_pk_add_f32 v[18:19], v[18:19], v[34:35]
    v_pk_add_f32 v[20:21], v[20:21], v[36:37]
    v_pk_add_f32 v[22:23], v[22:23], v[38:39]
    v_pk_add_f32 v[24:25], v[24:25], v[40:41]
    v_pk_add_f32 v[26:27], v[26:27], v[42:43]
    v_pk_add_f32 v[28:29], v[28:29], v[44:45]
    v_pk_add_f32 v[30:31], v[30:31], v[46:47]
    v_pk_add_f32 v[16:17], v[16:17], v[24:25]
    v_pk_add_f32 v[18:19], v[18:19], v[26:27]
    v_pk_add_f32 v[20:21], v[20:21], v[28:29]
    v_pk_add_f32 v[22:23], v[22:23], v[30:31]
    v_cvt_pk_bf16_f32 v112, v16, v17
    v_cvt_pk_bf16_f32 v113, v18, v19
    v_cvt_pk_bf16_f32 v116, v20, v21
    v_cvt_pk_bf16_f32 v117, v22, v23
    buffer_store_dwordx4 v[112:115], v5, s[36:39], 0 offen offset:0
    buffer_store_dwordx4 v[116:119], v5, s[36:39], 0 offen offset:1024
    v_mov_b32 v100, 0x24018
    v_mov_b32 v101, 1
    s_waitcnt lgkmcnt(0)
    s_mov_b64 exec, 1
    ds_add_u32 v100, v101
    s_mov_b64 exec, -1
    v_mov_b32 v100, 0x24040
    s_mov_b32 s80, 1600000
LW_13:
    ds_read_b32 v101, v100
    s_waitcnt lgkmcnt(0)
    v_readfirstlane_b32 s79, v101
    s_cmp_ge_u32 s79, 4
    s_cbranch_scc1 LWD_14
    s_sub_u32 s80, s80, 1
    s_cmp_lg_u32 s80, 0
    s_cbranch_scc1 LW_13
LWD_14:
    ds_read_b128 v[16:19], v7 offset:8192
    ds_read_b128 v[20:23], v7 offset:8208
    ds_read_b128 v[24:27], v7 offset:10240
    ds_read_b128 v[28:31], v7 offset:10256
    ds_read_b128 v[32:35], v7 offset:12288
    ds_read_b128 v[36:39], v7 offset:12304
    ds_read_b128 v[40:43], v7 offset:14336
    ds_read_b128 v[44:47], v7 offset:14352
    s_waitcnt lgkmcnt(0)
    v_pk_add_f32 v[16:17], v[16:17], v[32:33]
    v_pk_add_f32 v[18:19], v[18:19], v[34:35]
    v_pk_add_f32 v[20:21], v[20:21], v[36:37]
    v_pk_add_f32 v[22:23], v[22:23], v[38:39]
    v_pk_add_f32 v[24:25], v[24:25], v[40:41]
    v_pk_add_f32 v[26:27], v[26:27], v[42:43]
    v_pk_add_f32 v[28:29], v[28:29], v[44:45]
    v_pk_add_f32 v[30:31], v[30:31], v[46:47]
    v_pk_add_f32 v[16:17], v[16:17], v[24:25]
    v_pk_add_f32 v[18:19], v[18:19], v[26:27]
    v_pk_add_f32 v[20:21], v[20:21], v[28:29]
    v_pk_add_f32 v[22:23], v[22:23], v[30:31]
    v_cvt_pk_bf16_f32 v120, v16, v17
    v_cvt_pk_bf16_f32 v121, v18, v19
    v_cvt_pk_bf16_f32 v124, v20, v21
    v_cvt_pk_bf16_f32 v125, v22, v23
    buffer_store_dwordx4 v[120:123], v6, s[36:39], 0 offen offset:0
    buffer_store_dwordx4 v[124:127], v6, s[36:39], 0 offen offset:1024
    v_mov_b32 v100, 0x24018
    v_mov_b32 v101, 1
    s_waitcnt lgkmcnt(0)
    s_mov_b64 exec, 1
    ds_add_u32 v100, v101
    s_mov_b64 exec, -1
    v_mov_b32 v110, v5
    v_mov_b32 v111, v6
    s_getreg_b32 s96, hwreg(HW_REG_XCC_ID, 0, 4)
    s_lshl_b32 s7, s4, 5
    s_add_u32 s7, s7, s5
    s_lshl_b32 s7, s7, 4
    s_add_u32 s7, s7, 0xc0000
    v_mov_b32 v100, s7
    v_mov_b32 v102, s96
    v_mov_b32 v103, 0
    v_mov_b32 v104, s94
    v_mov_b32 v105, s95
    s_mov_b64 exec, 1
    buffer_store_dwordx4 v[102:105], v100, s[36:39], 0 offen
    s_mov_b64 exec, -1
    s_sleep 16
    buffer_load_dwordx4 v[32:35], v3, s[36:39], 0 offen offset:0 sc1
    buffer_load_dwordx4 v[36:39], v3, s[36:39], 0 offen offset:1024 sc1
    s_mov_b32 s80, 200000
PS_15:
    s_waitcnt vmcnt(0)
    s_mov_b32 s78, 0
    v_cmp_ne_u64 vcc, s[94:95], v[34:35]
    s_cbranch_vccz PSS_17
    buffer_load_dwordx4 v[32:35], v3, s[36:39], 0 offen offset:0 sc1
    s_mov_b32 s78, 1
PSS_17:
    v_cmp_ne_u64 vcc, s[94:95], v[38:39]
    s_cbranch_vccz PSS_18
    buffer_load_dwordx4 v[36:39], v3, s[36:39], 0 offen offset:1024 sc1
    s_mov_b32 s78, 1
PSS_18:
    s_cmp_eq_u32 s78, 0
    s_cbranch_scc1 PSD_16
    s_sleep 8
    s_cmp_lg_u32 s80, 199984
    s_cbranch_scc1 PSL_19
    buffer_store_dwordx4 v[112:115], v110, s[36:39], 0 offen offset:0 sc1
    buffer_store_dwordx4 v[116:119], v110, s[36:39], 0 offen offset:1024 sc1
    buffer_store_dwordx4 v[120:123], v111, s[36:39], 0 offen offset:0 sc1
    buffer_store_dwordx4 v[124:127], v111, s[36:39], 0 offen offset:1024 sc1
PSL_19:
    s_sub_u32 s80, s80, 1
    s_cmp_lg_u32 s80, 0
    s_cbranch_scc1 PS_15
    s_waitcnt vmcnt(0)
PSD_16:
    v_lshlrev_b32 v16, 16, v32
    v_and_b32 v17, 0xffff0000, v32
    v_lshlrev_b32 v18, 16, v33
    v_and_b32 v19, 0xffff0000, v33
    v_lshlrev_b32 v20, 16, v36
    v_and_b32 v21, 0xffff0000, v36
    v_lshlrev_b32 v22, 16, v37
    v_and_b32 v23, 0xffff0000, v37
    v_mov_b32 v24, v16
    v_mov_b32 v25, v17
    v_mov_b32 v26, v18
    v_mov_b32 v27, v19
    v_mov_b32 v28, v20
    v_mov_b32 v29, v21
    v_mov_b32 v30, v22
    v_mov_b32 v31, v23
    v_permlane32_swap_b32 v16, v24
    v_permlane32_swap_b32 v17, v25
    v_permlane32_swap_b32 v18, v26
    v_permlane32_swap_b32 v19, v27
    v_permlane32_swap_b32 v20, v28
    v_permlane32_swap_b32 v21, v29
    v_permlane32_swap_b32 v22, v30
    v_permlane32_swap_b32 v23, v31
    v_add_f32 v16, v16, v24
    v_add_f32 v17, v17, v25
    v_add_f32 v18, v18, v26
    v_add_f32 v19, v19, v27
    v_add_f32 v20, v20, v28
    v_add_f32 v21, v21, v29
    v_add_f32 v22, v22, v30
    v_add_f32 v23, v23, v31
    v_mov_b32 v24, v16
    v_mov_b32 v25, v17
    v_mov_b32 v26, v18
    v_mov_b32 v27, v19
    v_mov_b32 v28, v20
    v_mov_b32 v29, v21
    v_mov_b32 v30, v22
    v_mov_b32 v31, v23
    v_permlane16_swap_b32 v16, v24
    v_permlane16_swap_b32 v17, v25
    v_permlane16_swap_b32 v18, v26
    v_permlane16_swap_b32 v19, v27
    v_permlane16_swap_b32 v20, v28
    v_permlane16_swap_b32 v21, v29
    v_permlane16_swap_b32 v22, v30
    v_permlane16_swap_b32 v23, v31
    v_add_f32 v16, v16, v24
    v_add_f32 v17, v17, v25
    v_add_f32 v18, v18, v26
    v_add_f32 v19, v19, v27
    v_add_f32 v20, v20, v28
    v_add_f32 v21, v21, v29
    v_add_f32 v22, v22, v30
    v_add_f32 v23, v23, v31
    v_cvt_pk_bf16_f32 v8, v16, v17
    v_cvt_pk_bf16_f32 v9, v18, v19
    v_cvt_pk_bf16_f32 v10, v20, v21
    v_cvt_pk_bf16_f32 v11, v22, v23
    v_and_b32 v100, 15, v1
    v_lshlrev_b32 v100, 4, v100
    v_add_u32 v100, 0x24100, v100
    ds_write_b128 v100, v[8:11]
L_ACUT:
    v_mov_b32 v100, 0x24004
    v_mov_b32 v101, 1
    s_waitcnt lgkmcnt(0)
    s_mov_b64 exec, 1
    ds_add_u32 v100, v101
    s_mov_b64 exec, -1
    v_mov_b32 v100, 0x24008
    s_mov_b32 s80, 1600000
LW_20:
    ds_read_b32 v101, v100
    s_waitcnt lgkmcnt(0)
    v_readfirstlane_b32 s79, v101
    s_cmp_ge_u32 s79, 11
    s_cbranch_scc1 LWD_21
    s_sleep 8
    s_sub_u32 s80, s80, 1
    s_cmp_lg_u32 s80, 0
    s_cbranch_scc1 LW_20
LWD_21:
    v_and_b32 v100, 31, v1
    s_lshl_b32 s7, s4, 9
    s_add_u32 s7, s7, 0xc0000
    v_lshl_add_u32 v100, v100, 4, s7
    buffer_load_dwordx4 v[32:35], v100, s[36:39], 0 offen sc1
    s_waitcnt vmcnt(0)
    v_cmp_ne_u64 vcc, s[94:95], v[34:35]
    v_cmp_ne_u32 s[86:87], s96, v32
    s_or_b32 s97, vcc_lo, s86
    s_and_b32 s97, s97, 0xffff00ff
    s_cbranch_scc0 AF_22
    buffer_store_dwordx4 v[112:115], v110, s[36:39], 0 offen offset:0 sc1
    buffer_store_dwordx4 v[116:119], v110, s[36:39], 0 offen offset:1024 sc1
    buffer_store_dwordx4 v[120:123], v111, s[36:39], 0 offen offset:0 sc1
    buffer_store_dwordx4 v[124:127], v111, s[36:39], 0 offen offset:1024 sc1
AF_22:
    v_mov_b32 v100, 0x24200
    ds_read_b128 v[8:11], v100 offset:0
    ds_read_b128 v[12:15], v100 offset:16
    ds_read_b128 v[16:19], v100 offset:32
    ds_read_b128 v[20:23], v100 offset:48
    ds_read_b128 v[24:27], v100 offset:64
    ds_read_b128 v[28:31], v100 offset:80
    s_waitcnt lgkmcnt(0)
    v_max3_f32 v100, v8, v10, v12
    v_max3_f32 v100, v100, v14, v16
    v_max3_f32 v100, v100, v18, v20
    v_max3_f32 v100, v100, v22, v24
    v_max3_f32 v100, v100, v26, v28
    v_sub_f32 v8, v8, v100
    v_sub_f32 v10, v10, v100
    v_sub_f32 v12, v12, v100
    v_sub_f32 v14, v14, v100
    v_sub_f32 v16, v16, v100
    v_sub_f32 v18, v18, v100
    v_sub_f32 v20, v20, v100
    v_sub_f32 v22, v22, v100
    v_sub_f32 v24, v24, v100
    v_sub_f32 v26, v26, v100
    v_sub_f32 v28, v28, v100
    v_exp_f32 v8, v8
    v_exp_f32 v10, v10
    v_exp_f32 v12, v12
    v_exp_f32 v14, v14
    v_exp_f32 v16, v16
    v_exp_f32 v18, v18
    v_exp_f32 v20, v20
    v_exp_f32 v22, v22
    v_exp_f32 v24, v24
    v_exp_f32 v26, v26
    v_exp_f32 v28, v28
    v_mul_f32 v101, v8, v9
    v_fmac_f32 v101, v10, v11
    v_fmac_f32 v101, v12, v13
    v_fmac_f32 v101, v14, v15
    v_fmac_f32 v101, v16, v17
    v_fmac_f32 v101, v18, v19
    v_fmac_f32 v101, v20, v21
    v_fmac_f32 v101, v22, v23
    v_fmac_f32 v101, v24, v25
    v_fmac_f32 v101, v26, v27
    v_fmac_f32 v101, v28, v29
    v_rcp_f32 v101, v101
    s_nop 0
    v_mul_f32 v8, v8, v101
    v_mul_f32 v10, v10, v101
    v_mul_f32 v12, v12, v101
    v_mul_f32 v14, v14, v101
    v_mul_f32 v16, v16, v101
    v_mul_f32 v18, v18, v101
    v_mul_f32 v20, v20, v101
    v_mul_f32 v22, v22, v101
    v_mul_f32 v24, v24, v101
    v_mul_f32 v26, v26, v101
    v_mul_f32 v28, v28, v101
    v_and_b32 v100, 15, v1
    v_bfe_u32 v101, v1, 4, 1
    v_lshlrev_b32 v3, 5, v100
    v_lshl_add_u32 v3, v101, 4, v3
    v_add_u32 v3, 0x10000, v3
    s_lshl_b32 s7, s6, 3
    s_add_u32 s7, s7, s60
    s_lshl_b32 s7, s7, 8
    s_add_u32 s7, s7, 0xd0000
    v_lshlrev_b32 v2, 4, v100
    v_lshl_add_u32 v2, v101, 10, v2
    v_add_u32 v2, s7, v2
    v_mov_b32 v6, s94
    v_mov_b32 v7, s95
    v_mov_b32 v100, 0x2400c
    s_mov_b32 s80, 1600000
LW_23:
    ds_read_b32 v101, v100
    s_waitcnt lgkmcnt(0)
    v_readfirstlane_b32 s79, v101
    s_cmp_ge_u32 s79, 11
    s_cbranch_scc1 LWD_24
    s_sub_u32 s80, s80, 1
    s_cmp_lg_u32 s80, 0
    s_cbranch_scc1 LW_23
LWD_24:
    ds_read_b128 v[40:43], v3 offset:0
    ds_read_b128 v[44:47], v3 offset:512
    ds_read_b128 v[48:51], v3 offset:1024
    ds_read_b128 v[52:55], v3 offset:1536
    ds_read_b128 v[56:59], v3 offset:2048
    ds_read_b128 v[60:63], v3 offset:2560
    ds_read_b128 v[64:67], v3 offset:3072
    ds_read_b128 v[68:71], v3 offset:3584
    ds_read_b128 v[72:75], v3 offset:4096
    ds_read_b128 v[76:79], v3 offset:4608
    ds_read_b128 v[80:83], v3 offset:5120
    s_waitcnt lgkmcnt(10)
    v_pk_mul_f32 v[32:33], v[40:41], v[8:9] op_sel_hi:[1,0]
    v_pk_mul_f32 v[34:35], v[42:43], v[8:9] op_sel_hi:[1,0]
    s_waitcnt lgkmcnt(9)
    v_pk_mul_f32 v[36:37], v[44:45], v[10:11] op_sel_hi:[1,0]
    v_pk_mul_f32 v[38:39], v[46:47], v[10:11] op_sel_hi:[1,0]
    s_waitcnt lgkmcnt(8)
    v_pk_fma_f32 v[32:33], v[48:49], v[12:13], v[32:33] op_sel_hi:[1,0,1]
    v_pk_fma_f32 v[34:35], v[50:51], v[12:13], v[34:35] op_sel_hi:[1,0,1]
    s_waitcnt lgkmcnt(7)
    v_pk_fma_f32 v[36:37], v[52:53], v[14:15], v[36:37] op_sel_hi:[1,0,1]
    v_pk_fma_f32 v[38:39], v[54:55], v[14:15], v[38:39] op_sel_hi:[1,0,1]
    s_waitcnt lgkmcnt(6)
    v_pk_fma_f32 v[32:33], v[56:57], v[16:17], v[32:33] op_sel_hi:[1,0,1]
    v_pk_fma_f32 v[34:35], v[58:59], v[16:17], v[34:35] op_sel_hi:[1,0,1]
    s_waitcnt lgkmcnt(5)
    v_pk_fma_f32 v[36:37], v[60:61], v[18:19], v[36:37] op_sel_hi:[1,0,1]
    v_pk_fma_f32 v[38:39], v[62:63], v[18:19], v[38:39] op_sel_hi:[1,0,1]
    s_waitcnt lgkmcnt(4)
    v_pk_fma_f32 v[32:33], v[64:65], v[20:21], v[32:33] op_sel_hi:[1,0,1]
    v_pk_fma_f32 v[34:35], v[66:67], v[20:21], v[34:35] op_sel_hi:[1,0,1]
    s_waitcnt lgkmcnt(3)
    v_pk_fma_f32 v[36:37], v[68:69], v[22:23], v[36:37] op_sel_hi:[1,0,1]
    v_pk_fma_f32 v[38:39], v[70:71], v[22:23], v[38:39] op_sel_hi:[1,0,1]
    s_waitcnt lgkmcnt(2)
    v_pk_fma_f32 v[32:33], v[72:73], v[24:25], v[32:33] op_sel_hi:[1,0,1]
    v_pk_fma_f32 v[34:35], v[74:75], v[24:25], v[34:35] op_sel_hi:[1,0,1]
    s_waitcnt lgkmcnt(1)
    v_pk_fma_f32 v[36:37], v[76:77], v[26:27], v[36:37] op_sel_hi:[1,0,1]
    v_pk_fma_f32 v[38:39], v[78:79], v[26:27], v[38:39] op_sel_hi:[1,0,1]
    s_waitcnt lgkmcnt(0)
    v_pk_fma_f32 v[32:33], v[80:81], v[28:29], v[32:33] op_sel_hi:[1,0,1]
    v_pk_fma_f32 v[34:35], v[82:83], v[28:29], v[34:35] op_sel_hi:[1,0,1]
    v_pk_add_f32 v[32:33], v[32:33], v[36:37]
    v_pk_add_f32 v[34:35], v[34:35], v[38:39]
    v_cvt_pk_bf16_f32 v4, v32, v33
    v_cvt_pk_bf16_f32 v5, v34, v35
    s_mov_b64 exec, 0xffffffff
    buffer_store_dwordx4 v[4:7], v2, s[36:39], 0 offen
    s_cmp_eq_u32 s97, 0
    s_cbranch_scc1 AF_25
    buffer_store_dwordx4 v[4:7], v2, s[36:39], 0 offen sc1
AF_25:
    s_mov_b64 exec, -1
    s_endpgm
L_W:
    s_mov_b32 s92, 0x05040100
    s_mov_b32 s93, 0x07060302
    s_cmp_ge_u32 s3, 8
    s_cbranch_scc1 L_W2
    s_cmp_ge_u32 s3, 4
    s_cbranch_scc1 L_W1
    s_barrier
    s_cmp_ge_u32 s5, 4
    s_cbranch_scc1 L_PF
    v_mov_b32 v160, 0x24048
    s_mov_b32 s80, 1600000
LW_26:
    ds_read_b32 v161, v160
    s_waitcnt lgkmcnt(0)
    v_readfirstlane_b32 s79, v161
    s_cmp_ge_u32 s79, 4
    s_cbranch_scc1 LWD_27
    s_sleep 4
    s_sub_u32 s80, s80, 1
    s_cmp_lg_u32 s80, 0
    s_cbranch_scc1 LW_26
LWD_27:
    s_branch L_U1
L_PF:
    s_mov_b32 s44, s20
    s_and_b32 s45, s21, 0xffff
    s_mov_b32 s46, 0x1000000
    s_mov_b32 s47, 0x20000
    s_lshl_b32 s7, s4, 2
    s_add_u32 s7, s7, s5
    s_sub_u32 s7, s7, 4
    s_lshl_b32 s7, s7, 19
    s_lshl_b32 s60, s3, 10
    s_add_u32 s60, s60, s7
    s_add_u32 s60, s60, 196608
    s_add_u32 s61, s60, 0x40000
    v_lshlrev_b32 v2, 4, v1
    v_mov_b32 v160, 0x24048
    s_mov_b32 s80, 1600000
LW_28:
    ds_read_b32 v161, v160
    s_waitcnt lgkmcnt(0)
    v_readfirstlane_b32 s79, v161
    s_cmp_ge_u32 s79, 4
    s_cbranch_scc1 LWD_29
    s_sleep 4
    s_sub_u32 s80, s80, 1
    s_cmp_lg_u32 s80, 0
    s_cbranch_scc1 LW_28
LWD_29:
    s_mov_b32 s62, 16
PF_30:
    s_waitcnt vmcnt(7)
    buffer_load_dwordx4 v[4:7], v2, s[44:47], s60 offen
    s_add_u32 s60, s60, 4096
    s_waitcnt vmcnt(7)
    buffer_load_dwordx4 v[4:7], v2, s[44:47], s61 offen
    s_add_u32 s61, s61, 4096
    s_sub_u32 s62, s62, 1
    s_cmp_lg_u32 s62, 0
    s_cbranch_scc1 PF_30
    v_mov_b32 v160, 0x2405c
    v_mov_b32 v161, 1
    s_waitcnt lgkmcnt(0)
    s_mov_b64 exec, 1
    ds_add_u32 v160, v161
    s_mov_b64 exec, -1
    s_waitcnt vmcnt(0)
    s_branch L_END
L_W1:
    s_setprio 3
    s_cmp_lg_u32 s3, 4
    s_cbranch_scc1 W4_31
    s_cmp_lg_u32 s2, 0
    s_cbranch_scc1 NM_32
    s_memrealtime s[94:95]
    v_mov_b32 v160, 0
    s_waitcnt lgkmcnt(0)
    s_or_b32 s95, s95, 0x80000000
    v_mov_b32 v162, s94
    v_mov_b32 v163, s95
    s_mov_b64 exec, 1
    buffer_store_dwordx2 v[162:163], v160, s[40:43], 0 offen sc1
    s_mov_b64 exec, -1
NM_32:
W4_31:
    s_barrier
    s_cmp_lg_u32 s3, 4
    s_cbranch_scc1 W4_33
    s_sleep 8
    v_mov_b32 v152, 0
    s_mov_b32 s80, 200000
    s_mov_b64 exec, 1
    buffer_load_dwordx2 v[156:157], v152, s[40:43], 0 offen sc1
    s_sleep 16
    buffer_load_dwordx2 v[154:155], v152, s[40:43], 0 offen sc1
    s_mov_b64 exec, -1
    s_waitcnt vmcnt(1)
    v_readfirstlane_b32 s94, v156
    v_readfirstlane_b32 s95, v157
    s_cmp_lg_u32 s95, 0
    s_cbranch_scc1 NGD_35
    s_branch NG2_36
NG_34:
    s_mov_b64 exec, 1
    buffer_load_dwordx2 v[154:155], v152, s[40:43], 0 offen sc1
    s_mov_b64 exec, -1
NG2_36:
    s_waitcnt vmcnt(0)
    v_readfirstlane_b32 s94, v154
    v_readfirstlane_b32 s95, v155
    s_cmp_lg_u32 s95, 0
    s_cbranch_scc1 NGD_35
    s_sleep 4
    s_sub_u32 s80, s80, 1
    s_cmp_lg_u32 s80, 0
    s_cbranch_scc1 NG_34
NGD_35:
    v_mov_b32 v160, 0x24050
    v_mov_b32 v162, s94
    v_mov_b32 v163, s95
    ds_write_b64 v160, v[162:163]
    v_mov_b32 v160, 0x2404c
    v_mov_b32 v161, 1
    s_waitcnt lgkmcnt(0)
    s_mov_b64 exec, 1
    ds_add_u32 v160, v161
    s_mov_b64 exec, -1
    s_getreg_b32 s96, hwreg(HW_REG_XCC_ID, 0, 4)
    s_lshl_b32 s7, s4, 5
    s_add_u32 s7, s7, s5
    s_lshl_b32 s7, s7, 4
    s_add_u32 s7, s7, 0xc0000
    v_mov_b32 v160, s7
    v_mov_b32 v162, s96
    v_mov_b32 v163, 0
    v_mov_b32 v164, s94
    v_mov_b32 v165, s95
    s_mov_b64 exec, 1
    buffer_store_dwordx4 v[162:165], v160, s[36:39], 0 offen
    s_mov_b64 exec, -1
W4_33:
    s_sub_u32 s62, s3, 4
    s_lshl_b32 s61, s4, 2
    s_add_u32 s61, s61, s62
    v_lshrrev_b32 v162, 4, v1
    v_and_b32 v161, 15, v1
    v_lshlrev_b32 v2, 16, v162
    v_lshl_add_u32 v2, v161, 4, v2
    s_lshl_b32 s7, s61, 3
    s_add_u32 s7, s7, s5
    s_lshl_b32 s7, s7, 8
    s_add_u32 s7, s7, 0x0
    v_add_u32 v2, s7, v2
    v_lshlrev_b32 v3, 6, v161
    v_lshl_add_u32 v3, v162, 4, v3
    s_lshl_b32 s7, s61, 13
    s_add_u32 s7, s7, 0x40000
    v_add_u32 v3, s7, v3
    v_xor_b32 v5, v162, v161
    v_lshlrev_b32 v5, 4, v5
    v_lshl_add_u32 v4, v161, 12, v5
    s_lshl_b32 s7, s62, 8
    v_add_u32 v4, s7, v4
    v_mov_b32 v160, 0x2404c
    s_mov_b32 s80, 1600000
LW_37:
    ds_read_b32 v161, v160
    s_waitcnt lgkmcnt(0)
    v_readfirstlane_b32 s79, v161
    s_cmp_ge_u32 s79, 1
    s_cbranch_scc1 LWD_38
    s_sleep 2
    s_sub_u32 s80, s80, 1
    s_cmp_lg_u32 s80, 0
    s_cbranch_scc1 LW_37
LWD_38:
    v_mov_b32 v160, 0x24050
    ds_read_b64 v[162:163], v160
    s_waitcnt lgkmcnt(0)
    v_readfirstlane_b32 s94, v162
    v_readfirstlane_b32 s95, v163
    s_sleep 4
    s_mov_b32 s63, 4096
    buffer_load_dwordx4 v[72:75], v3, s[36:39], 0 offen offset:0 sc1
    buffer_load_dwordx4 v[76:79], v3, s[36:39], 0 offen offset:1024 sc1
    buffer_load_dwordx4 v[80:83], v3, s[36:39], 0 offen offset:2048 sc1
    buffer_load_dwordx4 v[84:87], v3, s[36:39], 0 offen offset:3072 sc1
    buffer_load_dwordx4 v[88:91], v3, s[36:39], s63 offen offset:0 sc1
    buffer_load_dwordx4 v[92:95], v3, s[36:39], s63 offen offset:1024 sc1
    buffer_load_dwordx4 v[96:99], v3, s[36:39], s63 offen offset:2048 sc1
    buffer_load_dwordx4 v[100:103], v3, s[36:39], s63 offen offset:3072 sc1
    v_mov_b32 v160, 0x24014
    s_mov_b32 s80, 1600000
LW_41:
    ds_read_b32 v161, v160
    s_waitcnt lgkmcnt(0)
    v_readfirstlane_b32 s79, v161
    s_cmp_ge_u32 s79, 4
    s_cbranch_scc1 LWD_42
    s_sleep 1
    s_sub_u32 s80, s80, 1
    s_cmp_lg_u32 s80, 0
    s_cbranch_scc1 LW_41
LWD_42:
    v_xor_b32 v160, 0x0, v4
    v_xor_b32 v161, 0x40, v4
    v_xor_b32 v162, 0x80, v4
    v_xor_b32 v163, 0xc0, v4
    ds_read_b128 v[8:11], v160 offset:0
    ds_read_b128 v[12:15], v161 offset:0
    ds_read_b128 v[16:19], v162 offset:0
    ds_read_b128 v[20:23], v163 offset:0
    ds_read_b128 v[24:27], v160 offset:1024
    ds_read_b128 v[28:31], v161 offset:1024
    ds_read_b128 v[32:35], v162 offset:1024
    ds_read_b128 v[36:39], v163 offset:1024
    ds_read_b128 v[40:43], v160 offset:2048
    ds_read_b128 v[44:47], v161 offset:2048
    ds_read_b128 v[48:51], v162 offset:2048
    ds_read_b128 v[52:55], v163 offset:2048
    ds_read_b128 v[56:59], v160 offset:3072
    ds_read_b128 v[60:63], v161 offset:3072
    ds_read_b128 v[64:67], v162 offset:3072
    ds_read_b128 v[68:71], v163 offset:3072
    s_mov_b32 s80, 200000
PS_39:
    s_waitcnt vmcnt(0)
    s_mov_b32 s78, 0
    v_cmp_ne_u64 vcc, s[94:95], v[74:75]
    s_cbranch_vccz PSS_43
    buffer_load_dwordx4 v[72:75], v3, s[36:39], 0 offen offset:0 sc1
    s_mov_b32 s78, 1
PSS_43:
    v_cmp_ne_u64 vcc, s[94:95], v[78:79]
    s_cbranch_vccz PSS_44
    buffer_load_dwordx4 v[76:79], v3, s[36:39], 0 offen offset:1024 sc1
    s_mov_b32 s78, 1
PSS_44:
    v_cmp_ne_u64 vcc, s[94:95], v[82:83]
    s_cbranch_vccz PSS_45
    buffer_load_dwordx4 v[80:83], v3, s[36:39], 0 offen offset:2048 sc1
    s_mov_b32 s78, 1
PSS_45:
    v_cmp_ne_u64 vcc, s[94:95], v[86:87]
    s_cbranch_vccz PSS_46
    buffer_load_dwordx4 v[84:87], v3, s[36:39], 0 offen offset:3072 sc1
    s_mov_b32 s78, 1
PSS_46:
    v_cmp_ne_u64 vcc, s[94:95], v[90:91]
    s_cbranch_vccz PSS_47
    buffer_load_dwordx4 v[88:91], v3, s[36:39], s63 offen offset:0 sc1
    s_mov_b32 s78, 1
PSS_47:
    v_cmp_ne_u64 vcc, s[94:95], v[94:95]
    s_cbranch_vccz PSS_48
    buffer_load_dwordx4 v[92:95], v3, s[36:39], s63 offen offset:1024 sc1
    s_mov_b32 s78, 1
PSS_48:
    v_cmp_ne_u64 vcc, s[94:95], v[98:99]
    s_cbranch_vccz PSS_49
    buffer_load_dwordx4 v[96:99], v3, s[36:39], s63 offen offset:2048 sc1
    s_mov_b32 s78, 1
PSS_49:
    v_cmp_ne_u64 vcc, s[94:95], v[102:103]
    s_cbranch_vccz PSS_50
    buffer_load_dwordx4 v[100:103], v3, s[36:39], s63 offen offset:3072 sc1
    s_mov_b32 s78, 1
PSS_50:
    s_cmp_eq_u32 s78, 0
    s_cbranch_scc1 PSD_40
    s_sub_u32 s80, s80, 1
    s_cmp_lg_u32 s80, 0
    s_cbranch_scc1 PS_39
    s_waitcnt vmcnt(0)
PSD_40:
    v_lshlrev_b32 v104, 16, v72
    v_and_b32 v105, 0xffff0000, v72
    v_lshlrev_b32 v106, 16, v73
    v_and_b32 v107, 0xffff0000, v73
    v_lshlrev_b32 v108, 16, v76
    v_and_b32 v109, 0xffff0000, v76
    v_lshlrev_b32 v110, 16, v77
    v_and_b32 v111, 0xffff0000, v77
    v_lshlrev_b32 v120, 16, v80
    v_and_b32 v121, 0xffff0000, v80
    v_lshlrev_b32 v122, 16, v81
    v_and_b32 v123, 0xffff0000, v81
    v_lshlrev_b32 v124, 16, v84
    v_and_b32 v125, 0xffff0000, v84
    v_lshlrev_b32 v126, 16, v85
    v_and_b32 v127, 0xffff0000, v85
    v_pk_add_f32 v[104:105], v[104:105], v[120:121]
    v_pk_add_f32 v[106:107], v[106:107], v[122:123]
    v_pk_add_f32 v[108:109], v[108:109], v[124:125]
    v_pk_add_f32 v[110:111], v[110:111], v[126:127]
    v_lshlrev_b32 v112, 16, v88
    v_and_b32 v113, 0xffff0000, v88
    v_lshlrev_b32 v114, 16, v89
    v_and_b32 v115, 0xffff0000, v89
    v_lshlrev_b32 v116, 16, v92
    v_and_b32 v117, 0xffff0000, v92
    v_lshlrev_b32 v118, 16, v93
    v_and_b32 v119, 0xffff0000, v93
    v_pk_add_f32 v[104:105], v[104:105], v[112:113]
    v_pk_add_f32 v[106:107], v[106:107], v[114:115]
    v_pk_add_f32 v[108:109], v[108:109], v[116:117]
    v_pk_add_f32 v[110:111], v[110:111], v[118:119]
    v_lshlrev_b32 v120, 16, v96
    v_and_b32 v121, 0xffff0000, v96
    v_lshlrev_b32 v122, 16, v97
    v_and_b32 v123, 0xffff0000, v97
    v_lshlrev_b32 v124, 16, v100
    v_and_b32 v125, 0xffff0000, v100
    v_lshlrev_b32 v126, 16, v101
    v_and_b32 v127, 0xffff0000, v101
    v_pk_add_f32 v[104:105], v[104:105], v[120:121]
    v_pk_add_f32 v[106:107], v[106:107], v[122:123]
    v_pk_add_f32 v[108:109], v[108:109], v[124:125]
    v_pk_add_f32 v[110:111], v[110:111], v[126:127]
    v_cvt_pk_bf16_f32 v136, v104, v105
    v_cvt_pk_bf16_f32 v137, v106, v107
    v_cvt_pk_bf16_f32 v138, v108, v109
    v_cvt_pk_bf16_f32 v139, v110, v111
    v_mov_b32_dpp v140, v136 quad_perm:[1,2,3,0] row_mask:0xf bank_mask:0xf
    v_mov_b32_dpp v141, v137 quad_perm:[1,2,3,0] row_mask:0xf bank_mask:0xf
    v_mov_b32_dpp v142, v138 quad_perm:[1,2,3,0] row_mask:0xf bank_mask:0xf
    v_mov_b32_dpp v143, v139 quad_perm:[1,2,3,0] row_mask:0xf bank_mask:0xf
    v_mov_b32_dpp v144, v136 quad_perm:[2,3,0,1] row_mask:0xf bank_mask:0xf
    v_mov_b32_dpp v145, v137 quad_perm:[2,3,0,1] row_mask:0xf bank_mask:0xf
    v_mov_b32_dpp v146, v138 quad_perm:[2,3,0,1] row_mask:0xf bank_mask:0xf
    v_mov_b32_dpp v147, v139 quad_perm:[2,3,0,1] row_mask:0xf bank_mask:0xf
    v_mov_b32_dpp v148, v136 quad_perm:[3,0,1,2] row_mask:0xf bank_mask:0xf
    v_mov_b32_dpp v149, v137 quad_perm:[3,0,1,2] row_mask:0xf bank_mask:0xf
    v_mov_b32_dpp v150, v138 quad_perm:[3,0,1,2] row_mask:0xf bank_mask:0xf
    v_mov_b32_dpp v151, v139 quad_perm:[3,0,1,2] row_mask:0xf bank_mask:0xf
    v_mov_b32 v74, s94
    v_mov_b32 v75, s95
    s_waitcnt lgkmcnt(0)
    v_mfma_f32_16x16x32_bf16 v[104:107], v[136:139], v[8:11], 0
    v_mfma_f32_16x16x32_bf16 v[108:111], v[136:139], v[28:31], 0
    v_mfma_f32_16x16x32_bf16 v[112:115], v[136:139], v[48:51], 0
    v_mfma_f32_16x16x32_bf16 v[116:119], v[136:139], v[68:71], 0
    v_mfma_f32_16x16x32_bf16 v[104:107], v[140:143], v[12:15], v[104:107]
    v_mfma_f32_16x16x32_bf16 v[108:111], v[140:143], v[32:35], v[108:111]
    v_mfma_f32_16x16x32_bf16 v[112:115], v[140:143], v[52:55], v[112:115]
    v_mfma_f32_16x16x32_bf16 v[116:119], v[140:143], v[56:59], v[116:119]
    v_mfma_f32_16x16x32_bf16 v[104:107], v[144:147], v[16:19], v[104:107]
    v_mfma_f32_16x16x32_bf16 v[108:111], v[144:147], v[36:39], v[108:111]
    v_mfma_f32_16x16x32_bf16 v[112:115], v[144:147], v[40:43], v[112:115]
    v_mfma_f32_16x16x32_bf16 v[116:119], v[144:147], v[60:63], v[116:119]
    v_mfma_f32_16x16x32_bf16 v[104:107], v[148:151], v[20:23], v[104:107]
    v_mfma_f32_16x16x32_bf16 v[108:111], v[148:151], v[24:27], v[108:111]
    v_mfma_f32_16x16x32_bf16 v[112:115], v[148:151], v[44:47], v[112:115]
    v_mfma_f32_16x16x32_bf16 v[116:119], v[148:151], v[64:67], v[116:119]
    s_nop 5
    v_cvt_pk_bf16_f32 v72, v104, v109
    s_nop 0
    v_cvt_pk_bf16_f32 v73, v114, v119
    buffer_store_dwordx4 v[72:75], v2, s[36:39], 0 offen sc1
    v_mov_b32 v160, 0x24048
    v_mov_b32 v161, 1
    s_waitcnt lgkmcnt(0)
    s_mov_b64 exec, 1
    ds_add_u32 v160, v161
    s_mov_b64 exec, -1
    s_setprio 0
    s_cmp_ge_u32 s5, 4
    s_cbranch_scc1 L_END
L_U1:
    s_mov_b32 s48, s26
    s_and_b32 s49, s27, 0xffff
    s_mov_b32 s50, 0x400000
    s_mov_b32 s51, 0x20000
    v_lshrrev_b32 v162, 4, v1
    v_lshlrev_b32 v2, 16, v162
    v_and_b32 v160, 15, v1
    v_lshl_add_u32 v2, v160, 4, v2
    s_lshl_b32 s7, s6, 8
    v_add_u32 v2, s7, v2
    s_lshl_b32 s70, s3, 19
    s_waitcnt vmcnt(2)
    buffer_load_dwordx4 v[8:11], v2, s[48:51], s70 offen nt
    s_add_u32 s70, s70, 8192
    s_waitcnt vmcnt(2)
    buffer_load_dwordx4 v[12:15], v2, s[48:51], s70 offen nt
    s_add_u32 s70, s70, 8192
    s_waitcnt vmcnt(2)
    buffer_load_dwordx4 v[16:19], v2, s[48:51], s70 offen nt
    s_add_u32 s70, s70, 8192
    s_waitcnt vmcnt(2)
    buffer_load_dwordx4 v[20:23], v2, s[48:51], s70 offen nt
    s_add_u32 s70, s70, 8192
    s_waitcnt vmcnt(2)
    buffer_load_dwordx4 v[24:27], v2, s[48:51], s70 offen nt
    s_add_u32 s70, s70, 8192
    s_waitcnt vmcnt(2)
    buffer_load_dwordx4 v[28:31], v2, s[48:51], s70 offen nt
    s_add_u32 s70, s70, 8192
    s_waitcnt vmcnt(2)
    buffer_load_dwordx4 v[32:35], v2, s[48:51], s70 offen nt
    s_add_u32 s70, s70, 8192
    s_waitcnt vmcnt(2)
    buffer_load_dwordx4 v[36:39], v2, s[48:51], s70 offen nt
    s_add_u32 s70, s70, 204800
    s_waitcnt vmcnt(2)
    buffer_load_dwordx4 v[104:107], v2, s[48:51], s70 offen nt
    s_add_u32 s70, s70, 8192
    s_waitcnt vmcnt(2)
    buffer_load_dwordx4 v[108:111], v2, s[48:51], s70 offen nt
    s_add_u32 s70, s70, 8192
    s_waitcnt vmcnt(2)
    buffer_load_dwordx4 v[112:115], v2, s[48:51], s70 offen nt
    s_add_u32 s70, s70, 8192
    s_waitcnt vmcnt(2)
    buffer_load_dwordx4 v[116:119], v2, s[48:51], s70 offen nt
    s_add_u32 s70, s70, 8192
    s_waitcnt vmcnt(2)
    buffer_load_dwordx4 v[120:123], v2, s[48:51], s70 offen nt
    s_add_u32 s70, s70, 8192
    s_waitcnt vmcnt(2)
    buffer_load_dwordx4 v[124:127], v2, s[48:51], s70 offen nt
    s_add_u32 s70, s70, 8192
    s_waitcnt vmcnt(2)
    buffer_load_dwordx4 v[128:131], v2, s[48:51], s70 offen nt
    s_add_u32 s70, s70, 8192
    s_waitcnt vmcnt(2)
    buffer_load_dwordx4 v[132:135], v2, s[48:51], s70 offen nt
    s_add_u32 s70, s70, 204800
    v_lshlrev_b32 v3, 4, v1
    v_add_u32 v3, 0x24800, v3
    v_lshrrev_b32 v4, 1, v160
    v_lshlrev_b32 v4, 18, v4
    v_lshl_add_u32 v4, v162, 4, v4
    v_and_b32 v163, 1, v1
    v_lshl_add_u32 v4, v163, 6, v4
    v_cmp_eq_u32 s[86:87], 1, v163
    s_lshl_b32 s7, s3, 5
    s_add_u32 s7, s7, s6
    s_lshl_b32 s7, s7, 7
    s_add_u32 s7, s7, 0x500000
    v_add_u32 v4, s7, v4
    s_lshl_b32 s7, s3, 11
    s_add_u32 s7, s7, 0x10000
    v_lshl_add_u32 v5, v1, 5, s7
    v_perm_b32 v40, v12, v8, s92
    v_perm_b32 v41, v20, v16, s92
    v_perm_b32 v42, v28, v24, s92
    v_perm_b32 v43, v36, v32, s92
    v_perm_b32 v44, v12, v8, s93
    v_perm_b32 v45, v20, v16, s93
    v_perm_b32 v46, v28, v24, s93
    v_perm_b32 v47, v36, v32, s93
    v_perm_b32 v48, v13, v9, s92
    v_perm_b32 v49, v21, v17, s92
    v_perm_b32 v50, v29, v25, s92
    v_perm_b32 v51, v37, v33, s92
    v_perm_b32 v52, v13, v9, s93
    v_perm_b32 v53, v21, v17, s93
    v_perm_b32 v54, v29, v25, s93
    v_perm_b32 v55, v37, v33, s93
    v_perm_b32 v56, v14, v10, s92
    v_perm_b32 v57, v22, v18, s92
    v_perm_b32 v58, v30, v26, s92
    v_perm_b32 v59, v38, v34, s92
    v_perm_b32 v60, v14, v10, s93
    v_perm_b32 v61, v22, v18, s93
    v_perm_b32 v62, v30, v26, s93
    v_perm_b32 v63, v38, v34, s93
    v_perm_b32 v64, v15, v11, s92
    v_perm_b32 v65, v23, v19, s92
    v_perm_b32 v66, v31, v27, s92
    v_perm_b32 v67, v39, v35, s92
    v_perm_b32 v68, v15, v11, s93
    v_perm_b32 v69, v23, v19, s93
    v_perm_b32 v70, v31, v27, s93
    v_perm_b32 v71, v39, v35, s93
    s_waitcnt vmcnt(0)
    v_perm_b32 v72, v108, v104, s92
    v_perm_b32 v73, v116, v112, s92
    v_perm_b32 v74, v124, v120, s92
    v_perm_b32 v75, v132, v128, s92
    v_perm_b32 v76, v108, v104, s93
    v_perm_b32 v77, v116, v112, s93
    v_perm_b32 v78, v124, v120, s93
    v_perm_b32 v79, v132, v128, s93
    v_perm_b32 v80, v109, v105, s92
    v_perm_b32 v81, v117, v113, s92
    v_perm_b32 v82, v125, v121, s92
    v_perm_b32 v83, v133, v129, s92
    v_perm_b32 v84, v109, v105, s93
    v_perm_b32 v85, v117, v113, s93
    v_perm_b32 v86, v125, v121, s93
    v_perm_b32 v87, v133, v129, s93
    v_perm_b32 v88, v110, v106, s92
    v_perm_b32 v89, v118, v114, s92
    v_perm_b32 v90, v126, v122, s92
    v_perm_b32 v91, v134, v130, s92
    v_perm_b32 v92, v110, v106, s93
    v_perm_b32 v93, v118, v114, s93
    v_perm_b32 v94, v126, v122, s93
    v_perm_b32 v95, v134, v130, s93
    v_perm_b32 v96, v111, v107, s92
    v_perm_b32 v97, v119, v115, s92
    v_perm_b32 v98, v127, v123, s92
    v_perm_b32 v99, v135, v131, s92
    v_perm_b32 v100, v111, v107, s93
    v_perm_b32 v101, v119, v115, s93
    v_perm_b32 v102, v127, v123, s93
    v_perm_b32 v103, v135, v131, s93
    v_mov_b32 v160, 0x2404c
    s_mov_b32 s80, 1600000
LW_51:
    ds_read_b32 v161, v160
    s_waitcnt lgkmcnt(0)
    v_readfirstlane_b32 s79, v161
    s_cmp_ge_u32 s79, 1
    s_cbranch_scc1 LWD_52
    s_sleep 2
    s_sub_u32 s80, s80, 1
    s_cmp_lg_u32 s80, 0
    s_cbranch_scc1 LW_51
LWD_52:
    v_mov_b32 v160, 0x24050
    ds_read_b64 v[162:163], v160
    s_waitcnt lgkmcnt(0)
    v_readfirstlane_b32 s94, v162
    v_readfirstlane_b32 s95, v163
    v_mov_b32 v160, 0x2401c
    s_mov_b32 s80, 1600000
LW_53:
    ds_read_b32 v161, v160
    s_waitcnt lgkmcnt(0)
    v_readfirstlane_b32 s79, v161
    s_cmp_ge_u32 s79, 1
    s_cbranch_scc1 LWD_54
    s_sleep 4
    s_sub_u32 s80, s80, 1
    s_cmp_lg_u32 s80, 0
    s_cbranch_scc1 LW_53
LWD_54:
    s_setprio 3
    s_mov_b64 s[88:89], 0
    s_mov_b32 s80, 1600000
UM_55:
    ds_read_b128 v[136:139], v3
    s_waitcnt lgkmcnt(0)
    v_cmp_ne_u64 vcc, s[94:95], v[138:139]
    s_or_b64 s[90:91], vcc, s[88:89]
    s_and_b32 s7, s90, 0x5555
    s_cbranch_scc1 UMS_57
    s_mov_b32 s70, 0
    buffer_load_dwordx4 v[8:11], v4, s[36:39], s70 offen sc1
    s_or_b32 s88, s88, 0x5555
UMS_57:
    s_and_b32 s7, s90, 0x55550000
    s_cbranch_scc1 UMS_58
    s_mov_b32 s70, 32768
    buffer_load_dwordx4 v[12:15], v4, s[36:39], s70 offen sc1
    s_or_b32 s88, s88, 0x55550000
UMS_58:
    s_and_b32 s7, s91, 0x5555
    s_cbranch_scc1 UMS_59
    s_mov_b32 s70, 65536
    buffer_load_dwordx4 v[16:19], v4, s[36:39], s70 offen sc1
    s_or_b32 s89, s89, 0x5555
UMS_59:
    s_and_b32 s7, s91, 0x55550000
    s_cbranch_scc1 UMS_60
    s_mov_b32 s70, 98304
    buffer_load_dwordx4 v[20:23], v4, s[36:39], s70 offen sc1
    s_or_b32 s89, s89, 0x55550000
UMS_60:
    s_and_b32 s7, s90, 0xaaaa
    s_cbranch_scc1 UMS_61
    s_mov_b32 s70, 131072
    buffer_load_dwordx4 v[24:27], v4, s[36:39], s70 offen sc1
    s_or_b32 s88, s88, 0xaaaa
UMS_61:
    s_and_b32 s7, s90, 0xaaaa0000
    s_cbranch_scc1 UMS_62
    s_mov_b32 s70, 163840
    buffer_load_dwordx4 v[28:31], v4, s[36:39], s70 offen sc1
    s_or_b32 s88, s88, 0xaaaa0000
UMS_62:
    s_and_b32 s7, s91, 0xaaaa
    s_cbranch_scc1 UMS_63
    s_mov_b32 s70, 196608
    buffer_load_dwordx4 v[32:35], v4, s[36:39], s70 offen sc1
    s_or_b32 s89, s89, 0xaaaa
UMS_63:
    s_and_b32 s7, s91, 0xaaaa0000
    s_cbranch_scc1 UMS_64
    s_mov_b32 s70, 229376
    buffer_load_dwordx4 v[36:39], v4, s[36:39], s70 offen sc1
    s_or_b32 s89, s89, 0xaaaa0000
UMS_64:
    s_cbranch_vccz UMD_56
    s_sleep 1
    s_sub_u32 s80, s80, 1
    s_cmp_lg_u32 s80, 0
    s_cbranch_scc1 UM_55
UMD_56:
    v_max_f32_dpp v138, v136, v136 quad_perm:[1,0,3,2] row_mask:0xf bank_mask:0xf
    s_nop 1
    v_max_f32_dpp v138, v138, v138 quad_perm:[2,3,0,1] row_mask:0xf bank_mask:0xf
    v_mov_b32 v139, v138
    s_nop 1
    v_permlane32_swap_b32 v138, v139
    v_max_f32 v138, v138, v139
    v_mov_b32 v139, v138
    s_nop 1
    v_permlane16_swap_b32 v138, v139
    v_max_f32 v138, v138, v139
    v_sub_f32 v136, v136, v138
    v_exp_f32 v136, v136
    s_nop 0
    v_mul_f32 v137, v137, v136
    s_nop 1
    v_add_f32_dpp v137, v137, v137 quad_perm:[1,0,3,2] row_mask:0xf bank_mask:0xf
    s_nop 1
    v_add_f32_dpp v137, v137, v137 quad_perm:[2,3,0,1] row_mask:0xf bank_mask:0xf
    v_mov_b32 v138, v137
    s_nop 1
    v_permlane32_swap_b32 v137, v138
    v_add_f32 v137, v137, v138
    v_mov_b32 v138, v137
    s_nop 1
    v_permlane16_swap_b32 v137, v138
    v_add_f32 v137, v137, v138
    v_rcp_f32 v137, v137
    s_nop 0
    v_mul_f32 v136, v136, v137
    v_mov_b32 v137, v136
    s_nop 1
    v_permlane16_swap_b32 v136, v137
    v_mov_b32 v138, v136
    v_mov_b32 v139, v137
    s_nop 0
    v_permlane32_swap_b32 v136, v138
    v_permlane32_swap_b32 v137, v139
    s_nop 0
    v_mov_b32_dpp v148, v136 quad_perm:[0,0,2,2] row_mask:0xf bank_mask:0xf
    v_mov_b32_dpp v149, v137 quad_perm:[0,0,2,2] row_mask:0xf bank_mask:0xf
    v_mov_b32_dpp v150, v138 quad_perm:[0,0,2,2] row_mask:0xf bank_mask:0xf
    v_mov_b32_dpp v151, v139 quad_perm:[0,0,2,2] row_mask:0xf bank_mask:0xf
    v_mov_b32_dpp v152, v136 quad_perm:[1,1,3,3] row_mask:0xf bank_mask:0xf
    v_mov_b32_dpp v153, v137 quad_perm:[1,1,3,3] row_mask:0xf bank_mask:0xf
    v_mov_b32_dpp v154, v138 quad_perm:[1,1,3,3] row_mask:0xf bank_mask:0xf
    v_mov_b32_dpp v155, v139 quad_perm:[1,1,3,3] row_mask:0xf bank_mask:0xf
    s_waitcnt vmcnt(0)
    v_lshlrev_b32 v104, 16, v8
    v_and_b32 v105, 0xffff0000, v8
    v_lshlrev_b32 v106, 16, v9
    v_and_b32 v107, 0xffff0000, v9
    v_lshlrev_b32 v108, 16, v10
    v_and_b32 v109, 0xffff0000, v10
    v_lshlrev_b32 v110, 16, v11
    v_and_b32 v111, 0xffff0000, v11
    v_pk_mul_f32 v[120:121], v[104:105], v[148:149] op_sel_hi:[1,0]
    v_pk_mul_f32 v[122:123], v[106:107], v[148:149] op_sel_hi:[1,0]
    v_pk_mul_f32 v[124:125], v[108:109], v[148:149] op_sel_hi:[1,0]
    v_pk_mul_f32 v[126:127], v[110:111], v[148:149] op_sel_hi:[1,0]
    v_lshlrev_b32 v112, 16, v12
    v_and_b32 v113, 0xffff0000, v12
    v_lshlrev_b32 v114, 16, v13
    v_and_b32 v115, 0xffff0000, v13
    v_lshlrev_b32 v116, 16, v14
    v_and_b32 v117, 0xffff0000, v14
    v_lshlrev_b32 v118, 16, v15
    v_and_b32 v119, 0xffff0000, v15
    v_pk_mul_f32 v[128:129], v[112:113], v[148:149] op_sel:[0,1] op_sel_hi:[1,1]
    v_pk_mul_f32 v[130:131], v[114:115], v[148:149] op_sel:[0,1] op_sel_hi:[1,1]
    v_pk_mul_f32 v[132:133], v[116:117], v[148:149] op_sel:[0,1] op_sel_hi:[1,1]
    v_pk_mul_f32 v[134:135], v[118:119], v[148:149] op_sel:[0,1] op_sel_hi:[1,1]
    v_lshlrev_b32 v104, 16, v16
    v_and_b32 v105, 0xffff0000, v16
    v_lshlrev_b32 v106, 16, v17
    v_and_b32 v107, 0xffff0000, v17
    v_lshlrev_b32 v108, 16, v18
    v_and_b32 v109, 0xffff0000, v18
    v_lshlrev_b32 v110, 16, v19
    v_and_b32 v111, 0xffff0000, v19
    v_pk_fma_f32 v[120:121], v[104:105], v[150:151], v[120:121] op_sel_hi:[1,0,1]
    v_pk_fma_f32 v[122:123], v[106:107], v[150:151], v[122:123] op_sel_hi:[1,0,1]
    v_pk_fma_f32 v[124:125], v[108:109], v[150:151], v[124:125] op_sel_hi:[1,0,1]
    v_pk_fma_f32 v[126:127], v[110:111], v[150:151], v[126:127] op_sel_hi:[1,0,1]
    v_lshlrev_b32 v112, 16, v20
    v_and_b32 v113, 0xffff0000, v20
    v_lshlrev_b32 v114, 16, v21
    v_and_b32 v115, 0xffff0000, v21
    v_lshlrev_b32 v116, 16, v22
    v_and_b32 v117, 0xffff0000, v22
    v_lshlrev_b32 v118, 16, v23
    v_and_b32 v119, 0xffff0000, v23
    v_pk_fma_f32 v[128:129], v[112:113], v[150:151], v[128:129] op_sel:[0,1,0] op_sel_hi:[1,1,1]
    v_pk_fma_f32 v[130:131], v[114:115], v[150:151], v[130:131] op_sel:[0,1,0] op_sel_hi:[1,1,1]
    v_pk_fma_f32 v[132:133], v[116:117], v[150:151], v[132:133] op_sel:[0,1,0] op_sel_hi:[1,1,1]
    v_pk_fma_f32 v[134:135], v[118:119], v[150:151], v[134:135] op_sel:[0,1,0] op_sel_hi:[1,1,1]
    v_lshlrev_b32 v104, 16, v24
    v_and_b32 v105, 0xffff0000, v24
    v_lshlrev_b32 v106, 16, v25
    v_and_b32 v107, 0xffff0000, v25
    v_lshlrev_b32 v108, 16, v26
    v_and_b32 v109, 0xffff0000, v26
    v_lshlrev_b32 v110, 16, v27
    v_and_b32 v111, 0xffff0000, v27
    v_pk_fma_f32 v[120:121], v[104:105], v[152:153], v[120:121] op_sel_hi:[1,0,1]
    v_pk_fma_f32 v[122:123], v[106:107], v[152:153], v[122:123] op_sel_hi:[1,0,1]
    v_pk_fma_f32 v[124:125], v[108:109], v[152:153], v[124:125] op_sel_hi:[1,0,1]
    v_pk_fma_f32 v[126:127], v[110:111], v[152:153], v[126:127] op_sel_hi:[1,0,1]
    v_lshlrev_b32 v112, 16, v28
    v_and_b32 v113, 0xffff0000, v28
    v_lshlrev_b32 v114, 16, v29
    v_and_b32 v115, 0xffff0000, v29
    v_lshlrev_b32 v116, 16, v30
    v_and_b32 v117, 0xffff0000, v30
    v_lshlrev_b32 v118, 16, v31
    v_and_b32 v119, 0xffff0000, v31
    v_pk_fma_f32 v[128:129], v[112:113], v[152:153], v[128:129] op_sel:[0,1,0] op_sel_hi:[1,1,1]
    v_pk_fma_f32 v[130:131], v[114:115], v[152:153], v[130:131] op_sel:[0,1,0] op_sel_hi:[1,1,1]
    v_pk_fma_f32 v[132:133], v[116:117], v[152:153], v[132:133] op_sel:[0,1,0] op_sel_hi:[1,1,1]
    v_pk_fma_f32 v[134:135], v[118:119], v[152:153], v[134:135] op_sel:[0,1,0] op_sel_hi:[1,1,1]
    v_lshlrev_b32 v104, 16, v32
    v_and_b32 v105, 0xffff0000, v32
    v_lshlrev_b32 v106, 16, v33
    v_and_b32 v107, 0xffff0000, v33
    v_lshlrev_b32 v108, 16, v34
    v_and_b32 v109, 0xffff0000, v34
    v_lshlrev_b32 v110, 16, v35
    v_and_b32 v111, 0xffff0000, v35
    v_pk_fma_f32 v[120:121], v[104:105], v[154:155], v[120:121] op_sel_hi:[1,0,1]
    v_pk_fma_f32 v[122:123], v[106:107], v[154:155], v[122:123] op_sel_hi:[1,0,1]
    v_pk_fma_f32 v[124:125], v[108:109], v[154:155], v[124:125] op_sel_hi:[1,0,1]
    v_pk_fma_f32 v[126:127], v[110:111], v[154:155], v[126:127] op_sel_hi:[1,0,1]
    v_lshlrev_b32 v112, 16, v36
    v_and_b32 v113, 0xffff0000, v36
    v_lshlrev_b32 v114, 16, v37
    v_and_b32 v115, 0xffff0000, v37
    v_lshlrev_b32 v116, 16, v38
    v_and_b32 v117, 0xffff0000, v38
    v_lshlrev_b32 v118, 16, v39
    v_and_b32 v119, 0xffff0000, v39
    v_pk_fma_f32 v[128:129], v[112:113], v[154:155], v[128:129] op_sel:[0,1,0] op_sel_hi:[1,1,1]
    v_pk_fma_f32 v[130:131], v[114:115], v[154:155], v[130:131] op_sel:[0,1,0] op_sel_hi:[1,1,1]
    v_pk_fma_f32 v[132:133], v[116:117], v[154:155], v[132:133] op_sel:[0,1,0] op_sel_hi:[1,1,1]
    v_pk_fma_f32 v[134:135], v[118:119], v[154:155], v[134:135] op_sel:[0,1,0] op_sel_hi:[1,1,1]
    v_pk_add_f32 v[120:121], v[120:121], v[128:129]
    v_pk_add_f32 v[122:123], v[122:123], v[130:131]
    v_pk_add_f32 v[124:125], v[124:125], v[132:133]
    v_pk_add_f32 v[126:127], v[126:127], v[134:135]
    v_cvt_pk_bf16_f32 v128, v120, v121
    v_cvt_pk_bf16_f32 v129, v122, v123
    v_cvt_pk_bf16_f32 v130, v124, v125
    v_cvt_pk_bf16_f32 v131, v126, v127
    v_cndmask_b32 v140, v128, 0, s[86:87]
    v_cndmask_b32 v144, 0, v128, s[86:87]
    v_cndmask_b32 v141, v129, 0, s[86:87]
    v_cndmask_b32 v145, 0, v129, s[86:87]
    v_cndmask_b32 v142, v130, 0, s[86:87]
    v_cndmask_b32 v146, 0, v130, s[86:87]
    v_cndmask_b32 v143, v131, 0, s[86:87]
    v_cndmask_b32 v147, 0, v131, s[86:87]
    s_nop 0
    v_mfma_f32_16x16x32_bf16 v[8:11], v[140:143], v[40:43], 0
    v_mfma_f32_16x16x32_bf16 v[12:15], v[140:143], v[44:47], 0
    v_mfma_f32_16x16x32_bf16 v[16:19], v[140:143], v[48:51], 0
    v_mfma_f32_16x16x32_bf16 v[20:23], v[140:143], v[52:55], 0
    v_mfma_f32_16x16x32_bf16 v[24:27], v[140:143], v[56:59], 0
    v_mfma_f32_16x16x32_bf16 v[28:31], v[140:143], v[60:63], 0
    v_mfma_f32_16x16x32_bf16 v[32:35], v[140:143], v[64:67], 0
    v_mfma_f32_16x16x32_bf16 v[36:39], v[140:143], v[68:71], 0
    v_mfma_f32_16x16x32_bf16 v[8:11], v[144:147], v[72:75], v[8:11]
    v_mfma_f32_16x16x32_bf16 v[12:15], v[144:147], v[76:79], v[12:15]
    v_mfma_f32_16x16x32_bf16 v[16:19], v[144:147], v[80:83], v[16:19]
    v_mfma_f32_16x16x32_bf16 v[20:23], v[144:147], v[84:87], v[20:23]
    v_mfma_f32_16x16x32_bf16 v[24:27], v[144:147], v[88:91], v[24:27]
    v_mfma_f32_16x16x32_bf16 v[28:31], v[144:147], v[92:95], v[28:31]
    v_mfma_f32_16x16x32_bf16 v[32:35], v[144:147], v[96:99], v[32:35]
    v_mfma_f32_16x16x32_bf16 v[36:39], v[144:147], v[100:103], v[36:39]
    s_nop 0
    v_pk_add_f32 v[8:9], v[8:9], v[10:11]
    v_pk_add_f32 v[12:13], v[12:13], v[14:15]
    v_pk_add_f32 v[16:17], v[16:17], v[18:19]
    v_pk_add_f32 v[20:21], v[20:21], v[22:23]
    v_pk_add_f32 v[24:25], v[24:25], v[26:27]
    v_pk_add_f32 v[28:29], v[28:29], v[30:31]
    v_pk_add_f32 v[32:33], v[32:33], v[34:35]
    v_pk_add_f32 v[36:37], v[36:37], v[38:39]
    v_add_f32 v104, v8, v9
    v_add_f32 v105, v12, v13
    v_add_f32 v106, v16, v17
    v_add_f32 v107, v20, v21
    v_add_f32 v108, v24, v25
    v_add_f32 v109, v28, v29
    v_add_f32 v110, v32, v33
    v_add_f32 v111, v36, v37
    ds_write_b128 v5, v[104:107]
    ds_write_b128 v5, v[108:111] offset:16
    v_mov_b32 v160, 0x2400c
    v_mov_b32 v161, 1
    s_waitcnt lgkmcnt(0)
    s_mov_b64 exec, 1
    ds_add_u32 v160, v161
    s_mov_b64 exec, -1
    v_and_b32 v160, 31, v1
    s_lshl_b32 s7, s3, 8
    s_add_u32 s7, s7, 0x10000
    v_lshl_add_u32 v5, v160, 3, s7
    s_lshl_b32 s7, s3, 7
    s_add_u32 s7, s7, 0x24400
    v_lshl_add_u32 v4, v160, 2, s7
    v_mov_b32 v160, 0x2400c
    s_mov_b32 s80, 1600000
LW_65:
    ds_read_b32 v161, v160
    s_waitcnt lgkmcnt(0)
    v_readfirstlane_b32 s79, v161
    s_cmp_ge_u32 s79, 8
    s_cbranch_scc1 LWD_66
    s_sub_u32 s80, s80, 1
    s_cmp_lg_u32 s80, 0
    s_cbranch_scc1 LW_65
LWD_66:
    ds_read_b64 v[8:9], v5 offset:0
    ds_read_b64 v[10:11], v5 offset:2048
    ds_read_b64 v[12:13], v5 offset:4096
    ds_read_b64 v[14:15], v5 offset:6144
    ds_read_b64 v[16:17], v5 offset:8192
    ds_read_b64 v[18:19], v5 offset:10240
    ds_read_b64 v[20:21], v5 offset:12288
    ds_read_b64 v[22:23], v5 offset:14336
    s_waitcnt lgkmcnt(0)
    v_pk_add_f32 v[8:9], v[8:9], v[16:17]
    v_pk_add_f32 v[10:11], v[10:11], v[18:19]
    v_pk_add_f32 v[12:13], v[12:13], v[20:21]
    v_pk_add_f32 v[14:15], v[14:15], v[22:23]
    v_pk_add_f32 v[8:9], v[8:9], v[12:13]
    v_pk_add_f32 v[10:11], v[10:11], v[14:15]
    v_pk_add_f32 v[8:9], v[8:9], v[10:11]
    v_cvt_pk_bf16_f32 v8, v8, v9
    ds_write_b32 v4, v8
    v_mov_b32 v160, 0x24020
    v_mov_b32 v161, 1
    s_waitcnt lgkmcnt(0)
    s_mov_b64 exec, 1
    ds_add_u32 v160, v161
    s_mov_b64 exec, -1
    s_endpgm
L_W2:
    s_mov_b32 s52, s24
    s_and_b32 s53, s25, 0xffff
    s_mov_b32 s54, 0x400000
    s_mov_b32 s55, 0x20000
    s_sub_u32 s62, s3, 8
    s_lshl_b32 s7, s5, 2
    s_add_u32 s7, s7, s62
    s_lshl_b32 s7, s7, 17
    s_lshl_b32 s70, s4, 10
    s_add_u32 s70, s70, s7
    s_lshl_b32 s71, s62, 14
    v_lshlrev_b32 v2, 4, v1
    s_lshl_b32 s7, s62, 6
    v_xor_b32 v4, s7, v2
    v_xor_b32 v5, 16, v4
    v_xor_b32 v6, 32, v4
    v_xor_b32 v7, 48, v4
    s_mov_b32 m0, s71
    s_nop 0
    buffer_load_dwordx4 v4, s[52:55], s70 offen nt lds
    s_add_u32 s70, s70, 8192
    s_add_u32 s71, s71, 1024
    s_mov_b32 m0, s71
    s_nop 0
    buffer_load_dwordx4 v4, s[52:55], s70 offen nt lds
    s_add_u32 s70, s70, 8192
    s_add_u32 s71, s71, 1024
    s_barrier
    s_mov_b32 m0, s71
    s_nop 0
    buffer_load_dwordx4 v4, s[52:55], s70 offen nt lds
    s_add_u32 s70, s70, 8192
    s_add_u32 s71, s71, 1024
    s_mov_b32 m0, s71
    s_nop 0
    buffer_load_dwordx4 v4, s[52:55], s70 offen nt lds
    s_add_u32 s70, s70, 8192
    s_add_u32 s71, s71, 1024
    s_mov_b32 m0, s71
    s_nop 0
    buffer_load_dwordx4 v5, s[52:55], s70 offen nt lds
    s_add_u32 s70, s70, 8192
    s_add_u32 s71, s71, 1024
    s_mov_b32 m0, s71
    s_nop 0
    buffer_load_dwordx4 v5, s[52:55], s70 offen nt lds
    s_add_u32 s70, s70, 8192
    s_add_u32 s71, s71, 1024
    s_mov_b32 m0, s71
    s_nop 0
    buffer_load_dwordx4 v5, s[52:55], s70 offen nt lds
    s_add_u32 s70, s70, 8192
    s_add_u32 s71, s71, 1024
    s_mov_b32 m0, s71
    s_nop 0
    buffer_load_dwordx4 v5, s[52:55], s70 offen nt lds
    s_add_u32 s70, s70, 8192
    s_add_u32 s71, s71, 1024
    s_mov_b32 m0, s71
    s_waitcnt vmcnt(7)
    buffer_load_dwordx4 v6, s[52:55], s70 offen nt lds
    s_add_u32 s70, s70, 8192
    s_add_u32 s71, s71, 1024
    s_mov_b32 m0, s71
    s_waitcnt vmcnt(7)
    buffer_load_dwordx4 v6, s[52:55], s70 offen nt lds
    s_add_u32 s70, s70, 8192
    s_add_u32 s71, s71, 1024
    s_mov_b32 m0, s71
    s_waitcnt vmcnt(7)
    buffer_load_dwordx4 v6, s[52:55], s70 offen nt lds
    s_add_u32 s70, s70, 8192
    s_add_u32 s71, s71, 1024
    s_mov_b32 m0, s71
    s_waitcnt vmcnt(7)
    buffer_load_dwordx4 v6, s[52:55], s70 offen nt lds
    s_add_u32 s70, s70, 8192
    s_add_u32 s71, s71, 1024
    s_mov_b32 m0, s71
    s_waitcnt vmcnt(7)
    buffer_load_dwordx4 v7, s[52:55], s70 offen nt lds
    s_add_u32 s70, s70, 8192
    s_add_u32 s71, s71, 1024
    s_mov_b32 m0, s71
    s_waitcnt vmcnt(7)
    buffer_load_dwordx4 v7, s[52:55], s70 offen nt lds
    s_add_u32 s70, s70, 8192
    s_add_u32 s71, s71, 1024
    s_mov_b32 m0, s71
    s_waitcnt vmcnt(7)
    buffer_load_dwordx4 v7, s[52:55], s70 offen nt lds
    s_add_u32 s70, s70, 8192
    s_add_u32 s71, s71, 1024
    s_mov_b32 m0, s71
    s_waitcnt vmcnt(7)
    buffer_load_dwordx4 v7, s[52:55], s70 offen nt lds
    s_add_u32 s70, s70, 8192
    s_add_u32 s71, s71, 1024
    s_cmp_lt_u32 s5, 4
    s_cselect_b32 s72, s28, s16
    s_cselect_b32 s73, s29, s17
    s_mov_b32 s56, s72
    s_and_b32 s57, s73, 0xffff
    s_mov_b32 s58, 0x400000
    s_mov_b32 s59, 0x20000
    v_lshrrev_b32 v4, 4, v1
    v_lshlrev_b32 v2, 13, v4
    v_and_b32 v4, 15, v1
    v_lshl_add_u32 v2, v4, 4, v2
    s_lshl_b32 s7, s6, 17
    s_lshl_b32 s70, s62, 8
    s_add_u32 s7, s7, s70
    v_add_u32 v2, s7, v2
    v_lshrrev_b32 v3, 4, v1
    v_lshlrev_b32 v3, 16, v3
    v_bfe_u32 v4, v1, 3, 1
    v_lshl_add_u32 v3, v4, 13, v3
    v_and_b32 v4, 7, v1
    v_lshl_add_u32 v3, v4, 4, v3
    s_cmp_lt_u32 s5, 4
    s_cselect_b32 s7, 0x800, 0x0
    s_add_u32 s7, s7, s6
    s_lshl_b32 s7, s7, 7
    s_add_u32 s7, s7, 0x100000
    v_add_u32 v3, s7, v3
    s_lshl_b32 s7, s62, 14
    v_add_u32 v3, s7, v3
    s_waitcnt vmcnt(0)
    v_mov_b32 v4, 0x24014
    v_mov_b32 v5, 1
    s_waitcnt lgkmcnt(0)
    s_mov_b64 exec, 1
    ds_add_u32 v4, v5
    s_mov_b64 exec, -1
    s_mov_b32 s70, 0
    v_mov_b32 v4, 0x24048
    s_mov_b32 s80, 1600000
LW_69:
    ds_read_b32 v5, v4
    s_waitcnt lgkmcnt(0)
    v_readfirstlane_b32 s79, v5
    s_cmp_ge_u32 s79, 4
    s_cbranch_scc1 LWD_70
    s_sleep 4
    s_sub_u32 s80, s80, 1
    s_cmp_lg_u32 s80, 0
    s_cbranch_scc1 LW_69
LWD_70:
    s_cmp_lt_u32 s5, 4
    s_cbranch_scc1 S2U_67
    v_mov_b32 v4, 0x2405c
    s_mov_b32 s80, 1600000
LW_71:
    ds_read_b32 v5, v4
    s_waitcnt lgkmcnt(0)
    v_readfirstlane_b32 s79, v5
    s_cmp_ge_u32 s79, 4
    s_cbranch_scc1 LWD_72
    s_sleep 8
    s_sub_u32 s80, s80, 1
    s_cmp_lg_u32 s80, 0
    s_cbranch_scc1 LW_71
LWD_72:
    buffer_load_dwordx4 v[40:43], v2, s[56:59], s70 offen offset:0 nt
    buffer_load_dwordx4 v[44:47], v2, s[56:59], s70 offen offset:1024 nt
    buffer_load_dwordx4 v[48:51], v2, s[56:59], s70 offen offset:2048 nt
    buffer_load_dwordx4 v[52:55], v2, s[56:59], s70 offen offset:3072 nt
    s_add_u32 s70, s70, 4096
    s_waitcnt vmcnt(2)
    buffer_load_dwordx4 v[56:59], v2, s[56:59], s70 offen offset:0 nt
    buffer_load_dwordx4 v[60:63], v2, s[56:59], s70 offen offset:1024 nt
    buffer_load_dwordx4 v[64:67], v2, s[56:59], s70 offen offset:2048 nt
    buffer_load_dwordx4 v[68:71], v2, s[56:59], s70 offen offset:3072 nt
    s_add_u32 s70, s70, 28672
    s_waitcnt vmcnt(2)
    buffer_load_dwordx4 v[72:75], v2, s[56:59], s70 offen offset:0 nt
    buffer_load_dwordx4 v[76:79], v2, s[56:59], s70 offen offset:1024 nt
    buffer_load_dwordx4 v[80:83], v2, s[56:59], s70 offen offset:2048 nt
    buffer_load_dwordx4 v[84:87], v2, s[56:59], s70 offen offset:3072 nt
    s_add_u32 s70, s70, 4096
    s_waitcnt vmcnt(2)
    buffer_load_dwordx4 v[88:91], v2, s[56:59], s70 offen offset:0 nt
    buffer_load_dwordx4 v[92:95], v2, s[56:59], s70 offen offset:1024 nt
    buffer_load_dwordx4 v[96:99], v2, s[56:59], s70 offen offset:2048 nt
    buffer_load_dwordx4 v[100:103], v2, s[56:59], s70 offen offset:3072 nt
    s_add_u32 s70, s70, 28672
    s_waitcnt vmcnt(2)
    buffer_load_dwordx4 v[104:107], v2, s[56:59], s70 offen offset:0 nt
    buffer_load_dwordx4 v[108:111], v2, s[56:59], s70 offen offset:1024 nt
    buffer_load_dwordx4 v[112:115], v2, s[56:59], s70 offen offset:2048 nt
    buffer_load_dwordx4 v[116:119], v2, s[56:59], s70 offen offset:3072 nt
    s_add_u32 s70, s70, 4096
    s_waitcnt vmcnt(2)
    buffer_load_dwordx4 v[120:123], v2, s[56:59], s70 offen offset:0 nt
    buffer_load_dwordx4 v[124:127], v2, s[56:59], s70 offen offset:1024 nt
    buffer_load_dwordx4 v[128:131], v2, s[56:59], s70 offen offset:2048 nt
    buffer_load_dwordx4 v[132:135], v2, s[56:59], s70 offen offset:3072 nt
    s_add_u32 s70, s70, 28672
    s_waitcnt vmcnt(2)
    buffer_load_dwordx4 v[136:139], v2, s[56:59], s70 offen offset:0 nt
    buffer_load_dwordx4 v[140:143], v2, s[56:59], s70 offen offset:1024 nt
    buffer_load_dwordx4 v[144:147], v2, s[56:59], s70 offen offset:2048 nt
    buffer_load_dwordx4 v[148:151], v2, s[56:59], s70 offen offset:3072 nt
    s_add_u32 s70, s70, 4096
    s_waitcnt vmcnt(2)
    buffer_load_dwordx4 v[152:155], v2, s[56:59], s70 offen offset:0 nt
    buffer_load_dwordx4 v[156:159], v2, s[56:59], s70 offen offset:1024 nt
    buffer_load_dwordx4 v[160:163], v2, s[56:59], s70 offen offset:2048 nt
    buffer_load_dwordx4 v[164:167], v2, s[56:59], s70 offen offset:3072 nt
    s_add_u32 s70, s70, 28672
    s_waitcnt vmcnt(0)
    s_branch S2J_68
S2U_67:
    buffer_load_dwordx4 v[40:43], v2, s[56:59], s70 offen offset:0 nt
    buffer_load_dwordx4 v[44:47], v2, s[56:59], s70 offen offset:1024 nt
    buffer_load_dwordx4 v[48:51], v2, s[56:59], s70 offen offset:2048 nt
    buffer_load_dwordx4 v[52:55], v2, s[56:59], s70 offen offset:3072 nt
    s_add_u32 s70, s70, 4096
    s_waitcnt vmcnt(2)
    buffer_load_dwordx4 v[56:59], v2, s[56:59], s70 offen offset:0 nt
    buffer_load_dwordx4 v[60:63], v2, s[56:59], s70 offen offset:1024 nt
    buffer_load_dwordx4 v[64:67], v2, s[56:59], s70 offen offset:2048 nt
    buffer_load_dwordx4 v[68:71], v2, s[56:59], s70 offen offset:3072 nt
    s_add_u32 s70, s70, 28672
    s_waitcnt vmcnt(2)
    buffer_load_dwordx4 v[72:75], v2, s[56:59], s70 offen offset:0 nt
    buffer_load_dwordx4 v[76:79], v2, s[56:59], s70 offen offset:1024 nt
    buffer_load_dwordx4 v[80:83], v2, s[56:59], s70 offen offset:2048 nt
    buffer_load_dwordx4 v[84:87], v2, s[56:59], s70 offen offset:3072 nt
    s_add_u32 s70, s70, 4096
    s_waitcnt vmcnt(2)
    buffer_load_dwordx4 v[88:91], v2, s[56:59], s70 offen offset:0 nt
    buffer_load_dwordx4 v[92:95], v2, s[56:59], s70 offen offset:1024 nt
    buffer_load_dwordx4 v[96:99], v2, s[56:59], s70 offen offset:2048 nt
    buffer_load_dwordx4 v[100:103], v2, s[56:59], s70 offen offset:3072 nt
    s_add_u32 s70, s70, 28672
    s_waitcnt vmcnt(2)
    buffer_load_dwordx4 v[104:107], v2, s[56:59], s70 offen offset:0 nt
    buffer_load_dwordx4 v[108:111], v2, s[56:59], s70 offen offset:1024 nt
    buffer_load_dwordx4 v[112:115], v2, s[56:59], s70 offen offset:2048 nt
    buffer_load_dwordx4 v[116:119], v2, s[56:59], s70 offen offset:3072 nt
    s_add_u32 s70, s70, 4096
    s_waitcnt vmcnt(2)
    buffer_load_dwordx4 v[120:123], v2, s[56:59], s70 offen offset:0 nt
    buffer_load_dwordx4 v[124:127], v2, s[56:59], s70 offen offset:1024 nt
    buffer_load_dwordx4 v[128:131], v2, s[56:59], s70 offen offset:2048 nt
    buffer_load_dwordx4 v[132:135], v2, s[56:59], s70 offen offset:3072 nt
    s_add_u32 s70, s70, 28672
    s_waitcnt vmcnt(2)
    buffer_load_dwordx4 v[136:139], v2, s[56:59], s70 offen offset:0 nt
    buffer_load_dwordx4 v[140:143], v2, s[56:59], s70 offen offset:1024 nt
    buffer_load_dwordx4 v[144:147], v2, s[56:59], s70 offen offset:2048 nt
    buffer_load_dwordx4 v[148:151], v2, s[56:59], s70 offen offset:3072 nt
    s_add_u32 s70, s70, 4096
    s_waitcnt vmcnt(2)
    buffer_load_dwordx4 v[152:155], v2, s[56:59], s70 offen offset:0 nt
    buffer_load_dwordx4 v[156:159], v2, s[56:59], s70 offen offset:1024 nt
    buffer_load_dwordx4 v[160:163], v2, s[56:59], s70 offen offset:2048 nt
    buffer_load_dwordx4 v[164:167], v2, s[56:59], s70 offen offset:3072 nt
    s_add_u32 s70, s70, 28672
    s_waitcnt vmcnt(0)
S2J_68:
    v_perm_b32 v8, v44, v40, s92
    v_perm_b32 v9, v52, v48, s92
    v_perm_b32 v10, v60, v56, s92
    v_perm_b32 v11, v68, v64, s92
    v_perm_b32 v12, v44, v40, s93
    v_perm_b32 v13, v52, v48, s93
    v_perm_b32 v14, v60, v56, s93
    v_perm_b32 v15, v68, v64, s93
    v_perm_b32 v16, v45, v41, s92
    v_perm_b32 v17, v53, v49, s92
    v_perm_b32 v18, v61, v57, s92
    v_perm_b32 v19, v69, v65, s92
    v_perm_b32 v20, v45, v41, s93
    v_perm_b32 v21, v53, v49, s93
    v_perm_b32 v22, v61, v57, s93
    v_perm_b32 v23, v69, v65, s93
    v_perm_b32 v24, v46, v42, s92
    v_perm_b32 v25, v54, v50, s92
    v_perm_b32 v26, v62, v58, s92
    v_perm_b32 v27, v70, v66, s92
    v_perm_b32 v28, v46, v42, s93
    v_perm_b32 v29, v54, v50, s93
    v_perm_b32 v30, v62, v58, s93
    v_perm_b32 v31, v70, v66, s93
    v_perm_b32 v32, v47, v43, s92
    v_perm_b32 v33, v55, v51, s92
    v_perm_b32 v34, v63, v59, s92
    v_perm_b32 v35, v71, v67, s92
    v_perm_b32 v36, v47, v43, s93
    v_perm_b32 v37, v55, v51, s93
    v_perm_b32 v38, v63, v59, s93
    v_perm_b32 v39, v71, v67, s93
    v_perm_b32 v40, v76, v72, s92
    v_perm_b32 v41, v84, v80, s92
    v_perm_b32 v42, v92, v88, s92
    v_perm_b32 v43, v100, v96, s92
    v_perm_b32 v44, v76, v72, s93
    v_perm_b32 v45, v84, v80, s93
    v_perm_b32 v46, v92, v88, s93
    v_perm_b32 v47, v100, v96, s93
    v_perm_b32 v48, v77, v73, s92
    v_perm_b32 v49, v85, v81, s92
    v_perm_b32 v50, v93, v89, s92
    v_perm_b32 v51, v101, v97, s92
    v_perm_b32 v52, v77, v73, s93
    v_perm_b32 v53, v85, v81, s93
    v_perm_b32 v54, v93, v89, s93
    v_perm_b32 v55, v101, v97, s93
    v_perm_b32 v56, v78, v74, s92
    v_perm_b32 v57, v86, v82, s92
    v_perm_b32 v58, v94, v90, s92
    v_perm_b32 v59, v102, v98, s92
    v_perm_b32 v60, v78, v74, s93
    v_perm_b32 v61, v86, v82, s93
    v_perm_b32 v62, v94, v90, s93
    v_perm_b32 v63, v102, v98, s93
    v_perm_b32 v64, v79, v75, s92
    v_perm_b32 v65, v87, v83, s92
    v_perm_b32 v66, v95, v91, s92
    v_perm_b32 v67, v103, v99, s92
    v_perm_b32 v68, v79, v75, s93
    v_perm_b32 v69, v87, v83, s93
    v_perm_b32 v70, v95, v91, s93
    v_perm_b32 v71, v103, v99, s93
    v_perm_b32 v72, v108, v104, s92
    v_perm_b32 v73, v116, v112, s92
    v_perm_b32 v74, v124, v120, s92
    v_perm_b32 v75, v132, v128, s92
    v_perm_b32 v76, v108, v104, s93
    v_perm_b32 v77, v116, v112, s93
    v_perm_b32 v78, v124, v120, s93
    v_perm_b32 v79, v132, v128, s93
    v_perm_b32 v80, v109, v105, s92
    v_perm_b32 v81, v117, v113, s92
    v_perm_b32 v82, v125, v121, s92
    v_perm_b32 v83, v133, v129, s92
    v_perm_b32 v84, v109, v105, s93
    v_perm_b32 v85, v117, v113, s93
    v_perm_b32 v86, v125, v121, s93
    v_perm_b32 v87, v133, v129, s93
    v_perm_b32 v88, v110, v106, s92
    v_perm_b32 v89, v118, v114, s92
    v_perm_b32 v90, v126, v122, s92
    v_perm_b32 v91, v134, v130, s92
    v_perm_b32 v92, v110, v106, s93
    v_perm_b32 v93, v118, v114, s93
    v_perm_b32 v94, v126, v122, s93
    v_perm_b32 v95, v134, v130, s93
    v_perm_b32 v96, v111, v107, s92
    v_perm_b32 v97, v119, v115, s92
    v_perm_b32 v98, v127, v123, s92
    v_perm_b32 v99, v135, v131, s92
    v_perm_b32 v100, v111, v107, s93
    v_perm_b32 v101, v119, v115, s93
    v_perm_b32 v102, v127, v123, s93
    v_perm_b32 v103, v135, v131, s93
    v_perm_b32 v104, v140, v136, s92
    v_perm_b32 v105, v148, v144, s92
    v_perm_b32 v106, v156, v152, s92
    v_perm_b32 v107, v164, v160, s92
    v_perm_b32 v108, v140, v136, s93
    v_perm_b32 v109, v148, v144, s93
    v_perm_b32 v110, v156, v152, s93
    v_perm_b32 v111, v164, v160, s93
    v_perm_b32 v112, v141, v137, s92
    v_perm_b32 v113, v149, v145, s92
    v_perm_b32 v114, v157, v153, s92
    v_perm_b32 v115, v165, v161, s92
    v_perm_b32 v116, v141, v137, s93
    v_perm_b32 v117, v149, v145, s93
    v_perm_b32 v118, v157, v153, s93
    v_perm_b32 v119, v165, v161, s93
    v_perm_b32 v120, v142, v138, s92
    v_perm_b32 v121, v150, v146, s92
    v_perm_b32 v122, v158, v154, s92
    v_perm_b32 v123, v166, v162, s92
    v_perm_b32 v124, v142, v138, s93
    v_perm_b32 v125, v150, v146, s93
    v_perm_b32 v126, v158, v154, s93
    v_perm_b32 v127, v166, v162, s93
    v_perm_b32 v128, v143, v139, s92
    v_perm_b32 v129, v151, v147, s92
    v_perm_b32 v130, v159, v155, s92
    v_perm_b32 v131, v167, v163, s92
    v_perm_b32 v132, v143, v139, s93
    v_perm_b32 v133, v151, v147, s93
    v_perm_b32 v134, v159, v155, s93
    v_perm_b32 v135, v167, v163, s93
    v_mov_b32 v160, 0x2404c
    s_mov_b32 s80, 1600000
LW_73:
    ds_read_b32 v161, v160
    s_waitcnt lgkmcnt(0)
    v_readfirstlane_b32 s79, v161
    s_cmp_ge_u32 s79, 1
    s_cbranch_scc1 LWD_74
    s_sleep 2
    s_sub_u32 s80, s80, 1
    s_cmp_lg_u32 s80, 0
    s_cbranch_scc1 LW_73
LWD_74:
    v_mov_b32 v160, 0x24050
    ds_read_b64 v[162:163], v160
    s_waitcnt lgkmcnt(0)
    v_readfirstlane_b32 s94, v162
    v_readfirstlane_b32 s95, v163
    v_bfe_u32 v4, v1, 2, 2
    v_lshlrev_b32 v4, 8, v4
    v_lshrrev_b32 v160, 4, v1
    v_lshl_add_u32 v4, v160, 4, v4
    s_mov_b32 s70, 4096
    s_cmp_ge_u32 s5, 4
    s_cbranch_scc1 S2X_75
    v_add_u32 v4, 0x24400, v4
    s_cmp_lg_u32 s3, 8
    s_cbranch_scc1 U8_77
    v_and_b32 v5, 15, v1
    v_lshl_add_u32 v5, v5, 2, v160
    s_lshl_b32 s7, s6, 4
    s_add_u32 s7, s7, 0xe0000
    v_lshl_add_u32 v5, v5, 9, s7
    v_lshlrev_b32 v6, 4, v1
    v_add_u32 v6, 0x24800, v6
    s_mov_b32 s80, 200000
PO_78:
    buffer_load_dwordx4 v[136:139], v5, s[36:39], 0 offen sc1
PO2_79:
    s_waitcnt vmcnt(0)
    v_cmp_ne_u64 vcc, s[94:95], v[138:139]
    s_cmp_lg_u64 vcc, -1
    s_cbranch_scc1 POD_80
    s_sleep 16
    s_sub_u32 s80, s80, 1
    s_cmp_lg_u32 s80, 0
    s_cbranch_scc1 PO_78
POD_80:
    s_setprio 3
    ds_write_b128 v6, v[136:139]
    v_mov_b32 v160, 0x2401c
    v_mov_b32 v161, 1
    s_waitcnt lgkmcnt(0)
    s_mov_b64 exec, 1
    ds_add_u32 v160, v161
    s_mov_b64 exec, -1
    s_cbranch_vccz U8D_82
    buffer_load_dwordx4 v[136:139], v5, s[36:39], 0 offen sc1
    s_sleep 4
    buffer_load_dwordx4 v[140:143], v5, s[36:39], 0 offen sc1
    s_sleep 4
    s_mov_b32 s80, 200000
U8P_81:
    s_waitcnt vmcnt(1)
    ds_write_b128 v6, v[136:139]
    v_cmp_ne_u64 vcc, s[94:95], v[138:139]
    s_cbranch_vccz U8D_82
    s_waitcnt lgkmcnt(0)
    buffer_load_dwordx4 v[136:139], v5, s[36:39], 0 offen sc1
    s_waitcnt vmcnt(1)
    ds_write_b128 v6, v[140:143]
    v_cmp_ne_u64 vcc, s[94:95], v[142:143]
    s_cbranch_vccz U8D_82
    s_waitcnt lgkmcnt(0)
    buffer_load_dwordx4 v[140:143], v5, s[36:39], 0 offen sc1
    s_sub_u32 s80, s80, 1
    s_cmp_lg_u32 s80, 0
    s_cbranch_scc1 U8P_81
U8D_82:
    s_waitcnt vmcnt(0)
U8_77:
    v_mov_b32 v160, 0x24020
    s_mov_b32 s80, 1600000
LW_83:
    ds_read_b32 v161, v160
    s_waitcnt lgkmcnt(0)
    v_readfirstlane_b32 s79, v161
    s_cmp_ge_u32 s79, 8
    s_cbranch_scc1 LWD_84
    s_sleep 1
    s_sub_u32 s80, s80, 1
    s_cmp_lg_u32 s80, 0
    s_cbranch_scc1 LW_83
LWD_84:
    s_setprio 3
    ds_read_b128 v[136:139], v4 offset:0
    ds_read_b128 v[140:143], v4 offset:64
    ds_read_b128 v[144:147], v4 offset:128
    ds_read_b128 v[148:151], v4 offset:192
    s_waitcnt lgkmcnt(0)
    s_branch S2M_76
S2X_75:
    v_and_b32 v160, 3, v1
    v_lshl_add_u32 v4, v160, 6, v4
    s_lshl_b32 s7, s6, 11
    s_add_u32 s7, s7, 0xd0000
    v_add_u32 v4, s7, v4
    s_mov_b32 s80, 200000
PO_85:
    buffer_load_dwordx4 v[152:155], v4, s[36:39], 0 offen offset:0 sc1
PO2_86:
    s_waitcnt vmcnt(0)
    v_cmp_ne_u64 vcc, s[94:95], v[154:155]
    s_cmp_lg_u64 vcc, -1
    s_cbranch_scc1 POD_87
    s_sleep 8
    s_sub_u32 s80, s80, 1
    s_cmp_lg_u32 s80, 0
    s_cbranch_scc1 PO_85
POD_87:
    s_setprio 3
    buffer_load_dwordx4 v[152:155], v4, s[36:39], 0 offen offset:0 sc1
    buffer_load_dwordx4 v[156:159], v4, s[36:39], 0 offen offset:1024 sc1
    s_sleep 4
    buffer_load_dwordx4 v[160:163], v4, s[36:39], 0 offen offset:0 sc1
    buffer_load_dwordx4 v[164:167], v4, s[36:39], 0 offen offset:1024 sc1
    s_sleep 4
    s_mov_b32 s80, 200000
PP_88:
    s_waitcnt vmcnt(2)
    v_cmp_ne_u64 vcc, s[94:95], v[154:155]
    v_cmp_ne_u64 s[84:85], s[94:95], v[158:159]
    s_or_b64 vcc, vcc, s[84:85]
    s_cmp_eq_u64 vcc, 0
    s_cbranch_scc1 PPO_90
    buffer_load_dwordx4 v[152:155], v4, s[36:39], 0 offen offset:0 sc1
    buffer_load_dwordx4 v[156:159], v4, s[36:39], 0 offen offset:1024 sc1
    s_waitcnt vmcnt(2)
    v_cmp_ne_u64 vcc, s[94:95], v[162:163]
    v_cmp_ne_u64 s[84:85], s[94:95], v[166:167]
    s_or_b64 vcc, vcc, s[84:85]
    s_cmp_eq_u64 vcc, 0
    s_cbranch_scc1 PPO_91
    buffer_load_dwordx4 v[160:163], v4, s[36:39], 0 offen offset:0 sc1
    buffer_load_dwordx4 v[164:167], v4, s[36:39], 0 offen offset:1024 sc1
    s_sub_u32 s80, s80, 1
    s_cmp_lg_u32 s80, 0
    s_cbranch_scc1 PP_88
PPO_90:
    v_mov_b32_dpp v136, v152 quad_perm:[0,0,0,0] row_mask:0xf bank_mask:0xf
    v_mov_b32_dpp v137, v153 quad_perm:[0,0,0,0] row_mask:0xf bank_mask:0xf
    v_mov_b32_dpp v138, v156 quad_perm:[0,0,0,0] row_mask:0xf bank_mask:0xf
    v_mov_b32_dpp v139, v157 quad_perm:[0,0,0,0] row_mask:0xf bank_mask:0xf
    v_mov_b32_dpp v140, v152 quad_perm:[1,1,1,1] row_mask:0xf bank_mask:0xf
    v_mov_b32_dpp v141, v153 quad_perm:[1,1,1,1] row_mask:0xf bank_mask:0xf
    v_mov_b32_dpp v142, v156 quad_perm:[1,1,1,1] row_mask:0xf bank_mask:0xf
    v_mov_b32_dpp v143, v157 quad_perm:[1,1,1,1] row_mask:0xf bank_mask:0xf
    v_mov_b32_dpp v144, v152 quad_perm:[2,2,2,2] row_mask:0xf bank_mask:0xf
    v_mov_b32_dpp v145, v153 quad_perm:[2,2,2,2] row_mask:0xf bank_mask:0xf
    v_mov_b32_dpp v146, v156 quad_perm:[2,2,2,2] row_mask:0xf bank_mask:0xf
    v_mov_b32_dpp v147, v157 quad_perm:[2,2,2,2] row_mask:0xf bank_mask:0xf
    v_mov_b32_dpp v148, v152 quad_perm:[3,3,3,3] row_mask:0xf bank_mask:0xf
    v_mov_b32_dpp v149, v153 quad_perm:[3,3,3,3] row_mask:0xf bank_mask:0xf
    v_mov_b32_dpp v150, v156 quad_perm:[3,3,3,3] row_mask:0xf bank_mask:0xf
    v_mov_b32_dpp v151, v157 quad_perm:[3,3,3,3] row_mask:0xf bank_mask:0xf
    s_branch PPD_89
PPO_91:
    v_mov_b32_dpp v136, v160 quad_perm:[0,0,0,0] row_mask:0xf bank_mask:0xf
    v_mov_b32_dpp v137, v161 quad_perm:[0,0,0,0] row_mask:0xf bank_mask:0xf
    v_mov_b32_dpp v138, v164 quad_perm:[0,0,0,0] row_mask:0xf bank_mask:0xf
    v_mov_b32_dpp v139, v165 quad_perm:[0,0,0,0] row_mask:0xf bank_mask:0xf
    v_mov_b32_dpp v140, v160 quad_perm:[1,1,1,1] row_mask:0xf bank_mask:0xf
    v_mov_b32_dpp v141, v161 quad_perm:[1,1,1,1] row_mask:0xf bank_mask:0xf
    v_mov_b32_dpp v142, v164 quad_perm:[1,1,1,1] row_mask:0xf bank_mask:0xf
    v_mov_b32_dpp v143, v165 quad_perm:[1,1,1,1] row_mask:0xf bank_mask:0xf
    v_mov_b32_dpp v144, v160 quad_perm:[2,2,2,2] row_mask:0xf bank_mask:0xf
    v_mov_b32_dpp v145, v161 quad_perm:[2,2,2,2] row_mask:0xf bank_mask:0xf
    v_mov_b32_dpp v146, v164 quad_perm:[2,2,2,2] row_mask:0xf bank_mask:0xf
    v_mov_b32_dpp v147, v165 quad_perm:[2,2,2,2] row_mask:0xf bank_mask:0xf
    v_mov_b32_dpp v148, v160 quad_perm:[3,3,3,3] row_mask:0xf bank_mask:0xf
    v_mov_b32_dpp v149, v161 quad_perm:[3,3,3,3] row_mask:0xf bank_mask:0xf
    v_mov_b32_dpp v150, v164 quad_perm:[3,3,3,3] row_mask:0xf bank_mask:0xf
    v_mov_b32_dpp v151, v165 quad_perm:[3,3,3,3] row_mask:0xf bank_mask:0xf
PPD_89:
S2M_76:
    s_nop 1
    v_mfma_f32_16x16x32_bf16 v[4:7], v[136:139], v[8:11], 0
    v_mfma_f32_16x16x32_bf16 v[4:7], v[140:143], v[40:43], v[4:7]
    v_mfma_f32_16x16x32_bf16 v[4:7], v[144:147], v[72:75], v[4:7]
    v_mfma_f32_16x16x32_bf16 v[4:7], v[148:151], v[104:107], v[4:7]
    v_mfma_f32_16x16x32_bf16 v[8:11], v[136:139], v[12:15], 0
    v_mfma_f32_16x16x32_bf16 v[8:11], v[140:143], v[44:47], v[8:11]
    v_mfma_f32_16x16x32_bf16 v[8:11], v[144:147], v[76:79], v[8:11]
    v_mfma_f32_16x16x32_bf16 v[8:11], v[148:151], v[108:111], v[8:11]
    v_mfma_f32_16x16x32_bf16 v[12:15], v[136:139], v[16:19], 0
    v_mfma_f32_16x16x32_bf16 v[12:15], v[140:143], v[48:51], v[12:15]
    v_mfma_f32_16x16x32_bf16 v[12:15], v[144:147], v[80:83], v[12:15]
    v_mfma_f32_16x16x32_bf16 v[12:15], v[148:151], v[112:115], v[12:15]
    v_mfma_f32_16x16x32_bf16 v[16:19], v[136:139], v[20:23], 0
    v_mfma_f32_16x16x32_bf16 v[16:19], v[140:143], v[52:55], v[16:19]
    v_mfma_f32_16x16x32_bf16 v[16:19], v[144:147], v[84:87], v[16:19]
    v_mfma_f32_16x16x32_bf16 v[16:19], v[148:151], v[116:119], v[16:19]
    v_mfma_f32_16x16x32_bf16 v[20:23], v[136:139], v[24:27], 0
    v_mfma_f32_16x16x32_bf16 v[20:23], v[140:143], v[56:59], v[20:23]
    v_mfma_f32_16x16x32_bf16 v[20:23], v[144:147], v[88:91], v[20:23]
    v_mfma_f32_16x16x32_bf16 v[20:23], v[148:151], v[120:123], v[20:23]
    v_mfma_f32_16x16x32_bf16 v[24:27], v[136:139], v[28:31], 0
    v_mfma_f32_16x16x32_bf16 v[24:27], v[140:143], v[60:63], v[24:27]
    v_mfma_f32_16x16x32_bf16 v[24:27], v[144:147], v[92:95], v[24:27]
    v_mfma_f32_16x16x32_bf16 v[24:27], v[148:151], v[124:127], v[24:27]
    v_mfma_f32_16x16x32_bf16 v[28:31], v[136:139], v[32:35], 0
    v_mfma_f32_16x16x32_bf16 v[28:31], v[140:143], v[64:67], v[28:31]
    v_mfma_f32_16x16x32_bf16 v[28:31], v[144:147], v[96:99], v[28:31]
    v_mfma_f32_16x16x32_bf16 v[28:31], v[148:151], v[128:131], v[28:31]
    v_mfma_f32_16x16x32_bf16 v[32:35], v[136:139], v[36:39], 0
    v_mfma_f32_16x16x32_bf16 v[32:35], v[140:143], v[68:71], v[32:35]
    v_mfma_f32_16x16x32_bf16 v[32:35], v[144:147], v[100:103], v[32:35]
    v_mfma_f32_16x16x32_bf16 v[32:35], v[148:151], v[132:135], v[32:35]
    v_mov_b32 v42, s94
    v_mov_b32 v43, s95
    v_cvt_pk_bf16_f32 v40, v4, v8
    v_cvt_pk_bf16_f32 v41, v12, v16
    buffer_store_dwordx4 v[40:43], v3, s[36:39], 0 offen sc1
    v_mov_b32 v46, s94
    v_mov_b32 v47, s95
    v_cvt_pk_bf16_f32 v44, v20, v24
    v_cvt_pk_bf16_f32 v45, v28, v32
    buffer_store_dwordx4 v[44:47], v3, s[36:39], s70 offen sc1
    s_endpgm
L_C:
    s_cmp_ge_u32 s3, 8
    s_cbranch_scc1 L_CSVC
    s_mov_b32 s44, s20
    s_and_b32 s45, s21, 0xffff
    s_mov_b32 s46, 0x1000000
    s_mov_b32 s47, 0x20000
    s_lshl_b32 s60, s4, 3
    s_add_u32 s60, s60, s5
    s_sub_u32 s60, s60, 8
    s_lshr_b32 s64, s3, 1
    s_and_b32 s65, s3, 1
    s_mov_b32 s67, 0x3e0293ee
    v_lshlrev_b32 v160, 4, v1
    s_and_b32 s7, s3, 3
    s_lshl_b32 s7, s7, 2
    s_lshr_b32 s66, s3, 2
    s_or_b32 s7, s7, s66
    s_lshl_b32 s62, s7, 4
    v_xor_b32 v2, s62, v160
    v_xor_b32 v3, 32, v2
    s_lshl_b32 s70, s60, 18
    s_lshl_b32 s68, s3, 10
    s_add_u32 s61, s70, s68
    s_mov_b32 m0, s68
    s_nop 0
    buffer_load_dwordx4 v2, s[44:47], s61 offen nt lds
    s_add_u32 s68, s68, 8192
    s_add_u32 s61, s61, 8192
    s_mov_b32 m0, s68
    s_nop 0
    buffer_load_dwordx4 v3, s[44:47], s61 offen nt lds
    s_add_u32 s68, s68, 8192
    s_add_u32 s61, s61, 8192
    s_mov_b32 m0, s68
    s_nop 0
    buffer_load_dwordx4 v2, s[44:47], s61 offen nt lds
    s_add_u32 s68, s68, 8192
    s_barrier
    s_add_u32 s61, s61, 8192
    s_mov_b32 m0, s68
    s_nop 0
    buffer_load_dwordx4 v3, s[44:47], s61 offen nt lds
    s_add_u32 s68, s68, 8192
    s_add_u32 s61, s61, 8192
    s_mov_b32 m0, s68
    s_waitcnt vmcnt(3)
    buffer_load_dwordx4 v2, s[44:47], s61 offen nt lds
    s_add_u32 s68, s68, 8192
    s_add_u32 s61, s61, 8192
    s_mov_b32 m0, s68
    s_waitcnt vmcnt(3)
    buffer_load_dwordx4 v3, s[44:47], s61 offen nt lds
    s_add_u32 s68, s68, 8192
    s_add_u32 s61, s61, 8192
    s_mov_b32 m0, s68
    s_waitcnt vmcnt(3)
    buffer_load_dwordx4 v2, s[44:47], s61 offen nt lds
    s_add_u32 s68, s68, 8192
    s_add_u32 s61, s61, 8192
    s_mov_b32 m0, s68
    s_waitcnt vmcnt(3)
    buffer_load_dwordx4 v3, s[44:47], s61 offen nt lds
    s_add_u32 s68, s68, 8192
    s_add_u32 s61, s61, 8192
    s_mov_b32 m0, s68
    s_waitcnt vmcnt(3)
    buffer_load_dwordx4 v2, s[44:47], s61 offen nt lds
    s_add_u32 s68, s68, 8192
    s_add_u32 s61, s61, 8192
    s_mov_b32 m0, s68
    s_waitcnt vmcnt(3)
    buffer_load_dwordx4 v3, s[44:47], s61 offen nt lds
    s_add_u32 s68, s68, 8192
    s_add_u32 s61, s61, 8192
    s_mov_b32 m0, s68
    s_waitcnt vmcnt(3)
    buffer_load_dwordx4 v2, s[44:47], s61 offen nt lds
    s_add_u32 s68, s68, 8192
    s_add_u32 s61, s61, 8192
    s_mov_b32 m0, s68
    s_waitcnt vmcnt(3)
    buffer_load_dwordx4 v3, s[44:47], s61 offen nt lds
    s_add_u32 s68, s68, 8192
    s_add_u32 s61, s61, 8192
    s_waitcnt vmcnt(3)
    buffer_load_dwordx4 v[128:131], v2, s[44:47], s61 offen nt
    s_add_u32 s61, s61, 8192
    s_waitcnt vmcnt(3)
    buffer_load_dwordx4 v[132:135], v3, s[44:47], s61 offen nt
    s_add_u32 s61, s61, 8192
    s_waitcnt vmcnt(3)
    buffer_load_dwordx4 v[136:139], v2, s[44:47], s61 offen nt
    s_add_u32 s61, s61, 8192
    s_waitcnt vmcnt(3)
    buffer_load_dwordx4 v[140:143], v3, s[44:47], s61 offen nt
    s_add_u32 s61, s61, 8192
    s_waitcnt vmcnt(3)
    buffer_load_dwordx4 v[96:99], v2, s[44:47], s61 offen nt
    s_add_u32 s61, s61, 8192
    s_waitcnt vmcnt(3)
    buffer_load_dwordx4 v[100:103], v3, s[44:47], s61 offen nt
    s_add_u32 s61, s61, 8192
    s_waitcnt vmcnt(3)
    buffer_load_dwordx4 v[104:107], v2, s[44:47], s61 offen nt
    s_add_u32 s61, s61, 8192
    s_waitcnt vmcnt(3)
    buffer_load_dwordx4 v[108:111], v3, s[44:47], s61 offen nt
    s_add_u32 s61, s61, 8192
    s_waitcnt vmcnt(3)
    buffer_load_dwordx4 v[112:115], v2, s[44:47], s61 offen nt
    s_add_u32 s61, s61, 8192
    s_waitcnt vmcnt(3)
    buffer_load_dwordx4 v[116:119], v3, s[44:47], s61 offen nt
    s_add_u32 s61, s61, 8192
    v_mov_b32 v160, 0x24018
    v_mov_b32 v161, 1
    s_waitcnt lgkmcnt(0)
    s_mov_b64 exec, 1
    ds_add_u32 v160, v161
    s_mov_b64 exec, -1
    s_waitcnt vmcnt(3)
    buffer_load_dwordx4 v[120:123], v2, s[44:47], s61 offen nt
    s_add_u32 s61, s61, 8192
    s_waitcnt vmcnt(3)
    buffer_load_dwordx4 v[124:127], v3, s[44:47], s61 offen nt
    s_add_u32 s61, s61, 8192
    v_and_b32 v160, 15, v1
    v_lshlrev_b32 v4, 10, v160
    v_lshrrev_b32 v161, 4, v1
    v_lshl_add_u32 v4, v161, 8, v4
    v_lshl_add_u32 v3, v160, 4, v4
    s_lshl_b32 s7, s65, 14
    s_add_u32 s7, s7, 0x18000
    v_add_u32 v3, s7, v3
    v_and_b32 v162, 3, v1
    v_lshl_add_u32 v4, v162, 6, v4
    v_bfe_u32 v162, v1, 2, 2
    v_lshl_add_u32 v4, v162, 4, v4
    s_lshl_b32 s7, s64, 14
    v_add_u32 v4, s7, v4
    v_add_u32 v2, 0x10000, v4
    s_lshl_b32 s7, s65, 6
    s_add_u32 s7, s7, 0x27200
    v_lshl_add_u32 v5, v160, 2, s7
    s_lshl_b32 s7, s64, 10
    s_lshl_b32 s66, s65, 9
    s_add_u32 s7, s7, s66
    s_add_u32 s7, s7, 0x25200
    v_lshl_add_u32 v6, v160, 5, s7
    v_lshl_add_u32 v6, v161, 3, v6
    v_and_b32 v162, 31, v1
    v_lshlrev_b32 v7, 5, v162
    v_lshrrev_b32 v163, 5, v1
    v_lshl_add_u32 v7, v163, 4, v7
    v_add_u32 v7, 0x25200, v7
    v_lshlrev_b32 v8, 2, v162
    v_add_u32 v8, 0x27e00, v8
    v_bfe_u32 v162, v1, 2, 2
    v_lshl_add_u32 v164, v163, 3, v162
    v_lshlrev_b32 v164, 10, v164
    v_and_b32 v165, 1, v1
    v_lshl_add_u32 v164, v165, 3, v164
    s_lshl_b32 s7, s64, 8
    v_add_u32 v164, s7, v164
    v_bfe_u32 v165, v1, 4, 1
    v_lshlrev_b32 v165, 1, v165
    v_bfe_u32 v160, v1, 1, 1
    v_or_b32 v165, v165, v160
    s_lshl_b32 s7, s65, 3
    v_or_b32 v165, s7, v165
    v_lshlrev_b32 v162, 2, v162
    v_xor_b32 v165, v165, v162
    v_lshlrev_b32 v163, 1, v163
    v_xor_b32 v165, v165, v163
    v_xor_b32 v160, 0, v165
    v_lshl_add_u32 v9, v160, 4, v164
    v_xor_b32 v160, 4, v165
    v_lshl_add_u32 v10, v160, 4, v164
    v_xor_b32 v160, 1, v165
    v_lshl_add_u32 v11, v160, 4, v164
    v_add_u32 v11, 0x1000, v11
    v_xor_b32 v160, 5, v165
    v_lshl_add_u32 v12, v160, 4, v164
    v_add_u32 v12, 0x1000, v12
    v_mov_b32 v13, 0xff800000
    v_mov_b32 v14, 0
    v_cmp_gt_u32 s[86:87], 16, v1
    s_cmp_eq_u32 s64, 0
    s_cselect_b32 s88, 0xffff, 0
    s_mov_b32 s89, 0
    s_barrier
    v_xor_b32 v160, 0x0, v3
    ds_read_b128 v[32:35], v160
    v_xor_b32 v161, 0x10, v3
    ds_read_b128 v[36:39], v161
    v_xor_b32 v160, 0x20, v3
    ds_read_b128 v[40:43], v160
    v_xor_b32 v161, 0x30, v3
    ds_read_b128 v[44:47], v161
    v_xor_b32 v160, 0x40, v3
    ds_read_b128 v[48:51], v160
    v_xor_b32 v161, 0x50, v3
    ds_read_b128 v[52:55], v161
    v_xor_b32 v160, 0x60, v3
    ds_read_b128 v[56:59], v160
    v_xor_b32 v161, 0x70, v3
    ds_read_b128 v[60:63], v161
    v_xor_b32 v160, 0x80, v3
    ds_read_b128 v[64:67], v160
    v_xor_b32 v161, 0x90, v3
    ds_read_b128 v[68:71], v161
    v_xor_b32 v160, 0xa0, v3
    ds_read_b128 v[72:75], v160
    v_xor_b32 v161, 0xb0, v3
    ds_read_b128 v[76:79], v161
    v_xor_b32 v160, 0xc0, v3
    ds_read_b128 v[80:83], v160
    v_xor_b32 v161, 0xd0, v3
    ds_read_b128 v[84:87], v161
    v_xor_b32 v160, 0xe0, v3
    ds_read_b128 v[88:91], v160
    v_xor_b32 v161, 0xf0, v3
    ds_read_b128 v[92:95], v161
    s_lshl_b32 s7, s3, 10
    s_add_u32 s7, s7, 0x18000
    v_lshl_add_u32 v3, v1, 4, s7
    s_waitcnt lgkmcnt(0)
    s_barrier
    ds_write_b128 v3, v[128:131] offset:0
    ds_write_b128 v3, v[132:135] offset:8192
    ds_write_b128 v3, v[136:139] offset:16384
    ds_write_b128 v3, v[140:143] offset:24576
    v_xor_b32 v160, 0x0, v4
    ds_read_b128 v[24:27], v160
    v_xor_b32 v161, 0x10, v4
    ds_read_b128 v[28:31], v161
    v_xor_b32 v162, 0x20, v4
    ds_read_b128 v[164:167], v162
    v_xor_b32 v160, 0x30, v4
    ds_read_b128 v[144:147], v160
    v_xor_b32 v161, 0x40, v4
    ds_read_b128 v[148:151], v161
    v_xor_b32 v162, 0x50, v4
    ds_read_b128 v[152:155], v162
    v_xor_b32 v160, 0x60, v4
    ds_read_b128 v[156:159], v160
    s_waitcnt lgkmcnt(6)
    v_mfma_f32_16x16x32_bf16 v[16:19], v[24:27], v[32:35], 0
    v_xor_b32 v161, 0x70, v4
    ds_read_b128 v[24:27], v161
    s_waitcnt lgkmcnt(6)
    v_mfma_f32_16x16x32_bf16 v[16:19], v[28:31], v[36:39], v[16:19]
    v_xor_b32 v162, 0x80, v4
    ds_read_b128 v[28:31], v162
    s_waitcnt lgkmcnt(6)
    v_mfma_f32_16x16x32_bf16 v[16:19], v[164:167], v[40:43], v[16:19]
    v_xor_b32 v160, 0x90, v4
    ds_read_b128 v[164:167], v160
    s_waitcnt lgkmcnt(6)
    v_mfma_f32_16x16x32_bf16 v[16:19], v[144:147], v[44:47], v[16:19]
    v_xor_b32 v161, 0xa0, v4
    ds_read_b128 v[144:147], v161
    s_waitcnt lgkmcnt(6)
    v_mfma_f32_16x16x32_bf16 v[16:19], v[148:151], v[48:51], v[16:19]
    v_xor_b32 v162, 0xb0, v4
    ds_read_b128 v[148:151], v162
    s_waitcnt lgkmcnt(6)
    v_mfma_f32_16x16x32_bf16 v[16:19], v[152:155], v[52:55], v[16:19]
    v_xor_b32 v160, 0xc0, v4
    ds_read_b128 v[152:155], v160
    s_waitcnt lgkmcnt(6)
    v_mfma_f32_16x16x32_bf16 v[16:19], v[156:159], v[56:59], v[16:19]
    v_xor_b32 v161, 0xd0, v4
    ds_read_b128 v[156:159], v161
    s_waitcnt lgkmcnt(6)
    v_mfma_f32_16x16x32_bf16 v[16:19], v[24:27], v[60:63], v[16:19]
    v_xor_b32 v162, 0xe0, v4
    ds_read_b128 v[24:27], v162
    s_waitcnt lgkmcnt(6)
    v_mfma_f32_16x16x32_bf16 v[16:19], v[28:31], v[64:67], v[16:19]
    v_xor_b32 v160, 0xf0, v4
    ds_read_b128 v[28:31], v160
    s_waitcnt lgkmcnt(6)
    v_mfma_f32_16x16x32_bf16 v[16:19], v[164:167], v[68:71], v[16:19]
    s_waitcnt lgkmcnt(5)
    v_mfma_f32_16x16x32_bf16 v[16:19], v[144:147], v[72:75], v[16:19]
    s_waitcnt lgkmcnt(4)
    v_mfma_f32_16x16x32_bf16 v[16:19], v[148:151], v[76:79], v[16:19]
    s_waitcnt lgkmcnt(3)
    v_mfma_f32_16x16x32_bf16 v[16:19], v[152:155], v[80:83], v[16:19]
    s_waitcnt lgkmcnt(2)
    v_mfma_f32_16x16x32_bf16 v[16:19], v[156:159], v[84:87], v[16:19]
    s_waitcnt lgkmcnt(1)
    v_mfma_f32_16x16x32_bf16 v[16:19], v[24:27], v[88:91], v[16:19]
    s_waitcnt lgkmcnt(0)
    v_mfma_f32_16x16x32_bf16 v[16:19], v[28:31], v[92:95], v[16:19]
    s_waitcnt lgkmcnt(0)
    s_barrier
    v_xor_b32 v160, 0x0, v2
    ds_read_b128 v[24:27], v160
    v_xor_b32 v161, 0x10, v2
    ds_read_b128 v[28:31], v161
    v_xor_b32 v162, 0x20, v2
    ds_read_b128 v[164:167], v162
    v_xor_b32 v160, 0x30, v2
    ds_read_b128 v[144:147], v160
    v_xor_b32 v161, 0x40, v2
    ds_read_b128 v[148:151], v161
    v_xor_b32 v162, 0x50, v2
    ds_read_b128 v[152:155], v162
    v_xor_b32 v160, 0x60, v2
    ds_read_b128 v[156:159], v160
    s_waitcnt lgkmcnt(6)
    v_mfma_f32_16x16x32_bf16 v[20:23], v[24:27], v[32:35], 0
    v_xor_b32 v161, 0x70, v2
    ds_read_b128 v[24:27], v161
    s_waitcnt lgkmcnt(6)
    v_mfma_f32_16x16x32_bf16 v[20:23], v[28:31], v[36:39], v[20:23]
    v_xor_b32 v162, 0x80, v2
    ds_read_b128 v[28:31], v162
    s_waitcnt lgkmcnt(6)
    v_mfma_f32_16x16x32_bf16 v[20:23], v[164:167], v[40:43], v[20:23]
    v_xor_b32 v160, 0x90, v2
    ds_read_b128 v[164:167], v160
    s_waitcnt lgkmcnt(6)
    v_mfma_f32_16x16x32_bf16 v[20:23], v[144:147], v[44:47], v[20:23]
    v_xor_b32 v161, 0xa0, v2
    ds_read_b128 v[144:147], v161
    s_waitcnt lgkmcnt(6)
    v_mfma_f32_16x16x32_bf16 v[20:23], v[148:151], v[48:51], v[20:23]
    v_xor_b32 v162, 0xb0, v2
    ds_read_b128 v[148:151], v162
    s_waitcnt lgkmcnt(6)
    v_mfma_f32_16x16x32_bf16 v[20:23], v[152:155], v[52:55], v[20:23]
    v_xor_b32 v160, 0xc0, v2
    ds_read_b128 v[152:155], v160
    s_waitcnt lgkmcnt(6)
    v_mfma_f32_16x16x32_bf16 v[20:23], v[156:159], v[56:59], v[20:23]
    v_xor_b32 v161, 0xd0, v2
    ds_read_b128 v[156:159], v161
    s_waitcnt lgkmcnt(6)
    v_mfma_f32_16x16x32_bf16 v[20:23], v[24:27], v[60:63], v[20:23]
    v_xor_b32 v162, 0xe0, v2
    ds_read_b128 v[24:27], v162
    s_waitcnt lgkmcnt(6)
    v_mfma_f32_16x16x32_bf16 v[20:23], v[28:31], v[64:67], v[20:23]
    v_xor_b32 v160, 0xf0, v2
    ds_read_b128 v[28:31], v160
    s_waitcnt lgkmcnt(6)
    v_mfma_f32_16x16x32_bf16 v[20:23], v[164:167], v[68:71], v[20:23]
    s_waitcnt lgkmcnt(5)
    v_mfma_f32_16x16x32_bf16 v[20:23], v[144:147], v[72:75], v[20:23]
    s_waitcnt lgkmcnt(4)
    v_mfma_f32_16x16x32_bf16 v[20:23], v[148:151], v[76:79], v[20:23]
    s_waitcnt lgkmcnt(3)
    v_mfma_f32_16x16x32_bf16 v[20:23], v[152:155], v[80:83], v[20:23]
    s_waitcnt lgkmcnt(2)
    v_mfma_f32_16x16x32_bf16 v[20:23], v[156:159], v[84:87], v[20:23]
    s_waitcnt lgkmcnt(1)
    v_mfma_f32_16x16x32_bf16 v[20:23], v[24:27], v[88:91], v[20:23]
    s_waitcnt lgkmcnt(0)
    v_mfma_f32_16x16x32_bf16 v[20:23], v[28:31], v[92:95], v[20:23]
    v_max3_f32 v160, v16, v17, v18
    s_nop 6
    v_max3_f32 v160, v160, v19, v20
    v_max3_f32 v160, v160, v21, v22
    v_max_f32 v160, v160, v23
    v_mov_b32 v161, v160
    s_nop 1
    v_permlane32_swap_b32 v160, v161
    v_max_f32 v160, v160, v161
    v_mov_b32 v161, v160
    s_nop 1
    v_permlane16_swap_b32 v160, v161
    v_max_f32 v160, v160, v161
    s_lshl_b32 s7, s64, 7
    v_add_u32 v161, s7, v5
    s_mov_b64 exec, s[86:87]
    ds_write_b32 v161, v160
    s_mov_b64 exec, -1
    s_waitcnt lgkmcnt(0)
    s_barrier
    ds_read_b32 v160, v5 offset:0
    ds_read_b32 v161, v5 offset:128
    ds_read_b32 v162, v5 offset:256
    ds_read_b32 v163, v5 offset:384
    s_waitcnt lgkmcnt(0)
    v_max3_f32 v160, v160, v161, v162
    v_max_f32 v160, v160, v163
    v_mul_f32 v160, s67, v160
    v_max_f32 v160, v160, v13
    v_sub_f32 v161, v13, v160
    v_exp_f32 v161, v161
    v_mov_b32 v13, v160
    v_fma_f32 v16, v16, s67, -v160
    v_fma_f32 v17, v17, s67, -v160
    v_fma_f32 v18, v18, s67, -v160
    v_fma_f32 v19, v19, s67, -v160
    v_fma_f32 v20, v20, s67, -v160
    v_fma_f32 v21, v21, s67, -v160
    v_fma_f32 v22, v22, s67, -v160
    v_fma_f32 v23, v23, s67, -v160
    v_exp_f32 v16, v16
    v_exp_f32 v17, v17
    v_exp_f32 v18, v18
    v_exp_f32 v19, v19
    v_exp_f32 v20, v20
    v_exp_f32 v21, v21
    v_exp_f32 v22, v22
    v_exp_f32 v23, v23
    v_cvt_pk_bf16_f32 v24, v16, v17
    v_cvt_pk_bf16_f32 v25, v18, v19
    v_cvt_pk_bf16_f32 v26, v20, v21
    v_cvt_pk_bf16_f32 v27, v22, v23
    ds_write_b64 v6, v[24:25]
    ds_write_b64 v6, v[26:27] offset:4096
    v_add_u32 v162, 0xc00, v5
    s_mov_b64 exec, s[88:89]
    ds_write_b32 v162, v161
    s_mov_b64 exec, -1
    v_mul_f32 v14, v14, v161
    v_add_f32 v16, v16, v20
    v_add_f32 v17, v17, v21
    v_add_f32 v18, v18, v22
    v_add_f32 v19, v19, v23
    v_add_f32 v16, v16, v18
    v_add_f32 v17, v17, v19
    v_add_f32 v16, v16, v17
    v_add_f32 v14, v14, v16
    v_lshlrev_b32 v3, 4, v1
    v_xor_b32 v3, s62, v3
    v_xor_b32 v15, 32, v3
    s_lshl_b32 s68, s3, 10
    s_waitcnt lgkmcnt(0)
    s_barrier
    ds_read_b128 v[16:19], v7 offset:0
    ds_read_b64_tr_b16 v[24:25], v9 offset:0
    ds_read_b64_tr_b16 v[26:27], v11 offset:0
    ds_read_b64_tr_b16 v[28:29], v10 offset:0
    ds_read_b64_tr_b16 v[30:31], v12 offset:0
    ds_read_b128 v[20:23], v7 offset:1024
    ds_read_b64_tr_b16 v[160:161], v9 offset:16384
    ds_read_b64_tr_b16 v[162:163], v11 offset:16384
    ds_read_b64_tr_b16 v[164:165], v10 offset:16384
    ds_read_b64_tr_b16 v[166:167], v12 offset:16384
    s_waitcnt lgkmcnt(7)
    v_mfma_f32_32x32x16_bf16 v[128:143], v[24:27], v[16:19], 0
    s_waitcnt lgkmcnt(5)
    v_mfma_f32_32x32x16_bf16 v[144:159], v[28:31], v[16:19], 0
    ds_read_b128 v[16:19], v7 offset:2048
    ds_read_b64_tr_b16 v[24:25], v9 offset:32768
    ds_read_b64_tr_b16 v[26:27], v11 offset:32768
    ds_read_b64_tr_b16 v[28:29], v10 offset:32768
    ds_read_b64_tr_b16 v[30:31], v12 offset:32768
    s_waitcnt lgkmcnt(7)
    v_mfma_f32_32x32x16_bf16 v[128:143], v[160:163], v[20:23], v[128:143]
    s_waitcnt lgkmcnt(5)
    v_mfma_f32_32x32x16_bf16 v[144:159], v[164:167], v[20:23], v[144:159]
    ds_read_b128 v[20:23], v7 offset:3072
    ds_read_b64_tr_b16 v[160:161], v9 offset:49152
    ds_read_b64_tr_b16 v[162:163], v11 offset:49152
    ds_read_b64_tr_b16 v[164:165], v10 offset:49152
    ds_read_b64_tr_b16 v[166:167], v12 offset:49152
    s_waitcnt lgkmcnt(7)
    v_mfma_f32_32x32x16_bf16 v[128:143], v[24:27], v[16:19], v[128:143]
    s_waitcnt lgkmcnt(5)
    v_mfma_f32_32x32x16_bf16 v[144:159], v[28:31], v[16:19], v[144:159]
    v_add_u32 v9, 0x10000, v9
    v_add_u32 v10, 0x10000, v10
    v_add_u32 v11, 0x10000, v11
    v_add_u32 v12, 0x10000, v12
    ds_read_b128 v[16:19], v7 offset:4096
    ds_read_b64_tr_b16 v[24:25], v9 offset:0
    ds_read_b64_tr_b16 v[26:27], v11 offset:0
    ds_read_b64_tr_b16 v[28:29], v10 offset:0
    ds_read_b64_tr_b16 v[30:31], v12 offset:0
    s_waitcnt lgkmcnt(7)
    v_mfma_f32_32x32x16_bf16 v[128:143], v[160:163], v[20:23], v[128:143]
    s_waitcnt lgkmcnt(5)
    v_mfma_f32_32x32x16_bf16 v[144:159], v[164:167], v[20:23], v[144:159]
    s_barrier
    s_mov_b32 m0, s68
    s_add_u32 s68, s68, 8192
    buffer_load_dwordx4 v3, s[44:47], s61 offen nt lds
    s_add_u32 s61, s61, 8192
    s_mov_b32 m0, s68
    s_add_u32 s68, s68, 8192
    buffer_load_dwordx4 v15, s[44:47], s61 offen nt lds
    s_add_u32 s61, s61, 8192
    s_mov_b32 m0, s68
    s_add_u32 s68, s68, 8192
    buffer_load_dwordx4 v3, s[44:47], s61 offen nt lds
    s_add_u32 s61, s61, 8192
    s_mov_b32 m0, s68
    s_add_u32 s68, s68, 8192
    buffer_load_dwordx4 v15, s[44:47], s61 offen nt lds
    s_add_u32 s61, s61, 8192
    ds_read_b128 v[20:23], v7 offset:5120
    ds_read_b64_tr_b16 v[160:161], v9 offset:16384
    ds_read_b64_tr_b16 v[162:163], v11 offset:16384
    ds_read_b64_tr_b16 v[164:165], v10 offset:16384
    ds_read_b64_tr_b16 v[166:167], v12 offset:16384
    s_waitcnt lgkmcnt(7)
    v_mfma_f32_32x32x16_bf16 v[128:143], v[24:27], v[16:19], v[128:143]
    s_waitcnt lgkmcnt(5)
    v_mfma_f32_32x32x16_bf16 v[144:159], v[28:31], v[16:19], v[144:159]
    s_mov_b32 m0, s68
    s_add_u32 s68, s68, 8192
    buffer_load_dwordx4 v3, s[44:47], s61 offen nt lds
    s_add_u32 s61, s61, 8192
    s_mov_b32 m0, s68
    s_add_u32 s68, s68, 8192
    buffer_load_dwordx4 v15, s[44:47], s61 offen nt lds
    s_add_u32 s61, s61, 8192
    s_mov_b32 m0, s68
    s_add_u32 s68, s68, 8192
    buffer_load_dwordx4 v3, s[44:47], s61 offen nt lds
    s_add_u32 s61, s61, 8192
    s_mov_b32 m0, s68
    s_add_u32 s68, s68, 8192
    buffer_load_dwordx4 v15, s[44:47], s61 offen nt lds
    s_add_u32 s61, s61, 8192
    ds_read_b128 v[16:19], v7 offset:6144
    ds_read_b64_tr_b16 v[24:25], v9 offset:32768
    ds_read_b64_tr_b16 v[26:27], v11 offset:32768
    ds_read_b64_tr_b16 v[28:29], v10 offset:32768
    ds_read_b64_tr_b16 v[30:31], v12 offset:32768
    s_waitcnt lgkmcnt(7)
    v_mfma_f32_32x32x16_bf16 v[128:143], v[160:163], v[20:23], v[128:143]
    s_waitcnt lgkmcnt(5)
    v_mfma_f32_32x32x16_bf16 v[144:159], v[164:167], v[20:23], v[144:159]
    ds_read_b128 v[20:23], v7 offset:7168
    ds_read_b64_tr_b16 v[160:161], v9 offset:49152
    ds_read_b64_tr_b16 v[162:163], v11 offset:49152
    ds_read_b64_tr_b16 v[164:165], v10 offset:49152
    ds_read_b64_tr_b16 v[166:167], v12 offset:49152
    s_waitcnt lgkmcnt(7)
    v_mfma_f32_32x32x16_bf16 v[128:143], v[24:27], v[16:19], v[128:143]
    s_waitcnt lgkmcnt(5)
    v_mfma_f32_32x32x16_bf16 v[144:159], v[28:31], v[16:19], v[144:159]
    s_waitcnt lgkmcnt(2)
    v_mfma_f32_32x32x16_bf16 v[128:143], v[160:163], v[20:23], v[128:143]
    s_waitcnt lgkmcnt(0)
    v_mfma_f32_32x32x16_bf16 v[144:159], v[164:167], v[20:23], v[144:159]
    v_add_u32 v9, 0xffff0000, v9
    v_add_u32 v10, 0xffff0000, v10
    v_add_u32 v11, 0xffff0000, v11
    v_add_u32 v12, 0xffff0000, v12
    s_lshl_b32 s7, s3, 10
    s_add_u32 s7, s7, 0x10000
    v_lshl_add_u32 v3, v1, 4, s7
    s_waitcnt vmcnt(8)
    s_barrier
    ds_write_b128 v3, v[96:99] offset:0
    ds_write_b128 v3, v[100:103] offset:8192
    ds_write_b128 v3, v[104:107] offset:16384
    ds_write_b128 v3, v[108:111] offset:24576
    ds_write_b128 v3, v[112:115] offset:32768
    ds_write_b128 v3, v[116:119] offset:40960
    ds_write_b128 v3, v[120:123] offset:49152
    ds_write_b128 v3, v[124:127] offset:57344
    s_waitcnt lgkmcnt(0)
    s_barrier
    v_xor_b32 v160, 0x0, v2
    ds_read_b128 v[24:27], v160
    v_xor_b32 v161, 0x10, v2
    ds_read_b128 v[28:31], v161
    v_xor_b32 v162, 0x20, v2
    ds_read_b128 v[164:167], v162
    v_xor_b32 v160, 0x30, v2
    ds_read_b128 v[96:99], v160
    v_xor_b32 v161, 0x40, v2
    ds_read_b128 v[100:103], v161
    v_xor_b32 v162, 0x50, v2
    ds_read_b128 v[104:107], v162
    v_xor_b32 v160, 0x60, v2
    ds_read_b128 v[108:111], v160
    s_waitcnt lgkmcnt(6)
    v_mfma_f32_16x16x32_bf16 v[20:23], v[24:27], v[32:35], 0
    v_xor_b32 v161, 0x70, v2
    ds_read_b128 v[24:27], v161
    s_waitcnt lgkmcnt(6)
    v_mfma_f32_16x16x32_bf16 v[20:23], v[28:31], v[36:39], v[20:23]
    v_xor_b32 v162, 0x80, v2
    ds_read_b128 v[28:31], v162
    s_waitcnt lgkmcnt(6)
    v_mfma_f32_16x16x32_bf16 v[20:23], v[164:167], v[40:43], v[20:23]
    v_xor_b32 v160, 0x90, v2
    ds_read_b128 v[164:167], v160
    s_waitcnt lgkmcnt(6)
    v_mfma_f32_16x16x32_bf16 v[20:23], v[96:99], v[44:47], v[20:23]
    v_xor_b32 v161, 0xa0, v2
    ds_read_b128 v[96:99], v161
    s_waitcnt lgkmcnt(6)
    v_mfma_f32_16x16x32_bf16 v[20:23], v[100:103], v[48:51], v[20:23]
    v_xor_b32 v162, 0xb0, v2
    ds_read_b128 v[100:103], v162
    s_waitcnt lgkmcnt(6)
    v_mfma_f32_16x16x32_bf16 v[20:23], v[104:107], v[52:55], v[20:23]
    v_xor_b32 v160, 0xc0, v2
    ds_read_b128 v[104:107], v160
    s_waitcnt lgkmcnt(6)
    v_mfma_f32_16x16x32_bf16 v[20:23], v[108:111], v[56:59], v[20:23]
    v_xor_b32 v161, 0xd0, v2
    ds_read_b128 v[108:111], v161
    s_waitcnt lgkmcnt(6)
    v_mfma_f32_16x16x32_bf16 v[20:23], v[24:27], v[60:63], v[20:23]
    v_xor_b32 v162, 0xe0, v2
    ds_read_b128 v[24:27], v162
    s_waitcnt lgkmcnt(6)
    v_mfma_f32_16x16x32_bf16 v[20:23], v[28:31], v[64:67], v[20:23]
    v_xor_b32 v160, 0xf0, v2
    ds_read_b128 v[28:31], v160
    s_waitcnt lgkmcnt(6)
    v_mfma_f32_16x16x32_bf16 v[20:23], v[164:167], v[68:71], v[20:23]
    s_waitcnt lgkmcnt(5)
    v_mfma_f32_16x16x32_bf16 v[20:23], v[96:99], v[72:75], v[20:23]
    s_waitcnt lgkmcnt(4)
    v_mfma_f32_16x16x32_bf16 v[20:23], v[100:103], v[76:79], v[20:23]
    s_waitcnt lgkmcnt(3)
    v_mfma_f32_16x16x32_bf16 v[20:23], v[104:107], v[80:83], v[20:23]
    s_waitcnt lgkmcnt(2)
    v_mfma_f32_16x16x32_bf16 v[20:23], v[108:111], v[84:87], v[20:23]
    s_waitcnt lgkmcnt(1)
    v_mfma_f32_16x16x32_bf16 v[20:23], v[24:27], v[88:91], v[20:23]
    s_waitcnt lgkmcnt(0)
    v_mfma_f32_16x16x32_bf16 v[20:23], v[28:31], v[92:95], v[20:23]
    s_waitcnt vmcnt(0)
    s_barrier
    v_xor_b32 v160, 0x0, v4
    ds_read_b128 v[24:27], v160
    v_xor_b32 v161, 0x10, v4
    ds_read_b128 v[28:31], v161
    v_xor_b32 v162, 0x20, v4
    ds_read_b128 v[164:167], v162
    v_xor_b32 v160, 0x30, v4
    ds_read_b128 v[96:99], v160
    v_xor_b32 v161, 0x40, v4
    ds_read_b128 v[100:103], v161
    v_xor_b32 v162, 0x50, v4
    ds_read_b128 v[104:107], v162
    v_xor_b32 v160, 0x60, v4
    ds_read_b128 v[108:111], v160
    s_waitcnt lgkmcnt(6)
    v_mfma_f32_16x16x32_bf16 v[16:19], v[24:27], v[32:35], 0
    v_xor_b32 v161, 0x70, v4
    ds_read_b128 v[24:27], v161
    s_waitcnt lgkmcnt(6)
    v_mfma_f32_16x16x32_bf16 v[16:19], v[28:31], v[36:39], v[16:19]
    v_xor_b32 v162, 0x80, v4
    ds_read_b128 v[28:31], v162
    s_waitcnt lgkmcnt(6)
    v_mfma_f32_16x16x32_bf16 v[16:19], v[164:167], v[40:43], v[16:19]
    v_xor_b32 v160, 0x90, v4
    ds_read_b128 v[164:167], v160
    s_waitcnt lgkmcnt(6)
    v_mfma_f32_16x16x32_bf16 v[16:19], v[96:99], v[44:47], v[16:19]
    v_xor_b32 v161, 0xa0, v4
    ds_read_b128 v[96:99], v161
    s_waitcnt lgkmcnt(6)
    v_mfma_f32_16x16x32_bf16 v[16:19], v[100:103], v[48:51], v[16:19]
    v_xor_b32 v162, 0xb0, v4
    ds_read_b128 v[100:103], v162
    s_waitcnt lgkmcnt(6)
    v_mfma_f32_16x16x32_bf16 v[16:19], v[104:107], v[52:55], v[16:19]
    v_xor_b32 v160, 0xc0, v4
    ds_read_b128 v[104:107], v160
    s_waitcnt lgkmcnt(6)
    v_mfma_f32_16x16x32_bf16 v[16:19], v[108:111], v[56:59], v[16:19]
    v_xor_b32 v161, 0xd0, v4
    ds_read_b128 v[108:111], v161
    s_waitcnt lgkmcnt(6)
    v_mfma_f32_16x16x32_bf16 v[16:19], v[24:27], v[60:63], v[16:19]
    v_xor_b32 v162, 0xe0, v4
    ds_read_b128 v[24:27], v162
    s_waitcnt lgkmcnt(6)
    v_mfma_f32_16x16x32_bf16 v[16:19], v[28:31], v[64:67], v[16:19]
    v_xor_b32 v160, 0xf0, v4
    ds_read_b128 v[28:31], v160
    s_waitcnt lgkmcnt(6)
    v_mfma_f32_16x16x32_bf16 v[16:19], v[164:167], v[68:71], v[16:19]
    s_waitcnt lgkmcnt(5)
    v_mfma_f32_16x16x32_bf16 v[16:19], v[96:99], v[72:75], v[16:19]
    s_waitcnt lgkmcnt(4)
    v_mfma_f32_16x16x32_bf16 v[16:19], v[100:103], v[76:79], v[16:19]
    s_waitcnt lgkmcnt(3)
    v_mfma_f32_16x16x32_bf16 v[16:19], v[104:107], v[80:83], v[16:19]
    s_waitcnt lgkmcnt(2)
    v_mfma_f32_16x16x32_bf16 v[16:19], v[108:111], v[84:87], v[16:19]
    s_waitcnt lgkmcnt(1)
    v_mfma_f32_16x16x32_bf16 v[16:19], v[24:27], v[88:91], v[16:19]
    s_waitcnt lgkmcnt(0)
    v_mfma_f32_16x16x32_bf16 v[16:19], v[28:31], v[92:95], v[16:19]
    s_nop 7
    v_max3_f32 v160, v16, v17, v18
    v_max3_f32 v160, v160, v19, v20
    v_max3_f32 v160, v160, v21, v22
    v_max_f32 v160, v160, v23
    v_mov_b32 v161, v160
    s_nop 1
    v_permlane32_swap_b32 v160, v161
    v_max_f32 v160, v160, v161
    v_mov_b32 v161, v160
    s_nop 1
    v_permlane16_swap_b32 v160, v161
    v_max_f32 v160, v160, v161
    s_lshl_b32 s7, s64, 7
    v_add_u32 v161, s7, v5
    s_mov_b64 exec, s[86:87]
    ds_write_b32 v161, v160
    s_mov_b64 exec, -1
    s_waitcnt lgkmcnt(0)
    s_barrier
    ds_read_b32 v160, v5 offset:0
    ds_read_b32 v161, v5 offset:128
    ds_read_b32 v162, v5 offset:256
    ds_read_b32 v163, v5 offset:384
    s_waitcnt lgkmcnt(0)
    v_max3_f32 v160, v160, v161, v162
    v_max_f32 v160, v160, v163
    v_mul_f32 v160, s67, v160
    v_max_f32 v160, v160, v13
    v_sub_f32 v161, v13, v160
    v_exp_f32 v161, v161
    v_mov_b32 v13, v160
    v_fma_f32 v16, v16, s67, -v160
    v_fma_f32 v17, v17, s67, -v160
    v_fma_f32 v18, v18, s67, -v160
    v_fma_f32 v19, v19, s67, -v160
    v_fma_f32 v20, v20, s67, -v160
    v_fma_f32 v21, v21, s67, -v160
    v_fma_f32 v22, v22, s67, -v160
    v_fma_f32 v23, v23, s67, -v160
    v_exp_f32 v16, v16
    v_exp_f32 v17, v17
    v_exp_f32 v18, v18
    v_exp_f32 v19, v19
    v_exp_f32 v20, v20
    v_exp_f32 v21, v21
    v_exp_f32 v22, v22
    v_exp_f32 v23, v23
    v_cvt_pk_bf16_f32 v24, v16, v17
    v_cvt_pk_bf16_f32 v25, v18, v19
    v_cvt_pk_bf16_f32 v26, v20, v21
    v_cvt_pk_bf16_f32 v27, v22, v23
    ds_write_b64 v6, v[24:25]
    ds_write_b64 v6, v[26:27] offset:4096
    v_add_u32 v162, 0xc00, v5
    s_mov_b64 exec, s[88:89]
    ds_write_b32 v162, v161
    s_mov_b64 exec, -1
    v_mul_f32 v14, v14, v161
    v_add_f32 v16, v16, v20
    v_add_f32 v17, v17, v21
    v_add_f32 v18, v18, v22
    v_add_f32 v19, v19, v23
    v_add_f32 v16, v16, v18
    v_add_f32 v17, v17, v19
    v_add_f32 v16, v16, v17
    v_add_f32 v14, v14, v16
    v_mov_b32 v160, v14
    s_nop 1
    v_permlane32_swap_b32 v14, v160
    v_add_f32 v14, v14, v160
    v_mov_b32 v160, v14
    s_nop 1
    v_permlane16_swap_b32 v14, v160
    v_add_f32 v14, v14, v160
    s_lshl_b32 s7, s64, 7
    s_add_u32 s7, s7, 0x200
    v_add_u32 v161, s7, v5
    v_add_u32 v162, 0xc80, v5
    s_mov_b64 exec, s[86:87]
    ds_write_b32 v161, v14
    s_mov_b64 exec, s[88:89]
    ds_write_b32 v162, v13
    s_mov_b64 exec, -1
    v_and_b32 v160, 31, v1
    v_lshlrev_b32 v98, 7, v160
    v_lshrrev_b32 v161, 5, v1
    v_and_b32 v160, 7, v1
    v_xor_b32 v161, v160, v161
    v_lshl_add_u32 v98, v161, 4, v98
    s_lshl_b32 s7, s3, 12
    v_add_u32 v98, s7, v98
    v_lshl_add_u32 v99, v1, 4, s7
    v_lshrrev_b32 v161, 3, v1
    v_xor_b32 v160, v160, v161
    v_lshlrev_b32 v100, 7, v161
    v_lshl_add_u32 v100, v160, 4, v100
    s_lshl_b32 s69, s60, 15
    s_add_u32 s69, s69, s7
    s_add_u32 s69, s69, 0x500000
    s_waitcnt lgkmcnt(0)
    s_barrier
    ds_read_b32 v15, v8
    ds_read_b128 v[16:19], v7 offset:0
    ds_read_b64_tr_b16 v[24:25], v9 offset:0
    ds_read_b64_tr_b16 v[26:27], v11 offset:0
    ds_read_b64_tr_b16 v[28:29], v10 offset:0
    ds_read_b64_tr_b16 v[30:31], v12 offset:0
    s_waitcnt lgkmcnt(5)
    v_mul_f32 v128, v15, v128
    v_mul_f32 v129, v15, v129
    v_mul_f32 v130, v15, v130
    v_mul_f32 v131, v15, v131
    v_mul_f32 v132, v15, v132
    v_mul_f32 v133, v15, v133
    v_mul_f32 v134, v15, v134
    v_mul_f32 v135, v15, v135
    v_mul_f32 v136, v15, v136
    v_mul_f32 v137, v15, v137
    v_mul_f32 v138, v15, v138
    v_mul_f32 v139, v15, v139
    v_mul_f32 v140, v15, v140
    v_mul_f32 v141, v15, v141
    v_mul_f32 v142, v15, v142
    v_mul_f32 v143, v15, v143
    v_mul_f32 v144, v15, v144
    v_mul_f32 v145, v15, v145
    v_mul_f32 v146, v15, v146
    v_mul_f32 v147, v15, v147
    v_mul_f32 v148, v15, v148
    v_mul_f32 v149, v15, v149
    v_mul_f32 v150, v15, v150
    v_mul_f32 v151, v15, v151
    v_mul_f32 v152, v15, v152
    v_mul_f32 v153, v15, v153
    v_mul_f32 v154, v15, v154
    v_mul_f32 v155, v15, v155
    v_mul_f32 v156, v15, v156
    v_mul_f32 v157, v15, v157
    v_mul_f32 v158, v15, v158
    v_mul_f32 v159, v15, v159
    ds_read_b128 v[20:23], v7 offset:1024
    ds_read_b64_tr_b16 v[160:161], v9 offset:16384
    ds_read_b64_tr_b16 v[162:163], v11 offset:16384
    ds_read_b64_tr_b16 v[164:165], v10 offset:16384
    ds_read_b64_tr_b16 v[166:167], v12 offset:16384
    s_waitcnt lgkmcnt(7)
    v_mfma_f32_32x32x16_bf16 v[128:143], v[24:27], v[16:19], v[128:143]
    s_waitcnt lgkmcnt(5)
    v_mfma_f32_32x32x16_bf16 v[144:159], v[28:31], v[16:19], v[144:159]
    ds_read_b128 v[16:19], v7 offset:2048
    ds_read_b64_tr_b16 v[24:25], v9 offset:32768
    ds_read_b64_tr_b16 v[26:27], v11 offset:32768
    ds_read_b64_tr_b16 v[28:29], v10 offset:32768
    ds_read_b64_tr_b16 v[30:31], v12 offset:32768
    s_waitcnt lgkmcnt(7)
    v_mfma_f32_32x32x16_bf16 v[128:143], v[160:163], v[20:23], v[128:143]
    s_waitcnt lgkmcnt(5)
    v_mfma_f32_32x32x16_bf16 v[144:159], v[164:167], v[20:23], v[144:159]
    ds_read_b128 v[20:23], v7 offset:3072
    ds_read_b64_tr_b16 v[160:161], v9 offset:49152
    ds_read_b64_tr_b16 v[162:163], v11 offset:49152
    ds_read_b64_tr_b16 v[164:165], v10 offset:49152
    ds_read_b64_tr_b16 v[166:167], v12 offset:49152
    s_waitcnt lgkmcnt(7)
    v_mfma_f32_32x32x16_bf16 v[128:143], v[24:27], v[16:19], v[128:143]
    s_waitcnt lgkmcnt(5)
    v_mfma_f32_32x32x16_bf16 v[144:159], v[28:31], v[16:19], v[144:159]
    v_add_u32 v9, 0x10000, v9
    v_add_u32 v10, 0x10000, v10
    v_add_u32 v11, 0x10000, v11
    v_add_u32 v12, 0x10000, v12
    ds_read_b128 v[16:19], v7 offset:4096
    ds_read_b64_tr_b16 v[24:25], v9 offset:0
    ds_read_b64_tr_b16 v[26:27], v11 offset:0
    ds_read_b64_tr_b16 v[28:29], v10 offset:0
    ds_read_b64_tr_b16 v[30:31], v12 offset:0
    s_waitcnt lgkmcnt(7)
    v_mfma_f32_32x32x16_bf16 v[128:143], v[160:163], v[20:23], v[128:143]
    s_waitcnt lgkmcnt(5)
    v_mfma_f32_32x32x16_bf16 v[144:159], v[164:167], v[20:23], v[144:159]
    s_barrier
    ds_read_b128 v[20:23], v7 offset:5120
    ds_read_b64_tr_b16 v[160:161], v9 offset:16384
    ds_read_b64_tr_b16 v[162:163], v11 offset:16384
    ds_read_b64_tr_b16 v[164:165], v10 offset:16384
    ds_read_b64_tr_b16 v[166:167], v12 offset:16384
    s_waitcnt lgkmcnt(7)
    v_mfma_f32_32x32x16_bf16 v[128:143], v[24:27], v[16:19], v[128:143]
    s_waitcnt lgkmcnt(5)
    v_mfma_f32_32x32x16_bf16 v[144:159], v[28:31], v[16:19], v[144:159]
    ds_read_b128 v[16:19], v7 offset:6144
    ds_read_b64_tr_b16 v[24:25], v9 offset:32768
    ds_read_b64_tr_b16 v[26:27], v11 offset:32768
    ds_read_b64_tr_b16 v[28:29], v10 offset:32768
    ds_read_b64_tr_b16 v[30:31], v12 offset:32768
    s_waitcnt lgkmcnt(7)
    v_mfma_f32_32x32x16_bf16 v[128:143], v[160:163], v[20:23], v[128:143]
    s_waitcnt lgkmcnt(5)
    v_mfma_f32_32x32x16_bf16 v[144:159], v[164:167], v[20:23], v[144:159]
    ds_read_b128 v[20:23], v7 offset:7168
    ds_read_b64_tr_b16 v[160:161], v9 offset:49152
    ds_read_b64_tr_b16 v[162:163], v11 offset:49152
    ds_read_b64_tr_b16 v[164:165], v10 offset:49152
    ds_read_b64_tr_b16 v[166:167], v12 offset:49152
    s_waitcnt lgkmcnt(7)
    v_mfma_f32_32x32x16_bf16 v[128:143], v[24:27], v[16:19], v[128:143]
    s_waitcnt lgkmcnt(5)
    v_mfma_f32_32x32x16_bf16 v[144:159], v[28:31], v[16:19], v[144:159]
    s_waitcnt lgkmcnt(2)
    v_mfma_f32_32x32x16_bf16 v[128:143], v[160:163], v[20:23], v[128:143]
    s_waitcnt lgkmcnt(0)
    v_mfma_f32_32x32x16_bf16 v[144:159], v[164:167], v[20:23], v[144:159]
    s_nop 9
    v_permlane32_swap_b32 v128, v132
    v_permlane32_swap_b32 v129, v133
    v_permlane32_swap_b32 v130, v134
    v_permlane32_swap_b32 v131, v135
    v_cvt_pk_bf16_f32 v16, v128, v129
    v_cvt_pk_bf16_f32 v17, v130, v131
    v_cvt_pk_bf16_f32 v18, v132, v133
    v_cvt_pk_bf16_f32 v19, v134, v135
    v_xor_b32 v160, 0x0, v98
    ds_write_b128 v160, v[16:19]
    v_permlane32_swap_b32 v136, v140
    v_permlane32_swap_b32 v137, v141
    v_permlane32_swap_b32 v138, v142
    v_permlane32_swap_b32 v139, v143
    v_cvt_pk_bf16_f32 v20, v136, v137
    v_cvt_pk_bf16_f32 v21, v138, v139
    v_cvt_pk_bf16_f32 v22, v140, v141
    v_cvt_pk_bf16_f32 v23, v142, v143
    v_xor_b32 v161, 0x20, v98
    ds_write_b128 v161, v[20:23]
    v_permlane32_swap_b32 v144, v148
    v_permlane32_swap_b32 v145, v149
    v_permlane32_swap_b32 v146, v150
    v_permlane32_swap_b32 v147, v151
    v_cvt_pk_bf16_f32 v24, v144, v145
    v_cvt_pk_bf16_f32 v25, v146, v147
    v_cvt_pk_bf16_f32 v26, v148, v149
    v_cvt_pk_bf16_f32 v27, v150, v151
    v_xor_b32 v160, 0x40, v98
    ds_write_b128 v160, v[24:27]
    v_permlane32_swap_b32 v152, v156
    v_permlane32_swap_b32 v153, v157
    v_permlane32_swap_b32 v154, v158
    v_permlane32_swap_b32 v155, v159
    v_cvt_pk_bf16_f32 v28, v152, v153
    v_cvt_pk_bf16_f32 v29, v154, v155
    v_cvt_pk_bf16_f32 v30, v156, v157
    v_cvt_pk_bf16_f32 v31, v158, v159
    v_xor_b32 v161, 0x60, v98
    ds_write_b128 v161, v[28:31]
    ds_read_b128 v[32:35], v99 offset:0
    ds_read_b128 v[36:39], v99 offset:1024
    ds_read_b128 v[40:43], v99 offset:2048
    ds_read_b128 v[44:47], v99 offset:3072
    s_waitcnt lgkmcnt(3)
    buffer_store_dwordx4 v[32:35], v100, s[36:39], s69 offen offset:0 sc1
    s_waitcnt lgkmcnt(2)
    buffer_store_dwordx4 v[36:39], v100, s[36:39], s69 offen offset:1024 sc1
    s_waitcnt lgkmcnt(1)
    buffer_store_dwordx4 v[40:43], v100, s[36:39], s69 offen offset:2048 sc1
    s_waitcnt lgkmcnt(0)
    buffer_store_dwordx4 v[44:47], v100, s[36:39], s69 offen offset:3072 sc1
    s_cmp_eq_u32 s3, 0
    s_cbranch_scc1 C0_92
    s_waitcnt vmcnt(0)
    s_barrier
    s_branch L_END
C0_92:
    v_mov_b32 v160, 0x2404c
    s_mov_b32 s80, 1600000
LW_93:
    ds_read_b32 v161, v160
    s_waitcnt lgkmcnt(0)
    v_readfirstlane_b32 s79, v161
    s_cmp_ge_u32 s79, 1
    s_cbranch_scc1 LWD_94
    s_sleep 2
    s_sub_u32 s80, s80, 1
    s_cmp_lg_u32 s80, 0
    s_cbranch_scc1 LW_93
LWD_94:
    v_mov_b32 v160, 0x24050
    ds_read_b64 v[162:163], v160
    s_waitcnt lgkmcnt(0)
    v_readfirstlane_b32 s94, v162
    v_readfirstlane_b32 s95, v163
    v_and_b32 v160, 31, v1
    v_lshlrev_b32 v3, 2, v160
    v_add_u32 v3, 0x27400, v3
    s_lshl_b32 s7, s60, 9
    s_add_u32 s7, s7, 0xe0000
    v_lshl_add_u32 v4, v160, 4, s7
    v_mov_b32 v22, s94
    v_mov_b32 v23, s95
    ds_read_b32 v16, v3 offset:0
    ds_read_b32 v17, v3 offset:128
    ds_read_b32 v18, v3 offset:256
    ds_read_b32 v19, v3 offset:384
    ds_read_b32 v20, v3 offset:2688
    s_waitcnt lgkmcnt(0)
    v_add_f32 v16, v16, v17
    v_add_f32 v18, v18, v19
    v_add_f32 v21, v16, v18
    s_waitcnt vmcnt(0)
    s_barrier
    s_mov_b64 exec, 0xffffffff
    buffer_store_dwordx4 v[20:23], v4, s[36:39], 0 offen sc1
    s_mov_b64 exec, -1
    s_mov_b32 s52, s30
    s_and_b32 s53, s31, 0xffff
    s_mov_b32 s54, 0x2000
    s_mov_b32 s55, 0x20000
    v_lshlrev_b32 v2, 4, v1
    s_lshl_b32 s7, s60, 13
    s_add_u32 s7, s7, 0x100000
    v_add_u32 v4, s7, v2
    s_bfe_u32 s7, s60, 0x20003
    s_lshl_b32 s7, s7, 11
    s_lshr_b32 s66, s60, 5
    s_lshl_b32 s66, s66, 10
    s_add_u32 s7, s7, s66
    s_and_b32 s66, s60, 7
    s_lshl_b32 s66, s66, 7
    s_add_u32 s7, s7, s66
    v_add_u32 v5, s7, v2
    s_mov_b32 s66, 4096
    s_mov_b32 s80, 200000
PO_95:
    buffer_load_dwordx4 v[32:35], v4, s[36:39], 0 offen offset:0 sc1
PO2_96:
    s_waitcnt vmcnt(0)
    v_cmp_ne_u64 vcc, s[94:95], v[34:35]
    s_cmp_lg_u64 vcc, -1
    s_cbranch_scc1 POD_97
    s_sleep 20
    s_sub_u32 s80, s80, 1
    s_cmp_lg_u32 s80, 0
    s_cbranch_scc1 PO_95
POD_97:
    buffer_load_dwordx4 v[32:35], v4, s[36:39], 0 offen offset:0 sc1
    buffer_load_dwordx4 v[36:39], v4, s[36:39], 0 offen offset:1024 sc1
    buffer_load_dwordx4 v[40:43], v4, s[36:39], 0 offen offset:2048 sc1
    buffer_load_dwordx4 v[44:47], v4, s[36:39], 0 offen offset:3072 sc1
    buffer_load_dwordx4 v[48:51], v4, s[36:39], s66 offen offset:0 sc1
    buffer_load_dwordx4 v[52:55], v4, s[36:39], s66 offen offset:1024 sc1
    buffer_load_dwordx4 v[56:59], v4, s[36:39], s66 offen offset:2048 sc1
    buffer_load_dwordx4 v[60:63], v4, s[36:39], s66 offen offset:3072 sc1
    s_sleep 4
    buffer_load_dwordx4 v[96:99], v4, s[36:39], 0 offen offset:0 sc1
    buffer_load_dwordx4 v[100:103], v4, s[36:39], 0 offen offset:1024 sc1
    buffer_load_dwordx4 v[104:107], v4, s[36:39], 0 offen offset:2048 sc1
    buffer_load_dwordx4 v[108:111], v4, s[36:39], 0 offen offset:3072 sc1
    buffer_load_dwordx4 v[112:115], v4, s[36:39], s66 offen offset:0 sc1
    buffer_load_dwordx4 v[116:119], v4, s[36:39], s66 offen offset:1024 sc1
    buffer_load_dwordx4 v[120:123], v4, s[36:39], s66 offen offset:2048 sc1
    buffer_load_dwordx4 v[124:127], v4, s[36:39], s66 offen offset:3072 sc1
    s_sleep 4
    buffer_load_dwordx4 v[128:131], v4, s[36:39], 0 offen offset:0 sc1
    buffer_load_dwordx4 v[132:135], v4, s[36:39], 0 offen offset:1024 sc1
    buffer_load_dwordx4 v[136:139], v4, s[36:39], 0 offen offset:2048 sc1
    buffer_load_dwordx4 v[140:143], v4, s[36:39], 0 offen offset:3072 sc1
    buffer_load_dwordx4 v[144:147], v4, s[36:39], s66 offen offset:0 sc1
    buffer_load_dwordx4 v[148:151], v4, s[36:39], s66 offen offset:1024 sc1
    buffer_load_dwordx4 v[152:155], v4, s[36:39], s66 offen offset:2048 sc1
    buffer_load_dwordx4 v[156:159], v4, s[36:39], s66 offen offset:3072 sc1
    s_sleep 4
    s_mov_b32 s80, 200000
PP_98:
    s_waitcnt vmcnt(16)
    v_cmp_ne_u64 vcc, s[94:95], v[34:35]
    v_cmp_ne_u64 s[84:85], s[94:95], v[38:39]
    s_or_b64 vcc, vcc, s[84:85]
    v_cmp_ne_u64 s[84:85], s[94:95], v[42:43]
    s_or_b64 vcc, vcc, s[84:85]
    v_cmp_ne_u64 s[84:85], s[94:95], v[46:47]
    s_or_b64 vcc, vcc, s[84:85]
    v_cmp_ne_u64 s[84:85], s[94:95], v[50:51]
    s_or_b64 vcc, vcc, s[84:85]
    v_cmp_ne_u64 s[84:85], s[94:95], v[54:55]
    s_or_b64 vcc, vcc, s[84:85]
    v_cmp_ne_u64 s[84:85], s[94:95], v[58:59]
    s_or_b64 vcc, vcc, s[84:85]
    v_cmp_ne_u64 s[84:85], s[94:95], v[62:63]
    s_or_b64 vcc, vcc, s[84:85]
    s_cmp_eq_u64 vcc, 0
    s_cbranch_scc1 PPO_100
    buffer_load_dwordx4 v[32:35], v4, s[36:39], 0 offen offset:0 sc1
    buffer_load_dwordx4 v[36:39], v4, s[36:39], 0 offen offset:1024 sc1
    buffer_load_dwordx4 v[40:43], v4, s[36:39], 0 offen offset:2048 sc1
    buffer_load_dwordx4 v[44:47], v4, s[36:39], 0 offen offset:3072 sc1
    buffer_load_dwordx4 v[48:51], v4, s[36:39], s66 offen offset:0 sc1
    buffer_load_dwordx4 v[52:55], v4, s[36:39], s66 offen offset:1024 sc1
    buffer_load_dwordx4 v[56:59], v4, s[36:39], s66 offen offset:2048 sc1
    buffer_load_dwordx4 v[60:63], v4, s[36:39], s66 offen offset:3072 sc1
    s_waitcnt vmcnt(16)
    v_cmp_ne_u64 vcc, s[94:95], v[98:99]
    v_cmp_ne_u64 s[84:85], s[94:95], v[102:103]
    s_or_b64 vcc, vcc, s[84:85]
    v_cmp_ne_u64 s[84:85], s[94:95], v[106:107]
    s_or_b64 vcc, vcc, s[84:85]
    v_cmp_ne_u64 s[84:85], s[94:95], v[110:111]
    s_or_b64 vcc, vcc, s[84:85]
    v_cmp_ne_u64 s[84:85], s[94:95], v[114:115]
    s_or_b64 vcc, vcc, s[84:85]
    v_cmp_ne_u64 s[84:85], s[94:95], v[118:119]
    s_or_b64 vcc, vcc, s[84:85]
    v_cmp_ne_u64 s[84:85], s[94:95], v[122:123]
    s_or_b64 vcc, vcc, s[84:85]
    v_cmp_ne_u64 s[84:85], s[94:95], v[126:127]
    s_or_b64 vcc, vcc, s[84:85]
    s_cmp_eq_u64 vcc, 0
    s_cbranch_scc1 PPO_101
    buffer_load_dwordx4 v[96:99], v4, s[36:39], 0 offen offset:0 sc1
    buffer_load_dwordx4 v[100:103], v4, s[36:39], 0 offen offset:1024 sc1
    buffer_load_dwordx4 v[104:107], v4, s[36:39], 0 offen offset:2048 sc1
    buffer_load_dwordx4 v[108:111], v4, s[36:39], 0 offen offset:3072 sc1
    buffer_load_dwordx4 v[112:115], v4, s[36:39], s66 offen offset:0 sc1
    buffer_load_dwordx4 v[116:119], v4, s[36:39], s66 offen offset:1024 sc1
    buffer_load_dwordx4 v[120:123], v4, s[36:39], s66 offen offset:2048 sc1
    buffer_load_dwordx4 v[124:127], v4, s[36:39], s66 offen offset:3072 sc1
    s_waitcnt vmcnt(16)
    v_cmp_ne_u64 vcc, s[94:95], v[130:131]
    v_cmp_ne_u64 s[84:85], s[94:95], v[134:135]
    s_or_b64 vcc, vcc, s[84:85]
    v_cmp_ne_u64 s[84:85], s[94:95], v[138:139]
    s_or_b64 vcc, vcc, s[84:85]
    v_cmp_ne_u64 s[84:85], s[94:95], v[142:143]
    s_or_b64 vcc, vcc, s[84:85]
    v_cmp_ne_u64 s[84:85], s[94:95], v[146:147]
    s_or_b64 vcc, vcc, s[84:85]
    v_cmp_ne_u64 s[84:85], s[94:95], v[150:151]
    s_or_b64 vcc, vcc, s[84:85]
    v_cmp_ne_u64 s[84:85], s[94:95], v[154:155]
    s_or_b64 vcc, vcc, s[84:85]
    v_cmp_ne_u64 s[84:85], s[94:95], v[158:159]
    s_or_b64 vcc, vcc, s[84:85]
    s_cmp_eq_u64 vcc, 0
    s_cbranch_scc1 PPO_102
    buffer_load_dwordx4 v[128:131], v4, s[36:39], 0 offen offset:0 sc1
    buffer_load_dwordx4 v[132:135], v4, s[36:39], 0 offen offset:1024 sc1
    buffer_load_dwordx4 v[136:139], v4, s[36:39], 0 offen offset:2048 sc1
    buffer_load_dwordx4 v[140:143], v4, s[36:39], 0 offen offset:3072 sc1
    buffer_load_dwordx4 v[144:147], v4, s[36:39], s66 offen offset:0 sc1
    buffer_load_dwordx4 v[148:151], v4, s[36:39], s66 offen offset:1024 sc1
    buffer_load_dwordx4 v[152:155], v4, s[36:39], s66 offen offset:2048 sc1
    buffer_load_dwordx4 v[156:159], v4, s[36:39], s66 offen offset:3072 sc1
    s_sub_u32 s80, s80, 1
    s_cmp_lg_u32 s80, 0
    s_cbranch_scc1 PP_98
PPO_100:
    v_lshlrev_b32 v64, 16, v32
    v_and_b32 v65, 0xffff0000, v32
    v_lshlrev_b32 v66, 16, v33
    v_and_b32 v67, 0xffff0000, v33
    v_lshlrev_b32 v68, 16, v36
    v_and_b32 v69, 0xffff0000, v36
    v_lshlrev_b32 v70, 16, v37
    v_and_b32 v71, 0xffff0000, v37
    v_lshlrev_b32 v72, 16, v40
    v_and_b32 v73, 0xffff0000, v40
    v_lshlrev_b32 v74, 16, v41
    v_and_b32 v75, 0xffff0000, v41
    v_lshlrev_b32 v76, 16, v44
    v_and_b32 v77, 0xffff0000, v44
    v_lshlrev_b32 v78, 16, v45
    v_and_b32 v79, 0xffff0000, v45
    v_lshlrev_b32 v80, 16, v48
    v_and_b32 v81, 0xffff0000, v48
    v_lshlrev_b32 v82, 16, v49
    v_and_b32 v83, 0xffff0000, v49
    v_lshlrev_b32 v84, 16, v52
    v_and_b32 v85, 0xffff0000, v52
    v_lshlrev_b32 v86, 16, v53
    v_and_b32 v87, 0xffff0000, v53
    v_lshlrev_b32 v88, 16, v56
    v_and_b32 v89, 0xffff0000, v56
    v_lshlrev_b32 v90, 16, v57
    v_and_b32 v91, 0xffff0000, v57
    v_lshlrev_b32 v92, 16, v60
    v_and_b32 v93, 0xffff0000, v60
    v_lshlrev_b32 v94, 16, v61
    v_and_b32 v95, 0xffff0000, v61
    s_branch PPD_99
PPO_101:
    v_lshlrev_b32 v64, 16, v96
    v_and_b32 v65, 0xffff0000, v96
    v_lshlrev_b32 v66, 16, v97
    v_and_b32 v67, 0xffff0000, v97
    v_lshlrev_b32 v68, 16, v100
    v_and_b32 v69, 0xffff0000, v100
    v_lshlrev_b32 v70, 16, v101
    v_and_b32 v71, 0xffff0000, v101
    v_lshlrev_b32 v72, 16, v104
    v_and_b32 v73, 0xffff0000, v104
    v_lshlrev_b32 v74, 16, v105
    v_and_b32 v75, 0xffff0000, v105
    v_lshlrev_b32 v76, 16, v108
    v_and_b32 v77, 0xffff0000, v108
    v_lshlrev_b32 v78, 16, v109
    v_and_b32 v79, 0xffff0000, v109
    v_lshlrev_b32 v80, 16, v112
    v_and_b32 v81, 0xffff0000, v112
    v_lshlrev_b32 v82, 16, v113
    v_and_b32 v83, 0xffff0000, v113
    v_lshlrev_b32 v84, 16, v116
    v_and_b32 v85, 0xffff0000, v116
    v_lshlrev_b32 v86, 16, v117
    v_and_b32 v87, 0xffff0000, v117
    v_lshlrev_b32 v88, 16, v120
    v_and_b32 v89, 0xffff0000, v120
    v_lshlrev_b32 v90, 16, v121
    v_and_b32 v91, 0xffff0000, v121
    v_lshlrev_b32 v92, 16, v124
    v_and_b32 v93, 0xffff0000, v124
    v_lshlrev_b32 v94, 16, v125
    v_and_b32 v95, 0xffff0000, v125
    s_branch PPD_99
PPO_102:
    v_lshlrev_b32 v64, 16, v128
    v_and_b32 v65, 0xffff0000, v128
    v_lshlrev_b32 v66, 16, v129
    v_and_b32 v67, 0xffff0000, v129
    v_lshlrev_b32 v68, 16, v132
    v_and_b32 v69, 0xffff0000, v132
    v_lshlrev_b32 v70, 16, v133
    v_and_b32 v71, 0xffff0000, v133
    v_lshlrev_b32 v72, 16, v136
    v_and_b32 v73, 0xffff0000, v136
    v_lshlrev_b32 v74, 16, v137
    v_and_b32 v75, 0xffff0000, v137
    v_lshlrev_b32 v76, 16, v140
    v_and_b32 v77, 0xffff0000, v140
    v_lshlrev_b32 v78, 16, v141
    v_and_b32 v79, 0xffff0000, v141
    v_lshlrev_b32 v80, 16, v144
    v_and_b32 v81, 0xffff0000, v144
    v_lshlrev_b32 v82, 16, v145
    v_and_b32 v83, 0xffff0000, v145
    v_lshlrev_b32 v84, 16, v148
    v_and_b32 v85, 0xffff0000, v148
    v_lshlrev_b32 v86, 16, v149
    v_and_b32 v87, 0xffff0000, v149
    v_lshlrev_b32 v88, 16, v152
    v_and_b32 v89, 0xffff0000, v152
    v_lshlrev_b32 v90, 16, v153
    v_and_b32 v91, 0xffff0000, v153
    v_lshlrev_b32 v92, 16, v156
    v_and_b32 v93, 0xffff0000, v156
    v_lshlrev_b32 v94, 16, v157
    v_and_b32 v95, 0xffff0000, v157
PPD_99:
    v_pk_add_f32 v[64:65], v[64:65], v[72:73]
    v_pk_add_f32 v[66:67], v[66:67], v[74:75]
    v_pk_add_f32 v[68:69], v[68:69], v[76:77]
    v_pk_add_f32 v[70:71], v[70:71], v[78:79]
    v_pk_add_f32 v[64:65], v[64:65], v[68:69]
    v_pk_add_f32 v[66:67], v[66:67], v[70:71]
    v_pk_add_f32 v[80:81], v[80:81], v[88:89]
    v_pk_add_f32 v[82:83], v[82:83], v[90:91]
    v_pk_add_f32 v[84:85], v[84:85], v[92:93]
    v_pk_add_f32 v[86:87], v[86:87], v[94:95]
    v_pk_add_f32 v[80:81], v[80:81], v[84:85]
    v_pk_add_f32 v[82:83], v[82:83], v[86:87]
    v_add_f32_dpp v64, v64, v64 row_ror:8 row_mask:0xf bank_mask:0xf
    v_add_f32_dpp v65, v65, v65 row_ror:8 row_mask:0xf bank_mask:0xf
    v_add_f32_dpp v66, v66, v66 row_ror:8 row_mask:0xf bank_mask:0xf
    v_add_f32_dpp v67, v67, v67 row_ror:8 row_mask:0xf bank_mask:0xf
    v_add_f32_dpp v80, v80, v80 row_ror:8 row_mask:0xf bank_mask:0xf
    v_add_f32_dpp v81, v81, v81 row_ror:8 row_mask:0xf bank_mask:0xf
    v_add_f32_dpp v82, v82, v82 row_ror:8 row_mask:0xf bank_mask:0xf
    v_add_f32_dpp v83, v83, v83 row_ror:8 row_mask:0xf bank_mask:0xf
    v_mov_b32 v12, v64
    v_mov_b32 v13, v65
    v_mov_b32 v14, v66
    v_mov_b32 v15, v67
    v_mov_b32 v16, v80
    v_mov_b32 v17, v81
    v_mov_b32 v18, v82
    v_mov_b32 v19, v83
    v_permlane32_swap_b32 v64, v12
    v_permlane32_swap_b32 v65, v13
    v_permlane32_swap_b32 v66, v14
    v_permlane32_swap_b32 v67, v15
    v_permlane32_swap_b32 v80, v16
    v_permlane32_swap_b32 v81, v17
    v_permlane32_swap_b32 v82, v18
    v_permlane32_swap_b32 v83, v19
    v_add_f32 v64, v64, v12
    v_add_f32 v65, v65, v13
    v_add_f32 v66, v66, v14
    v_add_f32 v67, v67, v15
    v_add_f32 v80, v80, v16
    v_add_f32 v81, v81, v17
    v_add_f32 v82, v82, v18
    v_add_f32 v83, v83, v19
    v_mov_b32 v12, v64
    v_mov_b32 v13, v65
    v_mov_b32 v14, v66
    v_mov_b32 v15, v67
    v_mov_b32 v16, v80
    v_mov_b32 v17, v81
    v_mov_b32 v18, v82
    v_mov_b32 v19, v83
    v_permlane16_swap_b32 v64, v12
    v_permlane16_swap_b32 v65, v13
    v_permlane16_swap_b32 v66, v14
    v_permlane16_swap_b32 v67, v15
    v_permlane16_swap_b32 v80, v16
    v_permlane16_swap_b32 v81, v17
    v_permlane16_swap_b32 v82, v18
    v_permlane16_swap_b32 v83, v19
    v_add_f32 v64, v64, v12
    v_add_f32 v65, v65, v13
    v_add_f32 v66, v66, v14
    v_add_f32 v67, v67, v15
    v_add_f32 v80, v80, v16
    v_add_f32 v81, v81, v17
    v_add_f32 v82, v82, v18
    v_add_f32 v83, v83, v19
    v_cvt_pk_bf16_f32 v8, v64, v65
    v_cvt_pk_bf16_f32 v9, v66, v67
    v_cvt_pk_bf16_f32 v10, v80, v81
    v_cvt_pk_bf16_f32 v11, v82, v83
    s_mov_b64 exec, 0xff
    buffer_store_dwordx4 v[8:11], v5, s[52:55], 0 offen
    s_mov_b64 exec, -1
    s_endpgm
L_CSVC:
    s_setprio 3
    s_sub_u32 s60, s3, 8
    s_lshl_b32 s64, s4, 3
    s_add_u32 s64, s64, s5
    s_sub_u32 s64, s64, 8
    v_lshlrev_b32 v2, 4, v1
    s_barrier
    s_cmp_lg_u32 s60, 0
    s_cbranch_scc1 C8_103
    s_sleep 24
    v_mov_b32 v160, 0
    s_mov_b32 s80, 200000
NG_104:
    s_mov_b64 exec, 1
    buffer_load_dwordx2 v[162:163], v160, s[40:43], 0 offen sc1
    s_mov_b64 exec, -1
    s_waitcnt vmcnt(0)
    v_readfirstlane_b32 s94, v162
    v_readfirstlane_b32 s95, v163
    s_cmp_lg_u32 s95, 0
    s_cbranch_scc1 NGD_105
    s_sleep 4
    s_sub_u32 s80, s80, 1
    s_cmp_lg_u32 s80, 0
    s_cbranch_scc1 NG_104
NGD_105:
    v_mov_b32 v160, 0x24050
    v_mov_b32 v162, s94
    v_mov_b32 v163, s95
    ds_write_b64 v160, v[162:163]
    v_mov_b32 v160, 0x2404c
    v_mov_b32 v161, 1
    s_waitcnt lgkmcnt(0)
    s_mov_b64 exec, 1
    ds_add_u32 v160, v161
    s_mov_b64 exec, -1
C8_103:
    s_lshr_b32 s7, s64, 4
    s_lshl_b32 s7, s7, 16
    s_lshl_b32 s63, s60, 14
    s_add_u32 s7, s7, s63
    s_add_u32 s7, s7, 0x0
    v_lshl_add_u32 v4, v1, 4, s7
    s_and_b32 s7, s60, 1
    s_lshl_b32 s7, s7, 7
    v_lshlrev_b32 v3, 3, v1
    v_xor_b32 v3, s7, v3
    s_lshl_b32 s7, s60, 13
    s_add_u32 s7, s7, 0x18000
    v_add_u32 v3, s7, v3
    v_mov_b32 v160, 0x2404c
    s_mov_b32 s80, 1600000
LW_106:
    ds_read_b32 v161, v160
    s_waitcnt lgkmcnt(0)
    v_readfirstlane_b32 s79, v161
    s_cmp_ge_u32 s79, 1
    s_cbranch_scc1 LWD_107
    s_sleep 4
    s_sub_u32 s80, s80, 1
    s_cmp_lg_u32 s80, 0
    s_cbranch_scc1 LW_106
LWD_107:
    v_mov_b32 v160, 0x24050
    ds_read_b64 v[162:163], v160
    s_waitcnt lgkmcnt(0)
    v_readfirstlane_b32 s94, v162
    v_readfirstlane_b32 s95, v163
    v_mov_b32 v160, 0x24018
    s_mov_b32 s80, 1600000
LW_108:
    ds_read_b32 v161, v160
    s_waitcnt lgkmcnt(0)
    v_readfirstlane_b32 s79, v161
    s_cmp_ge_u32 s79, 8
    s_cbranch_scc1 LWD_109
    s_sleep 2
    s_sub_u32 s80, s80, 1
    s_cmp_lg_u32 s80, 0
    s_cbranch_scc1 LW_108
LWD_109:
    s_sleep 1
    s_mov_b32 s67, 4096
    s_mov_b32 s68, 8192
    s_mov_b32 s69, 12288
    buffer_load_dwordx4 v[96:99], v4, s[36:39], 0 offen offset:0 sc1
    buffer_load_dwordx4 v[100:103], v4, s[36:39], 0 offen offset:1024 sc1
    buffer_load_dwordx4 v[104:107], v4, s[36:39], 0 offen offset:2048 sc1
    buffer_load_dwordx4 v[108:111], v4, s[36:39], 0 offen offset:3072 sc1
    buffer_load_dwordx4 v[112:115], v4, s[36:39], s67 offen offset:0 sc1
    buffer_load_dwordx4 v[116:119], v4, s[36:39], s67 offen offset:1024 sc1
    buffer_load_dwordx4 v[120:123], v4, s[36:39], s67 offen offset:2048 sc1
    buffer_load_dwordx4 v[124:127], v4, s[36:39], s67 offen offset:3072 sc1
    buffer_load_dwordx4 v[128:131], v4, s[36:39], s68 offen offset:0 sc1
    buffer_load_dwordx4 v[132:135], v4, s[36:39], s68 offen offset:1024 sc1
    buffer_load_dwordx4 v[136:139], v4, s[36:39], s68 offen offset:2048 sc1
    buffer_load_dwordx4 v[140:143], v4, s[36:39], s68 offen offset:3072 sc1
    buffer_load_dwordx4 v[144:147], v4, s[36:39], s69 offen offset:0 sc1
    buffer_load_dwordx4 v[148:151], v4, s[36:39], s69 offen offset:1024 sc1
    buffer_load_dwordx4 v[152:155], v4, s[36:39], s69 offen offset:2048 sc1
    buffer_load_dwordx4 v[156:159], v4, s[36:39], s69 offen offset:3072 sc1
    s_mov_b32 s80, 200000
PS_110:
    s_waitcnt vmcnt(0)
    s_mov_b32 s78, 0
    v_cmp_ne_u64 vcc, s[94:95], v[98:99]
    s_cbranch_vccz PSS_112
    buffer_load_dwordx4 v[96:99], v4, s[36:39], 0 offen offset:0 sc1
    s_mov_b32 s78, 1
PSS_112:
    v_cmp_ne_u64 vcc, s[94:95], v[102:103]
    s_cbranch_vccz PSS_113
    buffer_load_dwordx4 v[100:103], v4, s[36:39], 0 offen offset:1024 sc1
    s_mov_b32 s78, 1
PSS_113:
    v_cmp_ne_u64 vcc, s[94:95], v[106:107]
    s_cbranch_vccz PSS_114
    buffer_load_dwordx4 v[104:107], v4, s[36:39], 0 offen offset:2048 sc1
    s_mov_b32 s78, 1
PSS_114:
    v_cmp_ne_u64 vcc, s[94:95], v[110:111]
    s_cbranch_vccz PSS_115
    buffer_load_dwordx4 v[108:111], v4, s[36:39], 0 offen offset:3072 sc1
    s_mov_b32 s78, 1
PSS_115:
    v_cmp_ne_u64 vcc, s[94:95], v[114:115]
    s_cbranch_vccz PSS_116
    buffer_load_dwordx4 v[112:115], v4, s[36:39], s67 offen offset:0 sc1
    s_mov_b32 s78, 1
PSS_116:
    v_cmp_ne_u64 vcc, s[94:95], v[118:119]
    s_cbranch_vccz PSS_117
    buffer_load_dwordx4 v[116:119], v4, s[36:39], s67 offen offset:1024 sc1
    s_mov_b32 s78, 1
PSS_117:
    v_cmp_ne_u64 vcc, s[94:95], v[122:123]
    s_cbranch_vccz PSS_118
    buffer_load_dwordx4 v[120:123], v4, s[36:39], s67 offen offset:2048 sc1
    s_mov_b32 s78, 1
PSS_118:
    v_cmp_ne_u64 vcc, s[94:95], v[126:127]
    s_cbranch_vccz PSS_119
    buffer_load_dwordx4 v[124:127], v4, s[36:39], s67 offen offset:3072 sc1
    s_mov_b32 s78, 1
PSS_119:
    v_cmp_ne_u64 vcc, s[94:95], v[130:131]
    s_cbranch_vccz PSS_120
    buffer_load_dwordx4 v[128:131], v4, s[36:39], s68 offen offset:0 sc1
    s_mov_b32 s78, 1
PSS_120:
    v_cmp_ne_u64 vcc, s[94:95], v[134:135]
    s_cbranch_vccz PSS_121
    buffer_load_dwordx4 v[132:135], v4, s[36:39], s68 offen offset:1024 sc1
    s_mov_b32 s78, 1
PSS_121:
    v_cmp_ne_u64 vcc, s[94:95], v[138:139]
    s_cbranch_vccz PSS_122
    buffer_load_dwordx4 v[136:139], v4, s[36:39], s68 offen offset:2048 sc1
    s_mov_b32 s78, 1
PSS_122:
    v_cmp_ne_u64 vcc, s[94:95], v[142:143]
    s_cbranch_vccz PSS_123
    buffer_load_dwordx4 v[140:143], v4, s[36:39], s68 offen offset:3072 sc1
    s_mov_b32 s78, 1
PSS_123:
    v_cmp_ne_u64 vcc, s[94:95], v[146:147]
    s_cbranch_vccz PSS_124
    buffer_load_dwordx4 v[144:147], v4, s[36:39], s69 offen offset:0 sc1
    s_mov_b32 s78, 1
PSS_124:
    v_cmp_ne_u64 vcc, s[94:95], v[150:151]
    s_cbranch_vccz PSS_125
    buffer_load_dwordx4 v[148:151], v4, s[36:39], s69 offen offset:1024 sc1
    s_mov_b32 s78, 1
PSS_125:
    v_cmp_ne_u64 vcc, s[94:95], v[154:155]
    s_cbranch_vccz PSS_126
    buffer_load_dwordx4 v[152:155], v4, s[36:39], s69 offen offset:2048 sc1
    s_mov_b32 s78, 1
PSS_126:
    v_cmp_ne_u64 vcc, s[94:95], v[158:159]
    s_cbranch_vccz PSS_127
    buffer_load_dwordx4 v[156:159], v4, s[36:39], s69 offen offset:3072 sc1
    s_mov_b32 s78, 1
PSS_127:
    s_cmp_eq_u32 s78, 0
    s_cbranch_scc1 PSD_111
    s_sub_u32 s80, s80, 1
    s_cmp_lg_u32 s80, 0
    s_cbranch_scc1 PS_110
    s_waitcnt vmcnt(0)
PSD_111:
    v_xor_b32 v6, 0x0, v3
    ds_write_b64 v6, v[96:97] offset:0
    ds_write_b64 v6, v[100:101] offset:512
    v_xor_b32 v7, 0x10, v3
    ds_write_b64 v7, v[104:105] offset:1024
    ds_write_b64 v7, v[108:109] offset:1536
    v_xor_b32 v6, 0x20, v3
    ds_write_b64 v6, v[112:113] offset:2048
    ds_write_b64 v6, v[116:117] offset:2560
    v_xor_b32 v7, 0x30, v3
    ds_write_b64 v7, v[120:121] offset:3072
    ds_write_b64 v7, v[124:125] offset:3584
    v_xor_b32 v6, 0x40, v3
    ds_write_b64 v6, v[128:129] offset:4096
    ds_write_b64 v6, v[132:133] offset:4608
    v_xor_b32 v7, 0x50, v3
    ds_write_b64 v7, v[136:137] offset:5120
    ds_write_b64 v7, v[140:141] offset:5632
    v_xor_b32 v6, 0x60, v3
    ds_write_b64 v6, v[144:145] offset:6144
    ds_write_b64 v6, v[148:149] offset:6656
    v_xor_b32 v7, 0x70, v3
    ds_write_b64 v7, v[152:153] offset:7168
    ds_write_b64 v7, v[156:157] offset:7680
L_CCUT:
    s_waitcnt lgkmcnt(0)
    s_barrier
    s_endpgm
L_END:
    s_endpgm
L_END0:
    s_endpgm
.section .rodata,"a"
.p2align 6
.amdhsa_kernel concat_heads__sliding_block_cached__compressed_kv_cla__decode_kernel
  .amdhsa_next_free_vgpr 168
  .amdhsa_next_free_sgpr 102
  .amdhsa_accum_offset 168
  .amdhsa_group_segment_fixed_size 0
  .amdhsa_kernarg_size 112
  .amdhsa_user_sgpr_count 2
  .amdhsa_user_sgpr_kernarg_segment_ptr 1
  .amdhsa_system_sgpr_workgroup_id_x 1
  .amdhsa_float_denorm_mode_32 3
.end_amdhsa_kernel
```

```asm
; @launch grid=(256,1,1) block=(768,1,1) lds=163840
.amdgcn_target "amdgcn-amd-amdhsa--gfx950"
.text
.globl concat_heads__sliding_block_cached__compressed_kv_cla__decode_kernel
.p2align 8
.type concat_heads__sliding_block_cached__compressed_kv_cla__decode_kernel,@function
concat_heads__sliding_block_cached__compressed_kv_cla__decode_kernel:
    s_load_dwordx16 s[8:23], s[0:1], 0
    s_load_dwordx8 s[24:31], s[0:1], 64
    s_load_dwordx4 s[32:35], s[0:1], 96
    v_lshrrev_b32 v1, 6, v0
    s_and_b32 s4, s2, 7
    v_readfirstlane_b32 s3, v1
    s_lshr_b32 s5, s2, 3
    s_cmp_ge_u32 s2, 256
    s_cbranch_scc1 L_END0
    s_cmp_ge_u32 s5, 16
    s_cbranch_scc1 EA_1
    s_cmp_ge_u32 s5, 8
    s_cbranch_scc1 EC_2
    s_cmp_ge_u32 s3, 8
    s_cbranch_scc1 L_W2
    s_cmp_ge_u32 s3, 4
    s_cbranch_scc1 L_W1
    s_branch L_W
EC_2:
    s_cmp_ge_u32 s3, 8
    s_cbranch_scc1 L_CSVC
    s_branch L_C
EA_1:
    s_cmp_eq_u32 s3, 11
    s_cbranch_scc1 L_ASVC
    v_and_b32 v1, 63, v0
    s_and_b32 s7, s5, 3
    s_lshl_b32 s6, s4, 2
    s_add_u32 s6, s6, s7
    s_mov_b32 s92, 0x05040100
    s_mov_b32 s93, 0x07060302
    s_waitcnt lgkmcnt(0)
    s_mov_b32 s36, s34
    s_and_b32 s37, s35, 0xffff
    s_mov_b32 s38, 0x1000000
    s_mov_b32 s39, 0x20000
    s_mov_b32 s40, s32
    s_and_b32 s41, s33, 0xffff
    s_mov_b32 s42, 0x100
    s_mov_b32 s43, 0x20000
    s_mov_b32 s44, s10
    s_and_b32 s45, s11, 0xffff
    s_mov_b32 s46, 0x8000000
    s_mov_b32 s47, 0x20000
    s_mov_b32 s48, s12
    s_and_b32 s49, s13, 0xffff
    s_mov_b32 s50, 0x8000000
    s_mov_b32 s51, 0x20000
    s_lshr_b32 s7, s5, 2
    s_sub_u32 s7, s7, 4
    s_lshl_b32 s7, s7, 5
    s_add_u32 s7, s7, s6
    s_lshl_b32 s7, s7, 20
    s_add_u32 s7, s7, 0xC0000
    v_lshlrev_b32 v6, 4, v1
    v_add_u32 v6, s7, v6
    s_add_u32 s63, s3, 3
    s_cmp_ge_u32 s63, 11
    s_cselect_b32 s7, 11, 0
    s_sub_u32 s62, s63, s7
    s_mul_i32 s7, s2, 0
    s_add_u32 s7, s7, s62
    s_mul_i32 s7, s7, 1024
    s_and_b32 s60, s7, 0x3ffff
    s_mov_b32 s61, s60
    s_add_u32 s63, s60, 259072
    s_and_b32 s63, s63, 0x3ffff
    s_cmp_lt_u32 s62, 3
    s_cselect_b32 s63, s63, 0x40000000
    s_cselect_b32 s62, 0, 0xff800000
    s_mov_b32 s64, 0x3e0293ee
    s_cmp_ge_u32 s3, 8
    s_cbranch_scc1 AK_3
    s_cmp_lt_u32 s3, 4
    s_cselect_b32 s70, s18, s8
    s_cselect_b32 s71, s19, s9
    s_cselect_b32 s72, s22, s14
    s_cselect_b32 s73, s23, s15
    s_mov_b32 s52, s70
    s_and_b32 s53, s71, 0xffff
    s_mov_b32 s54, 0x1000
    s_mov_b32 s55, 0x20000
    s_mov_b32 s56, s72
    s_and_b32 s57, s73, 0xffff
    s_mov_b32 s58, 0x400000
    s_mov_b32 s59, 0x20000
    s_and_b32 s7, s5, 12
    s_and_b32 s66, s3, 3
    s_add_u32 s7, s7, s66
    v_lshrrev_b32 v2, 4, v1
    v_lshlrev_b32 v3, 16, v2
    v_and_b32 v4, 15, v1
    v_lshl_add_u32 v3, v4, 4, v3
    s_lshl_b32 s66, s7, 18
    s_lshl_b32 s67, s6, 8
    s_add_u32 s66, s66, s67
    s_cmp_lt_u32 s3, 4
    s_cbranch_scc1 AP_5
    s_barrier
    s_sleep 26
AP_5:
    buffer_load_dwordx4 v[128:131], v3, s[56:59], s66 offen nt
    s_add_u32 s66, s66, 8192
    buffer_load_dwordx4 v[132:135], v3, s[56:59], s66 offen nt
    s_add_u32 s66, s66, 8192
    buffer_load_dwordx4 v[136:139], v3, s[56:59], s66 offen nt
    s_add_u32 s66, s66, 8192
    buffer_load_dwordx4 v[140:143], v3, s[56:59], s66 offen nt
    s_add_u32 s66, s66, 8192
    buffer_load_dwordx4 v[144:147], v3, s[56:59], s66 offen nt
    s_add_u32 s66, s66, 8192
    buffer_load_dwordx4 v[148:151], v3, s[56:59], s66 offen nt
    s_add_u32 s66, s66, 8192
    buffer_load_dwordx4 v[152:155], v3, s[56:59], s66 offen nt
    s_add_u32 s66, s66, 8192
    buffer_load_dwordx4 v[156:159], v3, s[56:59], s66 offen nt
    s_add_u32 s66, s66, 8192
    v_bfe_u32 v4, v1, 2, 2
    v_lshlrev_b32 v4, 10, v4
    v_lshl_add_u32 v4, v2, 4, v4
    s_lshl_b32 s7, s7, 6
    buffer_load_dwordx4 v[160:163], v4, s[52:55], s7 offen
    s_cmp_ge_u32 s3, 4
    s_cbranch_scc1 AP_6
    s_barrier
AP_6:
    s_lshl_b32 s7, s3, 11
    s_add_u32 s7, s7, 0x0
    v_lshl_add_u32 v2, v1, 5, s7
    s_cmp_lt_u32 s3, 4
    s_cselect_b32 s7, 0x44, 0x40
    s_add_u32 s7, s7, 0x24000
    v_mov_b32 v3, s7
    v_mov_b32 v4, 1
    s_waitcnt vmcnt(0)
    v_perm_b32 v96, v132, v128, s92
    v_perm_b32 v97, v140, v136, s92
    v_perm_b32 v98, v148, v144, s92
    v_perm_b32 v99, v156, v152, s92
    v_perm_b32 v100, v132, v128, s93
    v_perm_b32 v101, v140, v136, s93
    v_perm_b32 v102, v148, v144, s93
    v_perm_b32 v103, v156, v152, s93
    v_perm_b32 v104, v133, v129, s92
    v_perm_b32 v105, v141, v137, s92
    v_perm_b32 v106, v149, v145, s92
    v_perm_b32 v107, v157, v153, s92
    v_perm_b32 v108, v133, v129, s93
    v_perm_b32 v109, v141, v137, s93
    v_perm_b32 v110, v149, v145, s93
    v_perm_b32 v111, v157, v153, s93
    v_perm_b32 v112, v134, v130, s92
    v_perm_b32 v113, v142, v138, s92
    v_perm_b32 v114, v150, v146, s92
    v_perm_b32 v115, v158, v154, s92
    v_perm_b32 v116, v134, v130, s93
    v_perm_b32 v117, v142, v138, s93
    v_perm_b32 v118, v150, v146, s93
    v_perm_b32 v119, v158, v154, s93
    v_perm_b32 v120, v135, v131, s92
    v_perm_b32 v121, v143, v139, s92
    v_perm_b32 v122, v151, v147, s92
    v_perm_b32 v123, v159, v155, s92
    v_perm_b32 v124, v135, v131, s93
    v_perm_b32 v125, v143, v139, s93
    v_perm_b32 v126, v151, v147, s93
    v_perm_b32 v127, v159, v155, s93
    v_mfma_f32_16x16x32_bf16 v[64:67], v[160:163], v[96:99], 0
    v_mfma_f32_16x16x32_bf16 v[68:71], v[160:163], v[100:103], 0
    v_mfma_f32_16x16x32_bf16 v[72:75], v[160:163], v[104:107], 0
    v_mfma_f32_16x16x32_bf16 v[76:79], v[160:163], v[108:111], 0
    v_mfma_f32_16x16x32_bf16 v[80:83], v[160:163], v[112:115], 0
    v_mfma_f32_16x16x32_bf16 v[84:87], v[160:163], v[116:119], 0
    v_mfma_f32_16x16x32_bf16 v[88:91], v[160:163], v[120:123], 0
    v_mfma_f32_16x16x32_bf16 v[92:95], v[160:163], v[124:127], 0
    s_nop 0
    v_mov_b32 v128, v64
    v_mov_b32 v129, v68
    v_mov_b32 v130, v72
    v_mov_b32 v131, v76
    v_mov_b32 v132, v80
    v_mov_b32 v133, v84
    v_mov_b32 v134, v88
    v_mov_b32 v135, v92
    ds_write_b128 v2, v[128:131]
    ds_write_b128 v2, v[132:135] offset:16
    s_waitcnt lgkmcnt(0)
    s_mov_b64 exec, 1
    ds_add_u32 v3, v4
    s_mov_b64 exec, -1
    s_branch AJ_4
AK_3:
    s_barrier
    s_sleep 26
AJ_4:
    buffer_load_dwordx4 v[32:35], v6, s[44:47], s60 offen offset:0 nt
    s_add_u32 s60, s60, 11264
    buffer_load_dwordx4 v[36:39], v6, s[44:47], s60 offen offset:0 nt
    s_add_u32 s60, s60, 11264
    buffer_load_dwordx4 v[40:43], v6, s[44:47], s60 offen offset:0 nt
    s_add_u32 s60, s60, 11264
    s_waitcnt vmcnt(2)
    buffer_load_dwordx4 v[44:47], v6, s[44:47], s60 offen offset:0 nt
    s_add_u32 s60, s60, 11264
    s_waitcnt vmcnt(2)
    buffer_load_dwordx4 v[48:51], v6, s[44:47], s60 offen offset:0 nt
    s_add_u32 s60, s60, 11264
    s_waitcnt vmcnt(2)
    buffer_load_dwordx4 v[52:55], v6, s[44:47], s60 offen offset:0 nt
    s_add_u32 s60, s60, 11264
    s_waitcnt vmcnt(2)
    buffer_load_dwordx4 v[56:59], v6, s[44:47], s60 offen offset:0 nt
    s_add_u32 s60, s60, 11264
    s_waitcnt vmcnt(2)
    buffer_load_dwordx4 v[60:63], v6, s[44:47], s60 offen offset:0 nt
    s_add_u32 s60, s60, 11264
    s_waitcnt vmcnt(2)
    buffer_load_dwordx4 v[64:67], v6, s[44:47], s60 offen offset:0 nt
    s_add_u32 s60, s60, 11264
    s_waitcnt vmcnt(2)
    buffer_load_dwordx4 v[68:71], v6, s[44:47], s60 offen offset:0 nt
    s_add_u32 s60, s60, 11264
    s_waitcnt vmcnt(2)
    buffer_load_dwordx4 v[72:75], v6, s[44:47], s60 offen offset:0 nt
    s_add_u32 s60, s60, 11264
    s_waitcnt vmcnt(2)
    buffer_load_dwordx4 v[76:79], v6, s[44:47], s60 offen offset:0 nt
    s_add_u32 s60, s60, 11264
    s_waitcnt vmcnt(2)
    buffer_load_dwordx4 v[80:83], v6, s[44:47], s60 offen offset:0 nt
    s_add_u32 s60, s60, 11264
    s_waitcnt vmcnt(2)
    buffer_load_dwordx4 v[84:87], v6, s[44:47], s60 offen offset:0 nt
    s_add_u32 s60, s60, 11264
    s_waitcnt vmcnt(2)
    buffer_load_dwordx4 v[88:91], v6, s[44:47], s60 offen offset:0 nt
    s_add_u32 s60, s60, 11264
    s_waitcnt vmcnt(2)
    buffer_load_dwordx4 v[92:95], v6, s[44:47], s60 offen offset:0 nt
    s_add_u32 s60, s60, 11264
    v_mov_b32 v160, 0x24004
    s_mov_b32 s80, 1600000
LW_7:
    ds_read_b32 v161, v160
    s_waitcnt lgkmcnt(0)
    v_readfirstlane_b32 s79, v161
    s_cmp_ge_u32 s79, 1
    s_cbranch_scc1 LWD_8
    s_sleep 4
    s_sub_u32 s80, s80, 1
    s_cmp_lg_u32 s80, 0
    s_cbranch_scc1 LW_7
LWD_8:
    v_and_b32 v160, 15, v1
    v_lshlrev_b32 v160, 4, v160
    v_add_u32 v160, 0x24100, v160
    ds_read_b128 v[2:5], v160
    s_waitcnt lgkmcnt(0)
    v_dot2_f32_bf16 v8, v32, v2, 0
    v_dot2_f32_bf16 v9, v36, v2, 0
    v_dot2_f32_bf16 v10, v40, v2, 0
    v_dot2_f32_bf16 v11, v44, v2, 0
    v_dot2_f32_bf16 v8, v33, v3, v8
    v_dot2_f32_bf16 v9, v37, v3, v9
    v_dot2_f32_bf16 v10, v41, v3, v10
    v_dot2_f32_bf16 v11, v45, v3, v11
    v_dot2_f32_bf16 v8, v34, v4, v8
    v_dot2_f32_bf16 v9, v38, v4, v9
    v_dot2_f32_bf16 v10, v42, v4, v10
    v_dot2_f32_bf16 v11, v46, v4, v11
    v_dot2_f32_bf16 v8, v35, v5, v8
    v_dot2_f32_bf16 v9, v39, v5, v9
    v_dot2_f32_bf16 v10, v43, v5, v10
    v_dot2_f32_bf16 v11, v47, v5, v11
    v_add_f32_dpp v8, v8, v8 row_ror:8 row_mask:0xf bank_mask:0xf
    v_add_f32_dpp v9, v9, v9 row_ror:8 row_mask:0xf bank_mask:0xf
    v_add_f32_dpp v10, v10, v10 row_ror:8 row_mask:0xf bank_mask:0xf
    v_add_f32_dpp v11, v11, v11 row_ror:8 row_mask:0xf bank_mask:0xf
    v_add_f32_dpp v8, v8, v8 row_ror:4 row_mask:0xf bank_mask:0xf
    v_add_f32_dpp v9, v9, v9 row_ror:4 row_mask:0xf bank_mask:0xf
    v_add_f32_dpp v10, v10, v10 row_ror:4 row_mask:0xf bank_mask:0xf
    v_add_f32_dpp v11, v11, v11 row_ror:4 row_mask:0xf bank_mask:0xf
    v_add_f32_dpp v8, v8, v8 row_ror:2 row_mask:0xf bank_mask:0xf
    v_add_f32_dpp v9, v9, v9 row_ror:2 row_mask:0xf bank_mask:0xf
    v_add_f32_dpp v10, v10, v10 row_ror:2 row_mask:0xf bank_mask:0xf
    v_add_f32_dpp v11, v11, v11 row_ror:2 row_mask:0xf bank_mask:0xf
    v_add_f32_dpp v8, v8, v8 row_ror:1 row_mask:0xf bank_mask:0xf
    v_add_f32_dpp v9, v9, v9 row_ror:1 row_mask:0xf bank_mask:0xf
    v_add_f32_dpp v10, v10, v10 row_ror:1 row_mask:0xf bank_mask:0xf
    v_add_f32_dpp v11, v11, v11 row_ror:1 row_mask:0xf bank_mask:0xf
    s_waitcnt vmcnt(2)
    buffer_load_dwordx4 v[96:99], v6, s[44:47], s60 offen offset:0 nt
    s_add_u32 s60, s60, 11264
    s_waitcnt vmcnt(2)
    buffer_load_dwordx4 v[100:103], v6, s[44:47], s60 offen offset:0 nt
    s_add_u32 s60, s60, 11264
    v_dot2_f32_bf16 v12, v48, v2, 0
    v_dot2_f32_bf16 v13, v52, v2, 0
    v_dot2_f32_bf16 v14, v56, v2, 0
    v_dot2_f32_bf16 v15, v60, v2, 0
    v_dot2_f32_bf16 v12, v49, v3, v12
    v_dot2_f32_bf16 v13, v53, v3, v13
    v_dot2_f32_bf16 v14, v57, v3, v14
    v_dot2_f32_bf16 v15, v61, v3, v15
    v_dot2_f32_bf16 v12, v50, v4, v12
    v_dot2_f32_bf16 v13, v54, v4, v13
    v_dot2_f32_bf16 v14, v58, v4, v14
    v_dot2_f32_bf16 v15, v62, v4, v15
    v_dot2_f32_bf16 v12, v51, v5, v12
    v_dot2_f32_bf16 v13, v55, v5, v13
    v_dot2_f32_bf16 v14, v59, v5, v14
    v_dot2_f32_bf16 v15, v63, v5, v15
    v_add_f32_dpp v12, v12, v12 row_ror:8 row_mask:0xf bank_mask:0xf
    v_add_f32_dpp v13, v13, v13 row_ror:8 row_mask:0xf bank_mask:0xf
    v_add_f32_dpp v14, v14, v14 row_ror:8 row_mask:0xf bank_mask:0xf
    v_add_f32_dpp v15, v15, v15 row_ror:8 row_mask:0xf bank_mask:0xf
    v_add_f32_dpp v12, v12, v12 row_ror:4 row_mask:0xf bank_mask:0xf
    v_add_f32_dpp v13, v13, v13 row_ror:4 row_mask:0xf bank_mask:0xf
    v_add_f32_dpp v14, v14, v14 row_ror:4 row_mask:0xf bank_mask:0xf
    v_add_f32_dpp v15, v15, v15 row_ror:4 row_mask:0xf bank_mask:0xf
    v_add_f32_dpp v12, v12, v12 row_ror:2 row_mask:0xf bank_mask:0xf
    v_add_f32_dpp v13, v13, v13 row_ror:2 row_mask:0xf bank_mask:0xf
    v_add_f32_dpp v14, v14, v14 row_ror:2 row_mask:0xf bank_mask:0xf
    v_add_f32_dpp v15, v15, v15 row_ror:2 row_mask:0xf bank_mask:0xf
    v_add_f32_dpp v12, v12, v12 row_ror:1 row_mask:0xf bank_mask:0xf
    v_add_f32_dpp v13, v13, v13 row_ror:1 row_mask:0xf bank_mask:0xf
    v_add_f32_dpp v14, v14, v14 row_ror:1 row_mask:0xf bank_mask:0xf
    v_add_f32_dpp v15, v15, v15 row_ror:1 row_mask:0xf bank_mask:0xf
    s_waitcnt vmcnt(2)
    buffer_load_dwordx4 v[104:107], v6, s[44:47], s60 offen offset:0 nt
    s_add_u32 s60, s60, 11264
    s_waitcnt vmcnt(2)
    buffer_load_dwordx4 v[108:111], v6, s[44:47], s60 offen offset:0 nt
    s_add_u32 s60, s60, 11264
    v_dot2_f32_bf16 v16, v64, v2, 0
    v_dot2_f32_bf16 v17, v68, v2, 0
    v_dot2_f32_bf16 v18, v72, v2, 0
    v_dot2_f32_bf16 v19, v76, v2, 0
    v_dot2_f32_bf16 v16, v65, v3, v16
    v_dot2_f32_bf16 v17, v69, v3, v17
    v_dot2_f32_bf16 v18, v73, v3, v18
    v_dot2_f32_bf16 v19, v77, v3, v19
    v_dot2_f32_bf16 v16, v66, v4, v16
    v_dot2_f32_bf16 v17, v70, v4, v17
    v_dot2_f32_bf16 v18, v74, v4, v18
    v_dot2_f32_bf16 v19, v78, v4, v19
    v_dot2_f32_bf16 v16, v67, v5, v16
    v_dot2_f32_bf16 v17, v71, v5, v17
    v_dot2_f32_bf16 v18, v75, v5, v18
    v_dot2_f32_bf16 v19, v79, v5, v19
    v_add_f32_dpp v16, v16, v16 row_ror:8 row_mask:0xf bank_mask:0xf
    v_add_f32_dpp v17, v17, v17 row_ror:8 row_mask:0xf bank_mask:0xf
    v_add_f32_dpp v18, v18, v18 row_ror:8 row_mask:0xf bank_mask:0xf
    v_add_f32_dpp v19, v19, v19 row_ror:8 row_mask:0xf bank_mask:0xf
    v_add_f32_dpp v16, v16, v16 row_ror:4 row_mask:0xf bank_mask:0xf
    v_add_f32_dpp v17, v17, v17 row_ror:4 row_mask:0xf bank_mask:0xf
    v_add_f32_dpp v18, v18, v18 row_ror:4 row_mask:0xf bank_mask:0xf
    v_add_f32_dpp v19, v19, v19 row_ror:4 row_mask:0xf bank_mask:0xf
    v_add_f32_dpp v16, v16, v16 row_ror:2 row_mask:0xf bank_mask:0xf
    v_add_f32_dpp v17, v17, v17 row_ror:2 row_mask:0xf bank_mask:0xf
    v_add_f32_dpp v18, v18, v18 row_ror:2 row_mask:0xf bank_mask:0xf
    v_add_f32_dpp v19, v19, v19 row_ror:2 row_mask:0xf bank_mask:0xf
    v_add_f32_dpp v16, v16, v16 row_ror:1 row_mask:0xf bank_mask:0xf
    v_add_f32_dpp v17, v17, v17 row_ror:1 row_mask:0xf bank_mask:0xf
    v_add_f32_dpp v18, v18, v18 row_ror:1 row_mask:0xf bank_mask:0xf
    v_add_f32_dpp v19, v19, v19 row_ror:1 row_mask:0xf bank_mask:0xf
    s_waitcnt vmcnt(2)
    buffer_load_dwordx4 v[112:115], v6, s[44:47], s60 offen offset:0 nt
    s_add_u32 s60, s60, 11264
    s_waitcnt vmcnt(2)
    buffer_load_dwordx4 v[116:119], v6, s[44:47], s60 offen offset:0 nt
    s_add_u32 s60, s60, 11264
    v_dot2_f32_bf16 v20, v80, v2, 0
    v_dot2_f32_bf16 v21, v84, v2, 0
    v_dot2_f32_bf16 v22, v88, v2, 0
    v_dot2_f32_bf16 v23, v92, v2, 0
    v_dot2_f32_bf16 v20, v81, v3, v20
    v_dot2_f32_bf16 v21, v85, v3, v21
    v_dot2_f32_bf16 v22, v89, v3, v22
    v_dot2_f32_bf16 v23, v93, v3, v23
    v_dot2_f32_bf16 v20, v82, v4, v20
    v_dot2_f32_bf16 v21, v86, v4, v21
    v_dot2_f32_bf16 v22, v90, v4, v22
    v_dot2_f32_bf16 v23, v94, v4, v23
    v_dot2_f32_bf16 v20, v83, v5, v20
    v_dot2_f32_bf16 v21, v87, v5, v21
    v_dot2_f32_bf16 v22, v91, v5, v22
    v_dot2_f32_bf16 v23, v95, v5, v23
    v_add_f32_dpp v20, v20, v20 row_ror:8 row_mask:0xf bank_mask:0xf
    v_add_f32_dpp v21, v21, v21 row_ror:8 row_mask:0xf bank_mask:0xf
    v_add_f32_dpp v22, v22, v22 row_ror:8 row_mask:0xf bank_mask:0xf
    v_add_f32_dpp v23, v23, v23 row_ror:8 row_mask:0xf bank_mask:0xf
    v_add_f32_dpp v20, v20, v20 row_ror:4 row_mask:0xf bank_mask:0xf
    v_add_f32_dpp v21, v21, v21 row_ror:4 row_mask:0xf bank_mask:0xf
    v_add_f32_dpp v22, v22, v22 row_ror:4 row_mask:0xf bank_mask:0xf
    v_add_f32_dpp v23, v23, v23 row_ror:4 row_mask:0xf bank_mask:0xf
    v_add_f32_dpp v20, v20, v20 row_ror:2 row_mask:0xf bank_mask:0xf
    v_add_f32_dpp v21, v21, v21 row_ror:2 row_mask:0xf bank_mask:0xf
    v_add_f32_dpp v22, v22, v22 row_ror:2 row_mask:0xf bank_mask:0xf
    v_add_f32_dpp v23, v23, v23 row_ror:2 row_mask:0xf bank_mask:0xf
    v_add_f32_dpp v20, v20, v20 row_ror:1 row_mask:0xf bank_mask:0xf
    v_add_f32_dpp v21, v21, v21 row_ror:1 row_mask:0xf bank_mask:0xf
    v_add_f32_dpp v22, v22, v22 row_ror:1 row_mask:0xf bank_mask:0xf
    v_add_f32_dpp v23, v23, v23 row_ror:1 row_mask:0xf bank_mask:0xf
    s_waitcnt vmcnt(2)
    buffer_load_dwordx4 v[120:123], v6, s[44:47], s60 offen offset:0 nt
    s_waitcnt vmcnt(2)
    buffer_load_dwordx4 v[124:127], v6, s[44:47], s63 offen offset:0 nt
    v_dot2_f32_bf16 v24, v96, v2, 0
    v_dot2_f32_bf16 v25, v100, v2, 0
    v_dot2_f32_bf16 v26, v104, v2, 0
    v_dot2_f32_bf16 v27, v108, v2, 0
    v_dot2_f32_bf16 v24, v97, v3, v24
    v_dot2_f32_bf16 v25, v101, v3, v25
    v_dot2_f32_bf16 v26, v105, v3, v26
    v_dot2_f32_bf16 v27, v109, v3, v27
    v_dot2_f32_bf16 v24, v98, v4, v24
    v_dot2_f32_bf16 v25, v102, v4, v25
    v_dot2_f32_bf16 v26, v106, v4, v26
    v_dot2_f32_bf16 v27, v110, v4, v27
    v_dot2_f32_bf16 v24, v99, v5, v24
    v_dot2_f32_bf16 v25, v103, v5, v25
    v_dot2_f32_bf16 v26, v107, v5, v26
    v_dot2_f32_bf16 v27, v111, v5, v27
    v_add_f32_dpp v24, v24, v24 row_ror:8 row_mask:0xf bank_mask:0xf
    v_add_f32_dpp v25, v25, v25 row_ror:8 row_mask:0xf bank_mask:0xf
    v_add_f32_dpp v26, v26, v26 row_ror:8 row_mask:0xf bank_mask:0xf
    v_add_f32_dpp v27, v27, v27 row_ror:8 row_mask:0xf bank_mask:0xf
    v_add_f32_dpp v24, v24, v24 row_ror:4 row_mask:0xf bank_mask:0xf
    v_add_f32_dpp v25, v25, v25 row_ror:4 row_mask:0xf bank_mask:0xf
    v_add_f32_dpp v26, v26, v26 row_ror:4 row_mask:0xf bank_mask:0xf
    v_add_f32_dpp v27, v27, v27 row_ror:4 row_mask:0xf bank_mask:0xf
    v_add_f32_dpp v24, v24, v24 row_ror:2 row_mask:0xf bank_mask:0xf
    v_add_f32_dpp v25, v25, v25 row_ror:2 row_mask:0xf bank_mask:0xf
    v_add_f32_dpp v26, v26, v26 row_ror:2 row_mask:0xf bank_mask:0xf
    v_add_f32_dpp v27, v27, v27 row_ror:2 row_mask:0xf bank_mask:0xf
    v_add_f32_dpp v24, v24, v24 row_ror:1 row_mask:0xf bank_mask:0xf
    v_add_f32_dpp v25, v25, v25 row_ror:1 row_mask:0xf bank_mask:0xf
    v_add_f32_dpp v26, v26, v26 row_ror:1 row_mask:0xf bank_mask:0xf
    v_add_f32_dpp v27, v27, v27 row_ror:1 row_mask:0xf bank_mask:0xf
    s_waitcnt vmcnt(2)
    buffer_load_dwordx4 v[128:131], v6, s[48:51], s61 offen offset:0 nt
    s_add_u32 s61, s61, 11264
    s_waitcnt vmcnt(2)
    buffer_load_dwordx4 v[132:135], v6, s[48:51], s61 offen offset:0 nt
    s_add_u32 s61, s61, 11264
    s_waitcnt vmcnt(2)
    buffer_load_dwordx4 v[136:139], v6, s[48:51], s61 offen offset:0 nt
    s_add_u32 s61, s61, 11264
    v_dot2_f32_bf16 v28, v112, v2, 0
    v_dot2_f32_bf16 v29, v116, v2, 0
    v_dot2_f32_bf16 v30, v120, v2, 0
    v_dot2_f32_bf16 v31, v124, v2, 0
    v_dot2_f32_bf16 v28, v113, v3, v28
    v_dot2_f32_bf16 v29, v117, v3, v29
    v_dot2_f32_bf16 v30, v121, v3, v30
    v_dot2_f32_bf16 v31, v125, v3, v31
    v_dot2_f32_bf16 v28, v114, v4, v28
    v_dot2_f32_bf16 v29, v118, v4, v29
    v_dot2_f32_bf16 v30, v122, v4, v30
    v_dot2_f32_bf16 v31, v126, v4, v31
    v_dot2_f32_bf16 v28, v115, v5, v28
    v_dot2_f32_bf16 v29, v119, v5, v29
    v_dot2_f32_bf16 v30, v123, v5, v30
    v_dot2_f32_bf16 v31, v127, v5, v31
    v_add_f32_dpp v28, v28, v28 row_ror:8 row_mask:0xf bank_mask:0xf
    v_add_f32_dpp v29, v29, v29 row_ror:8 row_mask:0xf bank_mask:0xf
    v_add_f32_dpp v30, v30, v30 row_ror:8 row_mask:0xf bank_mask:0xf
    v_add_f32_dpp v31, v31, v31 row_ror:8 row_mask:0xf bank_mask:0xf
    v_add_f32_dpp v28, v28, v28 row_ror:4 row_mask:0xf bank_mask:0xf
    v_add_f32_dpp v29, v29, v29 row_ror:4 row_mask:0xf bank_mask:0xf
    v_add_f32_dpp v30, v30, v30 row_ror:4 row_mask:0xf bank_mask:0xf
    v_add_f32_dpp v31, v31, v31 row_ror:4 row_mask:0xf bank_mask:0xf
    v_add_f32_dpp v28, v28, v28 row_ror:2 row_mask:0xf bank_mask:0xf
    v_add_f32_dpp v29, v29, v29 row_ror:2 row_mask:0xf bank_mask:0xf
    v_add_f32_dpp v30, v30, v30 row_ror:2 row_mask:0xf bank_mask:0xf
    v_add_f32_dpp v31, v31, v31 row_ror:2 row_mask:0xf bank_mask:0xf
    v_add_f32_dpp v28, v28, v28 row_ror:1 row_mask:0xf bank_mask:0xf
    v_add_f32_dpp v29, v29, v29 row_ror:1 row_mask:0xf bank_mask:0xf
    v_add_f32_dpp v30, v30, v30 row_ror:1 row_mask:0xf bank_mask:0xf
    v_add_f32_dpp v31, v31, v31 row_ror:1 row_mask:0xf bank_mask:0xf
    s_waitcnt vmcnt(2)
    buffer_load_dwordx4 v[140:143], v6, s[48:51], s61 offen offset:0 nt
    s_add_u32 s61, s61, 11264
    s_waitcnt vmcnt(2)
    buffer_load_dwordx4 v[144:147], v6, s[48:51], s61 offen offset:0 nt
    s_add_u32 s61, s61, 11264
    v_add_f32 v31, s62, v31
    v_max3_f32 v160, v8, v9, v10
    v_max3_f32 v160, v160, v11, v12
    v_max3_f32 v160, v160, v13, v14
    v_max3_f32 v160, v160, v15, v16
    v_max3_f32 v160, v160, v17, v18
    v_max3_f32 v160, v160, v19, v20
    v_max3_f32 v160, v160, v21, v22
    v_max3_f32 v160, v160, v23, v24
    v_max3_f32 v160, v160, v25, v26
    v_max3_f32 v160, v160, v27, v28
    v_max3_f32 v160, v160, v29, v30
    v_max_f32 v160, v160, v31
    v_mov_b32 v161, v160
    s_nop 1
    v_permlane32_swap_b32 v160, v161
    v_max_f32 v160, v160, v161
    v_mov_b32 v161, v160
    s_nop 1
    v_permlane16_swap_b32 v160, v161
    v_max_f32 v160, v160, v161
    v_mul_f32 v160, s64, v160
    v_fma_f32 v8, v8, s64, -v160
    v_fma_f32 v9, v9, s64, -v160
    v_fma_f32 v10, v10, s64, -v160
    v_fma_f32 v11, v11, s64, -v160
    v_fma_f32 v12, v12, s64, -v160
    v_fma_f32 v13, v13, s64, -v160
    v_fma_f32 v14, v14, s64, -v160
    v_fma_f32 v15, v15, s64, -v160
    v_fma_f32 v16, v16, s64, -v160
    v_fma_f32 v17, v17, s64, -v160
    v_fma_f32 v18, v18, s64, -v160
    v_fma_f32 v19, v19, s64, -v160
    v_fma_f32 v20, v20, s64, -v160
    v_fma_f32 v21, v21, s64, -v160
    v_fma_f32 v22, v22, s64, -v160
    v_fma_f32 v23, v23, s64, -v160
    v_fma_f32 v24, v24, s64, -v160
    v_fma_f32 v25, v25, s64, -v160
    v_fma_f32 v26, v26, s64, -v160
    v_fma_f32 v27, v27, s64, -v160
    v_fma_f32 v28, v28, s64, -v160
    v_fma_f32 v29, v29, s64, -v160
    v_fma_f32 v30, v30, s64, -v160
    v_fma_f32 v31, v31, s64, -v160
    v_exp_f32 v8, v8
    v_exp_f32 v9, v9
    v_exp_f32 v10, v10
    v_exp_f32 v11, v11
    v_exp_f32 v12, v12
    v_exp_f32 v13, v13
    v_exp_f32 v14, v14
    v_exp_f32 v15, v15
    v_exp_f32 v16, v16
    v_exp_f32 v17, v17
    v_exp_f32 v18, v18
    v_exp_f32 v19, v19
    v_exp_f32 v20, v20
    v_exp_f32 v21, v21
    v_exp_f32 v22, v22
    v_exp_f32 v23, v23
    v_exp_f32 v24, v24
    v_exp_f32 v25, v25
    v_exp_f32 v26, v26
    v_exp_f32 v27, v27
    v_exp_f32 v28, v28
    v_exp_f32 v29, v29
    v_exp_f32 v30, v30
    v_exp_f32 v31, v31
    s_waitcnt vmcnt(2)
    buffer_load_dwordx4 v[148:151], v6, s[48:51], s61 offen offset:0 nt
    s_add_u32 s61, s61, 11264
    v_add_f32 v162, v8, v9
    v_add_f32 v163, v10, v11
    v_add_f32 v162, v162, v12
    v_add_f32 v163, v163, v13
    v_add_f32 v162, v162, v14
    v_add_f32 v163, v163, v15
    v_add_f32 v162, v162, v16
    v_add_f32 v163, v163, v17
    v_add_f32 v162, v162, v18
    v_add_f32 v163, v163, v19
    v_add_f32 v162, v162, v20
    v_add_f32 v163, v163, v21
    v_add_f32 v162, v162, v22
    v_add_f32 v163, v163, v23
    v_add_f32 v162, v162, v24
    v_add_f32 v163, v163, v25
    v_add_f32 v162, v162, v26
    v_add_f32 v163, v163, v27
    v_add_f32 v162, v162, v28
    v_add_f32 v163, v163, v29
    v_add_f32 v162, v162, v30
    v_add_f32 v163, v163, v31
    v_add_f32 v162, v162, v163
    v_mov_b32 v163, v162
    s_nop 1
    v_permlane32_swap_b32 v162, v163
    v_add_f32 v162, v162, v163
    v_mov_b32 v163, v162
    s_nop 1
    v_permlane16_swap_b32 v162, v163
    v_add_f32 v161, v162, v163
    s_lshl_b32 s7, s3, 3
    s_add_u32 s7, s7, 0x24200
    v_mov_b32 v164, s7
    ds_write_b64 v164, v[160:161]
    v_mov_b32 v164, 0x24008
    v_mov_b32 v165, 1
    s_waitcnt lgkmcnt(0)
    s_mov_b64 exec, 1
    ds_add_u32 v164, v165
    s_mov_b64 exec, -1
    v_and_b32 v2, 15, v1
    v_lshlrev_b32 v2, 5, v2
    v_bfe_u32 v3, v1, 5, 1
    v_lshl_add_u32 v2, v3, 4, v2
    v_bfe_u32 v3, v1, 4, 1
    v_lshl_add_u32 v2, v3, 3, v2
    s_lshl_b32 s7, s3, 9
    s_add_u32 s7, s7, 0x10000
    v_add_u32 v2, s7, v2
    v_mov_b32 v3, 0x2400c
    v_mov_b32 v4, 1
    s_waitcnt vmcnt(2)
    buffer_load_dwordx4 v[32:35], v6, s[48:51], s61 offen offset:0 nt
    s_add_u32 s61, s61, 11264
    v_lshlrev_b32 v160, 16, v128
    v_and_b32 v161, 0xffff0000, v128
    v_lshlrev_b32 v162, 16, v129
    v_and_b32 v163, 0xffff0000, v129
    v_lshlrev_b32 v164, 16, v130
    v_and_b32 v165, 0xffff0000, v130
    v_lshlrev_b32 v166, 16, v131
    v_and_b32 v167, 0xffff0000, v131
    v_pk_mul_f32 v[152:153], v[160:161], v[8:9] op_sel_hi:[1,0]
    v_pk_mul_f32 v[154:155], v[162:163], v[8:9] op_sel_hi:[1,0]
    v_pk_mul_f32 v[156:157], v[164:165], v[8:9] op_sel_hi:[1,0]
    v_pk_mul_f32 v[158:159], v[166:167], v[8:9] op_sel_hi:[1,0]
    v_lshlrev_b32 v160, 16, v132
    v_and_b32 v161, 0xffff0000, v132
    v_lshlrev_b32 v162, 16, v133
    v_and_b32 v163, 0xffff0000, v133
    v_lshlrev_b32 v164, 16, v134
    v_and_b32 v165, 0xffff0000, v134
    v_lshlrev_b32 v166, 16, v135
    v_and_b32 v167, 0xffff0000, v135
    v_pk_fma_f32 v[152:153], v[160:161], v[8:9], v[152:153] op_sel:[0,1,0] op_sel_hi:[1,1,1]
    v_pk_fma_f32 v[154:155], v[162:163], v[8:9], v[154:155] op_sel:[0,1,0] op_sel_hi:[1,1,1]
    v_pk_fma_f32 v[156:157], v[164:165], v[8:9], v[156:157] op_sel:[0,1,0] op_sel_hi:[1,1,1]
    v_pk_fma_f32 v[158:159], v[166:167], v[8:9], v[158:159] op_sel:[0,1,0] op_sel_hi:[1,1,1]
    s_waitcnt vmcnt(2)
    buffer_load_dwordx4 v[36:39], v6, s[48:51], s61 offen offset:0 nt
    s_add_u32 s61, s61, 11264
    v_lshlrev_b32 v160, 16, v136
    v_and_b32 v161, 0xffff0000, v136
    v_lshlrev_b32 v162, 16, v137
    v_and_b32 v163, 0xffff0000, v137
    v_lshlrev_b32 v164, 16, v138
    v_and_b32 v165, 0xffff0000, v138
    v_lshlrev_b32 v166, 16, v139
    v_and_b32 v167, 0xffff0000, v139
    v_pk_fma_f32 v[152:153], v[160:161], v[10:11], v[152:153] op_sel_hi:[1,0,1]
    v_pk_fma_f32 v[154:155], v[162:163], v[10:11], v[154:155] op_sel_hi:[1,0,1]
    v_pk_fma_f32 v[156:157], v[164:165], v[10:11], v[156:157] op_sel_hi:[1,0,1]
    v_pk_fma_f32 v[158:159], v[166:167], v[10:11], v[158:159] op_sel_hi:[1,0,1]
    v_lshlrev_b32 v160, 16, v140
    v_and_b32 v161, 0xffff0000, v140
    v_lshlrev_b32 v162, 16, v141
    v_and_b32 v163, 0xffff0000, v141
    v_lshlrev_b32 v164, 16, v142
    v_and_b32 v165, 0xffff0000, v142
    v_lshlrev_b32 v166, 16, v143
    v_and_b32 v167, 0xffff0000, v143
    v_pk_fma_f32 v[152:153], v[160:161], v[10:11], v[152:153] op_sel:[0,1,0] op_sel_hi:[1,1,1]
    v_pk_fma_f32 v[154:155], v[162:163], v[10:11], v[154:155] op_sel:[0,1,0] op_sel_hi:[1,1,1]
    v_pk_fma_f32 v[156:157], v[164:165], v[10:11], v[156:157] op_sel:[0,1,0] op_sel_hi:[1,1,1]
    v_pk_fma_f32 v[158:159], v[166:167], v[10:11], v[158:159] op_sel:[0,1,0] op_sel_hi:[1,1,1]
    s_waitcnt vmcnt(2)
    buffer_load_dwordx4 v[40:43], v6, s[48:51], s61 offen offset:0 nt
    s_add_u32 s61, s61, 11264
    v_lshlrev_b32 v160, 16, v144
    v_and_b32 v161, 0xffff0000, v144
    v_lshlrev_b32 v162, 16, v145
    v_and_b32 v163, 0xffff0000, v145
    v_lshlrev_b32 v164, 16, v146
    v_and_b32 v165, 0xffff0000, v146
    v_lshlrev_b32 v166, 16, v147
    v_and_b32 v167, 0xffff0000, v147
    v_pk_fma_f32 v[152:153], v[160:161], v[12:13], v[152:153] op_sel_hi:[1,0,1]
    v_pk_fma_f32 v[154:155], v[162:163], v[12:13], v[154:155] op_sel_hi:[1,0,1]
    v_pk_fma_f32 v[156:157], v[164:165], v[12:13], v[156:157] op_sel_hi:[1,0,1]
    v_pk_fma_f32 v[158:159], v[166:167], v[12:13], v[158:159] op_sel_hi:[1,0,1]
    v_lshlrev_b32 v160, 16, v148
    v_and_b32 v161, 0xffff0000, v148
    v_lshlrev_b32 v162, 16, v149
    v_and_b32 v163, 0xffff0000, v149
    v_lshlrev_b32 v164, 16, v150
    v_and_b32 v165, 0xffff0000, v150
    v_lshlrev_b32 v166, 16, v151
    v_and_b32 v167, 0xffff0000, v151
    v_pk_fma_f32 v[152:153], v[160:161], v[12:13], v[152:153] op_sel:[0,1,0] op_sel_hi:[1,1,1]
    v_pk_fma_f32 v[154:155], v[162:163], v[12:13], v[154:155] op_sel:[0,1,0] op_sel_hi:[1,1,1]
    v_pk_fma_f32 v[156:157], v[164:165], v[12:13], v[156:157] op_sel:[0,1,0] op_sel_hi:[1,1,1]
    v_pk_fma_f32 v[158:159], v[166:167], v[12:13], v[158:159] op_sel:[0,1,0] op_sel_hi:[1,1,1]
    s_waitcnt vmcnt(2)
    buffer_load_dwordx4 v[44:47], v6, s[48:51], s61 offen offset:0 nt
    s_add_u32 s61, s61, 11264
    v_lshlrev_b32 v160, 16, v32
    v_and_b32 v161, 0xffff0000, v32
    v_lshlrev_b32 v162, 16, v33
    v_and_b32 v163, 0xffff0000, v33
    v_lshlrev_b32 v164, 16, v34
    v_and_b32 v165, 0xffff0000, v34
    v_lshlrev_b32 v166, 16, v35
    v_and_b32 v167, 0xffff0000, v35
    v_pk_fma_f32 v[152:153], v[160:161], v[14:15], v[152:153] op_sel_hi:[1,0,1]
    v_pk_fma_f32 v[154:155], v[162:163], v[14:15], v[154:155] op_sel_hi:[1,0,1]
    v_pk_fma_f32 v[156:157], v[164:165], v[14:15], v[156:157] op_sel_hi:[1,0,1]
    v_pk_fma_f32 v[158:159], v[166:167], v[14:15], v[158:159] op_sel_hi:[1,0,1]
    s_waitcnt vmcnt(2)
    buffer_load_dwordx4 v[48:51], v6, s[48:51], s61 offen offset:0 nt
    s_add_u32 s61, s61, 11264
    v_lshlrev_b32 v160, 16, v36
    v_and_b32 v161, 0xffff0000, v36
    v_lshlrev_b32 v162, 16, v37
    v_and_b32 v163, 0xffff0000, v37
    v_lshlrev_b32 v164, 16, v38
    v_and_b32 v165, 0xffff0000, v38
    v_lshlrev_b32 v166, 16, v39
    v_and_b32 v167, 0xffff0000, v39
    v_pk_fma_f32 v[152:153], v[160:161], v[14:15], v[152:153] op_sel:[0,1,0] op_sel_hi:[1,1,1]
    v_pk_fma_f32 v[154:155], v[162:163], v[14:15], v[154:155] op_sel:[0,1,0] op_sel_hi:[1,1,1]
    v_pk_fma_f32 v[156:157], v[164:165], v[14:15], v[156:157] op_sel:[0,1,0] op_sel_hi:[1,1,1]
    v_pk_fma_f32 v[158:159], v[166:167], v[14:15], v[158:159] op_sel:[0,1,0] op_sel_hi:[1,1,1]
    s_waitcnt vmcnt(2)
    buffer_load_dwordx4 v[52:55], v6, s[48:51], s61 offen offset:0 nt
    s_add_u32 s61, s61, 11264
    v_lshlrev_b32 v160, 16, v40
    v_and_b32 v161, 0xffff0000, v40
    v_lshlrev_b32 v162, 16, v41
    v_and_b32 v163, 0xffff0000, v41
    v_lshlrev_b32 v164, 16, v42
    v_and_b32 v165, 0xffff0000, v42
    v_lshlrev_b32 v166, 16, v43
    v_and_b32 v167, 0xffff0000, v43
    v_pk_fma_f32 v[152:153], v[160:161], v[16:17], v[152:153] op_sel_hi:[1,0,1]
    v_pk_fma_f32 v[154:155], v[162:163], v[16:17], v[154:155] op_sel_hi:[1,0,1]
    v_pk_fma_f32 v[156:157], v[164:165], v[16:17], v[156:157] op_sel_hi:[1,0,1]
    v_pk_fma_f32 v[158:159], v[166:167], v[16:17], v[158:159] op_sel_hi:[1,0,1]
    s_waitcnt vmcnt(2)
    buffer_load_dwordx4 v[56:59], v6, s[48:51], s61 offen offset:0 nt
    s_add_u32 s61, s61, 11264
    v_lshlrev_b32 v160, 16, v44
    v_and_b32 v161, 0xffff0000, v44
    v_lshlrev_b32 v162, 16, v45
    v_and_b32 v163, 0xffff0000, v45
    v_lshlrev_b32 v164, 16, v46
    v_and_b32 v165, 0xffff0000, v46
    v_lshlrev_b32 v166, 16, v47
    v_and_b32 v167, 0xffff0000, v47
    v_pk_fma_f32 v[152:153], v[160:161], v[16:17], v[152:153] op_sel:[0,1,0] op_sel_hi:[1,1,1]
    v_pk_fma_f32 v[154:155], v[162:163], v[16:17], v[154:155] op_sel:[0,1,0] op_sel_hi:[1,1,1]
    v_pk_fma_f32 v[156:157], v[164:165], v[16:17], v[156:157] op_sel:[0,1,0] op_sel_hi:[1,1,1]
    v_pk_fma_f32 v[158:159], v[166:167], v[16:17], v[158:159] op_sel:[0,1,0] op_sel_hi:[1,1,1]
    s_waitcnt vmcnt(2)
    buffer_load_dwordx4 v[60:63], v6, s[48:51], s61 offen offset:0 nt
    s_add_u32 s61, s61, 11264
    v_lshlrev_b32 v160, 16, v48
    v_and_b32 v161, 0xffff0000, v48
    v_lshlrev_b32 v162, 16, v49
    v_and_b32 v163, 0xffff0000, v49
    v_lshlrev_b32 v164, 16, v50
    v_and_b32 v165, 0xffff0000, v50
    v_lshlrev_b32 v166, 16, v51
    v_and_b32 v167, 0xffff0000, v51
    v_pk_fma_f32 v[152:153], v[160:161], v[18:19], v[152:153] op_sel_hi:[1,0,1]
    v_pk_fma_f32 v[154:155], v[162:163], v[18:19], v[154:155] op_sel_hi:[1,0,1]
    v_pk_fma_f32 v[156:157], v[164:165], v[18:19], v[156:157] op_sel_hi:[1,0,1]
    v_pk_fma_f32 v[158:159], v[166:167], v[18:19], v[158:159] op_sel_hi:[1,0,1]
    s_waitcnt vmcnt(2)
    buffer_load_dwordx4 v[64:67], v6, s[48:51], s61 offen offset:0 nt
    s_add_u32 s61, s61, 11264
    v_lshlrev_b32 v160, 16, v52
    v_and_b32 v161, 0xffff0000, v52
    v_lshlrev_b32 v162, 16, v53
    v_and_b32 v163, 0xffff0000, v53
    v_lshlrev_b32 v164, 16, v54
    v_and_b32 v165, 0xffff0000, v54
    v_lshlrev_b32 v166, 16, v55
    v_and_b32 v167, 0xffff0000, v55
    v_pk_fma_f32 v[152:153], v[160:161], v[18:19], v[152:153] op_sel:[0,1,0] op_sel_hi:[1,1,1]
    v_pk_fma_f32 v[154:155], v[162:163], v[18:19], v[154:155] op_sel:[0,1,0] op_sel_hi:[1,1,1]
    v_pk_fma_f32 v[156:157], v[164:165], v[18:19], v[156:157] op_sel:[0,1,0] op_sel_hi:[1,1,1]
    v_pk_fma_f32 v[158:159], v[166:167], v[18:19], v[158:159] op_sel:[0,1,0] op_sel_hi:[1,1,1]
    s_waitcnt vmcnt(2)
    buffer_load_dwordx4 v[68:71], v6, s[48:51], s61 offen offset:0 nt
    s_add_u32 s61, s61, 11264
    v_lshlrev_b32 v160, 16, v56
    v_and_b32 v161, 0xffff0000, v56
    v_lshlrev_b32 v162, 16, v57
    v_and_b32 v163, 0xffff0000, v57
    v_lshlrev_b32 v164, 16, v58
    v_and_b32 v165, 0xffff0000, v58
    v_lshlrev_b32 v166, 16, v59
    v_and_b32 v167, 0xffff0000, v59
    v_pk_fma_f32 v[152:153], v[160:161], v[20:21], v[152:153] op_sel_hi:[1,0,1]
    v_pk_fma_f32 v[154:155], v[162:163], v[20:21], v[154:155] op_sel_hi:[1,0,1]
    v_pk_fma_f32 v[156:157], v[164:165], v[20:21], v[156:157] op_sel_hi:[1,0,1]
    v_pk_fma_f32 v[158:159], v[166:167], v[20:21], v[158:159] op_sel_hi:[1,0,1]
    s_waitcnt vmcnt(2)
    buffer_load_dwordx4 v[72:75], v6, s[48:51], s61 offen offset:0 nt
    s_add_u32 s61, s61, 11264
    v_lshlrev_b32 v160, 16, v60
    v_and_b32 v161, 0xffff0000, v60
    v_lshlrev_b32 v162, 16, v61
    v_and_b32 v163, 0xffff0000, v61
    v_lshlrev_b32 v164, 16, v62
    v_and_b32 v165, 0xffff0000, v62
    v_lshlrev_b32 v166, 16, v63
    v_and_b32 v167, 0xffff0000, v63
    v_pk_fma_f32 v[152:153], v[160:161], v[20:21], v[152:153] op_sel:[0,1,0] op_sel_hi:[1,1,1]
    v_pk_fma_f32 v[154:155], v[162:163], v[20:21], v[154:155] op_sel:[0,1,0] op_sel_hi:[1,1,1]
    v_pk_fma_f32 v[156:157], v[164:165], v[20:21], v[156:157] op_sel:[0,1,0] op_sel_hi:[1,1,1]
    v_pk_fma_f32 v[158:159], v[166:167], v[20:21], v[158:159] op_sel:[0,1,0] op_sel_hi:[1,1,1]
    s_waitcnt vmcnt(2)
    buffer_load_dwordx4 v[76:79], v6, s[48:51], s61 offen offset:0 nt
    s_add_u32 s61, s61, 11264
    v_lshlrev_b32 v160, 16, v64
    v_and_b32 v161, 0xffff0000, v64
    v_lshlrev_b32 v162, 16, v65
    v_and_b32 v163, 0xffff0000, v65
    v_lshlrev_b32 v164, 16, v66
    v_and_b32 v165, 0xffff0000, v66
    v_lshlrev_b32 v166, 16, v67
    v_and_b32 v167, 0xffff0000, v67
    v_pk_fma_f32 v[152:153], v[160:161], v[22:23], v[152:153] op_sel_hi:[1,0,1]
    v_pk_fma_f32 v[154:155], v[162:163], v[22:23], v[154:155] op_sel_hi:[1,0,1]
    v_pk_fma_f32 v[156:157], v[164:165], v[22:23], v[156:157] op_sel_hi:[1,0,1]
    v_pk_fma_f32 v[158:159], v[166:167], v[22:23], v[158:159] op_sel_hi:[1,0,1]
    s_waitcnt vmcnt(2)
    buffer_load_dwordx4 v[80:83], v6, s[48:51], s61 offen offset:0 nt
    s_add_u32 s61, s61, 11264
    v_lshlrev_b32 v160, 16, v68
    v_and_b32 v161, 0xffff0000, v68
    v_lshlrev_b32 v162, 16, v69
    v_and_b32 v163, 0xffff0000, v69
    v_lshlrev_b32 v164, 16, v70
    v_and_b32 v165, 0xffff0000, v70
    v_lshlrev_b32 v166, 16, v71
    v_and_b32 v167, 0xffff0000, v71
    v_pk_fma_f32 v[152:153], v[160:161], v[22:23], v[152:153] op_sel:[0,1,0] op_sel_hi:[1,1,1]
    v_pk_fma_f32 v[154:155], v[162:163], v[22:23], v[154:155] op_sel:[0,1,0] op_sel_hi:[1,1,1]
    v_pk_fma_f32 v[156:157], v[164:165], v[22:23], v[156:157] op_sel:[0,1,0] op_sel_hi:[1,1,1]
    v_pk_fma_f32 v[158:159], v[166:167], v[22:23], v[158:159] op_sel:[0,1,0] op_sel_hi:[1,1,1]
    s_waitcnt vmcnt(2)
    buffer_load_dwordx4 v[84:87], v6, s[48:51], s61 offen offset:0 nt
    s_add_u32 s61, s61, 11264
    v_lshlrev_b32 v160, 16, v72
    v_and_b32 v161, 0xffff0000, v72
    v_lshlrev_b32 v162, 16, v73
    v_and_b32 v163, 0xffff0000, v73
    v_lshlrev_b32 v164, 16, v74
    v_and_b32 v165, 0xffff0000, v74
    v_lshlrev_b32 v166, 16, v75
    v_and_b32 v167, 0xffff0000, v75
    v_pk_fma_f32 v[152:153], v[160:161], v[24:25], v[152:153] op_sel_hi:[1,0,1]
    v_pk_fma_f32 v[154:155], v[162:163], v[24:25], v[154:155] op_sel_hi:[1,0,1]
    v_pk_fma_f32 v[156:157], v[164:165], v[24:25], v[156:157] op_sel_hi:[1,0,1]
    v_pk_fma_f32 v[158:159], v[166:167], v[24:25], v[158:159] op_sel_hi:[1,0,1]
    s_waitcnt vmcnt(2)
    buffer_load_dwordx4 v[88:91], v6, s[48:51], s61 offen offset:0 nt
    s_add_u32 s61, s61, 11264
    v_lshlrev_b32 v160, 16, v76
    v_and_b32 v161, 0xffff0000, v76
    v_lshlrev_b32 v162, 16, v77
    v_and_b32 v163, 0xffff0000, v77
    v_lshlrev_b32 v164, 16, v78
    v_and_b32 v165, 0xffff0000, v78
    v_lshlrev_b32 v166, 16, v79
    v_and_b32 v167, 0xffff0000, v79
    v_pk_fma_f32 v[152:153], v[160:161], v[24:25], v[152:153] op_sel:[0,1,0] op_sel_hi:[1,1,1]
    v_pk_fma_f32 v[154:155], v[162:163], v[24:25], v[154:155] op_sel:[0,1,0] op_sel_hi:[1,1,1]
    v_pk_fma_f32 v[156:157], v[164:165], v[24:25], v[156:157] op_sel:[0,1,0] op_sel_hi:[1,1,1]
    v_pk_fma_f32 v[158:159], v[166:167], v[24:25], v[158:159] op_sel:[0,1,0] op_sel_hi:[1,1,1]
    s_waitcnt vmcnt(2)
    buffer_load_dwordx4 v[92:95], v6, s[48:51], s61 offen offset:0 nt
    s_add_u32 s61, s61, 11264
    v_lshlrev_b32 v160, 16, v80
    v_and_b32 v161, 0xffff0000, v80
    v_lshlrev_b32 v162, 16, v81
    v_and_b32 v163, 0xffff0000, v81
    v_lshlrev_b32 v164, 16, v82
    v_and_b32 v165, 0xffff0000, v82
    v_lshlrev_b32 v166, 16, v83
    v_and_b32 v167, 0xffff0000, v83
    v_pk_fma_f32 v[152:153], v[160:161], v[26:27], v[152:153] op_sel_hi:[1,0,1]
    v_pk_fma_f32 v[154:155], v[162:163], v[26:27], v[154:155] op_sel_hi:[1,0,1]
    v_pk_fma_f32 v[156:157], v[164:165], v[26:27], v[156:157] op_sel_hi:[1,0,1]
    v_pk_fma_f32 v[158:159], v[166:167], v[26:27], v[158:159] op_sel_hi:[1,0,1]
    s_waitcnt vmcnt(2)
    buffer_load_dwordx4 v[96:99], v6, s[48:51], s61 offen offset:0 nt
    v_lshlrev_b32 v160, 16, v84
    v_and_b32 v161, 0xffff0000, v84
    v_lshlrev_b32 v162, 16, v85
    v_and_b32 v163, 0xffff0000, v85
    v_lshlrev_b32 v164, 16, v86
    v_and_b32 v165, 0xffff0000, v86
    v_lshlrev_b32 v166, 16, v87
    v_and_b32 v167, 0xffff0000, v87
    v_pk_fma_f32 v[152:153], v[160:161], v[26:27], v[152:153] op_sel:[0,1,0] op_sel_hi:[1,1,1]
    v_pk_fma_f32 v[154:155], v[162:163], v[26:27], v[154:155] op_sel:[0,1,0] op_sel_hi:[1,1,1]
    v_pk_fma_f32 v[156:157], v[164:165], v[26:27], v[156:157] op_sel:[0,1,0] op_sel_hi:[1,1,1]
    v_pk_fma_f32 v[158:159], v[166:167], v[26:27], v[158:159] op_sel:[0,1,0] op_sel_hi:[1,1,1]
    s_waitcnt vmcnt(2)
    buffer_load_dwordx4 v[100:103], v6, s[48:51], s63 offen offset:0 nt
    v_lshlrev_b32 v160, 16, v88
    v_and_b32 v161, 0xffff0000, v88
    v_lshlrev_b32 v162, 16, v89
    v_and_b32 v163, 0xffff0000, v89
    v_lshlrev_b32 v164, 16, v90
    v_and_b32 v165, 0xffff0000, v90
    v_lshlrev_b32 v166, 16, v91
    v_and_b32 v167, 0xffff0000, v91
    v_pk_fma_f32 v[152:153], v[160:161], v[28:29], v[152:153] op_sel_hi:[1,0,1]
    v_pk_fma_f32 v[154:155], v[162:163], v[28:29], v[154:155] op_sel_hi:[1,0,1]
    v_pk_fma_f32 v[156:157], v[164:165], v[28:29], v[156:157] op_sel_hi:[1,0,1]
    v_pk_fma_f32 v[158:159], v[166:167], v[28:29], v[158:159] op_sel_hi:[1,0,1]
    s_waitcnt vmcnt(2)
    v_lshlrev_b32 v160, 16, v92
    v_and_b32 v161, 0xffff0000, v92
    v_lshlrev_b32 v162, 16, v93
    v_and_b32 v163, 0xffff0000, v93
    v_lshlrev_b32 v164, 16, v94
    v_and_b32 v165, 0xffff0000, v94
    v_lshlrev_b32 v166, 16, v95
    v_and_b32 v167, 0xffff0000, v95
    v_pk_fma_f32 v[152:153], v[160:161], v[28:29], v[152:153] op_sel:[0,1,0] op_sel_hi:[1,1,1]
    v_pk_fma_f32 v[154:155], v[162:163], v[28:29], v[154:155] op_sel:[0,1,0] op_sel_hi:[1,1,1]
    v_pk_fma_f32 v[156:157], v[164:165], v[28:29], v[156:157] op_sel:[0,1,0] op_sel_hi:[1,1,1]
    v_pk_fma_f32 v[158:159], v[166:167], v[28:29], v[158:159] op_sel:[0,1,0] op_sel_hi:[1,1,1]
    s_waitcnt vmcnt(1)
    v_lshlrev_b32 v160, 16, v96
    v_and_b32 v161, 0xffff0000, v96
    v_lshlrev_b32 v162, 16, v97
    v_and_b32 v163, 0xffff0000, v97
    v_lshlrev_b32 v164, 16, v98
    v_and_b32 v165, 0xffff0000, v98
    v_lshlrev_b32 v166, 16, v99
    v_and_b32 v167, 0xffff0000, v99
    v_pk_fma_f32 v[152:153], v[160:161], v[30:31], v[152:153] op_sel_hi:[1,0,1]
    v_pk_fma_f32 v[154:155], v[162:163], v[30:31], v[154:155] op_sel_hi:[1,0,1]
    v_pk_fma_f32 v[156:157], v[164:165], v[30:31], v[156:157] op_sel_hi:[1,0,1]
    v_pk_fma_f32 v[158:159], v[166:167], v[30:31], v[158:159] op_sel_hi:[1,0,1]
    s_waitcnt vmcnt(0)
    v_lshlrev_b32 v160, 16, v100
    v_and_b32 v161, 0xffff0000, v100
    v_lshlrev_b32 v162, 16, v101
    v_and_b32 v163, 0xffff0000, v101
    v_lshlrev_b32 v164, 16, v102
    v_and_b32 v165, 0xffff0000, v102
    v_lshlrev_b32 v166, 16, v103
    v_and_b32 v167, 0xffff0000, v103
    v_pk_fma_f32 v[152:153], v[160:161], v[30:31], v[152:153] op_sel:[0,1,0] op_sel_hi:[1,1,1]
    v_pk_fma_f32 v[154:155], v[162:163], v[30:31], v[154:155] op_sel:[0,1,0] op_sel_hi:[1,1,1]
    v_pk_fma_f32 v[156:157], v[164:165], v[30:31], v[156:157] op_sel:[0,1,0] op_sel_hi:[1,1,1]
    v_pk_fma_f32 v[158:159], v[166:167], v[30:31], v[158:159] op_sel:[0,1,0] op_sel_hi:[1,1,1]
    s_nop 0
    v_permlane32_swap_b32 v152, v156
    v_permlane32_swap_b32 v153, v157
    v_permlane32_swap_b32 v154, v158
    v_permlane32_swap_b32 v155, v159
    v_add_f32 v152, v152, v156
    v_add_f32 v153, v153, v157
    v_add_f32 v154, v154, v158
    v_add_f32 v155, v155, v159
    s_nop 0
    v_permlane16_swap_b32 v152, v154
    v_permlane16_swap_b32 v153, v155
    v_add_f32 v152, v152, v154
    v_add_f32 v153, v153, v155
    ds_write_b64 v2, v[152:153]
    s_waitcnt lgkmcnt(0)
    s_mov_b64 exec, 1
    ds_add_u32 v3, v4
    s_mov_b64 exec, -1
    s_endpgm
L_ASVC:
    v_and_b32 v1, 63, v0
    s_and_b32 s7, s5, 3
    s_lshl_b32 s6, s4, 2
    s_add_u32 s6, s6, s7
    s_mov_b32 s92, 0x05040100
    s_mov_b32 s93, 0x07060302
    s_cmp_lg_u32 s3, 11
    s_cbranch_scc1 Z_9
    v_lshlrev_b32 v2, 2, v1
    v_add_u32 v2, 0x24000, v2
    v_mov_b32 v3, 0
    ds_write_b32 v2, v3
Z_9:
    s_waitcnt lgkmcnt(0)
    s_mov_b32 s36, s34
    s_and_b32 s37, s35, 0xffff
    s_mov_b32 s38, 0x1000000
    s_mov_b32 s39, 0x20000
    s_mov_b32 s40, s32
    s_and_b32 s41, s33, 0xffff
    s_mov_b32 s42, 0x100
    s_mov_b32 s43, 0x20000
    s_setprio 3
    s_lshr_b32 s60, s5, 2
    s_sub_u32 s60, s60, 4
    s_barrier
    s_lshl_b32 s7, s6, 2
    s_add_u32 s7, s7, s60
    s_lshl_b32 s7, s7, 11
    v_lshl_add_u32 v3, v1, 4, s7
    v_add_u32 v5, 0x40000, v3
    v_add_u32 v3, 0x80000, v3
    s_lshl_b32 s7, s6, 5
    s_add_u32 s7, s7, s60
    s_lshl_b32 s7, s7, 8
    s_add_u32 s7, s7, 0x80000
    v_lshrrev_b32 v6, 4, v1
    v_lshlrev_b32 v6, 11, v6
    v_and_b32 v100, 15, v1
    v_lshl_add_u32 v6, v100, 4, v6
    v_add_u32 v6, s7, v6
    s_sleep 8
    v_mov_b32 v90, 0
    s_mov_b32 s80, 200000
    s_mov_b64 exec, 1
    buffer_load_dwordx2 v[94:95], v90, s[40:43], 0 offen sc1
    s_sleep 16
    buffer_load_dwordx2 v[92:93], v90, s[40:43], 0 offen sc1
    s_mov_b64 exec, -1
    s_waitcnt vmcnt(1)
    v_readfirstlane_b32 s94, v94
    v_readfirstlane_b32 s95, v95
    s_cmp_lg_u32 s95, 0
    s_cbranch_scc1 NGD_11
    s_branch NG2_12
NG_10:
    s_mov_b64 exec, 1
    buffer_load_dwordx2 v[92:93], v90, s[40:43], 0 offen sc1
    s_mov_b64 exec, -1
NG2_12:
    s_waitcnt vmcnt(0)
    v_readfirstlane_b32 s94, v92
    v_readfirstlane_b32 s95, v93
    s_cmp_lg_u32 s95, 0
    s_cbranch_scc1 NGD_11
    s_sleep 4
    s_sub_u32 s80, s80, 1
    s_cmp_lg_u32 s80, 0
    s_cbranch_scc1 NG_10
NGD_11:
    v_lshlrev_b32 v7, 5, v1
    v_mov_b32 v114, s94
    v_mov_b32 v115, s95
    v_mov_b32 v118, s94
    v_mov_b32 v119, s95
    v_mov_b32 v122, s94
    v_mov_b32 v123, s95
    v_mov_b32 v126, s94
    v_mov_b32 v127, s95
    v_mov_b32 v100, 0x24044
    s_mov_b32 s80, 1600000
LW_13:
    ds_read_b32 v101, v100
    s_waitcnt lgkmcnt(0)
    v_readfirstlane_b32 s79, v101
    s_cmp_ge_u32 s79, 4
    s_cbranch_scc1 LWD_14
    s_sub_u32 s80, s80, 1
    s_cmp_lg_u32 s80, 0
    s_cbranch_scc1 LW_13
LWD_14:
    ds_read_b128 v[16:19], v7 offset:0
    ds_read_b128 v[20:23], v7 offset:16
    ds_read_b128 v[24:27], v7 offset:2048
    ds_read_b128 v[28:31], v7 offset:2064
    ds_read_b128 v[32:35], v7 offset:4096
    ds_read_b128 v[36:39], v7 offset:4112
    ds_read_b128 v[40:43], v7 offset:6144
    ds_read_b128 v[44:47], v7 offset:6160
    s_waitcnt lgkmcnt(0)
    v_pk_add_f32 v[16:17], v[16:17], v[32:33]
    v_pk_add_f32 v[18:19], v[18:19], v[34:35]
    v_pk_add_f32 v[20:21], v[20:21], v[36:37]
    v_pk_add_f32 v[22:23], v[22:23], v[38:39]
    v_pk_add_f32 v[24:25], v[24:25], v[40:41]
    v_pk_add_f32 v[26:27], v[26:27], v[42:43]
    v_pk_add_f32 v[28:29], v[28:29], v[44:45]
    v_pk_add_f32 v[30:31], v[30:31], v[46:47]
    v_pk_add_f32 v[16:17], v[16:17], v[24:25]
    v_pk_add_f32 v[18:19], v[18:19], v[26:27]
    v_pk_add_f32 v[20:21], v[20:21], v[28:29]
    v_pk_add_f32 v[22:23], v[22:23], v[30:31]
    v_cvt_pk_bf16_f32 v112, v16, v17
    v_cvt_pk_bf16_f32 v113, v18, v19
    v_cvt_pk_bf16_f32 v116, v20, v21
    v_cvt_pk_bf16_f32 v117, v22, v23
    buffer_store_dwordx4 v[112:115], v5, s[36:39], 0 offen offset:0
    buffer_store_dwordx4 v[116:119], v5, s[36:39], 0 offen offset:1024
    v_mov_b32 v100, 0x24018
    v_mov_b32 v101, 1
    s_waitcnt lgkmcnt(0)
    s_mov_b64 exec, 1
    ds_add_u32 v100, v101
    s_mov_b64 exec, -1
    v_mov_b32 v100, 0x24040
    s_mov_b32 s80, 1600000
LW_15:
    ds_read_b32 v101, v100
    s_waitcnt lgkmcnt(0)
    v_readfirstlane_b32 s79, v101
    s_cmp_ge_u32 s79, 4
    s_cbranch_scc1 LWD_16
    s_sub_u32 s80, s80, 1
    s_cmp_lg_u32 s80, 0
    s_cbranch_scc1 LW_15
LWD_16:
    ds_read_b128 v[16:19], v7 offset:8192
    ds_read_b128 v[20:23], v7 offset:8208
    ds_read_b128 v[24:27], v7 offset:10240
    ds_read_b128 v[28:31], v7 offset:10256
    ds_read_b128 v[32:35], v7 offset:12288
    ds_read_b128 v[36:39], v7 offset:12304
    ds_read_b128 v[40:43], v7 offset:14336
    ds_read_b128 v[44:47], v7 offset:14352
    s_waitcnt lgkmcnt(0)
    v_pk_add_f32 v[16:17], v[16:17], v[32:33]
    v_pk_add_f32 v[18:19], v[18:19], v[34:35]
    v_pk_add_f32 v[20:21], v[20:21], v[36:37]
    v_pk_add_f32 v[22:23], v[22:23], v[38:39]
    v_pk_add_f32 v[24:25], v[24:25], v[40:41]
    v_pk_add_f32 v[26:27], v[26:27], v[42:43]
    v_pk_add_f32 v[28:29], v[28:29], v[44:45]
    v_pk_add_f32 v[30:31], v[30:31], v[46:47]
    v_pk_add_f32 v[16:17], v[16:17], v[24:25]
    v_pk_add_f32 v[18:19], v[18:19], v[26:27]
    v_pk_add_f32 v[20:21], v[20:21], v[28:29]
    v_pk_add_f32 v[22:23], v[22:23], v[30:31]
    v_cvt_pk_bf16_f32 v120, v16, v17
    v_cvt_pk_bf16_f32 v121, v18, v19
    v_cvt_pk_bf16_f32 v124, v20, v21
    v_cvt_pk_bf16_f32 v125, v22, v23
    buffer_store_dwordx4 v[120:123], v6, s[36:39], 0 offen offset:0
    buffer_store_dwordx4 v[124:127], v6, s[36:39], 0 offen offset:1024
    v_mov_b32 v100, 0x24018
    v_mov_b32 v101, 1
    s_waitcnt lgkmcnt(0)
    s_mov_b64 exec, 1
    ds_add_u32 v100, v101
    s_mov_b64 exec, -1
    v_mov_b32 v110, v5
    v_mov_b32 v111, v6
    s_getreg_b32 s96, hwreg(HW_REG_XCC_ID, 0, 4)
    s_lshl_b32 s7, s4, 5
    s_add_u32 s7, s7, s5
    s_lshl_b32 s7, s7, 4
    s_add_u32 s7, s7, 0xc0000
    v_mov_b32 v100, s7
    v_mov_b32 v102, s96
    v_mov_b32 v103, 0
    v_mov_b32 v104, s94
    v_mov_b32 v105, s95
    s_mov_b64 exec, 1
    buffer_store_dwordx4 v[102:105], v100, s[36:39], 0 offen
    s_mov_b64 exec, -1
    s_sleep 16
    buffer_load_dwordx4 v[32:35], v3, s[36:39], 0 offen offset:0 sc1
    buffer_load_dwordx4 v[36:39], v3, s[36:39], 0 offen offset:1024 sc1
    s_mov_b32 s80, 200000
PS_17:
    s_waitcnt vmcnt(0)
    s_mov_b32 s78, 0
    v_cmp_ne_u64 vcc, s[94:95], v[34:35]
    s_cbranch_vccz PSS_19
    buffer_load_dwordx4 v[32:35], v3, s[36:39], 0 offen offset:0 sc1
    s_mov_b32 s78, 1
PSS_19:
    v_cmp_ne_u64 vcc, s[94:95], v[38:39]
    s_cbranch_vccz PSS_20
    buffer_load_dwordx4 v[36:39], v3, s[36:39], 0 offen offset:1024 sc1
    s_mov_b32 s78, 1
PSS_20:
    s_cmp_eq_u32 s78, 0
    s_cbranch_scc1 PSD_18
    s_sleep 8
    s_cmp_lg_u32 s80, 199984
    s_cbranch_scc1 PSL_21
    buffer_store_dwordx4 v[112:115], v110, s[36:39], 0 offen offset:0 sc1
    buffer_store_dwordx4 v[116:119], v110, s[36:39], 0 offen offset:1024 sc1
    buffer_store_dwordx4 v[120:123], v111, s[36:39], 0 offen offset:0 sc1
    buffer_store_dwordx4 v[124:127], v111, s[36:39], 0 offen offset:1024 sc1
PSL_21:
    s_sub_u32 s80, s80, 1
    s_cmp_lg_u32 s80, 0
    s_cbranch_scc1 PS_17
    s_waitcnt vmcnt(0)
PSD_18:
    v_lshlrev_b32 v16, 16, v32
    v_and_b32 v17, 0xffff0000, v32
    v_lshlrev_b32 v18, 16, v33
    v_and_b32 v19, 0xffff0000, v33
    v_lshlrev_b32 v20, 16, v36
    v_and_b32 v21, 0xffff0000, v36
    v_lshlrev_b32 v22, 16, v37
    v_and_b32 v23, 0xffff0000, v37
    v_mov_b32 v24, v16
    v_mov_b32 v25, v17
    v_mov_b32 v26, v18
    v_mov_b32 v27, v19
    v_mov_b32 v28, v20
    v_mov_b32 v29, v21
    v_mov_b32 v30, v22
    v_mov_b32 v31, v23
    v_permlane32_swap_b32 v16, v24
    v_permlane32_swap_b32 v17, v25
    v_permlane32_swap_b32 v18, v26
    v_permlane32_swap_b32 v19, v27
    v_permlane32_swap_b32 v20, v28
    v_permlane32_swap_b32 v21, v29
    v_permlane32_swap_b32 v22, v30
    v_permlane32_swap_b32 v23, v31
    v_add_f32 v16, v16, v24
    v_add_f32 v17, v17, v25
    v_add_f32 v18, v18, v26
    v_add_f32 v19, v19, v27
    v_add_f32 v20, v20, v28
    v_add_f32 v21, v21, v29
    v_add_f32 v22, v22, v30
    v_add_f32 v23, v23, v31
    v_mov_b32 v24, v16
    v_mov_b32 v25, v17
    v_mov_b32 v26, v18
    v_mov_b32 v27, v19
    v_mov_b32 v28, v20
    v_mov_b32 v29, v21
    v_mov_b32 v30, v22
    v_mov_b32 v31, v23
    v_permlane16_swap_b32 v16, v24
    v_permlane16_swap_b32 v17, v25
    v_permlane16_swap_b32 v18, v26
    v_permlane16_swap_b32 v19, v27
    v_permlane16_swap_b32 v20, v28
    v_permlane16_swap_b32 v21, v29
    v_permlane16_swap_b32 v22, v30
    v_permlane16_swap_b32 v23, v31
    v_add_f32 v16, v16, v24
    v_add_f32 v17, v17, v25
    v_add_f32 v18, v18, v26
    v_add_f32 v19, v19, v27
    v_add_f32 v20, v20, v28
    v_add_f32 v21, v21, v29
    v_add_f32 v22, v22, v30
    v_add_f32 v23, v23, v31
    v_cvt_pk_bf16_f32 v8, v16, v17
    v_cvt_pk_bf16_f32 v9, v18, v19
    v_cvt_pk_bf16_f32 v10, v20, v21
    v_cvt_pk_bf16_f32 v11, v22, v23
    v_and_b32 v100, 15, v1
    v_lshlrev_b32 v100, 4, v100
    v_add_u32 v100, 0x24100, v100
    ds_write_b128 v100, v[8:11]
L_ACUT:
    v_mov_b32 v100, 0x24004
    v_mov_b32 v101, 1
    s_waitcnt lgkmcnt(0)
    s_mov_b64 exec, 1
    ds_add_u32 v100, v101
    s_mov_b64 exec, -1
    v_mov_b32 v100, 0x24008
    s_mov_b32 s80, 1600000
LW_22:
    ds_read_b32 v101, v100
    s_waitcnt lgkmcnt(0)
    v_readfirstlane_b32 s79, v101
    s_cmp_ge_u32 s79, 11
    s_cbranch_scc1 LWD_23
    s_sleep 8
    s_sub_u32 s80, s80, 1
    s_cmp_lg_u32 s80, 0
    s_cbranch_scc1 LW_22
LWD_23:
    v_and_b32 v100, 31, v1
    s_lshl_b32 s7, s4, 9
    s_add_u32 s7, s7, 0xc0000
    v_lshl_add_u32 v100, v100, 4, s7
    buffer_load_dwordx4 v[32:35], v100, s[36:39], 0 offen sc1
    s_waitcnt vmcnt(0)
    v_cmp_ne_u64 vcc, s[94:95], v[34:35]
    v_cmp_ne_u32 s[86:87], s96, v32
    s_or_b32 s97, vcc_lo, s86
    s_and_b32 s97, s97, 0xffff00ff
    s_cbranch_scc0 AF_24
    buffer_store_dwordx4 v[112:115], v110, s[36:39], 0 offen offset:0 sc1
    buffer_store_dwordx4 v[116:119], v110, s[36:39], 0 offen offset:1024 sc1
    buffer_store_dwordx4 v[120:123], v111, s[36:39], 0 offen offset:0 sc1
    buffer_store_dwordx4 v[124:127], v111, s[36:39], 0 offen offset:1024 sc1
AF_24:
    v_mov_b32 v100, 0x24200
    ds_read_b128 v[8:11], v100 offset:0
    ds_read_b128 v[12:15], v100 offset:16
    ds_read_b128 v[16:19], v100 offset:32
    ds_read_b128 v[20:23], v100 offset:48
    ds_read_b128 v[24:27], v100 offset:64
    ds_read_b128 v[28:31], v100 offset:80
    s_waitcnt lgkmcnt(0)
    v_max3_f32 v100, v8, v10, v12
    v_max3_f32 v100, v100, v14, v16
    v_max3_f32 v100, v100, v18, v20
    v_max3_f32 v100, v100, v22, v24
    v_max3_f32 v100, v100, v26, v28
    v_sub_f32 v8, v8, v100
    v_sub_f32 v10, v10, v100
    v_sub_f32 v12, v12, v100
    v_sub_f32 v14, v14, v100
    v_sub_f32 v16, v16, v100
    v_sub_f32 v18, v18, v100
    v_sub_f32 v20, v20, v100
    v_sub_f32 v22, v22, v100
    v_sub_f32 v24, v24, v100
    v_sub_f32 v26, v26, v100
    v_sub_f32 v28, v28, v100
    v_exp_f32 v8, v8
    v_exp_f32 v10, v10
    v_exp_f32 v12, v12
    v_exp_f32 v14, v14
    v_exp_f32 v16, v16
    v_exp_f32 v18, v18
    v_exp_f32 v20, v20
    v_exp_f32 v22, v22
    v_exp_f32 v24, v24
    v_exp_f32 v26, v26
    v_exp_f32 v28, v28
    v_mul_f32 v101, v8, v9
    v_fmac_f32 v101, v10, v11
    v_fmac_f32 v101, v12, v13
    v_fmac_f32 v101, v14, v15
    v_fmac_f32 v101, v16, v17
    v_fmac_f32 v101, v18, v19
    v_fmac_f32 v101, v20, v21
    v_fmac_f32 v101, v22, v23
    v_fmac_f32 v101, v24, v25
    v_fmac_f32 v101, v26, v27
    v_fmac_f32 v101, v28, v29
    v_rcp_f32 v101, v101
    s_nop 0
    v_mul_f32 v8, v8, v101
    v_mul_f32 v10, v10, v101
    v_mul_f32 v12, v12, v101
    v_mul_f32 v14, v14, v101
    v_mul_f32 v16, v16, v101
    v_mul_f32 v18, v18, v101
    v_mul_f32 v20, v20, v101
    v_mul_f32 v22, v22, v101
    v_mul_f32 v24, v24, v101
    v_mul_f32 v26, v26, v101
    v_mul_f32 v28, v28, v101
    v_and_b32 v100, 15, v1
    v_bfe_u32 v101, v1, 4, 1
    v_lshlrev_b32 v3, 5, v100
    v_lshl_add_u32 v3, v101, 4, v3
    v_add_u32 v3, 0x10000, v3
    s_lshl_b32 s7, s6, 3
    s_add_u32 s7, s7, s60
    s_lshl_b32 s7, s7, 8
    s_add_u32 s7, s7, 0xd0000
    v_lshlrev_b32 v2, 4, v100
    v_lshl_add_u32 v2, v101, 10, v2
    v_add_u32 v2, s7, v2
    v_mov_b32 v6, s94
    v_mov_b32 v7, s95
    v_mov_b32 v100, 0x2400c
    s_mov_b32 s80, 1600000
LW_25:
    ds_read_b32 v101, v100
    s_waitcnt lgkmcnt(0)
    v_readfirstlane_b32 s79, v101
    s_cmp_ge_u32 s79, 11
    s_cbranch_scc1 LWD_26
    s_sub_u32 s80, s80, 1
    s_cmp_lg_u32 s80, 0
    s_cbranch_scc1 LW_25
LWD_26:
    ds_read_b128 v[40:43], v3 offset:0
    ds_read_b128 v[44:47], v3 offset:512
    ds_read_b128 v[48:51], v3 offset:1024
    ds_read_b128 v[52:55], v3 offset:1536
    ds_read_b128 v[56:59], v3 offset:2048
    ds_read_b128 v[60:63], v3 offset:2560
    ds_read_b128 v[64:67], v3 offset:3072
    ds_read_b128 v[68:71], v3 offset:3584
    ds_read_b128 v[72:75], v3 offset:4096
    ds_read_b128 v[76:79], v3 offset:4608
    ds_read_b128 v[80:83], v3 offset:5120
    s_waitcnt lgkmcnt(10)
    v_pk_mul_f32 v[32:33], v[40:41], v[8:9] op_sel_hi:[1,0]
    v_pk_mul_f32 v[34:35], v[42:43], v[8:9] op_sel_hi:[1,0]
    s_waitcnt lgkmcnt(9)
    v_pk_mul_f32 v[36:37], v[44:45], v[10:11] op_sel_hi:[1,0]
    v_pk_mul_f32 v[38:39], v[46:47], v[10:11] op_sel_hi:[1,0]
    s_waitcnt lgkmcnt(8)
    v_pk_fma_f32 v[32:33], v[48:49], v[12:13], v[32:33] op_sel_hi:[1,0,1]
    v_pk_fma_f32 v[34:35], v[50:51], v[12:13], v[34:35] op_sel_hi:[1,0,1]
    s_waitcnt lgkmcnt(7)
    v_pk_fma_f32 v[36:37], v[52:53], v[14:15], v[36:37] op_sel_hi:[1,0,1]
    v_pk_fma_f32 v[38:39], v[54:55], v[14:15], v[38:39] op_sel_hi:[1,0,1]
    s_waitcnt lgkmcnt(6)
    v_pk_fma_f32 v[32:33], v[56:57], v[16:17], v[32:33] op_sel_hi:[1,0,1]
    v_pk_fma_f32 v[34:35], v[58:59], v[16:17], v[34:35] op_sel_hi:[1,0,1]
    s_waitcnt lgkmcnt(5)
    v_pk_fma_f32 v[36:37], v[60:61], v[18:19], v[36:37] op_sel_hi:[1,0,1]
    v_pk_fma_f32 v[38:39], v[62:63], v[18:19], v[38:39] op_sel_hi:[1,0,1]
    s_waitcnt lgkmcnt(4)
    v_pk_fma_f32 v[32:33], v[64:65], v[20:21], v[32:33] op_sel_hi:[1,0,1]
    v_pk_fma_f32 v[34:35], v[66:67], v[20:21], v[34:35] op_sel_hi:[1,0,1]
    s_waitcnt lgkmcnt(3)
    v_pk_fma_f32 v[36:37], v[68:69], v[22:23], v[36:37] op_sel_hi:[1,0,1]
    v_pk_fma_f32 v[38:39], v[70:71], v[22:23], v[38:39] op_sel_hi:[1,0,1]
    s_waitcnt lgkmcnt(2)
    v_pk_fma_f32 v[32:33], v[72:73], v[24:25], v[32:33] op_sel_hi:[1,0,1]
    v_pk_fma_f32 v[34:35], v[74:75], v[24:25], v[34:35] op_sel_hi:[1,0,1]
    s_waitcnt lgkmcnt(1)
    v_pk_fma_f32 v[36:37], v[76:77], v[26:27], v[36:37] op_sel_hi:[1,0,1]
    v_pk_fma_f32 v[38:39], v[78:79], v[26:27], v[38:39] op_sel_hi:[1,0,1]
    s_waitcnt lgkmcnt(0)
    v_pk_fma_f32 v[32:33], v[80:81], v[28:29], v[32:33] op_sel_hi:[1,0,1]
    v_pk_fma_f32 v[34:35], v[82:83], v[28:29], v[34:35] op_sel_hi:[1,0,1]
    v_pk_add_f32 v[32:33], v[32:33], v[36:37]
    v_pk_add_f32 v[34:35], v[34:35], v[38:39]
    v_cvt_pk_bf16_f32 v4, v32, v33
    v_cvt_pk_bf16_f32 v5, v34, v35
    s_mov_b64 exec, 0xffffffff
    buffer_store_dwordx4 v[4:7], v2, s[36:39], 0 offen
    s_cmp_eq_u32 s97, 0
    s_cbranch_scc1 AF_27
    buffer_store_dwordx4 v[4:7], v2, s[36:39], 0 offen sc1
AF_27:
    s_mov_b64 exec, -1
    s_endpgm
L_W:
    v_and_b32 v1, 63, v0
    s_and_b32 s7, s5, 3
    s_lshl_b32 s6, s4, 2
    s_add_u32 s6, s6, s7
    s_mov_b32 s92, 0x05040100
    s_mov_b32 s93, 0x07060302
    s_waitcnt lgkmcnt(0)
    s_mov_b32 s36, s34
    s_and_b32 s37, s35, 0xffff
    s_mov_b32 s38, 0x1000000
    s_mov_b32 s39, 0x20000
    s_mov_b32 s40, s32
    s_and_b32 s41, s33, 0xffff
    s_mov_b32 s42, 0x100
    s_mov_b32 s43, 0x20000
    s_barrier
    s_cmp_ge_u32 s5, 4
    s_cbranch_scc1 L_PF
    v_mov_b32 v160, 0x24048
    s_mov_b32 s80, 1600000
LW_28:
    ds_read_b32 v161, v160
    s_waitcnt lgkmcnt(0)
    v_readfirstlane_b32 s79, v161
    s_cmp_ge_u32 s79, 4
    s_cbranch_scc1 LWD_29
    s_sleep 4
    s_sub_u32 s80, s80, 1
    s_cmp_lg_u32 s80, 0
    s_cbranch_scc1 LW_28
LWD_29:
    s_branch L_U1
L_PF:
    s_mov_b32 s44, s20
    s_and_b32 s45, s21, 0xffff
    s_mov_b32 s46, 0x1000000
    s_mov_b32 s47, 0x20000
    s_lshl_b32 s7, s4, 2
    s_add_u32 s7, s7, s5
    s_sub_u32 s7, s7, 4
    s_lshl_b32 s7, s7, 19
    s_lshl_b32 s60, s3, 10
    s_add_u32 s60, s60, s7
    s_add_u32 s60, s60, 196608
    s_add_u32 s61, s60, 0x40000
    v_lshlrev_b32 v2, 4, v1
    v_mov_b32 v160, 0x24048
    s_mov_b32 s80, 1600000
LW_30:
    ds_read_b32 v161, v160
    s_waitcnt lgkmcnt(0)
    v_readfirstlane_b32 s79, v161
    s_cmp_ge_u32 s79, 4
    s_cbranch_scc1 LWD_31
    s_sleep 4
    s_sub_u32 s80, s80, 1
    s_cmp_lg_u32 s80, 0
    s_cbranch_scc1 LW_30
LWD_31:
    s_mov_b32 s62, 16
PF_32:
    s_waitcnt vmcnt(7)
    buffer_load_dwordx4 v[4:7], v2, s[44:47], s60 offen
    s_add_u32 s60, s60, 4096
    s_waitcnt vmcnt(7)
    buffer_load_dwordx4 v[4:7], v2, s[44:47], s61 offen
    s_add_u32 s61, s61, 4096
    s_sub_u32 s62, s62, 1
    s_cmp_lg_u32 s62, 0
    s_cbranch_scc1 PF_32
    v_mov_b32 v160, 0x2405c
    v_mov_b32 v161, 1
    s_waitcnt lgkmcnt(0)
    s_mov_b64 exec, 1
    ds_add_u32 v160, v161
    s_mov_b64 exec, -1
    s_waitcnt vmcnt(0)
    s_branch L_END
L_W1:
    v_and_b32 v1, 63, v0
    s_and_b32 s7, s5, 3
    s_lshl_b32 s6, s4, 2
    s_add_u32 s6, s6, s7
    s_mov_b32 s92, 0x05040100
    s_mov_b32 s93, 0x07060302
    s_waitcnt lgkmcnt(0)
    s_mov_b32 s36, s34
    s_and_b32 s37, s35, 0xffff
    s_mov_b32 s38, 0x1000000
    s_mov_b32 s39, 0x20000
    s_mov_b32 s40, s32
    s_and_b32 s41, s33, 0xffff
    s_mov_b32 s42, 0x100
    s_mov_b32 s43, 0x20000
    s_setprio 3
    s_cmp_lg_u32 s3, 4
    s_cbranch_scc1 W4_33
    s_cmp_lg_u32 s2, 0
    s_cbranch_scc1 NM_34
    s_memrealtime s[94:95]
    v_mov_b32 v160, 0
    s_waitcnt lgkmcnt(0)
    s_or_b32 s95, s95, 0x80000000
    v_mov_b32 v162, s94
    v_mov_b32 v163, s95
    s_mov_b64 exec, 1
    buffer_store_dwordx2 v[162:163], v160, s[40:43], 0 offen sc1
    s_mov_b64 exec, -1
NM_34:
W4_33:
    s_barrier
    s_cmp_lg_u32 s3, 4
    s_cbranch_scc1 W4_35
    s_sleep 8
    v_mov_b32 v152, 0
    s_mov_b32 s80, 200000
    s_mov_b64 exec, 1
    buffer_load_dwordx2 v[156:157], v152, s[40:43], 0 offen sc1
    s_sleep 16
    buffer_load_dwordx2 v[154:155], v152, s[40:43], 0 offen sc1
    s_mov_b64 exec, -1
    s_waitcnt vmcnt(1)
    v_readfirstlane_b32 s94, v156
    v_readfirstlane_b32 s95, v157
    s_cmp_lg_u32 s95, 0
    s_cbranch_scc1 NGD_37
    s_branch NG2_38
NG_36:
    s_mov_b64 exec, 1
    buffer_load_dwordx2 v[154:155], v152, s[40:43], 0 offen sc1
    s_mov_b64 exec, -1
NG2_38:
    s_waitcnt vmcnt(0)
    v_readfirstlane_b32 s94, v154
    v_readfirstlane_b32 s95, v155
    s_cmp_lg_u32 s95, 0
    s_cbranch_scc1 NGD_37
    s_sleep 4
    s_sub_u32 s80, s80, 1
    s_cmp_lg_u32 s80, 0
    s_cbranch_scc1 NG_36
NGD_37:
    v_mov_b32 v160, 0x24050
    v_mov_b32 v162, s94
    v_mov_b32 v163, s95
    ds_write_b64 v160, v[162:163]
    v_mov_b32 v160, 0x2404c
    v_mov_b32 v161, 1
    s_waitcnt lgkmcnt(0)
    s_mov_b64 exec, 1
    ds_add_u32 v160, v161
    s_mov_b64 exec, -1
    s_getreg_b32 s96, hwreg(HW_REG_XCC_ID, 0, 4)
    s_lshl_b32 s7, s4, 5
    s_add_u32 s7, s7, s5
    s_lshl_b32 s7, s7, 4
    s_add_u32 s7, s7, 0xc0000
    v_mov_b32 v160, s7
    v_mov_b32 v162, s96
    v_mov_b32 v163, 0
    v_mov_b32 v164, s94
    v_mov_b32 v165, s95
    s_mov_b64 exec, 1
    buffer_store_dwordx4 v[162:165], v160, s[36:39], 0 offen
    s_mov_b64 exec, -1
W4_35:
    s_sub_u32 s62, s3, 4
    s_lshl_b32 s61, s4, 2
    s_add_u32 s61, s61, s62
    v_lshrrev_b32 v162, 4, v1
    v_and_b32 v161, 15, v1
    v_lshlrev_b32 v2, 16, v162
    v_lshl_add_u32 v2, v161, 4, v2
    s_lshl_b32 s7, s61, 3
    s_add_u32 s7, s7, s5
    s_lshl_b32 s7, s7, 8
    s_add_u32 s7, s7, 0x0
    v_add_u32 v2, s7, v2
    v_lshlrev_b32 v3, 6, v161
    v_lshl_add_u32 v3, v162, 4, v3
    s_lshl_b32 s7, s61, 13
    s_add_u32 s7, s7, 0x40000
    v_add_u32 v3, s7, v3
    v_xor_b32 v5, v162, v161
    v_lshlrev_b32 v5, 4, v5
    v_lshl_add_u32 v4, v161, 12, v5
    s_lshl_b32 s7, s62, 8
    v_add_u32 v4, s7, v4
    v_mov_b32 v160, 0x2404c
    s_mov_b32 s80, 1600000
LW_39:
    ds_read_b32 v161, v160
    s_waitcnt lgkmcnt(0)
    v_readfirstlane_b32 s79, v161
    s_cmp_ge_u32 s79, 1
    s_cbranch_scc1 LWD_40
    s_sleep 2
    s_sub_u32 s80, s80, 1
    s_cmp_lg_u32 s80, 0
    s_cbranch_scc1 LW_39
LWD_40:
    v_mov_b32 v160, 0x24050
    ds_read_b64 v[162:163], v160
    s_waitcnt lgkmcnt(0)
    v_readfirstlane_b32 s94, v162
    v_readfirstlane_b32 s95, v163
    s_sleep 4
    s_mov_b32 s63, 4096
    buffer_load_dwordx4 v[72:75], v3, s[36:39], 0 offen offset:0 sc1
    buffer_load_dwordx4 v[76:79], v3, s[36:39], 0 offen offset:1024 sc1
    buffer_load_dwordx4 v[80:83], v3, s[36:39], 0 offen offset:2048 sc1
    buffer_load_dwordx4 v[84:87], v3, s[36:39], 0 offen offset:3072 sc1
    buffer_load_dwordx4 v[88:91], v3, s[36:39], s63 offen offset:0 sc1
    buffer_load_dwordx4 v[92:95], v3, s[36:39], s63 offen offset:1024 sc1
    buffer_load_dwordx4 v[96:99], v3, s[36:39], s63 offen offset:2048 sc1
    buffer_load_dwordx4 v[100:103], v3, s[36:39], s63 offen offset:3072 sc1
    v_mov_b32 v160, 0x24014
    s_mov_b32 s80, 1600000
LW_43:
    ds_read_b32 v161, v160
    s_waitcnt lgkmcnt(0)
    v_readfirstlane_b32 s79, v161
    s_cmp_ge_u32 s79, 4
    s_cbranch_scc1 LWD_44
    s_sleep 1
    s_sub_u32 s80, s80, 1
    s_cmp_lg_u32 s80, 0
    s_cbranch_scc1 LW_43
LWD_44:
    v_xor_b32 v160, 0x0, v4
    v_xor_b32 v161, 0x40, v4
    v_xor_b32 v162, 0x80, v4
    v_xor_b32 v163, 0xc0, v4
    ds_read_b128 v[8:11], v160 offset:0
    ds_read_b128 v[12:15], v161 offset:0
    ds_read_b128 v[16:19], v162 offset:0
    ds_read_b128 v[20:23], v163 offset:0
    ds_read_b128 v[24:27], v160 offset:1024
    ds_read_b128 v[28:31], v161 offset:1024
    ds_read_b128 v[32:35], v162 offset:1024
    ds_read_b128 v[36:39], v163 offset:1024
    ds_read_b128 v[40:43], v160 offset:2048
    ds_read_b128 v[44:47], v161 offset:2048
    ds_read_b128 v[48:51], v162 offset:2048
    ds_read_b128 v[52:55], v163 offset:2048
    ds_read_b128 v[56:59], v160 offset:3072
    ds_read_b128 v[60:63], v161 offset:3072
    ds_read_b128 v[64:67], v162 offset:3072
    ds_read_b128 v[68:71], v163 offset:3072
    s_mov_b32 s80, 200000
PS_41:
    s_waitcnt vmcnt(0)
    s_mov_b32 s78, 0
    v_cmp_ne_u64 vcc, s[94:95], v[74:75]
    s_cbranch_vccz PSS_45
    buffer_load_dwordx4 v[72:75], v3, s[36:39], 0 offen offset:0 sc1
    s_mov_b32 s78, 1
PSS_45:
    v_cmp_ne_u64 vcc, s[94:95], v[78:79]
    s_cbranch_vccz PSS_46
    buffer_load_dwordx4 v[76:79], v3, s[36:39], 0 offen offset:1024 sc1
    s_mov_b32 s78, 1
PSS_46:
    v_cmp_ne_u64 vcc, s[94:95], v[82:83]
    s_cbranch_vccz PSS_47
    buffer_load_dwordx4 v[80:83], v3, s[36:39], 0 offen offset:2048 sc1
    s_mov_b32 s78, 1
PSS_47:
    v_cmp_ne_u64 vcc, s[94:95], v[86:87]
    s_cbranch_vccz PSS_48
    buffer_load_dwordx4 v[84:87], v3, s[36:39], 0 offen offset:3072 sc1
    s_mov_b32 s78, 1
PSS_48:
    v_cmp_ne_u64 vcc, s[94:95], v[90:91]
    s_cbranch_vccz PSS_49
    buffer_load_dwordx4 v[88:91], v3, s[36:39], s63 offen offset:0 sc1
    s_mov_b32 s78, 1
PSS_49:
    v_cmp_ne_u64 vcc, s[94:95], v[94:95]
    s_cbranch_vccz PSS_50
    buffer_load_dwordx4 v[92:95], v3, s[36:39], s63 offen offset:1024 sc1
    s_mov_b32 s78, 1
PSS_50:
    v_cmp_ne_u64 vcc, s[94:95], v[98:99]
    s_cbranch_vccz PSS_51
    buffer_load_dwordx4 v[96:99], v3, s[36:39], s63 offen offset:2048 sc1
    s_mov_b32 s78, 1
PSS_51:
    v_cmp_ne_u64 vcc, s[94:95], v[102:103]
    s_cbranch_vccz PSS_52
    buffer_load_dwordx4 v[100:103], v3, s[36:39], s63 offen offset:3072 sc1
    s_mov_b32 s78, 1
PSS_52:
    s_cmp_eq_u32 s78, 0
    s_cbranch_scc1 PSD_42
    s_sub_u32 s80, s80, 1
    s_cmp_lg_u32 s80, 0
    s_cbranch_scc1 PS_41
    s_waitcnt vmcnt(0)
PSD_42:
    v_lshlrev_b32 v104, 16, v72
    v_and_b32 v105, 0xffff0000, v72
    v_lshlrev_b32 v106, 16, v73
    v_and_b32 v107, 0xffff0000, v73
    v_lshlrev_b32 v108, 16, v76
    v_and_b32 v109, 0xffff0000, v76
    v_lshlrev_b32 v110, 16, v77
    v_and_b32 v111, 0xffff0000, v77
    v_lshlrev_b32 v120, 16, v80
    v_and_b32 v121, 0xffff0000, v80
    v_lshlrev_b32 v122, 16, v81
    v_and_b32 v123, 0xffff0000, v81
    v_lshlrev_b32 v124, 16, v84
    v_and_b32 v125, 0xffff0000, v84
    v_lshlrev_b32 v126, 16, v85
    v_and_b32 v127, 0xffff0000, v85
    v_pk_add_f32 v[104:105], v[104:105], v[120:121]
    v_pk_add_f32 v[106:107], v[106:107], v[122:123]
    v_pk_add_f32 v[108:109], v[108:109], v[124:125]
    v_pk_add_f32 v[110:111], v[110:111], v[126:127]
    v_lshlrev_b32 v112, 16, v88
    v_and_b32 v113, 0xffff0000, v88
    v_lshlrev_b32 v114, 16, v89
    v_and_b32 v115, 0xffff0000, v89
    v_lshlrev_b32 v116, 16, v92
    v_and_b32 v117, 0xffff0000, v92
    v_lshlrev_b32 v118, 16, v93
    v_and_b32 v119, 0xffff0000, v93
    v_pk_add_f32 v[104:105], v[104:105], v[112:113]
    v_pk_add_f32 v[106:107], v[106:107], v[114:115]
    v_pk_add_f32 v[108:109], v[108:109], v[116:117]
    v_pk_add_f32 v[110:111], v[110:111], v[118:119]
    v_lshlrev_b32 v120, 16, v96
    v_and_b32 v121, 0xffff0000, v96
    v_lshlrev_b32 v122, 16, v97
    v_and_b32 v123, 0xffff0000, v97
    v_lshlrev_b32 v124, 16, v100
    v_and_b32 v125, 0xffff0000, v100
    v_lshlrev_b32 v126, 16, v101
    v_and_b32 v127, 0xffff0000, v101
    v_pk_add_f32 v[104:105], v[104:105], v[120:121]
    v_pk_add_f32 v[106:107], v[106:107], v[122:123]
    v_pk_add_f32 v[108:109], v[108:109], v[124:125]
    v_pk_add_f32 v[110:111], v[110:111], v[126:127]
    v_cvt_pk_bf16_f32 v136, v104, v105
    v_cvt_pk_bf16_f32 v137, v106, v107
    v_cvt_pk_bf16_f32 v138, v108, v109
    v_cvt_pk_bf16_f32 v139, v110, v111
    v_mov_b32_dpp v140, v136 quad_perm:[1,2,3,0] row_mask:0xf bank_mask:0xf
    v_mov_b32_dpp v141, v137 quad_perm:[1,2,3,0] row_mask:0xf bank_mask:0xf
    v_mov_b32_dpp v142, v138 quad_perm:[1,2,3,0] row_mask:0xf bank_mask:0xf
    v_mov_b32_dpp v143, v139 quad_perm:[1,2,3,0] row_mask:0xf bank_mask:0xf
    v_mov_b32_dpp v144, v136 quad_perm:[2,3,0,1] row_mask:0xf bank_mask:0xf
    v_mov_b32_dpp v145, v137 quad_perm:[2,3,0,1] row_mask:0xf bank_mask:0xf
    v_mov_b32_dpp v146, v138 quad_perm:[2,3,0,1] row_mask:0xf bank_mask:0xf
    v_mov_b32_dpp v147, v139 quad_perm:[2,3,0,1] row_mask:0xf bank_mask:0xf
    v_mov_b32_dpp v148, v136 quad_perm:[3,0,1,2] row_mask:0xf bank_mask:0xf
    v_mov_b32_dpp v149, v137 quad_perm:[3,0,1,2] row_mask:0xf bank_mask:0xf
    v_mov_b32_dpp v150, v138 quad_perm:[3,0,1,2] row_mask:0xf bank_mask:0xf
    v_mov_b32_dpp v151, v139 quad_perm:[3,0,1,2] row_mask:0xf bank_mask:0xf
    v_mov_b32 v74, s94
    v_mov_b32 v75, s95
    s_waitcnt lgkmcnt(0)
    v_mfma_f32_16x16x32_bf16 v[104:107], v[136:139], v[8:11], 0
    v_mfma_f32_16x16x32_bf16 v[108:111], v[136:139], v[28:31], 0
    v_mfma_f32_16x16x32_bf16 v[112:115], v[136:139], v[48:51], 0
    v_mfma_f32_16x16x32_bf16 v[116:119], v[136:139], v[68:71], 0
    v_mfma_f32_16x16x32_bf16 v[104:107], v[140:143], v[12:15], v[104:107]
    v_mfma_f32_16x16x32_bf16 v[108:111], v[140:143], v[32:35], v[108:111]
    v_mfma_f32_16x16x32_bf16 v[112:115], v[140:143], v[52:55], v[112:115]
    v_mfma_f32_16x16x32_bf16 v[116:119], v[140:143], v[56:59], v[116:119]
    v_mfma_f32_16x16x32_bf16 v[104:107], v[144:147], v[16:19], v[104:107]
    v_mfma_f32_16x16x32_bf16 v[108:111], v[144:147], v[36:39], v[108:111]
    v_mfma_f32_16x16x32_bf16 v[112:115], v[144:147], v[40:43], v[112:115]
    v_mfma_f32_16x16x32_bf16 v[116:119], v[144:147], v[60:63], v[116:119]
    v_mfma_f32_16x16x32_bf16 v[104:107], v[148:151], v[20:23], v[104:107]
    v_mfma_f32_16x16x32_bf16 v[108:111], v[148:151], v[24:27], v[108:111]
    v_mfma_f32_16x16x32_bf16 v[112:115], v[148:151], v[44:47], v[112:115]
    v_mfma_f32_16x16x32_bf16 v[116:119], v[148:151], v[64:67], v[116:119]
    s_nop 5
    v_cvt_pk_bf16_f32 v72, v104, v109
    s_nop 0
    v_cvt_pk_bf16_f32 v73, v114, v119
    buffer_store_dwordx4 v[72:75], v2, s[36:39], 0 offen sc1
    v_mov_b32 v160, 0x24048
    v_mov_b32 v161, 1
    s_waitcnt lgkmcnt(0)
    s_mov_b64 exec, 1
    ds_add_u32 v160, v161
    s_mov_b64 exec, -1
    s_setprio 0
    s_cmp_ge_u32 s5, 4
    s_cbranch_scc1 L_END
L_U1:
    s_mov_b32 s48, s26
    s_and_b32 s49, s27, 0xffff
    s_mov_b32 s50, 0x400000
    s_mov_b32 s51, 0x20000
    v_lshrrev_b32 v162, 4, v1
    v_lshlrev_b32 v2, 16, v162
    v_and_b32 v160, 15, v1
    v_lshl_add_u32 v2, v160, 4, v2
    s_lshl_b32 s7, s6, 8
    v_add_u32 v2, s7, v2
    s_lshl_b32 s70, s3, 19
    s_waitcnt vmcnt(2)
    buffer_load_dwordx4 v[8:11], v2, s[48:51], s70 offen nt
    s_add_u32 s70, s70, 8192
    s_waitcnt vmcnt(2)
    buffer_load_dwordx4 v[12:15], v2, s[48:51], s70 offen nt
    s_add_u32 s70, s70, 8192
    s_waitcnt vmcnt(2)
    buffer_load_dwordx4 v[16:19], v2, s[48:51], s70 offen nt
    s_add_u32 s70, s70, 8192
    s_waitcnt vmcnt(2)
    buffer_load_dwordx4 v[20:23], v2, s[48:51], s70 offen nt
    s_add_u32 s70, s70, 8192
    s_waitcnt vmcnt(2)
    buffer_load_dwordx4 v[24:27], v2, s[48:51], s70 offen nt
    s_add_u32 s70, s70, 8192
    s_waitcnt vmcnt(2)
    buffer_load_dwordx4 v[28:31], v2, s[48:51], s70 offen nt
    s_add_u32 s70, s70, 8192
    s_waitcnt vmcnt(2)
    buffer_load_dwordx4 v[32:35], v2, s[48:51], s70 offen nt
    s_add_u32 s70, s70, 8192
    s_waitcnt vmcnt(2)
    buffer_load_dwordx4 v[36:39], v2, s[48:51], s70 offen nt
    s_add_u32 s70, s70, 204800
    s_waitcnt vmcnt(2)
    buffer_load_dwordx4 v[104:107], v2, s[48:51], s70 offen nt
    s_add_u32 s70, s70, 8192
    s_waitcnt vmcnt(2)
    buffer_load_dwordx4 v[108:111], v2, s[48:51], s70 offen nt
    s_add_u32 s70, s70, 8192
    s_waitcnt vmcnt(2)
    buffer_load_dwordx4 v[112:115], v2, s[48:51], s70 offen nt
    s_add_u32 s70, s70, 8192
    s_waitcnt vmcnt(2)
    buffer_load_dwordx4 v[116:119], v2, s[48:51], s70 offen nt
    s_add_u32 s70, s70, 8192
    s_waitcnt vmcnt(2)
    buffer_load_dwordx4 v[120:123], v2, s[48:51], s70 offen nt
    s_add_u32 s70, s70, 8192
    s_waitcnt vmcnt(2)
    buffer_load_dwordx4 v[124:127], v2, s[48:51], s70 offen nt
    s_add_u32 s70, s70, 8192
    s_waitcnt vmcnt(2)
    buffer_load_dwordx4 v[128:131], v2, s[48:51], s70 offen nt
    s_add_u32 s70, s70, 8192
    s_waitcnt vmcnt(2)
    buffer_load_dwordx4 v[132:135], v2, s[48:51], s70 offen nt
    s_add_u32 s70, s70, 204800
    v_lshlrev_b32 v3, 4, v1
    v_add_u32 v3, 0x24800, v3
    v_lshrrev_b32 v4, 1, v160
    v_lshlrev_b32 v4, 18, v4
    v_lshl_add_u32 v4, v162, 4, v4
    v_and_b32 v163, 1, v1
    v_lshl_add_u32 v4, v163, 6, v4
    v_cmp_eq_u32 s[86:87], 1, v163
    s_lshl_b32 s7, s3, 5
    s_add_u32 s7, s7, s6
    s_lshl_b32 s7, s7, 7
    s_add_u32 s7, s7, 0x500000
    v_add_u32 v4, s7, v4
    s_lshl_b32 s7, s3, 11
    s_add_u32 s7, s7, 0x10000
    v_lshl_add_u32 v5, v1, 5, s7
    v_perm_b32 v40, v12, v8, s92
    v_perm_b32 v41, v20, v16, s92
    v_perm_b32 v42, v28, v24, s92
    v_perm_b32 v43, v36, v32, s92
    v_perm_b32 v44, v12, v8, s93
    v_perm_b32 v45, v20, v16, s93
    v_perm_b32 v46, v28, v24, s93
    v_perm_b32 v47, v36, v32, s93
    v_perm_b32 v48, v13, v9, s92
    v_perm_b32 v49, v21, v17, s92
    v_perm_b32 v50, v29, v25, s92
    v_perm_b32 v51, v37, v33, s92
    v_perm_b32 v52, v13, v9, s93
    v_perm_b32 v53, v21, v17, s93
    v_perm_b32 v54, v29, v25, s93
    v_perm_b32 v55, v37, v33, s93
    v_perm_b32 v56, v14, v10, s92
    v_perm_b32 v57, v22, v18, s92
    v_perm_b32 v58, v30, v26, s92
    v_perm_b32 v59, v38, v34, s92
    v_perm_b32 v60, v14, v10, s93
    v_perm_b32 v61, v22, v18, s93
    v_perm_b32 v62, v30, v26, s93
    v_perm_b32 v63, v38, v34, s93
    v_perm_b32 v64, v15, v11, s92
    v_perm_b32 v65, v23, v19, s92
    v_perm_b32 v66, v31, v27, s92
    v_perm_b32 v67, v39, v35, s92
    v_perm_b32 v68, v15, v11, s93
    v_perm_b32 v69, v23, v19, s93
    v_perm_b32 v70, v31, v27, s93
    v_perm_b32 v71, v39, v35, s93
    s_waitcnt vmcnt(0)
    v_perm_b32 v72, v108, v104, s92
    v_perm_b32 v73, v116, v112, s92
    v_perm_b32 v74, v124, v120, s92
    v_perm_b32 v75, v132, v128, s92
    v_perm_b32 v76, v108, v104, s93
    v_perm_b32 v77, v116, v112, s93
    v_perm_b32 v78, v124, v120, s93
    v_perm_b32 v79, v132, v128, s93
    v_perm_b32 v80, v109, v105, s92
    v_perm_b32 v81, v117, v113, s92
    v_perm_b32 v82, v125, v121, s92
    v_perm_b32 v83, v133, v129, s92
    v_perm_b32 v84, v109, v105, s93
    v_perm_b32 v85, v117, v113, s93
    v_perm_b32 v86, v125, v121, s93
    v_perm_b32 v87, v133, v129, s93
    v_perm_b32 v88, v110, v106, s92
    v_perm_b32 v89, v118, v114, s92
    v_perm_b32 v90, v126, v122, s92
    v_perm_b32 v91, v134, v130, s92
    v_perm_b32 v92, v110, v106, s93
    v_perm_b32 v93, v118, v114, s93
    v_perm_b32 v94, v126, v122, s93
    v_perm_b32 v95, v134, v130, s93
    v_perm_b32 v96, v111, v107, s92
    v_perm_b32 v97, v119, v115, s92
    v_perm_b32 v98, v127, v123, s92
    v_perm_b32 v99, v135, v131, s92
    v_perm_b32 v100, v111, v107, s93
    v_perm_b32 v101, v119, v115, s93
    v_perm_b32 v102, v127, v123, s93
    v_perm_b32 v103, v135, v131, s93
    v_mov_b32 v160, 0x2404c
    s_mov_b32 s80, 1600000
LW_53:
    ds_read_b32 v161, v160
    s_waitcnt lgkmcnt(0)
    v_readfirstlane_b32 s79, v161
    s_cmp_ge_u32 s79, 1
    s_cbranch_scc1 LWD_54
    s_sleep 2
    s_sub_u32 s80, s80, 1
    s_cmp_lg_u32 s80, 0
    s_cbranch_scc1 LW_53
LWD_54:
    v_mov_b32 v160, 0x24050
    ds_read_b64 v[162:163], v160
    s_waitcnt lgkmcnt(0)
    v_readfirstlane_b32 s94, v162
    v_readfirstlane_b32 s95, v163
    v_mov_b32 v160, 0x2401c
    s_mov_b32 s80, 1600000
LW_55:
    ds_read_b32 v161, v160
    s_waitcnt lgkmcnt(0)
    v_readfirstlane_b32 s79, v161
    s_cmp_ge_u32 s79, 1
    s_cbranch_scc1 LWD_56
    s_sleep 4
    s_sub_u32 s80, s80, 1
    s_cmp_lg_u32 s80, 0
    s_cbranch_scc1 LW_55
LWD_56:
    s_setprio 3
    s_mov_b64 s[88:89], 0
    s_mov_b32 s80, 1600000
UM_57:
    ds_read_b128 v[136:139], v3
    s_waitcnt lgkmcnt(0)
    v_cmp_ne_u64 vcc, s[94:95], v[138:139]
    s_or_b64 s[90:91], vcc, s[88:89]
    s_and_b32 s7, s90, 0x5555
    s_cbranch_scc1 UMS_59
    s_mov_b32 s70, 0
    buffer_load_dwordx4 v[8:11], v4, s[36:39], s70 offen sc1
    s_or_b32 s88, s88, 0x5555
UMS_59:
    s_and_b32 s7, s90, 0x55550000
    s_cbranch_scc1 UMS_60
    s_mov_b32 s70, 32768
    buffer_load_dwordx4 v[12:15], v4, s[36:39], s70 offen sc1
    s_or_b32 s88, s88, 0x55550000
UMS_60:
    s_and_b32 s7, s91, 0x5555
    s_cbranch_scc1 UMS_61
    s_mov_b32 s70, 65536
    buffer_load_dwordx4 v[16:19], v4, s[36:39], s70 offen sc1
    s_or_b32 s89, s89, 0x5555
UMS_61:
    s_and_b32 s7, s91, 0x55550000
    s_cbranch_scc1 UMS_62
    s_mov_b32 s70, 98304
    buffer_load_dwordx4 v[20:23], v4, s[36:39], s70 offen sc1
    s_or_b32 s89, s89, 0x55550000
UMS_62:
    s_and_b32 s7, s90, 0xaaaa
    s_cbranch_scc1 UMS_63
    s_mov_b32 s70, 131072
    buffer_load_dwordx4 v[24:27], v4, s[36:39], s70 offen sc1
    s_or_b32 s88, s88, 0xaaaa
UMS_63:
    s_and_b32 s7, s90, 0xaaaa0000
    s_cbranch_scc1 UMS_64
    s_mov_b32 s70, 163840
    buffer_load_dwordx4 v[28:31], v4, s[36:39], s70 offen sc1
    s_or_b32 s88, s88, 0xaaaa0000
UMS_64:
    s_and_b32 s7, s91, 0xaaaa
    s_cbranch_scc1 UMS_65
    s_mov_b32 s70, 196608
    buffer_load_dwordx4 v[32:35], v4, s[36:39], s70 offen sc1
    s_or_b32 s89, s89, 0xaaaa
UMS_65:
    s_and_b32 s7, s91, 0xaaaa0000
    s_cbranch_scc1 UMS_66
    s_mov_b32 s70, 229376
    buffer_load_dwordx4 v[36:39], v4, s[36:39], s70 offen sc1
    s_or_b32 s89, s89, 0xaaaa0000
UMS_66:
    s_cbranch_vccz UMD_58
    s_sleep 1
    s_sub_u32 s80, s80, 1
    s_cmp_lg_u32 s80, 0
    s_cbranch_scc1 UM_57
UMD_58:
    v_max_f32_dpp v138, v136, v136 quad_perm:[1,0,3,2] row_mask:0xf bank_mask:0xf
    s_nop 1
    v_max_f32_dpp v138, v138, v138 quad_perm:[2,3,0,1] row_mask:0xf bank_mask:0xf
    v_mov_b32 v139, v138
    s_nop 1
    v_permlane32_swap_b32 v138, v139
    v_max_f32 v138, v138, v139
    v_mov_b32 v139, v138
    s_nop 1
    v_permlane16_swap_b32 v138, v139
    v_max_f32 v138, v138, v139
    v_sub_f32 v136, v136, v138
    v_exp_f32 v136, v136
    s_nop 0
    v_mul_f32 v137, v137, v136
    s_nop 1
    v_add_f32_dpp v137, v137, v137 quad_perm:[1,0,3,2] row_mask:0xf bank_mask:0xf
    s_nop 1
    v_add_f32_dpp v137, v137, v137 quad_perm:[2,3,0,1] row_mask:0xf bank_mask:0xf
    v_mov_b32 v138, v137
    s_nop 1
    v_permlane32_swap_b32 v137, v138
    v_add_f32 v137, v137, v138
    v_mov_b32 v138, v137
    s_nop 1
    v_permlane16_swap_b32 v137, v138
    v_add_f32 v137, v137, v138
    v_rcp_f32 v137, v137
    s_nop 0
    v_mul_f32 v136, v136, v137
    v_mov_b32 v137, v136
    s_nop 1
    v_permlane16_swap_b32 v136, v137
    v_mov_b32 v138, v136
    v_mov_b32 v139, v137
    s_nop 0
    v_permlane32_swap_b32 v136, v138
    v_permlane32_swap_b32 v137, v139
    s_nop 0
    v_mov_b32_dpp v148, v136 quad_perm:[0,0,2,2] row_mask:0xf bank_mask:0xf
    v_mov_b32_dpp v149, v137 quad_perm:[0,0,2,2] row_mask:0xf bank_mask:0xf
    v_mov_b32_dpp v150, v138 quad_perm:[0,0,2,2] row_mask:0xf bank_mask:0xf
    v_mov_b32_dpp v151, v139 quad_perm:[0,0,2,2] row_mask:0xf bank_mask:0xf
    v_mov_b32_dpp v152, v136 quad_perm:[1,1,3,3] row_mask:0xf bank_mask:0xf
    v_mov_b32_dpp v153, v137 quad_perm:[1,1,3,3] row_mask:0xf bank_mask:0xf
    v_mov_b32_dpp v154, v138 quad_perm:[1,1,3,3] row_mask:0xf bank_mask:0xf
    v_mov_b32_dpp v155, v139 quad_perm:[1,1,3,3] row_mask:0xf bank_mask:0xf
    s_waitcnt vmcnt(0)
    v_lshlrev_b32 v104, 16, v8
    v_and_b32 v105, 0xffff0000, v8
    v_lshlrev_b32 v106, 16, v9
    v_and_b32 v107, 0xffff0000, v9
    v_lshlrev_b32 v108, 16, v10
    v_and_b32 v109, 0xffff0000, v10
    v_lshlrev_b32 v110, 16, v11
    v_and_b32 v111, 0xffff0000, v11
    v_pk_mul_f32 v[120:121], v[104:105], v[148:149] op_sel_hi:[1,0]
    v_pk_mul_f32 v[122:123], v[106:107], v[148:149] op_sel_hi:[1,0]
    v_pk_mul_f32 v[124:125], v[108:109], v[148:149] op_sel_hi:[1,0]
    v_pk_mul_f32 v[126:127], v[110:111], v[148:149] op_sel_hi:[1,0]
    v_lshlrev_b32 v112, 16, v12
    v_and_b32 v113, 0xffff0000, v12
    v_lshlrev_b32 v114, 16, v13
    v_and_b32 v115, 0xffff0000, v13
    v_lshlrev_b32 v116, 16, v14
    v_and_b32 v117, 0xffff0000, v14
    v_lshlrev_b32 v118, 16, v15
    v_and_b32 v119, 0xffff0000, v15
    v_pk_mul_f32 v[128:129], v[112:113], v[148:149] op_sel:[0,1] op_sel_hi:[1,1]
    v_pk_mul_f32 v[130:131], v[114:115], v[148:149] op_sel:[0,1] op_sel_hi:[1,1]
    v_pk_mul_f32 v[132:133], v[116:117], v[148:149] op_sel:[0,1] op_sel_hi:[1,1]
    v_pk_mul_f32 v[134:135], v[118:119], v[148:149] op_sel:[0,1] op_sel_hi:[1,1]
    v_lshlrev_b32 v104, 16, v16
    v_and_b32 v105, 0xffff0000, v16
    v_lshlrev_b32 v106, 16, v17
    v_and_b32 v107, 0xffff0000, v17
    v_lshlrev_b32 v108, 16, v18
    v_and_b32 v109, 0xffff0000, v18
    v_lshlrev_b32 v110, 16, v19
    v_and_b32 v111, 0xffff0000, v19
    v_pk_fma_f32 v[120:121], v[104:105], v[150:151], v[120:121] op_sel_hi:[1,0,1]
    v_pk_fma_f32 v[122:123], v[106:107], v[150:151], v[122:123] op_sel_hi:[1,0,1]
    v_pk_fma_f32 v[124:125], v[108:109], v[150:151], v[124:125] op_sel_hi:[1,0,1]
    v_pk_fma_f32 v[126:127], v[110:111], v[150:151], v[126:127] op_sel_hi:[1,0,1]
    v_lshlrev_b32 v112, 16, v20
    v_and_b32 v113, 0xffff0000, v20
    v_lshlrev_b32 v114, 16, v21
    v_and_b32 v115, 0xffff0000, v21
    v_lshlrev_b32 v116, 16, v22
    v_and_b32 v117, 0xffff0000, v22
    v_lshlrev_b32 v118, 16, v23
    v_and_b32 v119, 0xffff0000, v23
    v_pk_fma_f32 v[128:129], v[112:113], v[150:151], v[128:129] op_sel:[0,1,0] op_sel_hi:[1,1,1]
    v_pk_fma_f32 v[130:131], v[114:115], v[150:151], v[130:131] op_sel:[0,1,0] op_sel_hi:[1,1,1]
    v_pk_fma_f32 v[132:133], v[116:117], v[150:151], v[132:133] op_sel:[0,1,0] op_sel_hi:[1,1,1]
    v_pk_fma_f32 v[134:135], v[118:119], v[150:151], v[134:135] op_sel:[0,1,0] op_sel_hi:[1,1,1]
    v_lshlrev_b32 v104, 16, v24
    v_and_b32 v105, 0xffff0000, v24
    v_lshlrev_b32 v106, 16, v25
    v_and_b32 v107, 0xffff0000, v25
    v_lshlrev_b32 v108, 16, v26
    v_and_b32 v109, 0xffff0000, v26
    v_lshlrev_b32 v110, 16, v27
    v_and_b32 v111, 0xffff0000, v27
    v_pk_fma_f32 v[120:121], v[104:105], v[152:153], v[120:121] op_sel_hi:[1,0,1]
    v_pk_fma_f32 v[122:123], v[106:107], v[152:153], v[122:123] op_sel_hi:[1,0,1]
    v_pk_fma_f32 v[124:125], v[108:109], v[152:153], v[124:125] op_sel_hi:[1,0,1]
    v_pk_fma_f32 v[126:127], v[110:111], v[152:153], v[126:127] op_sel_hi:[1,0,1]
    v_lshlrev_b32 v112, 16, v28
    v_and_b32 v113, 0xffff0000, v28
    v_lshlrev_b32 v114, 16, v29
    v_and_b32 v115, 0xffff0000, v29
    v_lshlrev_b32 v116, 16, v30
    v_and_b32 v117, 0xffff0000, v30
    v_lshlrev_b32 v118, 16, v31
    v_and_b32 v119, 0xffff0000, v31
    v_pk_fma_f32 v[128:129], v[112:113], v[152:153], v[128:129] op_sel:[0,1,0] op_sel_hi:[1,1,1]
    v_pk_fma_f32 v[130:131], v[114:115], v[152:153], v[130:131] op_sel:[0,1,0] op_sel_hi:[1,1,1]
    v_pk_fma_f32 v[132:133], v[116:117], v[152:153], v[132:133] op_sel:[0,1,0] op_sel_hi:[1,1,1]
    v_pk_fma_f32 v[134:135], v[118:119], v[152:153], v[134:135] op_sel:[0,1,0] op_sel_hi:[1,1,1]
    v_lshlrev_b32 v104, 16, v32
    v_and_b32 v105, 0xffff0000, v32
    v_lshlrev_b32 v106, 16, v33
    v_and_b32 v107, 0xffff0000, v33
    v_lshlrev_b32 v108, 16, v34
    v_and_b32 v109, 0xffff0000, v34
    v_lshlrev_b32 v110, 16, v35
    v_and_b32 v111, 0xffff0000, v35
    v_pk_fma_f32 v[120:121], v[104:105], v[154:155], v[120:121] op_sel_hi:[1,0,1]
    v_pk_fma_f32 v[122:123], v[106:107], v[154:155], v[122:123] op_sel_hi:[1,0,1]
    v_pk_fma_f32 v[124:125], v[108:109], v[154:155], v[124:125] op_sel_hi:[1,0,1]
    v_pk_fma_f32 v[126:127], v[110:111], v[154:155], v[126:127] op_sel_hi:[1,0,1]
    v_lshlrev_b32 v112, 16, v36
    v_and_b32 v113, 0xffff0000, v36
    v_lshlrev_b32 v114, 16, v37
    v_and_b32 v115, 0xffff0000, v37
    v_lshlrev_b32 v116, 16, v38
    v_and_b32 v117, 0xffff0000, v38
    v_lshlrev_b32 v118, 16, v39
    v_and_b32 v119, 0xffff0000, v39
    v_pk_fma_f32 v[128:129], v[112:113], v[154:155], v[128:129] op_sel:[0,1,0] op_sel_hi:[1,1,1]
    v_pk_fma_f32 v[130:131], v[114:115], v[154:155], v[130:131] op_sel:[0,1,0] op_sel_hi:[1,1,1]
    v_pk_fma_f32 v[132:133], v[116:117], v[154:155], v[132:133] op_sel:[0,1,0] op_sel_hi:[1,1,1]
    v_pk_fma_f32 v[134:135], v[118:119], v[154:155], v[134:135] op_sel:[0,1,0] op_sel_hi:[1,1,1]
    v_pk_add_f32 v[120:121], v[120:121], v[128:129]
    v_pk_add_f32 v[122:123], v[122:123], v[130:131]
    v_pk_add_f32 v[124:125], v[124:125], v[132:133]
    v_pk_add_f32 v[126:127], v[126:127], v[134:135]
    v_cvt_pk_bf16_f32 v128, v120, v121
    v_cvt_pk_bf16_f32 v129, v122, v123
    v_cvt_pk_bf16_f32 v130, v124, v125
    v_cvt_pk_bf16_f32 v131, v126, v127
    v_cndmask_b32 v140, v128, 0, s[86:87]
    v_cndmask_b32 v144, 0, v128, s[86:87]
    v_cndmask_b32 v141, v129, 0, s[86:87]
    v_cndmask_b32 v145, 0, v129, s[86:87]
    v_cndmask_b32 v142, v130, 0, s[86:87]
    v_cndmask_b32 v146, 0, v130, s[86:87]
    v_cndmask_b32 v143, v131, 0, s[86:87]
    v_cndmask_b32 v147, 0, v131, s[86:87]
    s_nop 0
    v_mfma_f32_16x16x32_bf16 v[8:11], v[140:143], v[40:43], 0
    v_mfma_f32_16x16x32_bf16 v[12:15], v[140:143], v[44:47], 0
    v_mfma_f32_16x16x32_bf16 v[16:19], v[140:143], v[48:51], 0
    v_mfma_f32_16x16x32_bf16 v[20:23], v[140:143], v[52:55], 0
    v_mfma_f32_16x16x32_bf16 v[24:27], v[140:143], v[56:59], 0
    v_mfma_f32_16x16x32_bf16 v[28:31], v[140:143], v[60:63], 0
    v_mfma_f32_16x16x32_bf16 v[32:35], v[140:143], v[64:67], 0
    v_mfma_f32_16x16x32_bf16 v[36:39], v[140:143], v[68:71], 0
    v_mfma_f32_16x16x32_bf16 v[8:11], v[144:147], v[72:75], v[8:11]
    v_mfma_f32_16x16x32_bf16 v[12:15], v[144:147], v[76:79], v[12:15]
    v_mfma_f32_16x16x32_bf16 v[16:19], v[144:147], v[80:83], v[16:19]
    v_mfma_f32_16x16x32_bf16 v[20:23], v[144:147], v[84:87], v[20:23]
    v_mfma_f32_16x16x32_bf16 v[24:27], v[144:147], v[88:91], v[24:27]
    v_mfma_f32_16x16x32_bf16 v[28:31], v[144:147], v[92:95], v[28:31]
    v_mfma_f32_16x16x32_bf16 v[32:35], v[144:147], v[96:99], v[32:35]
    v_mfma_f32_16x16x32_bf16 v[36:39], v[144:147], v[100:103], v[36:39]
    s_nop 0
    v_pk_add_f32 v[8:9], v[8:9], v[10:11]
    v_pk_add_f32 v[12:13], v[12:13], v[14:15]
    v_pk_add_f32 v[16:17], v[16:17], v[18:19]
    v_pk_add_f32 v[20:21], v[20:21], v[22:23]
    v_pk_add_f32 v[24:25], v[24:25], v[26:27]
    v_pk_add_f32 v[28:29], v[28:29], v[30:31]
    v_pk_add_f32 v[32:33], v[32:33], v[34:35]
    v_pk_add_f32 v[36:37], v[36:37], v[38:39]
    v_add_f32 v104, v8, v9
    v_add_f32 v105, v12, v13
    v_add_f32 v106, v16, v17
    v_add_f32 v107, v20, v21
    v_add_f32 v108, v24, v25
    v_add_f32 v109, v28, v29
    v_add_f32 v110, v32, v33
    v_add_f32 v111, v36, v37
    ds_write_b128 v5, v[104:107]
    ds_write_b128 v5, v[108:111] offset:16
    v_mov_b32 v160, 0x2400c
    v_mov_b32 v161, 1
    s_waitcnt lgkmcnt(0)
    s_mov_b64 exec, 1
    ds_add_u32 v160, v161
    s_mov_b64 exec, -1
    v_and_b32 v160, 31, v1
    s_lshl_b32 s7, s3, 8
    s_add_u32 s7, s7, 0x10000
    v_lshl_add_u32 v5, v160, 3, s7
    s_lshl_b32 s7, s3, 7
    s_add_u32 s7, s7, 0x24400
    v_lshl_add_u32 v4, v160, 2, s7
    v_mov_b32 v160, 0x2400c
    s_mov_b32 s80, 1600000
LW_67:
    ds_read_b32 v161, v160
    s_waitcnt lgkmcnt(0)
    v_readfirstlane_b32 s79, v161
    s_cmp_ge_u32 s79, 8
    s_cbranch_scc1 LWD_68
    s_sub_u32 s80, s80, 1
    s_cmp_lg_u32 s80, 0
    s_cbranch_scc1 LW_67
LWD_68:
    ds_read_b64 v[8:9], v5 offset:0
    ds_read_b64 v[10:11], v5 offset:2048
    ds_read_b64 v[12:13], v5 offset:4096
    ds_read_b64 v[14:15], v5 offset:6144
    ds_read_b64 v[16:17], v5 offset:8192
    ds_read_b64 v[18:19], v5 offset:10240
    ds_read_b64 v[20:21], v5 offset:12288
    ds_read_b64 v[22:23], v5 offset:14336
    s_waitcnt lgkmcnt(0)
    v_pk_add_f32 v[8:9], v[8:9], v[16:17]
    v_pk_add_f32 v[10:11], v[10:11], v[18:19]
    v_pk_add_f32 v[12:13], v[12:13], v[20:21]
    v_pk_add_f32 v[14:15], v[14:15], v[22:23]
    v_pk_add_f32 v[8:9], v[8:9], v[12:13]
    v_pk_add_f32 v[10:11], v[10:11], v[14:15]
    v_pk_add_f32 v[8:9], v[8:9], v[10:11]
    v_cvt_pk_bf16_f32 v8, v8, v9
    ds_write_b32 v4, v8
    v_mov_b32 v160, 0x24020
    v_mov_b32 v161, 1
    s_waitcnt lgkmcnt(0)
    s_mov_b64 exec, 1
    ds_add_u32 v160, v161
    s_mov_b64 exec, -1
    s_endpgm
L_W2:
    v_and_b32 v1, 63, v0
    s_and_b32 s7, s5, 3
    s_lshl_b32 s6, s4, 2
    s_add_u32 s6, s6, s7
    s_mov_b32 s92, 0x05040100
    s_mov_b32 s93, 0x07060302
    s_cmp_lg_u32 s3, 11
    s_cbranch_scc1 Z_69
    v_lshlrev_b32 v2, 2, v1
    v_add_u32 v2, 0x24000, v2
    v_mov_b32 v3, 0
    ds_write_b32 v2, v3
Z_69:
    s_waitcnt lgkmcnt(0)
    s_mov_b32 s36, s34
    s_and_b32 s37, s35, 0xffff
    s_mov_b32 s38, 0x1000000
    s_mov_b32 s39, 0x20000
    s_mov_b32 s40, s32
    s_and_b32 s41, s33, 0xffff
    s_mov_b32 s42, 0x100
    s_mov_b32 s43, 0x20000
    s_mov_b32 s52, s24
    s_and_b32 s53, s25, 0xffff
    s_mov_b32 s54, 0x400000
    s_mov_b32 s55, 0x20000
    s_sub_u32 s62, s3, 8
    s_lshl_b32 s7, s5, 2
    s_add_u32 s7, s7, s62
    s_lshl_b32 s7, s7, 17
    s_lshl_b32 s70, s4, 10
    s_add_u32 s70, s70, s7
    s_lshl_b32 s71, s62, 14
    v_lshlrev_b32 v2, 4, v1
    s_lshl_b32 s7, s62, 6
    v_xor_b32 v4, s7, v2
    v_xor_b32 v5, 16, v4
    v_xor_b32 v6, 32, v4
    v_xor_b32 v7, 48, v4
    s_mov_b32 m0, s71
    s_nop 0
    buffer_load_dwordx4 v4, s[52:55], s70 offen nt lds
    s_add_u32 s70, s70, 8192
    s_add_u32 s71, s71, 1024
    s_mov_b32 m0, s71
    s_nop 0
    buffer_load_dwordx4 v4, s[52:55], s70 offen nt lds
    s_add_u32 s70, s70, 8192
    s_add_u32 s71, s71, 1024
    s_barrier
    s_mov_b32 m0, s71
    s_nop 0
    buffer_load_dwordx4 v4, s[52:55], s70 offen nt lds
    s_add_u32 s70, s70, 8192
    s_add_u32 s71, s71, 1024
    s_mov_b32 m0, s71
    s_nop 0
    buffer_load_dwordx4 v4, s[52:55], s70 offen nt lds
    s_add_u32 s70, s70, 8192
    s_add_u32 s71, s71, 1024
    s_mov_b32 m0, s71
    s_nop 0
    buffer_load_dwordx4 v5, s[52:55], s70 offen nt lds
    s_add_u32 s70, s70, 8192
    s_add_u32 s71, s71, 1024
    s_mov_b32 m0, s71
    s_nop 0
    buffer_load_dwordx4 v5, s[52:55], s70 offen nt lds
    s_add_u32 s70, s70, 8192
    s_add_u32 s71, s71, 1024
    s_mov_b32 m0, s71
    s_nop 0
    buffer_load_dwordx4 v5, s[52:55], s70 offen nt lds
    s_add_u32 s70, s70, 8192
    s_add_u32 s71, s71, 1024
    s_mov_b32 m0, s71
    s_nop 0
    buffer_load_dwordx4 v5, s[52:55], s70 offen nt lds
    s_add_u32 s70, s70, 8192
    s_add_u32 s71, s71, 1024
    s_mov_b32 m0, s71
    s_waitcnt vmcnt(7)
    buffer_load_dwordx4 v6, s[52:55], s70 offen nt lds
    s_add_u32 s70, s70, 8192
    s_add_u32 s71, s71, 1024
    s_mov_b32 m0, s71
    s_waitcnt vmcnt(7)
    buffer_load_dwordx4 v6, s[52:55], s70 offen nt lds
    s_add_u32 s70, s70, 8192
    s_add_u32 s71, s71, 1024
    s_mov_b32 m0, s71
    s_waitcnt vmcnt(7)
    buffer_load_dwordx4 v6, s[52:55], s70 offen nt lds
    s_add_u32 s70, s70, 8192
    s_add_u32 s71, s71, 1024
    s_mov_b32 m0, s71
    s_waitcnt vmcnt(7)
    buffer_load_dwordx4 v6, s[52:55], s70 offen nt lds
    s_add_u32 s70, s70, 8192
    s_add_u32 s71, s71, 1024
    s_mov_b32 m0, s71
    s_waitcnt vmcnt(7)
    buffer_load_dwordx4 v7, s[52:55], s70 offen nt lds
    s_add_u32 s70, s70, 8192
    s_add_u32 s71, s71, 1024
    s_mov_b32 m0, s71
    s_waitcnt vmcnt(7)
    buffer_load_dwordx4 v7, s[52:55], s70 offen nt lds
    s_add_u32 s70, s70, 8192
    s_add_u32 s71, s71, 1024
    s_mov_b32 m0, s71
    s_waitcnt vmcnt(7)
    buffer_load_dwordx4 v7, s[52:55], s70 offen nt lds
    s_add_u32 s70, s70, 8192
    s_add_u32 s71, s71, 1024
    s_mov_b32 m0, s71
    s_waitcnt vmcnt(7)
    buffer_load_dwordx4 v7, s[52:55], s70 offen nt lds
    s_add_u32 s70, s70, 8192
    s_add_u32 s71, s71, 1024
    s_cmp_lt_u32 s5, 4
    s_cselect_b32 s72, s28, s16
    s_cselect_b32 s73, s29, s17
    s_mov_b32 s56, s72
    s_and_b32 s57, s73, 0xffff
    s_mov_b32 s58, 0x400000
    s_mov_b32 s59, 0x20000
    v_lshrrev_b32 v4, 4, v1
    v_lshlrev_b32 v2, 13, v4
    v_and_b32 v4, 15, v1
    v_lshl_add_u32 v2, v4, 4, v2
    s_lshl_b32 s7, s6, 17
    s_lshl_b32 s70, s62, 8
    s_add_u32 s7, s7, s70
    v_add_u32 v2, s7, v2
    v_lshrrev_b32 v3, 4, v1
    v_lshlrev_b32 v3, 16, v3
    v_bfe_u32 v4, v1, 3, 1
    v_lshl_add_u32 v3, v4, 13, v3
    v_and_b32 v4, 7, v1
    v_lshl_add_u32 v3, v4, 4, v3
    s_cmp_lt_u32 s5, 4
    s_cselect_b32 s7, 0x800, 0x0
    s_add_u32 s7, s7, s6
    s_lshl_b32 s7, s7, 7
    s_add_u32 s7, s7, 0x100000
    v_add_u32 v3, s7, v3
    s_lshl_b32 s7, s62, 14
    v_add_u32 v3, s7, v3
    s_waitcnt vmcnt(0)
    v_mov_b32 v4, 0x24014
    v_mov_b32 v5, 1
    s_waitcnt lgkmcnt(0)
    s_mov_b64 exec, 1
    ds_add_u32 v4, v5
    s_mov_b64 exec, -1
    s_mov_b32 s70, 0
    v_mov_b32 v4, 0x24048
    s_mov_b32 s80, 1600000
LW_72:
    ds_read_b32 v5, v4
    s_waitcnt lgkmcnt(0)
    v_readfirstlane_b32 s79, v5
    s_cmp_ge_u32 s79, 4
    s_cbranch_scc1 LWD_73
    s_sleep 4
    s_sub_u32 s80, s80, 1
    s_cmp_lg_u32 s80, 0
    s_cbranch_scc1 LW_72
LWD_73:
    s_cmp_lt_u32 s5, 4
    s_cbranch_scc1 S2U_70
    v_mov_b32 v4, 0x2405c
    s_mov_b32 s80, 1600000
LW_74:
    ds_read_b32 v5, v4
    s_waitcnt lgkmcnt(0)
    v_readfirstlane_b32 s79, v5
    s_cmp_ge_u32 s79, 4
    s_cbranch_scc1 LWD_75
    s_sleep 8
    s_sub_u32 s80, s80, 1
    s_cmp_lg_u32 s80, 0
    s_cbranch_scc1 LW_74
LWD_75:
    buffer_load_dwordx4 v[40:43], v2, s[56:59], s70 offen offset:0 nt
    buffer_load_dwordx4 v[44:47], v2, s[56:59], s70 offen offset:1024 nt
    buffer_load_dwordx4 v[48:51], v2, s[56:59], s70 offen offset:2048 nt
    buffer_load_dwordx4 v[52:55], v2, s[56:59], s70 offen offset:3072 nt
    s_add_u32 s70, s70, 4096
    s_waitcnt vmcnt(2)
    buffer_load_dwordx4 v[56:59], v2, s[56:59], s70 offen offset:0 nt
    buffer_load_dwordx4 v[60:63], v2, s[56:59], s70 offen offset:1024 nt
    buffer_load_dwordx4 v[64:67], v2, s[56:59], s70 offen offset:2048 nt
    buffer_load_dwordx4 v[68:71], v2, s[56:59], s70 offen offset:3072 nt
    s_add_u32 s70, s70, 28672
    s_waitcnt vmcnt(2)
    buffer_load_dwordx4 v[72:75], v2, s[56:59], s70 offen offset:0 nt
    buffer_load_dwordx4 v[76:79], v2, s[56:59], s70 offen offset:1024 nt
    buffer_load_dwordx4 v[80:83], v2, s[56:59], s70 offen offset:2048 nt
    buffer_load_dwordx4 v[84:87], v2, s[56:59], s70 offen offset:3072 nt
    s_add_u32 s70, s70, 4096
    s_waitcnt vmcnt(2)
    buffer_load_dwordx4 v[88:91], v2, s[56:59], s70 offen offset:0 nt
    buffer_load_dwordx4 v[92:95], v2, s[56:59], s70 offen offset:1024 nt
    buffer_load_dwordx4 v[96:99], v2, s[56:59], s70 offen offset:2048 nt
    buffer_load_dwordx4 v[100:103], v2, s[56:59], s70 offen offset:3072 nt
    s_add_u32 s70, s70, 28672
    s_waitcnt vmcnt(2)
    buffer_load_dwordx4 v[104:107], v2, s[56:59], s70 offen offset:0 nt
    buffer_load_dwordx4 v[108:111], v2, s[56:59], s70 offen offset:1024 nt
    buffer_load_dwordx4 v[112:115], v2, s[56:59], s70 offen offset:2048 nt
    buffer_load_dwordx4 v[116:119], v2, s[56:59], s70 offen offset:3072 nt
    s_add_u32 s70, s70, 4096
    s_waitcnt vmcnt(2)
    buffer_load_dwordx4 v[120:123], v2, s[56:59], s70 offen offset:0 nt
    buffer_load_dwordx4 v[124:127], v2, s[56:59], s70 offen offset:1024 nt
    buffer_load_dwordx4 v[128:131], v2, s[56:59], s70 offen offset:2048 nt
    buffer_load_dwordx4 v[132:135], v2, s[56:59], s70 offen offset:3072 nt
    s_add_u32 s70, s70, 28672
    s_waitcnt vmcnt(2)
    buffer_load_dwordx4 v[136:139], v2, s[56:59], s70 offen offset:0 nt
    buffer_load_dwordx4 v[140:143], v2, s[56:59], s70 offen offset:1024 nt
    buffer_load_dwordx4 v[144:147], v2, s[56:59], s70 offen offset:2048 nt
    buffer_load_dwordx4 v[148:151], v2, s[56:59], s70 offen offset:3072 nt
    s_add_u32 s70, s70, 4096
    s_waitcnt vmcnt(2)
    buffer_load_dwordx4 v[152:155], v2, s[56:59], s70 offen offset:0 nt
    buffer_load_dwordx4 v[156:159], v2, s[56:59], s70 offen offset:1024 nt
    buffer_load_dwordx4 v[160:163], v2, s[56:59], s70 offen offset:2048 nt
    buffer_load_dwordx4 v[164:167], v2, s[56:59], s70 offen offset:3072 nt
    s_add_u32 s70, s70, 28672
    s_waitcnt vmcnt(0)
    s_branch S2J_71
S2U_70:
    buffer_load_dwordx4 v[40:43], v2, s[56:59], s70 offen offset:0 nt
    buffer_load_dwordx4 v[44:47], v2, s[56:59], s70 offen offset:1024 nt
    buffer_load_dwordx4 v[48:51], v2, s[56:59], s70 offen offset:2048 nt
    buffer_load_dwordx4 v[52:55], v2, s[56:59], s70 offen offset:3072 nt
    s_add_u32 s70, s70, 4096
    s_waitcnt vmcnt(2)
    buffer_load_dwordx4 v[56:59], v2, s[56:59], s70 offen offset:0 nt
    buffer_load_dwordx4 v[60:63], v2, s[56:59], s70 offen offset:1024 nt
    buffer_load_dwordx4 v[64:67], v2, s[56:59], s70 offen offset:2048 nt
    buffer_load_dwordx4 v[68:71], v2, s[56:59], s70 offen offset:3072 nt
    s_add_u32 s70, s70, 28672
    s_waitcnt vmcnt(2)
    buffer_load_dwordx4 v[72:75], v2, s[56:59], s70 offen offset:0 nt
    buffer_load_dwordx4 v[76:79], v2, s[56:59], s70 offen offset:1024 nt
    buffer_load_dwordx4 v[80:83], v2, s[56:59], s70 offen offset:2048 nt
    buffer_load_dwordx4 v[84:87], v2, s[56:59], s70 offen offset:3072 nt
    s_add_u32 s70, s70, 4096
    s_waitcnt vmcnt(2)
    buffer_load_dwordx4 v[88:91], v2, s[56:59], s70 offen offset:0 nt
    buffer_load_dwordx4 v[92:95], v2, s[56:59], s70 offen offset:1024 nt
    buffer_load_dwordx4 v[96:99], v2, s[56:59], s70 offen offset:2048 nt
    buffer_load_dwordx4 v[100:103], v2, s[56:59], s70 offen offset:3072 nt
    s_add_u32 s70, s70, 28672
    s_waitcnt vmcnt(2)
    buffer_load_dwordx4 v[104:107], v2, s[56:59], s70 offen offset:0 nt
    buffer_load_dwordx4 v[108:111], v2, s[56:59], s70 offen offset:1024 nt
    buffer_load_dwordx4 v[112:115], v2, s[56:59], s70 offen offset:2048 nt
    buffer_load_dwordx4 v[116:119], v2, s[56:59], s70 offen offset:3072 nt
    s_add_u32 s70, s70, 4096
    s_waitcnt vmcnt(2)
    buffer_load_dwordx4 v[120:123], v2, s[56:59], s70 offen offset:0 nt
    buffer_load_dwordx4 v[124:127], v2, s[56:59], s70 offen offset:1024 nt
    buffer_load_dwordx4 v[128:131], v2, s[56:59], s70 offen offset:2048 nt
    buffer_load_dwordx4 v[132:135], v2, s[56:59], s70 offen offset:3072 nt
    s_add_u32 s70, s70, 28672
    s_waitcnt vmcnt(2)
    buffer_load_dwordx4 v[136:139], v2, s[56:59], s70 offen offset:0 nt
    buffer_load_dwordx4 v[140:143], v2, s[56:59], s70 offen offset:1024 nt
    buffer_load_dwordx4 v[144:147], v2, s[56:59], s70 offen offset:2048 nt
    buffer_load_dwordx4 v[148:151], v2, s[56:59], s70 offen offset:3072 nt
    s_add_u32 s70, s70, 4096
    s_waitcnt vmcnt(2)
    buffer_load_dwordx4 v[152:155], v2, s[56:59], s70 offen offset:0 nt
    buffer_load_dwordx4 v[156:159], v2, s[56:59], s70 offen offset:1024 nt
    buffer_load_dwordx4 v[160:163], v2, s[56:59], s70 offen offset:2048 nt
    buffer_load_dwordx4 v[164:167], v2, s[56:59], s70 offen offset:3072 nt
    s_add_u32 s70, s70, 28672
    s_waitcnt vmcnt(0)
S2J_71:
    v_perm_b32 v8, v44, v40, s92
    v_perm_b32 v9, v52, v48, s92
    v_perm_b32 v10, v60, v56, s92
    v_perm_b32 v11, v68, v64, s92
    v_perm_b32 v12, v44, v40, s93
    v_perm_b32 v13, v52, v48, s93
    v_perm_b32 v14, v60, v56, s93
    v_perm_b32 v15, v68, v64, s93
    v_perm_b32 v16, v45, v41, s92
    v_perm_b32 v17, v53, v49, s92
    v_perm_b32 v18, v61, v57, s92
    v_perm_b32 v19, v69, v65, s92
    v_perm_b32 v20, v45, v41, s93
    v_perm_b32 v21, v53, v49, s93
    v_perm_b32 v22, v61, v57, s93
    v_perm_b32 v23, v69, v65, s93
    v_perm_b32 v24, v46, v42, s92
    v_perm_b32 v25, v54, v50, s92
    v_perm_b32 v26, v62, v58, s92
    v_perm_b32 v27, v70, v66, s92
    v_perm_b32 v28, v46, v42, s93
    v_perm_b32 v29, v54, v50, s93
    v_perm_b32 v30, v62, v58, s93
    v_perm_b32 v31, v70, v66, s93
    v_perm_b32 v32, v47, v43, s92
    v_perm_b32 v33, v55, v51, s92
    v_perm_b32 v34, v63, v59, s92
    v_perm_b32 v35, v71, v67, s92
    v_perm_b32 v36, v47, v43, s93
    v_perm_b32 v37, v55, v51, s93
    v_perm_b32 v38, v63, v59, s93
    v_perm_b32 v39, v71, v67, s93
    v_perm_b32 v40, v76, v72, s92
    v_perm_b32 v41, v84, v80, s92
    v_perm_b32 v42, v92, v88, s92
    v_perm_b32 v43, v100, v96, s92
    v_perm_b32 v44, v76, v72, s93
    v_perm_b32 v45, v84, v80, s93
    v_perm_b32 v46, v92, v88, s93
    v_perm_b32 v47, v100, v96, s93
    v_perm_b32 v48, v77, v73, s92
    v_perm_b32 v49, v85, v81, s92
    v_perm_b32 v50, v93, v89, s92
    v_perm_b32 v51, v101, v97, s92
    v_perm_b32 v52, v77, v73, s93
    v_perm_b32 v53, v85, v81, s93
    v_perm_b32 v54, v93, v89, s93
    v_perm_b32 v55, v101, v97, s93
    v_perm_b32 v56, v78, v74, s92
    v_perm_b32 v57, v86, v82, s92
    v_perm_b32 v58, v94, v90, s92
    v_perm_b32 v59, v102, v98, s92
    v_perm_b32 v60, v78, v74, s93
    v_perm_b32 v61, v86, v82, s93
    v_perm_b32 v62, v94, v90, s93
    v_perm_b32 v63, v102, v98, s93
    v_perm_b32 v64, v79, v75, s92
    v_perm_b32 v65, v87, v83, s92
    v_perm_b32 v66, v95, v91, s92
    v_perm_b32 v67, v103, v99, s92
    v_perm_b32 v68, v79, v75, s93
    v_perm_b32 v69, v87, v83, s93
    v_perm_b32 v70, v95, v91, s93
    v_perm_b32 v71, v103, v99, s93
    v_perm_b32 v72, v108, v104, s92
    v_perm_b32 v73, v116, v112, s92
    v_perm_b32 v74, v124, v120, s92
    v_perm_b32 v75, v132, v128, s92
    v_perm_b32 v76, v108, v104, s93
    v_perm_b32 v77, v116, v112, s93
    v_perm_b32 v78, v124, v120, s93
    v_perm_b32 v79, v132, v128, s93
    v_perm_b32 v80, v109, v105, s92
    v_perm_b32 v81, v117, v113, s92
    v_perm_b32 v82, v125, v121, s92
    v_perm_b32 v83, v133, v129, s92
    v_perm_b32 v84, v109, v105, s93
    v_perm_b32 v85, v117, v113, s93
    v_perm_b32 v86, v125, v121, s93
    v_perm_b32 v87, v133, v129, s93
    v_perm_b32 v88, v110, v106, s92
    v_perm_b32 v89, v118, v114, s92
    v_perm_b32 v90, v126, v122, s92
    v_perm_b32 v91, v134, v130, s92
    v_perm_b32 v92, v110, v106, s93
    v_perm_b32 v93, v118, v114, s93
    v_perm_b32 v94, v126, v122, s93
    v_perm_b32 v95, v134, v130, s93
    v_perm_b32 v96, v111, v107, s92
    v_perm_b32 v97, v119, v115, s92
    v_perm_b32 v98, v127, v123, s92
    v_perm_b32 v99, v135, v131, s92
    v_perm_b32 v100, v111, v107, s93
    v_perm_b32 v101, v119, v115, s93
    v_perm_b32 v102, v127, v123, s93
    v_perm_b32 v103, v135, v131, s93
    v_perm_b32 v104, v140, v136, s92
    v_perm_b32 v105, v148, v144, s92
    v_perm_b32 v106, v156, v152, s92
    v_perm_b32 v107, v164, v160, s92
    v_perm_b32 v108, v140, v136, s93
    v_perm_b32 v109, v148, v144, s93
    v_perm_b32 v110, v156, v152, s93
    v_perm_b32 v111, v164, v160, s93
    v_perm_b32 v112, v141, v137, s92
    v_perm_b32 v113, v149, v145, s92
    v_perm_b32 v114, v157, v153, s92
    v_perm_b32 v115, v165, v161, s92
    v_perm_b32 v116, v141, v137, s93
    v_perm_b32 v117, v149, v145, s93
    v_perm_b32 v118, v157, v153, s93
    v_perm_b32 v119, v165, v161, s93
    v_perm_b32 v120, v142, v138, s92
    v_perm_b32 v121, v150, v146, s92
    v_perm_b32 v122, v158, v154, s92
    v_perm_b32 v123, v166, v162, s92
    v_perm_b32 v124, v142, v138, s93
    v_perm_b32 v125, v150, v146, s93
    v_perm_b32 v126, v158, v154, s93
    v_perm_b32 v127, v166, v162, s93
    v_perm_b32 v128, v143, v139, s92
    v_perm_b32 v129, v151, v147, s92
    v_perm_b32 v130, v159, v155, s92
    v_perm_b32 v131, v167, v163, s92
    v_perm_b32 v132, v143, v139, s93
    v_perm_b32 v133, v151, v147, s93
    v_perm_b32 v134, v159, v155, s93
    v_perm_b32 v135, v167, v163, s93
    v_mov_b32 v160, 0x2404c
    s_mov_b32 s80, 1600000
LW_76:
    ds_read_b32 v161, v160
    s_waitcnt lgkmcnt(0)
    v_readfirstlane_b32 s79, v161
    s_cmp_ge_u32 s79, 1
    s_cbranch_scc1 LWD_77
    s_sleep 2
    s_sub_u32 s80, s80, 1
    s_cmp_lg_u32 s80, 0
    s_cbranch_scc1 LW_76
LWD_77:
    v_mov_b32 v160, 0x24050
    ds_read_b64 v[162:163], v160
    s_waitcnt lgkmcnt(0)
    v_readfirstlane_b32 s94, v162
    v_readfirstlane_b32 s95, v163
    v_bfe_u32 v4, v1, 2, 2
    v_lshlrev_b32 v4, 8, v4
    v_lshrrev_b32 v160, 4, v1
    v_lshl_add_u32 v4, v160, 4, v4
    s_mov_b32 s70, 4096
    s_cmp_ge_u32 s5, 4
    s_cbranch_scc1 S2X_78
    v_add_u32 v4, 0x24400, v4
    s_cmp_lg_u32 s3, 8
    s_cbranch_scc1 U8_80
    v_and_b32 v5, 15, v1
    v_lshl_add_u32 v5, v5, 2, v160
    s_lshl_b32 s7, s6, 4
    s_add_u32 s7, s7, 0xe0000
    v_lshl_add_u32 v5, v5, 9, s7
    v_lshlrev_b32 v6, 4, v1
    v_add_u32 v6, 0x24800, v6
    s_mov_b32 s80, 200000
PO_81:
    buffer_load_dwordx4 v[136:139], v5, s[36:39], 0 offen sc1
PO2_82:
    s_waitcnt vmcnt(0)
    v_cmp_ne_u64 vcc, s[94:95], v[138:139]
    s_cmp_lg_u64 vcc, -1
    s_cbranch_scc1 POD_83
    s_sleep 16
    s_sub_u32 s80, s80, 1
    s_cmp_lg_u32 s80, 0
    s_cbranch_scc1 PO_81
POD_83:
    s_setprio 3
    ds_write_b128 v6, v[136:139]
    v_mov_b32 v160, 0x2401c
    v_mov_b32 v161, 1
    s_waitcnt lgkmcnt(0)
    s_mov_b64 exec, 1
    ds_add_u32 v160, v161
    s_mov_b64 exec, -1
    s_cbranch_vccz U8D_85
    buffer_load_dwordx4 v[136:139], v5, s[36:39], 0 offen sc1
    s_sleep 4
    buffer_load_dwordx4 v[140:143], v5, s[36:39], 0 offen sc1
    s_sleep 4
    s_mov_b32 s80, 200000
U8P_84:
    s_waitcnt vmcnt(1)
    ds_write_b128 v6, v[136:139]
    v_cmp_ne_u64 vcc, s[94:95], v[138:139]
    s_cbranch_vccz U8D_85
    s_waitcnt lgkmcnt(0)
    buffer_load_dwordx4 v[136:139], v5, s[36:39], 0 offen sc1
    s_waitcnt vmcnt(1)
    ds_write_b128 v6, v[140:143]
    v_cmp_ne_u64 vcc, s[94:95], v[142:143]
    s_cbranch_vccz U8D_85
    s_waitcnt lgkmcnt(0)
    buffer_load_dwordx4 v[140:143], v5, s[36:39], 0 offen sc1
    s_sub_u32 s80, s80, 1
    s_cmp_lg_u32 s80, 0
    s_cbranch_scc1 U8P_84
U8D_85:
    s_waitcnt vmcnt(0)
U8_80:
    v_mov_b32 v160, 0x24020
    s_mov_b32 s80, 1600000
LW_86:
    ds_read_b32 v161, v160
    s_waitcnt lgkmcnt(0)
    v_readfirstlane_b32 s79, v161
    s_cmp_ge_u32 s79, 8
    s_cbranch_scc1 LWD_87
    s_sleep 1
    s_sub_u32 s80, s80, 1
    s_cmp_lg_u32 s80, 0
    s_cbranch_scc1 LW_86
LWD_87:
    s_setprio 3
    ds_read_b128 v[136:139], v4 offset:0
    ds_read_b128 v[140:143], v4 offset:64
    ds_read_b128 v[144:147], v4 offset:128
    ds_read_b128 v[148:151], v4 offset:192
    s_waitcnt lgkmcnt(0)
    s_branch S2M_79
S2X_78:
    v_and_b32 v160, 3, v1
    v_lshl_add_u32 v4, v160, 6, v4
    s_lshl_b32 s7, s6, 11
    s_add_u32 s7, s7, 0xd0000
    v_add_u32 v4, s7, v4
    s_mov_b32 s80, 200000
PO_88:
    buffer_load_dwordx4 v[152:155], v4, s[36:39], 0 offen offset:0 sc1
PO2_89:
    s_waitcnt vmcnt(0)
    v_cmp_ne_u64 vcc, s[94:95], v[154:155]
    s_cmp_lg_u64 vcc, -1
    s_cbranch_scc1 POD_90
    s_sleep 8
    s_sub_u32 s80, s80, 1
    s_cmp_lg_u32 s80, 0
    s_cbranch_scc1 PO_88
POD_90:
    s_setprio 3
    buffer_load_dwordx4 v[152:155], v4, s[36:39], 0 offen offset:0 sc1
    buffer_load_dwordx4 v[156:159], v4, s[36:39], 0 offen offset:1024 sc1
    s_sleep 4
    buffer_load_dwordx4 v[160:163], v4, s[36:39], 0 offen offset:0 sc1
    buffer_load_dwordx4 v[164:167], v4, s[36:39], 0 offen offset:1024 sc1
    s_sleep 4
    s_mov_b32 s80, 200000
PP_91:
    s_waitcnt vmcnt(2)
    v_cmp_ne_u64 vcc, s[94:95], v[154:155]
    v_cmp_ne_u64 s[84:85], s[94:95], v[158:159]
    s_or_b64 vcc, vcc, s[84:85]
    s_cmp_eq_u64 vcc, 0
    s_cbranch_scc1 PPO_93
    buffer_load_dwordx4 v[152:155], v4, s[36:39], 0 offen offset:0 sc1
    buffer_load_dwordx4 v[156:159], v4, s[36:39], 0 offen offset:1024 sc1
    s_waitcnt vmcnt(2)
    v_cmp_ne_u64 vcc, s[94:95], v[162:163]
    v_cmp_ne_u64 s[84:85], s[94:95], v[166:167]
    s_or_b64 vcc, vcc, s[84:85]
    s_cmp_eq_u64 vcc, 0
    s_cbranch_scc1 PPO_94
    buffer_load_dwordx4 v[160:163], v4, s[36:39], 0 offen offset:0 sc1
    buffer_load_dwordx4 v[164:167], v4, s[36:39], 0 offen offset:1024 sc1
    s_sub_u32 s80, s80, 1
    s_cmp_lg_u32 s80, 0
    s_cbranch_scc1 PP_91
PPO_93:
    v_mov_b32_dpp v136, v152 quad_perm:[0,0,0,0] row_mask:0xf bank_mask:0xf
    v_mov_b32_dpp v137, v153 quad_perm:[0,0,0,0] row_mask:0xf bank_mask:0xf
    v_mov_b32_dpp v138, v156 quad_perm:[0,0,0,0] row_mask:0xf bank_mask:0xf
    v_mov_b32_dpp v139, v157 quad_perm:[0,0,0,0] row_mask:0xf bank_mask:0xf
    v_mov_b32_dpp v140, v152 quad_perm:[1,1,1,1] row_mask:0xf bank_mask:0xf
    v_mov_b32_dpp v141, v153 quad_perm:[1,1,1,1] row_mask:0xf bank_mask:0xf
    v_mov_b32_dpp v142, v156 quad_perm:[1,1,1,1] row_mask:0xf bank_mask:0xf
    v_mov_b32_dpp v143, v157 quad_perm:[1,1,1,1] row_mask:0xf bank_mask:0xf
    v_mov_b32_dpp v144, v152 quad_perm:[2,2,2,2] row_mask:0xf bank_mask:0xf
    v_mov_b32_dpp v145, v153 quad_perm:[2,2,2,2] row_mask:0xf bank_mask:0xf
    v_mov_b32_dpp v146, v156 quad_perm:[2,2,2,2] row_mask:0xf bank_mask:0xf
    v_mov_b32_dpp v147, v157 quad_perm:[2,2,2,2] row_mask:0xf bank_mask:0xf
    v_mov_b32_dpp v148, v152 quad_perm:[3,3,3,3] row_mask:0xf bank_mask:0xf
    v_mov_b32_dpp v149, v153 quad_perm:[3,3,3,3] row_mask:0xf bank_mask:0xf
    v_mov_b32_dpp v150, v156 quad_perm:[3,3,3,3] row_mask:0xf bank_mask:0xf
    v_mov_b32_dpp v151, v157 quad_perm:[3,3,3,3] row_mask:0xf bank_mask:0xf
    s_branch PPD_92
PPO_94:
    v_mov_b32_dpp v136, v160 quad_perm:[0,0,0,0] row_mask:0xf bank_mask:0xf
    v_mov_b32_dpp v137, v161 quad_perm:[0,0,0,0] row_mask:0xf bank_mask:0xf
    v_mov_b32_dpp v138, v164 quad_perm:[0,0,0,0] row_mask:0xf bank_mask:0xf
    v_mov_b32_dpp v139, v165 quad_perm:[0,0,0,0] row_mask:0xf bank_mask:0xf
    v_mov_b32_dpp v140, v160 quad_perm:[1,1,1,1] row_mask:0xf bank_mask:0xf
    v_mov_b32_dpp v141, v161 quad_perm:[1,1,1,1] row_mask:0xf bank_mask:0xf
    v_mov_b32_dpp v142, v164 quad_perm:[1,1,1,1] row_mask:0xf bank_mask:0xf
    v_mov_b32_dpp v143, v165 quad_perm:[1,1,1,1] row_mask:0xf bank_mask:0xf
    v_mov_b32_dpp v144, v160 quad_perm:[2,2,2,2] row_mask:0xf bank_mask:0xf
    v_mov_b32_dpp v145, v161 quad_perm:[2,2,2,2] row_mask:0xf bank_mask:0xf
    v_mov_b32_dpp v146, v164 quad_perm:[2,2,2,2] row_mask:0xf bank_mask:0xf
    v_mov_b32_dpp v147, v165 quad_perm:[2,2,2,2] row_mask:0xf bank_mask:0xf
    v_mov_b32_dpp v148, v160 quad_perm:[3,3,3,3] row_mask:0xf bank_mask:0xf
    v_mov_b32_dpp v149, v161 quad_perm:[3,3,3,3] row_mask:0xf bank_mask:0xf
    v_mov_b32_dpp v150, v164 quad_perm:[3,3,3,3] row_mask:0xf bank_mask:0xf
    v_mov_b32_dpp v151, v165 quad_perm:[3,3,3,3] row_mask:0xf bank_mask:0xf
PPD_92:
S2M_79:
    s_nop 1
    v_mfma_f32_16x16x32_bf16 v[4:7], v[136:139], v[8:11], 0
    v_mfma_f32_16x16x32_bf16 v[4:7], v[140:143], v[40:43], v[4:7]
    v_mfma_f32_16x16x32_bf16 v[4:7], v[144:147], v[72:75], v[4:7]
    v_mfma_f32_16x16x32_bf16 v[4:7], v[148:151], v[104:107], v[4:7]
    v_mfma_f32_16x16x32_bf16 v[8:11], v[136:139], v[12:15], 0
    v_mfma_f32_16x16x32_bf16 v[8:11], v[140:143], v[44:47], v[8:11]
    v_mfma_f32_16x16x32_bf16 v[8:11], v[144:147], v[76:79], v[8:11]
    v_mfma_f32_16x16x32_bf16 v[8:11], v[148:151], v[108:111], v[8:11]
    v_mfma_f32_16x16x32_bf16 v[12:15], v[136:139], v[16:19], 0
    v_mfma_f32_16x16x32_bf16 v[12:15], v[140:143], v[48:51], v[12:15]
    v_mfma_f32_16x16x32_bf16 v[12:15], v[144:147], v[80:83], v[12:15]
    v_mfma_f32_16x16x32_bf16 v[12:15], v[148:151], v[112:115], v[12:15]
    v_mfma_f32_16x16x32_bf16 v[16:19], v[136:139], v[20:23], 0
    v_mfma_f32_16x16x32_bf16 v[16:19], v[140:143], v[52:55], v[16:19]
    v_mfma_f32_16x16x32_bf16 v[16:19], v[144:147], v[84:87], v[16:19]
    v_mfma_f32_16x16x32_bf16 v[16:19], v[148:151], v[116:119], v[16:19]
    v_mfma_f32_16x16x32_bf16 v[20:23], v[136:139], v[24:27], 0
    v_mfma_f32_16x16x32_bf16 v[20:23], v[140:143], v[56:59], v[20:23]
    v_mfma_f32_16x16x32_bf16 v[20:23], v[144:147], v[88:91], v[20:23]
    v_mfma_f32_16x16x32_bf16 v[20:23], v[148:151], v[120:123], v[20:23]
    v_mfma_f32_16x16x32_bf16 v[24:27], v[136:139], v[28:31], 0
    v_mfma_f32_16x16x32_bf16 v[24:27], v[140:143], v[60:63], v[24:27]
    v_mfma_f32_16x16x32_bf16 v[24:27], v[144:147], v[92:95], v[24:27]
    v_mfma_f32_16x16x32_bf16 v[24:27], v[148:151], v[124:127], v[24:27]
    v_mfma_f32_16x16x32_bf16 v[28:31], v[136:139], v[32:35], 0
    v_mfma_f32_16x16x32_bf16 v[28:31], v[140:143], v[64:67], v[28:31]
    v_mfma_f32_16x16x32_bf16 v[28:31], v[144:147], v[96:99], v[28:31]
    v_mfma_f32_16x16x32_bf16 v[28:31], v[148:151], v[128:131], v[28:31]
    v_mfma_f32_16x16x32_bf16 v[32:35], v[136:139], v[36:39], 0
    v_mfma_f32_16x16x32_bf16 v[32:35], v[140:143], v[68:71], v[32:35]
    v_mfma_f32_16x16x32_bf16 v[32:35], v[144:147], v[100:103], v[32:35]
    v_mfma_f32_16x16x32_bf16 v[32:35], v[148:151], v[132:135], v[32:35]
    v_mov_b32 v42, s94
    v_mov_b32 v43, s95
    v_cvt_pk_bf16_f32 v40, v4, v8
    v_cvt_pk_bf16_f32 v41, v12, v16
    buffer_store_dwordx4 v[40:43], v3, s[36:39], 0 offen sc1
    v_mov_b32 v46, s94
    v_mov_b32 v47, s95
    v_cvt_pk_bf16_f32 v44, v20, v24
    v_cvt_pk_bf16_f32 v45, v28, v32
    buffer_store_dwordx4 v[44:47], v3, s[36:39], s70 offen sc1
    s_endpgm
L_C:
    v_and_b32 v1, 63, v0
    s_and_b32 s7, s5, 3
    s_lshl_b32 s6, s4, 2
    s_add_u32 s6, s6, s7
    s_mov_b32 s92, 0x05040100
    s_mov_b32 s93, 0x07060302
    s_waitcnt lgkmcnt(0)
    s_mov_b32 s36, s34
    s_and_b32 s37, s35, 0xffff
    s_mov_b32 s38, 0x1000000
    s_mov_b32 s39, 0x20000
    s_mov_b32 s40, s32
    s_and_b32 s41, s33, 0xffff
    s_mov_b32 s42, 0x100
    s_mov_b32 s43, 0x20000
    s_mov_b32 s44, s20
    s_and_b32 s45, s21, 0xffff
    s_mov_b32 s46, 0x1000000
    s_mov_b32 s47, 0x20000
    s_lshl_b32 s60, s4, 3
    s_add_u32 s60, s60, s5
    s_sub_u32 s60, s60, 8
    s_lshr_b32 s64, s3, 1
    s_and_b32 s65, s3, 1
    s_mov_b32 s67, 0x3e0293ee
    v_lshlrev_b32 v160, 4, v1
    s_and_b32 s7, s3, 3
    s_lshl_b32 s7, s7, 2
    s_lshr_b32 s66, s3, 2
    s_or_b32 s7, s7, s66
    s_lshl_b32 s62, s7, 4
    v_xor_b32 v2, s62, v160
    v_xor_b32 v3, 32, v2
    s_lshl_b32 s70, s60, 18
    s_lshl_b32 s68, s3, 10
    s_add_u32 s61, s70, s68
    s_mov_b32 m0, s68
    s_nop 0
    buffer_load_dwordx4 v2, s[44:47], s61 offen nt lds
    s_add_u32 s68, s68, 8192
    s_add_u32 s61, s61, 8192
    s_mov_b32 m0, s68
    s_nop 0
    buffer_load_dwordx4 v3, s[44:47], s61 offen nt lds
    s_add_u32 s68, s68, 8192
    s_add_u32 s61, s61, 8192
    s_mov_b32 m0, s68
    s_nop 0
    buffer_load_dwordx4 v2, s[44:47], s61 offen nt lds
    s_add_u32 s68, s68, 8192
    s_barrier
    s_add_u32 s61, s61, 8192
    s_mov_b32 m0, s68
    s_nop 0
    buffer_load_dwordx4 v3, s[44:47], s61 offen nt lds
    s_add_u32 s68, s68, 8192
    s_add_u32 s61, s61, 8192
    s_mov_b32 m0, s68
    s_waitcnt vmcnt(3)
    buffer_load_dwordx4 v2, s[44:47], s61 offen nt lds
    s_add_u32 s68, s68, 8192
    s_add_u32 s61, s61, 8192
    s_mov_b32 m0, s68
    s_waitcnt vmcnt(3)
    buffer_load_dwordx4 v3, s[44:47], s61 offen nt lds
    s_add_u32 s68, s68, 8192
    s_add_u32 s61, s61, 8192
    s_mov_b32 m0, s68
    s_waitcnt vmcnt(3)
    buffer_load_dwordx4 v2, s[44:47], s61 offen nt lds
    s_add_u32 s68, s68, 8192
    s_add_u32 s61, s61, 8192
    s_mov_b32 m0, s68
    s_waitcnt vmcnt(3)
    buffer_load_dwordx4 v3, s[44:47], s61 offen nt lds
    s_add_u32 s68, s68, 8192
    s_add_u32 s61, s61, 8192
    s_mov_b32 m0, s68
    s_waitcnt vmcnt(3)
    buffer_load_dwordx4 v2, s[44:47], s61 offen nt lds
    s_add_u32 s68, s68, 8192
    s_add_u32 s61, s61, 8192
    s_mov_b32 m0, s68
    s_waitcnt vmcnt(3)
    buffer_load_dwordx4 v3, s[44:47], s61 offen nt lds
    s_add_u32 s68, s68, 8192
    s_add_u32 s61, s61, 8192
    s_mov_b32 m0, s68
    s_waitcnt vmcnt(3)
    buffer_load_dwordx4 v2, s[44:47], s61 offen nt lds
    s_add_u32 s68, s68, 8192
    s_add_u32 s61, s61, 8192
    s_mov_b32 m0, s68
    s_waitcnt vmcnt(3)
    buffer_load_dwordx4 v3, s[44:47], s61 offen nt lds
    s_add_u32 s68, s68, 8192
    s_add_u32 s61, s61, 8192
    s_waitcnt vmcnt(3)
    buffer_load_dwordx4 v[128:131], v2, s[44:47], s61 offen nt
    s_add_u32 s61, s61, 8192
    s_waitcnt vmcnt(3)
    buffer_load_dwordx4 v[132:135], v3, s[44:47], s61 offen nt
    s_add_u32 s61, s61, 8192
    s_waitcnt vmcnt(3)
    buffer_load_dwordx4 v[136:139], v2, s[44:47], s61 offen nt
    s_add_u32 s61, s61, 8192
    s_waitcnt vmcnt(3)
    buffer_load_dwordx4 v[140:143], v3, s[44:47], s61 offen nt
    s_add_u32 s61, s61, 8192
    s_waitcnt vmcnt(3)
    buffer_load_dwordx4 v[96:99], v2, s[44:47], s61 offen nt
    s_add_u32 s61, s61, 8192
    s_waitcnt vmcnt(3)
    buffer_load_dwordx4 v[100:103], v3, s[44:47], s61 offen nt
    s_add_u32 s61, s61, 8192
    s_waitcnt vmcnt(3)
    buffer_load_dwordx4 v[104:107], v2, s[44:47], s61 offen nt
    s_add_u32 s61, s61, 8192
    s_waitcnt vmcnt(3)
    buffer_load_dwordx4 v[108:111], v3, s[44:47], s61 offen nt
    s_add_u32 s61, s61, 8192
    s_waitcnt vmcnt(3)
    buffer_load_dwordx4 v[112:115], v2, s[44:47], s61 offen nt
    s_add_u32 s61, s61, 8192
    s_waitcnt vmcnt(3)
    buffer_load_dwordx4 v[116:119], v3, s[44:47], s61 offen nt
    s_add_u32 s61, s61, 8192
    v_mov_b32 v160, 0x24018
    v_mov_b32 v161, 1
    s_waitcnt lgkmcnt(0)
    s_mov_b64 exec, 1
    ds_add_u32 v160, v161
    s_mov_b64 exec, -1
    s_waitcnt vmcnt(3)
    buffer_load_dwordx4 v[120:123], v2, s[44:47], s61 offen nt
    s_add_u32 s61, s61, 8192
    s_waitcnt vmcnt(3)
    buffer_load_dwordx4 v[124:127], v3, s[44:47], s61 offen nt
    s_add_u32 s61, s61, 8192
    v_and_b32 v160, 15, v1
    v_lshlrev_b32 v4, 10, v160
    v_lshrrev_b32 v161, 4, v1
    v_lshl_add_u32 v4, v161, 8, v4
    v_lshl_add_u32 v3, v160, 4, v4
    s_lshl_b32 s7, s65, 14
    s_add_u32 s7, s7, 0x18000
    v_add_u32 v3, s7, v3
    v_and_b32 v162, 3, v1
    v_lshl_add_u32 v4, v162, 6, v4
    v_bfe_u32 v162, v1, 2, 2
    v_lshl_add_u32 v4, v162, 4, v4
    s_lshl_b32 s7, s64, 14
    v_add_u32 v4, s7, v4
    v_add_u32 v2, 0x10000, v4
    s_lshl_b32 s7, s65, 6
    s_add_u32 s7, s7, 0x27200
    v_lshl_add_u32 v5, v160, 2, s7
    s_lshl_b32 s7, s64, 10
    s_lshl_b32 s66, s65, 9
    s_add_u32 s7, s7, s66
    s_add_u32 s7, s7, 0x25200
    v_lshl_add_u32 v6, v160, 5, s7
    v_lshl_add_u32 v6, v161, 3, v6
    v_and_b32 v162, 31, v1
    v_lshlrev_b32 v7, 5, v162
    v_lshrrev_b32 v163, 5, v1
    v_lshl_add_u32 v7, v163, 4, v7
    v_add_u32 v7, 0x25200, v7
    v_lshlrev_b32 v8, 2, v162
    v_add_u32 v8, 0x27e00, v8
    v_bfe_u32 v162, v1, 2, 2
    v_lshl_add_u32 v164, v163, 3, v162
    v_lshlrev_b32 v164, 10, v164
    v_and_b32 v165, 1, v1
    v_lshl_add_u32 v164, v165, 3, v164
    s_lshl_b32 s7, s64, 8
    v_add_u32 v164, s7, v164
    v_bfe_u32 v165, v1, 4, 1
    v_lshlrev_b32 v165, 1, v165
    v_bfe_u32 v160, v1, 1, 1
    v_or_b32 v165, v165, v160
    s_lshl_b32 s7, s65, 3
    v_or_b32 v165, s7, v165
    v_lshlrev_b32 v162, 2, v162
    v_xor_b32 v165, v165, v162
    v_lshlrev_b32 v163, 1, v163
    v_xor_b32 v165, v165, v163
    v_xor_b32 v160, 0, v165
    v_lshl_add_u32 v9, v160, 4, v164
    v_xor_b32 v160, 4, v165
    v_lshl_add_u32 v10, v160, 4, v164
    v_xor_b32 v160, 1, v165
    v_lshl_add_u32 v11, v160, 4, v164
    v_add_u32 v11, 0x1000, v11
    v_xor_b32 v160, 5, v165
    v_lshl_add_u32 v12, v160, 4, v164
    v_add_u32 v12, 0x1000, v12
    v_mov_b32 v13, 0xff800000
    v_mov_b32 v14, 0
    v_cmp_gt_u32 s[86:87], 16, v1
    s_cmp_eq_u32 s64, 0
    s_cselect_b32 s88, 0xffff, 0
    s_mov_b32 s89, 0
    s_barrier
    v_xor_b32 v160, 0x0, v3
    ds_read_b128 v[32:35], v160
    v_xor_b32 v161, 0x10, v3
    ds_read_b128 v[36:39], v161
    v_xor_b32 v160, 0x20, v3
    ds_read_b128 v[40:43], v160
    v_xor_b32 v161, 0x30, v3
    ds_read_b128 v[44:47], v161
    v_xor_b32 v160, 0x40, v3
    ds_read_b128 v[48:51], v160
    v_xor_b32 v161, 0x50, v3
    ds_read_b128 v[52:55], v161
    v_xor_b32 v160, 0x60, v3
    ds_read_b128 v[56:59], v160
    v_xor_b32 v161, 0x70, v3
    ds_read_b128 v[60:63], v161
    v_xor_b32 v160, 0x80, v3
    ds_read_b128 v[64:67], v160
    v_xor_b32 v161, 0x90, v3
    ds_read_b128 v[68:71], v161
    v_xor_b32 v160, 0xa0, v3
    ds_read_b128 v[72:75], v160
    v_xor_b32 v161, 0xb0, v3
    ds_read_b128 v[76:79], v161
    v_xor_b32 v160, 0xc0, v3
    ds_read_b128 v[80:83], v160
    v_xor_b32 v161, 0xd0, v3
    ds_read_b128 v[84:87], v161
    v_xor_b32 v160, 0xe0, v3
    ds_read_b128 v[88:91], v160
    v_xor_b32 v161, 0xf0, v3
    ds_read_b128 v[92:95], v161
    s_lshl_b32 s7, s3, 10
    s_add_u32 s7, s7, 0x18000
    v_lshl_add_u32 v3, v1, 4, s7
    s_waitcnt lgkmcnt(0)
    s_barrier
    ds_write_b128 v3, v[128:131] offset:0
    ds_write_b128 v3, v[132:135] offset:8192
    ds_write_b128 v3, v[136:139] offset:16384
    ds_write_b128 v3, v[140:143] offset:24576
    v_xor_b32 v160, 0x0, v4
    ds_read_b128 v[24:27], v160
    v_xor_b32 v161, 0x10, v4
    ds_read_b128 v[28:31], v161
    v_xor_b32 v162, 0x20, v4
    ds_read_b128 v[164:167], v162
    v_xor_b32 v160, 0x30, v4
    ds_read_b128 v[144:147], v160
    v_xor_b32 v161, 0x40, v4
    ds_read_b128 v[148:151], v161
    v_xor_b32 v162, 0x50, v4
    ds_read_b128 v[152:155], v162
    v_xor_b32 v160, 0x60, v4
    ds_read_b128 v[156:159], v160
    s_waitcnt lgkmcnt(6)
    v_mfma_f32_16x16x32_bf16 v[16:19], v[24:27], v[32:35], 0
    v_xor_b32 v161, 0x70, v4
    ds_read_b128 v[24:27], v161
    s_waitcnt lgkmcnt(6)
    v_mfma_f32_16x16x32_bf16 v[16:19], v[28:31], v[36:39], v[16:19]
    v_xor_b32 v162, 0x80, v4
    ds_read_b128 v[28:31], v162
    s_waitcnt lgkmcnt(6)
    v_mfma_f32_16x16x32_bf16 v[16:19], v[164:167], v[40:43], v[16:19]
    v_xor_b32 v160, 0x90, v4
    ds_read_b128 v[164:167], v160
    s_waitcnt lgkmcnt(6)
    v_mfma_f32_16x16x32_bf16 v[16:19], v[144:147], v[44:47], v[16:19]
    v_xor_b32 v161, 0xa0, v4
    ds_read_b128 v[144:147], v161
    s_waitcnt lgkmcnt(6)
    v_mfma_f32_16x16x32_bf16 v[16:19], v[148:151], v[48:51], v[16:19]
    v_xor_b32 v162, 0xb0, v4
    ds_read_b128 v[148:151], v162
    s_waitcnt lgkmcnt(6)
    v_mfma_f32_16x16x32_bf16 v[16:19], v[152:155], v[52:55], v[16:19]
    v_xor_b32 v160, 0xc0, v4
    ds_read_b128 v[152:155], v160
    s_waitcnt lgkmcnt(6)
    v_mfma_f32_16x16x32_bf16 v[16:19], v[156:159], v[56:59], v[16:19]
    v_xor_b32 v161, 0xd0, v4
    ds_read_b128 v[156:159], v161
    s_waitcnt lgkmcnt(6)
    v_mfma_f32_16x16x32_bf16 v[16:19], v[24:27], v[60:63], v[16:19]
    v_xor_b32 v162, 0xe0, v4
    ds_read_b128 v[24:27], v162
    s_waitcnt lgkmcnt(6)
    v_mfma_f32_16x16x32_bf16 v[16:19], v[28:31], v[64:67], v[16:19]
    v_xor_b32 v160, 0xf0, v4
    ds_read_b128 v[28:31], v160
    s_waitcnt lgkmcnt(6)
    v_mfma_f32_16x16x32_bf16 v[16:19], v[164:167], v[68:71], v[16:19]
    s_waitcnt lgkmcnt(5)
    v_mfma_f32_16x16x32_bf16 v[16:19], v[144:147], v[72:75], v[16:19]
    s_waitcnt lgkmcnt(4)
    v_mfma_f32_16x16x32_bf16 v[16:19], v[148:151], v[76:79], v[16:19]
    s_waitcnt lgkmcnt(3)
    v_mfma_f32_16x16x32_bf16 v[16:19], v[152:155], v[80:83], v[16:19]
    s_waitcnt lgkmcnt(2)
    v_mfma_f32_16x16x32_bf16 v[16:19], v[156:159], v[84:87], v[16:19]
    s_waitcnt lgkmcnt(1)
    v_mfma_f32_16x16x32_bf16 v[16:19], v[24:27], v[88:91], v[16:19]
    s_waitcnt lgkmcnt(0)
    v_mfma_f32_16x16x32_bf16 v[16:19], v[28:31], v[92:95], v[16:19]
    s_waitcnt lgkmcnt(0)
    s_barrier
    v_xor_b32 v160, 0x0, v2
    ds_read_b128 v[24:27], v160
    v_xor_b32 v161, 0x10, v2
    ds_read_b128 v[28:31], v161
    v_xor_b32 v162, 0x20, v2
    ds_read_b128 v[164:167], v162
    v_xor_b32 v160, 0x30, v2
    ds_read_b128 v[144:147], v160
    v_xor_b32 v161, 0x40, v2
    ds_read_b128 v[148:151], v161
    v_xor_b32 v162, 0x50, v2
    ds_read_b128 v[152:155], v162
    v_xor_b32 v160, 0x60, v2
    ds_read_b128 v[156:159], v160
    s_waitcnt lgkmcnt(6)
    v_mfma_f32_16x16x32_bf16 v[20:23], v[24:27], v[32:35], 0
    v_xor_b32 v161, 0x70, v2
    ds_read_b128 v[24:27], v161
    s_waitcnt lgkmcnt(6)
    v_mfma_f32_16x16x32_bf16 v[20:23], v[28:31], v[36:39], v[20:23]
    v_xor_b32 v162, 0x80, v2
    ds_read_b128 v[28:31], v162
    s_waitcnt lgkmcnt(6)
    v_mfma_f32_16x16x32_bf16 v[20:23], v[164:167], v[40:43], v[20:23]
    v_xor_b32 v160, 0x90, v2
    ds_read_b128 v[164:167], v160
    s_waitcnt lgkmcnt(6)
    v_mfma_f32_16x16x32_bf16 v[20:23], v[144:147], v[44:47], v[20:23]
    v_xor_b32 v161, 0xa0, v2
    ds_read_b128 v[144:147], v161
    s_waitcnt lgkmcnt(6)
    v_mfma_f32_16x16x32_bf16 v[20:23], v[148:151], v[48:51], v[20:23]
    v_xor_b32 v162, 0xb0, v2
    ds_read_b128 v[148:151], v162
    s_waitcnt lgkmcnt(6)
    v_mfma_f32_16x16x32_bf16 v[20:23], v[152:155], v[52:55], v[20:23]
    v_xor_b32 v160, 0xc0, v2
    ds_read_b128 v[152:155], v160
    s_waitcnt lgkmcnt(6)
    v_mfma_f32_16x16x32_bf16 v[20:23], v[156:159], v[56:59], v[20:23]
    v_xor_b32 v161, 0xd0, v2
    ds_read_b128 v[156:159], v161
    s_waitcnt lgkmcnt(6)
    v_mfma_f32_16x16x32_bf16 v[20:23], v[24:27], v[60:63], v[20:23]
    v_xor_b32 v162, 0xe0, v2
    ds_read_b128 v[24:27], v162
    s_waitcnt lgkmcnt(6)
    v_mfma_f32_16x16x32_bf16 v[20:23], v[28:31], v[64:67], v[20:23]
    v_xor_b32 v160, 0xf0, v2
    ds_read_b128 v[28:31], v160
    s_waitcnt lgkmcnt(6)
    v_mfma_f32_16x16x32_bf16 v[20:23], v[164:167], v[68:71], v[20:23]
    s_waitcnt lgkmcnt(5)
    v_mfma_f32_16x16x32_bf16 v[20:23], v[144:147], v[72:75], v[20:23]
    s_waitcnt lgkmcnt(4)
    v_mfma_f32_16x16x32_bf16 v[20:23], v[148:151], v[76:79], v[20:23]
    s_waitcnt lgkmcnt(3)
    v_mfma_f32_16x16x32_bf16 v[20:23], v[152:155], v[80:83], v[20:23]
    s_waitcnt lgkmcnt(2)
    v_mfma_f32_16x16x32_bf16 v[20:23], v[156:159], v[84:87], v[20:23]
    s_waitcnt lgkmcnt(1)
    v_mfma_f32_16x16x32_bf16 v[20:23], v[24:27], v[88:91], v[20:23]
    s_waitcnt lgkmcnt(0)
    v_mfma_f32_16x16x32_bf16 v[20:23], v[28:31], v[92:95], v[20:23]
    v_max3_f32 v160, v16, v17, v18
    s_nop 6
    v_max3_f32 v160, v160, v19, v20
    v_max3_f32 v160, v160, v21, v22
    v_max_f32 v160, v160, v23
    v_mov_b32 v161, v160
    s_nop 1
    v_permlane32_swap_b32 v160, v161
    v_max_f32 v160, v160, v161
    v_mov_b32 v161, v160
    s_nop 1
    v_permlane16_swap_b32 v160, v161
    v_max_f32 v160, v160, v161
    s_lshl_b32 s7, s64, 7
    v_add_u32 v161, s7, v5
    s_mov_b64 exec, s[86:87]
    ds_write_b32 v161, v160
    s_mov_b64 exec, -1
    s_waitcnt lgkmcnt(0)
    s_barrier
    ds_read_b32 v160, v5 offset:0
    ds_read_b32 v161, v5 offset:128
    ds_read_b32 v162, v5 offset:256
    ds_read_b32 v163, v5 offset:384
    s_waitcnt lgkmcnt(0)
    v_max3_f32 v160, v160, v161, v162
    v_max_f32 v160, v160, v163
    v_mul_f32 v160, s67, v160
    v_max_f32 v160, v160, v13
    v_sub_f32 v161, v13, v160
    v_exp_f32 v161, v161
    v_mov_b32 v13, v160
    v_fma_f32 v16, v16, s67, -v160
    v_fma_f32 v17, v17, s67, -v160
    v_fma_f32 v18, v18, s67, -v160
    v_fma_f32 v19, v19, s67, -v160
    v_fma_f32 v20, v20, s67, -v160
    v_fma_f32 v21, v21, s67, -v160
    v_fma_f32 v22, v22, s67, -v160
    v_fma_f32 v23, v23, s67, -v160
    v_exp_f32 v16, v16
    v_exp_f32 v17, v17
    v_exp_f32 v18, v18
    v_exp_f32 v19, v19
    v_exp_f32 v20, v20
    v_exp_f32 v21, v21
    v_exp_f32 v22, v22
    v_exp_f32 v23, v23
    v_cvt_pk_bf16_f32 v24, v16, v17
    v_cvt_pk_bf16_f32 v25, v18, v19
    v_cvt_pk_bf16_f32 v26, v20, v21
    v_cvt_pk_bf16_f32 v27, v22, v23
    ds_write_b64 v6, v[24:25]
    ds_write_b64 v6, v[26:27] offset:4096
    v_add_u32 v162, 0xc00, v5
    s_mov_b64 exec, s[88:89]
    ds_write_b32 v162, v161
    s_mov_b64 exec, -1
    v_mul_f32 v14, v14, v161
    v_add_f32 v16, v16, v20
    v_add_f32 v17, v17, v21
    v_add_f32 v18, v18, v22
    v_add_f32 v19, v19, v23
    v_add_f32 v16, v16, v18
    v_add_f32 v17, v17, v19
    v_add_f32 v16, v16, v17
    v_add_f32 v14, v14, v16
    v_lshlrev_b32 v3, 4, v1
    v_xor_b32 v3, s62, v3
    v_xor_b32 v15, 32, v3
    s_lshl_b32 s68, s3, 10
    s_waitcnt lgkmcnt(0)
    s_barrier
    ds_read_b128 v[16:19], v7 offset:0
    ds_read_b64_tr_b16 v[24:25], v9 offset:0
    ds_read_b64_tr_b16 v[26:27], v11 offset:0
    ds_read_b64_tr_b16 v[28:29], v10 offset:0
    ds_read_b64_tr_b16 v[30:31], v12 offset:0
    ds_read_b128 v[20:23], v7 offset:1024
    ds_read_b64_tr_b16 v[160:161], v9 offset:16384
    ds_read_b64_tr_b16 v[162:163], v11 offset:16384
    ds_read_b64_tr_b16 v[164:165], v10 offset:16384
    ds_read_b64_tr_b16 v[166:167], v12 offset:16384
    s_waitcnt lgkmcnt(7)
    v_mfma_f32_32x32x16_bf16 v[128:143], v[24:27], v[16:19], 0
    s_waitcnt lgkmcnt(5)
    v_mfma_f32_32x32x16_bf16 v[144:159], v[28:31], v[16:19], 0
    ds_read_b128 v[16:19], v7 offset:2048
    ds_read_b64_tr_b16 v[24:25], v9 offset:32768
    ds_read_b64_tr_b16 v[26:27], v11 offset:32768
    ds_read_b64_tr_b16 v[28:29], v10 offset:32768
    ds_read_b64_tr_b16 v[30:31], v12 offset:32768
    s_waitcnt lgkmcnt(7)
    v_mfma_f32_32x32x16_bf16 v[128:143], v[160:163], v[20:23], v[128:143]
    s_waitcnt lgkmcnt(5)
    v_mfma_f32_32x32x16_bf16 v[144:159], v[164:167], v[20:23], v[144:159]
    ds_read_b128 v[20:23], v7 offset:3072
    ds_read_b64_tr_b16 v[160:161], v9 offset:49152
    ds_read_b64_tr_b16 v[162:163], v11 offset:49152
    ds_read_b64_tr_b16 v[164:165], v10 offset:49152
    ds_read_b64_tr_b16 v[166:167], v12 offset:49152
    s_waitcnt lgkmcnt(7)
    v_mfma_f32_32x32x16_bf16 v[128:143], v[24:27], v[16:19], v[128:143]
    s_waitcnt lgkmcnt(5)
    v_mfma_f32_32x32x16_bf16 v[144:159], v[28:31], v[16:19], v[144:159]
    v_add_u32 v9, 0x10000, v9
    v_add_u32 v10, 0x10000, v10
    v_add_u32 v11, 0x10000, v11
    v_add_u32 v12, 0x10000, v12
    ds_read_b128 v[16:19], v7 offset:4096
    ds_read_b64_tr_b16 v[24:25], v9 offset:0
    ds_read_b64_tr_b16 v[26:27], v11 offset:0
    ds_read_b64_tr_b16 v[28:29], v10 offset:0
    ds_read_b64_tr_b16 v[30:31], v12 offset:0
    s_waitcnt lgkmcnt(7)
    v_mfma_f32_32x32x16_bf16 v[128:143], v[160:163], v[20:23], v[128:143]
    s_waitcnt lgkmcnt(5)
    v_mfma_f32_32x32x16_bf16 v[144:159], v[164:167], v[20:23], v[144:159]
    s_barrier
    s_mov_b32 m0, s68
    s_add_u32 s68, s68, 8192
    buffer_load_dwordx4 v3, s[44:47], s61 offen nt lds
    s_add_u32 s61, s61, 8192
    s_mov_b32 m0, s68
    s_add_u32 s68, s68, 8192
    buffer_load_dwordx4 v15, s[44:47], s61 offen nt lds
    s_add_u32 s61, s61, 8192
    s_mov_b32 m0, s68
    s_add_u32 s68, s68, 8192
    buffer_load_dwordx4 v3, s[44:47], s61 offen nt lds
    s_add_u32 s61, s61, 8192
    s_mov_b32 m0, s68
    s_add_u32 s68, s68, 8192
    buffer_load_dwordx4 v15, s[44:47], s61 offen nt lds
    s_add_u32 s61, s61, 8192
    ds_read_b128 v[20:23], v7 offset:5120
    ds_read_b64_tr_b16 v[160:161], v9 offset:16384
    ds_read_b64_tr_b16 v[162:163], v11 offset:16384
    ds_read_b64_tr_b16 v[164:165], v10 offset:16384
    ds_read_b64_tr_b16 v[166:167], v12 offset:16384
    s_waitcnt lgkmcnt(7)
    v_mfma_f32_32x32x16_bf16 v[128:143], v[24:27], v[16:19], v[128:143]
    s_waitcnt lgkmcnt(5)
    v_mfma_f32_32x32x16_bf16 v[144:159], v[28:31], v[16:19], v[144:159]
    s_mov_b32 m0, s68
    s_add_u32 s68, s68, 8192
    buffer_load_dwordx4 v3, s[44:47], s61 offen nt lds
    s_add_u32 s61, s61, 8192
    s_mov_b32 m0, s68
    s_add_u32 s68, s68, 8192
    buffer_load_dwordx4 v15, s[44:47], s61 offen nt lds
    s_add_u32 s61, s61, 8192
    s_mov_b32 m0, s68
    s_add_u32 s68, s68, 8192
    buffer_load_dwordx4 v3, s[44:47], s61 offen nt lds
    s_add_u32 s61, s61, 8192
    s_mov_b32 m0, s68
    s_add_u32 s68, s68, 8192
    buffer_load_dwordx4 v15, s[44:47], s61 offen nt lds
    s_add_u32 s61, s61, 8192
    ds_read_b128 v[16:19], v7 offset:6144
    ds_read_b64_tr_b16 v[24:25], v9 offset:32768
    ds_read_b64_tr_b16 v[26:27], v11 offset:32768
    ds_read_b64_tr_b16 v[28:29], v10 offset:32768
    ds_read_b64_tr_b16 v[30:31], v12 offset:32768
    s_waitcnt lgkmcnt(7)
    v_mfma_f32_32x32x16_bf16 v[128:143], v[160:163], v[20:23], v[128:143]
    s_waitcnt lgkmcnt(5)
    v_mfma_f32_32x32x16_bf16 v[144:159], v[164:167], v[20:23], v[144:159]
    ds_read_b128 v[20:23], v7 offset:7168
    ds_read_b64_tr_b16 v[160:161], v9 offset:49152
    ds_read_b64_tr_b16 v[162:163], v11 offset:49152
    ds_read_b64_tr_b16 v[164:165], v10 offset:49152
    ds_read_b64_tr_b16 v[166:167], v12 offset:49152
    s_waitcnt lgkmcnt(7)
    v_mfma_f32_32x32x16_bf16 v[128:143], v[24:27], v[16:19], v[128:143]
    s_waitcnt lgkmcnt(5)
    v_mfma_f32_32x32x16_bf16 v[144:159], v[28:31], v[16:19], v[144:159]
    s_waitcnt lgkmcnt(2)
    v_mfma_f32_32x32x16_bf16 v[128:143], v[160:163], v[20:23], v[128:143]
    s_waitcnt lgkmcnt(0)
    v_mfma_f32_32x32x16_bf16 v[144:159], v[164:167], v[20:23], v[144:159]
    v_add_u32 v9, 0xffff0000, v9
    v_add_u32 v10, 0xffff0000, v10
    v_add_u32 v11, 0xffff0000, v11
    v_add_u32 v12, 0xffff0000, v12
    s_lshl_b32 s7, s3, 10
    s_add_u32 s7, s7, 0x10000
    v_lshl_add_u32 v3, v1, 4, s7
    s_waitcnt vmcnt(8)
    s_barrier
    ds_write_b128 v3, v[96:99] offset:0
    ds_write_b128 v3, v[100:103] offset:8192
    ds_write_b128 v3, v[104:107] offset:16384
    ds_write_b128 v3, v[108:111] offset:24576
    ds_write_b128 v3, v[112:115] offset:32768
    ds_write_b128 v3, v[116:119] offset:40960
    ds_write_b128 v3, v[120:123] offset:49152
    ds_write_b128 v3, v[124:127] offset:57344
    s_waitcnt lgkmcnt(0)
    s_barrier
    v_xor_b32 v160, 0x0, v2
    ds_read_b128 v[24:27], v160
    v_xor_b32 v161, 0x10, v2
    ds_read_b128 v[28:31], v161
    v_xor_b32 v162, 0x20, v2
    ds_read_b128 v[164:167], v162
    v_xor_b32 v160, 0x30, v2
    ds_read_b128 v[96:99], v160
    v_xor_b32 v161, 0x40, v2
    ds_read_b128 v[100:103], v161
    v_xor_b32 v162, 0x50, v2
    ds_read_b128 v[104:107], v162
    v_xor_b32 v160, 0x60, v2
    ds_read_b128 v[108:111], v160
    s_waitcnt lgkmcnt(6)
    v_mfma_f32_16x16x32_bf16 v[20:23], v[24:27], v[32:35], 0
    v_xor_b32 v161, 0x70, v2
    ds_read_b128 v[24:27], v161
    s_waitcnt lgkmcnt(6)
    v_mfma_f32_16x16x32_bf16 v[20:23], v[28:31], v[36:39], v[20:23]
    v_xor_b32 v162, 0x80, v2
    ds_read_b128 v[28:31], v162
    s_waitcnt lgkmcnt(6)
    v_mfma_f32_16x16x32_bf16 v[20:23], v[164:167], v[40:43], v[20:23]
    v_xor_b32 v160, 0x90, v2
    ds_read_b128 v[164:167], v160
    s_waitcnt lgkmcnt(6)
    v_mfma_f32_16x16x32_bf16 v[20:23], v[96:99], v[44:47], v[20:23]
    v_xor_b32 v161, 0xa0, v2
    ds_read_b128 v[96:99], v161
    s_waitcnt lgkmcnt(6)
    v_mfma_f32_16x16x32_bf16 v[20:23], v[100:103], v[48:51], v[20:23]
    v_xor_b32 v162, 0xb0, v2
    ds_read_b128 v[100:103], v162
    s_waitcnt lgkmcnt(6)
    v_mfma_f32_16x16x32_bf16 v[20:23], v[104:107], v[52:55], v[20:23]
    v_xor_b32 v160, 0xc0, v2
    ds_read_b128 v[104:107], v160
    s_waitcnt lgkmcnt(6)
    v_mfma_f32_16x16x32_bf16 v[20:23], v[108:111], v[56:59], v[20:23]
    v_xor_b32 v161, 0xd0, v2
    ds_read_b128 v[108:111], v161
    s_waitcnt lgkmcnt(6)
    v_mfma_f32_16x16x32_bf16 v[20:23], v[24:27], v[60:63], v[20:23]
    v_xor_b32 v162, 0xe0, v2
    ds_read_b128 v[24:27], v162
    s_waitcnt lgkmcnt(6)
    v_mfma_f32_16x16x32_bf16 v[20:23], v[28:31], v[64:67], v[20:23]
    v_xor_b32 v160, 0xf0, v2
    ds_read_b128 v[28:31], v160
    s_waitcnt lgkmcnt(6)
    v_mfma_f32_16x16x32_bf16 v[20:23], v[164:167], v[68:71], v[20:23]
    s_waitcnt lgkmcnt(5)
    v_mfma_f32_16x16x32_bf16 v[20:23], v[96:99], v[72:75], v[20:23]
    s_waitcnt lgkmcnt(4)
    v_mfma_f32_16x16x32_bf16 v[20:23], v[100:103], v[76:79], v[20:23]
    s_waitcnt lgkmcnt(3)
    v_mfma_f32_16x16x32_bf16 v[20:23], v[104:107], v[80:83], v[20:23]
    s_waitcnt lgkmcnt(2)
    v_mfma_f32_16x16x32_bf16 v[20:23], v[108:111], v[84:87], v[20:23]
    s_waitcnt lgkmcnt(1)
    v_mfma_f32_16x16x32_bf16 v[20:23], v[24:27], v[88:91], v[20:23]
    s_waitcnt lgkmcnt(0)
    v_mfma_f32_16x16x32_bf16 v[20:23], v[28:31], v[92:95], v[20:23]
    s_waitcnt vmcnt(0)
    s_barrier
    v_xor_b32 v160, 0x0, v4
    ds_read_b128 v[24:27], v160
    v_xor_b32 v161, 0x10, v4
    ds_read_b128 v[28:31], v161
    v_xor_b32 v162, 0x20, v4
    ds_read_b128 v[164:167], v162
    v_xor_b32 v160, 0x30, v4
    ds_read_b128 v[96:99], v160
    v_xor_b32 v161, 0x40, v4
    ds_read_b128 v[100:103], v161
    v_xor_b32 v162, 0x50, v4
    ds_read_b128 v[104:107], v162
    v_xor_b32 v160, 0x60, v4
    ds_read_b128 v[108:111], v160
    s_waitcnt lgkmcnt(6)
    v_mfma_f32_16x16x32_bf16 v[16:19], v[24:27], v[32:35], 0
    v_xor_b32 v161, 0x70, v4
    ds_read_b128 v[24:27], v161
    s_waitcnt lgkmcnt(6)
    v_mfma_f32_16x16x32_bf16 v[16:19], v[28:31], v[36:39], v[16:19]
    v_xor_b32 v162, 0x80, v4
    ds_read_b128 v[28:31], v162
    s_waitcnt lgkmcnt(6)
    v_mfma_f32_16x16x32_bf16 v[16:19], v[164:167], v[40:43], v[16:19]
    v_xor_b32 v160, 0x90, v4
    ds_read_b128 v[164:167], v160
    s_waitcnt lgkmcnt(6)
    v_mfma_f32_16x16x32_bf16 v[16:19], v[96:99], v[44:47], v[16:19]
    v_xor_b32 v161, 0xa0, v4
    ds_read_b128 v[96:99], v161
    s_waitcnt lgkmcnt(6)
    v_mfma_f32_16x16x32_bf16 v[16:19], v[100:103], v[48:51], v[16:19]
    v_xor_b32 v162, 0xb0, v4
    ds_read_b128 v[100:103], v162
    s_waitcnt lgkmcnt(6)
    v_mfma_f32_16x16x32_bf16 v[16:19], v[104:107], v[52:55], v[16:19]
    v_xor_b32 v160, 0xc0, v4
    ds_read_b128 v[104:107], v160
    s_waitcnt lgkmcnt(6)
    v_mfma_f32_16x16x32_bf16 v[16:19], v[108:111], v[56:59], v[16:19]
    v_xor_b32 v161, 0xd0, v4
    ds_read_b128 v[108:111], v161
    s_waitcnt lgkmcnt(6)
    v_mfma_f32_16x16x32_bf16 v[16:19], v[24:27], v[60:63], v[16:19]
    v_xor_b32 v162, 0xe0, v4
    ds_read_b128 v[24:27], v162
    s_waitcnt lgkmcnt(6)
    v_mfma_f32_16x16x32_bf16 v[16:19], v[28:31], v[64:67], v[16:19]
    v_xor_b32 v160, 0xf0, v4
    ds_read_b128 v[28:31], v160
    s_waitcnt lgkmcnt(6)
    v_mfma_f32_16x16x32_bf16 v[16:19], v[164:167], v[68:71], v[16:19]
    s_waitcnt lgkmcnt(5)
    v_mfma_f32_16x16x32_bf16 v[16:19], v[96:99], v[72:75], v[16:19]
    s_waitcnt lgkmcnt(4)
    v_mfma_f32_16x16x32_bf16 v[16:19], v[100:103], v[76:79], v[16:19]
    s_waitcnt lgkmcnt(3)
    v_mfma_f32_16x16x32_bf16 v[16:19], v[104:107], v[80:83], v[16:19]
    s_waitcnt lgkmcnt(2)
    v_mfma_f32_16x16x32_bf16 v[16:19], v[108:111], v[84:87], v[16:19]
    s_waitcnt lgkmcnt(1)
    v_mfma_f32_16x16x32_bf16 v[16:19], v[24:27], v[88:91], v[16:19]
    s_waitcnt lgkmcnt(0)
    v_mfma_f32_16x16x32_bf16 v[16:19], v[28:31], v[92:95], v[16:19]
    s_nop 7
    v_max3_f32 v160, v16, v17, v18
    v_max3_f32 v160, v160, v19, v20
    v_max3_f32 v160, v160, v21, v22
    v_max_f32 v160, v160, v23
    v_mov_b32 v161, v160
    s_nop 1
    v_permlane32_swap_b32 v160, v161
    v_max_f32 v160, v160, v161
    v_mov_b32 v161, v160
    s_nop 1
    v_permlane16_swap_b32 v160, v161
    v_max_f32 v160, v160, v161
    s_lshl_b32 s7, s64, 7
    v_add_u32 v161, s7, v5
    s_mov_b64 exec, s[86:87]
    ds_write_b32 v161, v160
    s_mov_b64 exec, -1
    s_waitcnt lgkmcnt(0)
    s_barrier
    ds_read_b32 v160, v5 offset:0
    ds_read_b32 v161, v5 offset:128
    ds_read_b32 v162, v5 offset:256
    ds_read_b32 v163, v5 offset:384
    s_waitcnt lgkmcnt(0)
    v_max3_f32 v160, v160, v161, v162
    v_max_f32 v160, v160, v163
    v_mul_f32 v160, s67, v160
    v_max_f32 v160, v160, v13
    v_sub_f32 v161, v13, v160
    v_exp_f32 v161, v161
    v_mov_b32 v13, v160
    v_fma_f32 v16, v16, s67, -v160
    v_fma_f32 v17, v17, s67, -v160
    v_fma_f32 v18, v18, s67, -v160
    v_fma_f32 v19, v19, s67, -v160
    v_fma_f32 v20, v20, s67, -v160
    v_fma_f32 v21, v21, s67, -v160
    v_fma_f32 v22, v22, s67, -v160
    v_fma_f32 v23, v23, s67, -v160
    v_exp_f32 v16, v16
    v_exp_f32 v17, v17
    v_exp_f32 v18, v18
    v_exp_f32 v19, v19
    v_exp_f32 v20, v20
    v_exp_f32 v21, v21
    v_exp_f32 v22, v22
    v_exp_f32 v23, v23
    v_cvt_pk_bf16_f32 v24, v16, v17
    v_cvt_pk_bf16_f32 v25, v18, v19
    v_cvt_pk_bf16_f32 v26, v20, v21
    v_cvt_pk_bf16_f32 v27, v22, v23
    ds_write_b64 v6, v[24:25]
    ds_write_b64 v6, v[26:27] offset:4096
    v_add_u32 v162, 0xc00, v5
    s_mov_b64 exec, s[88:89]
    ds_write_b32 v162, v161
    s_mov_b64 exec, -1
    v_mul_f32 v14, v14, v161
    v_add_f32 v16, v16, v20
    v_add_f32 v17, v17, v21
    v_add_f32 v18, v18, v22
    v_add_f32 v19, v19, v23
    v_add_f32 v16, v16, v18
    v_add_f32 v17, v17, v19
    v_add_f32 v16, v16, v17
    v_add_f32 v14, v14, v16
    v_mov_b32 v160, v14
    s_nop 1
    v_permlane32_swap_b32 v14, v160
    v_add_f32 v14, v14, v160
    v_mov_b32 v160, v14
    s_nop 1
    v_permlane16_swap_b32 v14, v160
    v_add_f32 v14, v14, v160
    s_lshl_b32 s7, s64, 7
    s_add_u32 s7, s7, 0x200
    v_add_u32 v161, s7, v5
    v_add_u32 v162, 0xc80, v5
    s_mov_b64 exec, s[86:87]
    ds_write_b32 v161, v14
    s_mov_b64 exec, s[88:89]
    ds_write_b32 v162, v13
    s_mov_b64 exec, -1
    v_and_b32 v160, 31, v1
    v_lshlrev_b32 v98, 7, v160
    v_lshrrev_b32 v161, 5, v1
    v_and_b32 v160, 7, v1
    v_xor_b32 v161, v160, v161
    v_lshl_add_u32 v98, v161, 4, v98
    s_lshl_b32 s7, s3, 12
    v_add_u32 v98, s7, v98
    v_lshl_add_u32 v99, v1, 4, s7
    v_lshrrev_b32 v161, 3, v1
    v_xor_b32 v160, v160, v161
    v_lshlrev_b32 v100, 7, v161
    v_lshl_add_u32 v100, v160, 4, v100
    s_lshl_b32 s69, s60, 15
    s_add_u32 s69, s69, s7
    s_add_u32 s69, s69, 0x500000
    s_waitcnt lgkmcnt(0)
    s_barrier
    ds_read_b32 v15, v8
    ds_read_b128 v[16:19], v7 offset:0
    ds_read_b64_tr_b16 v[24:25], v9 offset:0
    ds_read_b64_tr_b16 v[26:27], v11 offset:0
    ds_read_b64_tr_b16 v[28:29], v10 offset:0
    ds_read_b64_tr_b16 v[30:31], v12 offset:0
    s_waitcnt lgkmcnt(5)
    v_mul_f32 v128, v15, v128
    v_mul_f32 v129, v15, v129
    v_mul_f32 v130, v15, v130
    v_mul_f32 v131, v15, v131
    v_mul_f32 v132, v15, v132
    v_mul_f32 v133, v15, v133
    v_mul_f32 v134, v15, v134
    v_mul_f32 v135, v15, v135
    v_mul_f32 v136, v15, v136
    v_mul_f32 v137, v15, v137
    v_mul_f32 v138, v15, v138
    v_mul_f32 v139, v15, v139
    v_mul_f32 v140, v15, v140
    v_mul_f32 v141, v15, v141
    v_mul_f32 v142, v15, v142
    v_mul_f32 v143, v15, v143
    v_mul_f32 v144, v15, v144
    v_mul_f32 v145, v15, v145
    v_mul_f32 v146, v15, v146
    v_mul_f32 v147, v15, v147
    v_mul_f32 v148, v15, v148
    v_mul_f32 v149, v15, v149
    v_mul_f32 v150, v15, v150
    v_mul_f32 v151, v15, v151
    v_mul_f32 v152, v15, v152
    v_mul_f32 v153, v15, v153
    v_mul_f32 v154, v15, v154
    v_mul_f32 v155, v15, v155
    v_mul_f32 v156, v15, v156
    v_mul_f32 v157, v15, v157
    v_mul_f32 v158, v15, v158
    v_mul_f32 v159, v15, v159
    ds_read_b128 v[20:23], v7 offset:1024
    ds_read_b64_tr_b16 v[160:161], v9 offset:16384
    ds_read_b64_tr_b16 v[162:163], v11 offset:16384
    ds_read_b64_tr_b16 v[164:165], v10 offset:16384
    ds_read_b64_tr_b16 v[166:167], v12 offset:16384
    s_waitcnt lgkmcnt(7)
    v_mfma_f32_32x32x16_bf16 v[128:143], v[24:27], v[16:19], v[128:143]
    s_waitcnt lgkmcnt(5)
    v_mfma_f32_32x32x16_bf16 v[144:159], v[28:31], v[16:19], v[144:159]
    ds_read_b128 v[16:19], v7 offset:2048
    ds_read_b64_tr_b16 v[24:25], v9 offset:32768
    ds_read_b64_tr_b16 v[26:27], v11 offset:32768
    ds_read_b64_tr_b16 v[28:29], v10 offset:32768
    ds_read_b64_tr_b16 v[30:31], v12 offset:32768
    s_waitcnt lgkmcnt(7)
    v_mfma_f32_32x32x16_bf16 v[128:143], v[160:163], v[20:23], v[128:143]
    s_waitcnt lgkmcnt(5)
    v_mfma_f32_32x32x16_bf16 v[144:159], v[164:167], v[20:23], v[144:159]
    ds_read_b128 v[20:23], v7 offset:3072
    ds_read_b64_tr_b16 v[160:161], v9 offset:49152
    ds_read_b64_tr_b16 v[162:163], v11 offset:49152
    ds_read_b64_tr_b16 v[164:165], v10 offset:49152
    ds_read_b64_tr_b16 v[166:167], v12 offset:49152
    s_waitcnt lgkmcnt(7)
    v_mfma_f32_32x32x16_bf16 v[128:143], v[24:27], v[16:19], v[128:143]
    s_waitcnt lgkmcnt(5)
    v_mfma_f32_32x32x16_bf16 v[144:159], v[28:31], v[16:19], v[144:159]
    v_add_u32 v9, 0x10000, v9
    v_add_u32 v10, 0x10000, v10
    v_add_u32 v11, 0x10000, v11
    v_add_u32 v12, 0x10000, v12
    ds_read_b128 v[16:19], v7 offset:4096
    ds_read_b64_tr_b16 v[24:25], v9 offset:0
    ds_read_b64_tr_b16 v[26:27], v11 offset:0
    ds_read_b64_tr_b16 v[28:29], v10 offset:0
    ds_read_b64_tr_b16 v[30:31], v12 offset:0
    s_waitcnt lgkmcnt(7)
    v_mfma_f32_32x32x16_bf16 v[128:143], v[160:163], v[20:23], v[128:143]
    s_waitcnt lgkmcnt(5)
    v_mfma_f32_32x32x16_bf16 v[144:159], v[164:167], v[20:23], v[144:159]
    s_barrier
    ds_read_b128 v[20:23], v7 offset:5120
    ds_read_b64_tr_b16 v[160:161], v9 offset:16384
    ds_read_b64_tr_b16 v[162:163], v11 offset:16384
    ds_read_b64_tr_b16 v[164:165], v10 offset:16384
    ds_read_b64_tr_b16 v[166:167], v12 offset:16384
    s_waitcnt lgkmcnt(7)
    v_mfma_f32_32x32x16_bf16 v[128:143], v[24:27], v[16:19], v[128:143]
    s_waitcnt lgkmcnt(5)
    v_mfma_f32_32x32x16_bf16 v[144:159], v[28:31], v[16:19], v[144:159]
    ds_read_b128 v[16:19], v7 offset:6144
    ds_read_b64_tr_b16 v[24:25], v9 offset:32768
    ds_read_b64_tr_b16 v[26:27], v11 offset:32768
    ds_read_b64_tr_b16 v[28:29], v10 offset:32768
    ds_read_b64_tr_b16 v[30:31], v12 offset:32768
    s_waitcnt lgkmcnt(7)
    v_mfma_f32_32x32x16_bf16 v[128:143], v[160:163], v[20:23], v[128:143]
    s_waitcnt lgkmcnt(5)
    v_mfma_f32_32x32x16_bf16 v[144:159], v[164:167], v[20:23], v[144:159]
    ds_read_b128 v[20:23], v7 offset:7168
    ds_read_b64_tr_b16 v[160:161], v9 offset:49152
    ds_read_b64_tr_b16 v[162:163], v11 offset:49152
    ds_read_b64_tr_b16 v[164:165], v10 offset:49152
    ds_read_b64_tr_b16 v[166:167], v12 offset:49152
    s_waitcnt lgkmcnt(7)
    v_mfma_f32_32x32x16_bf16 v[128:143], v[24:27], v[16:19], v[128:143]
    s_waitcnt lgkmcnt(5)
    v_mfma_f32_32x32x16_bf16 v[144:159], v[28:31], v[16:19], v[144:159]
    s_waitcnt lgkmcnt(2)
    v_mfma_f32_32x32x16_bf16 v[128:143], v[160:163], v[20:23], v[128:143]
    s_waitcnt lgkmcnt(0)
    v_mfma_f32_32x32x16_bf16 v[144:159], v[164:167], v[20:23], v[144:159]
    s_nop 9
    v_permlane32_swap_b32 v128, v132
    v_permlane32_swap_b32 v129, v133
    v_permlane32_swap_b32 v130, v134
    v_permlane32_swap_b32 v131, v135
    v_cvt_pk_bf16_f32 v16, v128, v129
    v_cvt_pk_bf16_f32 v17, v130, v131
    v_cvt_pk_bf16_f32 v18, v132, v133
    v_cvt_pk_bf16_f32 v19, v134, v135
    v_xor_b32 v160, 0x0, v98
    ds_write_b128 v160, v[16:19]
    v_permlane32_swap_b32 v136, v140
    v_permlane32_swap_b32 v137, v141
    v_permlane32_swap_b32 v138, v142
    v_permlane32_swap_b32 v139, v143
    v_cvt_pk_bf16_f32 v20, v136, v137
    v_cvt_pk_bf16_f32 v21, v138, v139
    v_cvt_pk_bf16_f32 v22, v140, v141
    v_cvt_pk_bf16_f32 v23, v142, v143
    v_xor_b32 v161, 0x20, v98
    ds_write_b128 v161, v[20:23]
    v_permlane32_swap_b32 v144, v148
    v_permlane32_swap_b32 v145, v149
    v_permlane32_swap_b32 v146, v150
    v_permlane32_swap_b32 v147, v151
    v_cvt_pk_bf16_f32 v24, v144, v145
    v_cvt_pk_bf16_f32 v25, v146, v147
    v_cvt_pk_bf16_f32 v26, v148, v149
    v_cvt_pk_bf16_f32 v27, v150, v151
    v_xor_b32 v160, 0x40, v98
    ds_write_b128 v160, v[24:27]
    v_permlane32_swap_b32 v152, v156
    v_permlane32_swap_b32 v153, v157
    v_permlane32_swap_b32 v154, v158
    v_permlane32_swap_b32 v155, v159
    v_cvt_pk_bf16_f32 v28, v152, v153
    v_cvt_pk_bf16_f32 v29, v154, v155
    v_cvt_pk_bf16_f32 v30, v156, v157
    v_cvt_pk_bf16_f32 v31, v158, v159
    v_xor_b32 v161, 0x60, v98
    ds_write_b128 v161, v[28:31]
    ds_read_b128 v[32:35], v99 offset:0
    ds_read_b128 v[36:39], v99 offset:1024
    ds_read_b128 v[40:43], v99 offset:2048
    ds_read_b128 v[44:47], v99 offset:3072
    s_waitcnt lgkmcnt(3)
    buffer_store_dwordx4 v[32:35], v100, s[36:39], s69 offen offset:0 sc1
    s_waitcnt lgkmcnt(2)
    buffer_store_dwordx4 v[36:39], v100, s[36:39], s69 offen offset:1024 sc1
    s_waitcnt lgkmcnt(1)
    buffer_store_dwordx4 v[40:43], v100, s[36:39], s69 offen offset:2048 sc1
    s_waitcnt lgkmcnt(0)
    buffer_store_dwordx4 v[44:47], v100, s[36:39], s69 offen offset:3072 sc1
    v_mov_b32 v160, 0x2404c
    s_mov_b32 s80, 1600000
LW_95:
    ds_read_b32 v161, v160
    s_waitcnt lgkmcnt(0)
    v_readfirstlane_b32 s79, v161
    s_cmp_ge_u32 s79, 1
    s_cbranch_scc1 LWD_96
    s_sleep 2
    s_sub_u32 s80, s80, 1
    s_cmp_lg_u32 s80, 0
    s_cbranch_scc1 LW_95
LWD_96:
    v_mov_b32 v160, 0x24050
    ds_read_b64 v[162:163], v160
    s_waitcnt lgkmcnt(0)
    v_readfirstlane_b32 s94, v162
    v_readfirstlane_b32 s95, v163
    v_and_b32 v160, 31, v1
    v_lshlrev_b32 v3, 2, v160
    v_add_u32 v3, 0x27400, v3
    s_lshl_b32 s7, s60, 9
    s_add_u32 s7, s7, 0xe0000
    s_cmp_eq_u32 s3, 0
    s_cselect_b32 s7, s7, 0x40000000
    v_lshl_add_u32 v4, v160, 4, s7
    v_mov_b32 v22, s94
    v_mov_b32 v23, s95
    ds_read_b32 v16, v3 offset:0
    ds_read_b32 v17, v3 offset:128
    ds_read_b32 v18, v3 offset:256
    ds_read_b32 v19, v3 offset:384
    ds_read_b32 v20, v3 offset:2688
    s_waitcnt lgkmcnt(0)
    v_add_f32 v16, v16, v17
    v_add_f32 v18, v18, v19
    v_add_f32 v21, v16, v18
    s_waitcnt vmcnt(0)
    s_barrier
    s_mov_b64 exec, 0xffffffff
    buffer_store_dwordx4 v[20:23], v4, s[36:39], 0 offen sc1
    s_mov_b64 exec, -1
    v_lshlrev_b32 v2, 4, v1
    s_mov_b32 s44, s12
    s_and_b32 s45, s13, 0xffff
    s_mov_b32 s46, 0x8000000
    s_mov_b32 s47, 0x20000
    s_bfe_u32 s7, s5, 0x10002
    s_lshl_b32 s7, s7, 6
    s_add_u32 s7, s7, s6
    s_lshl_b32 s7, s7, 20
    s_lshl_b32 s72, s3, 10
    s_add_u32 s72, s72, s7
    s_add_u32 s72, s72, 1040384
    s_add_u32 s73, s72, 0x2000000
    s_mov_b32 s74, 4
    s_sleep 60
PV_97:
    s_waitcnt vmcnt(3)
    buffer_load_dwordx4 v[8:11], v2, s[44:47], s72 offen
    s_sub_u32 s72, s72, 8192
    s_waitcnt vmcnt(3)
    buffer_load_dwordx4 v[8:11], v2, s[44:47], s73 offen
    s_sub_u32 s73, s73, 8192
    s_sub_u32 s74, s74, 1
    s_cmp_lg_u32 s74, 0
    s_cbranch_scc1 PV_97
    s_mov_b32 s52, s30
    s_and_b32 s53, s31, 0xffff
    s_mov_b32 s54, 0x2000
    s_mov_b32 s55, 0x20000
    s_lshl_b32 s7, s60, 3
    s_add_u32 s7, s7, s3
    s_lshl_b32 s7, s7, 10
    s_add_u32 s7, s7, 0x100000
    v_add_u32 v4, s7, v2
    s_bfe_u32 s7, s60, 0x20003
    s_lshl_b32 s7, s7, 11
    s_lshr_b32 s66, s60, 5
    s_lshl_b32 s66, s66, 10
    s_add_u32 s7, s7, s66
    s_and_b32 s66, s60, 7
    s_lshl_b32 s66, s66, 7
    s_add_u32 s7, s7, s66
    v_and_b32 v5, 7, v1
    v_lshl_add_u32 v5, v5, 4, s7
    v_lshrrev_b32 v6, 4, v1
    v_lshl_add_u32 v5, v6, 2, v5
    s_mov_b32 s90, 0x00ff00ff
    s_mov_b32 s91, 0x00ff00ff
    s_lshl_b32 s7, s3, 10
    s_add_u32 s7, s7, 0x25200
    v_add_u32 v6, s7, v2
    s_mov_b32 s80, 200000
PO_98:
    buffer_load_dwordx4 v[32:35], v4, s[36:39], 0 offen sc1
PO2_99:
    s_waitcnt vmcnt(0)
    v_cmp_ne_u64 vcc, s[94:95], v[34:35]
    s_cmp_lg_u64 vcc, -1
    s_cbranch_scc1 POD_100
    s_sleep 20
    s_sub_u32 s80, s80, 1
    s_cmp_lg_u32 s80, 0
    s_cbranch_scc1 PO_98
POD_100:
    v_lshlrev_b32 v64, 16, v32
    v_and_b32 v65, 0xffff0000, v32
    v_lshlrev_b32 v66, 16, v33
    v_and_b32 v67, 0xffff0000, v33
    s_cbranch_vccz RD_101
    buffer_load_dwordx4 v[32:35], v4, s[36:39], 0 offen sc1
    s_sleep 4
    buffer_load_dwordx4 v[36:39], v4, s[36:39], 0 offen sc1
    s_sleep 4
    s_mov_b32 s80, 200000
PP_102:
    s_waitcnt vmcnt(1)
    v_cmp_ne_u64 vcc, s[94:95], v[34:35]
    s_cmp_eq_u64 vcc, 0
    s_cbranch_scc1 PPO_104
    buffer_load_dwordx4 v[32:35], v4, s[36:39], 0 offen sc1
    s_waitcnt vmcnt(1)
    v_cmp_ne_u64 vcc, s[94:95], v[38:39]
    s_cmp_eq_u64 vcc, 0
    s_cbranch_scc1 PPO_105
    buffer_load_dwordx4 v[36:39], v4, s[36:39], 0 offen sc1
    s_sub_u32 s80, s80, 1
    s_cmp_lg_u32 s80, 0
    s_cbranch_scc1 PP_102
PPO_104:
    v_lshlrev_b32 v64, 16, v32
    v_and_b32 v65, 0xffff0000, v32
    v_lshlrev_b32 v66, 16, v33
    v_and_b32 v67, 0xffff0000, v33
    s_branch PPD_103
PPO_105:
    v_lshlrev_b32 v64, 16, v36
    v_and_b32 v65, 0xffff0000, v36
    v_lshlrev_b32 v66, 16, v37
    v_and_b32 v67, 0xffff0000, v37
PPD_103:
RD_101:
    ds_write_b128 v6, v[64:67]
    s_waitcnt lgkmcnt(0)
    s_barrier
    s_cmp_lg_u32 s3, 0
    s_cbranch_scc1 L_END
    ds_read_b128 v[64:67], v6 offset:0
    ds_read_b128 v[68:71], v6 offset:1024
    ds_read_b128 v[72:75], v6 offset:2048
    ds_read_b128 v[76:79], v6 offset:3072
    ds_read_b128 v[80:83], v6 offset:4096
    ds_read_b128 v[84:87], v6 offset:5120
    ds_read_b128 v[88:91], v6 offset:6144
    ds_read_b128 v[92:95], v6 offset:7168
    s_waitcnt lgkmcnt(4)
    v_pk_add_f32 v[64:65], v[64:65], v[72:73]
    v_pk_add_f32 v[66:67], v[66:67], v[74:75]
    v_pk_add_f32 v[68:69], v[68:69], v[76:77]
    v_pk_add_f32 v[70:71], v[70:71], v[78:79]
    v_pk_add_f32 v[64:65], v[64:65], v[68:69]
    v_pk_add_f32 v[66:67], v[66:67], v[70:71]
    s_waitcnt lgkmcnt(0)
    v_pk_add_f32 v[80:81], v[80:81], v[88:89]
    v_pk_add_f32 v[82:83], v[82:83], v[90:91]
    v_pk_add_f32 v[84:85], v[84:85], v[92:93]
    v_pk_add_f32 v[86:87], v[86:87], v[94:95]
    v_pk_add_f32 v[80:81], v[80:81], v[84:85]
    v_pk_add_f32 v[82:83], v[82:83], v[86:87]
    s_nop 0
    v_permlane32_swap_b32 v64, v80
    v_permlane32_swap_b32 v65, v81
    v_permlane32_swap_b32 v66, v82
    v_permlane32_swap_b32 v67, v83
    v_add_f32 v64, v64, v80
    v_add_f32 v65, v65, v81
    v_add_f32 v66, v66, v82
    v_add_f32 v67, v67, v83
    s_nop 0
    v_permlane16_swap_b32 v64, v66
    v_permlane16_swap_b32 v65, v67
    v_add_f32 v64, v64, v66
    v_add_f32 v65, v65, v67
    s_nop 0
    v_add_f32_dpp v64, v64, v64 row_ror:8 row_mask:0xf bank_mask:0xf
    v_add_f32_dpp v65, v65, v65 row_ror:8 row_mask:0xf bank_mask:0xf
    v_cvt_pk_bf16_f32 v8, v64, v65
    s_mov_b64 exec, s[90:91]
    buffer_store_dword v8, v5, s[52:55], 0 offen
    s_mov_b64 exec, -1
    s_endpgm
L_CSVC:
    v_and_b32 v1, 63, v0
    s_and_b32 s7, s5, 3
    s_lshl_b32 s6, s4, 2
    s_add_u32 s6, s6, s7
    s_mov_b32 s92, 0x05040100
    s_mov_b32 s93, 0x07060302
    s_cmp_lg_u32 s3, 11
    s_cbranch_scc1 Z_106
    v_lshlrev_b32 v2, 2, v1
    v_add_u32 v2, 0x24000, v2
    v_mov_b32 v3, 0
    ds_write_b32 v2, v3
Z_106:
    s_waitcnt lgkmcnt(0)
    s_mov_b32 s36, s34
    s_and_b32 s37, s35, 0xffff
    s_mov_b32 s38, 0x1000000
    s_mov_b32 s39, 0x20000
    s_mov_b32 s40, s32
    s_and_b32 s41, s33, 0xffff
    s_mov_b32 s42, 0x100
    s_mov_b32 s43, 0x20000
    s_setprio 3
    s_sub_u32 s60, s3, 8
    s_lshl_b32 s64, s4, 3
    s_add_u32 s64, s64, s5
    s_sub_u32 s64, s64, 8
    v_lshlrev_b32 v2, 4, v1
    s_barrier
    s_cmp_lg_u32 s60, 0
    s_cbranch_scc1 C8_107
    s_sleep 24
    v_mov_b32 v160, 0
    s_mov_b32 s80, 200000
NG_108:
    s_mov_b64 exec, 1
    buffer_load_dwordx2 v[162:163], v160, s[40:43], 0 offen sc1
    s_mov_b64 exec, -1
    s_waitcnt vmcnt(0)
    v_readfirstlane_b32 s94, v162
    v_readfirstlane_b32 s95, v163
    s_cmp_lg_u32 s95, 0
    s_cbranch_scc1 NGD_109
    s_sleep 4
    s_sub_u32 s80, s80, 1
    s_cmp_lg_u32 s80, 0
    s_cbranch_scc1 NG_108
NGD_109:
    v_mov_b32 v160, 0x24050
    v_mov_b32 v162, s94
    v_mov_b32 v163, s95
    ds_write_b64 v160, v[162:163]
    v_mov_b32 v160, 0x2404c
    v_mov_b32 v161, 1
    s_waitcnt lgkmcnt(0)
    s_mov_b64 exec, 1
    ds_add_u32 v160, v161
    s_mov_b64 exec, -1
C8_107:
    s_lshr_b32 s7, s64, 4
    s_lshl_b32 s7, s7, 16
    s_lshl_b32 s63, s60, 14
    s_add_u32 s7, s7, s63
    s_add_u32 s7, s7, 0x0
    v_lshl_add_u32 v4, v1, 4, s7
    s_and_b32 s7, s60, 1
    s_lshl_b32 s7, s7, 7
    v_lshlrev_b32 v3, 3, v1
    v_xor_b32 v3, s7, v3
    s_lshl_b32 s7, s60, 13
    s_add_u32 s7, s7, 0x18000
    v_add_u32 v3, s7, v3
    v_mov_b32 v160, 0x2404c
    s_mov_b32 s80, 1600000
LW_110:
    ds_read_b32 v161, v160
    s_waitcnt lgkmcnt(0)
    v_readfirstlane_b32 s79, v161
    s_cmp_ge_u32 s79, 1
    s_cbranch_scc1 LWD_111
    s_sleep 4
    s_sub_u32 s80, s80, 1
    s_cmp_lg_u32 s80, 0
    s_cbranch_scc1 LW_110
LWD_111:
    v_mov_b32 v160, 0x24050
    ds_read_b64 v[162:163], v160
    s_waitcnt lgkmcnt(0)
    v_readfirstlane_b32 s94, v162
    v_readfirstlane_b32 s95, v163
    v_mov_b32 v160, 0x24018
    s_mov_b32 s80, 1600000
LW_112:
    ds_read_b32 v161, v160
    s_waitcnt lgkmcnt(0)
    v_readfirstlane_b32 s79, v161
    s_cmp_ge_u32 s79, 8
    s_cbranch_scc1 LWD_113
    s_sleep 2
    s_sub_u32 s80, s80, 1
    s_cmp_lg_u32 s80, 0
    s_cbranch_scc1 LW_112
LWD_113:
    s_sleep 1
    s_mov_b32 s67, 4096
    s_mov_b32 s68, 8192
    s_mov_b32 s69, 12288
    buffer_load_dwordx4 v[96:99], v4, s[36:39], 0 offen offset:0 sc1
    buffer_load_dwordx4 v[100:103], v4, s[36:39], 0 offen offset:1024 sc1
    buffer_load_dwordx4 v[104:107], v4, s[36:39], 0 offen offset:2048 sc1
    buffer_load_dwordx4 v[108:111], v4, s[36:39], 0 offen offset:3072 sc1
    buffer_load_dwordx4 v[112:115], v4, s[36:39], s67 offen offset:0 sc1
    buffer_load_dwordx4 v[116:119], v4, s[36:39], s67 offen offset:1024 sc1
    buffer_load_dwordx4 v[120:123], v4, s[36:39], s67 offen offset:2048 sc1
    buffer_load_dwordx4 v[124:127], v4, s[36:39], s67 offen offset:3072 sc1
    buffer_load_dwordx4 v[128:131], v4, s[36:39], s68 offen offset:0 sc1
    buffer_load_dwordx4 v[132:135], v4, s[36:39], s68 offen offset:1024 sc1
    buffer_load_dwordx4 v[136:139], v4, s[36:39], s68 offen offset:2048 sc1
    buffer_load_dwordx4 v[140:143], v4, s[36:39], s68 offen offset:3072 sc1
    buffer_load_dwordx4 v[144:147], v4, s[36:39], s69 offen offset:0 sc1
    buffer_load_dwordx4 v[148:151], v4, s[36:39], s69 offen offset:1024 sc1
    buffer_load_dwordx4 v[152:155], v4, s[36:39], s69 offen offset:2048 sc1
    buffer_load_dwordx4 v[156:159], v4, s[36:39], s69 offen offset:3072 sc1
    s_mov_b32 s80, 200000
PS_114:
    s_waitcnt vmcnt(0)
    s_mov_b32 s78, 0
    v_cmp_ne_u64 vcc, s[94:95], v[98:99]
    s_cbranch_vccz PSS_116
    buffer_load_dwordx4 v[96:99], v4, s[36:39], 0 offen offset:0 sc1
    s_mov_b32 s78, 1
PSS_116:
    v_cmp_ne_u64 vcc, s[94:95], v[102:103]
    s_cbranch_vccz PSS_117
    buffer_load_dwordx4 v[100:103], v4, s[36:39], 0 offen offset:1024 sc1
    s_mov_b32 s78, 1
PSS_117:
    v_cmp_ne_u64 vcc, s[94:95], v[106:107]
    s_cbranch_vccz PSS_118
    buffer_load_dwordx4 v[104:107], v4, s[36:39], 0 offen offset:2048 sc1
    s_mov_b32 s78, 1
PSS_118:
    v_cmp_ne_u64 vcc, s[94:95], v[110:111]
    s_cbranch_vccz PSS_119
    buffer_load_dwordx4 v[108:111], v4, s[36:39], 0 offen offset:3072 sc1
    s_mov_b32 s78, 1
PSS_119:
    v_cmp_ne_u64 vcc, s[94:95], v[114:115]
    s_cbranch_vccz PSS_120
    buffer_load_dwordx4 v[112:115], v4, s[36:39], s67 offen offset:0 sc1
    s_mov_b32 s78, 1
PSS_120:
    v_cmp_ne_u64 vcc, s[94:95], v[118:119]
    s_cbranch_vccz PSS_121
    buffer_load_dwordx4 v[116:119], v4, s[36:39], s67 offen offset:1024 sc1
    s_mov_b32 s78, 1
PSS_121:
    v_cmp_ne_u64 vcc, s[94:95], v[122:123]
    s_cbranch_vccz PSS_122
    buffer_load_dwordx4 v[120:123], v4, s[36:39], s67 offen offset:2048 sc1
    s_mov_b32 s78, 1
PSS_122:
    v_cmp_ne_u64 vcc, s[94:95], v[126:127]
    s_cbranch_vccz PSS_123
    buffer_load_dwordx4 v[124:127], v4, s[36:39], s67 offen offset:3072 sc1
    s_mov_b32 s78, 1
PSS_123:
    v_cmp_ne_u64 vcc, s[94:95], v[130:131]
    s_cbranch_vccz PSS_124
    buffer_load_dwordx4 v[128:131], v4, s[36:39], s68 offen offset:0 sc1
    s_mov_b32 s78, 1
PSS_124:
    v_cmp_ne_u64 vcc, s[94:95], v[134:135]
    s_cbranch_vccz PSS_125
    buffer_load_dwordx4 v[132:135], v4, s[36:39], s68 offen offset:1024 sc1
    s_mov_b32 s78, 1
PSS_125:
    v_cmp_ne_u64 vcc, s[94:95], v[138:139]
    s_cbranch_vccz PSS_126
    buffer_load_dwordx4 v[136:139], v4, s[36:39], s68 offen offset:2048 sc1
    s_mov_b32 s78, 1
PSS_126:
    v_cmp_ne_u64 vcc, s[94:95], v[142:143]
    s_cbranch_vccz PSS_127
    buffer_load_dwordx4 v[140:143], v4, s[36:39], s68 offen offset:3072 sc1
    s_mov_b32 s78, 1
PSS_127:
    v_cmp_ne_u64 vcc, s[94:95], v[146:147]
    s_cbranch_vccz PSS_128
    buffer_load_dwordx4 v[144:147], v4, s[36:39], s69 offen offset:0 sc1
    s_mov_b32 s78, 1
PSS_128:
    v_cmp_ne_u64 vcc, s[94:95], v[150:151]
    s_cbranch_vccz PSS_129
    buffer_load_dwordx4 v[148:151], v4, s[36:39], s69 offen offset:1024 sc1
    s_mov_b32 s78, 1
PSS_129:
    v_cmp_ne_u64 vcc, s[94:95], v[154:155]
    s_cbranch_vccz PSS_130
    buffer_load_dwordx4 v[152:155], v4, s[36:39], s69 offen offset:2048 sc1
    s_mov_b32 s78, 1
PSS_130:
    v_cmp_ne_u64 vcc, s[94:95], v[158:159]
    s_cbranch_vccz PSS_131
    buffer_load_dwordx4 v[156:159], v4, s[36:39], s69 offen offset:3072 sc1
    s_mov_b32 s78, 1
PSS_131:
    s_cmp_eq_u32 s78, 0
    s_cbranch_scc1 PSD_115
    s_sub_u32 s80, s80, 1
    s_cmp_lg_u32 s80, 0
    s_cbranch_scc1 PS_114
    s_waitcnt vmcnt(0)
PSD_115:
    v_xor_b32 v6, 0x0, v3
    ds_write_b64 v6, v[96:97] offset:0
    ds_write_b64 v6, v[100:101] offset:512
    v_xor_b32 v7, 0x10, v3
    ds_write_b64 v7, v[104:105] offset:1024
    ds_write_b64 v7, v[108:109] offset:1536
    v_xor_b32 v6, 0x20, v3
    ds_write_b64 v6, v[112:113] offset:2048
    ds_write_b64 v6, v[116:117] offset:2560
    v_xor_b32 v7, 0x30, v3
    ds_write_b64 v7, v[120:121] offset:3072
    ds_write_b64 v7, v[124:125] offset:3584
    v_xor_b32 v6, 0x40, v3
    ds_write_b64 v6, v[128:129] offset:4096
    ds_write_b64 v6, v[132:133] offset:4608
    v_xor_b32 v7, 0x50, v3
    ds_write_b64 v7, v[136:137] offset:5120
    ds_write_b64 v7, v[140:141] offset:5632
    v_xor_b32 v6, 0x60, v3
    ds_write_b64 v6, v[144:145] offset:6144
    ds_write_b64 v6, v[148:149] offset:6656
    v_xor_b32 v7, 0x70, v3
    ds_write_b64 v7, v[152:153] offset:7168
    ds_write_b64 v7, v[156:157] offset:7680
L_CCUT:
    s_waitcnt lgkmcnt(0)
    s_barrier
    s_endpgm
L_END:
    s_endpgm
L_END0:
    s_endpgm
L_CODE_END:
.section .rodata,"a"
.p2align 6
.amdhsa_kernel concat_heads__sliding_block_cached__compressed_kv_cla__decode_kernel
  .amdhsa_next_free_vgpr 168
  .amdhsa_next_free_sgpr 102
  .amdhsa_accum_offset 168
  .amdhsa_group_segment_fixed_size 0
  .amdhsa_kernarg_size 112
  .amdhsa_user_sgpr_count 2
  .amdhsa_user_sgpr_kernarg_segment_ptr 1
  .amdhsa_system_sgpr_workgroup_id_x 1
  .amdhsa_float_denorm_mode_32 3
.end_amdhsa_kernel
```

```asm
; @launch grid=(256,1,1) block=(768,1,1) lds=163840
.amdgcn_target "amdgcn-amd-amdhsa--gfx950"
.text
.globl concat_heads__sliding_block_cached__compressed_kv_cla__decode_kernel
.p2align 8
.type concat_heads__sliding_block_cached__compressed_kv_cla__decode_kernel,@function
concat_heads__sliding_block_cached__compressed_kv_cla__decode_kernel:
    s_load_dwordx16 s[8:23], s[0:1], 0
    s_load_dwordx8 s[24:31], s[0:1], 64
    s_load_dwordx4 s[32:35], s[0:1], 96
    v_lshrrev_b32 v1, 6, v0
    s_and_b32 s4, s2, 7
    v_readfirstlane_b32 s3, v1
    s_lshr_b32 s5, s2, 3
    s_cmp_ge_u32 s2, 256
    s_cbranch_scc1 L_END0
    s_cmp_ge_u32 s5, 16
    s_cbranch_scc1 EA_1
    s_cmp_ge_u32 s5, 8
    s_cbranch_scc1 EC_2
    s_cmp_ge_u32 s3, 8
    s_cbranch_scc1 L_W2
    s_cmp_ge_u32 s3, 4
    s_cbranch_scc1 L_W1
    s_branch L_W
EC_2:
    s_cmp_ge_u32 s3, 8
    s_cbranch_scc1 L_CSVC
    s_branch L_C
EA_1:
    s_cmp_eq_u32 s3, 11
    s_cbranch_scc1 L_ASVC
    v_and_b32 v1, 63, v0
    s_and_b32 s7, s5, 3
    s_lshl_b32 s6, s4, 2
    s_add_u32 s6, s6, s7
    s_mov_b32 s92, 0x05040100
    s_mov_b32 s93, 0x07060302
    s_lshr_b32 s7, s5, 2
    s_sub_u32 s7, s7, 4
    s_lshl_b32 s7, s7, 5
    s_add_u32 s7, s7, s6
    s_lshl_b32 s7, s7, 20
    s_add_u32 s7, s7, 0xC0000
    v_lshlrev_b32 v6, 4, v1
    v_add_u32 v6, s7, v6
    s_add_u32 s63, s3, 3
    s_cmp_ge_u32 s63, 11
    s_cselect_b32 s7, 11, 0
    s_sub_u32 s62, s63, s7
    s_mov_b32 s65, s62
    s_mul_i32 s7, s2, 0
    s_add_u32 s7, s7, s62
    s_mul_i32 s7, s7, 1024
    s_and_b32 s60, s7, 0x3ffff
    s_mov_b32 s61, s60
    s_add_u32 s63, s60, 259072
    s_and_b32 s63, s63, 0x3ffff
    s_cmp_lt_u32 s62, 3
    s_cselect_b32 s63, s63, 0x40000000
    s_cselect_b32 s62, 0, 0xff800000
    s_mov_b32 s64, 0x3e0293ee
    s_lshl_b32 s60, s3, 10
    s_mov_b32 s61, s60
    s_cmp_ge_u32 s3, 8
    s_cselect_b32 s7, 4096, 0
    s_sub_u32 s63, s60, s7
    s_add_u32 s63, s63, 247808
    s_add_u32 s65, s63, 7168
    s_and_b32 s7, s3, 12
    s_cmp_eq_u32 s7, 4
    s_cselect_b32 s62, 0xff800000, 0
    s_and_b32 s7, s5, 12
    s_and_b32 s66, s3, 3
    s_add_u32 s7, s7, s66
    v_lshrrev_b32 v2, 4, v1
    v_lshlrev_b32 v3, 16, v2
    v_and_b32 v4, 15, v1
    v_lshl_add_u32 v3, v4, 4, v3
    s_lshl_b32 s66, s7, 18
    s_lshl_b32 s67, s6, 8
    s_add_u32 s66, s66, s67
    v_bfe_u32 v4, v1, 2, 2
    v_lshlrev_b32 v4, 10, v4
    v_lshl_add_u32 v4, v2, 4, v4
    s_lshl_b32 s67, s7, 6
    s_cmp_ge_u32 s3, 8
    s_cbranch_scc1 AK_3
    s_cmp_lt_u32 s3, 4
    s_cbranch_scc1 AP_5
    s_barrier
    s_sleep 26
AP_5:
    s_cmp_lt_u32 s3, 4
    s_waitcnt lgkmcnt(0)
    s_cselect_b32 s72, s22, s14
    s_cselect_b32 s73, s23, s15
    s_cselect_b32 s70, s18, s8
    s_cselect_b32 s71, s19, s9
    s_mov_b32 s56, s72
    s_and_b32 s57, s73, 0xffff
    s_mov_b32 s58, 0x400000
    s_mov_b32 s59, 0x20000
    buffer_load_dwordx4 v[128:131], v3, s[56:59], s66 offen nt
    s_add_u32 s66, s66, 8192
    buffer_load_dwordx4 v[132:135], v3, s[56:59], s66 offen nt
    s_add_u32 s66, s66, 8192
    buffer_load_dwordx4 v[136:139], v3, s[56:59], s66 offen nt
    s_add_u32 s66, s66, 8192
    buffer_load_dwordx4 v[140:143], v3, s[56:59], s66 offen nt
    s_add_u32 s66, s66, 8192
    buffer_load_dwordx4 v[144:147], v3, s[56:59], s66 offen nt
    s_add_u32 s66, s66, 8192
    buffer_load_dwordx4 v[148:151], v3, s[56:59], s66 offen nt
    s_add_u32 s66, s66, 8192
    buffer_load_dwordx4 v[152:155], v3, s[56:59], s66 offen nt
    s_add_u32 s66, s66, 8192
    buffer_load_dwordx4 v[156:159], v3, s[56:59], s66 offen nt
    s_add_u32 s66, s66, 8192
    s_mov_b32 s52, s70
    s_and_b32 s53, s71, 0xffff
    s_mov_b32 s54, 0x1000
    s_mov_b32 s55, 0x20000
    buffer_load_dwordx4 v[160:163], v4, s[52:55], s67 offen
    s_mov_b32 s36, s34
    s_and_b32 s37, s35, 0xffff
    s_mov_b32 s38, 0x1000000
    s_mov_b32 s39, 0x20000
    s_mov_b32 s40, s32
    s_and_b32 s41, s33, 0xffff
    s_mov_b32 s42, 0x100
    s_mov_b32 s43, 0x20000
    s_mov_b32 s44, s10
    s_and_b32 s45, s11, 0xffff
    s_mov_b32 s46, 0x8000000
    s_mov_b32 s47, 0x20000
    s_mov_b32 s48, s12
    s_and_b32 s49, s13, 0xffff
    s_mov_b32 s50, 0x8000000
    s_mov_b32 s51, 0x20000
    s_cmp_ge_u32 s3, 4
    s_cbranch_scc1 AP_6
    s_barrier
AP_6:
    s_lshl_b32 s7, s3, 11
    s_add_u32 s7, s7, 0x0
    v_lshl_add_u32 v2, v1, 5, s7
    s_cmp_lt_u32 s3, 4
    s_cselect_b32 s7, 0x44, 0x40
    s_add_u32 s7, s7, 0x24000
    v_mov_b32 v3, s7
    v_mov_b32 v4, 1
    s_waitcnt vmcnt(0)
    v_perm_b32 v96, v132, v128, s92
    v_perm_b32 v97, v140, v136, s92
    v_perm_b32 v98, v148, v144, s92
    v_perm_b32 v99, v156, v152, s92
    v_perm_b32 v100, v132, v128, s93
    v_perm_b32 v101, v140, v136, s93
    v_perm_b32 v102, v148, v144, s93
    v_perm_b32 v103, v156, v152, s93
    v_perm_b32 v104, v133, v129, s92
    v_perm_b32 v105, v141, v137, s92
    v_perm_b32 v106, v149, v145, s92
    v_perm_b32 v107, v157, v153, s92
    v_perm_b32 v108, v133, v129, s93
    v_perm_b32 v109, v141, v137, s93
    v_perm_b32 v110, v149, v145, s93
    v_perm_b32 v111, v157, v153, s93
    v_perm_b32 v112, v134, v130, s92
    v_perm_b32 v113, v142, v138, s92
    v_perm_b32 v114, v150, v146, s92
    v_perm_b32 v115, v158, v154, s92
    v_perm_b32 v116, v134, v130, s93
    v_perm_b32 v117, v142, v138, s93
    v_perm_b32 v118, v150, v146, s93
    v_perm_b32 v119, v158, v154, s93
    v_perm_b32 v120, v135, v131, s92
    v_perm_b32 v121, v143, v139, s92
    v_perm_b32 v122, v151, v147, s92
    v_perm_b32 v123, v159, v155, s92
    v_perm_b32 v124, v135, v131, s93
    v_perm_b32 v125, v143, v139, s93
    v_perm_b32 v126, v151, v147, s93
    v_perm_b32 v127, v159, v155, s93
    v_mfma_f32_16x16x32_bf16 v[64:67], v[160:163], v[96:99], 0
    v_mfma_f32_16x16x32_bf16 v[68:71], v[160:163], v[100:103], 0
    v_mfma_f32_16x16x32_bf16 v[72:75], v[160:163], v[104:107], 0
    v_mfma_f32_16x16x32_bf16 v[76:79], v[160:163], v[108:111], 0
    v_mfma_f32_16x16x32_bf16 v[80:83], v[160:163], v[112:115], 0
    v_mfma_f32_16x16x32_bf16 v[84:87], v[160:163], v[116:119], 0
    v_mfma_f32_16x16x32_bf16 v[88:91], v[160:163], v[120:123], 0
    v_mfma_f32_16x16x32_bf16 v[92:95], v[160:163], v[124:127], 0
    s_nop 0
    v_mov_b32 v128, v64
    v_mov_b32 v129, v68
    v_mov_b32 v130, v72
    v_mov_b32 v131, v76
    v_mov_b32 v132, v80
    v_mov_b32 v133, v84
    v_mov_b32 v134, v88
    v_mov_b32 v135, v92
    ds_write_b128 v2, v[128:131]
    ds_write_b128 v2, v[132:135] offset:16
    s_waitcnt lgkmcnt(0)
    s_mov_b64 exec, 1
    ds_add_u32 v3, v4
    s_mov_b64 exec, -1
    s_branch AJ_4
AK_3:
    s_waitcnt lgkmcnt(0)
    s_mov_b32 s36, s34
    s_and_b32 s37, s35, 0xffff
    s_mov_b32 s38, 0x1000000
    s_mov_b32 s39, 0x20000
    s_mov_b32 s40, s32
    s_and_b32 s41, s33, 0xffff
    s_mov_b32 s42, 0x100
    s_mov_b32 s43, 0x20000
    s_mov_b32 s44, s10
    s_and_b32 s45, s11, 0xffff
    s_mov_b32 s46, 0x8000000
    s_mov_b32 s47, 0x20000
    s_mov_b32 s48, s12
    s_and_b32 s49, s13, 0xffff
    s_mov_b32 s50, 0x8000000
    s_mov_b32 s51, 0x20000
    s_barrier
    s_sleep 26
AJ_4:
    v_mov_b32 v32, 0
    v_mov_b32 v33, 0
    v_mov_b32 v34, 0
    v_mov_b32 v35, 0
    v_mov_b32 v36, 0
    v_mov_b32 v37, 0
    v_mov_b32 v38, 0
    v_mov_b32 v39, 0
    s_cmp_lg_u32 s62, 0
    s_cbranch_scc1 L_AK2
    buffer_load_dwordx4 v[32:35], v6, s[44:47], s63 offen nt
    buffer_load_dwordx4 v[36:39], v6, s[44:47], s65 offen nt
L_AK2:
    buffer_load_dwordx4 v[40:43], v6, s[44:47], s60 offen nt
    s_add_u32 s60, s60, 11264
    s_waitcnt vmcnt(2)
    buffer_load_dwordx4 v[44:47], v6, s[44:47], s60 offen nt
    s_add_u32 s60, s60, 11264
    s_waitcnt vmcnt(2)
    buffer_load_dwordx4 v[48:51], v6, s[44:47], s60 offen nt
    s_add_u32 s60, s60, 11264
    s_waitcnt vmcnt(2)
    buffer_load_dwordx4 v[52:55], v6, s[44:47], s60 offen nt
    s_add_u32 s60, s60, 11264
    s_waitcnt vmcnt(2)
    buffer_load_dwordx4 v[56:59], v6, s[44:47], s60 offen nt
    s_add_u32 s60, s60, 11264
    s_waitcnt vmcnt(2)
    buffer_load_dwordx4 v[60:63], v6, s[44:47], s60 offen nt
    s_add_u32 s60, s60, 11264
    s_waitcnt vmcnt(2)
    buffer_load_dwordx4 v[64:67], v6, s[44:47], s60 offen nt
    s_add_u32 s60, s60, 11264
    s_waitcnt vmcnt(2)
    buffer_load_dwordx4 v[68:71], v6, s[44:47], s60 offen nt
    s_add_u32 s60, s60, 11264
    s_waitcnt vmcnt(2)
    buffer_load_dwordx4 v[72:75], v6, s[44:47], s60 offen nt
    s_add_u32 s60, s60, 11264
    s_waitcnt vmcnt(2)
    buffer_load_dwordx4 v[76:79], v6, s[44:47], s60 offen nt
    s_add_u32 s60, s60, 11264
    s_waitcnt vmcnt(2)
    buffer_load_dwordx4 v[80:83], v6, s[44:47], s60 offen nt
    s_add_u32 s60, s60, 11264
    s_waitcnt vmcnt(2)
    buffer_load_dwordx4 v[84:87], v6, s[44:47], s60 offen nt
    s_add_u32 s60, s60, 11264
    s_waitcnt vmcnt(2)
    buffer_load_dwordx4 v[88:91], v6, s[44:47], s60 offen nt
    s_add_u32 s60, s60, 11264
    s_waitcnt vmcnt(2)
    buffer_load_dwordx4 v[92:95], v6, s[44:47], s60 offen nt
    s_add_u32 s60, s60, 11264
    v_mov_b32 v160, 0x24004
    s_mov_b32 s80, 1600000
LW_7:
    ds_read_b32 v161, v160
    s_waitcnt lgkmcnt(0)
    v_readfirstlane_b32 s79, v161
    s_cmp_ge_u32 s79, 1
    s_cbranch_scc1 LWD_8
    s_sleep 4
    s_sub_u32 s80, s80, 1
    s_cmp_lg_u32 s80, 0
    s_cbranch_scc1 LW_7
LWD_8:
    v_and_b32 v160, 15, v1
    v_lshlrev_b32 v160, 4, v160
    v_add_u32 v160, 0x24100, v160
    ds_read_b128 v[2:5], v160
    s_waitcnt lgkmcnt(0)
    v_dot2_f32_bf16 v8, v32, v2, 0
    v_dot2_f32_bf16 v9, v36, v2, 0
    v_dot2_f32_bf16 v10, v40, v2, 0
    v_dot2_f32_bf16 v11, v44, v2, 0
    v_dot2_f32_bf16 v8, v33, v3, v8
    v_dot2_f32_bf16 v9, v37, v3, v9
    v_dot2_f32_bf16 v10, v41, v3, v10
    v_dot2_f32_bf16 v11, v45, v3, v11
    v_dot2_f32_bf16 v8, v34, v4, v8
    v_dot2_f32_bf16 v9, v38, v4, v9
    v_dot2_f32_bf16 v10, v42, v4, v10
    v_dot2_f32_bf16 v11, v46, v4, v11
    v_dot2_f32_bf16 v8, v35, v5, v8
    v_dot2_f32_bf16 v9, v39, v5, v9
    v_dot2_f32_bf16 v10, v43, v5, v10
    v_dot2_f32_bf16 v11, v47, v5, v11
    v_add_f32_dpp v8, v8, v8 row_ror:8 row_mask:0xf bank_mask:0xf
    v_add_f32_dpp v9, v9, v9 row_ror:8 row_mask:0xf bank_mask:0xf
    v_add_f32_dpp v10, v10, v10 row_ror:8 row_mask:0xf bank_mask:0xf
    v_add_f32_dpp v11, v11, v11 row_ror:8 row_mask:0xf bank_mask:0xf
    v_add_f32_dpp v8, v8, v8 row_ror:4 row_mask:0xf bank_mask:0xf
    v_add_f32_dpp v9, v9, v9 row_ror:4 row_mask:0xf bank_mask:0xf
    v_add_f32_dpp v10, v10, v10 row_ror:4 row_mask:0xf bank_mask:0xf
    v_add_f32_dpp v11, v11, v11 row_ror:4 row_mask:0xf bank_mask:0xf
    v_add_f32_dpp v8, v8, v8 row_ror:2 row_mask:0xf bank_mask:0xf
    v_add_f32_dpp v9, v9, v9 row_ror:2 row_mask:0xf bank_mask:0xf
    v_add_f32_dpp v10, v10, v10 row_ror:2 row_mask:0xf bank_mask:0xf
    v_add_f32_dpp v11, v11, v11 row_ror:2 row_mask:0xf bank_mask:0xf
    v_add_f32_dpp v8, v8, v8 row_ror:1 row_mask:0xf bank_mask:0xf
    v_add_f32_dpp v9, v9, v9 row_ror:1 row_mask:0xf bank_mask:0xf
    v_add_f32_dpp v10, v10, v10 row_ror:1 row_mask:0xf bank_mask:0xf
    v_add_f32_dpp v11, v11, v11 row_ror:1 row_mask:0xf bank_mask:0xf
    s_waitcnt vmcnt(2)
    buffer_load_dwordx4 v[96:99], v6, s[44:47], s60 offen nt
    s_add_u32 s60, s60, 11264
    s_waitcnt vmcnt(2)
    buffer_load_dwordx4 v[100:103], v6, s[44:47], s60 offen nt
    s_add_u32 s60, s60, 11264
    v_dot2_f32_bf16 v12, v48, v2, 0
    v_dot2_f32_bf16 v13, v52, v2, 0
    v_dot2_f32_bf16 v14, v56, v2, 0
    v_dot2_f32_bf16 v15, v60, v2, 0
    v_dot2_f32_bf16 v12, v49, v3, v12
    v_dot2_f32_bf16 v13, v53, v3, v13
    v_dot2_f32_bf16 v14, v57, v3, v14
    v_dot2_f32_bf16 v15, v61, v3, v15
    v_dot2_f32_bf16 v12, v50, v4, v12
    v_dot2_f32_bf16 v13, v54, v4, v13
    v_dot2_f32_bf16 v14, v58, v4, v14
    v_dot2_f32_bf16 v15, v62, v4, v15
    v_dot2_f32_bf16 v12, v51, v5, v12
    v_dot2_f32_bf16 v13, v55, v5, v13
    v_dot2_f32_bf16 v14, v59, v5, v14
    v_dot2_f32_bf16 v15, v63, v5, v15
    v_add_f32_dpp v12, v12, v12 row_ror:8 row_mask:0xf bank_mask:0xf
    v_add_f32_dpp v13, v13, v13 row_ror:8 row_mask:0xf bank_mask:0xf
    v_add_f32_dpp v14, v14, v14 row_ror:8 row_mask:0xf bank_mask:0xf
    v_add_f32_dpp v15, v15, v15 row_ror:8 row_mask:0xf bank_mask:0xf
    v_add_f32_dpp v12, v12, v12 row_ror:4 row_mask:0xf bank_mask:0xf
    v_add_f32_dpp v13, v13, v13 row_ror:4 row_mask:0xf bank_mask:0xf
    v_add_f32_dpp v14, v14, v14 row_ror:4 row_mask:0xf bank_mask:0xf
    v_add_f32_dpp v15, v15, v15 row_ror:4 row_mask:0xf bank_mask:0xf
    v_add_f32_dpp v12, v12, v12 row_ror:2 row_mask:0xf bank_mask:0xf
    v_add_f32_dpp v13, v13, v13 row_ror:2 row_mask:0xf bank_mask:0xf
    v_add_f32_dpp v14, v14, v14 row_ror:2 row_mask:0xf bank_mask:0xf
    v_add_f32_dpp v15, v15, v15 row_ror:2 row_mask:0xf bank_mask:0xf
    v_add_f32_dpp v12, v12, v12 row_ror:1 row_mask:0xf bank_mask:0xf
    v_add_f32_dpp v13, v13, v13 row_ror:1 row_mask:0xf bank_mask:0xf
    v_add_f32_dpp v14, v14, v14 row_ror:1 row_mask:0xf bank_mask:0xf
    v_add_f32_dpp v15, v15, v15 row_ror:1 row_mask:0xf bank_mask:0xf
    s_waitcnt vmcnt(2)
    buffer_load_dwordx4 v[104:107], v6, s[44:47], s60 offen nt
    s_add_u32 s60, s60, 11264
    s_waitcnt vmcnt(2)
    buffer_load_dwordx4 v[108:111], v6, s[44:47], s60 offen nt
    s_add_u32 s60, s60, 11264
    v_dot2_f32_bf16 v16, v64, v2, 0
    v_dot2_f32_bf16 v17, v68, v2, 0
    v_dot2_f32_bf16 v18, v72, v2, 0
    v_dot2_f32_bf16 v19, v76, v2, 0
    v_dot2_f32_bf16 v16, v65, v3, v16
    v_dot2_f32_bf16 v17, v69, v3, v17
    v_dot2_f32_bf16 v18, v73, v3, v18
    v_dot2_f32_bf16 v19, v77, v3, v19
    v_dot2_f32_bf16 v16, v66, v4, v16
    v_dot2_f32_bf16 v17, v70, v4, v17
    v_dot2_f32_bf16 v18, v74, v4, v18
    v_dot2_f32_bf16 v19, v78, v4, v19
    v_dot2_f32_bf16 v16, v67, v5, v16
    v_dot2_f32_bf16 v17, v71, v5, v17
    v_dot2_f32_bf16 v18, v75, v5, v18
    v_dot2_f32_bf16 v19, v79, v5, v19
    v_add_f32_dpp v16, v16, v16 row_ror:8 row_mask:0xf bank_mask:0xf
    v_add_f32_dpp v17, v17, v17 row_ror:8 row_mask:0xf bank_mask:0xf
    v_add_f32_dpp v18, v18, v18 row_ror:8 row_mask:0xf bank_mask:0xf
    v_add_f32_dpp v19, v19, v19 row_ror:8 row_mask:0xf bank_mask:0xf
    v_add_f32_dpp v16, v16, v16 row_ror:4 row_mask:0xf bank_mask:0xf
    v_add_f32_dpp v17, v17, v17 row_ror:4 row_mask:0xf bank_mask:0xf
    v_add_f32_dpp v18, v18, v18 row_ror:4 row_mask:0xf bank_mask:0xf
    v_add_f32_dpp v19, v19, v19 row_ror:4 row_mask:0xf bank_mask:0xf
    v_add_f32_dpp v16, v16, v16 row_ror:2 row_mask:0xf bank_mask:0xf
    v_add_f32_dpp v17, v17, v17 row_ror:2 row_mask:0xf bank_mask:0xf
    v_add_f32_dpp v18, v18, v18 row_ror:2 row_mask:0xf bank_mask:0xf
    v_add_f32_dpp v19, v19, v19 row_ror:2 row_mask:0xf bank_mask:0xf
    v_add_f32_dpp v16, v16, v16 row_ror:1 row_mask:0xf bank_mask:0xf
    v_add_f32_dpp v17, v17, v17 row_ror:1 row_mask:0xf bank_mask:0xf
    v_add_f32_dpp v18, v18, v18 row_ror:1 row_mask:0xf bank_mask:0xf
    v_add_f32_dpp v19, v19, v19 row_ror:1 row_mask:0xf bank_mask:0xf
    s_waitcnt vmcnt(2)
    buffer_load_dwordx4 v[112:115], v6, s[44:47], s60 offen nt
    s_add_u32 s60, s60, 11264
    s_waitcnt vmcnt(2)
    buffer_load_dwordx4 v[116:119], v6, s[44:47], s60 offen nt
    s_add_u32 s60, s60, 11264
    v_dot2_f32_bf16 v20, v80, v2, 0
    v_dot2_f32_bf16 v21, v84, v2, 0
    v_dot2_f32_bf16 v22, v88, v2, 0
    v_dot2_f32_bf16 v23, v92, v2, 0
    v_dot2_f32_bf16 v20, v81, v3, v20
    v_dot2_f32_bf16 v21, v85, v3, v21
    v_dot2_f32_bf16 v22, v89, v3, v22
    v_dot2_f32_bf16 v23, v93, v3, v23
    v_dot2_f32_bf16 v20, v82, v4, v20
    v_dot2_f32_bf16 v21, v86, v4, v21
    v_dot2_f32_bf16 v22, v90, v4, v22
    v_dot2_f32_bf16 v23, v94, v4, v23
    v_dot2_f32_bf16 v20, v83, v5, v20
    v_dot2_f32_bf16 v21, v87, v5, v21
    v_dot2_f32_bf16 v22, v91, v5, v22
    v_dot2_f32_bf16 v23, v95, v5, v23
    v_add_f32_dpp v20, v20, v20 row_ror:8 row_mask:0xf bank_mask:0xf
    v_add_f32_dpp v21, v21, v21 row_ror:8 row_mask:0xf bank_mask:0xf
    v_add_f32_dpp v22, v22, v22 row_ror:8 row_mask:0xf bank_mask:0xf
    v_add_f32_dpp v23, v23, v23 row_ror:8 row_mask:0xf bank_mask:0xf
    v_add_f32_dpp v20, v20, v20 row_ror:4 row_mask:0xf bank_mask:0xf
    v_add_f32_dpp v21, v21, v21 row_ror:4 row_mask:0xf bank_mask:0xf
    v_add_f32_dpp v22, v22, v22 row_ror:4 row_mask:0xf bank_mask:0xf
    v_add_f32_dpp v23, v23, v23 row_ror:4 row_mask:0xf bank_mask:0xf
    v_add_f32_dpp v20, v20, v20 row_ror:2 row_mask:0xf bank_mask:0xf
    v_add_f32_dpp v21, v21, v21 row_ror:2 row_mask:0xf bank_mask:0xf
    v_add_f32_dpp v22, v22, v22 row_ror:2 row_mask:0xf bank_mask:0xf
    v_add_f32_dpp v23, v23, v23 row_ror:2 row_mask:0xf bank_mask:0xf
    v_add_f32_dpp v20, v20, v20 row_ror:1 row_mask:0xf bank_mask:0xf
    v_add_f32_dpp v21, v21, v21 row_ror:1 row_mask:0xf bank_mask:0xf
    v_add_f32_dpp v22, v22, v22 row_ror:1 row_mask:0xf bank_mask:0xf
    v_add_f32_dpp v23, v23, v23 row_ror:1 row_mask:0xf bank_mask:0xf
    s_waitcnt vmcnt(2)
    buffer_load_dwordx4 v[120:123], v6, s[44:47], s60 offen nt
    s_add_u32 s60, s60, 11264
    s_waitcnt vmcnt(2)
    buffer_load_dwordx4 v[124:127], v6, s[44:47], s60 offen nt
    v_dot2_f32_bf16 v24, v96, v2, 0
    v_dot2_f32_bf16 v25, v100, v2, 0
    v_dot2_f32_bf16 v26, v104, v2, 0
    v_dot2_f32_bf16 v27, v108, v2, 0
    v_dot2_f32_bf16 v24, v97, v3, v24
    v_dot2_f32_bf16 v25, v101, v3, v25
    v_dot2_f32_bf16 v26, v105, v3, v26
    v_dot2_f32_bf16 v27, v109, v3, v27
    v_dot2_f32_bf16 v24, v98, v4, v24
    v_dot2_f32_bf16 v25, v102, v4, v25
    v_dot2_f32_bf16 v26, v106, v4, v26
    v_dot2_f32_bf16 v27, v110, v4, v27
    v_dot2_f32_bf16 v24, v99, v5, v24
    v_dot2_f32_bf16 v25, v103, v5, v25
    v_dot2_f32_bf16 v26, v107, v5, v26
    v_dot2_f32_bf16 v27, v111, v5, v27
    v_add_f32_dpp v24, v24, v24 row_ror:8 row_mask:0xf bank_mask:0xf
    v_add_f32_dpp v25, v25, v25 row_ror:8 row_mask:0xf bank_mask:0xf
    v_add_f32_dpp v26, v26, v26 row_ror:8 row_mask:0xf bank_mask:0xf
    v_add_f32_dpp v27, v27, v27 row_ror:8 row_mask:0xf bank_mask:0xf
    v_add_f32_dpp v24, v24, v24 row_ror:4 row_mask:0xf bank_mask:0xf
    v_add_f32_dpp v25, v25, v25 row_ror:4 row_mask:0xf bank_mask:0xf
    v_add_f32_dpp v26, v26, v26 row_ror:4 row_mask:0xf bank_mask:0xf
    v_add_f32_dpp v27, v27, v27 row_ror:4 row_mask:0xf bank_mask:0xf
    v_add_f32_dpp v24, v24, v24 row_ror:2 row_mask:0xf bank_mask:0xf
    v_add_f32_dpp v25, v25, v25 row_ror:2 row_mask:0xf bank_mask:0xf
    v_add_f32_dpp v26, v26, v26 row_ror:2 row_mask:0xf bank_mask:0xf
    v_add_f32_dpp v27, v27, v27 row_ror:2 row_mask:0xf bank_mask:0xf
    v_add_f32_dpp v24, v24, v24 row_ror:1 row_mask:0xf bank_mask:0xf
    v_add_f32_dpp v25, v25, v25 row_ror:1 row_mask:0xf bank_mask:0xf
    v_add_f32_dpp v26, v26, v26 row_ror:1 row_mask:0xf bank_mask:0xf
    v_add_f32_dpp v27, v27, v27 row_ror:1 row_mask:0xf bank_mask:0xf
    s_waitcnt vmcnt(2)
    buffer_load_dwordx4 v[128:131], v6, s[48:51], s61 offen nt
    s_add_u32 s61, s61, 11264
    s_waitcnt vmcnt(2)
    buffer_load_dwordx4 v[132:135], v6, s[48:51], s61 offen nt
    s_add_u32 s61, s61, 11264
    s_waitcnt vmcnt(2)
    buffer_load_dwordx4 v[136:139], v6, s[48:51], s61 offen nt
    s_add_u32 s61, s61, 11264
    v_dot2_f32_bf16 v28, v112, v2, 0
    v_dot2_f32_bf16 v29, v116, v2, 0
    v_dot2_f32_bf16 v30, v120, v2, 0
    v_dot2_f32_bf16 v31, v124, v2, 0
    v_dot2_f32_bf16 v28, v113, v3, v28
    v_dot2_f32_bf16 v29, v117, v3, v29
    v_dot2_f32_bf16 v30, v121, v3, v30
    v_dot2_f32_bf16 v31, v125, v3, v31
    v_dot2_f32_bf16 v28, v114, v4, v28
    v_dot2_f32_bf16 v29, v118, v4, v29
    v_dot2_f32_bf16 v30, v122, v4, v30
    v_dot2_f32_bf16 v31, v126, v4, v31
    v_dot2_f32_bf16 v28, v115, v5, v28
    v_dot2_f32_bf16 v29, v119, v5, v29
    v_dot2_f32_bf16 v30, v123, v5, v30
    v_dot2_f32_bf16 v31, v127, v5, v31
    v_add_f32_dpp v28, v28, v28 row_ror:8 row_mask:0xf bank_mask:0xf
    v_add_f32_dpp v29, v29, v29 row_ror:8 row_mask:0xf bank_mask:0xf
    v_add_f32_dpp v30, v30, v30 row_ror:8 row_mask:0xf bank_mask:0xf
    v_add_f32_dpp v31, v31, v31 row_ror:8 row_mask:0xf bank_mask:0xf
    v_add_f32_dpp v28, v28, v28 row_ror:4 row_mask:0xf bank_mask:0xf
    v_add_f32_dpp v29, v29, v29 row_ror:4 row_mask:0xf bank_mask:0xf
    v_add_f32_dpp v30, v30, v30 row_ror:4 row_mask:0xf bank_mask:0xf
    v_add_f32_dpp v31, v31, v31 row_ror:4 row_mask:0xf bank_mask:0xf
    v_add_f32_dpp v28, v28, v28 row_ror:2 row_mask:0xf bank_mask:0xf
    v_add_f32_dpp v29, v29, v29 row_ror:2 row_mask:0xf bank_mask:0xf
    v_add_f32_dpp v30, v30, v30 row_ror:2 row_mask:0xf bank_mask:0xf
    v_add_f32_dpp v31, v31, v31 row_ror:2 row_mask:0xf bank_mask:0xf
    v_add_f32_dpp v28, v28, v28 row_ror:1 row_mask:0xf bank_mask:0xf
    v_add_f32_dpp v29, v29, v29 row_ror:1 row_mask:0xf bank_mask:0xf
    v_add_f32_dpp v30, v30, v30 row_ror:1 row_mask:0xf bank_mask:0xf
    v_add_f32_dpp v31, v31, v31 row_ror:1 row_mask:0xf bank_mask:0xf
    s_waitcnt vmcnt(2)
    buffer_load_dwordx4 v[140:143], v6, s[48:51], s61 offen nt
    s_add_u32 s61, s61, 11264
    s_waitcnt vmcnt(2)
    buffer_load_dwordx4 v[144:147], v6, s[48:51], s61 offen nt
    s_add_u32 s61, s61, 11264
    v_add_f32 v8, s62, v8
    v_add_f32 v9, s62, v9
    v_max3_f32 v160, v8, v9, v10
    v_max3_f32 v160, v160, v11, v12
    v_max3_f32 v160, v160, v13, v14
    v_max3_f32 v160, v160, v15, v16
    v_max3_f32 v160, v160, v17, v18
    v_max3_f32 v160, v160, v19, v20
    v_max3_f32 v160, v160, v21, v22
    v_max3_f32 v160, v160, v23, v24
    v_max3_f32 v160, v160, v25, v26
    v_max3_f32 v160, v160, v27, v28
    v_max3_f32 v160, v160, v29, v30
    v_max_f32 v160, v160, v31
    v_mov_b32 v161, v160
    s_nop 1
    v_permlane32_swap_b32 v160, v161
    v_max_f32 v160, v160, v161
    v_mov_b32 v161, v160
    s_nop 1
    v_permlane16_swap_b32 v160, v161
    v_max_f32 v160, v160, v161
    v_mul_f32 v160, s64, v160
    v_fma_f32 v8, v8, s64, -v160
    v_fma_f32 v9, v9, s64, -v160
    v_fma_f32 v10, v10, s64, -v160
    v_fma_f32 v11, v11, s64, -v160
    v_fma_f32 v12, v12, s64, -v160
    v_fma_f32 v13, v13, s64, -v160
    v_fma_f32 v14, v14, s64, -v160
    v_fma_f32 v15, v15, s64, -v160
    v_fma_f32 v16, v16, s64, -v160
    v_fma_f32 v17, v17, s64, -v160
    v_fma_f32 v18, v18, s64, -v160
    v_fma_f32 v19, v19, s64, -v160
    v_fma_f32 v20, v20, s64, -v160
    v_fma_f32 v21, v21, s64, -v160
    v_fma_f32 v22, v22, s64, -v160
    v_fma_f32 v23, v23, s64, -v160
    v_fma_f32 v24, v24, s64, -v160
    v_fma_f32 v25, v25, s64, -v160
    v_fma_f32 v26, v26, s64, -v160
    v_fma_f32 v27, v27, s64, -v160
    v_fma_f32 v28, v28, s64, -v160
    v_fma_f32 v29, v29, s64, -v160
    v_fma_f32 v30, v30, s64, -v160
    v_fma_f32 v31, v31, s64, -v160
    v_exp_f32 v8, v8
    v_exp_f32 v9, v9
    v_exp_f32 v10, v10
    v_exp_f32 v11, v11
    v_exp_f32 v12, v12
    v_exp_f32 v13, v13
    v_exp_f32 v14, v14
    v_exp_f32 v15, v15
    v_exp_f32 v16, v16
    v_exp_f32 v17, v17
    v_exp_f32 v18, v18
    v_exp_f32 v19, v19
    v_exp_f32 v20, v20
    v_exp_f32 v21, v21
    v_exp_f32 v22, v22
    v_exp_f32 v23, v23
    v_exp_f32 v24, v24
    v_exp_f32 v25, v25
    v_exp_f32 v26, v26
    v_exp_f32 v27, v27
    v_exp_f32 v28, v28
    v_exp_f32 v29, v29
    v_exp_f32 v30, v30
    v_exp_f32 v31, v31
    s_waitcnt vmcnt(2)
    buffer_load_dwordx4 v[148:151], v6, s[48:51], s61 offen nt
    s_add_u32 s61, s61, 11264
    v_add_f32 v162, v8, v9
    v_add_f32 v163, v10, v11
    v_add_f32 v162, v162, v12
    v_add_f32 v163, v163, v13
    v_add_f32 v162, v162, v14
    v_add_f32 v163, v163, v15
    v_add_f32 v162, v162, v16
    v_add_f32 v163, v163, v17
    v_add_f32 v162, v162, v18
    v_add_f32 v163, v163, v19
    v_add_f32 v162, v162, v20
    v_add_f32 v163, v163, v21
    v_add_f32 v162, v162, v22
    v_add_f32 v163, v163, v23
    v_add_f32 v162, v162, v24
    v_add_f32 v163, v163, v25
    v_add_f32 v162, v162, v26
    v_add_f32 v163, v163, v27
    v_add_f32 v162, v162, v28
    v_add_f32 v163, v163, v29
    v_add_f32 v162, v162, v30
    v_add_f32 v163, v163, v31
    v_add_f32 v162, v162, v163
    v_mov_b32 v163, v162
    s_nop 1
    v_permlane32_swap_b32 v162, v163
    v_add_f32 v162, v162, v163
    v_mov_b32 v163, v162
    s_nop 1
    v_permlane16_swap_b32 v162, v163
    v_add_f32 v161, v162, v163
    s_lshl_b32 s7, s3, 3
    s_add_u32 s7, s7, 0x24200
    v_mov_b32 v164, s7
    ds_write_b64 v164, v[160:161]
    v_mov_b32 v164, 0x24008
    v_mov_b32 v165, 1
    s_waitcnt lgkmcnt(0)
    s_mov_b64 exec, 1
    ds_add_u32 v164, v165
    s_mov_b64 exec, -1
    v_and_b32 v2, 15, v1
    v_lshlrev_b32 v2, 5, v2
    v_bfe_u32 v3, v1, 5, 1
    v_lshl_add_u32 v2, v3, 4, v2
    v_bfe_u32 v3, v1, 4, 1
    v_lshl_add_u32 v2, v3, 3, v2
    s_lshl_b32 s7, s3, 9
    s_add_u32 s7, s7, 0x10000
    v_add_u32 v2, s7, v2
    s_waitcnt vmcnt(2)
    buffer_load_dwordx4 v[32:35], v6, s[48:51], s61 offen nt
    s_add_u32 s61, s61, 11264
    v_lshlrev_b32 v160, 16, v128
    v_and_b32 v161, 0xffff0000, v128
    v_lshlrev_b32 v162, 16, v129
    v_and_b32 v163, 0xffff0000, v129
    v_lshlrev_b32 v164, 16, v130
    v_and_b32 v165, 0xffff0000, v130
    v_lshlrev_b32 v166, 16, v131
    v_and_b32 v167, 0xffff0000, v131
    v_pk_mul_f32 v[152:153], v[160:161], v[10:11] op_sel_hi:[1,0]
    v_pk_mul_f32 v[154:155], v[162:163], v[10:11] op_sel_hi:[1,0]
    v_pk_mul_f32 v[156:157], v[164:165], v[10:11] op_sel_hi:[1,0]
    v_pk_mul_f32 v[158:159], v[166:167], v[10:11] op_sel_hi:[1,0]
    v_lshlrev_b32 v160, 16, v132
    v_and_b32 v161, 0xffff0000, v132
    v_lshlrev_b32 v162, 16, v133
    v_and_b32 v163, 0xffff0000, v133
    v_lshlrev_b32 v164, 16, v134
    v_and_b32 v165, 0xffff0000, v134
    v_lshlrev_b32 v166, 16, v135
    v_and_b32 v167, 0xffff0000, v135
    v_pk_fma_f32 v[152:153], v[160:161], v[10:11], v[152:153] op_sel:[0,1,0] op_sel_hi:[1,1,1]
    v_pk_fma_f32 v[154:155], v[162:163], v[10:11], v[154:155] op_sel:[0,1,0] op_sel_hi:[1,1,1]
    v_pk_fma_f32 v[156:157], v[164:165], v[10:11], v[156:157] op_sel:[0,1,0] op_sel_hi:[1,1,1]
    v_pk_fma_f32 v[158:159], v[166:167], v[10:11], v[158:159] op_sel:[0,1,0] op_sel_hi:[1,1,1]
    s_waitcnt vmcnt(2)
    buffer_load_dwordx4 v[36:39], v6, s[48:51], s61 offen nt
    s_add_u32 s61, s61, 11264
    v_lshlrev_b32 v160, 16, v136
    v_and_b32 v161, 0xffff0000, v136
    v_lshlrev_b32 v162, 16, v137
    v_and_b32 v163, 0xffff0000, v137
    v_lshlrev_b32 v164, 16, v138
    v_and_b32 v165, 0xffff0000, v138
    v_lshlrev_b32 v166, 16, v139
    v_and_b32 v167, 0xffff0000, v139
    v_pk_fma_f32 v[152:153], v[160:161], v[12:13], v[152:153] op_sel_hi:[1,0,1]
    v_pk_fma_f32 v[154:155], v[162:163], v[12:13], v[154:155] op_sel_hi:[1,0,1]
    v_pk_fma_f32 v[156:157], v[164:165], v[12:13], v[156:157] op_sel_hi:[1,0,1]
    v_pk_fma_f32 v[158:159], v[166:167], v[12:13], v[158:159] op_sel_hi:[1,0,1]
    v_lshlrev_b32 v160, 16, v140
    v_and_b32 v161, 0xffff0000, v140
    v_lshlrev_b32 v162, 16, v141
    v_and_b32 v163, 0xffff0000, v141
    v_lshlrev_b32 v164, 16, v142
    v_and_b32 v165, 0xffff0000, v142
    v_lshlrev_b32 v166, 16, v143
    v_and_b32 v167, 0xffff0000, v143
    v_pk_fma_f32 v[152:153], v[160:161], v[12:13], v[152:153] op_sel:[0,1,0] op_sel_hi:[1,1,1]
    v_pk_fma_f32 v[154:155], v[162:163], v[12:13], v[154:155] op_sel:[0,1,0] op_sel_hi:[1,1,1]
    v_pk_fma_f32 v[156:157], v[164:165], v[12:13], v[156:157] op_sel:[0,1,0] op_sel_hi:[1,1,1]
    v_pk_fma_f32 v[158:159], v[166:167], v[12:13], v[158:159] op_sel:[0,1,0] op_sel_hi:[1,1,1]
    s_waitcnt vmcnt(2)
    buffer_load_dwordx4 v[40:43], v6, s[48:51], s61 offen nt
    s_add_u32 s61, s61, 11264
    v_lshlrev_b32 v160, 16, v144
    v_and_b32 v161, 0xffff0000, v144
    v_lshlrev_b32 v162, 16, v145
    v_and_b32 v163, 0xffff0000, v145
    v_lshlrev_b32 v164, 16, v146
    v_and_b32 v165, 0xffff0000, v146
    v_lshlrev_b32 v166, 16, v147
    v_and_b32 v167, 0xffff0000, v147
    v_pk_fma_f32 v[152:153], v[160:161], v[14:15], v[152:153] op_sel_hi:[1,0,1]
    v_pk_fma_f32 v[154:155], v[162:163], v[14:15], v[154:155] op_sel_hi:[1,0,1]
    v_pk_fma_f32 v[156:157], v[164:165], v[14:15], v[156:157] op_sel_hi:[1,0,1]
    v_pk_fma_f32 v[158:159], v[166:167], v[14:15], v[158:159] op_sel_hi:[1,0,1]
    v_lshlrev_b32 v160, 16, v148
    v_and_b32 v161, 0xffff0000, v148
    v_lshlrev_b32 v162, 16, v149
    v_and_b32 v163, 0xffff0000, v149
    v_lshlrev_b32 v164, 16, v150
    v_and_b32 v165, 0xffff0000, v150
    v_lshlrev_b32 v166, 16, v151
    v_and_b32 v167, 0xffff0000, v151
    v_pk_fma_f32 v[152:153], v[160:161], v[14:15], v[152:153] op_sel:[0,1,0] op_sel_hi:[1,1,1]
    v_pk_fma_f32 v[154:155], v[162:163], v[14:15], v[154:155] op_sel:[0,1,0] op_sel_hi:[1,1,1]
    v_pk_fma_f32 v[156:157], v[164:165], v[14:15], v[156:157] op_sel:[0,1,0] op_sel_hi:[1,1,1]
    v_pk_fma_f32 v[158:159], v[166:167], v[14:15], v[158:159] op_sel:[0,1,0] op_sel_hi:[1,1,1]
    s_waitcnt vmcnt(2)
    buffer_load_dwordx4 v[44:47], v6, s[48:51], s61 offen nt
    s_add_u32 s61, s61, 11264
    v_lshlrev_b32 v160, 16, v32
    v_and_b32 v161, 0xffff0000, v32
    v_lshlrev_b32 v162, 16, v33
    v_and_b32 v163, 0xffff0000, v33
    v_lshlrev_b32 v164, 16, v34
    v_and_b32 v165, 0xffff0000, v34
    v_lshlrev_b32 v166, 16, v35
    v_and_b32 v167, 0xffff0000, v35
    v_pk_fma_f32 v[152:153], v[160:161], v[16:17], v[152:153] op_sel_hi:[1,0,1]
    v_pk_fma_f32 v[154:155], v[162:163], v[16:17], v[154:155] op_sel_hi:[1,0,1]
    v_pk_fma_f32 v[156:157], v[164:165], v[16:17], v[156:157] op_sel_hi:[1,0,1]
    v_pk_fma_f32 v[158:159], v[166:167], v[16:17], v[158:159] op_sel_hi:[1,0,1]
    s_waitcnt vmcnt(2)
    buffer_load_dwordx4 v[48:51], v6, s[48:51], s61 offen nt
    s_add_u32 s61, s61, 11264
    v_lshlrev_b32 v160, 16, v36
    v_and_b32 v161, 0xffff0000, v36
    v_lshlrev_b32 v162, 16, v37
    v_and_b32 v163, 0xffff0000, v37
    v_lshlrev_b32 v164, 16, v38
    v_and_b32 v165, 0xffff0000, v38
    v_lshlrev_b32 v166, 16, v39
    v_and_b32 v167, 0xffff0000, v39
    v_pk_fma_f32 v[152:153], v[160:161], v[16:17], v[152:153] op_sel:[0,1,0] op_sel_hi:[1,1,1]
    v_pk_fma_f32 v[154:155], v[162:163], v[16:17], v[154:155] op_sel:[0,1,0] op_sel_hi:[1,1,1]
    v_pk_fma_f32 v[156:157], v[164:165], v[16:17], v[156:157] op_sel:[0,1,0] op_sel_hi:[1,1,1]
    v_pk_fma_f32 v[158:159], v[166:167], v[16:17], v[158:159] op_sel:[0,1,0] op_sel_hi:[1,1,1]
    s_waitcnt vmcnt(2)
    buffer_load_dwordx4 v[52:55], v6, s[48:51], s61 offen nt
    s_add_u32 s61, s61, 11264
    v_lshlrev_b32 v160, 16, v40
    v_and_b32 v161, 0xffff0000, v40
    v_lshlrev_b32 v162, 16, v41
    v_and_b32 v163, 0xffff0000, v41
    v_lshlrev_b32 v164, 16, v42
    v_and_b32 v165, 0xffff0000, v42
    v_lshlrev_b32 v166, 16, v43
    v_and_b32 v167, 0xffff0000, v43
    v_pk_fma_f32 v[152:153], v[160:161], v[18:19], v[152:153] op_sel_hi:[1,0,1]
    v_pk_fma_f32 v[154:155], v[162:163], v[18:19], v[154:155] op_sel_hi:[1,0,1]
    v_pk_fma_f32 v[156:157], v[164:165], v[18:19], v[156:157] op_sel_hi:[1,0,1]
    v_pk_fma_f32 v[158:159], v[166:167], v[18:19], v[158:159] op_sel_hi:[1,0,1]
    s_waitcnt vmcnt(2)
    buffer_load_dwordx4 v[56:59], v6, s[48:51], s61 offen nt
    s_add_u32 s61, s61, 11264
    v_lshlrev_b32 v160, 16, v44
    v_and_b32 v161, 0xffff0000, v44
    v_lshlrev_b32 v162, 16, v45
    v_and_b32 v163, 0xffff0000, v45
    v_lshlrev_b32 v164, 16, v46
    v_and_b32 v165, 0xffff0000, v46
    v_lshlrev_b32 v166, 16, v47
    v_and_b32 v167, 0xffff0000, v47
    v_pk_fma_f32 v[152:153], v[160:161], v[18:19], v[152:153] op_sel:[0,1,0] op_sel_hi:[1,1,1]
    v_pk_fma_f32 v[154:155], v[162:163], v[18:19], v[154:155] op_sel:[0,1,0] op_sel_hi:[1,1,1]
    v_pk_fma_f32 v[156:157], v[164:165], v[18:19], v[156:157] op_sel:[0,1,0] op_sel_hi:[1,1,1]
    v_pk_fma_f32 v[158:159], v[166:167], v[18:19], v[158:159] op_sel:[0,1,0] op_sel_hi:[1,1,1]
    s_waitcnt vmcnt(2)
    buffer_load_dwordx4 v[60:63], v6, s[48:51], s61 offen nt
    s_add_u32 s61, s61, 11264
    v_lshlrev_b32 v160, 16, v48
    v_and_b32 v161, 0xffff0000, v48
    v_lshlrev_b32 v162, 16, v49
    v_and_b32 v163, 0xffff0000, v49
    v_lshlrev_b32 v164, 16, v50
    v_and_b32 v165, 0xffff0000, v50
    v_lshlrev_b32 v166, 16, v51
    v_and_b32 v167, 0xffff0000, v51
    v_pk_fma_f32 v[152:153], v[160:161], v[20:21], v[152:153] op_sel_hi:[1,0,1]
    v_pk_fma_f32 v[154:155], v[162:163], v[20:21], v[154:155] op_sel_hi:[1,0,1]
    v_pk_fma_f32 v[156:157], v[164:165], v[20:21], v[156:157] op_sel_hi:[1,0,1]
    v_pk_fma_f32 v[158:159], v[166:167], v[20:21], v[158:159] op_sel_hi:[1,0,1]
    s_waitcnt vmcnt(2)
    buffer_load_dwordx4 v[64:67], v6, s[48:51], s61 offen nt
    s_add_u32 s61, s61, 11264
    v_lshlrev_b32 v160, 16, v52
    v_and_b32 v161, 0xffff0000, v52
    v_lshlrev_b32 v162, 16, v53
    v_and_b32 v163, 0xffff0000, v53
    v_lshlrev_b32 v164, 16, v54
    v_and_b32 v165, 0xffff0000, v54
    v_lshlrev_b32 v166, 16, v55
    v_and_b32 v167, 0xffff0000, v55
    v_pk_fma_f32 v[152:153], v[160:161], v[20:21], v[152:153] op_sel:[0,1,0] op_sel_hi:[1,1,1]
    v_pk_fma_f32 v[154:155], v[162:163], v[20:21], v[154:155] op_sel:[0,1,0] op_sel_hi:[1,1,1]
    v_pk_fma_f32 v[156:157], v[164:165], v[20:21], v[156:157] op_sel:[0,1,0] op_sel_hi:[1,1,1]
    v_pk_fma_f32 v[158:159], v[166:167], v[20:21], v[158:159] op_sel:[0,1,0] op_sel_hi:[1,1,1]
    s_waitcnt vmcnt(2)
    buffer_load_dwordx4 v[68:71], v6, s[48:51], s61 offen nt
    s_add_u32 s61, s61, 11264
    v_lshlrev_b32 v160, 16, v56
    v_and_b32 v161, 0xffff0000, v56
    v_lshlrev_b32 v162, 16, v57
    v_and_b32 v163, 0xffff0000, v57
    v_lshlrev_b32 v164, 16, v58
    v_and_b32 v165, 0xffff0000, v58
    v_lshlrev_b32 v166, 16, v59
    v_and_b32 v167, 0xffff0000, v59
    v_pk_fma_f32 v[152:153], v[160:161], v[22:23], v[152:153] op_sel_hi:[1,0,1]
    v_pk_fma_f32 v[154:155], v[162:163], v[22:23], v[154:155] op_sel_hi:[1,0,1]
    v_pk_fma_f32 v[156:157], v[164:165], v[22:23], v[156:157] op_sel_hi:[1,0,1]
    v_pk_fma_f32 v[158:159], v[166:167], v[22:23], v[158:159] op_sel_hi:[1,0,1]
    s_waitcnt vmcnt(2)
    buffer_load_dwordx4 v[72:75], v6, s[48:51], s61 offen nt
    s_add_u32 s61, s61, 11264
    v_lshlrev_b32 v160, 16, v60
    v_and_b32 v161, 0xffff0000, v60
    v_lshlrev_b32 v162, 16, v61
    v_and_b32 v163, 0xffff0000, v61
    v_lshlrev_b32 v164, 16, v62
    v_and_b32 v165, 0xffff0000, v62
    v_lshlrev_b32 v166, 16, v63
    v_and_b32 v167, 0xffff0000, v63
    v_pk_fma_f32 v[152:153], v[160:161], v[22:23], v[152:153] op_sel:[0,1,0] op_sel_hi:[1,1,1]
    v_pk_fma_f32 v[154:155], v[162:163], v[22:23], v[154:155] op_sel:[0,1,0] op_sel_hi:[1,1,1]
    v_pk_fma_f32 v[156:157], v[164:165], v[22:23], v[156:157] op_sel:[0,1,0] op_sel_hi:[1,1,1]
    v_pk_fma_f32 v[158:159], v[166:167], v[22:23], v[158:159] op_sel:[0,1,0] op_sel_hi:[1,1,1]
    s_waitcnt vmcnt(2)
    buffer_load_dwordx4 v[76:79], v6, s[48:51], s61 offen nt
    s_add_u32 s61, s61, 11264
    v_lshlrev_b32 v160, 16, v64
    v_and_b32 v161, 0xffff0000, v64
    v_lshlrev_b32 v162, 16, v65
    v_and_b32 v163, 0xffff0000, v65
    v_lshlrev_b32 v164, 16, v66
    v_and_b32 v165, 0xffff0000, v66
    v_lshlrev_b32 v166, 16, v67
    v_and_b32 v167, 0xffff0000, v67
    v_pk_fma_f32 v[152:153], v[160:161], v[24:25], v[152:153] op_sel_hi:[1,0,1]
    v_pk_fma_f32 v[154:155], v[162:163], v[24:25], v[154:155] op_sel_hi:[1,0,1]
    v_pk_fma_f32 v[156:157], v[164:165], v[24:25], v[156:157] op_sel_hi:[1,0,1]
    v_pk_fma_f32 v[158:159], v[166:167], v[24:25], v[158:159] op_sel_hi:[1,0,1]
    s_waitcnt vmcnt(2)
    buffer_load_dwordx4 v[80:83], v6, s[48:51], s61 offen nt
    s_add_u32 s61, s61, 11264
    v_lshlrev_b32 v160, 16, v68
    v_and_b32 v161, 0xffff0000, v68
    v_lshlrev_b32 v162, 16, v69
    v_and_b32 v163, 0xffff0000, v69
    v_lshlrev_b32 v164, 16, v70
    v_and_b32 v165, 0xffff0000, v70
    v_lshlrev_b32 v166, 16, v71
    v_and_b32 v167, 0xffff0000, v71
    v_pk_fma_f32 v[152:153], v[160:161], v[24:25], v[152:153] op_sel:[0,1,0] op_sel_hi:[1,1,1]
    v_pk_fma_f32 v[154:155], v[162:163], v[24:25], v[154:155] op_sel:[0,1,0] op_sel_hi:[1,1,1]
    v_pk_fma_f32 v[156:157], v[164:165], v[24:25], v[156:157] op_sel:[0,1,0] op_sel_hi:[1,1,1]
    v_pk_fma_f32 v[158:159], v[166:167], v[24:25], v[158:159] op_sel:[0,1,0] op_sel_hi:[1,1,1]
    s_waitcnt vmcnt(2)
    buffer_load_dwordx4 v[84:87], v6, s[48:51], s61 offen nt
    s_add_u32 s61, s61, 11264
    v_lshlrev_b32 v160, 16, v72
    v_and_b32 v161, 0xffff0000, v72
    v_lshlrev_b32 v162, 16, v73
    v_and_b32 v163, 0xffff0000, v73
    v_lshlrev_b32 v164, 16, v74
    v_and_b32 v165, 0xffff0000, v74
    v_lshlrev_b32 v166, 16, v75
    v_and_b32 v167, 0xffff0000, v75
    v_pk_fma_f32 v[152:153], v[160:161], v[26:27], v[152:153] op_sel_hi:[1,0,1]
    v_pk_fma_f32 v[154:155], v[162:163], v[26:27], v[154:155] op_sel_hi:[1,0,1]
    v_pk_fma_f32 v[156:157], v[164:165], v[26:27], v[156:157] op_sel_hi:[1,0,1]
    v_pk_fma_f32 v[158:159], v[166:167], v[26:27], v[158:159] op_sel_hi:[1,0,1]
    s_waitcnt vmcnt(2)
    buffer_load_dwordx4 v[88:91], v6, s[48:51], s61 offen nt
    s_add_u32 s61, s61, 11264
    v_lshlrev_b32 v160, 16, v76
    v_and_b32 v161, 0xffff0000, v76
    v_lshlrev_b32 v162, 16, v77
    v_and_b32 v163, 0xffff0000, v77
    v_lshlrev_b32 v164, 16, v78
    v_and_b32 v165, 0xffff0000, v78
    v_lshlrev_b32 v166, 16, v79
    v_and_b32 v167, 0xffff0000, v79
    v_pk_fma_f32 v[152:153], v[160:161], v[26:27], v[152:153] op_sel:[0,1,0] op_sel_hi:[1,1,1]
    v_pk_fma_f32 v[154:155], v[162:163], v[26:27], v[154:155] op_sel:[0,1,0] op_sel_hi:[1,1,1]
    v_pk_fma_f32 v[156:157], v[164:165], v[26:27], v[156:157] op_sel:[0,1,0] op_sel_hi:[1,1,1]
    v_pk_fma_f32 v[158:159], v[166:167], v[26:27], v[158:159] op_sel:[0,1,0] op_sel_hi:[1,1,1]
    s_waitcnt vmcnt(2)
    buffer_load_dwordx4 v[92:95], v6, s[48:51], s61 offen nt
    v_lshlrev_b32 v160, 16, v80
    v_and_b32 v161, 0xffff0000, v80
    v_lshlrev_b32 v162, 16, v81
    v_and_b32 v163, 0xffff0000, v81
    v_lshlrev_b32 v164, 16, v82
    v_and_b32 v165, 0xffff0000, v82
    v_lshlrev_b32 v166, 16, v83
    v_and_b32 v167, 0xffff0000, v83
    v_pk_fma_f32 v[152:153], v[160:161], v[28:29], v[152:153] op_sel_hi:[1,0,1]
    v_pk_fma_f32 v[154:155], v[162:163], v[28:29], v[154:155] op_sel_hi:[1,0,1]
    v_pk_fma_f32 v[156:157], v[164:165], v[28:29], v[156:157] op_sel_hi:[1,0,1]
    v_pk_fma_f32 v[158:159], v[166:167], v[28:29], v[158:159] op_sel_hi:[1,0,1]
    s_cmp_eq_u32 s62, 0
    s_cbranch_scc1 AL_9
    s_waitcnt vmcnt(2)
    v_lshlrev_b32 v160, 16, v84
    v_and_b32 v161, 0xffff0000, v84
    v_lshlrev_b32 v162, 16, v85
    v_and_b32 v163, 0xffff0000, v85
    v_lshlrev_b32 v164, 16, v86
    v_and_b32 v165, 0xffff0000, v86
    v_lshlrev_b32 v166, 16, v87
    v_and_b32 v167, 0xffff0000, v87
    v_pk_fma_f32 v[152:153], v[160:161], v[28:29], v[152:153] op_sel:[0,1,0] op_sel_hi:[1,1,1]
    v_pk_fma_f32 v[154:155], v[162:163], v[28:29], v[154:155] op_sel:[0,1,0] op_sel_hi:[1,1,1]
    v_pk_fma_f32 v[156:157], v[164:165], v[28:29], v[156:157] op_sel:[0,1,0] op_sel_hi:[1,1,1]
    v_pk_fma_f32 v[158:159], v[166:167], v[28:29], v[158:159] op_sel:[0,1,0] op_sel_hi:[1,1,1]
    s_waitcnt vmcnt(1)
    v_lshlrev_b32 v160, 16, v88
    v_and_b32 v161, 0xffff0000, v88
    v_lshlrev_b32 v162, 16, v89
    v_and_b32 v163, 0xffff0000, v89
    v_lshlrev_b32 v164, 16, v90
    v_and_b32 v165, 0xffff0000, v90
    v_lshlrev_b32 v166, 16, v91
    v_and_b32 v167, 0xffff0000, v91
    v_pk_fma_f32 v[152:153], v[160:161], v[30:31], v[152:153] op_sel_hi:[1,0,1]
    v_pk_fma_f32 v[154:155], v[162:163], v[30:31], v[154:155] op_sel_hi:[1,0,1]
    v_pk_fma_f32 v[156:157], v[164:165], v[30:31], v[156:157] op_sel_hi:[1,0,1]
    v_pk_fma_f32 v[158:159], v[166:167], v[30:31], v[158:159] op_sel_hi:[1,0,1]
    s_waitcnt vmcnt(0)
    v_lshlrev_b32 v160, 16, v92
    v_and_b32 v161, 0xffff0000, v92
    v_lshlrev_b32 v162, 16, v93
    v_and_b32 v163, 0xffff0000, v93
    v_lshlrev_b32 v164, 16, v94
    v_and_b32 v165, 0xffff0000, v94
    v_lshlrev_b32 v166, 16, v95
    v_and_b32 v167, 0xffff0000, v95
    v_pk_fma_f32 v[152:153], v[160:161], v[30:31], v[152:153] op_sel:[0,1,0] op_sel_hi:[1,1,1]
    v_pk_fma_f32 v[154:155], v[162:163], v[30:31], v[154:155] op_sel:[0,1,0] op_sel_hi:[1,1,1]
    v_pk_fma_f32 v[156:157], v[164:165], v[30:31], v[156:157] op_sel:[0,1,0] op_sel_hi:[1,1,1]
    v_pk_fma_f32 v[158:159], v[166:167], v[30:31], v[158:159] op_sel:[0,1,0] op_sel_hi:[1,1,1]
    s_branch L_AFIN
AL_9:
    s_waitcnt vmcnt(2)
    buffer_load_dwordx4 v[96:99], v6, s[48:51], s63 offen nt
    v_lshlrev_b32 v160, 16, v84
    v_and_b32 v161, 0xffff0000, v84
    v_lshlrev_b32 v162, 16, v85
    v_and_b32 v163, 0xffff0000, v85
    v_lshlrev_b32 v164, 16, v86
    v_and_b32 v165, 0xffff0000, v86
    v_lshlrev_b32 v166, 16, v87
    v_and_b32 v167, 0xffff0000, v87
    v_pk_fma_f32 v[152:153], v[160:161], v[28:29], v[152:153] op_sel:[0,1,0] op_sel_hi:[1,1,1]
    v_pk_fma_f32 v[154:155], v[162:163], v[28:29], v[154:155] op_sel:[0,1,0] op_sel_hi:[1,1,1]
    v_pk_fma_f32 v[156:157], v[164:165], v[28:29], v[156:157] op_sel:[0,1,0] op_sel_hi:[1,1,1]
    v_pk_fma_f32 v[158:159], v[166:167], v[28:29], v[158:159] op_sel:[0,1,0] op_sel_hi:[1,1,1]
    s_waitcnt vmcnt(2)
    buffer_load_dwordx4 v[100:103], v6, s[48:51], s65 offen nt
    v_lshlrev_b32 v160, 16, v88
    v_and_b32 v161, 0xffff0000, v88
    v_lshlrev_b32 v162, 16, v89
    v_and_b32 v163, 0xffff0000, v89
    v_lshlrev_b32 v164, 16, v90
    v_and_b32 v165, 0xffff0000, v90
    v_lshlrev_b32 v166, 16, v91
    v_and_b32 v167, 0xffff0000, v91
    v_pk_fma_f32 v[152:153], v[160:161], v[30:31], v[152:153] op_sel_hi:[1,0,1]
    v_pk_fma_f32 v[154:155], v[162:163], v[30:31], v[154:155] op_sel_hi:[1,0,1]
    v_pk_fma_f32 v[156:157], v[164:165], v[30:31], v[156:157] op_sel_hi:[1,0,1]
    v_pk_fma_f32 v[158:159], v[166:167], v[30:31], v[158:159] op_sel_hi:[1,0,1]
    s_waitcnt vmcnt(2)
    v_lshlrev_b32 v160, 16, v92
    v_and_b32 v161, 0xffff0000, v92
    v_lshlrev_b32 v162, 16, v93
    v_and_b32 v163, 0xffff0000, v93
    v_lshlrev_b32 v164, 16, v94
    v_and_b32 v165, 0xffff0000, v94
    v_lshlrev_b32 v166, 16, v95
    v_and_b32 v167, 0xffff0000, v95
    v_pk_fma_f32 v[152:153], v[160:161], v[30:31], v[152:153] op_sel:[0,1,0] op_sel_hi:[1,1,1]
    v_pk_fma_f32 v[154:155], v[162:163], v[30:31], v[154:155] op_sel:[0,1,0] op_sel_hi:[1,1,1]
    v_pk_fma_f32 v[156:157], v[164:165], v[30:31], v[156:157] op_sel:[0,1,0] op_sel_hi:[1,1,1]
    v_pk_fma_f32 v[158:159], v[166:167], v[30:31], v[158:159] op_sel:[0,1,0] op_sel_hi:[1,1,1]
    s_waitcnt vmcnt(1)
    v_lshlrev_b32 v160, 16, v96
    v_and_b32 v161, 0xffff0000, v96
    v_lshlrev_b32 v162, 16, v97
    v_and_b32 v163, 0xffff0000, v97
    v_lshlrev_b32 v164, 16, v98
    v_and_b32 v165, 0xffff0000, v98
    v_lshlrev_b32 v166, 16, v99
    v_and_b32 v167, 0xffff0000, v99
    v_pk_fma_f32 v[152:153], v[160:161], v[8:9], v[152:153] op_sel_hi:[1,0,1]
    v_pk_fma_f32 v[154:155], v[162:163], v[8:9], v[154:155] op_sel_hi:[1,0,1]
    v_pk_fma_f32 v[156:157], v[164:165], v[8:9], v[156:157] op_sel_hi:[1,0,1]
    v_pk_fma_f32 v[158:159], v[166:167], v[8:9], v[158:159] op_sel_hi:[1,0,1]
    s_waitcnt vmcnt(0)
    v_lshlrev_b32 v160, 16, v100
    v_and_b32 v161, 0xffff0000, v100
    v_lshlrev_b32 v162, 16, v101
    v_and_b32 v163, 0xffff0000, v101
    v_lshlrev_b32 v164, 16, v102
    v_and_b32 v165, 0xffff0000, v102
    v_lshlrev_b32 v166, 16, v103
    v_and_b32 v167, 0xffff0000, v103
    v_pk_fma_f32 v[152:153], v[160:161], v[8:9], v[152:153] op_sel:[0,1,0] op_sel_hi:[1,1,1]
    v_pk_fma_f32 v[154:155], v[162:163], v[8:9], v[154:155] op_sel:[0,1,0] op_sel_hi:[1,1,1]
    v_pk_fma_f32 v[156:157], v[164:165], v[8:9], v[156:157] op_sel:[0,1,0] op_sel_hi:[1,1,1]
    v_pk_fma_f32 v[158:159], v[166:167], v[8:9], v[158:159] op_sel:[0,1,0] op_sel_hi:[1,1,1]
L_AFIN:
    s_nop 1
    v_permlane32_swap_b32 v152, v156
    v_permlane32_swap_b32 v153, v157
    v_permlane32_swap_b32 v154, v158
    v_permlane32_swap_b32 v155, v159
    v_add_f32 v152, v152, v156
    v_add_f32 v153, v153, v157
    v_add_f32 v154, v154, v158
    v_add_f32 v155, v155, v159
    s_nop 0
    v_permlane16_swap_b32 v152, v154
    v_permlane16_swap_b32 v153, v155
    v_add_f32 v152, v152, v154
    v_add_f32 v153, v153, v155
    ds_write_b64 v2, v[152:153]
    s_waitcnt lgkmcnt(0)
    s_barrier
    s_endpgm
L_ASVC:
    v_and_b32 v1, 63, v0
    s_and_b32 s7, s5, 3
    s_lshl_b32 s6, s4, 2
    s_add_u32 s6, s6, s7
    s_mov_b32 s92, 0x05040100
    s_mov_b32 s93, 0x07060302
    s_cmp_lg_u32 s3, 11
    s_cbranch_scc1 Z_10
    v_lshlrev_b32 v2, 2, v1
    v_add_u32 v2, 0x24000, v2
    v_mov_b32 v3, 0
    ds_write_b32 v2, v3
Z_10:
    s_waitcnt lgkmcnt(0)
    s_mov_b32 s36, s34
    s_and_b32 s37, s35, 0xffff
    s_mov_b32 s38, 0x1000000
    s_mov_b32 s39, 0x20000
    s_mov_b32 s40, s32
    s_and_b32 s41, s33, 0xffff
    s_mov_b32 s42, 0x100
    s_mov_b32 s43, 0x20000
    s_setprio 3
    s_lshr_b32 s60, s5, 2
    s_sub_u32 s60, s60, 4
    s_barrier
    s_lshl_b32 s7, s6, 2
    s_add_u32 s7, s7, s60
    s_lshl_b32 s7, s7, 11
    v_lshl_add_u32 v3, v1, 4, s7
    v_add_u32 v5, 0x40000, v3
    v_add_u32 v3, 0x80000, v3
    s_lshl_b32 s7, s6, 5
    s_add_u32 s7, s7, s60
    s_lshl_b32 s7, s7, 8
    s_add_u32 s7, s7, 0x80000
    v_lshrrev_b32 v6, 4, v1
    v_lshlrev_b32 v6, 11, v6
    v_and_b32 v100, 15, v1
    v_lshl_add_u32 v6, v100, 4, v6
    v_add_u32 v6, s7, v6
    s_sleep 8
    v_mov_b32 v90, 0
    s_mov_b32 s80, 200000
    s_mov_b64 exec, 1
    buffer_load_dwordx2 v[94:95], v90, s[40:43], 0 offen sc1
    s_sleep 16
    buffer_load_dwordx2 v[92:93], v90, s[40:43], 0 offen sc1
    s_mov_b64 exec, -1
    s_waitcnt vmcnt(1)
    v_readfirstlane_b32 s94, v94
    v_readfirstlane_b32 s95, v95
    s_cmp_lg_u32 s95, 0
    s_cbranch_scc1 NGD_12
    s_branch NG2_13
NG_11:
    s_mov_b64 exec, 1
    buffer_load_dwordx2 v[92:93], v90, s[40:43], 0 offen sc1
    s_mov_b64 exec, -1
NG2_13:
    s_waitcnt vmcnt(0)
    v_readfirstlane_b32 s94, v92
    v_readfirstlane_b32 s95, v93
    s_cmp_lg_u32 s95, 0
    s_cbranch_scc1 NGD_12
    s_sleep 4
    s_sub_u32 s80, s80, 1
    s_cmp_lg_u32 s80, 0
    s_cbranch_scc1 NG_11
NGD_12:
    v_lshlrev_b32 v7, 5, v1
    v_mov_b32 v114, s94
    v_mov_b32 v115, s95
    v_mov_b32 v118, s94
    v_mov_b32 v119, s95
    v_mov_b32 v122, s94
    v_mov_b32 v123, s95
    v_mov_b32 v126, s94
    v_mov_b32 v127, s95
    v_mov_b32 v100, 0x24044
    s_mov_b32 s80, 1600000
LW_14:
    ds_read_b32 v101, v100
    s_waitcnt lgkmcnt(0)
    v_readfirstlane_b32 s79, v101
    s_cmp_ge_u32 s79, 4
    s_cbranch_scc1 LWD_15
    s_sub_u32 s80, s80, 1
    s_cmp_lg_u32 s80, 0
    s_cbranch_scc1 LW_14
LWD_15:
    ds_read_b128 v[16:19], v7 offset:0
    ds_read_b128 v[20:23], v7 offset:16
    ds_read_b128 v[24:27], v7 offset:2048
    ds_read_b128 v[28:31], v7 offset:2064
    ds_read_b128 v[32:35], v7 offset:4096
    ds_read_b128 v[36:39], v7 offset:4112
    ds_read_b128 v[40:43], v7 offset:6144
    ds_read_b128 v[44:47], v7 offset:6160
    s_waitcnt lgkmcnt(0)
    v_pk_add_f32 v[16:17], v[16:17], v[32:33]
    v_pk_add_f32 v[18:19], v[18:19], v[34:35]
    v_pk_add_f32 v[20:21], v[20:21], v[36:37]
    v_pk_add_f32 v[22:23], v[22:23], v[38:39]
    v_pk_add_f32 v[24:25], v[24:25], v[40:41]
    v_pk_add_f32 v[26:27], v[26:27], v[42:43]
    v_pk_add_f32 v[28:29], v[28:29], v[44:45]
    v_pk_add_f32 v[30:31], v[30:31], v[46:47]
    v_pk_add_f32 v[16:17], v[16:17], v[24:25]
    v_pk_add_f32 v[18:19], v[18:19], v[26:27]
    v_pk_add_f32 v[20:21], v[20:21], v[28:29]
    v_pk_add_f32 v[22:23], v[22:23], v[30:31]
    v_cvt_pk_bf16_f32 v112, v16, v17
    v_cvt_pk_bf16_f32 v113, v18, v19
    v_cvt_pk_bf16_f32 v116, v20, v21
    v_cvt_pk_bf16_f32 v117, v22, v23
    buffer_store_dwordx4 v[112:115], v5, s[36:39], 0 offen offset:0
    buffer_store_dwordx4 v[116:119], v5, s[36:39], 0 offen offset:1024
    v_mov_b32 v100, 0x24018
    v_mov_b32 v101, 1
    s_waitcnt lgkmcnt(0)
    s_mov_b64 exec, 1
    ds_add_u32 v100, v101
    s_mov_b64 exec, -1
    v_mov_b32 v100, 0x24040
    s_mov_b32 s80, 1600000
LW_16:
    ds_read_b32 v101, v100
    s_waitcnt lgkmcnt(0)
    v_readfirstlane_b32 s79, v101
    s_cmp_ge_u32 s79, 4
    s_cbranch_scc1 LWD_17
    s_sub_u32 s80, s80, 1
    s_cmp_lg_u32 s80, 0
    s_cbranch_scc1 LW_16
LWD_17:
    ds_read_b128 v[16:19], v7 offset:8192
    ds_read_b128 v[20:23], v7 offset:8208
    ds_read_b128 v[24:27], v7 offset:10240
    ds_read_b128 v[28:31], v7 offset:10256
    ds_read_b128 v[32:35], v7 offset:12288
    ds_read_b128 v[36:39], v7 offset:12304
    ds_read_b128 v[40:43], v7 offset:14336
    ds_read_b128 v[44:47], v7 offset:14352
    s_waitcnt lgkmcnt(0)
    v_pk_add_f32 v[16:17], v[16:17], v[32:33]
    v_pk_add_f32 v[18:19], v[18:19], v[34:35]
    v_pk_add_f32 v[20:21], v[20:21], v[36:37]
    v_pk_add_f32 v[22:23], v[22:23], v[38:39]
    v_pk_add_f32 v[24:25], v[24:25], v[40:41]
    v_pk_add_f32 v[26:27], v[26:27], v[42:43]
    v_pk_add_f32 v[28:29], v[28:29], v[44:45]
    v_pk_add_f32 v[30:31], v[30:31], v[46:47]
    v_pk_add_f32 v[16:17], v[16:17], v[24:25]
    v_pk_add_f32 v[18:19], v[18:19], v[26:27]
    v_pk_add_f32 v[20:21], v[20:21], v[28:29]
    v_pk_add_f32 v[22:23], v[22:23], v[30:31]
    v_cvt_pk_bf16_f32 v120, v16, v17
    v_cvt_pk_bf16_f32 v121, v18, v19
    v_cvt_pk_bf16_f32 v124, v20, v21
    v_cvt_pk_bf16_f32 v125, v22, v23
    buffer_store_dwordx4 v[120:123], v6, s[36:39], 0 offen offset:0
    buffer_store_dwordx4 v[124:127], v6, s[36:39], 0 offen offset:1024
    v_mov_b32 v100, 0x24018
    v_mov_b32 v101, 1
    s_waitcnt lgkmcnt(0)
    s_mov_b64 exec, 1
    ds_add_u32 v100, v101
    s_mov_b64 exec, -1
    v_mov_b32 v110, v5
    v_mov_b32 v111, v6
    s_getreg_b32 s96, hwreg(HW_REG_XCC_ID, 0, 4)
    s_lshl_b32 s7, s4, 5
    s_add_u32 s7, s7, s5
    s_lshl_b32 s7, s7, 4
    s_add_u32 s7, s7, 0xc0000
    v_mov_b32 v100, s7
    v_mov_b32 v102, s96
    v_mov_b32 v103, 0
    v_mov_b32 v104, s94
    v_mov_b32 v105, s95
    s_mov_b64 exec, 1
    buffer_store_dwordx4 v[102:105], v100, s[36:39], 0 offen
    s_mov_b64 exec, -1
    s_sleep 16
    buffer_load_dwordx4 v[32:35], v3, s[36:39], 0 offen offset:0 sc1
    buffer_load_dwordx4 v[36:39], v3, s[36:39], 0 offen offset:1024 sc1
    s_mov_b32 s80, 200000
PS_18:
    s_waitcnt vmcnt(0)
    s_mov_b32 s78, 0
    v_cmp_ne_u64 vcc, s[94:95], v[34:35]
    s_cbranch_vccz PSS_20
    buffer_load_dwordx4 v[32:35], v3, s[36:39], 0 offen offset:0 sc1
    s_mov_b32 s78, 1
PSS_20:
    v_cmp_ne_u64 vcc, s[94:95], v[38:39]
    s_cbranch_vccz PSS_21
    buffer_load_dwordx4 v[36:39], v3, s[36:39], 0 offen offset:1024 sc1
    s_mov_b32 s78, 1
PSS_21:
    s_cmp_eq_u32 s78, 0
    s_cbranch_scc1 PSD_19
    s_sleep 8
    s_cmp_lg_u32 s80, 199984
    s_cbranch_scc1 PSL_22
    buffer_store_dwordx4 v[112:115], v110, s[36:39], 0 offen offset:0 sc1
    buffer_store_dwordx4 v[116:119], v110, s[36:39], 0 offen offset:1024 sc1
    buffer_store_dwordx4 v[120:123], v111, s[36:39], 0 offen offset:0 sc1
    buffer_store_dwordx4 v[124:127], v111, s[36:39], 0 offen offset:1024 sc1
PSL_22:
    s_sub_u32 s80, s80, 1
    s_cmp_lg_u32 s80, 0
    s_cbranch_scc1 PS_18
    s_waitcnt vmcnt(0)
PSD_19:
    v_lshlrev_b32 v16, 16, v32
    v_and_b32 v17, 0xffff0000, v32
    v_lshlrev_b32 v18, 16, v33
    v_and_b32 v19, 0xffff0000, v33
    v_lshlrev_b32 v20, 16, v36
    v_and_b32 v21, 0xffff0000, v36
    v_lshlrev_b32 v22, 16, v37
    v_and_b32 v23, 0xffff0000, v37
    v_mov_b32 v24, v16
    v_mov_b32 v25, v17
    v_mov_b32 v26, v18
    v_mov_b32 v27, v19
    v_mov_b32 v28, v20
    v_mov_b32 v29, v21
    v_mov_b32 v30, v22
    v_mov_b32 v31, v23
    v_permlane32_swap_b32 v16, v24
    v_permlane32_swap_b32 v17, v25
    v_permlane32_swap_b32 v18, v26
    v_permlane32_swap_b32 v19, v27
    v_permlane32_swap_b32 v20, v28
    v_permlane32_swap_b32 v21, v29
    v_permlane32_swap_b32 v22, v30
    v_permlane32_swap_b32 v23, v31
    v_add_f32 v16, v16, v24
    v_add_f32 v17, v17, v25
    v_add_f32 v18, v18, v26
    v_add_f32 v19, v19, v27
    v_add_f32 v20, v20, v28
    v_add_f32 v21, v21, v29
    v_add_f32 v22, v22, v30
    v_add_f32 v23, v23, v31
    v_mov_b32 v24, v16
    v_mov_b32 v25, v17
    v_mov_b32 v26, v18
    v_mov_b32 v27, v19
    v_mov_b32 v28, v20
    v_mov_b32 v29, v21
    v_mov_b32 v30, v22
    v_mov_b32 v31, v23
    v_permlane16_swap_b32 v16, v24
    v_permlane16_swap_b32 v17, v25
    v_permlane16_swap_b32 v18, v26
    v_permlane16_swap_b32 v19, v27
    v_permlane16_swap_b32 v20, v28
    v_permlane16_swap_b32 v21, v29
    v_permlane16_swap_b32 v22, v30
    v_permlane16_swap_b32 v23, v31
    v_add_f32 v16, v16, v24
    v_add_f32 v17, v17, v25
    v_add_f32 v18, v18, v26
    v_add_f32 v19, v19, v27
    v_add_f32 v20, v20, v28
    v_add_f32 v21, v21, v29
    v_add_f32 v22, v22, v30
    v_add_f32 v23, v23, v31
    v_cvt_pk_bf16_f32 v8, v16, v17
    v_cvt_pk_bf16_f32 v9, v18, v19
    v_cvt_pk_bf16_f32 v10, v20, v21
    v_cvt_pk_bf16_f32 v11, v22, v23
    v_and_b32 v100, 15, v1
    v_lshlrev_b32 v100, 4, v100
    v_add_u32 v100, 0x24100, v100
    ds_write_b128 v100, v[8:11]
L_ACUT:
    v_mov_b32 v100, 0x24004
    v_mov_b32 v101, 1
    s_waitcnt lgkmcnt(0)
    s_mov_b64 exec, 1
    ds_add_u32 v100, v101
    s_mov_b64 exec, -1
    v_mov_b32 v100, 0x24008
    s_mov_b32 s80, 1600000
LW_23:
    ds_read_b32 v101, v100
    s_waitcnt lgkmcnt(0)
    v_readfirstlane_b32 s79, v101
    s_cmp_ge_u32 s79, 11
    s_cbranch_scc1 LWD_24
    s_sleep 8
    s_sub_u32 s80, s80, 1
    s_cmp_lg_u32 s80, 0
    s_cbranch_scc1 LW_23
LWD_24:
    v_and_b32 v100, 31, v1
    s_lshl_b32 s7, s4, 9
    s_add_u32 s7, s7, 0xc0000
    v_lshl_add_u32 v100, v100, 4, s7
    buffer_load_dwordx4 v[32:35], v100, s[36:39], 0 offen sc1
    s_waitcnt vmcnt(0)
    v_cmp_ne_u64 vcc, s[94:95], v[34:35]
    v_cmp_ne_u32 s[86:87], s96, v32
    s_or_b32 s97, vcc_lo, s86
    s_and_b32 s97, s97, 0xffff00ff
    s_cbranch_scc0 AF_25
    buffer_store_dwordx4 v[112:115], v110, s[36:39], 0 offen offset:0 sc1
    buffer_store_dwordx4 v[116:119], v110, s[36:39], 0 offen offset:1024 sc1
    buffer_store_dwordx4 v[120:123], v111, s[36:39], 0 offen offset:0 sc1
    buffer_store_dwordx4 v[124:127], v111, s[36:39], 0 offen offset:1024 sc1
AF_25:
    v_mov_b32 v100, 0x24200
    ds_read_b128 v[8:11], v100 offset:0
    ds_read_b128 v[12:15], v100 offset:16
    ds_read_b128 v[16:19], v100 offset:32
    ds_read_b128 v[20:23], v100 offset:48
    ds_read_b128 v[24:27], v100 offset:64
    ds_read_b128 v[28:31], v100 offset:80
    s_waitcnt lgkmcnt(0)
    v_max3_f32 v100, v8, v10, v12
    v_max3_f32 v100, v100, v14, v16
    v_max3_f32 v100, v100, v18, v20
    v_max3_f32 v100, v100, v22, v24
    v_max3_f32 v100, v100, v26, v28
    v_sub_f32 v8, v8, v100
    v_sub_f32 v10, v10, v100
    v_sub_f32 v12, v12, v100
    v_sub_f32 v14, v14, v100
    v_sub_f32 v16, v16, v100
    v_sub_f32 v18, v18, v100
    v_sub_f32 v20, v20, v100
    v_sub_f32 v22, v22, v100
    v_sub_f32 v24, v24, v100
    v_sub_f32 v26, v26, v100
    v_sub_f32 v28, v28, v100
    v_exp_f32 v8, v8
    v_exp_f32 v10, v10
    v_exp_f32 v12, v12
    v_exp_f32 v14, v14
    v_exp_f32 v16, v16
    v_exp_f32 v18, v18
    v_exp_f32 v20, v20
    v_exp_f32 v22, v22
    v_exp_f32 v24, v24
    v_exp_f32 v26, v26
    v_exp_f32 v28, v28
    v_mul_f32 v101, v8, v9
    v_fmac_f32 v101, v10, v11
    v_fmac_f32 v101, v12, v13
    v_fmac_f32 v101, v14, v15
    v_fmac_f32 v101, v16, v17
    v_fmac_f32 v101, v18, v19
    v_fmac_f32 v101, v20, v21
    v_fmac_f32 v101, v22, v23
    v_fmac_f32 v101, v24, v25
    v_fmac_f32 v101, v26, v27
    v_fmac_f32 v101, v28, v29
    v_rcp_f32 v101, v101
    s_nop 0
    v_mul_f32 v8, v8, v101
    v_mul_f32 v10, v10, v101
    v_mul_f32 v12, v12, v101
    v_mul_f32 v14, v14, v101
    v_mul_f32 v16, v16, v101
    v_mul_f32 v18, v18, v101
    v_mul_f32 v20, v20, v101
    v_mul_f32 v22, v22, v101
    v_mul_f32 v24, v24, v101
    v_mul_f32 v26, v26, v101
    v_mul_f32 v28, v28, v101
    v_and_b32 v100, 15, v1
    v_bfe_u32 v101, v1, 4, 1
    v_lshlrev_b32 v3, 5, v100
    v_lshl_add_u32 v3, v101, 4, v3
    v_add_u32 v3, 0x10000, v3
    s_lshl_b32 s7, s6, 3
    s_add_u32 s7, s7, s60
    s_lshl_b32 s7, s7, 8
    s_add_u32 s7, s7, 0xd0000
    v_lshlrev_b32 v2, 4, v100
    v_lshl_add_u32 v2, v101, 10, v2
    v_add_u32 v2, s7, v2
    v_mov_b32 v6, s94
    v_mov_b32 v7, s95
    s_barrier
    ds_read_b128 v[40:43], v3 offset:0
    ds_read_b128 v[44:47], v3 offset:512
    ds_read_b128 v[48:51], v3 offset:1024
    ds_read_b128 v[52:55], v3 offset:1536
    ds_read_b128 v[56:59], v3 offset:2048
    ds_read_b128 v[60:63], v3 offset:2560
    ds_read_b128 v[64:67], v3 offset:3072
    ds_read_b128 v[68:71], v3 offset:3584
    ds_read_b128 v[72:75], v3 offset:4096
    ds_read_b128 v[76:79], v3 offset:4608
    ds_read_b128 v[80:83], v3 offset:5120
    s_waitcnt lgkmcnt(10)
    v_pk_mul_f32 v[32:33], v[40:41], v[8:9] op_sel_hi:[1,0]
    v_pk_mul_f32 v[34:35], v[42:43], v[8:9] op_sel_hi:[1,0]
    s_waitcnt lgkmcnt(9)
    v_pk_mul_f32 v[36:37], v[44:45], v[10:11] op_sel_hi:[1,0]
    v_pk_mul_f32 v[38:39], v[46:47], v[10:11] op_sel_hi:[1,0]
    s_waitcnt lgkmcnt(8)
    v_pk_fma_f32 v[32:33], v[48:49], v[12:13], v[32:33] op_sel_hi:[1,0,1]
    v_pk_fma_f32 v[34:35], v[50:51], v[12:13], v[34:35] op_sel_hi:[1,0,1]
    s_waitcnt lgkmcnt(7)
    v_pk_fma_f32 v[36:37], v[52:53], v[14:15], v[36:37] op_sel_hi:[1,0,1]
    v_pk_fma_f32 v[38:39], v[54:55], v[14:15], v[38:39] op_sel_hi:[1,0,1]
    s_waitcnt lgkmcnt(6)
    v_pk_fma_f32 v[32:33], v[56:57], v[16:17], v[32:33] op_sel_hi:[1,0,1]
    v_pk_fma_f32 v[34:35], v[58:59], v[16:17], v[34:35] op_sel_hi:[1,0,1]
    s_waitcnt lgkmcnt(5)
    v_pk_fma_f32 v[36:37], v[60:61], v[18:19], v[36:37] op_sel_hi:[1,0,1]
    v_pk_fma_f32 v[38:39], v[62:63], v[18:19], v[38:39] op_sel_hi:[1,0,1]
    s_waitcnt lgkmcnt(4)
    v_pk_fma_f32 v[32:33], v[64:65], v[20:21], v[32:33] op_sel_hi:[1,0,1]
    v_pk_fma_f32 v[34:35], v[66:67], v[20:21], v[34:35] op_sel_hi:[1,0,1]
    s_waitcnt lgkmcnt(3)
    v_pk_fma_f32 v[36:37], v[68:69], v[22:23], v[36:37] op_sel_hi:[1,0,1]
    v_pk_fma_f32 v[38:39], v[70:71], v[22:23], v[38:39] op_sel_hi:[1,0,1]
    s_waitcnt lgkmcnt(2)
    v_pk_fma_f32 v[32:33], v[72:73], v[24:25], v[32:33] op_sel_hi:[1,0,1]
    v_pk_fma_f32 v[34:35], v[74:75], v[24:25], v[34:35] op_sel_hi:[1,0,1]
    s_waitcnt lgkmcnt(1)
    v_pk_fma_f32 v[36:37], v[76:77], v[26:27], v[36:37] op_sel_hi:[1,0,1]
    v_pk_fma_f32 v[38:39], v[78:79], v[26:27], v[38:39] op_sel_hi:[1,0,1]
    s_waitcnt lgkmcnt(0)
    v_pk_fma_f32 v[32:33], v[80:81], v[28:29], v[32:33] op_sel_hi:[1,0,1]
    v_pk_fma_f32 v[34:35], v[82:83], v[28:29], v[34:35] op_sel_hi:[1,0,1]
    v_pk_add_f32 v[32:33], v[32:33], v[36:37]
    v_pk_add_f32 v[34:35], v[34:35], v[38:39]
    v_cvt_pk_bf16_f32 v4, v32, v33
    v_cvt_pk_bf16_f32 v5, v34, v35
    s_mov_b64 exec, 0xffffffff
    buffer_store_dwordx4 v[4:7], v2, s[36:39], 0 offen
    s_cmp_eq_u32 s97, 0
    s_cbranch_scc1 AF_26
    buffer_store_dwordx4 v[4:7], v2, s[36:39], 0 offen sc1
AF_26:
    s_mov_b64 exec, -1
    s_endpgm
L_W:
    v_and_b32 v1, 63, v0
    s_and_b32 s7, s5, 3
    s_lshl_b32 s6, s4, 2
    s_add_u32 s6, s6, s7
    s_mov_b32 s92, 0x05040100
    s_mov_b32 s93, 0x07060302
    s_waitcnt lgkmcnt(0)
    s_mov_b32 s36, s34
    s_and_b32 s37, s35, 0xffff
    s_mov_b32 s38, 0x1000000
    s_mov_b32 s39, 0x20000
    s_mov_b32 s40, s32
    s_and_b32 s41, s33, 0xffff
    s_mov_b32 s42, 0x100
    s_mov_b32 s43, 0x20000
    s_barrier
    s_cmp_ge_u32 s5, 4
    s_cbranch_scc1 L_PF
    v_mov_b32 v160, 0x24048
    s_mov_b32 s80, 1600000
LW_27:
    ds_read_b32 v161, v160
    s_waitcnt lgkmcnt(0)
    v_readfirstlane_b32 s79, v161
    s_cmp_ge_u32 s79, 4
    s_cbranch_scc1 LWD_28
    s_sleep 4
    s_sub_u32 s80, s80, 1
    s_cmp_lg_u32 s80, 0
    s_cbranch_scc1 LW_27
LWD_28:
    s_branch L_U1
L_PF:
    s_mov_b32 s44, s20
    s_and_b32 s45, s21, 0xffff
    s_mov_b32 s46, 0x1000000
    s_mov_b32 s47, 0x20000
    s_lshl_b32 s7, s4, 2
    s_add_u32 s7, s7, s5
    s_sub_u32 s7, s7, 4
    s_lshl_b32 s7, s7, 19
    s_lshl_b32 s60, s3, 10
    s_add_u32 s60, s60, s7
    s_add_u32 s60, s60, 196608
    s_add_u32 s61, s60, 0x40000
    v_lshlrev_b32 v2, 4, v1
    v_mov_b32 v160, 0x24048
    s_mov_b32 s80, 1600000
LW_29:
    ds_read_b32 v161, v160
    s_waitcnt lgkmcnt(0)
    v_readfirstlane_b32 s79, v161
    s_cmp_ge_u32 s79, 4
    s_cbranch_scc1 LWD_30
    s_sleep 4
    s_sub_u32 s80, s80, 1
    s_cmp_lg_u32 s80, 0
    s_cbranch_scc1 LW_29
LWD_30:
    s_mov_b32 s62, 16
PF_31:
    s_waitcnt vmcnt(7)
    buffer_load_dwordx4 v[4:7], v2, s[44:47], s60 offen
    s_add_u32 s60, s60, 4096
    s_waitcnt vmcnt(7)
    buffer_load_dwordx4 v[4:7], v2, s[44:47], s61 offen
    s_add_u32 s61, s61, 4096
    s_sub_u32 s62, s62, 1
    s_cmp_lg_u32 s62, 0
    s_cbranch_scc1 PF_31
    v_mov_b32 v160, 0x2405c
    v_mov_b32 v161, 1
    s_waitcnt lgkmcnt(0)
    s_mov_b64 exec, 1
    ds_add_u32 v160, v161
    s_mov_b64 exec, -1
    s_waitcnt vmcnt(0)
    s_branch L_END
L_W1:
    v_and_b32 v1, 63, v0
    s_and_b32 s7, s5, 3
    s_lshl_b32 s6, s4, 2
    s_add_u32 s6, s6, s7
    s_mov_b32 s92, 0x05040100
    s_mov_b32 s93, 0x07060302
    s_waitcnt lgkmcnt(0)
    s_mov_b32 s36, s34
    s_and_b32 s37, s35, 0xffff
    s_mov_b32 s38, 0x1000000
    s_mov_b32 s39, 0x20000
    s_mov_b32 s40, s32
    s_and_b32 s41, s33, 0xffff
    s_mov_b32 s42, 0x100
    s_mov_b32 s43, 0x20000
    s_setprio 3
    s_cmp_lg_u32 s3, 4
    s_cbranch_scc1 W4_32
    s_cmp_lg_u32 s2, 0
    s_cbranch_scc1 NM_33
    s_memrealtime s[94:95]
    v_mov_b32 v160, 0
    s_waitcnt lgkmcnt(0)
    s_or_b32 s95, s95, 0x80000000
    v_mov_b32 v162, s94
    v_mov_b32 v163, s95
    s_mov_b64 exec, 1
    buffer_store_dwordx2 v[162:163], v160, s[40:43], 0 offen sc1
    s_mov_b64 exec, -1
NM_33:
W4_32:
    s_barrier
    s_cmp_lg_u32 s3, 4
    s_cbranch_scc1 W4_34
    s_sleep 8
    v_mov_b32 v152, 0
    s_mov_b32 s80, 200000
    s_mov_b64 exec, 1
    buffer_load_dwordx2 v[156:157], v152, s[40:43], 0 offen sc1
    s_sleep 16
    buffer_load_dwordx2 v[154:155], v152, s[40:43], 0 offen sc1
    s_mov_b64 exec, -1
    s_waitcnt vmcnt(1)
    v_readfirstlane_b32 s94, v156
    v_readfirstlane_b32 s95, v157
    s_cmp_lg_u32 s95, 0
    s_cbranch_scc1 NGD_36
    s_branch NG2_37
NG_35:
    s_mov_b64 exec, 1
    buffer_load_dwordx2 v[154:155], v152, s[40:43], 0 offen sc1
    s_mov_b64 exec, -1
NG2_37:
    s_waitcnt vmcnt(0)
    v_readfirstlane_b32 s94, v154
    v_readfirstlane_b32 s95, v155
    s_cmp_lg_u32 s95, 0
    s_cbranch_scc1 NGD_36
    s_sleep 4
    s_sub_u32 s80, s80, 1
    s_cmp_lg_u32 s80, 0
    s_cbranch_scc1 NG_35
NGD_36:
    v_mov_b32 v160, 0x24050
    v_mov_b32 v162, s94
    v_mov_b32 v163, s95
    ds_write_b64 v160, v[162:163]
    v_mov_b32 v160, 0x2404c
    v_mov_b32 v161, 1
    s_waitcnt lgkmcnt(0)
    s_mov_b64 exec, 1
    ds_add_u32 v160, v161
    s_mov_b64 exec, -1
    s_getreg_b32 s96, hwreg(HW_REG_XCC_ID, 0, 4)
    s_lshl_b32 s7, s4, 5
    s_add_u32 s7, s7, s5
    s_lshl_b32 s7, s7, 4
    s_add_u32 s7, s7, 0xc0000
    v_mov_b32 v160, s7
    v_mov_b32 v162, s96
    v_mov_b32 v163, 0
    v_mov_b32 v164, s94
    v_mov_b32 v165, s95
    s_mov_b64 exec, 1
    buffer_store_dwordx4 v[162:165], v160, s[36:39], 0 offen
    s_mov_b64 exec, -1
W4_34:
    s_sub_u32 s62, s3, 4
    s_lshl_b32 s61, s4, 2
    s_add_u32 s61, s61, s62
    v_lshrrev_b32 v162, 4, v1
    v_and_b32 v161, 15, v1
    v_lshlrev_b32 v2, 16, v162
    v_lshl_add_u32 v2, v161, 4, v2
    s_lshl_b32 s7, s61, 3
    s_add_u32 s7, s7, s5
    s_lshl_b32 s7, s7, 8
    s_add_u32 s7, s7, 0x0
    v_add_u32 v2, s7, v2
    v_lshlrev_b32 v3, 6, v161
    v_lshl_add_u32 v3, v162, 4, v3
    s_lshl_b32 s7, s61, 13
    s_add_u32 s7, s7, 0x40000
    v_add_u32 v3, s7, v3
    v_xor_b32 v5, v162, v161
    v_lshlrev_b32 v5, 4, v5
    v_lshl_add_u32 v4, v161, 12, v5
    s_lshl_b32 s7, s62, 8
    v_add_u32 v4, s7, v4
    v_mov_b32 v160, 0x2404c
    s_mov_b32 s80, 1600000
LW_38:
    ds_read_b32 v161, v160
    s_waitcnt lgkmcnt(0)
    v_readfirstlane_b32 s79, v161
    s_cmp_ge_u32 s79, 1
    s_cbranch_scc1 LWD_39
    s_sleep 2
    s_sub_u32 s80, s80, 1
    s_cmp_lg_u32 s80, 0
    s_cbranch_scc1 LW_38
LWD_39:
    v_mov_b32 v160, 0x24050
    ds_read_b64 v[162:163], v160
    s_waitcnt lgkmcnt(0)
    v_readfirstlane_b32 s94, v162
    v_readfirstlane_b32 s95, v163
    s_sleep 4
    s_mov_b32 s63, 4096
    buffer_load_dwordx4 v[72:75], v3, s[36:39], 0 offen offset:0 sc1
    buffer_load_dwordx4 v[76:79], v3, s[36:39], 0 offen offset:1024 sc1
    buffer_load_dwordx4 v[80:83], v3, s[36:39], 0 offen offset:2048 sc1
    buffer_load_dwordx4 v[84:87], v3, s[36:39], 0 offen offset:3072 sc1
    buffer_load_dwordx4 v[88:91], v3, s[36:39], s63 offen offset:0 sc1
    buffer_load_dwordx4 v[92:95], v3, s[36:39], s63 offen offset:1024 sc1
    buffer_load_dwordx4 v[96:99], v3, s[36:39], s63 offen offset:2048 sc1
    buffer_load_dwordx4 v[100:103], v3, s[36:39], s63 offen offset:3072 sc1
    v_mov_b32 v160, 0x24014
    s_mov_b32 s80, 1600000
LW_42:
    ds_read_b32 v161, v160
    s_waitcnt lgkmcnt(0)
    v_readfirstlane_b32 s79, v161
    s_cmp_ge_u32 s79, 4
    s_cbranch_scc1 LWD_43
    s_sleep 1
    s_sub_u32 s80, s80, 1
    s_cmp_lg_u32 s80, 0
    s_cbranch_scc1 LW_42
LWD_43:
    v_xor_b32 v160, 0x0, v4
    v_xor_b32 v161, 0x40, v4
    v_xor_b32 v162, 0x80, v4
    v_xor_b32 v163, 0xc0, v4
    ds_read_b128 v[8:11], v160 offset:0
    ds_read_b128 v[12:15], v161 offset:0
    ds_read_b128 v[16:19], v162 offset:0
    ds_read_b128 v[20:23], v163 offset:0
    ds_read_b128 v[24:27], v160 offset:1024
    ds_read_b128 v[28:31], v161 offset:1024
    ds_read_b128 v[32:35], v162 offset:1024
    ds_read_b128 v[36:39], v163 offset:1024
    ds_read_b128 v[40:43], v160 offset:2048
    ds_read_b128 v[44:47], v161 offset:2048
    ds_read_b128 v[48:51], v162 offset:2048
    ds_read_b128 v[52:55], v163 offset:2048
    ds_read_b128 v[56:59], v160 offset:3072
    ds_read_b128 v[60:63], v161 offset:3072
    ds_read_b128 v[64:67], v162 offset:3072
    ds_read_b128 v[68:71], v163 offset:3072
    s_mov_b32 s80, 200000
PS_40:
    s_waitcnt vmcnt(0)
    s_mov_b32 s78, 0
    v_cmp_ne_u64 vcc, s[94:95], v[74:75]
    s_cbranch_vccz PSS_44
    buffer_load_dwordx4 v[72:75], v3, s[36:39], 0 offen offset:0 sc1
    s_mov_b32 s78, 1
PSS_44:
    v_cmp_ne_u64 vcc, s[94:95], v[78:79]
    s_cbranch_vccz PSS_45
    buffer_load_dwordx4 v[76:79], v3, s[36:39], 0 offen offset:1024 sc1
    s_mov_b32 s78, 1
PSS_45:
    v_cmp_ne_u64 vcc, s[94:95], v[82:83]
    s_cbranch_vccz PSS_46
    buffer_load_dwordx4 v[80:83], v3, s[36:39], 0 offen offset:2048 sc1
    s_mov_b32 s78, 1
PSS_46:
    v_cmp_ne_u64 vcc, s[94:95], v[86:87]
    s_cbranch_vccz PSS_47
    buffer_load_dwordx4 v[84:87], v3, s[36:39], 0 offen offset:3072 sc1
    s_mov_b32 s78, 1
PSS_47:
    v_cmp_ne_u64 vcc, s[94:95], v[90:91]
    s_cbranch_vccz PSS_48
    buffer_load_dwordx4 v[88:91], v3, s[36:39], s63 offen offset:0 sc1
    s_mov_b32 s78, 1
PSS_48:
    v_cmp_ne_u64 vcc, s[94:95], v[94:95]
    s_cbranch_vccz PSS_49
    buffer_load_dwordx4 v[92:95], v3, s[36:39], s63 offen offset:1024 sc1
    s_mov_b32 s78, 1
PSS_49:
    v_cmp_ne_u64 vcc, s[94:95], v[98:99]
    s_cbranch_vccz PSS_50
    buffer_load_dwordx4 v[96:99], v3, s[36:39], s63 offen offset:2048 sc1
    s_mov_b32 s78, 1
PSS_50:
    v_cmp_ne_u64 vcc, s[94:95], v[102:103]
    s_cbranch_vccz PSS_51
    buffer_load_dwordx4 v[100:103], v3, s[36:39], s63 offen offset:3072 sc1
    s_mov_b32 s78, 1
PSS_51:
    s_cmp_eq_u32 s78, 0
    s_cbranch_scc1 PSD_41
    s_sub_u32 s80, s80, 1
    s_cmp_lg_u32 s80, 0
    s_cbranch_scc1 PS_40
    s_waitcnt vmcnt(0)
PSD_41:
    v_lshlrev_b32 v104, 16, v72
    v_and_b32 v105, 0xffff0000, v72
    v_lshlrev_b32 v106, 16, v73
    v_and_b32 v107, 0xffff0000, v73
    v_lshlrev_b32 v108, 16, v76
    v_and_b32 v109, 0xffff0000, v76
    v_lshlrev_b32 v110, 16, v77
    v_and_b32 v111, 0xffff0000, v77
    v_lshlrev_b32 v120, 16, v80
    v_and_b32 v121, 0xffff0000, v80
    v_lshlrev_b32 v122, 16, v81
    v_and_b32 v123, 0xffff0000, v81
    v_lshlrev_b32 v124, 16, v84
    v_and_b32 v125, 0xffff0000, v84
    v_lshlrev_b32 v126, 16, v85
    v_and_b32 v127, 0xffff0000, v85
    v_pk_add_f32 v[104:105], v[104:105], v[120:121]
    v_pk_add_f32 v[106:107], v[106:107], v[122:123]
    v_pk_add_f32 v[108:109], v[108:109], v[124:125]
    v_pk_add_f32 v[110:111], v[110:111], v[126:127]
    v_lshlrev_b32 v112, 16, v88
    v_and_b32 v113, 0xffff0000, v88
    v_lshlrev_b32 v114, 16, v89
    v_and_b32 v115, 0xffff0000, v89
    v_lshlrev_b32 v116, 16, v92
    v_and_b32 v117, 0xffff0000, v92
    v_lshlrev_b32 v118, 16, v93
    v_and_b32 v119, 0xffff0000, v93
    v_pk_add_f32 v[104:105], v[104:105], v[112:113]
    v_pk_add_f32 v[106:107], v[106:107], v[114:115]
    v_pk_add_f32 v[108:109], v[108:109], v[116:117]
    v_pk_add_f32 v[110:111], v[110:111], v[118:119]
    v_lshlrev_b32 v120, 16, v96
    v_and_b32 v121, 0xffff0000, v96
    v_lshlrev_b32 v122, 16, v97
    v_and_b32 v123, 0xffff0000, v97
    v_lshlrev_b32 v124, 16, v100
    v_and_b32 v125, 0xffff0000, v100
    v_lshlrev_b32 v126, 16, v101
    v_and_b32 v127, 0xffff0000, v101
    v_pk_add_f32 v[104:105], v[104:105], v[120:121]
    v_pk_add_f32 v[106:107], v[106:107], v[122:123]
    v_pk_add_f32 v[108:109], v[108:109], v[124:125]
    v_pk_add_f32 v[110:111], v[110:111], v[126:127]
    v_cvt_pk_bf16_f32 v136, v104, v105
    v_cvt_pk_bf16_f32 v137, v106, v107
    v_cvt_pk_bf16_f32 v138, v108, v109
    v_cvt_pk_bf16_f32 v139, v110, v111
    v_mov_b32_dpp v140, v136 quad_perm:[1,2,3,0] row_mask:0xf bank_mask:0xf
    v_mov_b32_dpp v141, v137 quad_perm:[1,2,3,0] row_mask:0xf bank_mask:0xf
    v_mov_b32_dpp v142, v138 quad_perm:[1,2,3,0] row_mask:0xf bank_mask:0xf
    v_mov_b32_dpp v143, v139 quad_perm:[1,2,3,0] row_mask:0xf bank_mask:0xf
    v_mov_b32_dpp v144, v136 quad_perm:[2,3,0,1] row_mask:0xf bank_mask:0xf
    v_mov_b32_dpp v145, v137 quad_perm:[2,3,0,1] row_mask:0xf bank_mask:0xf
    v_mov_b32_dpp v146, v138 quad_perm:[2,3,0,1] row_mask:0xf bank_mask:0xf
    v_mov_b32_dpp v147, v139 quad_perm:[2,3,0,1] row_mask:0xf bank_mask:0xf
    v_mov_b32_dpp v148, v136 quad_perm:[3,0,1,2] row_mask:0xf bank_mask:0xf
    v_mov_b32_dpp v149, v137 quad_perm:[3,0,1,2] row_mask:0xf bank_mask:0xf
    v_mov_b32_dpp v150, v138 quad_perm:[3,0,1,2] row_mask:0xf bank_mask:0xf
    v_mov_b32_dpp v151, v139 quad_perm:[3,0,1,2] row_mask:0xf bank_mask:0xf
    v_mov_b32 v74, s94
    v_mov_b32 v75, s95
    s_waitcnt lgkmcnt(0)
    v_mfma_f32_16x16x32_bf16 v[104:107], v[136:139], v[8:11], 0
    v_mfma_f32_16x16x32_bf16 v[108:111], v[136:139], v[28:31], 0
    v_mfma_f32_16x16x32_bf16 v[112:115], v[136:139], v[48:51], 0
    v_mfma_f32_16x16x32_bf16 v[116:119], v[136:139], v[68:71], 0
    v_mfma_f32_16x16x32_bf16 v[104:107], v[140:143], v[12:15], v[104:107]
    v_mfma_f32_16x16x32_bf16 v[108:111], v[140:143], v[32:35], v[108:111]
    v_mfma_f32_16x16x32_bf16 v[112:115], v[140:143], v[52:55], v[112:115]
    v_mfma_f32_16x16x32_bf16 v[116:119], v[140:143], v[56:59], v[116:119]
    v_mfma_f32_16x16x32_bf16 v[104:107], v[144:147], v[16:19], v[104:107]
    v_mfma_f32_16x16x32_bf16 v[108:111], v[144:147], v[36:39], v[108:111]
    v_mfma_f32_16x16x32_bf16 v[112:115], v[144:147], v[40:43], v[112:115]
    v_mfma_f32_16x16x32_bf16 v[116:119], v[144:147], v[60:63], v[116:119]
    v_mfma_f32_16x16x32_bf16 v[104:107], v[148:151], v[20:23], v[104:107]
    v_mfma_f32_16x16x32_bf16 v[108:111], v[148:151], v[24:27], v[108:111]
    v_mfma_f32_16x16x32_bf16 v[112:115], v[148:151], v[44:47], v[112:115]
    v_mfma_f32_16x16x32_bf16 v[116:119], v[148:151], v[64:67], v[116:119]
    s_nop 5
    v_cvt_pk_bf16_f32 v72, v104, v109
    s_nop 0
    v_cvt_pk_bf16_f32 v73, v114, v119
    buffer_store_dwordx4 v[72:75], v2, s[36:39], 0 offen sc1
    v_mov_b32 v160, 0x24048
    v_mov_b32 v161, 1
    s_waitcnt lgkmcnt(0)
    s_mov_b64 exec, 1
    ds_add_u32 v160, v161
    s_mov_b64 exec, -1
    s_setprio 0
    s_cmp_ge_u32 s5, 4
    s_cbranch_scc1 L_END
L_U1:
    s_mov_b32 s48, s26
    s_and_b32 s49, s27, 0xffff
    s_mov_b32 s50, 0x400000
    s_mov_b32 s51, 0x20000
    v_lshrrev_b32 v162, 4, v1
    v_lshlrev_b32 v2, 16, v162
    v_and_b32 v160, 15, v1
    v_lshl_add_u32 v2, v160, 4, v2
    s_lshl_b32 s7, s6, 8
    v_add_u32 v2, s7, v2
    s_lshl_b32 s70, s3, 19
    s_waitcnt vmcnt(2)
    buffer_load_dwordx4 v[8:11], v2, s[48:51], s70 offen nt
    s_add_u32 s70, s70, 8192
    s_waitcnt vmcnt(2)
    buffer_load_dwordx4 v[12:15], v2, s[48:51], s70 offen nt
    s_add_u32 s70, s70, 8192
    s_waitcnt vmcnt(2)
    buffer_load_dwordx4 v[16:19], v2, s[48:51], s70 offen nt
    s_add_u32 s70, s70, 8192
    s_waitcnt vmcnt(2)
    buffer_load_dwordx4 v[20:23], v2, s[48:51], s70 offen nt
    s_add_u32 s70, s70, 8192
    s_waitcnt vmcnt(2)
    buffer_load_dwordx4 v[24:27], v2, s[48:51], s70 offen nt
    s_add_u32 s70, s70, 8192
    s_waitcnt vmcnt(2)
    buffer_load_dwordx4 v[28:31], v2, s[48:51], s70 offen nt
    s_add_u32 s70, s70, 8192
    s_waitcnt vmcnt(2)
    buffer_load_dwordx4 v[32:35], v2, s[48:51], s70 offen nt
    s_add_u32 s70, s70, 8192
    s_waitcnt vmcnt(2)
    buffer_load_dwordx4 v[36:39], v2, s[48:51], s70 offen nt
    s_add_u32 s70, s70, 204800
    s_waitcnt vmcnt(2)
    buffer_load_dwordx4 v[104:107], v2, s[48:51], s70 offen nt
    s_add_u32 s70, s70, 8192
    s_waitcnt vmcnt(2)
    buffer_load_dwordx4 v[108:111], v2, s[48:51], s70 offen nt
    s_add_u32 s70, s70, 8192
    s_waitcnt vmcnt(2)
    buffer_load_dwordx4 v[112:115], v2, s[48:51], s70 offen nt
    s_add_u32 s70, s70, 8192
    s_waitcnt vmcnt(2)
    buffer_load_dwordx4 v[116:119], v2, s[48:51], s70 offen nt
    s_add_u32 s70, s70, 8192
    s_waitcnt vmcnt(2)
    buffer_load_dwordx4 v[120:123], v2, s[48:51], s70 offen nt
    s_add_u32 s70, s70, 8192
    s_waitcnt vmcnt(2)
    buffer_load_dwordx4 v[124:127], v2, s[48:51], s70 offen nt
    s_add_u32 s70, s70, 8192
    s_waitcnt vmcnt(2)
    buffer_load_dwordx4 v[128:131], v2, s[48:51], s70 offen nt
    s_add_u32 s70, s70, 8192
    s_waitcnt vmcnt(2)
    buffer_load_dwordx4 v[132:135], v2, s[48:51], s70 offen nt
    s_add_u32 s70, s70, 204800
    v_lshlrev_b32 v3, 4, v1
    v_add_u32 v3, 0x24800, v3
    v_lshrrev_b32 v4, 1, v160
    v_lshlrev_b32 v4, 18, v4
    v_lshl_add_u32 v4, v162, 4, v4
    v_and_b32 v163, 1, v1
    v_lshl_add_u32 v4, v163, 6, v4
    v_cmp_eq_u32 s[86:87], 1, v163
    s_lshl_b32 s7, s3, 5
    s_add_u32 s7, s7, s6
    s_lshl_b32 s7, s7, 7
    s_add_u32 s7, s7, 0x500000
    v_add_u32 v4, s7, v4
    s_lshl_b32 s7, s3, 11
    s_add_u32 s7, s7, 0x10000
    v_lshl_add_u32 v5, v1, 5, s7
    v_perm_b32 v40, v12, v8, s92
    v_perm_b32 v41, v20, v16, s92
    v_perm_b32 v42, v28, v24, s92
    v_perm_b32 v43, v36, v32, s92
    v_perm_b32 v44, v12, v8, s93
    v_perm_b32 v45, v20, v16, s93
    v_perm_b32 v46, v28, v24, s93
    v_perm_b32 v47, v36, v32, s93
    v_perm_b32 v48, v13, v9, s92
    v_perm_b32 v49, v21, v17, s92
    v_perm_b32 v50, v29, v25, s92
    v_perm_b32 v51, v37, v33, s92
    v_perm_b32 v52, v13, v9, s93
    v_perm_b32 v53, v21, v17, s93
    v_perm_b32 v54, v29, v25, s93
    v_perm_b32 v55, v37, v33, s93
    v_perm_b32 v56, v14, v10, s92
    v_perm_b32 v57, v22, v18, s92
    v_perm_b32 v58, v30, v26, s92
    v_perm_b32 v59, v38, v34, s92
    v_perm_b32 v60, v14, v10, s93
    v_perm_b32 v61, v22, v18, s93
    v_perm_b32 v62, v30, v26, s93
    v_perm_b32 v63, v38, v34, s93
    v_perm_b32 v64, v15, v11, s92
    v_perm_b32 v65, v23, v19, s92
    v_perm_b32 v66, v31, v27, s92
    v_perm_b32 v67, v39, v35, s92
    v_perm_b32 v68, v15, v11, s93
    v_perm_b32 v69, v23, v19, s93
    v_perm_b32 v70, v31, v27, s93
    v_perm_b32 v71, v39, v35, s93
    s_waitcnt vmcnt(0)
    v_perm_b32 v72, v108, v104, s92
    v_perm_b32 v73, v116, v112, s92
    v_perm_b32 v74, v124, v120, s92
    v_perm_b32 v75, v132, v128, s92
    v_perm_b32 v76, v108, v104, s93
    v_perm_b32 v77, v116, v112, s93
    v_perm_b32 v78, v124, v120, s93
    v_perm_b32 v79, v132, v128, s93
    v_perm_b32 v80, v109, v105, s92
    v_perm_b32 v81, v117, v113, s92
    v_perm_b32 v82, v125, v121, s92
    v_perm_b32 v83, v133, v129, s92
    v_perm_b32 v84, v109, v105, s93
    v_perm_b32 v85, v117, v113, s93
    v_perm_b32 v86, v125, v121, s93
    v_perm_b32 v87, v133, v129, s93
    v_perm_b32 v88, v110, v106, s92
    v_perm_b32 v89, v118, v114, s92
    v_perm_b32 v90, v126, v122, s92
    v_perm_b32 v91, v134, v130, s92
    v_perm_b32 v92, v110, v106, s93
    v_perm_b32 v93, v118, v114, s93
    v_perm_b32 v94, v126, v122, s93
    v_perm_b32 v95, v134, v130, s93
    v_perm_b32 v96, v111, v107, s92
    v_perm_b32 v97, v119, v115, s92
    v_perm_b32 v98, v127, v123, s92
    v_perm_b32 v99, v135, v131, s92
    v_perm_b32 v100, v111, v107, s93
    v_perm_b32 v101, v119, v115, s93
    v_perm_b32 v102, v127, v123, s93
    v_perm_b32 v103, v135, v131, s93
    v_mov_b32 v160, 0x2404c
    s_mov_b32 s80, 1600000
LW_52:
    ds_read_b32 v161, v160
    s_waitcnt lgkmcnt(0)
    v_readfirstlane_b32 s79, v161
    s_cmp_ge_u32 s79, 1
    s_cbranch_scc1 LWD_53
    s_sleep 2
    s_sub_u32 s80, s80, 1
    s_cmp_lg_u32 s80, 0
    s_cbranch_scc1 LW_52
LWD_53:
    v_mov_b32 v160, 0x24050
    ds_read_b64 v[162:163], v160
    s_waitcnt lgkmcnt(0)
    v_readfirstlane_b32 s94, v162
    v_readfirstlane_b32 s95, v163
    v_mov_b32 v160, 0x2401c
    s_mov_b32 s80, 1600000
LW_54:
    ds_read_b32 v161, v160
    s_waitcnt lgkmcnt(0)
    v_readfirstlane_b32 s79, v161
    s_cmp_ge_u32 s79, 1
    s_cbranch_scc1 LWD_55
    s_sleep 4
    s_sub_u32 s80, s80, 1
    s_cmp_lg_u32 s80, 0
    s_cbranch_scc1 LW_54
LWD_55:
    s_setprio 3
    s_mov_b64 s[88:89], 0
    s_mov_b32 s80, 1600000
UM_56:
    ds_read_b128 v[136:139], v3
    s_waitcnt lgkmcnt(0)
    v_cmp_ne_u64 vcc, s[94:95], v[138:139]
    s_or_b64 s[90:91], vcc, s[88:89]
    s_and_b32 s7, s90, 0x5555
    s_cbranch_scc1 UMS_58
    s_mov_b32 s70, 0
    buffer_load_dwordx4 v[8:11], v4, s[36:39], s70 offen sc1
    s_or_b32 s88, s88, 0x5555
UMS_58:
    s_and_b32 s7, s90, 0x55550000
    s_cbranch_scc1 UMS_59
    s_mov_b32 s70, 32768
    buffer_load_dwordx4 v[12:15], v4, s[36:39], s70 offen sc1
    s_or_b32 s88, s88, 0x55550000
UMS_59:
    s_and_b32 s7, s91, 0x5555
    s_cbranch_scc1 UMS_60
    s_mov_b32 s70, 65536
    buffer_load_dwordx4 v[16:19], v4, s[36:39], s70 offen sc1
    s_or_b32 s89, s89, 0x5555
UMS_60:
    s_and_b32 s7, s91, 0x55550000
    s_cbranch_scc1 UMS_61
    s_mov_b32 s70, 98304
    buffer_load_dwordx4 v[20:23], v4, s[36:39], s70 offen sc1
    s_or_b32 s89, s89, 0x55550000
UMS_61:
    s_and_b32 s7, s90, 0xaaaa
    s_cbranch_scc1 UMS_62
    s_mov_b32 s70, 131072
    buffer_load_dwordx4 v[24:27], v4, s[36:39], s70 offen sc1
    s_or_b32 s88, s88, 0xaaaa
UMS_62:
    s_and_b32 s7, s90, 0xaaaa0000
    s_cbranch_scc1 UMS_63
    s_mov_b32 s70, 163840
    buffer_load_dwordx4 v[28:31], v4, s[36:39], s70 offen sc1
    s_or_b32 s88, s88, 0xaaaa0000
UMS_63:
    s_and_b32 s7, s91, 0xaaaa
    s_cbranch_scc1 UMS_64
    s_mov_b32 s70, 196608
    buffer_load_dwordx4 v[32:35], v4, s[36:39], s70 offen sc1
    s_or_b32 s89, s89, 0xaaaa
UMS_64:
    s_and_b32 s7, s91, 0xaaaa0000
    s_cbranch_scc1 UMS_65
    s_mov_b32 s70, 229376
    buffer_load_dwordx4 v[36:39], v4, s[36:39], s70 offen sc1
    s_or_b32 s89, s89, 0xaaaa0000
UMS_65:
    s_cbranch_vccz UMD_57
    s_sleep 1
    s_sub_u32 s80, s80, 1
    s_cmp_lg_u32 s80, 0
    s_cbranch_scc1 UM_56
UMD_57:
    v_max_f32_dpp v138, v136, v136 quad_perm:[1,0,3,2] row_mask:0xf bank_mask:0xf
    s_nop 1
    v_max_f32_dpp v138, v138, v138 quad_perm:[2,3,0,1] row_mask:0xf bank_mask:0xf
    v_mov_b32 v139, v138
    s_nop 1
    v_permlane32_swap_b32 v138, v139
    v_max_f32 v138, v138, v139
    v_mov_b32 v139, v138
    s_nop 1
    v_permlane16_swap_b32 v138, v139
    v_max_f32 v138, v138, v139
    v_sub_f32 v136, v136, v138
    v_exp_f32 v136, v136
    s_nop 0
    v_mul_f32 v137, v137, v136
    s_nop 1
    v_add_f32_dpp v137, v137, v137 quad_perm:[1,0,3,2] row_mask:0xf bank_mask:0xf
    s_nop 1
    v_add_f32_dpp v137, v137, v137 quad_perm:[2,3,0,1] row_mask:0xf bank_mask:0xf
    v_mov_b32 v138, v137
    s_nop 1
    v_permlane32_swap_b32 v137, v138
    v_add_f32 v137, v137, v138
    v_mov_b32 v138, v137
    s_nop 1
    v_permlane16_swap_b32 v137, v138
    v_add_f32 v137, v137, v138
    v_rcp_f32 v137, v137
    s_nop 0
    v_mul_f32 v136, v136, v137
    v_mov_b32 v137, v136
    s_nop 1
    v_permlane16_swap_b32 v136, v137
    v_mov_b32 v138, v136
    v_mov_b32 v139, v137
    s_nop 0
    v_permlane32_swap_b32 v136, v138
    v_permlane32_swap_b32 v137, v139
    s_nop 0
    v_mov_b32_dpp v148, v136 quad_perm:[0,0,2,2] row_mask:0xf bank_mask:0xf
    v_mov_b32_dpp v149, v137 quad_perm:[0,0,2,2] row_mask:0xf bank_mask:0xf
    v_mov_b32_dpp v150, v138 quad_perm:[0,0,2,2] row_mask:0xf bank_mask:0xf
    v_mov_b32_dpp v151, v139 quad_perm:[0,0,2,2] row_mask:0xf bank_mask:0xf
    v_mov_b32_dpp v152, v136 quad_perm:[1,1,3,3] row_mask:0xf bank_mask:0xf
    v_mov_b32_dpp v153, v137 quad_perm:[1,1,3,3] row_mask:0xf bank_mask:0xf
    v_mov_b32_dpp v154, v138 quad_perm:[1,1,3,3] row_mask:0xf bank_mask:0xf
    v_mov_b32_dpp v155, v139 quad_perm:[1,1,3,3] row_mask:0xf bank_mask:0xf
    s_waitcnt vmcnt(0)
    v_lshlrev_b32 v104, 16, v8
    v_and_b32 v105, 0xffff0000, v8
    v_lshlrev_b32 v106, 16, v9
    v_and_b32 v107, 0xffff0000, v9
    v_lshlrev_b32 v108, 16, v10
    v_and_b32 v109, 0xffff0000, v10
    v_lshlrev_b32 v110, 16, v11
    v_and_b32 v111, 0xffff0000, v11
    v_pk_mul_f32 v[120:121], v[104:105], v[148:149] op_sel_hi:[1,0]
    v_pk_mul_f32 v[122:123], v[106:107], v[148:149] op_sel_hi:[1,0]
    v_pk_mul_f32 v[124:125], v[108:109], v[148:149] op_sel_hi:[1,0]
    v_pk_mul_f32 v[126:127], v[110:111], v[148:149] op_sel_hi:[1,0]
    v_lshlrev_b32 v112, 16, v12
    v_and_b32 v113, 0xffff0000, v12
    v_lshlrev_b32 v114, 16, v13
    v_and_b32 v115, 0xffff0000, v13
    v_lshlrev_b32 v116, 16, v14
    v_and_b32 v117, 0xffff0000, v14
    v_lshlrev_b32 v118, 16, v15
    v_and_b32 v119, 0xffff0000, v15
    v_pk_mul_f32 v[128:129], v[112:113], v[148:149] op_sel:[0,1] op_sel_hi:[1,1]
    v_pk_mul_f32 v[130:131], v[114:115], v[148:149] op_sel:[0,1] op_sel_hi:[1,1]
    v_pk_mul_f32 v[132:133], v[116:117], v[148:149] op_sel:[0,1] op_sel_hi:[1,1]
    v_pk_mul_f32 v[134:135], v[118:119], v[148:149] op_sel:[0,1] op_sel_hi:[1,1]
    v_lshlrev_b32 v104, 16, v16
    v_and_b32 v105, 0xffff0000, v16
    v_lshlrev_b32 v106, 16, v17
    v_and_b32 v107, 0xffff0000, v17
    v_lshlrev_b32 v108, 16, v18
    v_and_b32 v109, 0xffff0000, v18
    v_lshlrev_b32 v110, 16, v19
    v_and_b32 v111, 0xffff0000, v19
    v_pk_fma_f32 v[120:121], v[104:105], v[150:151], v[120:121] op_sel_hi:[1,0,1]
    v_pk_fma_f32 v[122:123], v[106:107], v[150:151], v[122:123] op_sel_hi:[1,0,1]
    v_pk_fma_f32 v[124:125], v[108:109], v[150:151], v[124:125] op_sel_hi:[1,0,1]
    v_pk_fma_f32 v[126:127], v[110:111], v[150:151], v[126:127] op_sel_hi:[1,0,1]
    v_lshlrev_b32 v112, 16, v20
    v_and_b32 v113, 0xffff0000, v20
    v_lshlrev_b32 v114, 16, v21
    v_and_b32 v115, 0xffff0000, v21
    v_lshlrev_b32 v116, 16, v22
    v_and_b32 v117, 0xffff0000, v22
    v_lshlrev_b32 v118, 16, v23
    v_and_b32 v119, 0xffff0000, v23
    v_pk_fma_f32 v[128:129], v[112:113], v[150:151], v[128:129] op_sel:[0,1,0] op_sel_hi:[1,1,1]
    v_pk_fma_f32 v[130:131], v[114:115], v[150:151], v[130:131] op_sel:[0,1,0] op_sel_hi:[1,1,1]
    v_pk_fma_f32 v[132:133], v[116:117], v[150:151], v[132:133] op_sel:[0,1,0] op_sel_hi:[1,1,1]
    v_pk_fma_f32 v[134:135], v[118:119], v[150:151], v[134:135] op_sel:[0,1,0] op_sel_hi:[1,1,1]
    v_lshlrev_b32 v104, 16, v24
    v_and_b32 v105, 0xffff0000, v24
    v_lshlrev_b32 v106, 16, v25
    v_and_b32 v107, 0xffff0000, v25
    v_lshlrev_b32 v108, 16, v26
    v_and_b32 v109, 0xffff0000, v26
    v_lshlrev_b32 v110, 16, v27
    v_and_b32 v111, 0xffff0000, v27
    v_pk_fma_f32 v[120:121], v[104:105], v[152:153], v[120:121] op_sel_hi:[1,0,1]
    v_pk_fma_f32 v[122:123], v[106:107], v[152:153], v[122:123] op_sel_hi:[1,0,1]
    v_pk_fma_f32 v[124:125], v[108:109], v[152:153], v[124:125] op_sel_hi:[1,0,1]
    v_pk_fma_f32 v[126:127], v[110:111], v[152:153], v[126:127] op_sel_hi:[1,0,1]
    v_lshlrev_b32 v112, 16, v28
    v_and_b32 v113, 0xffff0000, v28
    v_lshlrev_b32 v114, 16, v29
    v_and_b32 v115, 0xffff0000, v29
    v_lshlrev_b32 v116, 16, v30
    v_and_b32 v117, 0xffff0000, v30
    v_lshlrev_b32 v118, 16, v31
    v_and_b32 v119, 0xffff0000, v31
    v_pk_fma_f32 v[128:129], v[112:113], v[152:153], v[128:129] op_sel:[0,1,0] op_sel_hi:[1,1,1]
    v_pk_fma_f32 v[130:131], v[114:115], v[152:153], v[130:131] op_sel:[0,1,0] op_sel_hi:[1,1,1]
    v_pk_fma_f32 v[132:133], v[116:117], v[152:153], v[132:133] op_sel:[0,1,0] op_sel_hi:[1,1,1]
    v_pk_fma_f32 v[134:135], v[118:119], v[152:153], v[134:135] op_sel:[0,1,0] op_sel_hi:[1,1,1]
    v_lshlrev_b32 v104, 16, v32
    v_and_b32 v105, 0xffff0000, v32
    v_lshlrev_b32 v106, 16, v33
    v_and_b32 v107, 0xffff0000, v33
    v_lshlrev_b32 v108, 16, v34
    v_and_b32 v109, 0xffff0000, v34
    v_lshlrev_b32 v110, 16, v35
    v_and_b32 v111, 0xffff0000, v35
    v_pk_fma_f32 v[120:121], v[104:105], v[154:155], v[120:121] op_sel_hi:[1,0,1]
    v_pk_fma_f32 v[122:123], v[106:107], v[154:155], v[122:123] op_sel_hi:[1,0,1]
    v_pk_fma_f32 v[124:125], v[108:109], v[154:155], v[124:125] op_sel_hi:[1,0,1]
    v_pk_fma_f32 v[126:127], v[110:111], v[154:155], v[126:127] op_sel_hi:[1,0,1]
    v_lshlrev_b32 v112, 16, v36
    v_and_b32 v113, 0xffff0000, v36
    v_lshlrev_b32 v114, 16, v37
    v_and_b32 v115, 0xffff0000, v37
    v_lshlrev_b32 v116, 16, v38
    v_and_b32 v117, 0xffff0000, v38
    v_lshlrev_b32 v118, 16, v39
    v_and_b32 v119, 0xffff0000, v39
    v_pk_fma_f32 v[128:129], v[112:113], v[154:155], v[128:129] op_sel:[0,1,0] op_sel_hi:[1,1,1]
    v_pk_fma_f32 v[130:131], v[114:115], v[154:155], v[130:131] op_sel:[0,1,0] op_sel_hi:[1,1,1]
    v_pk_fma_f32 v[132:133], v[116:117], v[154:155], v[132:133] op_sel:[0,1,0] op_sel_hi:[1,1,1]
    v_pk_fma_f32 v[134:135], v[118:119], v[154:155], v[134:135] op_sel:[0,1,0] op_sel_hi:[1,1,1]
    v_pk_add_f32 v[120:121], v[120:121], v[128:129]
    v_pk_add_f32 v[122:123], v[122:123], v[130:131]
    v_pk_add_f32 v[124:125], v[124:125], v[132:133]
    v_pk_add_f32 v[126:127], v[126:127], v[134:135]
    v_cvt_pk_bf16_f32 v128, v120, v121
    v_cvt_pk_bf16_f32 v129, v122, v123
    v_cvt_pk_bf16_f32 v130, v124, v125
    v_cvt_pk_bf16_f32 v131, v126, v127
    v_cndmask_b32 v140, v128, 0, s[86:87]
    v_cndmask_b32 v144, 0, v128, s[86:87]
    v_cndmask_b32 v141, v129, 0, s[86:87]
    v_cndmask_b32 v145, 0, v129, s[86:87]
    v_cndmask_b32 v142, v130, 0, s[86:87]
    v_cndmask_b32 v146, 0, v130, s[86:87]
    v_cndmask_b32 v143, v131, 0, s[86:87]
    v_cndmask_b32 v147, 0, v131, s[86:87]
    s_nop 0
    v_mfma_f32_16x16x32_bf16 v[8:11], v[140:143], v[40:43], 0
    v_mfma_f32_16x16x32_bf16 v[12:15], v[140:143], v[44:47], 0
    v_mfma_f32_16x16x32_bf16 v[16:19], v[140:143], v[48:51], 0
    v_mfma_f32_16x16x32_bf16 v[20:23], v[140:143], v[52:55], 0
    v_mfma_f32_16x16x32_bf16 v[24:27], v[140:143], v[56:59], 0
    v_mfma_f32_16x16x32_bf16 v[28:31], v[140:143], v[60:63], 0
    v_mfma_f32_16x16x32_bf16 v[32:35], v[140:143], v[64:67], 0
    v_mfma_f32_16x16x32_bf16 v[36:39], v[140:143], v[68:71], 0
    v_mfma_f32_16x16x32_bf16 v[8:11], v[144:147], v[72:75], v[8:11]
    v_mfma_f32_16x16x32_bf16 v[12:15], v[144:147], v[76:79], v[12:15]
    v_mfma_f32_16x16x32_bf16 v[16:19], v[144:147], v[80:83], v[16:19]
    v_mfma_f32_16x16x32_bf16 v[20:23], v[144:147], v[84:87], v[20:23]
    v_mfma_f32_16x16x32_bf16 v[24:27], v[144:147], v[88:91], v[24:27]
    v_mfma_f32_16x16x32_bf16 v[28:31], v[144:147], v[92:95], v[28:31]
    v_mfma_f32_16x16x32_bf16 v[32:35], v[144:147], v[96:99], v[32:35]
    v_mfma_f32_16x16x32_bf16 v[36:39], v[144:147], v[100:103], v[36:39]
    s_nop 0
    v_pk_add_f32 v[8:9], v[8:9], v[10:11]
    v_pk_add_f32 v[12:13], v[12:13], v[14:15]
    v_pk_add_f32 v[16:17], v[16:17], v[18:19]
    v_pk_add_f32 v[20:21], v[20:21], v[22:23]
    v_pk_add_f32 v[24:25], v[24:25], v[26:27]
    v_pk_add_f32 v[28:29], v[28:29], v[30:31]
    v_pk_add_f32 v[32:33], v[32:33], v[34:35]
    v_pk_add_f32 v[36:37], v[36:37], v[38:39]
    v_add_f32 v104, v8, v9
    v_add_f32 v105, v12, v13
    v_add_f32 v106, v16, v17
    v_add_f32 v107, v20, v21
    v_add_f32 v108, v24, v25
    v_add_f32 v109, v28, v29
    v_add_f32 v110, v32, v33
    v_add_f32 v111, v36, v37
    ds_write_b128 v5, v[104:107]
    ds_write_b128 v5, v[108:111] offset:16
    v_and_b32 v160, 31, v1
    s_lshl_b32 s7, s3, 8
    s_add_u32 s7, s7, 0x10000
    v_lshl_add_u32 v5, v160, 3, s7
    s_lshl_b32 s7, s3, 7
    s_add_u32 s7, s7, 0x24400
    v_lshl_add_u32 v4, v160, 2, s7
    s_waitcnt lgkmcnt(0)
    s_barrier
    ds_read_b64 v[8:9], v5 offset:0
    ds_read_b64 v[10:11], v5 offset:2048
    ds_read_b64 v[12:13], v5 offset:4096
    ds_read_b64 v[14:15], v5 offset:6144
    ds_read_b64 v[16:17], v5 offset:8192
    ds_read_b64 v[18:19], v5 offset:10240
    ds_read_b64 v[20:21], v5 offset:12288
    ds_read_b64 v[22:23], v5 offset:14336
    s_waitcnt lgkmcnt(0)
    v_pk_add_f32 v[8:9], v[8:9], v[16:17]
    v_pk_add_f32 v[10:11], v[10:11], v[18:19]
    v_pk_add_f32 v[12:13], v[12:13], v[20:21]
    v_pk_add_f32 v[14:15], v[14:15], v[22:23]
    v_pk_add_f32 v[8:9], v[8:9], v[12:13]
    v_pk_add_f32 v[10:11], v[10:11], v[14:15]
    v_pk_add_f32 v[8:9], v[8:9], v[10:11]
    v_cvt_pk_bf16_f32 v8, v8, v9
    ds_write_b32 v4, v8
    s_waitcnt lgkmcnt(0)
    s_barrier
    s_endpgm
L_W2:
    v_and_b32 v1, 63, v0
    s_and_b32 s7, s5, 3
    s_lshl_b32 s6, s4, 2
    s_add_u32 s6, s6, s7
    s_mov_b32 s92, 0x05040100
    s_mov_b32 s93, 0x07060302
    s_cmp_lg_u32 s3, 11
    s_cbranch_scc1 Z_66
    v_lshlrev_b32 v2, 2, v1
    v_add_u32 v2, 0x24000, v2
    v_mov_b32 v3, 0
    ds_write_b32 v2, v3
Z_66:
    s_sub_u32 s62, s3, 8
    s_lshl_b32 s7, s5, 2
    s_add_u32 s7, s7, s62
    s_lshl_b32 s7, s7, 17
    s_lshl_b32 s70, s4, 10
    s_add_u32 s70, s70, s7
    s_lshl_b32 s71, s62, 14
    v_lshlrev_b32 v2, 4, v1
    s_lshl_b32 s7, s62, 6
    v_xor_b32 v4, s7, v2
    v_xor_b32 v5, 16, v4
    v_xor_b32 v6, 32, v4
    v_xor_b32 v7, 48, v4
    s_waitcnt lgkmcnt(0)
    s_mov_b32 s52, s24
    s_and_b32 s53, s25, 0xffff
    s_mov_b32 s54, 0x400000
    s_mov_b32 s55, 0x20000
    s_mov_b32 m0, s71
    s_nop 0
    buffer_load_dwordx4 v4, s[52:55], s70 offen nt lds
    s_add_u32 s70, s70, 8192
    s_add_u32 s71, s71, 1024
    s_mov_b32 m0, s71
    s_nop 0
    buffer_load_dwordx4 v4, s[52:55], s70 offen nt lds
    s_add_u32 s70, s70, 8192
    s_add_u32 s71, s71, 1024
    s_mov_b32 m0, s71
    s_nop 0
    buffer_load_dwordx4 v4, s[52:55], s70 offen nt lds
    s_add_u32 s70, s70, 8192
    s_add_u32 s71, s71, 1024
    s_mov_b32 m0, s71
    s_nop 0
    buffer_load_dwordx4 v4, s[52:55], s70 offen nt lds
    s_add_u32 s70, s70, 8192
    s_add_u32 s71, s71, 1024
    s_mov_b32 m0, s71
    s_nop 0
    buffer_load_dwordx4 v5, s[52:55], s70 offen nt lds
    s_add_u32 s70, s70, 8192
    s_add_u32 s71, s71, 1024
    s_mov_b32 m0, s71
    s_nop 0
    buffer_load_dwordx4 v5, s[52:55], s70 offen nt lds
    s_add_u32 s70, s70, 8192
    s_add_u32 s71, s71, 1024
    s_mov_b32 m0, s71
    s_nop 0
    buffer_load_dwordx4 v5, s[52:55], s70 offen nt lds
    s_add_u32 s70, s70, 8192
    s_add_u32 s71, s71, 1024
    s_mov_b32 m0, s71
    s_nop 0
    buffer_load_dwordx4 v5, s[52:55], s70 offen nt lds
    s_add_u32 s70, s70, 8192
    s_add_u32 s71, s71, 1024
    s_mov_b32 s36, s34
    s_and_b32 s37, s35, 0xffff
    s_mov_b32 s38, 0x1000000
    s_mov_b32 s39, 0x20000
    s_mov_b32 s40, s32
    s_and_b32 s41, s33, 0xffff
    s_mov_b32 s42, 0x100
    s_mov_b32 s43, 0x20000
    s_barrier
    s_mov_b32 m0, s71
    s_waitcnt vmcnt(7)
    buffer_load_dwordx4 v6, s[52:55], s70 offen nt lds
    s_add_u32 s70, s70, 8192
    s_add_u32 s71, s71, 1024
    s_mov_b32 m0, s71
    s_waitcnt vmcnt(7)
    buffer_load_dwordx4 v6, s[52:55], s70 offen nt lds
    s_add_u32 s70, s70, 8192
    s_add_u32 s71, s71, 1024
    s_mov_b32 m0, s71
    s_waitcnt vmcnt(7)
    buffer_load_dwordx4 v6, s[52:55], s70 offen nt lds
    s_add_u32 s70, s70, 8192
    s_add_u32 s71, s71, 1024
    s_mov_b32 m0, s71
    s_waitcnt vmcnt(7)
    buffer_load_dwordx4 v6, s[52:55], s70 offen nt lds
    s_add_u32 s70, s70, 8192
    s_add_u32 s71, s71, 1024
    s_mov_b32 m0, s71
    s_waitcnt vmcnt(7)
    buffer_load_dwordx4 v7, s[52:55], s70 offen nt lds
    s_add_u32 s70, s70, 8192
    s_add_u32 s71, s71, 1024
    s_mov_b32 m0, s71
    s_waitcnt vmcnt(7)
    buffer_load_dwordx4 v7, s[52:55], s70 offen nt lds
    s_add_u32 s70, s70, 8192
    s_add_u32 s71, s71, 1024
    s_mov_b32 m0, s71
    s_waitcnt vmcnt(7)
    buffer_load_dwordx4 v7, s[52:55], s70 offen nt lds
    s_add_u32 s70, s70, 8192
    s_add_u32 s71, s71, 1024
    s_mov_b32 m0, s71
    s_waitcnt vmcnt(7)
    buffer_load_dwordx4 v7, s[52:55], s70 offen nt lds
    s_add_u32 s70, s70, 8192
    s_add_u32 s71, s71, 1024
    s_cmp_lt_u32 s5, 4
    s_cselect_b32 s72, s28, s16
    s_cselect_b32 s73, s29, s17
    s_mov_b32 s56, s72
    s_and_b32 s57, s73, 0xffff
    s_mov_b32 s58, 0x400000
    s_mov_b32 s59, 0x20000
    v_lshrrev_b32 v4, 4, v1
    v_lshlrev_b32 v2, 13, v4
    v_and_b32 v4, 15, v1
    v_lshl_add_u32 v2, v4, 4, v2
    s_lshl_b32 s7, s6, 17
    s_lshl_b32 s70, s62, 8
    s_add_u32 s7, s7, s70
    v_add_u32 v2, s7, v2
    v_lshrrev_b32 v3, 4, v1
    v_lshlrev_b32 v3, 16, v3
    v_bfe_u32 v4, v1, 3, 1
    v_lshl_add_u32 v3, v4, 13, v3
    v_and_b32 v4, 7, v1
    v_lshl_add_u32 v3, v4, 4, v3
    s_cmp_lt_u32 s5, 4
    s_cselect_b32 s7, 0x800, 0x0
    s_add_u32 s7, s7, s6
    s_lshl_b32 s7, s7, 7
    s_add_u32 s7, s7, 0x100000
    v_add_u32 v3, s7, v3
    s_lshl_b32 s7, s62, 14
    v_add_u32 v3, s7, v3
    s_waitcnt vmcnt(0)
    v_mov_b32 v4, 0x24014
    v_mov_b32 v5, 1
    s_waitcnt lgkmcnt(0)
    s_mov_b64 exec, 1
    ds_add_u32 v4, v5
    s_mov_b64 exec, -1
    s_mov_b32 s70, 0
    v_mov_b32 v4, 0x24048
    s_mov_b32 s80, 1600000
LW_69:
    ds_read_b32 v5, v4
    s_waitcnt lgkmcnt(0)
    v_readfirstlane_b32 s79, v5
    s_cmp_ge_u32 s79, 4
    s_cbranch_scc1 LWD_70
    s_sleep 4
    s_sub_u32 s80, s80, 1
    s_cmp_lg_u32 s80, 0
    s_cbranch_scc1 LW_69
LWD_70:
    s_cmp_lt_u32 s5, 4
    s_cbranch_scc1 S2U_67
    v_mov_b32 v4, 0x2405c
    s_mov_b32 s80, 1600000
LW_71:
    ds_read_b32 v5, v4
    s_waitcnt lgkmcnt(0)
    v_readfirstlane_b32 s79, v5
    s_cmp_ge_u32 s79, 4
    s_cbranch_scc1 LWD_72
    s_sleep 8
    s_sub_u32 s80, s80, 1
    s_cmp_lg_u32 s80, 0
    s_cbranch_scc1 LW_71
LWD_72:
    buffer_load_dwordx4 v[40:43], v2, s[56:59], s70 offen offset:0 nt
    buffer_load_dwordx4 v[44:47], v2, s[56:59], s70 offen offset:1024 nt
    buffer_load_dwordx4 v[48:51], v2, s[56:59], s70 offen offset:2048 nt
    buffer_load_dwordx4 v[52:55], v2, s[56:59], s70 offen offset:3072 nt
    s_add_u32 s70, s70, 4096
    s_waitcnt vmcnt(2)
    buffer_load_dwordx4 v[56:59], v2, s[56:59], s70 offen offset:0 nt
    buffer_load_dwordx4 v[60:63], v2, s[56:59], s70 offen offset:1024 nt
    buffer_load_dwordx4 v[64:67], v2, s[56:59], s70 offen offset:2048 nt
    buffer_load_dwordx4 v[68:71], v2, s[56:59], s70 offen offset:3072 nt
    s_add_u32 s70, s70, 28672
    s_waitcnt vmcnt(2)
    buffer_load_dwordx4 v[72:75], v2, s[56:59], s70 offen offset:0 nt
    buffer_load_dwordx4 v[76:79], v2, s[56:59], s70 offen offset:1024 nt
    buffer_load_dwordx4 v[80:83], v2, s[56:59], s70 offen offset:2048 nt
    buffer_load_dwordx4 v[84:87], v2, s[56:59], s70 offen offset:3072 nt
    s_add_u32 s70, s70, 4096
    s_waitcnt vmcnt(2)
    buffer_load_dwordx4 v[88:91], v2, s[56:59], s70 offen offset:0 nt
    buffer_load_dwordx4 v[92:95], v2, s[56:59], s70 offen offset:1024 nt
    buffer_load_dwordx4 v[96:99], v2, s[56:59], s70 offen offset:2048 nt
    buffer_load_dwordx4 v[100:103], v2, s[56:59], s70 offen offset:3072 nt
    s_add_u32 s70, s70, 28672
    s_waitcnt vmcnt(2)
    buffer_load_dwordx4 v[104:107], v2, s[56:59], s70 offen offset:0 nt
    buffer_load_dwordx4 v[108:111], v2, s[56:59], s70 offen offset:1024 nt
    buffer_load_dwordx4 v[112:115], v2, s[56:59], s70 offen offset:2048 nt
    buffer_load_dwordx4 v[116:119], v2, s[56:59], s70 offen offset:3072 nt
    s_add_u32 s70, s70, 4096
    s_waitcnt vmcnt(2)
    buffer_load_dwordx4 v[120:123], v2, s[56:59], s70 offen offset:0 nt
    buffer_load_dwordx4 v[124:127], v2, s[56:59], s70 offen offset:1024 nt
    buffer_load_dwordx4 v[128:131], v2, s[56:59], s70 offen offset:2048 nt
    buffer_load_dwordx4 v[132:135], v2, s[56:59], s70 offen offset:3072 nt
    s_add_u32 s70, s70, 28672
    s_waitcnt vmcnt(2)
    buffer_load_dwordx4 v[136:139], v2, s[56:59], s70 offen offset:0 nt
    buffer_load_dwordx4 v[140:143], v2, s[56:59], s70 offen offset:1024 nt
    buffer_load_dwordx4 v[144:147], v2, s[56:59], s70 offen offset:2048 nt
    buffer_load_dwordx4 v[148:151], v2, s[56:59], s70 offen offset:3072 nt
    s_add_u32 s70, s70, 4096
    s_waitcnt vmcnt(2)
    buffer_load_dwordx4 v[152:155], v2, s[56:59], s70 offen offset:0 nt
    buffer_load_dwordx4 v[156:159], v2, s[56:59], s70 offen offset:1024 nt
    buffer_load_dwordx4 v[160:163], v2, s[56:59], s70 offen offset:2048 nt
    buffer_load_dwordx4 v[164:167], v2, s[56:59], s70 offen offset:3072 nt
    s_add_u32 s70, s70, 28672
    s_waitcnt vmcnt(0)
    s_branch S2J_68
S2U_67:
    buffer_load_dwordx4 v[40:43], v2, s[56:59], s70 offen offset:0 nt
    buffer_load_dwordx4 v[44:47], v2, s[56:59], s70 offen offset:1024 nt
    buffer_load_dwordx4 v[48:51], v2, s[56:59], s70 offen offset:2048 nt
    buffer_load_dwordx4 v[52:55], v2, s[56:59], s70 offen offset:3072 nt
    s_add_u32 s70, s70, 4096
    s_waitcnt vmcnt(2)
    buffer_load_dwordx4 v[56:59], v2, s[56:59], s70 offen offset:0 nt
    buffer_load_dwordx4 v[60:63], v2, s[56:59], s70 offen offset:1024 nt
    buffer_load_dwordx4 v[64:67], v2, s[56:59], s70 offen offset:2048 nt
    buffer_load_dwordx4 v[68:71], v2, s[56:59], s70 offen offset:3072 nt
    s_add_u32 s70, s70, 28672
    s_waitcnt vmcnt(2)
    buffer_load_dwordx4 v[72:75], v2, s[56:59], s70 offen offset:0 nt
    buffer_load_dwordx4 v[76:79], v2, s[56:59], s70 offen offset:1024 nt
    buffer_load_dwordx4 v[80:83], v2, s[56:59], s70 offen offset:2048 nt
    buffer_load_dwordx4 v[84:87], v2, s[56:59], s70 offen offset:3072 nt
    s_add_u32 s70, s70, 4096
    s_waitcnt vmcnt(2)
    buffer_load_dwordx4 v[88:91], v2, s[56:59], s70 offen offset:0 nt
    buffer_load_dwordx4 v[92:95], v2, s[56:59], s70 offen offset:1024 nt
    buffer_load_dwordx4 v[96:99], v2, s[56:59], s70 offen offset:2048 nt
    buffer_load_dwordx4 v[100:103], v2, s[56:59], s70 offen offset:3072 nt
    s_add_u32 s70, s70, 28672
    s_waitcnt vmcnt(2)
    buffer_load_dwordx4 v[104:107], v2, s[56:59], s70 offen offset:0 nt
    buffer_load_dwordx4 v[108:111], v2, s[56:59], s70 offen offset:1024 nt
    buffer_load_dwordx4 v[112:115], v2, s[56:59], s70 offen offset:2048 nt
    buffer_load_dwordx4 v[116:119], v2, s[56:59], s70 offen offset:3072 nt
    s_add_u32 s70, s70, 4096
    s_waitcnt vmcnt(2)
    buffer_load_dwordx4 v[120:123], v2, s[56:59], s70 offen offset:0 nt
    buffer_load_dwordx4 v[124:127], v2, s[56:59], s70 offen offset:1024 nt
    buffer_load_dwordx4 v[128:131], v2, s[56:59], s70 offen offset:2048 nt
    buffer_load_dwordx4 v[132:135], v2, s[56:59], s70 offen offset:3072 nt
    s_add_u32 s70, s70, 28672
    s_waitcnt vmcnt(2)
    buffer_load_dwordx4 v[136:139], v2, s[56:59], s70 offen offset:0 nt
    buffer_load_dwordx4 v[140:143], v2, s[56:59], s70 offen offset:1024 nt
    buffer_load_dwordx4 v[144:147], v2, s[56:59], s70 offen offset:2048 nt
    buffer_load_dwordx4 v[148:151], v2, s[56:59], s70 offen offset:3072 nt
    s_add_u32 s70, s70, 4096
    s_waitcnt vmcnt(2)
    buffer_load_dwordx4 v[152:155], v2, s[56:59], s70 offen offset:0 nt
    buffer_load_dwordx4 v[156:159], v2, s[56:59], s70 offen offset:1024 nt
    buffer_load_dwordx4 v[160:163], v2, s[56:59], s70 offen offset:2048 nt
    buffer_load_dwordx4 v[164:167], v2, s[56:59], s70 offen offset:3072 nt
    s_add_u32 s70, s70, 28672
    s_waitcnt vmcnt(0)
S2J_68:
    v_perm_b32 v8, v44, v40, s92
    v_perm_b32 v9, v52, v48, s92
    v_perm_b32 v10, v60, v56, s92
    v_perm_b32 v11, v68, v64, s92
    v_perm_b32 v12, v44, v40, s93
    v_perm_b32 v13, v52, v48, s93
    v_perm_b32 v14, v60, v56, s93
    v_perm_b32 v15, v68, v64, s93
    v_perm_b32 v16, v45, v41, s92
    v_perm_b32 v17, v53, v49, s92
    v_perm_b32 v18, v61, v57, s92
    v_perm_b32 v19, v69, v65, s92
    v_perm_b32 v20, v45, v41, s93
    v_perm_b32 v21, v53, v49, s93
    v_perm_b32 v22, v61, v57, s93
    v_perm_b32 v23, v69, v65, s93
    v_perm_b32 v24, v46, v42, s92
    v_perm_b32 v25, v54, v50, s92
    v_perm_b32 v26, v62, v58, s92
    v_perm_b32 v27, v70, v66, s92
    v_perm_b32 v28, v46, v42, s93
    v_perm_b32 v29, v54, v50, s93
    v_perm_b32 v30, v62, v58, s93
    v_perm_b32 v31, v70, v66, s93
    v_perm_b32 v32, v47, v43, s92
    v_perm_b32 v33, v55, v51, s92
    v_perm_b32 v34, v63, v59, s92
    v_perm_b32 v35, v71, v67, s92
    v_perm_b32 v36, v47, v43, s93
    v_perm_b32 v37, v55, v51, s93
    v_perm_b32 v38, v63, v59, s93
    v_perm_b32 v39, v71, v67, s93
    v_perm_b32 v40, v76, v72, s92
    v_perm_b32 v41, v84, v80, s92
    v_perm_b32 v42, v92, v88, s92
    v_perm_b32 v43, v100, v96, s92
    v_perm_b32 v44, v76, v72, s93
    v_perm_b32 v45, v84, v80, s93
    v_perm_b32 v46, v92, v88, s93
    v_perm_b32 v47, v100, v96, s93
    v_perm_b32 v48, v77, v73, s92
    v_perm_b32 v49, v85, v81, s92
    v_perm_b32 v50, v93, v89, s92
    v_perm_b32 v51, v101, v97, s92
    v_perm_b32 v52, v77, v73, s93
    v_perm_b32 v53, v85, v81, s93
    v_perm_b32 v54, v93, v89, s93
    v_perm_b32 v55, v101, v97, s93
    v_perm_b32 v56, v78, v74, s92
    v_perm_b32 v57, v86, v82, s92
    v_perm_b32 v58, v94, v90, s92
    v_perm_b32 v59, v102, v98, s92
    v_perm_b32 v60, v78, v74, s93
    v_perm_b32 v61, v86, v82, s93
    v_perm_b32 v62, v94, v90, s93
    v_perm_b32 v63, v102, v98, s93
    v_perm_b32 v64, v79, v75, s92
    v_perm_b32 v65, v87, v83, s92
    v_perm_b32 v66, v95, v91, s92
    v_perm_b32 v67, v103, v99, s92
    v_perm_b32 v68, v79, v75, s93
    v_perm_b32 v69, v87, v83, s93
    v_perm_b32 v70, v95, v91, s93
    v_perm_b32 v71, v103, v99, s93
    v_perm_b32 v72, v108, v104, s92
    v_perm_b32 v73, v116, v112, s92
    v_perm_b32 v74, v124, v120, s92
    v_perm_b32 v75, v132, v128, s92
    v_perm_b32 v76, v108, v104, s93
    v_perm_b32 v77, v116, v112, s93
    v_perm_b32 v78, v124, v120, s93
    v_perm_b32 v79, v132, v128, s93
    v_perm_b32 v80, v109, v105, s92
    v_perm_b32 v81, v117, v113, s92
    v_perm_b32 v82, v125, v121, s92
    v_perm_b32 v83, v133, v129, s92
    v_perm_b32 v84, v109, v105, s93
    v_perm_b32 v85, v117, v113, s93
    v_perm_b32 v86, v125, v121, s93
    v_perm_b32 v87, v133, v129, s93
    v_perm_b32 v88, v110, v106, s92
    v_perm_b32 v89, v118, v114, s92
    v_perm_b32 v90, v126, v122, s92
    v_perm_b32 v91, v134, v130, s92
    v_perm_b32 v92, v110, v106, s93
    v_perm_b32 v93, v118, v114, s93
    v_perm_b32 v94, v126, v122, s93
    v_perm_b32 v95, v134, v130, s93
    v_perm_b32 v96, v111, v107, s92
    v_perm_b32 v97, v119, v115, s92
    v_perm_b32 v98, v127, v123, s92
    v_perm_b32 v99, v135, v131, s92
    v_perm_b32 v100, v111, v107, s93
    v_perm_b32 v101, v119, v115, s93
    v_perm_b32 v102, v127, v123, s93
    v_perm_b32 v103, v135, v131, s93
    v_perm_b32 v104, v140, v136, s92
    v_perm_b32 v105, v148, v144, s92
    v_perm_b32 v106, v156, v152, s92
    v_perm_b32 v107, v164, v160, s92
    v_perm_b32 v108, v140, v136, s93
    v_perm_b32 v109, v148, v144, s93
    v_perm_b32 v110, v156, v152, s93
    v_perm_b32 v111, v164, v160, s93
    v_perm_b32 v112, v141, v137, s92
    v_perm_b32 v113, v149, v145, s92
    v_perm_b32 v114, v157, v153, s92
    v_perm_b32 v115, v165, v161, s92
    v_perm_b32 v116, v141, v137, s93
    v_perm_b32 v117, v149, v145, s93
    v_perm_b32 v118, v157, v153, s93
    v_perm_b32 v119, v165, v161, s93
    v_perm_b32 v120, v142, v138, s92
    v_perm_b32 v121, v150, v146, s92
    v_perm_b32 v122, v158, v154, s92
    v_perm_b32 v123, v166, v162, s92
    v_perm_b32 v124, v142, v138, s93
    v_perm_b32 v125, v150, v146, s93
    v_perm_b32 v126, v158, v154, s93
    v_perm_b32 v127, v166, v162, s93
    v_perm_b32 v128, v143, v139, s92
    v_perm_b32 v129, v151, v147, s92
    v_perm_b32 v130, v159, v155, s92
    v_perm_b32 v131, v167, v163, s92
    v_perm_b32 v132, v143, v139, s93
    v_perm_b32 v133, v151, v147, s93
    v_perm_b32 v134, v159, v155, s93
    v_perm_b32 v135, v167, v163, s93
    v_mov_b32 v160, 0x2404c
    s_mov_b32 s80, 1600000
LW_73:
    ds_read_b32 v161, v160
    s_waitcnt lgkmcnt(0)
    v_readfirstlane_b32 s79, v161
    s_cmp_ge_u32 s79, 1
    s_cbranch_scc1 LWD_74
    s_sleep 2
    s_sub_u32 s80, s80, 1
    s_cmp_lg_u32 s80, 0
    s_cbranch_scc1 LW_73
LWD_74:
    v_mov_b32 v160, 0x24050
    ds_read_b64 v[162:163], v160
    s_waitcnt lgkmcnt(0)
    v_readfirstlane_b32 s94, v162
    v_readfirstlane_b32 s95, v163
    v_bfe_u32 v4, v1, 2, 2
    v_lshlrev_b32 v4, 8, v4
    v_lshrrev_b32 v160, 4, v1
    v_lshl_add_u32 v4, v160, 4, v4
    s_mov_b32 s70, 4096
    s_cmp_ge_u32 s5, 4
    s_cbranch_scc1 S2X_75
    v_add_u32 v4, 0x24400, v4
    s_cmp_lg_u32 s3, 8
    s_cbranch_scc1 U8_77
    v_and_b32 v5, 15, v1
    v_lshl_add_u32 v5, v5, 2, v160
    s_lshl_b32 s7, s6, 4
    s_add_u32 s7, s7, 0xe0000
    v_lshl_add_u32 v5, v5, 9, s7
    v_lshlrev_b32 v6, 4, v1
    v_add_u32 v6, 0x24800, v6
    s_mov_b32 s80, 200000
PO_78:
    buffer_load_dwordx4 v[136:139], v5, s[36:39], 0 offen sc1
PO2_79:
    s_waitcnt vmcnt(0)
    v_cmp_ne_u64 vcc, s[94:95], v[138:139]
    s_cmp_lg_u64 vcc, -1
    s_cbranch_scc1 POD_80
    s_sleep 16
    s_sub_u32 s80, s80, 1
    s_cmp_lg_u32 s80, 0
    s_cbranch_scc1 PO_78
POD_80:
    s_setprio 3
    ds_write_b128 v6, v[136:139]
    v_mov_b32 v160, 0x2401c
    v_mov_b32 v161, 1
    s_waitcnt lgkmcnt(0)
    s_mov_b64 exec, 1
    ds_add_u32 v160, v161
    s_mov_b64 exec, -1
    s_cbranch_vccz U8D_82
    buffer_load_dwordx4 v[136:139], v5, s[36:39], 0 offen sc1
    s_sleep 4
    buffer_load_dwordx4 v[140:143], v5, s[36:39], 0 offen sc1
    s_sleep 4
    s_mov_b32 s80, 200000
U8P_81:
    s_waitcnt vmcnt(1)
    ds_write_b128 v6, v[136:139]
    v_cmp_ne_u64 vcc, s[94:95], v[138:139]
    s_cbranch_vccz U8D_82
    s_waitcnt lgkmcnt(0)
    buffer_load_dwordx4 v[136:139], v5, s[36:39], 0 offen sc1
    s_waitcnt vmcnt(1)
    ds_write_b128 v6, v[140:143]
    v_cmp_ne_u64 vcc, s[94:95], v[142:143]
    s_cbranch_vccz U8D_82
    s_waitcnt lgkmcnt(0)
    buffer_load_dwordx4 v[140:143], v5, s[36:39], 0 offen sc1
    s_sub_u32 s80, s80, 1
    s_cmp_lg_u32 s80, 0
    s_cbranch_scc1 U8P_81
U8D_82:
    s_waitcnt vmcnt(0)
U8_77:
    s_setprio 3
    s_barrier
    s_barrier
    ds_read_b128 v[136:139], v4 offset:0
    ds_read_b128 v[140:143], v4 offset:64
    ds_read_b128 v[144:147], v4 offset:128
    ds_read_b128 v[148:151], v4 offset:192
    s_waitcnt lgkmcnt(0)
    s_branch S2M_76
S2X_75:
    v_and_b32 v160, 3, v1
    v_lshl_add_u32 v4, v160, 6, v4
    s_lshl_b32 s7, s6, 11
    s_add_u32 s7, s7, 0xd0000
    v_add_u32 v4, s7, v4
    s_mov_b32 s80, 200000
PO_83:
    buffer_load_dwordx4 v[152:155], v4, s[36:39], 0 offen offset:0 sc1
PO2_84:
    s_waitcnt vmcnt(0)
    v_cmp_ne_u64 vcc, s[94:95], v[154:155]
    s_cmp_lg_u64 vcc, -1
    s_cbranch_scc1 POD_85
    s_sleep 2
    s_sub_u32 s80, s80, 1
    s_cmp_lg_u32 s80, 0
    s_cbranch_scc1 PO_83
POD_85:
    s_setprio 3
    buffer_load_dwordx4 v[152:155], v4, s[36:39], 0 offen offset:0 sc1
    buffer_load_dwordx4 v[156:159], v4, s[36:39], 0 offen offset:1024 sc1
    s_sleep 4
    buffer_load_dwordx4 v[160:163], v4, s[36:39], 0 offen offset:0 sc1
    buffer_load_dwordx4 v[164:167], v4, s[36:39], 0 offen offset:1024 sc1
    s_sleep 4
    s_mov_b32 s80, 200000
PP_86:
    s_waitcnt vmcnt(2)
    v_cmp_ne_u64 vcc, s[94:95], v[154:155]
    v_cmp_ne_u64 s[84:85], s[94:95], v[158:159]
    s_or_b64 vcc, vcc, s[84:85]
    s_cmp_eq_u64 vcc, 0
    s_cbranch_scc1 PPO_88
    buffer_load_dwordx4 v[152:155], v4, s[36:39], 0 offen offset:0 sc1
    buffer_load_dwordx4 v[156:159], v4, s[36:39], 0 offen offset:1024 sc1
    s_waitcnt vmcnt(2)
    v_cmp_ne_u64 vcc, s[94:95], v[162:163]
    v_cmp_ne_u64 s[84:85], s[94:95], v[166:167]
    s_or_b64 vcc, vcc, s[84:85]
    s_cmp_eq_u64 vcc, 0
    s_cbranch_scc1 PPO_89
    buffer_load_dwordx4 v[160:163], v4, s[36:39], 0 offen offset:0 sc1
    buffer_load_dwordx4 v[164:167], v4, s[36:39], 0 offen offset:1024 sc1
    s_sub_u32 s80, s80, 1
    s_cmp_lg_u32 s80, 0
    s_cbranch_scc1 PP_86
PPO_88:
    v_mov_b32_dpp v136, v152 quad_perm:[0,0,0,0] row_mask:0xf bank_mask:0xf
    v_mov_b32_dpp v137, v153 quad_perm:[0,0,0,0] row_mask:0xf bank_mask:0xf
    v_mov_b32_dpp v138, v156 quad_perm:[0,0,0,0] row_mask:0xf bank_mask:0xf
    v_mov_b32_dpp v139, v157 quad_perm:[0,0,0,0] row_mask:0xf bank_mask:0xf
    v_mov_b32_dpp v140, v152 quad_perm:[1,1,1,1] row_mask:0xf bank_mask:0xf
    v_mov_b32_dpp v141, v153 quad_perm:[1,1,1,1] row_mask:0xf bank_mask:0xf
    v_mov_b32_dpp v142, v156 quad_perm:[1,1,1,1] row_mask:0xf bank_mask:0xf
    v_mov_b32_dpp v143, v157 quad_perm:[1,1,1,1] row_mask:0xf bank_mask:0xf
    v_mov_b32_dpp v144, v152 quad_perm:[2,2,2,2] row_mask:0xf bank_mask:0xf
    v_mov_b32_dpp v145, v153 quad_perm:[2,2,2,2] row_mask:0xf bank_mask:0xf
    v_mov_b32_dpp v146, v156 quad_perm:[2,2,2,2] row_mask:0xf bank_mask:0xf
    v_mov_b32_dpp v147, v157 quad_perm:[2,2,2,2] row_mask:0xf bank_mask:0xf
    v_mov_b32_dpp v148, v152 quad_perm:[3,3,3,3] row_mask:0xf bank_mask:0xf
    v_mov_b32_dpp v149, v153 quad_perm:[3,3,3,3] row_mask:0xf bank_mask:0xf
    v_mov_b32_dpp v150, v156 quad_perm:[3,3,3,3] row_mask:0xf bank_mask:0xf
    v_mov_b32_dpp v151, v157 quad_perm:[3,3,3,3] row_mask:0xf bank_mask:0xf
    s_branch PPD_87
PPO_89:
    v_mov_b32_dpp v136, v160 quad_perm:[0,0,0,0] row_mask:0xf bank_mask:0xf
    v_mov_b32_dpp v137, v161 quad_perm:[0,0,0,0] row_mask:0xf bank_mask:0xf
    v_mov_b32_dpp v138, v164 quad_perm:[0,0,0,0] row_mask:0xf bank_mask:0xf
    v_mov_b32_dpp v139, v165 quad_perm:[0,0,0,0] row_mask:0xf bank_mask:0xf
    v_mov_b32_dpp v140, v160 quad_perm:[1,1,1,1] row_mask:0xf bank_mask:0xf
    v_mov_b32_dpp v141, v161 quad_perm:[1,1,1,1] row_mask:0xf bank_mask:0xf
    v_mov_b32_dpp v142, v164 quad_perm:[1,1,1,1] row_mask:0xf bank_mask:0xf
    v_mov_b32_dpp v143, v165 quad_perm:[1,1,1,1] row_mask:0xf bank_mask:0xf
    v_mov_b32_dpp v144, v160 quad_perm:[2,2,2,2] row_mask:0xf bank_mask:0xf
    v_mov_b32_dpp v145, v161 quad_perm:[2,2,2,2] row_mask:0xf bank_mask:0xf
    v_mov_b32_dpp v146, v164 quad_perm:[2,2,2,2] row_mask:0xf bank_mask:0xf
    v_mov_b32_dpp v147, v165 quad_perm:[2,2,2,2] row_mask:0xf bank_mask:0xf
    v_mov_b32_dpp v148, v160 quad_perm:[3,3,3,3] row_mask:0xf bank_mask:0xf
    v_mov_b32_dpp v149, v161 quad_perm:[3,3,3,3] row_mask:0xf bank_mask:0xf
    v_mov_b32_dpp v150, v164 quad_perm:[3,3,3,3] row_mask:0xf bank_mask:0xf
    v_mov_b32_dpp v151, v165 quad_perm:[3,3,3,3] row_mask:0xf bank_mask:0xf
PPD_87:
S2M_76:
    s_nop 1
    v_mfma_f32_16x16x32_bf16 v[4:7], v[136:139], v[8:11], 0
    v_mfma_f32_16x16x32_bf16 v[4:7], v[140:143], v[40:43], v[4:7]
    v_mfma_f32_16x16x32_bf16 v[4:7], v[144:147], v[72:75], v[4:7]
    v_mfma_f32_16x16x32_bf16 v[4:7], v[148:151], v[104:107], v[4:7]
    v_mfma_f32_16x16x32_bf16 v[8:11], v[136:139], v[12:15], 0
    v_mfma_f32_16x16x32_bf16 v[8:11], v[140:143], v[44:47], v[8:11]
    v_mfma_f32_16x16x32_bf16 v[8:11], v[144:147], v[76:79], v[8:11]
    v_mfma_f32_16x16x32_bf16 v[8:11], v[148:151], v[108:111], v[8:11]
    v_mfma_f32_16x16x32_bf16 v[12:15], v[136:139], v[16:19], 0
    v_mfma_f32_16x16x32_bf16 v[12:15], v[140:143], v[48:51], v[12:15]
    v_mfma_f32_16x16x32_bf16 v[12:15], v[144:147], v[80:83], v[12:15]
    v_mfma_f32_16x16x32_bf16 v[12:15], v[148:151], v[112:115], v[12:15]
    v_mfma_f32_16x16x32_bf16 v[16:19], v[136:139], v[20:23], 0
    v_mfma_f32_16x16x32_bf16 v[16:19], v[140:143], v[52:55], v[16:19]
    v_mfma_f32_16x16x32_bf16 v[16:19], v[144:147], v[84:87], v[16:19]
    v_mfma_f32_16x16x32_bf16 v[16:19], v[148:151], v[116:119], v[16:19]
    v_mfma_f32_16x16x32_bf16 v[20:23], v[136:139], v[24:27], 0
    v_mfma_f32_16x16x32_bf16 v[20:23], v[140:143], v[56:59], v[20:23]
    v_mfma_f32_16x16x32_bf16 v[20:23], v[144:147], v[88:91], v[20:23]
    v_mfma_f32_16x16x32_bf16 v[20:23], v[148:151], v[120:123], v[20:23]
    v_mfma_f32_16x16x32_bf16 v[24:27], v[136:139], v[28:31], 0
    v_mfma_f32_16x16x32_bf16 v[24:27], v[140:143], v[60:63], v[24:27]
    v_mfma_f32_16x16x32_bf16 v[24:27], v[144:147], v[92:95], v[24:27]
    v_mfma_f32_16x16x32_bf16 v[24:27], v[148:151], v[124:127], v[24:27]
    v_mfma_f32_16x16x32_bf16 v[28:31], v[136:139], v[32:35], 0
    v_mfma_f32_16x16x32_bf16 v[28:31], v[140:143], v[64:67], v[28:31]
    v_mfma_f32_16x16x32_bf16 v[28:31], v[144:147], v[96:99], v[28:31]
    v_mfma_f32_16x16x32_bf16 v[28:31], v[148:151], v[128:131], v[28:31]
    v_mfma_f32_16x16x32_bf16 v[32:35], v[136:139], v[36:39], 0
    v_mfma_f32_16x16x32_bf16 v[32:35], v[140:143], v[68:71], v[32:35]
    v_mfma_f32_16x16x32_bf16 v[32:35], v[144:147], v[100:103], v[32:35]
    v_mfma_f32_16x16x32_bf16 v[32:35], v[148:151], v[132:135], v[32:35]
    v_mov_b32 v42, s94
    v_mov_b32 v43, s95
    v_cvt_pk_bf16_f32 v40, v4, v8
    v_cvt_pk_bf16_f32 v41, v12, v16
    buffer_store_dwordx4 v[40:43], v3, s[36:39], 0 offen sc1
    v_mov_b32 v46, s94
    v_mov_b32 v47, s95
    v_cvt_pk_bf16_f32 v44, v20, v24
    v_cvt_pk_bf16_f32 v45, v28, v32
    buffer_store_dwordx4 v[44:47], v3, s[36:39], s70 offen sc1
    s_endpgm
L_C:
    v_and_b32 v1, 63, v0
    s_and_b32 s7, s5, 3
    s_lshl_b32 s6, s4, 2
    s_add_u32 s6, s6, s7
    s_mov_b32 s92, 0x05040100
    s_mov_b32 s93, 0x07060302
    s_lshl_b32 s60, s4, 3
    s_add_u32 s60, s60, s5
    s_sub_u32 s60, s60, 8
    s_lshr_b32 s64, s3, 1
    s_and_b32 s65, s3, 1
    s_mov_b32 s67, 0x3e0293ee
    v_lshlrev_b32 v160, 4, v1
    s_and_b32 s7, s3, 3
    s_lshl_b32 s7, s7, 2
    s_lshr_b32 s66, s3, 2
    s_or_b32 s7, s7, s66
    s_lshl_b32 s62, s7, 4
    v_xor_b32 v2, s62, v160
    v_xor_b32 v3, 32, v2
    s_lshl_b32 s70, s60, 18
    s_lshl_b32 s68, s3, 10
    s_add_u32 s61, s70, s68
    s_waitcnt lgkmcnt(0)
    s_mov_b32 s44, s20
    s_and_b32 s45, s21, 0xffff
    s_mov_b32 s46, 0x1000000
    s_mov_b32 s47, 0x20000
    s_mov_b32 m0, s68
    s_nop 0
    buffer_load_dwordx4 v2, s[44:47], s61 offen nt lds
    s_add_u32 s68, s68, 8192
    s_add_u32 s61, s61, 8192
    s_mov_b32 m0, s68
    s_nop 0
    buffer_load_dwordx4 v3, s[44:47], s61 offen nt lds
    s_add_u32 s68, s68, 8192
    s_add_u32 s61, s61, 8192
    s_mov_b32 m0, s68
    s_nop 0
    buffer_load_dwordx4 v2, s[44:47], s61 offen nt lds
    s_add_u32 s68, s68, 8192
    s_add_u32 s61, s61, 8192
    s_mov_b32 m0, s68
    s_nop 0
    buffer_load_dwordx4 v3, s[44:47], s61 offen nt lds
    s_add_u32 s68, s68, 8192
    s_mov_b32 s36, s34
    s_and_b32 s37, s35, 0xffff
    s_mov_b32 s38, 0x1000000
    s_mov_b32 s39, 0x20000
    s_mov_b32 s40, s32
    s_and_b32 s41, s33, 0xffff
    s_mov_b32 s42, 0x100
    s_mov_b32 s43, 0x20000
    s_barrier
    s_add_u32 s61, s61, 8192
    s_mov_b32 m0, s68
    s_waitcnt vmcnt(3)
    buffer_load_dwordx4 v2, s[44:47], s61 offen nt lds
    s_add_u32 s68, s68, 8192
    s_add_u32 s61, s61, 8192
    s_mov_b32 m0, s68
    s_waitcnt vmcnt(3)
    buffer_load_dwordx4 v3, s[44:47], s61 offen nt lds
    s_add_u32 s68, s68, 8192
    s_add_u32 s61, s61, 8192
    s_mov_b32 m0, s68
    s_waitcnt vmcnt(3)
    buffer_load_dwordx4 v2, s[44:47], s61 offen nt lds
    s_add_u32 s68, s68, 8192
    s_add_u32 s61, s61, 8192
    s_mov_b32 m0, s68
    s_waitcnt vmcnt(3)
    buffer_load_dwordx4 v3, s[44:47], s61 offen nt lds
    s_add_u32 s68, s68, 8192
    s_add_u32 s61, s61, 8192
    s_mov_b32 m0, s68
    s_waitcnt vmcnt(3)
    buffer_load_dwordx4 v2, s[44:47], s61 offen nt lds
    s_add_u32 s68, s68, 8192
    s_add_u32 s61, s61, 8192
    s_mov_b32 m0, s68
    s_waitcnt vmcnt(3)
    buffer_load_dwordx4 v3, s[44:47], s61 offen nt lds
    s_add_u32 s68, s68, 8192
    s_add_u32 s61, s61, 8192
    s_mov_b32 m0, s68
    s_waitcnt vmcnt(3)
    buffer_load_dwordx4 v2, s[44:47], s61 offen nt lds
    s_add_u32 s68, s68, 8192
    s_add_u32 s61, s61, 8192
    s_mov_b32 m0, s68
    s_waitcnt vmcnt(3)
    buffer_load_dwordx4 v3, s[44:47], s61 offen nt lds
    s_add_u32 s68, s68, 8192
    s_add_u32 s61, s61, 8192
    s_waitcnt vmcnt(3)
    buffer_load_dwordx4 v[128:131], v2, s[44:47], s61 offen nt
    s_add_u32 s61, s61, 8192
    s_waitcnt vmcnt(3)
    buffer_load_dwordx4 v[132:135], v3, s[44:47], s61 offen nt
    s_add_u32 s61, s61, 8192
    s_waitcnt vmcnt(3)
    buffer_load_dwordx4 v[136:139], v2, s[44:47], s61 offen nt
    s_add_u32 s61, s61, 8192
    s_waitcnt vmcnt(3)
    buffer_load_dwordx4 v[140:143], v3, s[44:47], s61 offen nt
    s_add_u32 s61, s61, 8192
    s_waitcnt vmcnt(3)
    buffer_load_dwordx4 v[96:99], v2, s[44:47], s61 offen nt
    s_add_u32 s61, s61, 8192
    s_waitcnt vmcnt(3)
    buffer_load_dwordx4 v[100:103], v3, s[44:47], s61 offen nt
    s_add_u32 s61, s61, 8192
    s_waitcnt vmcnt(3)
    buffer_load_dwordx4 v[104:107], v2, s[44:47], s61 offen nt
    s_add_u32 s61, s61, 8192
    s_waitcnt vmcnt(3)
    buffer_load_dwordx4 v[108:111], v3, s[44:47], s61 offen nt
    s_add_u32 s61, s61, 8192
    s_waitcnt vmcnt(3)
    buffer_load_dwordx4 v[112:115], v2, s[44:47], s61 offen nt
    s_add_u32 s61, s61, 8192
    s_waitcnt vmcnt(3)
    buffer_load_dwordx4 v[116:119], v3, s[44:47], s61 offen nt
    s_add_u32 s61, s61, 8192
    v_mov_b32 v160, 0x24018
    v_mov_b32 v161, 1
    s_waitcnt lgkmcnt(0)
    s_mov_b64 exec, 1
    ds_add_u32 v160, v161
    s_mov_b64 exec, -1
    s_waitcnt vmcnt(3)
    buffer_load_dwordx4 v[120:123], v2, s[44:47], s61 offen nt
    s_add_u32 s61, s61, 8192
    s_waitcnt vmcnt(3)
    buffer_load_dwordx4 v[124:127], v3, s[44:47], s61 offen nt
    s_add_u32 s61, s61, 8192
    v_and_b32 v160, 15, v1
    v_lshlrev_b32 v4, 10, v160
    v_lshrrev_b32 v161, 4, v1
    v_lshl_add_u32 v4, v161, 8, v4
    v_lshl_add_u32 v3, v160, 4, v4
    s_lshl_b32 s7, s65, 14
    s_add_u32 s7, s7, 0x18000
    v_add_u32 v3, s7, v3
    v_and_b32 v162, 3, v1
    v_lshl_add_u32 v4, v162, 6, v4
    v_bfe_u32 v162, v1, 2, 2
    v_lshl_add_u32 v4, v162, 4, v4
    s_lshl_b32 s7, s64, 14
    v_add_u32 v4, s7, v4
    v_add_u32 v2, 0x10000, v4
    s_lshl_b32 s7, s65, 6
    s_add_u32 s7, s7, 0x27200
    v_lshl_add_u32 v5, v160, 2, s7
    s_lshl_b32 s7, s64, 10
    s_lshl_b32 s66, s65, 9
    s_add_u32 s7, s7, s66
    s_add_u32 s7, s7, 0x25200
    v_lshl_add_u32 v6, v160, 5, s7
    v_lshl_add_u32 v6, v161, 3, v6
    v_and_b32 v162, 31, v1
    v_lshlrev_b32 v7, 5, v162
    v_lshrrev_b32 v163, 5, v1
    v_lshl_add_u32 v7, v163, 4, v7
    v_add_u32 v7, 0x25200, v7
    v_lshlrev_b32 v8, 2, v162
    v_add_u32 v8, 0x27e00, v8
    v_bfe_u32 v162, v1, 2, 2
    v_lshl_add_u32 v164, v163, 3, v162
    v_lshlrev_b32 v164, 10, v164
    v_and_b32 v165, 1, v1
    v_lshl_add_u32 v164, v165, 3, v164
    s_lshl_b32 s7, s64, 8
    v_add_u32 v164, s7, v164
    v_bfe_u32 v165, v1, 4, 1
    v_lshlrev_b32 v165, 1, v165
    v_bfe_u32 v160, v1, 1, 1
    v_or_b32 v165, v165, v160
    s_lshl_b32 s7, s65, 3
    v_or_b32 v165, s7, v165
    v_lshlrev_b32 v162, 2, v162
    v_xor_b32 v165, v165, v162
    v_lshlrev_b32 v163, 1, v163
    v_xor_b32 v165, v165, v163
    v_xor_b32 v160, 0, v165
    v_lshl_add_u32 v9, v160, 4, v164
    v_xor_b32 v160, 4, v165
    v_lshl_add_u32 v10, v160, 4, v164
    v_xor_b32 v160, 1, v165
    v_lshl_add_u32 v11, v160, 4, v164
    v_add_u32 v11, 0x1000, v11
    v_xor_b32 v160, 5, v165
    v_lshl_add_u32 v12, v160, 4, v164
    v_add_u32 v12, 0x1000, v12
    v_mov_b32 v13, 0xff800000
    v_mov_b32 v14, 0
    v_cmp_gt_u32 s[86:87], 16, v1
    s_cmp_eq_u32 s64, 0
    s_cselect_b32 s88, 0xffff, 0
    s_mov_b32 s89, 0
    s_barrier
    v_xor_b32 v160, 0x0, v3
    ds_read_b128 v[32:35], v160
    v_xor_b32 v161, 0x10, v3
    ds_read_b128 v[36:39], v161
    v_xor_b32 v160, 0x20, v3
    ds_read_b128 v[40:43], v160
    v_xor_b32 v161, 0x30, v3
    ds_read_b128 v[44:47], v161
    v_xor_b32 v160, 0x40, v3
    ds_read_b128 v[48:51], v160
    v_xor_b32 v161, 0x50, v3
    ds_read_b128 v[52:55], v161
    v_xor_b32 v160, 0x60, v3
    ds_read_b128 v[56:59], v160
    v_xor_b32 v161, 0x70, v3
    ds_read_b128 v[60:63], v161
    v_xor_b32 v160, 0x80, v3
    ds_read_b128 v[64:67], v160
    v_xor_b32 v161, 0x90, v3
    ds_read_b128 v[68:71], v161
    v_xor_b32 v160, 0xa0, v3
    ds_read_b128 v[72:75], v160
    v_xor_b32 v161, 0xb0, v3
    ds_read_b128 v[76:79], v161
    v_xor_b32 v160, 0xc0, v3
    ds_read_b128 v[80:83], v160
    v_xor_b32 v161, 0xd0, v3
    ds_read_b128 v[84:87], v161
    v_xor_b32 v160, 0xe0, v3
    ds_read_b128 v[88:91], v160
    v_xor_b32 v161, 0xf0, v3
    ds_read_b128 v[92:95], v161
    s_lshl_b32 s7, s3, 10
    s_add_u32 s7, s7, 0x18000
    v_lshl_add_u32 v3, v1, 4, s7
    s_waitcnt lgkmcnt(0)
    s_barrier
    ds_write_b128 v3, v[128:131] offset:0
    ds_write_b128 v3, v[132:135] offset:8192
    ds_write_b128 v3, v[136:139] offset:16384
    ds_write_b128 v3, v[140:143] offset:24576
    v_xor_b32 v160, 0x0, v4
    ds_read_b128 v[24:27], v160
    v_xor_b32 v161, 0x10, v4
    ds_read_b128 v[28:31], v161
    v_xor_b32 v162, 0x20, v4
    ds_read_b128 v[164:167], v162
    v_xor_b32 v160, 0x30, v4
    ds_read_b128 v[144:147], v160
    v_xor_b32 v161, 0x40, v4
    ds_read_b128 v[148:151], v161
    v_xor_b32 v162, 0x50, v4
    ds_read_b128 v[152:155], v162
    v_xor_b32 v160, 0x60, v4
    ds_read_b128 v[156:159], v160
    s_waitcnt lgkmcnt(6)
    v_mfma_f32_16x16x32_bf16 v[16:19], v[24:27], v[32:35], 0
    v_xor_b32 v161, 0x70, v4
    ds_read_b128 v[24:27], v161
    s_waitcnt lgkmcnt(6)
    v_mfma_f32_16x16x32_bf16 v[16:19], v[28:31], v[36:39], v[16:19]
    v_xor_b32 v162, 0x80, v4
    ds_read_b128 v[28:31], v162
    s_waitcnt lgkmcnt(6)
    v_mfma_f32_16x16x32_bf16 v[16:19], v[164:167], v[40:43], v[16:19]
    v_xor_b32 v160, 0x90, v4
    ds_read_b128 v[164:167], v160
    s_waitcnt lgkmcnt(6)
    v_mfma_f32_16x16x32_bf16 v[16:19], v[144:147], v[44:47], v[16:19]
    v_xor_b32 v161, 0xa0, v4
    ds_read_b128 v[144:147], v161
    s_waitcnt lgkmcnt(6)
    v_mfma_f32_16x16x32_bf16 v[16:19], v[148:151], v[48:51], v[16:19]
    v_xor_b32 v162, 0xb0, v4
    ds_read_b128 v[148:151], v162
    s_waitcnt lgkmcnt(6)
    v_mfma_f32_16x16x32_bf16 v[16:19], v[152:155], v[52:55], v[16:19]
    v_xor_b32 v160, 0xc0, v4
    ds_read_b128 v[152:155], v160
    s_waitcnt lgkmcnt(6)
    v_mfma_f32_16x16x32_bf16 v[16:19], v[156:159], v[56:59], v[16:19]
    v_xor_b32 v161, 0xd0, v4
    ds_read_b128 v[156:159], v161
    s_waitcnt lgkmcnt(6)
    v_mfma_f32_16x16x32_bf16 v[16:19], v[24:27], v[60:63], v[16:19]
    v_xor_b32 v162, 0xe0, v4
    ds_read_b128 v[24:27], v162
    s_waitcnt lgkmcnt(6)
    v_mfma_f32_16x16x32_bf16 v[16:19], v[28:31], v[64:67], v[16:19]
    v_xor_b32 v160, 0xf0, v4
    ds_read_b128 v[28:31], v160
    s_waitcnt lgkmcnt(6)
    v_mfma_f32_16x16x32_bf16 v[16:19], v[164:167], v[68:71], v[16:19]
    s_waitcnt lgkmcnt(5)
    v_mfma_f32_16x16x32_bf16 v[16:19], v[144:147], v[72:75], v[16:19]
    s_waitcnt lgkmcnt(4)
    v_mfma_f32_16x16x32_bf16 v[16:19], v[148:151], v[76:79], v[16:19]
    s_waitcnt lgkmcnt(3)
    v_mfma_f32_16x16x32_bf16 v[16:19], v[152:155], v[80:83], v[16:19]
    s_waitcnt lgkmcnt(2)
    v_mfma_f32_16x16x32_bf16 v[16:19], v[156:159], v[84:87], v[16:19]
    s_waitcnt lgkmcnt(1)
    v_mfma_f32_16x16x32_bf16 v[16:19], v[24:27], v[88:91], v[16:19]
    s_waitcnt lgkmcnt(0)
    v_mfma_f32_16x16x32_bf16 v[16:19], v[28:31], v[92:95], v[16:19]
    s_waitcnt lgkmcnt(0)
    s_barrier
    v_xor_b32 v160, 0x0, v2
    ds_read_b128 v[24:27], v160
    v_xor_b32 v161, 0x10, v2
    ds_read_b128 v[28:31], v161
    v_xor_b32 v162, 0x20, v2
    ds_read_b128 v[164:167], v162
    v_xor_b32 v160, 0x30, v2
    ds_read_b128 v[144:147], v160
    v_xor_b32 v161, 0x40, v2
    ds_read_b128 v[148:151], v161
    v_xor_b32 v162, 0x50, v2
    ds_read_b128 v[152:155], v162
    v_xor_b32 v160, 0x60, v2
    ds_read_b128 v[156:159], v160
    s_waitcnt lgkmcnt(6)
    v_mfma_f32_16x16x32_bf16 v[20:23], v[24:27], v[32:35], 0
    v_xor_b32 v161, 0x70, v2
    ds_read_b128 v[24:27], v161
    s_waitcnt lgkmcnt(6)
    v_mfma_f32_16x16x32_bf16 v[20:23], v[28:31], v[36:39], v[20:23]
    v_xor_b32 v162, 0x80, v2
    ds_read_b128 v[28:31], v162
    s_waitcnt lgkmcnt(6)
    v_mfma_f32_16x16x32_bf16 v[20:23], v[164:167], v[40:43], v[20:23]
    v_xor_b32 v160, 0x90, v2
    ds_read_b128 v[164:167], v160
    s_waitcnt lgkmcnt(6)
    v_mfma_f32_16x16x32_bf16 v[20:23], v[144:147], v[44:47], v[20:23]
    v_xor_b32 v161, 0xa0, v2
    ds_read_b128 v[144:147], v161
    s_waitcnt lgkmcnt(6)
    v_mfma_f32_16x16x32_bf16 v[20:23], v[148:151], v[48:51], v[20:23]
    v_xor_b32 v162, 0xb0, v2
    ds_read_b128 v[148:151], v162
    s_waitcnt lgkmcnt(6)
    v_mfma_f32_16x16x32_bf16 v[20:23], v[152:155], v[52:55], v[20:23]
    v_xor_b32 v160, 0xc0, v2
    ds_read_b128 v[152:155], v160
    s_waitcnt lgkmcnt(6)
    v_mfma_f32_16x16x32_bf16 v[20:23], v[156:159], v[56:59], v[20:23]
    v_xor_b32 v161, 0xd0, v2
    ds_read_b128 v[156:159], v161
    s_waitcnt lgkmcnt(6)
    v_mfma_f32_16x16x32_bf16 v[20:23], v[24:27], v[60:63], v[20:23]
    v_xor_b32 v162, 0xe0, v2
    ds_read_b128 v[24:27], v162
    s_waitcnt lgkmcnt(6)
    v_mfma_f32_16x16x32_bf16 v[20:23], v[28:31], v[64:67], v[20:23]
    v_xor_b32 v160, 0xf0, v2
    ds_read_b128 v[28:31], v160
    s_waitcnt lgkmcnt(6)
    v_mfma_f32_16x16x32_bf16 v[20:23], v[164:167], v[68:71], v[20:23]
    s_waitcnt lgkmcnt(5)
    v_mfma_f32_16x16x32_bf16 v[20:23], v[144:147], v[72:75], v[20:23]
    s_waitcnt lgkmcnt(4)
    v_mfma_f32_16x16x32_bf16 v[20:23], v[148:151], v[76:79], v[20:23]
    s_waitcnt lgkmcnt(3)
    v_mfma_f32_16x16x32_bf16 v[20:23], v[152:155], v[80:83], v[20:23]
    s_waitcnt lgkmcnt(2)
    v_mfma_f32_16x16x32_bf16 v[20:23], v[156:159], v[84:87], v[20:23]
    s_waitcnt lgkmcnt(1)
    v_mfma_f32_16x16x32_bf16 v[20:23], v[24:27], v[88:91], v[20:23]
    s_waitcnt lgkmcnt(0)
    v_mfma_f32_16x16x32_bf16 v[20:23], v[28:31], v[92:95], v[20:23]
    v_max3_f32 v160, v16, v17, v18
    s_nop 6
    v_max3_f32 v160, v160, v19, v20
    v_max3_f32 v160, v160, v21, v22
    v_max_f32 v160, v160, v23
    v_mov_b32 v161, v160
    s_nop 1
    v_permlane32_swap_b32 v160, v161
    v_max_f32 v160, v160, v161
    v_mov_b32 v161, v160
    s_nop 1
    v_permlane16_swap_b32 v160, v161
    v_max_f32 v160, v160, v161
    s_lshl_b32 s7, s64, 7
    v_add_u32 v161, s7, v5
    s_mov_b64 exec, s[86:87]
    ds_write_b32 v161, v160
    s_mov_b64 exec, -1
    s_waitcnt lgkmcnt(0)
    s_barrier
    ds_read_b32 v160, v5 offset:0
    ds_read_b32 v161, v5 offset:128
    ds_read_b32 v162, v5 offset:256
    ds_read_b32 v163, v5 offset:384
    s_waitcnt lgkmcnt(0)
    v_max3_f32 v160, v160, v161, v162
    v_max_f32 v160, v160, v163
    v_mul_f32 v160, s67, v160
    v_max_f32 v160, v160, v13
    v_sub_f32 v161, v13, v160
    v_exp_f32 v161, v161
    v_mov_b32 v13, v160
    v_fma_f32 v16, v16, s67, -v160
    v_fma_f32 v17, v17, s67, -v160
    v_fma_f32 v18, v18, s67, -v160
    v_fma_f32 v19, v19, s67, -v160
    v_fma_f32 v20, v20, s67, -v160
    v_fma_f32 v21, v21, s67, -v160
    v_fma_f32 v22, v22, s67, -v160
    v_fma_f32 v23, v23, s67, -v160
    v_exp_f32 v16, v16
    v_exp_f32 v17, v17
    v_exp_f32 v18, v18
    v_exp_f32 v19, v19
    v_exp_f32 v20, v20
    v_exp_f32 v21, v21
    v_exp_f32 v22, v22
    v_exp_f32 v23, v23
    v_cvt_pk_bf16_f32 v24, v16, v17
    v_cvt_pk_bf16_f32 v25, v18, v19
    v_cvt_pk_bf16_f32 v26, v20, v21
    v_cvt_pk_bf16_f32 v27, v22, v23
    ds_write_b64 v6, v[24:25]
    ds_write_b64 v6, v[26:27] offset:4096
    v_add_u32 v162, 0xc00, v5
    s_mov_b64 exec, s[88:89]
    ds_write_b32 v162, v161
    s_mov_b64 exec, -1
    v_mul_f32 v14, v14, v161
    v_add_f32 v16, v16, v20
    v_add_f32 v17, v17, v21
    v_add_f32 v18, v18, v22
    v_add_f32 v19, v19, v23
    v_add_f32 v16, v16, v18
    v_add_f32 v17, v17, v19
    v_add_f32 v16, v16, v17
    v_add_f32 v14, v14, v16
    v_lshlrev_b32 v3, 4, v1
    v_xor_b32 v3, s62, v3
    v_xor_b32 v15, 32, v3
    s_lshl_b32 s68, s3, 10
    s_waitcnt lgkmcnt(0)
    s_barrier
    ds_read_b128 v[16:19], v7 offset:0
    ds_read_b64_tr_b16 v[24:25], v9 offset:0
    ds_read_b64_tr_b16 v[26:27], v11 offset:0
    ds_read_b64_tr_b16 v[28:29], v10 offset:0
    ds_read_b64_tr_b16 v[30:31], v12 offset:0
    ds_read_b128 v[20:23], v7 offset:1024
    ds_read_b64_tr_b16 v[160:161], v9 offset:16384
    ds_read_b64_tr_b16 v[162:163], v11 offset:16384
    ds_read_b64_tr_b16 v[164:165], v10 offset:16384
    ds_read_b64_tr_b16 v[166:167], v12 offset:16384
    s_waitcnt lgkmcnt(7)
    v_mfma_f32_32x32x16_bf16 v[128:143], v[24:27], v[16:19], 0
    s_waitcnt lgkmcnt(5)
    v_mfma_f32_32x32x16_bf16 v[144:159], v[28:31], v[16:19], 0
    ds_read_b128 v[16:19], v7 offset:2048
    ds_read_b64_tr_b16 v[24:25], v9 offset:32768
    ds_read_b64_tr_b16 v[26:27], v11 offset:32768
    ds_read_b64_tr_b16 v[28:29], v10 offset:32768
    ds_read_b64_tr_b16 v[30:31], v12 offset:32768
    s_waitcnt lgkmcnt(7)
    v_mfma_f32_32x32x16_bf16 v[128:143], v[160:163], v[20:23], v[128:143]
    s_waitcnt lgkmcnt(5)
    v_mfma_f32_32x32x16_bf16 v[144:159], v[164:167], v[20:23], v[144:159]
    ds_read_b128 v[20:23], v7 offset:3072
    ds_read_b64_tr_b16 v[160:161], v9 offset:49152
    ds_read_b64_tr_b16 v[162:163], v11 offset:49152
    ds_read_b64_tr_b16 v[164:165], v10 offset:49152
    ds_read_b64_tr_b16 v[166:167], v12 offset:49152
    s_waitcnt lgkmcnt(7)
    v_mfma_f32_32x32x16_bf16 v[128:143], v[24:27], v[16:19], v[128:143]
    s_waitcnt lgkmcnt(5)
    v_mfma_f32_32x32x16_bf16 v[144:159], v[28:31], v[16:19], v[144:159]
    v_add_u32 v9, 0x10000, v9
    v_add_u32 v10, 0x10000, v10
    v_add_u32 v11, 0x10000, v11
    v_add_u32 v12, 0x10000, v12
    ds_read_b128 v[16:19], v7 offset:4096
    ds_read_b64_tr_b16 v[24:25], v9 offset:0
    ds_read_b64_tr_b16 v[26:27], v11 offset:0
    ds_read_b64_tr_b16 v[28:29], v10 offset:0
    ds_read_b64_tr_b16 v[30:31], v12 offset:0
    s_waitcnt lgkmcnt(7)
    v_mfma_f32_32x32x16_bf16 v[128:143], v[160:163], v[20:23], v[128:143]
    s_waitcnt lgkmcnt(5)
    v_mfma_f32_32x32x16_bf16 v[144:159], v[164:167], v[20:23], v[144:159]
    s_barrier
    s_mov_b32 m0, s68
    s_add_u32 s68, s68, 8192
    buffer_load_dwordx4 v3, s[44:47], s61 offen nt lds
    s_add_u32 s61, s61, 8192
    s_mov_b32 m0, s68
    s_add_u32 s68, s68, 8192
    buffer_load_dwordx4 v15, s[44:47], s61 offen nt lds
    s_add_u32 s61, s61, 8192
    s_mov_b32 m0, s68
    s_add_u32 s68, s68, 8192
    buffer_load_dwordx4 v3, s[44:47], s61 offen nt lds
    s_add_u32 s61, s61, 8192
    s_mov_b32 m0, s68
    s_add_u32 s68, s68, 8192
    buffer_load_dwordx4 v15, s[44:47], s61 offen nt lds
    s_add_u32 s61, s61, 8192
    ds_read_b128 v[20:23], v7 offset:5120
    ds_read_b64_tr_b16 v[160:161], v9 offset:16384
    ds_read_b64_tr_b16 v[162:163], v11 offset:16384
    ds_read_b64_tr_b16 v[164:165], v10 offset:16384
    ds_read_b64_tr_b16 v[166:167], v12 offset:16384
    s_waitcnt lgkmcnt(7)
    v_mfma_f32_32x32x16_bf16 v[128:143], v[24:27], v[16:19], v[128:143]
    s_waitcnt lgkmcnt(5)
    v_mfma_f32_32x32x16_bf16 v[144:159], v[28:31], v[16:19], v[144:159]
    s_mov_b32 m0, s68
    s_add_u32 s68, s68, 8192
    buffer_load_dwordx4 v3, s[44:47], s61 offen nt lds
    s_add_u32 s61, s61, 8192
    s_mov_b32 m0, s68
    s_add_u32 s68, s68, 8192
    buffer_load_dwordx4 v15, s[44:47], s61 offen nt lds
    s_add_u32 s61, s61, 8192
    s_mov_b32 m0, s68
    s_add_u32 s68, s68, 8192
    buffer_load_dwordx4 v3, s[44:47], s61 offen nt lds
    s_add_u32 s61, s61, 8192
    s_mov_b32 m0, s68
    s_add_u32 s68, s68, 8192
    buffer_load_dwordx4 v15, s[44:47], s61 offen nt lds
    s_add_u32 s61, s61, 8192
    ds_read_b128 v[16:19], v7 offset:6144
    ds_read_b64_tr_b16 v[24:25], v9 offset:32768
    ds_read_b64_tr_b16 v[26:27], v11 offset:32768
    ds_read_b64_tr_b16 v[28:29], v10 offset:32768
    ds_read_b64_tr_b16 v[30:31], v12 offset:32768
    s_waitcnt lgkmcnt(7)
    v_mfma_f32_32x32x16_bf16 v[128:143], v[160:163], v[20:23], v[128:143]
    s_waitcnt lgkmcnt(5)
    v_mfma_f32_32x32x16_bf16 v[144:159], v[164:167], v[20:23], v[144:159]
    ds_read_b128 v[20:23], v7 offset:7168
    ds_read_b64_tr_b16 v[160:161], v9 offset:49152
    ds_read_b64_tr_b16 v[162:163], v11 offset:49152
    ds_read_b64_tr_b16 v[164:165], v10 offset:49152
    ds_read_b64_tr_b16 v[166:167], v12 offset:49152
    s_waitcnt lgkmcnt(7)
    v_mfma_f32_32x32x16_bf16 v[128:143], v[24:27], v[16:19], v[128:143]
    s_waitcnt lgkmcnt(5)
    v_mfma_f32_32x32x16_bf16 v[144:159], v[28:31], v[16:19], v[144:159]
    s_waitcnt lgkmcnt(2)
    v_mfma_f32_32x32x16_bf16 v[128:143], v[160:163], v[20:23], v[128:143]
    s_waitcnt lgkmcnt(0)
    v_mfma_f32_32x32x16_bf16 v[144:159], v[164:167], v[20:23], v[144:159]
    v_add_u32 v9, 0xffff0000, v9
    v_add_u32 v10, 0xffff0000, v10
    v_add_u32 v11, 0xffff0000, v11
    v_add_u32 v12, 0xffff0000, v12
    s_lshl_b32 s7, s3, 10
    s_add_u32 s7, s7, 0x10000
    v_lshl_add_u32 v3, v1, 4, s7
    s_waitcnt vmcnt(8)
    s_barrier
    ds_write_b128 v3, v[96:99] offset:0
    ds_write_b128 v3, v[100:103] offset:8192
    ds_write_b128 v3, v[104:107] offset:16384
    ds_write_b128 v3, v[108:111] offset:24576
    ds_write_b128 v3, v[112:115] offset:32768
    ds_write_b128 v3, v[116:119] offset:40960
    ds_write_b128 v3, v[120:123] offset:49152
    ds_write_b128 v3, v[124:127] offset:57344
    s_waitcnt lgkmcnt(0)
    s_barrier
    v_xor_b32 v160, 0x0, v2
    ds_read_b128 v[24:27], v160
    v_xor_b32 v161, 0x10, v2
    ds_read_b128 v[28:31], v161
    v_xor_b32 v162, 0x20, v2
    ds_read_b128 v[164:167], v162
    v_xor_b32 v160, 0x30, v2
    ds_read_b128 v[96:99], v160
    v_xor_b32 v161, 0x40, v2
    ds_read_b128 v[100:103], v161
    v_xor_b32 v162, 0x50, v2
    ds_read_b128 v[104:107], v162
    v_xor_b32 v160, 0x60, v2
    ds_read_b128 v[108:111], v160
    s_waitcnt lgkmcnt(6)
    v_mfma_f32_16x16x32_bf16 v[20:23], v[24:27], v[32:35], 0
    v_xor_b32 v161, 0x70, v2
    ds_read_b128 v[24:27], v161
    s_waitcnt lgkmcnt(6)
    v_mfma_f32_16x16x32_bf16 v[20:23], v[28:31], v[36:39], v[20:23]
    v_xor_b32 v162, 0x80, v2
    ds_read_b128 v[28:31], v162
    s_waitcnt lgkmcnt(6)
    v_mfma_f32_16x16x32_bf16 v[20:23], v[164:167], v[40:43], v[20:23]
    v_xor_b32 v160, 0x90, v2
    ds_read_b128 v[164:167], v160
    s_waitcnt lgkmcnt(6)
    v_mfma_f32_16x16x32_bf16 v[20:23], v[96:99], v[44:47], v[20:23]
    v_xor_b32 v161, 0xa0, v2
    ds_read_b128 v[96:99], v161
    s_waitcnt lgkmcnt(6)
    v_mfma_f32_16x16x32_bf16 v[20:23], v[100:103], v[48:51], v[20:23]
    v_xor_b32 v162, 0xb0, v2
    ds_read_b128 v[100:103], v162
    s_waitcnt lgkmcnt(6)
    v_mfma_f32_16x16x32_bf16 v[20:23], v[104:107], v[52:55], v[20:23]
    v_xor_b32 v160, 0xc0, v2
    ds_read_b128 v[104:107], v160
    s_waitcnt lgkmcnt(6)
    v_mfma_f32_16x16x32_bf16 v[20:23], v[108:111], v[56:59], v[20:23]
    v_xor_b32 v161, 0xd0, v2
    ds_read_b128 v[108:111], v161
    s_waitcnt lgkmcnt(6)
    v_mfma_f32_16x16x32_bf16 v[20:23], v[24:27], v[60:63], v[20:23]
    v_xor_b32 v162, 0xe0, v2
    ds_read_b128 v[24:27], v162
    s_waitcnt lgkmcnt(6)
    v_mfma_f32_16x16x32_bf16 v[20:23], v[28:31], v[64:67], v[20:23]
    v_xor_b32 v160, 0xf0, v2
    ds_read_b128 v[28:31], v160
    s_waitcnt lgkmcnt(6)
    v_mfma_f32_16x16x32_bf16 v[20:23], v[164:167], v[68:71], v[20:23]
    s_waitcnt lgkmcnt(5)
    v_mfma_f32_16x16x32_bf16 v[20:23], v[96:99], v[72:75], v[20:23]
    s_waitcnt lgkmcnt(4)
    v_mfma_f32_16x16x32_bf16 v[20:23], v[100:103], v[76:79], v[20:23]
    s_waitcnt lgkmcnt(3)
    v_mfma_f32_16x16x32_bf16 v[20:23], v[104:107], v[80:83], v[20:23]
    s_waitcnt lgkmcnt(2)
    v_mfma_f32_16x16x32_bf16 v[20:23], v[108:111], v[84:87], v[20:23]
    s_waitcnt lgkmcnt(1)
    v_mfma_f32_16x16x32_bf16 v[20:23], v[24:27], v[88:91], v[20:23]
    s_waitcnt lgkmcnt(0)
    v_mfma_f32_16x16x32_bf16 v[20:23], v[28:31], v[92:95], v[20:23]
    s_waitcnt vmcnt(0)
    s_barrier
    v_xor_b32 v160, 0x0, v4
    ds_read_b128 v[24:27], v160
    v_xor_b32 v161, 0x10, v4
    ds_read_b128 v[28:31], v161
    v_xor_b32 v162, 0x20, v4
    ds_read_b128 v[164:167], v162
    v_xor_b32 v160, 0x30, v4
    ds_read_b128 v[96:99], v160
    v_xor_b32 v161, 0x40, v4
    ds_read_b128 v[100:103], v161
    v_xor_b32 v162, 0x50, v4
    ds_read_b128 v[104:107], v162
    v_xor_b32 v160, 0x60, v4
    ds_read_b128 v[108:111], v160
    s_waitcnt lgkmcnt(6)
    v_mfma_f32_16x16x32_bf16 v[16:19], v[24:27], v[32:35], 0
    v_xor_b32 v161, 0x70, v4
    ds_read_b128 v[24:27], v161
    s_waitcnt lgkmcnt(6)
    v_mfma_f32_16x16x32_bf16 v[16:19], v[28:31], v[36:39], v[16:19]
    v_xor_b32 v162, 0x80, v4
    ds_read_b128 v[28:31], v162
    s_waitcnt lgkmcnt(6)
    v_mfma_f32_16x16x32_bf16 v[16:19], v[164:167], v[40:43], v[16:19]
    v_xor_b32 v160, 0x90, v4
    ds_read_b128 v[164:167], v160
    s_waitcnt lgkmcnt(6)
    v_mfma_f32_16x16x32_bf16 v[16:19], v[96:99], v[44:47], v[16:19]
    v_xor_b32 v161, 0xa0, v4
    ds_read_b128 v[96:99], v161
    s_waitcnt lgkmcnt(6)
    v_mfma_f32_16x16x32_bf16 v[16:19], v[100:103], v[48:51], v[16:19]
    v_xor_b32 v162, 0xb0, v4
    ds_read_b128 v[100:103], v162
    s_waitcnt lgkmcnt(6)
    v_mfma_f32_16x16x32_bf16 v[16:19], v[104:107], v[52:55], v[16:19]
    v_xor_b32 v160, 0xc0, v4
    ds_read_b128 v[104:107], v160
    s_waitcnt lgkmcnt(6)
    v_mfma_f32_16x16x32_bf16 v[16:19], v[108:111], v[56:59], v[16:19]
    v_xor_b32 v161, 0xd0, v4
    ds_read_b128 v[108:111], v161
    s_waitcnt lgkmcnt(6)
    v_mfma_f32_16x16x32_bf16 v[16:19], v[24:27], v[60:63], v[16:19]
    v_xor_b32 v162, 0xe0, v4
    ds_read_b128 v[24:27], v162
    s_waitcnt lgkmcnt(6)
    v_mfma_f32_16x16x32_bf16 v[16:19], v[28:31], v[64:67], v[16:19]
    v_xor_b32 v160, 0xf0, v4
    ds_read_b128 v[28:31], v160
    s_waitcnt lgkmcnt(6)
    v_mfma_f32_16x16x32_bf16 v[16:19], v[164:167], v[68:71], v[16:19]
    s_waitcnt lgkmcnt(5)
    v_mfma_f32_16x16x32_bf16 v[16:19], v[96:99], v[72:75], v[16:19]
    s_waitcnt lgkmcnt(4)
    v_mfma_f32_16x16x32_bf16 v[16:19], v[100:103], v[76:79], v[16:19]
    s_waitcnt lgkmcnt(3)
    v_mfma_f32_16x16x32_bf16 v[16:19], v[104:107], v[80:83], v[16:19]
    s_waitcnt lgkmcnt(2)
    v_mfma_f32_16x16x32_bf16 v[16:19], v[108:111], v[84:87], v[16:19]
    s_waitcnt lgkmcnt(1)
    v_mfma_f32_16x16x32_bf16 v[16:19], v[24:27], v[88:91], v[16:19]
    s_waitcnt lgkmcnt(0)
    v_mfma_f32_16x16x32_bf16 v[16:19], v[28:31], v[92:95], v[16:19]
    s_nop 7
    v_max3_f32 v160, v16, v17, v18
    v_max3_f32 v160, v160, v19, v20
    v_max3_f32 v160, v160, v21, v22
    v_max_f32 v160, v160, v23
    v_mov_b32 v161, v160
    s_nop 1
    v_permlane32_swap_b32 v160, v161
    v_max_f32 v160, v160, v161
    v_mov_b32 v161, v160
    s_nop 1
    v_permlane16_swap_b32 v160, v161
    v_max_f32 v160, v160, v161
    s_lshl_b32 s7, s64, 7
    v_add_u32 v161, s7, v5
    s_mov_b64 exec, s[86:87]
    ds_write_b32 v161, v160
    s_mov_b64 exec, -1
    s_waitcnt lgkmcnt(0)
    s_barrier
    ds_read_b32 v160, v5 offset:0
    ds_read_b32 v161, v5 offset:128
    ds_read_b32 v162, v5 offset:256
    ds_read_b32 v163, v5 offset:384
    s_waitcnt lgkmcnt(0)
    v_max3_f32 v160, v160, v161, v162
    v_max_f32 v160, v160, v163
    v_mul_f32 v160, s67, v160
    v_max_f32 v160, v160, v13
    v_sub_f32 v161, v13, v160
    v_exp_f32 v161, v161
    v_mov_b32 v13, v160
    v_fma_f32 v16, v16, s67, -v160
    v_fma_f32 v17, v17, s67, -v160
    v_fma_f32 v18, v18, s67, -v160
    v_fma_f32 v19, v19, s67, -v160
    v_fma_f32 v20, v20, s67, -v160
    v_fma_f32 v21, v21, s67, -v160
    v_fma_f32 v22, v22, s67, -v160
    v_fma_f32 v23, v23, s67, -v160
    v_exp_f32 v16, v16
    v_exp_f32 v17, v17
    v_exp_f32 v18, v18
    v_exp_f32 v19, v19
    v_exp_f32 v20, v20
    v_exp_f32 v21, v21
    v_exp_f32 v22, v22
    v_exp_f32 v23, v23
    v_cvt_pk_bf16_f32 v24, v16, v17
    v_cvt_pk_bf16_f32 v25, v18, v19
    v_cvt_pk_bf16_f32 v26, v20, v21
    v_cvt_pk_bf16_f32 v27, v22, v23
    ds_write_b64 v6, v[24:25]
    ds_write_b64 v6, v[26:27] offset:4096
    v_add_u32 v162, 0xc00, v5
    s_mov_b64 exec, s[88:89]
    ds_write_b32 v162, v161
    s_mov_b64 exec, -1
    v_mul_f32 v14, v14, v161
    v_add_f32 v16, v16, v20
    v_add_f32 v17, v17, v21
    v_add_f32 v18, v18, v22
    v_add_f32 v19, v19, v23
    v_add_f32 v16, v16, v18
    v_add_f32 v17, v17, v19
    v_add_f32 v16, v16, v17
    v_add_f32 v14, v14, v16
    v_mov_b32 v160, v14
    s_nop 1
    v_permlane32_swap_b32 v14, v160
    v_add_f32 v14, v14, v160
    v_mov_b32 v160, v14
    s_nop 1
    v_permlane16_swap_b32 v14, v160
    v_add_f32 v14, v14, v160
    s_lshl_b32 s7, s64, 7
    s_add_u32 s7, s7, 0x200
    v_add_u32 v161, s7, v5
    v_add_u32 v162, 0xc80, v5
    s_mov_b64 exec, s[86:87]
    ds_write_b32 v161, v14
    s_mov_b64 exec, s[88:89]
    ds_write_b32 v162, v13
    s_mov_b64 exec, -1
    v_and_b32 v160, 31, v1
    v_lshlrev_b32 v98, 7, v160
    v_lshrrev_b32 v161, 5, v1
    v_and_b32 v160, 7, v1
    v_xor_b32 v161, v160, v161
    v_lshl_add_u32 v98, v161, 4, v98
    s_lshl_b32 s7, s3, 12
    v_add_u32 v98, s7, v98
    v_lshl_add_u32 v99, v1, 4, s7
    v_lshrrev_b32 v161, 3, v1
    v_xor_b32 v160, v160, v161
    v_lshlrev_b32 v100, 7, v161
    v_lshl_add_u32 v100, v160, 4, v100
    s_lshl_b32 s69, s60, 15
    s_add_u32 s69, s69, s7
    s_add_u32 s69, s69, 0x500000
    s_waitcnt lgkmcnt(0)
    s_barrier
    ds_read_b32 v15, v8
    ds_read_b128 v[16:19], v7 offset:0
    ds_read_b64_tr_b16 v[24:25], v9 offset:0
    ds_read_b64_tr_b16 v[26:27], v11 offset:0
    ds_read_b64_tr_b16 v[28:29], v10 offset:0
    ds_read_b64_tr_b16 v[30:31], v12 offset:0
    s_waitcnt lgkmcnt(5)
    v_mul_f32 v128, v15, v128
    v_mul_f32 v129, v15, v129
    v_mul_f32 v130, v15, v130
    v_mul_f32 v131, v15, v131
    v_mul_f32 v132, v15, v132
    v_mul_f32 v133, v15, v133
    v_mul_f32 v134, v15, v134
    v_mul_f32 v135, v15, v135
    v_mul_f32 v136, v15, v136
    v_mul_f32 v137, v15, v137
    v_mul_f32 v138, v15, v138
    v_mul_f32 v139, v15, v139
    v_mul_f32 v140, v15, v140
    v_mul_f32 v141, v15, v141
    v_mul_f32 v142, v15, v142
    v_mul_f32 v143, v15, v143
    v_mul_f32 v144, v15, v144
    v_mul_f32 v145, v15, v145
    v_mul_f32 v146, v15, v146
    v_mul_f32 v147, v15, v147
    v_mul_f32 v148, v15, v148
    v_mul_f32 v149, v15, v149
    v_mul_f32 v150, v15, v150
    v_mul_f32 v151, v15, v151
    v_mul_f32 v152, v15, v152
    v_mul_f32 v153, v15, v153
    v_mul_f32 v154, v15, v154
    v_mul_f32 v155, v15, v155
    v_mul_f32 v156, v15, v156
    v_mul_f32 v157, v15, v157
    v_mul_f32 v158, v15, v158
    v_mul_f32 v159, v15, v159
    ds_read_b128 v[20:23], v7 offset:1024
    ds_read_b64_tr_b16 v[160:161], v9 offset:16384
    ds_read_b64_tr_b16 v[162:163], v11 offset:16384
    ds_read_b64_tr_b16 v[164:165], v10 offset:16384
    ds_read_b64_tr_b16 v[166:167], v12 offset:16384
    s_waitcnt lgkmcnt(7)
    v_mfma_f32_32x32x16_bf16 v[128:143], v[24:27], v[16:19], v[128:143]
    s_waitcnt lgkmcnt(5)
    v_mfma_f32_32x32x16_bf16 v[144:159], v[28:31], v[16:19], v[144:159]
    ds_read_b128 v[16:19], v7 offset:2048
    ds_read_b64_tr_b16 v[24:25], v9 offset:32768
    ds_read_b64_tr_b16 v[26:27], v11 offset:32768
    ds_read_b64_tr_b16 v[28:29], v10 offset:32768
    ds_read_b64_tr_b16 v[30:31], v12 offset:32768
    s_waitcnt lgkmcnt(7)
    v_mfma_f32_32x32x16_bf16 v[128:143], v[160:163], v[20:23], v[128:143]
    s_waitcnt lgkmcnt(5)
    v_mfma_f32_32x32x16_bf16 v[144:159], v[164:167], v[20:23], v[144:159]
    ds_read_b128 v[20:23], v7 offset:3072
    ds_read_b64_tr_b16 v[160:161], v9 offset:49152
    ds_read_b64_tr_b16 v[162:163], v11 offset:49152
    ds_read_b64_tr_b16 v[164:165], v10 offset:49152
    ds_read_b64_tr_b16 v[166:167], v12 offset:49152
    s_waitcnt lgkmcnt(7)
    v_mfma_f32_32x32x16_bf16 v[128:143], v[24:27], v[16:19], v[128:143]
    s_waitcnt lgkmcnt(5)
    v_mfma_f32_32x32x16_bf16 v[144:159], v[28:31], v[16:19], v[144:159]
    v_add_u32 v9, 0x10000, v9
    v_add_u32 v10, 0x10000, v10
    v_add_u32 v11, 0x10000, v11
    v_add_u32 v12, 0x10000, v12
    ds_read_b128 v[16:19], v7 offset:4096
    ds_read_b64_tr_b16 v[24:25], v9 offset:0
    ds_read_b64_tr_b16 v[26:27], v11 offset:0
    ds_read_b64_tr_b16 v[28:29], v10 offset:0
    ds_read_b64_tr_b16 v[30:31], v12 offset:0
    s_waitcnt lgkmcnt(7)
    v_mfma_f32_32x32x16_bf16 v[128:143], v[160:163], v[20:23], v[128:143]
    s_waitcnt lgkmcnt(5)
    v_mfma_f32_32x32x16_bf16 v[144:159], v[164:167], v[20:23], v[144:159]
    s_barrier
    ds_read_b128 v[20:23], v7 offset:5120
    ds_read_b64_tr_b16 v[160:161], v9 offset:16384
    ds_read_b64_tr_b16 v[162:163], v11 offset:16384
    ds_read_b64_tr_b16 v[164:165], v10 offset:16384
    ds_read_b64_tr_b16 v[166:167], v12 offset:16384
    s_waitcnt lgkmcnt(7)
    v_mfma_f32_32x32x16_bf16 v[128:143], v[24:27], v[16:19], v[128:143]
    s_waitcnt lgkmcnt(5)
    v_mfma_f32_32x32x16_bf16 v[144:159], v[28:31], v[16:19], v[144:159]
    ds_read_b128 v[16:19], v7 offset:6144
    ds_read_b64_tr_b16 v[24:25], v9 offset:32768
    ds_read_b64_tr_b16 v[26:27], v11 offset:32768
    ds_read_b64_tr_b16 v[28:29], v10 offset:32768
    ds_read_b64_tr_b16 v[30:31], v12 offset:32768
    s_waitcnt lgkmcnt(7)
    v_mfma_f32_32x32x16_bf16 v[128:143], v[160:163], v[20:23], v[128:143]
    s_waitcnt lgkmcnt(5)
    v_mfma_f32_32x32x16_bf16 v[144:159], v[164:167], v[20:23], v[144:159]
    ds_read_b128 v[20:23], v7 offset:7168
    ds_read_b64_tr_b16 v[160:161], v9 offset:49152
    ds_read_b64_tr_b16 v[162:163], v11 offset:49152
    ds_read_b64_tr_b16 v[164:165], v10 offset:49152
    ds_read_b64_tr_b16 v[166:167], v12 offset:49152
    s_waitcnt lgkmcnt(7)
    v_mfma_f32_32x32x16_bf16 v[128:143], v[24:27], v[16:19], v[128:143]
    s_waitcnt lgkmcnt(5)
    v_mfma_f32_32x32x16_bf16 v[144:159], v[28:31], v[16:19], v[144:159]
    s_waitcnt lgkmcnt(2)
    v_mfma_f32_32x32x16_bf16 v[128:143], v[160:163], v[20:23], v[128:143]
    s_waitcnt lgkmcnt(0)
    v_mfma_f32_32x32x16_bf16 v[144:159], v[164:167], v[20:23], v[144:159]
    s_nop 9
    v_permlane32_swap_b32 v128, v132
    v_permlane32_swap_b32 v129, v133
    v_permlane32_swap_b32 v130, v134
    v_permlane32_swap_b32 v131, v135
    v_cvt_pk_bf16_f32 v16, v128, v129
    v_cvt_pk_bf16_f32 v17, v130, v131
    v_cvt_pk_bf16_f32 v18, v132, v133
    v_cvt_pk_bf16_f32 v19, v134, v135
    v_xor_b32 v160, 0x0, v98
    ds_write_b128 v160, v[16:19]
    v_permlane32_swap_b32 v136, v140
    v_permlane32_swap_b32 v137, v141
    v_permlane32_swap_b32 v138, v142
    v_permlane32_swap_b32 v139, v143
    v_cvt_pk_bf16_f32 v20, v136, v137
    v_cvt_pk_bf16_f32 v21, v138, v139
    v_cvt_pk_bf16_f32 v22, v140, v141
    v_cvt_pk_bf16_f32 v23, v142, v143
    v_xor_b32 v161, 0x20, v98
    ds_write_b128 v161, v[20:23]
    v_permlane32_swap_b32 v144, v148
    v_permlane32_swap_b32 v145, v149
    v_permlane32_swap_b32 v146, v150
    v_permlane32_swap_b32 v147, v151
    v_cvt_pk_bf16_f32 v24, v144, v145
    v_cvt_pk_bf16_f32 v25, v146, v147
    v_cvt_pk_bf16_f32 v26, v148, v149
    v_cvt_pk_bf16_f32 v27, v150, v151
    v_xor_b32 v160, 0x40, v98
    ds_write_b128 v160, v[24:27]
    v_permlane32_swap_b32 v152, v156
    v_permlane32_swap_b32 v153, v157
    v_permlane32_swap_b32 v154, v158
    v_permlane32_swap_b32 v155, v159
    v_cvt_pk_bf16_f32 v28, v152, v153
    v_cvt_pk_bf16_f32 v29, v154, v155
    v_cvt_pk_bf16_f32 v30, v156, v157
    v_cvt_pk_bf16_f32 v31, v158, v159
    v_xor_b32 v161, 0x60, v98
    ds_write_b128 v161, v[28:31]
    ds_read_b128 v[32:35], v99 offset:0
    ds_read_b128 v[36:39], v99 offset:1024
    ds_read_b128 v[40:43], v99 offset:2048
    ds_read_b128 v[44:47], v99 offset:3072
    s_waitcnt lgkmcnt(3)
    buffer_store_dwordx4 v[32:35], v100, s[36:39], s69 offen offset:0 sc1
    s_waitcnt lgkmcnt(2)
    buffer_store_dwordx4 v[36:39], v100, s[36:39], s69 offen offset:1024 sc1
    s_waitcnt lgkmcnt(1)
    buffer_store_dwordx4 v[40:43], v100, s[36:39], s69 offen offset:2048 sc1
    s_waitcnt lgkmcnt(0)
    buffer_store_dwordx4 v[44:47], v100, s[36:39], s69 offen offset:3072 sc1
    v_mov_b32 v160, 0x2404c
    s_mov_b32 s80, 1600000
LW_90:
    ds_read_b32 v161, v160
    s_waitcnt lgkmcnt(0)
    v_readfirstlane_b32 s79, v161
    s_cmp_ge_u32 s79, 1
    s_cbranch_scc1 LWD_91
    s_sleep 2
    s_sub_u32 s80, s80, 1
    s_cmp_lg_u32 s80, 0
    s_cbranch_scc1 LW_90
LWD_91:
    v_mov_b32 v160, 0x24050
    ds_read_b64 v[162:163], v160
    s_waitcnt lgkmcnt(0)
    v_readfirstlane_b32 s94, v162
    v_readfirstlane_b32 s95, v163
    v_and_b32 v160, 31, v1
    v_lshlrev_b32 v3, 2, v160
    v_add_u32 v3, 0x27400, v3
    s_lshl_b32 s7, s60, 9
    s_add_u32 s7, s7, 0xe0000
    s_cmp_eq_u32 s3, 0
    s_cselect_b32 s7, s7, 0x40000000
    v_lshl_add_u32 v4, v160, 4, s7
    v_mov_b32 v22, s94
    v_mov_b32 v23, s95
    ds_read_b32 v16, v3 offset:0
    ds_read_b32 v17, v3 offset:128
    ds_read_b32 v18, v3 offset:256
    ds_read_b32 v19, v3 offset:384
    ds_read_b32 v20, v3 offset:2688
    s_waitcnt lgkmcnt(0)
    v_add_f32 v16, v16, v17
    v_add_f32 v18, v18, v19
    v_add_f32 v21, v16, v18
    s_waitcnt vmcnt(0)
    s_barrier
    s_mov_b64 exec, 0xffffffff
    buffer_store_dwordx4 v[20:23], v4, s[36:39], 0 offen sc1
    s_mov_b64 exec, -1
    v_lshlrev_b32 v2, 4, v1
    s_mov_b32 s44, s12
    s_and_b32 s45, s13, 0xffff
    s_mov_b32 s46, 0x8000000
    s_mov_b32 s47, 0x20000
    s_bfe_u32 s7, s5, 0x10002
    s_lshl_b32 s7, s7, 6
    s_add_u32 s7, s7, s6
    s_lshl_b32 s7, s7, 20
    s_lshl_b32 s72, s3, 10
    s_add_u32 s72, s72, s7
    s_add_u32 s72, s72, 1040384
    s_add_u32 s73, s72, 0x2000000
    s_mov_b32 s74, 4
    s_sleep 60
PV_92:
    s_waitcnt vmcnt(3)
    buffer_load_dwordx4 v[8:11], v2, s[44:47], s72 offen
    s_sub_u32 s72, s72, 8192
    s_waitcnt vmcnt(3)
    buffer_load_dwordx4 v[8:11], v2, s[44:47], s73 offen
    s_sub_u32 s73, s73, 8192
    s_sub_u32 s74, s74, 1
    s_cmp_lg_u32 s74, 0
    s_cbranch_scc1 PV_92
    s_mov_b32 s52, s30
    s_and_b32 s53, s31, 0xffff
    s_mov_b32 s54, 0x2000
    s_mov_b32 s55, 0x20000
    s_lshl_b32 s7, s60, 3
    s_add_u32 s7, s7, s3
    s_lshl_b32 s7, s7, 10
    s_add_u32 s7, s7, 0x100000
    v_add_u32 v4, s7, v2
    s_bfe_u32 s7, s60, 0x20003
    s_lshl_b32 s7, s7, 11
    s_lshr_b32 s66, s60, 5
    s_lshl_b32 s66, s66, 10
    s_add_u32 s7, s7, s66
    s_and_b32 s66, s60, 7
    s_lshl_b32 s66, s66, 7
    s_add_u32 s7, s7, s66
    v_and_b32 v5, 7, v1
    v_lshl_add_u32 v5, v5, 4, s7
    v_lshrrev_b32 v6, 4, v1
    v_lshl_add_u32 v5, v6, 2, v5
    s_mov_b32 s90, 0x00ff00ff
    s_mov_b32 s91, 0x00ff00ff
    s_lshl_b32 s7, s3, 10
    s_add_u32 s7, s7, 0x25200
    v_add_u32 v6, s7, v2
    s_mov_b32 s80, 200000
PO_93:
    buffer_load_dwordx4 v[32:35], v4, s[36:39], 0 offen sc1
PO2_94:
    s_waitcnt vmcnt(0)
    v_cmp_ne_u64 vcc, s[94:95], v[34:35]
    s_cmp_lg_u64 vcc, -1
    s_cbranch_scc1 POD_95
    s_sleep 20
    s_sub_u32 s80, s80, 1
    s_cmp_lg_u32 s80, 0
    s_cbranch_scc1 PO_93
POD_95:
    v_lshlrev_b32 v64, 16, v32
    v_and_b32 v65, 0xffff0000, v32
    v_lshlrev_b32 v66, 16, v33
    v_and_b32 v67, 0xffff0000, v33
    s_cbranch_vccz RD_96
    buffer_load_dwordx4 v[32:35], v4, s[36:39], 0 offen sc1
    s_sleep 4
    buffer_load_dwordx4 v[36:39], v4, s[36:39], 0 offen sc1
    s_sleep 4
    s_mov_b32 s80, 200000
PP_97:
    s_waitcnt vmcnt(1)
    v_cmp_ne_u64 vcc, s[94:95], v[34:35]
    s_cmp_eq_u64 vcc, 0
    s_cbranch_scc1 PPO_99
    buffer_load_dwordx4 v[32:35], v4, s[36:39], 0 offen sc1
    s_waitcnt vmcnt(1)
    v_cmp_ne_u64 vcc, s[94:95], v[38:39]
    s_cmp_eq_u64 vcc, 0
    s_cbranch_scc1 PPO_100
    buffer_load_dwordx4 v[36:39], v4, s[36:39], 0 offen sc1
    s_sub_u32 s80, s80, 1
    s_cmp_lg_u32 s80, 0
    s_cbranch_scc1 PP_97
PPO_99:
    v_lshlrev_b32 v64, 16, v32
    v_and_b32 v65, 0xffff0000, v32
    v_lshlrev_b32 v66, 16, v33
    v_and_b32 v67, 0xffff0000, v33
    s_branch PPD_98
PPO_100:
    v_lshlrev_b32 v64, 16, v36
    v_and_b32 v65, 0xffff0000, v36
    v_lshlrev_b32 v66, 16, v37
    v_and_b32 v67, 0xffff0000, v37
PPD_98:
RD_96:
    ds_write_b128 v6, v[64:67]
    s_waitcnt lgkmcnt(0)
    s_barrier
    s_cmp_lg_u32 s3, 0
    s_cbranch_scc1 L_END
    ds_read_b128 v[64:67], v6 offset:0
    ds_read_b128 v[68:71], v6 offset:1024
    ds_read_b128 v[72:75], v6 offset:2048
    ds_read_b128 v[76:79], v6 offset:3072
    ds_read_b128 v[80:83], v6 offset:4096
    ds_read_b128 v[84:87], v6 offset:5120
    ds_read_b128 v[88:91], v6 offset:6144
    ds_read_b128 v[92:95], v6 offset:7168
    s_waitcnt lgkmcnt(4)
    v_pk_add_f32 v[64:65], v[64:65], v[72:73]
    v_pk_add_f32 v[66:67], v[66:67], v[74:75]
    v_pk_add_f32 v[68:69], v[68:69], v[76:77]
    v_pk_add_f32 v[70:71], v[70:71], v[78:79]
    v_pk_add_f32 v[64:65], v[64:65], v[68:69]
    v_pk_add_f32 v[66:67], v[66:67], v[70:71]
    s_waitcnt lgkmcnt(0)
    v_pk_add_f32 v[80:81], v[80:81], v[88:89]
    v_pk_add_f32 v[82:83], v[82:83], v[90:91]
    v_pk_add_f32 v[84:85], v[84:85], v[92:93]
    v_pk_add_f32 v[86:87], v[86:87], v[94:95]
    v_pk_add_f32 v[80:81], v[80:81], v[84:85]
    v_pk_add_f32 v[82:83], v[82:83], v[86:87]
    s_nop 0
    v_permlane32_swap_b32 v64, v80
    v_permlane32_swap_b32 v65, v81
    v_permlane32_swap_b32 v66, v82
    v_permlane32_swap_b32 v67, v83
    v_add_f32 v64, v64, v80
    v_add_f32 v65, v65, v81
    v_add_f32 v66, v66, v82
    v_add_f32 v67, v67, v83
    s_nop 0
    v_permlane16_swap_b32 v64, v66
    v_permlane16_swap_b32 v65, v67
    v_add_f32 v64, v64, v66
    v_add_f32 v65, v65, v67
    s_nop 0
    v_add_f32_dpp v64, v64, v64 row_ror:8 row_mask:0xf bank_mask:0xf
    v_add_f32_dpp v65, v65, v65 row_ror:8 row_mask:0xf bank_mask:0xf
    v_cvt_pk_bf16_f32 v8, v64, v65
    s_mov_b64 exec, s[90:91]
    buffer_store_dword v8, v5, s[52:55], 0 offen
    s_mov_b64 exec, -1
    s_endpgm
L_CSVC:
    v_and_b32 v1, 63, v0
    s_and_b32 s7, s5, 3
    s_lshl_b32 s6, s4, 2
    s_add_u32 s6, s6, s7
    s_mov_b32 s92, 0x05040100
    s_mov_b32 s93, 0x07060302
    s_cmp_lg_u32 s3, 11
    s_cbranch_scc1 Z_101
    v_lshlrev_b32 v2, 2, v1
    v_add_u32 v2, 0x24000, v2
    v_mov_b32 v3, 0
    ds_write_b32 v2, v3
Z_101:
    s_waitcnt lgkmcnt(0)
    s_mov_b32 s36, s34
    s_and_b32 s37, s35, 0xffff
    s_mov_b32 s38, 0x1000000
    s_mov_b32 s39, 0x20000
    s_mov_b32 s40, s32
    s_and_b32 s41, s33, 0xffff
    s_mov_b32 s42, 0x100
    s_mov_b32 s43, 0x20000
    s_setprio 3
    s_sub_u32 s60, s3, 8
    s_lshl_b32 s64, s4, 3
    s_add_u32 s64, s64, s5
    s_sub_u32 s64, s64, 8
    v_lshlrev_b32 v2, 4, v1
    s_barrier
    s_cmp_lg_u32 s60, 0
    s_cbranch_scc1 C8_102
    s_sleep 24
    v_mov_b32 v160, 0
    s_mov_b32 s80, 200000
NG_103:
    s_mov_b64 exec, 1
    buffer_load_dwordx2 v[162:163], v160, s[40:43], 0 offen sc1
    s_mov_b64 exec, -1
    s_waitcnt vmcnt(0)
    v_readfirstlane_b32 s94, v162
    v_readfirstlane_b32 s95, v163
    s_cmp_lg_u32 s95, 0
    s_cbranch_scc1 NGD_104
    s_sleep 4
    s_sub_u32 s80, s80, 1
    s_cmp_lg_u32 s80, 0
    s_cbranch_scc1 NG_103
NGD_104:
    v_mov_b32 v160, 0x24050
    v_mov_b32 v162, s94
    v_mov_b32 v163, s95
    ds_write_b64 v160, v[162:163]
    v_mov_b32 v160, 0x2404c
    v_mov_b32 v161, 1
    s_waitcnt lgkmcnt(0)
    s_mov_b64 exec, 1
    ds_add_u32 v160, v161
    s_mov_b64 exec, -1
C8_102:
    s_lshr_b32 s7, s64, 4
    s_lshl_b32 s7, s7, 16
    s_lshl_b32 s63, s60, 14
    s_add_u32 s7, s7, s63
    s_add_u32 s7, s7, 0x0
    v_lshl_add_u32 v4, v1, 4, s7
    s_and_b32 s7, s60, 1
    s_lshl_b32 s7, s7, 7
    v_lshlrev_b32 v3, 3, v1
    v_xor_b32 v3, s7, v3
    s_lshl_b32 s7, s60, 13
    s_add_u32 s7, s7, 0x18000
    v_add_u32 v3, s7, v3
    v_mov_b32 v160, 0x2404c
    s_mov_b32 s80, 1600000
LW_105:
    ds_read_b32 v161, v160
    s_waitcnt lgkmcnt(0)
    v_readfirstlane_b32 s79, v161
    s_cmp_ge_u32 s79, 1
    s_cbranch_scc1 LWD_106
    s_sleep 4
    s_sub_u32 s80, s80, 1
    s_cmp_lg_u32 s80, 0
    s_cbranch_scc1 LW_105
LWD_106:
    v_mov_b32 v160, 0x24050
    ds_read_b64 v[162:163], v160
    s_waitcnt lgkmcnt(0)
    v_readfirstlane_b32 s94, v162
    v_readfirstlane_b32 s95, v163
    v_mov_b32 v160, 0x24018
    s_mov_b32 s80, 1600000
LW_107:
    ds_read_b32 v161, v160
    s_waitcnt lgkmcnt(0)
    v_readfirstlane_b32 s79, v161
    s_cmp_ge_u32 s79, 8
    s_cbranch_scc1 LWD_108
    s_sleep 2
    s_sub_u32 s80, s80, 1
    s_cmp_lg_u32 s80, 0
    s_cbranch_scc1 LW_107
LWD_108:
    s_sleep 1
    s_mov_b32 s67, 4096
    s_mov_b32 s68, 8192
    s_mov_b32 s69, 12288
    buffer_load_dwordx4 v[96:99], v4, s[36:39], 0 offen offset:0 sc1
    buffer_load_dwordx4 v[100:103], v4, s[36:39], 0 offen offset:1024 sc1
    buffer_load_dwordx4 v[104:107], v4, s[36:39], 0 offen offset:2048 sc1
    buffer_load_dwordx4 v[108:111], v4, s[36:39], 0 offen offset:3072 sc1
    buffer_load_dwordx4 v[112:115], v4, s[36:39], s67 offen offset:0 sc1
    buffer_load_dwordx4 v[116:119], v4, s[36:39], s67 offen offset:1024 sc1
    buffer_load_dwordx4 v[120:123], v4, s[36:39], s67 offen offset:2048 sc1
    buffer_load_dwordx4 v[124:127], v4, s[36:39], s67 offen offset:3072 sc1
    buffer_load_dwordx4 v[128:131], v4, s[36:39], s68 offen offset:0 sc1
    buffer_load_dwordx4 v[132:135], v4, s[36:39], s68 offen offset:1024 sc1
    buffer_load_dwordx4 v[136:139], v4, s[36:39], s68 offen offset:2048 sc1
    buffer_load_dwordx4 v[140:143], v4, s[36:39], s68 offen offset:3072 sc1
    buffer_load_dwordx4 v[144:147], v4, s[36:39], s69 offen offset:0 sc1
    buffer_load_dwordx4 v[148:151], v4, s[36:39], s69 offen offset:1024 sc1
    buffer_load_dwordx4 v[152:155], v4, s[36:39], s69 offen offset:2048 sc1
    buffer_load_dwordx4 v[156:159], v4, s[36:39], s69 offen offset:3072 sc1
    s_mov_b32 s80, 200000
PS_109:
    s_waitcnt vmcnt(0)
    s_mov_b32 s78, 0
    v_cmp_ne_u64 vcc, s[94:95], v[98:99]
    s_cbranch_vccz PSS_111
    buffer_load_dwordx4 v[96:99], v4, s[36:39], 0 offen offset:0 sc1
    s_mov_b32 s78, 1
PSS_111:
    v_cmp_ne_u64 vcc, s[94:95], v[102:103]
    s_cbranch_vccz PSS_112
    buffer_load_dwordx4 v[100:103], v4, s[36:39], 0 offen offset:1024 sc1
    s_mov_b32 s78, 1
PSS_112:
    v_cmp_ne_u64 vcc, s[94:95], v[106:107]
    s_cbranch_vccz PSS_113
    buffer_load_dwordx4 v[104:107], v4, s[36:39], 0 offen offset:2048 sc1
    s_mov_b32 s78, 1
PSS_113:
    v_cmp_ne_u64 vcc, s[94:95], v[110:111]
    s_cbranch_vccz PSS_114
    buffer_load_dwordx4 v[108:111], v4, s[36:39], 0 offen offset:3072 sc1
    s_mov_b32 s78, 1
PSS_114:
    v_cmp_ne_u64 vcc, s[94:95], v[114:115]
    s_cbranch_vccz PSS_115
    buffer_load_dwordx4 v[112:115], v4, s[36:39], s67 offen offset:0 sc1
    s_mov_b32 s78, 1
PSS_115:
    v_cmp_ne_u64 vcc, s[94:95], v[118:119]
    s_cbranch_vccz PSS_116
    buffer_load_dwordx4 v[116:119], v4, s[36:39], s67 offen offset:1024 sc1
    s_mov_b32 s78, 1
PSS_116:
    v_cmp_ne_u64 vcc, s[94:95], v[122:123]
    s_cbranch_vccz PSS_117
    buffer_load_dwordx4 v[120:123], v4, s[36:39], s67 offen offset:2048 sc1
    s_mov_b32 s78, 1
PSS_117:
    v_cmp_ne_u64 vcc, s[94:95], v[126:127]
    s_cbranch_vccz PSS_118
    buffer_load_dwordx4 v[124:127], v4, s[36:39], s67 offen offset:3072 sc1
    s_mov_b32 s78, 1
PSS_118:
    v_cmp_ne_u64 vcc, s[94:95], v[130:131]
    s_cbranch_vccz PSS_119
    buffer_load_dwordx4 v[128:131], v4, s[36:39], s68 offen offset:0 sc1
    s_mov_b32 s78, 1
PSS_119:
    v_cmp_ne_u64 vcc, s[94:95], v[134:135]
    s_cbranch_vccz PSS_120
    buffer_load_dwordx4 v[132:135], v4, s[36:39], s68 offen offset:1024 sc1
    s_mov_b32 s78, 1
PSS_120:
    v_cmp_ne_u64 vcc, s[94:95], v[138:139]
    s_cbranch_vccz PSS_121
    buffer_load_dwordx4 v[136:139], v4, s[36:39], s68 offen offset:2048 sc1
    s_mov_b32 s78, 1
PSS_121:
    v_cmp_ne_u64 vcc, s[94:95], v[142:143]
    s_cbranch_vccz PSS_122
    buffer_load_dwordx4 v[140:143], v4, s[36:39], s68 offen offset:3072 sc1
    s_mov_b32 s78, 1
PSS_122:
    v_cmp_ne_u64 vcc, s[94:95], v[146:147]
    s_cbranch_vccz PSS_123
    buffer_load_dwordx4 v[144:147], v4, s[36:39], s69 offen offset:0 sc1
    s_mov_b32 s78, 1
PSS_123:
    v_cmp_ne_u64 vcc, s[94:95], v[150:151]
    s_cbranch_vccz PSS_124
    buffer_load_dwordx4 v[148:151], v4, s[36:39], s69 offen offset:1024 sc1
    s_mov_b32 s78, 1
PSS_124:
    v_cmp_ne_u64 vcc, s[94:95], v[154:155]
    s_cbranch_vccz PSS_125
    buffer_load_dwordx4 v[152:155], v4, s[36:39], s69 offen offset:2048 sc1
    s_mov_b32 s78, 1
PSS_125:
    v_cmp_ne_u64 vcc, s[94:95], v[158:159]
    s_cbranch_vccz PSS_126
    buffer_load_dwordx4 v[156:159], v4, s[36:39], s69 offen offset:3072 sc1
    s_mov_b32 s78, 1
PSS_126:
    s_cmp_eq_u32 s78, 0
    s_cbranch_scc1 PSD_110
    s_sub_u32 s80, s80, 1
    s_cmp_lg_u32 s80, 0
    s_cbranch_scc1 PS_109
    s_waitcnt vmcnt(0)
PSD_110:
    v_xor_b32 v6, 0x0, v3
    ds_write_b64 v6, v[96:97] offset:0
    ds_write_b64 v6, v[100:101] offset:512
    v_xor_b32 v7, 0x10, v3
    ds_write_b64 v7, v[104:105] offset:1024
    ds_write_b64 v7, v[108:109] offset:1536
    v_xor_b32 v6, 0x20, v3
    ds_write_b64 v6, v[112:113] offset:2048
    ds_write_b64 v6, v[116:117] offset:2560
    v_xor_b32 v7, 0x30, v3
    ds_write_b64 v7, v[120:121] offset:3072
    ds_write_b64 v7, v[124:125] offset:3584
    v_xor_b32 v6, 0x40, v3
    ds_write_b64 v6, v[128:129] offset:4096
    ds_write_b64 v6, v[132:133] offset:4608
    v_xor_b32 v7, 0x50, v3
    ds_write_b64 v7, v[136:137] offset:5120
    ds_write_b64 v7, v[140:141] offset:5632
    v_xor_b32 v6, 0x60, v3
    ds_write_b64 v6, v[144:145] offset:6144
    ds_write_b64 v6, v[148:149] offset:6656
    v_xor_b32 v7, 0x70, v3
    ds_write_b64 v7, v[152:153] offset:7168
    ds_write_b64 v7, v[156:157] offset:7680
L_CCUT:
    s_waitcnt lgkmcnt(0)
    s_barrier
    s_endpgm
L_END:
    s_endpgm
L_END0:
    s_endpgm
L_CODE_END:
.section .rodata,"a"
.p2align 6
.amdhsa_kernel concat_heads__sliding_block_cached__compressed_kv_cla__decode_kernel
  .amdhsa_next_free_vgpr 168
  .amdhsa_next_free_sgpr 102
  .amdhsa_accum_offset 168
  .amdhsa_group_segment_fixed_size 0
  .amdhsa_kernarg_size 112
  .amdhsa_user_sgpr_count 2
  .amdhsa_user_sgpr_kernarg_segment_ptr 1
  .amdhsa_system_sgpr_workgroup_id_x 1
  .amdhsa_float_denorm_mode_32 3
.end_amdhsa_kernel
```

```asm
; @launch grid=(256,1,1) block=(768,1,1) lds=163840
.amdgcn_target "amdgcn-amd-amdhsa--gfx950"
.text
.globl concat_heads__sliding_block_cached__compressed_kv_cla__decode_kernel
.p2align 8
.type concat_heads__sliding_block_cached__compressed_kv_cla__decode_kernel,@function
concat_heads__sliding_block_cached__compressed_kv_cla__decode_kernel:
    s_load_dwordx16 s[8:23], s[0:1], 0
    s_load_dwordx8 s[24:31], s[0:1], 64
    s_load_dwordx4 s[32:35], s[0:1], 96
    v_lshrrev_b32 v1, 6, v0
    s_and_b32 s4, s2, 7
    v_readfirstlane_b32 s3, v1
    s_lshr_b32 s5, s2, 3
    s_cmp_ge_u32 s2, 256
    s_cbranch_scc1 L_END0
    s_cmp_ge_u32 s5, 16
    s_cbranch_scc1 EA_1
    s_cmp_ge_u32 s5, 8
    s_cbranch_scc1 EC_2
    s_cmp_ge_u32 s3, 8
    s_cbranch_scc1 L_W2
    s_cmp_ge_u32 s3, 4
    s_cbranch_scc1 L_W1
    s_branch L_W
EC_2:
    s_cmp_ge_u32 s3, 8
    s_cbranch_scc1 L_CSVC
    s_branch L_C
EA_1:
    s_cmp_eq_u32 s3, 11
    s_cbranch_scc1 L_ASVC
    v_and_b32 v1, 63, v0
    s_and_b32 s7, s5, 3
    s_lshl_b32 s6, s4, 2
    s_add_u32 s6, s6, s7
    s_mov_b32 s92, 0x05040100
    s_mov_b32 s93, 0x07060302
    s_lshr_b32 s7, s5, 2
    s_sub_u32 s7, s7, 4
    s_lshl_b32 s7, s7, 5
    s_add_u32 s7, s7, s6
    s_lshl_b32 s7, s7, 20
    s_add_u32 s7, s7, 0xC0000
    v_lshlrev_b32 v6, 4, v1
    v_add_u32 v6, s7, v6
    s_add_u32 s63, s3, 3
    s_cmp_ge_u32 s63, 11
    s_cselect_b32 s7, 11, 0
    s_sub_u32 s62, s63, s7
    s_mov_b32 s65, s62
    s_mul_i32 s7, s2, 0
    s_add_u32 s7, s7, s62
    s_mul_i32 s7, s7, 1024
    s_and_b32 s60, s7, 0x3ffff
    s_mov_b32 s61, s60
    s_add_u32 s63, s60, 259072
    s_and_b32 s63, s63, 0x3ffff
    s_cmp_lt_u32 s62, 3
    s_cselect_b32 s63, s63, 0x40000000
    s_cselect_b32 s62, 0, 0xff800000
    s_mov_b32 s64, 0x3e0293ee
    s_lshl_b32 s60, s3, 10
    s_mov_b32 s61, s60
    s_cmp_ge_u32 s3, 8
    s_cselect_b32 s7, 4096, 0
    s_sub_u32 s63, s60, s7
    s_add_u32 s63, s63, 247808
    s_add_u32 s65, s63, 7168
    s_and_b32 s7, s3, 12
    s_cmp_eq_u32 s7, 4
    s_cselect_b32 s62, 0xff800000, 0
    s_and_b32 s7, s5, 12
    s_and_b32 s66, s3, 3
    s_add_u32 s7, s7, s66
    v_lshrrev_b32 v2, 4, v1
    v_lshlrev_b32 v3, 16, v2
    v_and_b32 v4, 15, v1
    v_lshl_add_u32 v3, v4, 4, v3
    s_lshl_b32 s66, s7, 18
    s_lshl_b32 s67, s6, 8
    s_add_u32 s66, s66, s67
    v_bfe_u32 v4, v1, 2, 2
    v_lshlrev_b32 v4, 10, v4
    v_lshl_add_u32 v4, v2, 4, v4
    s_lshl_b32 s67, s7, 6
    s_cmp_ge_u32 s3, 8
    s_cbranch_scc1 AK_3
    s_cmp_lt_u32 s3, 4
    s_cbranch_scc1 AP_5
    s_barrier
    s_sleep 26
AP_5:
    s_cmp_lt_u32 s3, 4
    s_waitcnt lgkmcnt(0)
    s_cselect_b32 s72, s22, s14
    s_cselect_b32 s73, s23, s15
    s_cselect_b32 s70, s18, s8
    s_cselect_b32 s71, s19, s9
    s_mov_b32 s56, s72
    s_and_b32 s57, s73, 0xffff
    s_mov_b32 s58, 0x400000
    s_mov_b32 s59, 0x20000
    buffer_load_dwordx4 v[128:131], v3, s[56:59], s66 offen nt
    s_add_u32 s66, s66, 8192
    buffer_load_dwordx4 v[132:135], v3, s[56:59], s66 offen nt
    s_add_u32 s66, s66, 8192
    buffer_load_dwordx4 v[136:139], v3, s[56:59], s66 offen nt
    s_add_u32 s66, s66, 8192
    buffer_load_dwordx4 v[140:143], v3, s[56:59], s66 offen nt
    s_add_u32 s66, s66, 8192
    buffer_load_dwordx4 v[144:147], v3, s[56:59], s66 offen nt
    s_add_u32 s66, s66, 8192
    buffer_load_dwordx4 v[148:151], v3, s[56:59], s66 offen nt
    s_add_u32 s66, s66, 8192
    buffer_load_dwordx4 v[152:155], v3, s[56:59], s66 offen nt
    s_add_u32 s66, s66, 8192
    buffer_load_dwordx4 v[156:159], v3, s[56:59], s66 offen nt
    s_add_u32 s66, s66, 8192
    s_mov_b32 s52, s70
    s_and_b32 s53, s71, 0xffff
    s_mov_b32 s54, 0x1000
    s_mov_b32 s55, 0x20000
    buffer_load_dwordx4 v[160:163], v4, s[52:55], s67 offen
    s_mov_b32 s36, s34
    s_and_b32 s37, s35, 0xffff
    s_mov_b32 s38, 0x1000000
    s_mov_b32 s39, 0x20000
    s_mov_b32 s40, s32
    s_and_b32 s41, s33, 0xffff
    s_mov_b32 s42, 0x100
    s_mov_b32 s43, 0x20000
    s_mov_b32 s44, s10
    s_and_b32 s45, s11, 0xffff
    s_mov_b32 s46, 0x8000000
    s_mov_b32 s47, 0x20000
    s_mov_b32 s48, s12
    s_and_b32 s49, s13, 0xffff
    s_mov_b32 s50, 0x8000000
    s_mov_b32 s51, 0x20000
    s_cmp_ge_u32 s3, 4
    s_cbranch_scc1 AP_6
    s_barrier
AP_6:
    s_lshl_b32 s7, s3, 11
    s_add_u32 s7, s7, 0x0
    v_lshl_add_u32 v2, v1, 5, s7
    s_cmp_lt_u32 s3, 4
    s_cselect_b32 s7, 0x44, 0x40
    s_add_u32 s7, s7, 0x24000
    v_mov_b32 v3, s7
    v_mov_b32 v4, 1
    s_waitcnt vmcnt(0)
    v_perm_b32 v96, v132, v128, s92
    v_perm_b32 v97, v140, v136, s92
    v_perm_b32 v98, v148, v144, s92
    v_perm_b32 v99, v156, v152, s92
    v_perm_b32 v100, v132, v128, s93
    v_perm_b32 v101, v140, v136, s93
    v_perm_b32 v102, v148, v144, s93
    v_perm_b32 v103, v156, v152, s93
    v_perm_b32 v104, v133, v129, s92
    v_perm_b32 v105, v141, v137, s92
    v_perm_b32 v106, v149, v145, s92
    v_perm_b32 v107, v157, v153, s92
    v_perm_b32 v108, v133, v129, s93
    v_perm_b32 v109, v141, v137, s93
    v_perm_b32 v110, v149, v145, s93
    v_perm_b32 v111, v157, v153, s93
    v_perm_b32 v112, v134, v130, s92
    v_perm_b32 v113, v142, v138, s92
    v_perm_b32 v114, v150, v146, s92
    v_perm_b32 v115, v158, v154, s92
    v_perm_b32 v116, v134, v130, s93
    v_perm_b32 v117, v142, v138, s93
    v_perm_b32 v118, v150, v146, s93
    v_perm_b32 v119, v158, v154, s93
    v_perm_b32 v120, v135, v131, s92
    v_perm_b32 v121, v143, v139, s92
    v_perm_b32 v122, v151, v147, s92
    v_perm_b32 v123, v159, v155, s92
    v_perm_b32 v124, v135, v131, s93
    v_perm_b32 v125, v143, v139, s93
    v_perm_b32 v126, v151, v147, s93
    v_perm_b32 v127, v159, v155, s93
    v_mfma_f32_16x16x32_bf16 v[64:67], v[160:163], v[96:99], 0
    v_mfma_f32_16x16x32_bf16 v[68:71], v[160:163], v[100:103], 0
    v_mfma_f32_16x16x32_bf16 v[72:75], v[160:163], v[104:107], 0
    v_mfma_f32_16x16x32_bf16 v[76:79], v[160:163], v[108:111], 0
    v_mfma_f32_16x16x32_bf16 v[80:83], v[160:163], v[112:115], 0
    v_mfma_f32_16x16x32_bf16 v[84:87], v[160:163], v[116:119], 0
    v_mfma_f32_16x16x32_bf16 v[88:91], v[160:163], v[120:123], 0
    v_mfma_f32_16x16x32_bf16 v[92:95], v[160:163], v[124:127], 0
    s_nop 0
    v_mov_b32 v128, v64
    v_mov_b32 v129, v68
    v_mov_b32 v130, v72
    v_mov_b32 v131, v76
    v_mov_b32 v132, v80
    v_mov_b32 v133, v84
    v_mov_b32 v134, v88
    v_mov_b32 v135, v92
    ds_write_b128 v2, v[128:131]
    ds_write_b128 v2, v[132:135] offset:16
    s_waitcnt lgkmcnt(0)
    s_mov_b64 exec, 1
    ds_add_u32 v3, v4
    s_mov_b64 exec, -1
    s_branch AJ_4
AK_3:
    s_waitcnt lgkmcnt(0)
    s_mov_b32 s36, s34
    s_and_b32 s37, s35, 0xffff
    s_mov_b32 s38, 0x1000000
    s_mov_b32 s39, 0x20000
    s_mov_b32 s40, s32
    s_and_b32 s41, s33, 0xffff
    s_mov_b32 s42, 0x100
    s_mov_b32 s43, 0x20000
    s_mov_b32 s44, s10
    s_and_b32 s45, s11, 0xffff
    s_mov_b32 s46, 0x8000000
    s_mov_b32 s47, 0x20000
    s_mov_b32 s48, s12
    s_and_b32 s49, s13, 0xffff
    s_mov_b32 s50, 0x8000000
    s_mov_b32 s51, 0x20000
    s_barrier
    s_sleep 26
AJ_4:
    v_mov_b32 v32, 0
    v_mov_b32 v33, 0
    v_mov_b32 v34, 0
    v_mov_b32 v35, 0
    v_mov_b32 v36, 0
    v_mov_b32 v37, 0
    v_mov_b32 v38, 0
    v_mov_b32 v39, 0
    s_cmp_lg_u32 s62, 0
    s_cbranch_scc1 L_AK2
    buffer_load_dwordx4 v[32:35], v6, s[44:47], s63 offen nt
    buffer_load_dwordx4 v[36:39], v6, s[44:47], s65 offen nt
L_AK2:
    buffer_load_dwordx4 v[40:43], v6, s[44:47], s60 offen nt
    s_add_u32 s60, s60, 11264
    s_waitcnt vmcnt(2)
    buffer_load_dwordx4 v[44:47], v6, s[44:47], s60 offen nt
    s_add_u32 s60, s60, 11264
    s_waitcnt vmcnt(2)
    buffer_load_dwordx4 v[48:51], v6, s[44:47], s60 offen nt
    s_add_u32 s60, s60, 11264
    s_waitcnt vmcnt(2)
    buffer_load_dwordx4 v[52:55], v6, s[44:47], s60 offen nt
    s_add_u32 s60, s60, 11264
    s_waitcnt vmcnt(2)
    buffer_load_dwordx4 v[56:59], v6, s[44:47], s60 offen nt
    s_add_u32 s60, s60, 11264
    s_waitcnt vmcnt(2)
    buffer_load_dwordx4 v[60:63], v6, s[44:47], s60 offen nt
    s_add_u32 s60, s60, 11264
    s_waitcnt vmcnt(2)
    buffer_load_dwordx4 v[64:67], v6, s[44:47], s60 offen nt
    s_add_u32 s60, s60, 11264
    s_waitcnt vmcnt(2)
    buffer_load_dwordx4 v[68:71], v6, s[44:47], s60 offen nt
    s_add_u32 s60, s60, 11264
    s_waitcnt vmcnt(2)
    buffer_load_dwordx4 v[72:75], v6, s[44:47], s60 offen nt
    s_add_u32 s60, s60, 11264
    s_waitcnt vmcnt(2)
    buffer_load_dwordx4 v[76:79], v6, s[44:47], s60 offen nt
    s_add_u32 s60, s60, 11264
    s_waitcnt vmcnt(2)
    buffer_load_dwordx4 v[80:83], v6, s[44:47], s60 offen nt
    s_add_u32 s60, s60, 11264
    s_waitcnt vmcnt(2)
    buffer_load_dwordx4 v[84:87], v6, s[44:47], s60 offen nt
    s_add_u32 s60, s60, 11264
    s_waitcnt vmcnt(2)
    buffer_load_dwordx4 v[88:91], v6, s[44:47], s60 offen nt
    s_add_u32 s60, s60, 11264
    s_waitcnt vmcnt(2)
    buffer_load_dwordx4 v[92:95], v6, s[44:47], s60 offen nt
    s_add_u32 s60, s60, 11264
    v_mov_b32 v160, 0x24004
    s_mov_b32 s80, 1600000
LW_7:
    ds_read_b32 v161, v160
    s_waitcnt lgkmcnt(0)
    v_readfirstlane_b32 s79, v161
    s_cmp_ge_u32 s79, 1
    s_cbranch_scc1 LWD_8
    s_sleep 4
    s_sub_u32 s80, s80, 1
    s_cmp_lg_u32 s80, 0
    s_cbranch_scc1 LW_7
LWD_8:
    v_and_b32 v160, 15, v1
    v_lshlrev_b32 v160, 4, v160
    v_add_u32 v160, 0x24100, v160
    ds_read_b128 v[2:5], v160
    s_waitcnt lgkmcnt(0)
    v_dot2_f32_bf16 v8, v32, v2, 0
    v_dot2_f32_bf16 v9, v36, v2, 0
    v_dot2_f32_bf16 v10, v40, v2, 0
    v_dot2_f32_bf16 v11, v44, v2, 0
    v_dot2_f32_bf16 v8, v33, v3, v8
    v_dot2_f32_bf16 v9, v37, v3, v9
    v_dot2_f32_bf16 v10, v41, v3, v10
    v_dot2_f32_bf16 v11, v45, v3, v11
    v_dot2_f32_bf16 v8, v34, v4, v8
    v_dot2_f32_bf16 v9, v38, v4, v9
    v_dot2_f32_bf16 v10, v42, v4, v10
    v_dot2_f32_bf16 v11, v46, v4, v11
    v_dot2_f32_bf16 v8, v35, v5, v8
    v_dot2_f32_bf16 v9, v39, v5, v9
    v_dot2_f32_bf16 v10, v43, v5, v10
    v_dot2_f32_bf16 v11, v47, v5, v11
    v_add_f32_dpp v8, v8, v8 row_ror:8 row_mask:0xf bank_mask:0xf
    v_add_f32_dpp v9, v9, v9 row_ror:8 row_mask:0xf bank_mask:0xf
    v_add_f32_dpp v10, v10, v10 row_ror:8 row_mask:0xf bank_mask:0xf
    v_add_f32_dpp v11, v11, v11 row_ror:8 row_mask:0xf bank_mask:0xf
    v_add_f32_dpp v8, v8, v8 row_ror:4 row_mask:0xf bank_mask:0xf
    v_add_f32_dpp v9, v9, v9 row_ror:4 row_mask:0xf bank_mask:0xf
    v_add_f32_dpp v10, v10, v10 row_ror:4 row_mask:0xf bank_mask:0xf
    v_add_f32_dpp v11, v11, v11 row_ror:4 row_mask:0xf bank_mask:0xf
    v_add_f32_dpp v8, v8, v8 row_ror:2 row_mask:0xf bank_mask:0xf
    v_add_f32_dpp v9, v9, v9 row_ror:2 row_mask:0xf bank_mask:0xf
    v_add_f32_dpp v10, v10, v10 row_ror:2 row_mask:0xf bank_mask:0xf
    v_add_f32_dpp v11, v11, v11 row_ror:2 row_mask:0xf bank_mask:0xf
    v_add_f32_dpp v8, v8, v8 row_ror:1 row_mask:0xf bank_mask:0xf
    v_add_f32_dpp v9, v9, v9 row_ror:1 row_mask:0xf bank_mask:0xf
    v_add_f32_dpp v10, v10, v10 row_ror:1 row_mask:0xf bank_mask:0xf
    v_add_f32_dpp v11, v11, v11 row_ror:1 row_mask:0xf bank_mask:0xf
    s_waitcnt vmcnt(2)
    buffer_load_dwordx4 v[96:99], v6, s[44:47], s60 offen nt
    s_add_u32 s60, s60, 11264
    s_waitcnt vmcnt(2)
    buffer_load_dwordx4 v[100:103], v6, s[44:47], s60 offen nt
    s_add_u32 s60, s60, 11264
    v_dot2_f32_bf16 v12, v48, v2, 0
    v_dot2_f32_bf16 v13, v52, v2, 0
    v_dot2_f32_bf16 v14, v56, v2, 0
    v_dot2_f32_bf16 v15, v60, v2, 0
    v_dot2_f32_bf16 v12, v49, v3, v12
    v_dot2_f32_bf16 v13, v53, v3, v13
    v_dot2_f32_bf16 v14, v57, v3, v14
    v_dot2_f32_bf16 v15, v61, v3, v15
    v_dot2_f32_bf16 v12, v50, v4, v12
    v_dot2_f32_bf16 v13, v54, v4, v13
    v_dot2_f32_bf16 v14, v58, v4, v14
    v_dot2_f32_bf16 v15, v62, v4, v15
    v_dot2_f32_bf16 v12, v51, v5, v12
    v_dot2_f32_bf16 v13, v55, v5, v13
    v_dot2_f32_bf16 v14, v59, v5, v14
    v_dot2_f32_bf16 v15, v63, v5, v15
    v_add_f32_dpp v12, v12, v12 row_ror:8 row_mask:0xf bank_mask:0xf
    v_add_f32_dpp v13, v13, v13 row_ror:8 row_mask:0xf bank_mask:0xf
    v_add_f32_dpp v14, v14, v14 row_ror:8 row_mask:0xf bank_mask:0xf
    v_add_f32_dpp v15, v15, v15 row_ror:8 row_mask:0xf bank_mask:0xf
    v_add_f32_dpp v12, v12, v12 row_ror:4 row_mask:0xf bank_mask:0xf
    v_add_f32_dpp v13, v13, v13 row_ror:4 row_mask:0xf bank_mask:0xf
    v_add_f32_dpp v14, v14, v14 row_ror:4 row_mask:0xf bank_mask:0xf
    v_add_f32_dpp v15, v15, v15 row_ror:4 row_mask:0xf bank_mask:0xf
    v_add_f32_dpp v12, v12, v12 row_ror:2 row_mask:0xf bank_mask:0xf
    v_add_f32_dpp v13, v13, v13 row_ror:2 row_mask:0xf bank_mask:0xf
    v_add_f32_dpp v14, v14, v14 row_ror:2 row_mask:0xf bank_mask:0xf
    v_add_f32_dpp v15, v15, v15 row_ror:2 row_mask:0xf bank_mask:0xf
    v_add_f32_dpp v12, v12, v12 row_ror:1 row_mask:0xf bank_mask:0xf
    v_add_f32_dpp v13, v13, v13 row_ror:1 row_mask:0xf bank_mask:0xf
    v_add_f32_dpp v14, v14, v14 row_ror:1 row_mask:0xf bank_mask:0xf
    v_add_f32_dpp v15, v15, v15 row_ror:1 row_mask:0xf bank_mask:0xf
    s_waitcnt vmcnt(2)
    buffer_load_dwordx4 v[104:107], v6, s[44:47], s60 offen nt
    s_add_u32 s60, s60, 11264
    s_waitcnt vmcnt(2)
    buffer_load_dwordx4 v[108:111], v6, s[44:47], s60 offen nt
    s_add_u32 s60, s60, 11264
    v_dot2_f32_bf16 v16, v64, v2, 0
    v_dot2_f32_bf16 v17, v68, v2, 0
    v_dot2_f32_bf16 v18, v72, v2, 0
    v_dot2_f32_bf16 v19, v76, v2, 0
    v_dot2_f32_bf16 v16, v65, v3, v16
    v_dot2_f32_bf16 v17, v69, v3, v17
    v_dot2_f32_bf16 v18, v73, v3, v18
    v_dot2_f32_bf16 v19, v77, v3, v19
    v_dot2_f32_bf16 v16, v66, v4, v16
    v_dot2_f32_bf16 v17, v70, v4, v17
    v_dot2_f32_bf16 v18, v74, v4, v18
    v_dot2_f32_bf16 v19, v78, v4, v19
    v_dot2_f32_bf16 v16, v67, v5, v16
    v_dot2_f32_bf16 v17, v71, v5, v17
    v_dot2_f32_bf16 v18, v75, v5, v18
    v_dot2_f32_bf16 v19, v79, v5, v19
    v_add_f32_dpp v16, v16, v16 row_ror:8 row_mask:0xf bank_mask:0xf
    v_add_f32_dpp v17, v17, v17 row_ror:8 row_mask:0xf bank_mask:0xf
    v_add_f32_dpp v18, v18, v18 row_ror:8 row_mask:0xf bank_mask:0xf
    v_add_f32_dpp v19, v19, v19 row_ror:8 row_mask:0xf bank_mask:0xf
    v_add_f32_dpp v16, v16, v16 row_ror:4 row_mask:0xf bank_mask:0xf
    v_add_f32_dpp v17, v17, v17 row_ror:4 row_mask:0xf bank_mask:0xf
    v_add_f32_dpp v18, v18, v18 row_ror:4 row_mask:0xf bank_mask:0xf
    v_add_f32_dpp v19, v19, v19 row_ror:4 row_mask:0xf bank_mask:0xf
    v_add_f32_dpp v16, v16, v16 row_ror:2 row_mask:0xf bank_mask:0xf
    v_add_f32_dpp v17, v17, v17 row_ror:2 row_mask:0xf bank_mask:0xf
    v_add_f32_dpp v18, v18, v18 row_ror:2 row_mask:0xf bank_mask:0xf
    v_add_f32_dpp v19, v19, v19 row_ror:2 row_mask:0xf bank_mask:0xf
    v_add_f32_dpp v16, v16, v16 row_ror:1 row_mask:0xf bank_mask:0xf
    v_add_f32_dpp v17, v17, v17 row_ror:1 row_mask:0xf bank_mask:0xf
    v_add_f32_dpp v18, v18, v18 row_ror:1 row_mask:0xf bank_mask:0xf
    v_add_f32_dpp v19, v19, v19 row_ror:1 row_mask:0xf bank_mask:0xf
    s_waitcnt vmcnt(2)
    buffer_load_dwordx4 v[112:115], v6, s[44:47], s60 offen nt
    s_add_u32 s60, s60, 11264
    s_waitcnt vmcnt(2)
    buffer_load_dwordx4 v[116:119], v6, s[44:47], s60 offen nt
    s_add_u32 s60, s60, 11264
    v_dot2_f32_bf16 v20, v80, v2, 0
    v_dot2_f32_bf16 v21, v84, v2, 0
    v_dot2_f32_bf16 v22, v88, v2, 0
    v_dot2_f32_bf16 v23, v92, v2, 0
    v_dot2_f32_bf16 v20, v81, v3, v20
    v_dot2_f32_bf16 v21, v85, v3, v21
    v_dot2_f32_bf16 v22, v89, v3, v22
    v_dot2_f32_bf16 v23, v93, v3, v23
    v_dot2_f32_bf16 v20, v82, v4, v20
    v_dot2_f32_bf16 v21, v86, v4, v21
    v_dot2_f32_bf16 v22, v90, v4, v22
    v_dot2_f32_bf16 v23, v94, v4, v23
    v_dot2_f32_bf16 v20, v83, v5, v20
    v_dot2_f32_bf16 v21, v87, v5, v21
    v_dot2_f32_bf16 v22, v91, v5, v22
    v_dot2_f32_bf16 v23, v95, v5, v23
    v_add_f32_dpp v20, v20, v20 row_ror:8 row_mask:0xf bank_mask:0xf
    v_add_f32_dpp v21, v21, v21 row_ror:8 row_mask:0xf bank_mask:0xf
    v_add_f32_dpp v22, v22, v22 row_ror:8 row_mask:0xf bank_mask:0xf
    v_add_f32_dpp v23, v23, v23 row_ror:8 row_mask:0xf bank_mask:0xf
    v_add_f32_dpp v20, v20, v20 row_ror:4 row_mask:0xf bank_mask:0xf
    v_add_f32_dpp v21, v21, v21 row_ror:4 row_mask:0xf bank_mask:0xf
    v_add_f32_dpp v22, v22, v22 row_ror:4 row_mask:0xf bank_mask:0xf
    v_add_f32_dpp v23, v23, v23 row_ror:4 row_mask:0xf bank_mask:0xf
    v_add_f32_dpp v20, v20, v20 row_ror:2 row_mask:0xf bank_mask:0xf
    v_add_f32_dpp v21, v21, v21 row_ror:2 row_mask:0xf bank_mask:0xf
    v_add_f32_dpp v22, v22, v22 row_ror:2 row_mask:0xf bank_mask:0xf
    v_add_f32_dpp v23, v23, v23 row_ror:2 row_mask:0xf bank_mask:0xf
    v_add_f32_dpp v20, v20, v20 row_ror:1 row_mask:0xf bank_mask:0xf
    v_add_f32_dpp v21, v21, v21 row_ror:1 row_mask:0xf bank_mask:0xf
    v_add_f32_dpp v22, v22, v22 row_ror:1 row_mask:0xf bank_mask:0xf
    v_add_f32_dpp v23, v23, v23 row_ror:1 row_mask:0xf bank_mask:0xf
    s_waitcnt vmcnt(2)
    buffer_load_dwordx4 v[120:123], v6, s[44:47], s60 offen nt
    s_add_u32 s60, s60, 11264
    s_waitcnt vmcnt(2)
    buffer_load_dwordx4 v[124:127], v6, s[44:47], s60 offen nt
    v_dot2_f32_bf16 v24, v96, v2, 0
    v_dot2_f32_bf16 v25, v100, v2, 0
    v_dot2_f32_bf16 v26, v104, v2, 0
    v_dot2_f32_bf16 v27, v108, v2, 0
    v_dot2_f32_bf16 v24, v97, v3, v24
    v_dot2_f32_bf16 v25, v101, v3, v25
    v_dot2_f32_bf16 v26, v105, v3, v26
    v_dot2_f32_bf16 v27, v109, v3, v27
    v_dot2_f32_bf16 v24, v98, v4, v24
    v_dot2_f32_bf16 v25, v102, v4, v25
    v_dot2_f32_bf16 v26, v106, v4, v26
    v_dot2_f32_bf16 v27, v110, v4, v27
    v_dot2_f32_bf16 v24, v99, v5, v24
    v_dot2_f32_bf16 v25, v103, v5, v25
    v_dot2_f32_bf16 v26, v107, v5, v26
    v_dot2_f32_bf16 v27, v111, v5, v27
    v_add_f32_dpp v24, v24, v24 row_ror:8 row_mask:0xf bank_mask:0xf
    v_add_f32_dpp v25, v25, v25 row_ror:8 row_mask:0xf bank_mask:0xf
    v_add_f32_dpp v26, v26, v26 row_ror:8 row_mask:0xf bank_mask:0xf
    v_add_f32_dpp v27, v27, v27 row_ror:8 row_mask:0xf bank_mask:0xf
    v_add_f32_dpp v24, v24, v24 row_ror:4 row_mask:0xf bank_mask:0xf
    v_add_f32_dpp v25, v25, v25 row_ror:4 row_mask:0xf bank_mask:0xf
    v_add_f32_dpp v26, v26, v26 row_ror:4 row_mask:0xf bank_mask:0xf
    v_add_f32_dpp v27, v27, v27 row_ror:4 row_mask:0xf bank_mask:0xf
    v_add_f32_dpp v24, v24, v24 row_ror:2 row_mask:0xf bank_mask:0xf
    v_add_f32_dpp v25, v25, v25 row_ror:2 row_mask:0xf bank_mask:0xf
    v_add_f32_dpp v26, v26, v26 row_ror:2 row_mask:0xf bank_mask:0xf
    v_add_f32_dpp v27, v27, v27 row_ror:2 row_mask:0xf bank_mask:0xf
    v_add_f32_dpp v24, v24, v24 row_ror:1 row_mask:0xf bank_mask:0xf
    v_add_f32_dpp v25, v25, v25 row_ror:1 row_mask:0xf bank_mask:0xf
    v_add_f32_dpp v26, v26, v26 row_ror:1 row_mask:0xf bank_mask:0xf
    v_add_f32_dpp v27, v27, v27 row_ror:1 row_mask:0xf bank_mask:0xf
    s_waitcnt vmcnt(2)
    buffer_load_dwordx4 v[128:131], v6, s[48:51], s61 offen nt
    s_add_u32 s61, s61, 11264
    s_waitcnt vmcnt(2)
    buffer_load_dwordx4 v[132:135], v6, s[48:51], s61 offen nt
    s_add_u32 s61, s61, 11264
    s_waitcnt vmcnt(2)
    buffer_load_dwordx4 v[136:139], v6, s[48:51], s61 offen nt
    s_add_u32 s61, s61, 11264
    v_dot2_f32_bf16 v28, v112, v2, 0
    v_dot2_f32_bf16 v29, v116, v2, 0
    v_dot2_f32_bf16 v30, v120, v2, 0
    v_dot2_f32_bf16 v31, v124, v2, 0
    v_dot2_f32_bf16 v28, v113, v3, v28
    v_dot2_f32_bf16 v29, v117, v3, v29
    v_dot2_f32_bf16 v30, v121, v3, v30
    v_dot2_f32_bf16 v31, v125, v3, v31
    v_dot2_f32_bf16 v28, v114, v4, v28
    v_dot2_f32_bf16 v29, v118, v4, v29
    v_dot2_f32_bf16 v30, v122, v4, v30
    v_dot2_f32_bf16 v31, v126, v4, v31
    v_dot2_f32_bf16 v28, v115, v5, v28
    v_dot2_f32_bf16 v29, v119, v5, v29
    v_dot2_f32_bf16 v30, v123, v5, v30
    v_dot2_f32_bf16 v31, v127, v5, v31
    v_add_f32_dpp v28, v28, v28 row_ror:8 row_mask:0xf bank_mask:0xf
    v_add_f32_dpp v29, v29, v29 row_ror:8 row_mask:0xf bank_mask:0xf
    v_add_f32_dpp v30, v30, v30 row_ror:8 row_mask:0xf bank_mask:0xf
    v_add_f32_dpp v31, v31, v31 row_ror:8 row_mask:0xf bank_mask:0xf
    v_add_f32_dpp v28, v28, v28 row_ror:4 row_mask:0xf bank_mask:0xf
    v_add_f32_dpp v29, v29, v29 row_ror:4 row_mask:0xf bank_mask:0xf
    v_add_f32_dpp v30, v30, v30 row_ror:4 row_mask:0xf bank_mask:0xf
    v_add_f32_dpp v31, v31, v31 row_ror:4 row_mask:0xf bank_mask:0xf
    v_add_f32_dpp v28, v28, v28 row_ror:2 row_mask:0xf bank_mask:0xf
    v_add_f32_dpp v29, v29, v29 row_ror:2 row_mask:0xf bank_mask:0xf
    v_add_f32_dpp v30, v30, v30 row_ror:2 row_mask:0xf bank_mask:0xf
    v_add_f32_dpp v31, v31, v31 row_ror:2 row_mask:0xf bank_mask:0xf
    v_add_f32_dpp v28, v28, v28 row_ror:1 row_mask:0xf bank_mask:0xf
    v_add_f32_dpp v29, v29, v29 row_ror:1 row_mask:0xf bank_mask:0xf
    v_add_f32_dpp v30, v30, v30 row_ror:1 row_mask:0xf bank_mask:0xf
    v_add_f32_dpp v31, v31, v31 row_ror:1 row_mask:0xf bank_mask:0xf
    s_waitcnt vmcnt(2)
    buffer_load_dwordx4 v[140:143], v6, s[48:51], s61 offen nt
    s_add_u32 s61, s61, 11264
    s_waitcnt vmcnt(2)
    buffer_load_dwordx4 v[144:147], v6, s[48:51], s61 offen nt
    s_add_u32 s61, s61, 11264
    v_add_f32 v8, s62, v8
    v_add_f32 v9, s62, v9
    v_max3_f32 v160, v8, v9, v10
    v_max3_f32 v160, v160, v11, v12
    v_max3_f32 v160, v160, v13, v14
    v_max3_f32 v160, v160, v15, v16
    v_max3_f32 v160, v160, v17, v18
    v_max3_f32 v160, v160, v19, v20
    v_max3_f32 v160, v160, v21, v22
    v_max3_f32 v160, v160, v23, v24
    v_max3_f32 v160, v160, v25, v26
    v_max3_f32 v160, v160, v27, v28
    v_max3_f32 v160, v160, v29, v30
    v_max_f32 v160, v160, v31
    v_mov_b32 v161, v160
    s_nop 1
    v_permlane32_swap_b32 v160, v161
    v_max_f32 v160, v160, v161
    v_mov_b32 v161, v160
    s_nop 1
    v_permlane16_swap_b32 v160, v161
    v_max_f32 v160, v160, v161
    v_mul_f32 v160, s64, v160
    v_fma_f32 v8, v8, s64, -v160
    v_fma_f32 v9, v9, s64, -v160
    v_fma_f32 v10, v10, s64, -v160
    v_fma_f32 v11, v11, s64, -v160
    v_fma_f32 v12, v12, s64, -v160
    v_fma_f32 v13, v13, s64, -v160
    v_fma_f32 v14, v14, s64, -v160
    v_fma_f32 v15, v15, s64, -v160
    v_fma_f32 v16, v16, s64, -v160
    v_fma_f32 v17, v17, s64, -v160
    v_fma_f32 v18, v18, s64, -v160
    v_fma_f32 v19, v19, s64, -v160
    v_fma_f32 v20, v20, s64, -v160
    v_fma_f32 v21, v21, s64, -v160
    v_fma_f32 v22, v22, s64, -v160
    v_fma_f32 v23, v23, s64, -v160
    v_fma_f32 v24, v24, s64, -v160
    v_fma_f32 v25, v25, s64, -v160
    v_fma_f32 v26, v26, s64, -v160
    v_fma_f32 v27, v27, s64, -v160
    v_fma_f32 v28, v28, s64, -v160
    v_fma_f32 v29, v29, s64, -v160
    v_fma_f32 v30, v30, s64, -v160
    v_fma_f32 v31, v31, s64, -v160
    v_exp_f32 v8, v8
    v_exp_f32 v9, v9
    v_exp_f32 v10, v10
    v_exp_f32 v11, v11
    v_exp_f32 v12, v12
    v_exp_f32 v13, v13
    v_exp_f32 v14, v14
    v_exp_f32 v15, v15
    v_exp_f32 v16, v16
    v_exp_f32 v17, v17
    v_exp_f32 v18, v18
    v_exp_f32 v19, v19
    v_exp_f32 v20, v20
    v_exp_f32 v21, v21
    v_exp_f32 v22, v22
    v_exp_f32 v23, v23
    v_exp_f32 v24, v24
    v_exp_f32 v25, v25
    v_exp_f32 v26, v26
    v_exp_f32 v27, v27
    v_exp_f32 v28, v28
    v_exp_f32 v29, v29
    v_exp_f32 v30, v30
    v_exp_f32 v31, v31
    s_waitcnt vmcnt(2)
    buffer_load_dwordx4 v[148:151], v6, s[48:51], s61 offen nt
    s_add_u32 s61, s61, 11264
    v_add_f32 v162, v8, v9
    v_add_f32 v163, v10, v11
    v_add_f32 v162, v162, v12
    v_add_f32 v163, v163, v13
    v_add_f32 v162, v162, v14
    v_add_f32 v163, v163, v15
    v_add_f32 v162, v162, v16
    v_add_f32 v163, v163, v17
    v_add_f32 v162, v162, v18
    v_add_f32 v163, v163, v19
    v_add_f32 v162, v162, v20
    v_add_f32 v163, v163, v21
    v_add_f32 v162, v162, v22
    v_add_f32 v163, v163, v23
    v_add_f32 v162, v162, v24
    v_add_f32 v163, v163, v25
    v_add_f32 v162, v162, v26
    v_add_f32 v163, v163, v27
    v_add_f32 v162, v162, v28
    v_add_f32 v163, v163, v29
    v_add_f32 v162, v162, v30
    v_add_f32 v163, v163, v31
    v_add_f32 v162, v162, v163
    v_mov_b32 v163, v162
    s_nop 1
    v_permlane32_swap_b32 v162, v163
    v_add_f32 v162, v162, v163
    v_mov_b32 v163, v162
    s_nop 1
    v_permlane16_swap_b32 v162, v163
    v_add_f32 v161, v162, v163
    s_lshl_b32 s7, s3, 3
    s_add_u32 s7, s7, 0x24200
    v_mov_b32 v164, s7
    ds_write_b64 v164, v[160:161]
    v_mov_b32 v164, 0x24008
    v_mov_b32 v165, 1
    s_waitcnt lgkmcnt(0)
    s_mov_b64 exec, 1
    ds_add_u32 v164, v165
    s_mov_b64 exec, -1
    v_and_b32 v2, 15, v1
    v_lshlrev_b32 v2, 5, v2
    v_bfe_u32 v3, v1, 5, 1
    v_lshl_add_u32 v2, v3, 4, v2
    v_bfe_u32 v3, v1, 4, 1
    v_lshl_add_u32 v2, v3, 3, v2
    s_lshl_b32 s7, s3, 9
    s_add_u32 s7, s7, 0x10000
    v_add_u32 v2, s7, v2
    s_waitcnt vmcnt(2)
    buffer_load_dwordx4 v[32:35], v6, s[48:51], s61 offen nt
    s_add_u32 s61, s61, 11264
    v_lshlrev_b32 v160, 16, v128
    v_and_b32 v161, 0xffff0000, v128
    v_lshlrev_b32 v162, 16, v129
    v_and_b32 v163, 0xffff0000, v129
    v_lshlrev_b32 v164, 16, v130
    v_and_b32 v165, 0xffff0000, v130
    v_lshlrev_b32 v166, 16, v131
    v_and_b32 v167, 0xffff0000, v131
    v_pk_mul_f32 v[152:153], v[160:161], v[10:11] op_sel_hi:[1,0]
    v_pk_mul_f32 v[154:155], v[162:163], v[10:11] op_sel_hi:[1,0]
    v_pk_mul_f32 v[156:157], v[164:165], v[10:11] op_sel_hi:[1,0]
    v_pk_mul_f32 v[158:159], v[166:167], v[10:11] op_sel_hi:[1,0]
    v_lshlrev_b32 v160, 16, v132
    v_and_b32 v161, 0xffff0000, v132
    v_lshlrev_b32 v162, 16, v133
    v_and_b32 v163, 0xffff0000, v133
    v_lshlrev_b32 v164, 16, v134
    v_and_b32 v165, 0xffff0000, v134
    v_lshlrev_b32 v166, 16, v135
    v_and_b32 v167, 0xffff0000, v135
    v_pk_fma_f32 v[152:153], v[160:161], v[10:11], v[152:153] op_sel:[0,1,0] op_sel_hi:[1,1,1]
    v_pk_fma_f32 v[154:155], v[162:163], v[10:11], v[154:155] op_sel:[0,1,0] op_sel_hi:[1,1,1]
    v_pk_fma_f32 v[156:157], v[164:165], v[10:11], v[156:157] op_sel:[0,1,0] op_sel_hi:[1,1,1]
    v_pk_fma_f32 v[158:159], v[166:167], v[10:11], v[158:159] op_sel:[0,1,0] op_sel_hi:[1,1,1]
    s_waitcnt vmcnt(2)
    buffer_load_dwordx4 v[36:39], v6, s[48:51], s61 offen nt
    s_add_u32 s61, s61, 11264
    v_lshlrev_b32 v160, 16, v136
    v_and_b32 v161, 0xffff0000, v136
    v_lshlrev_b32 v162, 16, v137
    v_and_b32 v163, 0xffff0000, v137
    v_lshlrev_b32 v164, 16, v138
    v_and_b32 v165, 0xffff0000, v138
    v_lshlrev_b32 v166, 16, v139
    v_and_b32 v167, 0xffff0000, v139
    v_pk_fma_f32 v[152:153], v[160:161], v[12:13], v[152:153] op_sel_hi:[1,0,1]
    v_pk_fma_f32 v[154:155], v[162:163], v[12:13], v[154:155] op_sel_hi:[1,0,1]
    v_pk_fma_f32 v[156:157], v[164:165], v[12:13], v[156:157] op_sel_hi:[1,0,1]
    v_pk_fma_f32 v[158:159], v[166:167], v[12:13], v[158:159] op_sel_hi:[1,0,1]
    v_lshlrev_b32 v160, 16, v140
    v_and_b32 v161, 0xffff0000, v140
    v_lshlrev_b32 v162, 16, v141
    v_and_b32 v163, 0xffff0000, v141
    v_lshlrev_b32 v164, 16, v142
    v_and_b32 v165, 0xffff0000, v142
    v_lshlrev_b32 v166, 16, v143
    v_and_b32 v167, 0xffff0000, v143
    v_pk_fma_f32 v[152:153], v[160:161], v[12:13], v[152:153] op_sel:[0,1,0] op_sel_hi:[1,1,1]
    v_pk_fma_f32 v[154:155], v[162:163], v[12:13], v[154:155] op_sel:[0,1,0] op_sel_hi:[1,1,1]
    v_pk_fma_f32 v[156:157], v[164:165], v[12:13], v[156:157] op_sel:[0,1,0] op_sel_hi:[1,1,1]
    v_pk_fma_f32 v[158:159], v[166:167], v[12:13], v[158:159] op_sel:[0,1,0] op_sel_hi:[1,1,1]
    s_waitcnt vmcnt(2)
    buffer_load_dwordx4 v[40:43], v6, s[48:51], s61 offen nt
    s_add_u32 s61, s61, 11264
    v_lshlrev_b32 v160, 16, v144
    v_and_b32 v161, 0xffff0000, v144
    v_lshlrev_b32 v162, 16, v145
    v_and_b32 v163, 0xffff0000, v145
    v_lshlrev_b32 v164, 16, v146
    v_and_b32 v165, 0xffff0000, v146
    v_lshlrev_b32 v166, 16, v147
    v_and_b32 v167, 0xffff0000, v147
    v_pk_fma_f32 v[152:153], v[160:161], v[14:15], v[152:153] op_sel_hi:[1,0,1]
    v_pk_fma_f32 v[154:155], v[162:163], v[14:15], v[154:155] op_sel_hi:[1,0,1]
    v_pk_fma_f32 v[156:157], v[164:165], v[14:15], v[156:157] op_sel_hi:[1,0,1]
    v_pk_fma_f32 v[158:159], v[166:167], v[14:15], v[158:159] op_sel_hi:[1,0,1]
    v_lshlrev_b32 v160, 16, v148
    v_and_b32 v161, 0xffff0000, v148
    v_lshlrev_b32 v162, 16, v149
    v_and_b32 v163, 0xffff0000, v149
    v_lshlrev_b32 v164, 16, v150
    v_and_b32 v165, 0xffff0000, v150
    v_lshlrev_b32 v166, 16, v151
    v_and_b32 v167, 0xffff0000, v151
    v_pk_fma_f32 v[152:153], v[160:161], v[14:15], v[152:153] op_sel:[0,1,0] op_sel_hi:[1,1,1]
    v_pk_fma_f32 v[154:155], v[162:163], v[14:15], v[154:155] op_sel:[0,1,0] op_sel_hi:[1,1,1]
    v_pk_fma_f32 v[156:157], v[164:165], v[14:15], v[156:157] op_sel:[0,1,0] op_sel_hi:[1,1,1]
    v_pk_fma_f32 v[158:159], v[166:167], v[14:15], v[158:159] op_sel:[0,1,0] op_sel_hi:[1,1,1]
    s_waitcnt vmcnt(2)
    buffer_load_dwordx4 v[44:47], v6, s[48:51], s61 offen nt
    s_add_u32 s61, s61, 11264
    v_lshlrev_b32 v160, 16, v32
    v_and_b32 v161, 0xffff0000, v32
    v_lshlrev_b32 v162, 16, v33
    v_and_b32 v163, 0xffff0000, v33
    v_lshlrev_b32 v164, 16, v34
    v_and_b32 v165, 0xffff0000, v34
    v_lshlrev_b32 v166, 16, v35
    v_and_b32 v167, 0xffff0000, v35
    v_pk_fma_f32 v[152:153], v[160:161], v[16:17], v[152:153] op_sel_hi:[1,0,1]
    v_pk_fma_f32 v[154:155], v[162:163], v[16:17], v[154:155] op_sel_hi:[1,0,1]
    v_pk_fma_f32 v[156:157], v[164:165], v[16:17], v[156:157] op_sel_hi:[1,0,1]
    v_pk_fma_f32 v[158:159], v[166:167], v[16:17], v[158:159] op_sel_hi:[1,0,1]
    s_waitcnt vmcnt(2)
    buffer_load_dwordx4 v[48:51], v6, s[48:51], s61 offen nt
    s_add_u32 s61, s61, 11264
    v_lshlrev_b32 v160, 16, v36
    v_and_b32 v161, 0xffff0000, v36
    v_lshlrev_b32 v162, 16, v37
    v_and_b32 v163, 0xffff0000, v37
    v_lshlrev_b32 v164, 16, v38
    v_and_b32 v165, 0xffff0000, v38
    v_lshlrev_b32 v166, 16, v39
    v_and_b32 v167, 0xffff0000, v39
    v_pk_fma_f32 v[152:153], v[160:161], v[16:17], v[152:153] op_sel:[0,1,0] op_sel_hi:[1,1,1]
    v_pk_fma_f32 v[154:155], v[162:163], v[16:17], v[154:155] op_sel:[0,1,0] op_sel_hi:[1,1,1]
    v_pk_fma_f32 v[156:157], v[164:165], v[16:17], v[156:157] op_sel:[0,1,0] op_sel_hi:[1,1,1]
    v_pk_fma_f32 v[158:159], v[166:167], v[16:17], v[158:159] op_sel:[0,1,0] op_sel_hi:[1,1,1]
    s_waitcnt vmcnt(2)
    buffer_load_dwordx4 v[52:55], v6, s[48:51], s61 offen nt
    s_add_u32 s61, s61, 11264
    v_lshlrev_b32 v160, 16, v40
    v_and_b32 v161, 0xffff0000, v40
    v_lshlrev_b32 v162, 16, v41
    v_and_b32 v163, 0xffff0000, v41
    v_lshlrev_b32 v164, 16, v42
    v_and_b32 v165, 0xffff0000, v42
    v_lshlrev_b32 v166, 16, v43
    v_and_b32 v167, 0xffff0000, v43
    v_pk_fma_f32 v[152:153], v[160:161], v[18:19], v[152:153] op_sel_hi:[1,0,1]
    v_pk_fma_f32 v[154:155], v[162:163], v[18:19], v[154:155] op_sel_hi:[1,0,1]
    v_pk_fma_f32 v[156:157], v[164:165], v[18:19], v[156:157] op_sel_hi:[1,0,1]
    v_pk_fma_f32 v[158:159], v[166:167], v[18:19], v[158:159] op_sel_hi:[1,0,1]
    s_waitcnt vmcnt(2)
    buffer_load_dwordx4 v[56:59], v6, s[48:51], s61 offen nt
    s_add_u32 s61, s61, 11264
    v_lshlrev_b32 v160, 16, v44
    v_and_b32 v161, 0xffff0000, v44
    v_lshlrev_b32 v162, 16, v45
    v_and_b32 v163, 0xffff0000, v45
    v_lshlrev_b32 v164, 16, v46
    v_and_b32 v165, 0xffff0000, v46
    v_lshlrev_b32 v166, 16, v47
    v_and_b32 v167, 0xffff0000, v47
    v_pk_fma_f32 v[152:153], v[160:161], v[18:19], v[152:153] op_sel:[0,1,0] op_sel_hi:[1,1,1]
    v_pk_fma_f32 v[154:155], v[162:163], v[18:19], v[154:155] op_sel:[0,1,0] op_sel_hi:[1,1,1]
    v_pk_fma_f32 v[156:157], v[164:165], v[18:19], v[156:157] op_sel:[0,1,0] op_sel_hi:[1,1,1]
    v_pk_fma_f32 v[158:159], v[166:167], v[18:19], v[158:159] op_sel:[0,1,0] op_sel_hi:[1,1,1]
    s_waitcnt vmcnt(2)
    buffer_load_dwordx4 v[60:63], v6, s[48:51], s61 offen nt
    s_add_u32 s61, s61, 11264
    v_lshlrev_b32 v160, 16, v48
    v_and_b32 v161, 0xffff0000, v48
    v_lshlrev_b32 v162, 16, v49
    v_and_b32 v163, 0xffff0000, v49
    v_lshlrev_b32 v164, 16, v50
    v_and_b32 v165, 0xffff0000, v50
    v_lshlrev_b32 v166, 16, v51
    v_and_b32 v167, 0xffff0000, v51
    v_pk_fma_f32 v[152:153], v[160:161], v[20:21], v[152:153] op_sel_hi:[1,0,1]
    v_pk_fma_f32 v[154:155], v[162:163], v[20:21], v[154:155] op_sel_hi:[1,0,1]
    v_pk_fma_f32 v[156:157], v[164:165], v[20:21], v[156:157] op_sel_hi:[1,0,1]
    v_pk_fma_f32 v[158:159], v[166:167], v[20:21], v[158:159] op_sel_hi:[1,0,1]
    s_waitcnt vmcnt(2)
    buffer_load_dwordx4 v[64:67], v6, s[48:51], s61 offen nt
    s_add_u32 s61, s61, 11264
    v_lshlrev_b32 v160, 16, v52
    v_and_b32 v161, 0xffff0000, v52
    v_lshlrev_b32 v162, 16, v53
    v_and_b32 v163, 0xffff0000, v53
    v_lshlrev_b32 v164, 16, v54
    v_and_b32 v165, 0xffff0000, v54
    v_lshlrev_b32 v166, 16, v55
    v_and_b32 v167, 0xffff0000, v55
    v_pk_fma_f32 v[152:153], v[160:161], v[20:21], v[152:153] op_sel:[0,1,0] op_sel_hi:[1,1,1]
    v_pk_fma_f32 v[154:155], v[162:163], v[20:21], v[154:155] op_sel:[0,1,0] op_sel_hi:[1,1,1]
    v_pk_fma_f32 v[156:157], v[164:165], v[20:21], v[156:157] op_sel:[0,1,0] op_sel_hi:[1,1,1]
    v_pk_fma_f32 v[158:159], v[166:167], v[20:21], v[158:159] op_sel:[0,1,0] op_sel_hi:[1,1,1]
    s_waitcnt vmcnt(2)
    buffer_load_dwordx4 v[68:71], v6, s[48:51], s61 offen nt
    s_add_u32 s61, s61, 11264
    v_lshlrev_b32 v160, 16, v56
    v_and_b32 v161, 0xffff0000, v56
    v_lshlrev_b32 v162, 16, v57
    v_and_b32 v163, 0xffff0000, v57
    v_lshlrev_b32 v164, 16, v58
    v_and_b32 v165, 0xffff0000, v58
    v_lshlrev_b32 v166, 16, v59
    v_and_b32 v167, 0xffff0000, v59
    v_pk_fma_f32 v[152:153], v[160:161], v[22:23], v[152:153] op_sel_hi:[1,0,1]
    v_pk_fma_f32 v[154:155], v[162:163], v[22:23], v[154:155] op_sel_hi:[1,0,1]
    v_pk_fma_f32 v[156:157], v[164:165], v[22:23], v[156:157] op_sel_hi:[1,0,1]
    v_pk_fma_f32 v[158:159], v[166:167], v[22:23], v[158:159] op_sel_hi:[1,0,1]
    s_waitcnt vmcnt(2)
    buffer_load_dwordx4 v[72:75], v6, s[48:51], s61 offen nt
    s_add_u32 s61, s61, 11264
    v_lshlrev_b32 v160, 16, v60
    v_and_b32 v161, 0xffff0000, v60
    v_lshlrev_b32 v162, 16, v61
    v_and_b32 v163, 0xffff0000, v61
    v_lshlrev_b32 v164, 16, v62
    v_and_b32 v165, 0xffff0000, v62
    v_lshlrev_b32 v166, 16, v63
    v_and_b32 v167, 0xffff0000, v63
    v_pk_fma_f32 v[152:153], v[160:161], v[22:23], v[152:153] op_sel:[0,1,0] op_sel_hi:[1,1,1]
    v_pk_fma_f32 v[154:155], v[162:163], v[22:23], v[154:155] op_sel:[0,1,0] op_sel_hi:[1,1,1]
    v_pk_fma_f32 v[156:157], v[164:165], v[22:23], v[156:157] op_sel:[0,1,0] op_sel_hi:[1,1,1]
    v_pk_fma_f32 v[158:159], v[166:167], v[22:23], v[158:159] op_sel:[0,1,0] op_sel_hi:[1,1,1]
    s_waitcnt vmcnt(2)
    buffer_load_dwordx4 v[76:79], v6, s[48:51], s61 offen nt
    s_add_u32 s61, s61, 11264
    v_lshlrev_b32 v160, 16, v64
    v_and_b32 v161, 0xffff0000, v64
    v_lshlrev_b32 v162, 16, v65
    v_and_b32 v163, 0xffff0000, v65
    v_lshlrev_b32 v164, 16, v66
    v_and_b32 v165, 0xffff0000, v66
    v_lshlrev_b32 v166, 16, v67
    v_and_b32 v167, 0xffff0000, v67
    v_pk_fma_f32 v[152:153], v[160:161], v[24:25], v[152:153] op_sel_hi:[1,0,1]
    v_pk_fma_f32 v[154:155], v[162:163], v[24:25], v[154:155] op_sel_hi:[1,0,1]
    v_pk_fma_f32 v[156:157], v[164:165], v[24:25], v[156:157] op_sel_hi:[1,0,1]
    v_pk_fma_f32 v[158:159], v[166:167], v[24:25], v[158:159] op_sel_hi:[1,0,1]
    s_waitcnt vmcnt(2)
    buffer_load_dwordx4 v[80:83], v6, s[48:51], s61 offen nt
    s_add_u32 s61, s61, 11264
    v_lshlrev_b32 v160, 16, v68
    v_and_b32 v161, 0xffff0000, v68
    v_lshlrev_b32 v162, 16, v69
    v_and_b32 v163, 0xffff0000, v69
    v_lshlrev_b32 v164, 16, v70
    v_and_b32 v165, 0xffff0000, v70
    v_lshlrev_b32 v166, 16, v71
    v_and_b32 v167, 0xffff0000, v71
    v_pk_fma_f32 v[152:153], v[160:161], v[24:25], v[152:153] op_sel:[0,1,0] op_sel_hi:[1,1,1]
    v_pk_fma_f32 v[154:155], v[162:163], v[24:25], v[154:155] op_sel:[0,1,0] op_sel_hi:[1,1,1]
    v_pk_fma_f32 v[156:157], v[164:165], v[24:25], v[156:157] op_sel:[0,1,0] op_sel_hi:[1,1,1]
    v_pk_fma_f32 v[158:159], v[166:167], v[24:25], v[158:159] op_sel:[0,1,0] op_sel_hi:[1,1,1]
    s_waitcnt vmcnt(2)
    buffer_load_dwordx4 v[84:87], v6, s[48:51], s61 offen nt
    s_add_u32 s61, s61, 11264
    v_lshlrev_b32 v160, 16, v72
    v_and_b32 v161, 0xffff0000, v72
    v_lshlrev_b32 v162, 16, v73
    v_and_b32 v163, 0xffff0000, v73
    v_lshlrev_b32 v164, 16, v74
    v_and_b32 v165, 0xffff0000, v74
    v_lshlrev_b32 v166, 16, v75
    v_and_b32 v167, 0xffff0000, v75
    v_pk_fma_f32 v[152:153], v[160:161], v[26:27], v[152:153] op_sel_hi:[1,0,1]
    v_pk_fma_f32 v[154:155], v[162:163], v[26:27], v[154:155] op_sel_hi:[1,0,1]
    v_pk_fma_f32 v[156:157], v[164:165], v[26:27], v[156:157] op_sel_hi:[1,0,1]
    v_pk_fma_f32 v[158:159], v[166:167], v[26:27], v[158:159] op_sel_hi:[1,0,1]
    s_waitcnt vmcnt(2)
    buffer_load_dwordx4 v[88:91], v6, s[48:51], s61 offen nt
    s_add_u32 s61, s61, 11264
    v_lshlrev_b32 v160, 16, v76
    v_and_b32 v161, 0xffff0000, v76
    v_lshlrev_b32 v162, 16, v77
    v_and_b32 v163, 0xffff0000, v77
    v_lshlrev_b32 v164, 16, v78
    v_and_b32 v165, 0xffff0000, v78
    v_lshlrev_b32 v166, 16, v79
    v_and_b32 v167, 0xffff0000, v79
    v_pk_fma_f32 v[152:153], v[160:161], v[26:27], v[152:153] op_sel:[0,1,0] op_sel_hi:[1,1,1]
    v_pk_fma_f32 v[154:155], v[162:163], v[26:27], v[154:155] op_sel:[0,1,0] op_sel_hi:[1,1,1]
    v_pk_fma_f32 v[156:157], v[164:165], v[26:27], v[156:157] op_sel:[0,1,0] op_sel_hi:[1,1,1]
    v_pk_fma_f32 v[158:159], v[166:167], v[26:27], v[158:159] op_sel:[0,1,0] op_sel_hi:[1,1,1]
    s_waitcnt vmcnt(2)
    buffer_load_dwordx4 v[92:95], v6, s[48:51], s61 offen nt
    v_lshlrev_b32 v160, 16, v80
    v_and_b32 v161, 0xffff0000, v80
    v_lshlrev_b32 v162, 16, v81
    v_and_b32 v163, 0xffff0000, v81
    v_lshlrev_b32 v164, 16, v82
    v_and_b32 v165, 0xffff0000, v82
    v_lshlrev_b32 v166, 16, v83
    v_and_b32 v167, 0xffff0000, v83
    v_pk_fma_f32 v[152:153], v[160:161], v[28:29], v[152:153] op_sel_hi:[1,0,1]
    v_pk_fma_f32 v[154:155], v[162:163], v[28:29], v[154:155] op_sel_hi:[1,0,1]
    v_pk_fma_f32 v[156:157], v[164:165], v[28:29], v[156:157] op_sel_hi:[1,0,1]
    v_pk_fma_f32 v[158:159], v[166:167], v[28:29], v[158:159] op_sel_hi:[1,0,1]
    s_cmp_eq_u32 s62, 0
    s_cbranch_scc1 AL_9
    s_waitcnt vmcnt(2)
    v_lshlrev_b32 v160, 16, v84
    v_and_b32 v161, 0xffff0000, v84
    v_lshlrev_b32 v162, 16, v85
    v_and_b32 v163, 0xffff0000, v85
    v_lshlrev_b32 v164, 16, v86
    v_and_b32 v165, 0xffff0000, v86
    v_lshlrev_b32 v166, 16, v87
    v_and_b32 v167, 0xffff0000, v87
    v_pk_fma_f32 v[152:153], v[160:161], v[28:29], v[152:153] op_sel:[0,1,0] op_sel_hi:[1,1,1]
    v_pk_fma_f32 v[154:155], v[162:163], v[28:29], v[154:155] op_sel:[0,1,0] op_sel_hi:[1,1,1]
    v_pk_fma_f32 v[156:157], v[164:165], v[28:29], v[156:157] op_sel:[0,1,0] op_sel_hi:[1,1,1]
    v_pk_fma_f32 v[158:159], v[166:167], v[28:29], v[158:159] op_sel:[0,1,0] op_sel_hi:[1,1,1]
    s_waitcnt vmcnt(1)
    v_lshlrev_b32 v160, 16, v88
    v_and_b32 v161, 0xffff0000, v88
    v_lshlrev_b32 v162, 16, v89
    v_and_b32 v163, 0xffff0000, v89
    v_lshlrev_b32 v164, 16, v90
    v_and_b32 v165, 0xffff0000, v90
    v_lshlrev_b32 v166, 16, v91
    v_and_b32 v167, 0xffff0000, v91
    v_pk_fma_f32 v[152:153], v[160:161], v[30:31], v[152:153] op_sel_hi:[1,0,1]
    v_pk_fma_f32 v[154:155], v[162:163], v[30:31], v[154:155] op_sel_hi:[1,0,1]
    v_pk_fma_f32 v[156:157], v[164:165], v[30:31], v[156:157] op_sel_hi:[1,0,1]
    v_pk_fma_f32 v[158:159], v[166:167], v[30:31], v[158:159] op_sel_hi:[1,0,1]
    s_waitcnt vmcnt(0)
    v_lshlrev_b32 v160, 16, v92
    v_and_b32 v161, 0xffff0000, v92
    v_lshlrev_b32 v162, 16, v93
    v_and_b32 v163, 0xffff0000, v93
    v_lshlrev_b32 v164, 16, v94
    v_and_b32 v165, 0xffff0000, v94
    v_lshlrev_b32 v166, 16, v95
    v_and_b32 v167, 0xffff0000, v95
    v_pk_fma_f32 v[152:153], v[160:161], v[30:31], v[152:153] op_sel:[0,1,0] op_sel_hi:[1,1,1]
    v_pk_fma_f32 v[154:155], v[162:163], v[30:31], v[154:155] op_sel:[0,1,0] op_sel_hi:[1,1,1]
    v_pk_fma_f32 v[156:157], v[164:165], v[30:31], v[156:157] op_sel:[0,1,0] op_sel_hi:[1,1,1]
    v_pk_fma_f32 v[158:159], v[166:167], v[30:31], v[158:159] op_sel:[0,1,0] op_sel_hi:[1,1,1]
    s_branch L_AFIN
AL_9:
    s_waitcnt vmcnt(2)
    buffer_load_dwordx4 v[96:99], v6, s[48:51], s63 offen nt
    v_lshlrev_b32 v160, 16, v84
    v_and_b32 v161, 0xffff0000, v84
    v_lshlrev_b32 v162, 16, v85
    v_and_b32 v163, 0xffff0000, v85
    v_lshlrev_b32 v164, 16, v86
    v_and_b32 v165, 0xffff0000, v86
    v_lshlrev_b32 v166, 16, v87
    v_and_b32 v167, 0xffff0000, v87
    v_pk_fma_f32 v[152:153], v[160:161], v[28:29], v[152:153] op_sel:[0,1,0] op_sel_hi:[1,1,1]
    v_pk_fma_f32 v[154:155], v[162:163], v[28:29], v[154:155] op_sel:[0,1,0] op_sel_hi:[1,1,1]
    v_pk_fma_f32 v[156:157], v[164:165], v[28:29], v[156:157] op_sel:[0,1,0] op_sel_hi:[1,1,1]
    v_pk_fma_f32 v[158:159], v[166:167], v[28:29], v[158:159] op_sel:[0,1,0] op_sel_hi:[1,1,1]
    s_waitcnt vmcnt(2)
    buffer_load_dwordx4 v[100:103], v6, s[48:51], s65 offen nt
    v_lshlrev_b32 v160, 16, v88
    v_and_b32 v161, 0xffff0000, v88
    v_lshlrev_b32 v162, 16, v89
    v_and_b32 v163, 0xffff0000, v89
    v_lshlrev_b32 v164, 16, v90
    v_and_b32 v165, 0xffff0000, v90
    v_lshlrev_b32 v166, 16, v91
    v_and_b32 v167, 0xffff0000, v91
    v_pk_fma_f32 v[152:153], v[160:161], v[30:31], v[152:153] op_sel_hi:[1,0,1]
    v_pk_fma_f32 v[154:155], v[162:163], v[30:31], v[154:155] op_sel_hi:[1,0,1]
    v_pk_fma_f32 v[156:157], v[164:165], v[30:31], v[156:157] op_sel_hi:[1,0,1]
    v_pk_fma_f32 v[158:159], v[166:167], v[30:31], v[158:159] op_sel_hi:[1,0,1]
    s_waitcnt vmcnt(2)
    v_lshlrev_b32 v160, 16, v92
    v_and_b32 v161, 0xffff0000, v92
    v_lshlrev_b32 v162, 16, v93
    v_and_b32 v163, 0xffff0000, v93
    v_lshlrev_b32 v164, 16, v94
    v_and_b32 v165, 0xffff0000, v94
    v_lshlrev_b32 v166, 16, v95
    v_and_b32 v167, 0xffff0000, v95
    v_pk_fma_f32 v[152:153], v[160:161], v[30:31], v[152:153] op_sel:[0,1,0] op_sel_hi:[1,1,1]
    v_pk_fma_f32 v[154:155], v[162:163], v[30:31], v[154:155] op_sel:[0,1,0] op_sel_hi:[1,1,1]
    v_pk_fma_f32 v[156:157], v[164:165], v[30:31], v[156:157] op_sel:[0,1,0] op_sel_hi:[1,1,1]
    v_pk_fma_f32 v[158:159], v[166:167], v[30:31], v[158:159] op_sel:[0,1,0] op_sel_hi:[1,1,1]
    s_waitcnt vmcnt(1)
    v_lshlrev_b32 v160, 16, v96
    v_and_b32 v161, 0xffff0000, v96
    v_lshlrev_b32 v162, 16, v97
    v_and_b32 v163, 0xffff0000, v97
    v_lshlrev_b32 v164, 16, v98
    v_and_b32 v165, 0xffff0000, v98
    v_lshlrev_b32 v166, 16, v99
    v_and_b32 v167, 0xffff0000, v99
    v_pk_fma_f32 v[152:153], v[160:161], v[8:9], v[152:153] op_sel_hi:[1,0,1]
    v_pk_fma_f32 v[154:155], v[162:163], v[8:9], v[154:155] op_sel_hi:[1,0,1]
    v_pk_fma_f32 v[156:157], v[164:165], v[8:9], v[156:157] op_sel_hi:[1,0,1]
    v_pk_fma_f32 v[158:159], v[166:167], v[8:9], v[158:159] op_sel_hi:[1,0,1]
    s_waitcnt vmcnt(0)
    v_lshlrev_b32 v160, 16, v100
    v_and_b32 v161, 0xffff0000, v100
    v_lshlrev_b32 v162, 16, v101
    v_and_b32 v163, 0xffff0000, v101
    v_lshlrev_b32 v164, 16, v102
    v_and_b32 v165, 0xffff0000, v102
    v_lshlrev_b32 v166, 16, v103
    v_and_b32 v167, 0xffff0000, v103
    v_pk_fma_f32 v[152:153], v[160:161], v[8:9], v[152:153] op_sel:[0,1,0] op_sel_hi:[1,1,1]
    v_pk_fma_f32 v[154:155], v[162:163], v[8:9], v[154:155] op_sel:[0,1,0] op_sel_hi:[1,1,1]
    v_pk_fma_f32 v[156:157], v[164:165], v[8:9], v[156:157] op_sel:[0,1,0] op_sel_hi:[1,1,1]
    v_pk_fma_f32 v[158:159], v[166:167], v[8:9], v[158:159] op_sel:[0,1,0] op_sel_hi:[1,1,1]
L_AFIN:
    s_nop 1
    v_permlane32_swap_b32 v152, v156
    v_permlane32_swap_b32 v153, v157
    v_permlane32_swap_b32 v154, v158
    v_permlane32_swap_b32 v155, v159
    v_add_f32 v152, v152, v156
    v_add_f32 v153, v153, v157
    v_add_f32 v154, v154, v158
    v_add_f32 v155, v155, v159
    s_nop 0
    v_permlane16_swap_b32 v152, v154
    v_permlane16_swap_b32 v153, v155
    v_add_f32 v152, v152, v154
    v_add_f32 v153, v153, v155
    ds_write_b64 v2, v[152:153]
    s_waitcnt lgkmcnt(0)
    s_barrier
    s_endpgm
L_ASVC:
    v_and_b32 v1, 63, v0
    s_and_b32 s7, s5, 3
    s_lshl_b32 s6, s4, 2
    s_add_u32 s6, s6, s7
    s_mov_b32 s92, 0x05040100
    s_mov_b32 s93, 0x07060302
    s_cmp_lg_u32 s3, 11
    s_cbranch_scc1 Z_10
    v_lshlrev_b32 v2, 2, v1
    v_add_u32 v2, 0x24000, v2
    v_mov_b32 v3, 0
    ds_write_b32 v2, v3
Z_10:
    s_waitcnt lgkmcnt(0)
    s_mov_b32 s36, s34
    s_and_b32 s37, s35, 0xffff
    s_mov_b32 s38, 0x1000000
    s_mov_b32 s39, 0x20000
    s_mov_b32 s40, s32
    s_and_b32 s41, s33, 0xffff
    s_mov_b32 s42, 0x100
    s_mov_b32 s43, 0x20000
    s_setprio 3
    s_lshr_b32 s60, s5, 2
    s_sub_u32 s60, s60, 4
    s_barrier
    s_lshl_b32 s7, s6, 2
    s_add_u32 s7, s7, s60
    s_lshl_b32 s7, s7, 11
    v_lshl_add_u32 v3, v1, 4, s7
    v_add_u32 v5, 0x40000, v3
    v_add_u32 v3, 0x80000, v3
    s_lshl_b32 s7, s6, 5
    s_add_u32 s7, s7, s60
    s_lshl_b32 s7, s7, 8
    s_add_u32 s7, s7, 0x80000
    v_lshrrev_b32 v6, 4, v1
    v_lshlrev_b32 v6, 11, v6
    v_and_b32 v100, 15, v1
    v_lshl_add_u32 v6, v100, 4, v6
    v_add_u32 v6, s7, v6
    s_sleep 8
    v_mov_b32 v90, 0
    s_mov_b32 s80, 200000
    s_mov_b64 exec, 1
    buffer_load_dwordx2 v[94:95], v90, s[40:43], 0 offen sc1
    s_sleep 16
    buffer_load_dwordx2 v[92:93], v90, s[40:43], 0 offen sc1
    s_mov_b64 exec, -1
    s_waitcnt vmcnt(1)
    v_readfirstlane_b32 s94, v94
    v_readfirstlane_b32 s95, v95
    s_cmp_lg_u32 s95, 0
    s_cbranch_scc1 NGD_12
    s_branch NG2_13
NG_11:
    s_mov_b64 exec, 1
    buffer_load_dwordx2 v[92:93], v90, s[40:43], 0 offen sc1
    s_mov_b64 exec, -1
NG2_13:
    s_waitcnt vmcnt(0)
    v_readfirstlane_b32 s94, v92
    v_readfirstlane_b32 s95, v93
    s_cmp_lg_u32 s95, 0
    s_cbranch_scc1 NGD_12
    s_sleep 4
    s_sub_u32 s80, s80, 1
    s_cmp_lg_u32 s80, 0
    s_cbranch_scc1 NG_11
NGD_12:
    v_lshlrev_b32 v7, 5, v1
    v_mov_b32 v114, s94
    v_mov_b32 v115, s95
    v_mov_b32 v118, s94
    v_mov_b32 v119, s95
    v_mov_b32 v122, s94
    v_mov_b32 v123, s95
    v_mov_b32 v126, s94
    v_mov_b32 v127, s95
    v_mov_b32 v100, 0x24044
    s_mov_b32 s80, 1600000
LW_14:
    ds_read_b32 v101, v100
    s_waitcnt lgkmcnt(0)
    v_readfirstlane_b32 s79, v101
    s_cmp_ge_u32 s79, 4
    s_cbranch_scc1 LWD_15
    s_sub_u32 s80, s80, 1
    s_cmp_lg_u32 s80, 0
    s_cbranch_scc1 LW_14
LWD_15:
    ds_read_b128 v[16:19], v7 offset:0
    ds_read_b128 v[20:23], v7 offset:16
    ds_read_b128 v[24:27], v7 offset:2048
    ds_read_b128 v[28:31], v7 offset:2064
    ds_read_b128 v[32:35], v7 offset:4096
    ds_read_b128 v[36:39], v7 offset:4112
    ds_read_b128 v[40:43], v7 offset:6144
    ds_read_b128 v[44:47], v7 offset:6160
    s_waitcnt lgkmcnt(0)
    v_add_f32 v16, v16, v32
    v_add_f32 v17, v17, v33
    v_add_f32 v18, v18, v34
    v_add_f32 v19, v19, v35
    v_add_f32 v20, v20, v36
    v_add_f32 v21, v21, v37
    v_add_f32 v22, v22, v38
    v_add_f32 v23, v23, v39
    v_add_f32 v24, v24, v40
    v_add_f32 v25, v25, v41
    v_add_f32 v26, v26, v42
    v_add_f32 v27, v27, v43
    v_add_f32 v28, v28, v44
    v_add_f32 v29, v29, v45
    v_add_f32 v30, v30, v46
    v_add_f32 v31, v31, v47
    v_add_f32 v16, v16, v24
    v_add_f32 v17, v17, v25
    v_add_f32 v18, v18, v26
    v_add_f32 v19, v19, v27
    v_add_f32 v20, v20, v28
    v_add_f32 v21, v21, v29
    v_add_f32 v22, v22, v30
    v_add_f32 v23, v23, v31
    v_cvt_pk_bf16_f32 v112, v16, v17
    v_cvt_pk_bf16_f32 v113, v18, v19
    v_cvt_pk_bf16_f32 v116, v20, v21
    v_cvt_pk_bf16_f32 v117, v22, v23
    buffer_store_dwordx4 v[112:115], v5, s[36:39], 0 offen offset:0
    buffer_store_dwordx4 v[116:119], v5, s[36:39], 0 offen offset:1024
    v_mov_b32 v100, 0x24018
    v_mov_b32 v101, 1
    s_waitcnt lgkmcnt(0)
    s_mov_b64 exec, 1
    ds_add_u32 v100, v101
    s_mov_b64 exec, -1
    v_mov_b32 v100, 0x24040
    s_mov_b32 s80, 1600000
LW_16:
    ds_read_b32 v101, v100
    s_waitcnt lgkmcnt(0)
    v_readfirstlane_b32 s79, v101
    s_cmp_ge_u32 s79, 4
    s_cbranch_scc1 LWD_17
    s_sub_u32 s80, s80, 1
    s_cmp_lg_u32 s80, 0
    s_cbranch_scc1 LW_16
LWD_17:
    ds_read_b128 v[16:19], v7 offset:8192
    ds_read_b128 v[20:23], v7 offset:8208
    ds_read_b128 v[24:27], v7 offset:10240
    ds_read_b128 v[28:31], v7 offset:10256
    ds_read_b128 v[32:35], v7 offset:12288
    ds_read_b128 v[36:39], v7 offset:12304
    ds_read_b128 v[40:43], v7 offset:14336
    ds_read_b128 v[44:47], v7 offset:14352
    s_waitcnt lgkmcnt(0)
    v_add_f32 v16, v16, v32
    v_add_f32 v17, v17, v33
    v_add_f32 v18, v18, v34
    v_add_f32 v19, v19, v35
    v_add_f32 v20, v20, v36
    v_add_f32 v21, v21, v37
    v_add_f32 v22, v22, v38
    v_add_f32 v23, v23, v39
    v_add_f32 v24, v24, v40
    v_add_f32 v25, v25, v41
    v_add_f32 v26, v26, v42
    v_add_f32 v27, v27, v43
    v_add_f32 v28, v28, v44
    v_add_f32 v29, v29, v45
    v_add_f32 v30, v30, v46
    v_add_f32 v31, v31, v47
    v_add_f32 v16, v16, v24
    v_add_f32 v17, v17, v25
    v_add_f32 v18, v18, v26
    v_add_f32 v19, v19, v27
    v_add_f32 v20, v20, v28
    v_add_f32 v21, v21, v29
    v_add_f32 v22, v22, v30
    v_add_f32 v23, v23, v31
    v_cvt_pk_bf16_f32 v120, v16, v17
    v_cvt_pk_bf16_f32 v121, v18, v19
    v_cvt_pk_bf16_f32 v124, v20, v21
    v_cvt_pk_bf16_f32 v125, v22, v23
    buffer_store_dwordx4 v[120:123], v6, s[36:39], 0 offen offset:0
    buffer_store_dwordx4 v[124:127], v6, s[36:39], 0 offen offset:1024
    v_mov_b32 v100, 0x24018
    v_mov_b32 v101, 1
    s_waitcnt lgkmcnt(0)
    s_mov_b64 exec, 1
    ds_add_u32 v100, v101
    s_mov_b64 exec, -1
    v_mov_b32 v110, v5
    v_mov_b32 v111, v6
    s_getreg_b32 s96, hwreg(HW_REG_XCC_ID, 0, 4)
    s_lshl_b32 s7, s4, 5
    s_add_u32 s7, s7, s5
    s_lshl_b32 s7, s7, 4
    s_add_u32 s7, s7, 0xc0000
    v_mov_b32 v100, s7
    v_mov_b32 v102, s96
    v_mov_b32 v103, 0
    v_mov_b32 v104, s94
    v_mov_b32 v105, s95
    s_mov_b64 exec, 1
    buffer_store_dwordx4 v[102:105], v100, s[36:39], 0 offen
    s_mov_b64 exec, -1
    s_sleep 16
    buffer_load_dwordx4 v[32:35], v3, s[36:39], 0 offen offset:0 sc1
    buffer_load_dwordx4 v[36:39], v3, s[36:39], 0 offen offset:1024 sc1
    s_mov_b32 s80, 200000
PS_18:
    s_waitcnt vmcnt(0)
    s_mov_b32 s78, 0
    v_cmp_ne_u64 vcc, s[94:95], v[34:35]
    s_cbranch_vccz PSS_20
    buffer_load_dwordx4 v[32:35], v3, s[36:39], 0 offen offset:0 sc1
    s_mov_b32 s78, 1
PSS_20:
    v_cmp_ne_u64 vcc, s[94:95], v[38:39]
    s_cbranch_vccz PSS_21
    buffer_load_dwordx4 v[36:39], v3, s[36:39], 0 offen offset:1024 sc1
    s_mov_b32 s78, 1
PSS_21:
    s_cmp_eq_u32 s78, 0
    s_cbranch_scc1 PSD_19
    s_sleep 8
    s_cmp_lg_u32 s80, 199984
    s_cbranch_scc1 PSL_22
    buffer_store_dwordx4 v[112:115], v110, s[36:39], 0 offen offset:0 sc1
    buffer_store_dwordx4 v[116:119], v110, s[36:39], 0 offen offset:1024 sc1
    buffer_store_dwordx4 v[120:123], v111, s[36:39], 0 offen offset:0 sc1
    buffer_store_dwordx4 v[124:127], v111, s[36:39], 0 offen offset:1024 sc1
PSL_22:
    s_sub_u32 s80, s80, 1
    s_cmp_lg_u32 s80, 0
    s_cbranch_scc1 PS_18
    s_waitcnt vmcnt(0)
PSD_19:
    v_lshlrev_b32 v16, 16, v32
    v_and_b32 v17, 0xffff0000, v32
    v_lshlrev_b32 v18, 16, v33
    v_and_b32 v19, 0xffff0000, v33
    v_lshlrev_b32 v20, 16, v36
    v_and_b32 v21, 0xffff0000, v36
    v_lshlrev_b32 v22, 16, v37
    v_and_b32 v23, 0xffff0000, v37
    v_mov_b32 v24, v16
    v_mov_b32 v25, v17
    v_mov_b32 v26, v18
    v_mov_b32 v27, v19
    v_mov_b32 v28, v20
    v_mov_b32 v29, v21
    v_mov_b32 v30, v22
    v_mov_b32 v31, v23
    v_permlane32_swap_b32 v16, v24
    v_permlane32_swap_b32 v17, v25
    v_permlane32_swap_b32 v18, v26
    v_permlane32_swap_b32 v19, v27
    v_permlane32_swap_b32 v20, v28
    v_permlane32_swap_b32 v21, v29
    v_permlane32_swap_b32 v22, v30
    v_permlane32_swap_b32 v23, v31
    v_add_f32 v16, v16, v24
    v_add_f32 v17, v17, v25
    v_add_f32 v18, v18, v26
    v_add_f32 v19, v19, v27
    v_add_f32 v20, v20, v28
    v_add_f32 v21, v21, v29
    v_add_f32 v22, v22, v30
    v_add_f32 v23, v23, v31
    v_mov_b32 v24, v16
    v_mov_b32 v25, v17
    v_mov_b32 v26, v18
    v_mov_b32 v27, v19
    v_mov_b32 v28, v20
    v_mov_b32 v29, v21
    v_mov_b32 v30, v22
    v_mov_b32 v31, v23
    v_permlane16_swap_b32 v16, v24
    v_permlane16_swap_b32 v17, v25
    v_permlane16_swap_b32 v18, v26
    v_permlane16_swap_b32 v19, v27
    v_permlane16_swap_b32 v20, v28
    v_permlane16_swap_b32 v21, v29
    v_permlane16_swap_b32 v22, v30
    v_permlane16_swap_b32 v23, v31
    v_add_f32 v16, v16, v24
    v_add_f32 v17, v17, v25
    v_add_f32 v18, v18, v26
    v_add_f32 v19, v19, v27
    v_add_f32 v20, v20, v28
    v_add_f32 v21, v21, v29
    v_add_f32 v22, v22, v30
    v_add_f32 v23, v23, v31
    v_cvt_pk_bf16_f32 v8, v16, v17
    v_cvt_pk_bf16_f32 v9, v18, v19
    v_cvt_pk_bf16_f32 v10, v20, v21
    v_cvt_pk_bf16_f32 v11, v22, v23
    v_and_b32 v100, 15, v1
    v_lshlrev_b32 v100, 4, v100
    v_add_u32 v100, 0x24100, v100
    ds_write_b128 v100, v[8:11]
L_ACUT:
    v_mov_b32 v100, 0x24004
    v_mov_b32 v101, 1
    s_waitcnt lgkmcnt(0)
    s_mov_b64 exec, 1
    ds_add_u32 v100, v101
    s_mov_b64 exec, -1
    v_mov_b32 v100, 0x24008
    s_mov_b32 s80, 1600000
LW_23:
    ds_read_b32 v101, v100
    s_waitcnt lgkmcnt(0)
    v_readfirstlane_b32 s79, v101
    s_cmp_ge_u32 s79, 11
    s_cbranch_scc1 LWD_24
    s_sleep 8
    s_sub_u32 s80, s80, 1
    s_cmp_lg_u32 s80, 0
    s_cbranch_scc1 LW_23
LWD_24:
    v_and_b32 v100, 31, v1
    s_lshl_b32 s7, s4, 9
    s_add_u32 s7, s7, 0xc0000
    v_lshl_add_u32 v100, v100, 4, s7
    buffer_load_dwordx4 v[32:35], v100, s[36:39], 0 offen sc1
    s_waitcnt vmcnt(0)
    v_cmp_ne_u64 vcc, s[94:95], v[34:35]
    v_cmp_ne_u32 s[86:87], s96, v32
    s_or_b32 s97, vcc_lo, s86
    s_and_b32 s97, s97, 0xffff00ff
    s_cbranch_scc0 AF_25
    buffer_store_dwordx4 v[112:115], v110, s[36:39], 0 offen offset:0 sc1
    buffer_store_dwordx4 v[116:119], v110, s[36:39], 0 offen offset:1024 sc1
    buffer_store_dwordx4 v[120:123], v111, s[36:39], 0 offen offset:0 sc1
    buffer_store_dwordx4 v[124:127], v111, s[36:39], 0 offen offset:1024 sc1
AF_25:
    v_mov_b32 v100, 0x24200
    ds_read_b128 v[8:11], v100 offset:0
    ds_read_b128 v[12:15], v100 offset:16
    ds_read_b128 v[16:19], v100 offset:32
    ds_read_b128 v[20:23], v100 offset:48
    ds_read_b128 v[24:27], v100 offset:64
    ds_read_b128 v[28:31], v100 offset:80
    s_waitcnt lgkmcnt(0)
    v_max3_f32 v100, v8, v10, v12
    v_max3_f32 v100, v100, v14, v16
    v_max3_f32 v100, v100, v18, v20
    v_max3_f32 v100, v100, v22, v24
    v_max3_f32 v100, v100, v26, v28
    v_sub_f32 v8, v8, v100
    v_sub_f32 v10, v10, v100
    v_sub_f32 v12, v12, v100
    v_sub_f32 v14, v14, v100
    v_sub_f32 v16, v16, v100
    v_sub_f32 v18, v18, v100
    v_sub_f32 v20, v20, v100
    v_sub_f32 v22, v22, v100
    v_sub_f32 v24, v24, v100
    v_sub_f32 v26, v26, v100
    v_sub_f32 v28, v28, v100
    v_exp_f32 v8, v8
    v_exp_f32 v10, v10
    v_exp_f32 v12, v12
    v_exp_f32 v14, v14
    v_exp_f32 v16, v16
    v_exp_f32 v18, v18
    v_exp_f32 v20, v20
    v_exp_f32 v22, v22
    v_exp_f32 v24, v24
    v_exp_f32 v26, v26
    v_exp_f32 v28, v28
    v_mul_f32 v101, v8, v9
    v_fmac_f32 v101, v10, v11
    v_fmac_f32 v101, v12, v13
    v_fmac_f32 v101, v14, v15
    v_fmac_f32 v101, v16, v17
    v_fmac_f32 v101, v18, v19
    v_fmac_f32 v101, v20, v21
    v_fmac_f32 v101, v22, v23
    v_fmac_f32 v101, v24, v25
    v_fmac_f32 v101, v26, v27
    v_fmac_f32 v101, v28, v29
    v_rcp_f32 v101, v101
    s_nop 0
    v_mul_f32 v8, v8, v101
    v_mul_f32 v10, v10, v101
    v_mul_f32 v12, v12, v101
    v_mul_f32 v14, v14, v101
    v_mul_f32 v16, v16, v101
    v_mul_f32 v18, v18, v101
    v_mul_f32 v20, v20, v101
    v_mul_f32 v22, v22, v101
    v_mul_f32 v24, v24, v101
    v_mul_f32 v26, v26, v101
    v_mul_f32 v28, v28, v101
    v_and_b32 v100, 15, v1
    v_bfe_u32 v101, v1, 4, 1
    v_lshlrev_b32 v3, 5, v100
    v_lshl_add_u32 v3, v101, 4, v3
    v_add_u32 v3, 0x10000, v3
    s_lshl_b32 s7, s6, 3
    s_add_u32 s7, s7, s60
    s_lshl_b32 s7, s7, 8
    s_add_u32 s7, s7, 0xd0000
    v_lshlrev_b32 v2, 4, v100
    v_lshl_add_u32 v2, v101, 10, v2
    v_add_u32 v2, s7, v2
    v_mov_b32 v6, s94
    v_mov_b32 v7, s95
    s_barrier
    ds_read_b128 v[40:43], v3 offset:0
    ds_read_b128 v[44:47], v3 offset:512
    ds_read_b128 v[48:51], v3 offset:1024
    ds_read_b128 v[52:55], v3 offset:1536
    ds_read_b128 v[56:59], v3 offset:2048
    ds_read_b128 v[60:63], v3 offset:2560
    ds_read_b128 v[64:67], v3 offset:3072
    ds_read_b128 v[68:71], v3 offset:3584
    ds_read_b128 v[72:75], v3 offset:4096
    ds_read_b128 v[76:79], v3 offset:4608
    ds_read_b128 v[80:83], v3 offset:5120
    s_waitcnt lgkmcnt(10)
    v_pk_mul_f32 v[32:33], v[40:41], v[8:9] op_sel_hi:[1,0]
    v_pk_mul_f32 v[34:35], v[42:43], v[8:9] op_sel_hi:[1,0]
    s_waitcnt lgkmcnt(9)
    v_pk_mul_f32 v[36:37], v[44:45], v[10:11] op_sel_hi:[1,0]
    v_pk_mul_f32 v[38:39], v[46:47], v[10:11] op_sel_hi:[1,0]
    s_waitcnt lgkmcnt(8)
    v_pk_fma_f32 v[32:33], v[48:49], v[12:13], v[32:33] op_sel_hi:[1,0,1]
    v_pk_fma_f32 v[34:35], v[50:51], v[12:13], v[34:35] op_sel_hi:[1,0,1]
    s_waitcnt lgkmcnt(7)
    v_pk_fma_f32 v[36:37], v[52:53], v[14:15], v[36:37] op_sel_hi:[1,0,1]
    v_pk_fma_f32 v[38:39], v[54:55], v[14:15], v[38:39] op_sel_hi:[1,0,1]
    s_waitcnt lgkmcnt(6)
    v_pk_fma_f32 v[32:33], v[56:57], v[16:17], v[32:33] op_sel_hi:[1,0,1]
    v_pk_fma_f32 v[34:35], v[58:59], v[16:17], v[34:35] op_sel_hi:[1,0,1]
    s_waitcnt lgkmcnt(5)
    v_pk_fma_f32 v[36:37], v[60:61], v[18:19], v[36:37] op_sel_hi:[1,0,1]
    v_pk_fma_f32 v[38:39], v[62:63], v[18:19], v[38:39] op_sel_hi:[1,0,1]
    s_waitcnt lgkmcnt(4)
    v_pk_fma_f32 v[32:33], v[64:65], v[20:21], v[32:33] op_sel_hi:[1,0,1]
    v_pk_fma_f32 v[34:35], v[66:67], v[20:21], v[34:35] op_sel_hi:[1,0,1]
    s_waitcnt lgkmcnt(3)
    v_pk_fma_f32 v[36:37], v[68:69], v[22:23], v[36:37] op_sel_hi:[1,0,1]
    v_pk_fma_f32 v[38:39], v[70:71], v[22:23], v[38:39] op_sel_hi:[1,0,1]
    s_waitcnt lgkmcnt(2)
    v_pk_fma_f32 v[32:33], v[72:73], v[24:25], v[32:33] op_sel_hi:[1,0,1]
    v_pk_fma_f32 v[34:35], v[74:75], v[24:25], v[34:35] op_sel_hi:[1,0,1]
    s_waitcnt lgkmcnt(1)
    v_pk_fma_f32 v[36:37], v[76:77], v[26:27], v[36:37] op_sel_hi:[1,0,1]
    v_pk_fma_f32 v[38:39], v[78:79], v[26:27], v[38:39] op_sel_hi:[1,0,1]
    s_waitcnt lgkmcnt(0)
    v_pk_fma_f32 v[32:33], v[80:81], v[28:29], v[32:33] op_sel_hi:[1,0,1]
    v_pk_fma_f32 v[34:35], v[82:83], v[28:29], v[34:35] op_sel_hi:[1,0,1]
    v_pk_add_f32 v[32:33], v[32:33], v[36:37]
    v_pk_add_f32 v[34:35], v[34:35], v[38:39]
    v_cvt_pk_bf16_f32 v4, v32, v33
    v_cvt_pk_bf16_f32 v5, v34, v35
    s_mov_b64 exec, 0xffffffff
    buffer_store_dwordx4 v[4:7], v2, s[36:39], 0 offen
    s_cmp_eq_u32 s97, 0
    s_cbranch_scc1 AF_26
    buffer_store_dwordx4 v[4:7], v2, s[36:39], 0 offen sc1
AF_26:
    s_mov_b64 exec, -1
    s_endpgm
L_W:
    v_and_b32 v1, 63, v0
    s_and_b32 s7, s5, 3
    s_lshl_b32 s6, s4, 2
    s_add_u32 s6, s6, s7
    s_mov_b32 s92, 0x05040100
    s_mov_b32 s93, 0x07060302
    s_waitcnt lgkmcnt(0)
    s_mov_b32 s36, s34
    s_and_b32 s37, s35, 0xffff
    s_mov_b32 s38, 0x1000000
    s_mov_b32 s39, 0x20000
    s_mov_b32 s40, s32
    s_and_b32 s41, s33, 0xffff
    s_mov_b32 s42, 0x100
    s_mov_b32 s43, 0x20000
    s_barrier
    s_cmp_ge_u32 s5, 4
    s_cbranch_scc1 L_PF
    v_mov_b32 v160, 0x24048
    s_mov_b32 s80, 1600000
LW_27:
    ds_read_b32 v161, v160
    s_waitcnt lgkmcnt(0)
    v_readfirstlane_b32 s79, v161
    s_cmp_ge_u32 s79, 4
    s_cbranch_scc1 LWD_28
    s_sleep 4
    s_sub_u32 s80, s80, 1
    s_cmp_lg_u32 s80, 0
    s_cbranch_scc1 LW_27
LWD_28:
    s_branch L_U1
L_PF:
    s_mov_b32 s44, s20
    s_and_b32 s45, s21, 0xffff
    s_mov_b32 s46, 0x1000000
    s_mov_b32 s47, 0x20000
    s_lshl_b32 s7, s4, 2
    s_add_u32 s7, s7, s5
    s_sub_u32 s7, s7, 4
    s_lshl_b32 s7, s7, 19
    s_lshl_b32 s60, s3, 10
    s_add_u32 s60, s60, s7
    s_add_u32 s60, s60, 196608
    s_add_u32 s61, s60, 0x40000
    v_lshlrev_b32 v2, 4, v1
    v_mov_b32 v160, 0x24048
    s_mov_b32 s80, 1600000
LW_29:
    ds_read_b32 v161, v160
    s_waitcnt lgkmcnt(0)
    v_readfirstlane_b32 s79, v161
    s_cmp_ge_u32 s79, 4
    s_cbranch_scc1 LWD_30
    s_sleep 4
    s_sub_u32 s80, s80, 1
    s_cmp_lg_u32 s80, 0
    s_cbranch_scc1 LW_29
LWD_30:
    s_mov_b32 s62, 16
PF_31:
    s_waitcnt vmcnt(7)
    buffer_load_dwordx4 v[4:7], v2, s[44:47], s60 offen
    s_add_u32 s60, s60, 4096
    s_waitcnt vmcnt(7)
    buffer_load_dwordx4 v[4:7], v2, s[44:47], s61 offen
    s_add_u32 s61, s61, 4096
    s_sub_u32 s62, s62, 1
    s_cmp_lg_u32 s62, 0
    s_cbranch_scc1 PF_31
    v_mov_b32 v160, 0x2405c
    v_mov_b32 v161, 1
    s_waitcnt lgkmcnt(0)
    s_mov_b64 exec, 1
    ds_add_u32 v160, v161
    s_mov_b64 exec, -1
    s_waitcnt vmcnt(0)
    s_branch L_END
L_W1:
    v_and_b32 v1, 63, v0
    s_and_b32 s7, s5, 3
    s_lshl_b32 s6, s4, 2
    s_add_u32 s6, s6, s7
    s_mov_b32 s92, 0x05040100
    s_mov_b32 s93, 0x07060302
    s_waitcnt lgkmcnt(0)
    s_mov_b32 s36, s34
    s_and_b32 s37, s35, 0xffff
    s_mov_b32 s38, 0x1000000
    s_mov_b32 s39, 0x20000
    s_mov_b32 s40, s32
    s_and_b32 s41, s33, 0xffff
    s_mov_b32 s42, 0x100
    s_mov_b32 s43, 0x20000
    s_setprio 3
    s_cmp_lg_u32 s3, 4
    s_cbranch_scc1 W4_32
    s_cmp_lg_u32 s2, 0
    s_cbranch_scc1 NM_33
    s_memrealtime s[94:95]
    v_mov_b32 v160, 0
    s_waitcnt lgkmcnt(0)
    s_or_b32 s95, s95, 0x80000000
    v_mov_b32 v162, s94
    v_mov_b32 v163, s95
    s_mov_b64 exec, 1
    buffer_store_dwordx2 v[162:163], v160, s[40:43], 0 offen sc1
    s_mov_b64 exec, -1
NM_33:
W4_32:
    s_barrier
    s_cmp_lg_u32 s3, 4
    s_cbranch_scc1 W4_34
    s_sleep 8
    v_mov_b32 v152, 0
    s_mov_b32 s80, 200000
    s_mov_b64 exec, 1
    buffer_load_dwordx2 v[156:157], v152, s[40:43], 0 offen sc1
    s_sleep 16
    buffer_load_dwordx2 v[154:155], v152, s[40:43], 0 offen sc1
    s_mov_b64 exec, -1
    s_waitcnt vmcnt(1)
    v_readfirstlane_b32 s94, v156
    v_readfirstlane_b32 s95, v157
    s_cmp_lg_u32 s95, 0
    s_cbranch_scc1 NGD_36
    s_branch NG2_37
NG_35:
    s_mov_b64 exec, 1
    buffer_load_dwordx2 v[154:155], v152, s[40:43], 0 offen sc1
    s_mov_b64 exec, -1
NG2_37:
    s_waitcnt vmcnt(0)
    v_readfirstlane_b32 s94, v154
    v_readfirstlane_b32 s95, v155
    s_cmp_lg_u32 s95, 0
    s_cbranch_scc1 NGD_36
    s_sleep 4
    s_sub_u32 s80, s80, 1
    s_cmp_lg_u32 s80, 0
    s_cbranch_scc1 NG_35
NGD_36:
    v_mov_b32 v160, 0x24050
    v_mov_b32 v162, s94
    v_mov_b32 v163, s95
    ds_write_b64 v160, v[162:163]
    v_mov_b32 v160, 0x2404c
    v_mov_b32 v161, 1
    s_waitcnt lgkmcnt(0)
    s_mov_b64 exec, 1
    ds_add_u32 v160, v161
    s_mov_b64 exec, -1
    s_getreg_b32 s96, hwreg(HW_REG_XCC_ID, 0, 4)
    s_lshl_b32 s7, s4, 5
    s_add_u32 s7, s7, s5
    s_lshl_b32 s7, s7, 4
    s_add_u32 s7, s7, 0xc0000
    v_mov_b32 v160, s7
    v_mov_b32 v162, s96
    v_mov_b32 v163, 0
    v_mov_b32 v164, s94
    v_mov_b32 v165, s95
    s_mov_b64 exec, 1
    buffer_store_dwordx4 v[162:165], v160, s[36:39], 0 offen
    s_mov_b64 exec, -1
W4_34:
    s_sub_u32 s62, s3, 4
    s_lshl_b32 s61, s4, 2
    s_add_u32 s61, s61, s62
    v_lshrrev_b32 v162, 4, v1
    v_and_b32 v161, 15, v1
    v_lshlrev_b32 v2, 16, v162
    v_lshl_add_u32 v2, v161, 4, v2
    s_lshl_b32 s7, s61, 3
    s_add_u32 s7, s7, s5
    s_lshl_b32 s7, s7, 8
    s_add_u32 s7, s7, 0x0
    v_add_u32 v2, s7, v2
    v_lshlrev_b32 v3, 6, v161
    v_lshl_add_u32 v3, v162, 4, v3
    s_lshl_b32 s7, s61, 13
    s_add_u32 s7, s7, 0x40000
    v_add_u32 v3, s7, v3
    v_xor_b32 v5, v162, v161
    v_lshlrev_b32 v5, 4, v5
    v_lshl_add_u32 v4, v161, 12, v5
    s_lshl_b32 s7, s62, 8
    v_add_u32 v4, s7, v4
    v_mov_b32 v160, 0x2404c
    s_mov_b32 s80, 1600000
LW_38:
    ds_read_b32 v161, v160
    s_waitcnt lgkmcnt(0)
    v_readfirstlane_b32 s79, v161
    s_cmp_ge_u32 s79, 1
    s_cbranch_scc1 LWD_39
    s_sleep 2
    s_sub_u32 s80, s80, 1
    s_cmp_lg_u32 s80, 0
    s_cbranch_scc1 LW_38
LWD_39:
    v_mov_b32 v160, 0x24050
    ds_read_b64 v[162:163], v160
    s_waitcnt lgkmcnt(0)
    v_readfirstlane_b32 s94, v162
    v_readfirstlane_b32 s95, v163
    s_sleep 4
    s_mov_b32 s63, 4096
    buffer_load_dwordx4 v[72:75], v3, s[36:39], 0 offen offset:0 sc1
    buffer_load_dwordx4 v[76:79], v3, s[36:39], 0 offen offset:1024 sc1
    buffer_load_dwordx4 v[80:83], v3, s[36:39], 0 offen offset:2048 sc1
    buffer_load_dwordx4 v[84:87], v3, s[36:39], 0 offen offset:3072 sc1
    buffer_load_dwordx4 v[88:91], v3, s[36:39], s63 offen offset:0 sc1
    buffer_load_dwordx4 v[92:95], v3, s[36:39], s63 offen offset:1024 sc1
    buffer_load_dwordx4 v[96:99], v3, s[36:39], s63 offen offset:2048 sc1
    buffer_load_dwordx4 v[100:103], v3, s[36:39], s63 offen offset:3072 sc1
    v_mov_b32 v160, 0x24014
    s_mov_b32 s80, 1600000
LW_42:
    ds_read_b32 v161, v160
    s_waitcnt lgkmcnt(0)
    v_readfirstlane_b32 s79, v161
    s_cmp_ge_u32 s79, 4
    s_cbranch_scc1 LWD_43
    s_sleep 1
    s_sub_u32 s80, s80, 1
    s_cmp_lg_u32 s80, 0
    s_cbranch_scc1 LW_42
LWD_43:
    v_xor_b32 v160, 0x0, v4
    v_xor_b32 v161, 0x40, v4
    v_xor_b32 v162, 0x80, v4
    v_xor_b32 v163, 0xc0, v4
    ds_read_b128 v[8:11], v160 offset:0
    ds_read_b128 v[12:15], v161 offset:0
    ds_read_b128 v[16:19], v162 offset:0
    ds_read_b128 v[20:23], v163 offset:0
    ds_read_b128 v[24:27], v160 offset:1024
    ds_read_b128 v[28:31], v161 offset:1024
    ds_read_b128 v[32:35], v162 offset:1024
    ds_read_b128 v[36:39], v163 offset:1024
    ds_read_b128 v[40:43], v160 offset:2048
    ds_read_b128 v[44:47], v161 offset:2048
    ds_read_b128 v[48:51], v162 offset:2048
    ds_read_b128 v[52:55], v163 offset:2048
    ds_read_b128 v[56:59], v160 offset:3072
    ds_read_b128 v[60:63], v161 offset:3072
    ds_read_b128 v[64:67], v162 offset:3072
    ds_read_b128 v[68:71], v163 offset:3072
    s_mov_b32 s80, 200000
PS_40:
    s_waitcnt vmcnt(0)
    s_mov_b32 s78, 0
    v_cmp_ne_u64 vcc, s[94:95], v[74:75]
    s_cbranch_vccz PSS_44
    buffer_load_dwordx4 v[72:75], v3, s[36:39], 0 offen offset:0 sc1
    s_mov_b32 s78, 1
PSS_44:
    v_cmp_ne_u64 vcc, s[94:95], v[78:79]
    s_cbranch_vccz PSS_45
    buffer_load_dwordx4 v[76:79], v3, s[36:39], 0 offen offset:1024 sc1
    s_mov_b32 s78, 1
PSS_45:
    v_cmp_ne_u64 vcc, s[94:95], v[82:83]
    s_cbranch_vccz PSS_46
    buffer_load_dwordx4 v[80:83], v3, s[36:39], 0 offen offset:2048 sc1
    s_mov_b32 s78, 1
PSS_46:
    v_cmp_ne_u64 vcc, s[94:95], v[86:87]
    s_cbranch_vccz PSS_47
    buffer_load_dwordx4 v[84:87], v3, s[36:39], 0 offen offset:3072 sc1
    s_mov_b32 s78, 1
PSS_47:
    v_cmp_ne_u64 vcc, s[94:95], v[90:91]
    s_cbranch_vccz PSS_48
    buffer_load_dwordx4 v[88:91], v3, s[36:39], s63 offen offset:0 sc1
    s_mov_b32 s78, 1
PSS_48:
    v_cmp_ne_u64 vcc, s[94:95], v[94:95]
    s_cbranch_vccz PSS_49
    buffer_load_dwordx4 v[92:95], v3, s[36:39], s63 offen offset:1024 sc1
    s_mov_b32 s78, 1
PSS_49:
    v_cmp_ne_u64 vcc, s[94:95], v[98:99]
    s_cbranch_vccz PSS_50
    buffer_load_dwordx4 v[96:99], v3, s[36:39], s63 offen offset:2048 sc1
    s_mov_b32 s78, 1
PSS_50:
    v_cmp_ne_u64 vcc, s[94:95], v[102:103]
    s_cbranch_vccz PSS_51
    buffer_load_dwordx4 v[100:103], v3, s[36:39], s63 offen offset:3072 sc1
    s_mov_b32 s78, 1
PSS_51:
    s_cmp_eq_u32 s78, 0
    s_cbranch_scc1 PSD_41
    s_sub_u32 s80, s80, 1
    s_cmp_lg_u32 s80, 0
    s_cbranch_scc1 PS_40
    s_waitcnt vmcnt(0)
PSD_41:
    v_lshlrev_b32 v104, 16, v72
    v_and_b32 v105, 0xffff0000, v72
    v_lshlrev_b32 v106, 16, v73
    v_and_b32 v107, 0xffff0000, v73
    v_lshlrev_b32 v108, 16, v76
    v_and_b32 v109, 0xffff0000, v76
    v_lshlrev_b32 v110, 16, v77
    v_and_b32 v111, 0xffff0000, v77
    v_lshlrev_b32 v120, 16, v80
    v_and_b32 v121, 0xffff0000, v80
    v_lshlrev_b32 v122, 16, v81
    v_and_b32 v123, 0xffff0000, v81
    v_lshlrev_b32 v124, 16, v84
    v_and_b32 v125, 0xffff0000, v84
    v_lshlrev_b32 v126, 16, v85
    v_and_b32 v127, 0xffff0000, v85
    v_add_f32 v104, v104, v120
    v_add_f32 v105, v105, v121
    v_add_f32 v106, v106, v122
    v_add_f32 v107, v107, v123
    v_add_f32 v108, v108, v124
    v_add_f32 v109, v109, v125
    v_add_f32 v110, v110, v126
    v_add_f32 v111, v111, v127
    v_lshlrev_b32 v112, 16, v88
    v_and_b32 v113, 0xffff0000, v88
    v_lshlrev_b32 v114, 16, v89
    v_and_b32 v115, 0xffff0000, v89
    v_lshlrev_b32 v116, 16, v92
    v_and_b32 v117, 0xffff0000, v92
    v_lshlrev_b32 v118, 16, v93
    v_and_b32 v119, 0xffff0000, v93
    v_add_f32 v104, v104, v112
    v_add_f32 v105, v105, v113
    v_add_f32 v106, v106, v114
    v_add_f32 v107, v107, v115
    v_add_f32 v108, v108, v116
    v_add_f32 v109, v109, v117
    v_add_f32 v110, v110, v118
    v_add_f32 v111, v111, v119
    v_lshlrev_b32 v120, 16, v96
    v_and_b32 v121, 0xffff0000, v96
    v_lshlrev_b32 v122, 16, v97
    v_and_b32 v123, 0xffff0000, v97
    v_lshlrev_b32 v124, 16, v100
    v_and_b32 v125, 0xffff0000, v100
    v_lshlrev_b32 v126, 16, v101
    v_and_b32 v127, 0xffff0000, v101
    v_add_f32 v104, v104, v120
    v_add_f32 v105, v105, v121
    v_add_f32 v106, v106, v122
    v_add_f32 v107, v107, v123
    v_add_f32 v108, v108, v124
    v_add_f32 v109, v109, v125
    v_add_f32 v110, v110, v126
    v_add_f32 v111, v111, v127
    v_cvt_pk_bf16_f32 v136, v104, v105
    v_cvt_pk_bf16_f32 v137, v106, v107
    v_cvt_pk_bf16_f32 v138, v108, v109
    v_cvt_pk_bf16_f32 v139, v110, v111
    v_mov_b32_dpp v140, v136 quad_perm:[1,2,3,0] row_mask:0xf bank_mask:0xf
    v_mov_b32_dpp v141, v137 quad_perm:[1,2,3,0] row_mask:0xf bank_mask:0xf
    v_mov_b32_dpp v142, v138 quad_perm:[1,2,3,0] row_mask:0xf bank_mask:0xf
    v_mov_b32_dpp v143, v139 quad_perm:[1,2,3,0] row_mask:0xf bank_mask:0xf
    v_mov_b32_dpp v144, v136 quad_perm:[2,3,0,1] row_mask:0xf bank_mask:0xf
    v_mov_b32_dpp v145, v137 quad_perm:[2,3,0,1] row_mask:0xf bank_mask:0xf
    v_mov_b32_dpp v146, v138 quad_perm:[2,3,0,1] row_mask:0xf bank_mask:0xf
    v_mov_b32_dpp v147, v139 quad_perm:[2,3,0,1] row_mask:0xf bank_mask:0xf
    v_mov_b32_dpp v148, v136 quad_perm:[3,0,1,2] row_mask:0xf bank_mask:0xf
    v_mov_b32_dpp v149, v137 quad_perm:[3,0,1,2] row_mask:0xf bank_mask:0xf
    v_mov_b32_dpp v150, v138 quad_perm:[3,0,1,2] row_mask:0xf bank_mask:0xf
    v_mov_b32_dpp v151, v139 quad_perm:[3,0,1,2] row_mask:0xf bank_mask:0xf
    v_mov_b32 v74, s94
    v_mov_b32 v75, s95
    s_waitcnt lgkmcnt(0)
    v_mfma_f32_16x16x32_bf16 v[104:107], v[136:139], v[8:11], 0
    v_mfma_f32_16x16x32_bf16 v[108:111], v[136:139], v[28:31], 0
    v_mfma_f32_16x16x32_bf16 v[112:115], v[136:139], v[48:51], 0
    v_mfma_f32_16x16x32_bf16 v[116:119], v[136:139], v[68:71], 0
    v_mfma_f32_16x16x32_bf16 v[104:107], v[140:143], v[12:15], v[104:107]
    v_mfma_f32_16x16x32_bf16 v[108:111], v[140:143], v[32:35], v[108:111]
    v_mfma_f32_16x16x32_bf16 v[112:115], v[140:143], v[52:55], v[112:115]
    v_mfma_f32_16x16x32_bf16 v[116:119], v[140:143], v[56:59], v[116:119]
    v_mfma_f32_16x16x32_bf16 v[104:107], v[144:147], v[16:19], v[104:107]
    v_mfma_f32_16x16x32_bf16 v[108:111], v[144:147], v[36:39], v[108:111]
    v_mfma_f32_16x16x32_bf16 v[112:115], v[144:147], v[40:43], v[112:115]
    v_mfma_f32_16x16x32_bf16 v[116:119], v[144:147], v[60:63], v[116:119]
    v_mfma_f32_16x16x32_bf16 v[104:107], v[148:151], v[20:23], v[104:107]
    v_mfma_f32_16x16x32_bf16 v[108:111], v[148:151], v[24:27], v[108:111]
    v_mfma_f32_16x16x32_bf16 v[112:115], v[148:151], v[44:47], v[112:115]
    v_mfma_f32_16x16x32_bf16 v[116:119], v[148:151], v[64:67], v[116:119]
    s_nop 5
    v_cvt_pk_bf16_f32 v72, v104, v109
    s_nop 0
    v_cvt_pk_bf16_f32 v73, v114, v119
    buffer_store_dwordx4 v[72:75], v2, s[36:39], 0 offen sc1
    v_mov_b32 v160, 0x24048
    v_mov_b32 v161, 1
    s_waitcnt lgkmcnt(0)
    s_mov_b64 exec, 1
    ds_add_u32 v160, v161
    s_mov_b64 exec, -1
    s_setprio 0
    s_cmp_ge_u32 s5, 4
    s_cbranch_scc1 L_END
L_U1:
    s_mov_b32 s48, s26
    s_and_b32 s49, s27, 0xffff
    s_mov_b32 s50, 0x400000
    s_mov_b32 s51, 0x20000
    v_lshrrev_b32 v162, 4, v1
    v_lshlrev_b32 v2, 16, v162
    v_and_b32 v160, 15, v1
    v_lshl_add_u32 v2, v160, 4, v2
    s_lshl_b32 s7, s6, 8
    v_add_u32 v2, s7, v2
    s_lshl_b32 s70, s3, 19
    s_waitcnt vmcnt(2)
    buffer_load_dwordx4 v[8:11], v2, s[48:51], s70 offen nt
    s_add_u32 s70, s70, 8192
    s_waitcnt vmcnt(2)
    buffer_load_dwordx4 v[12:15], v2, s[48:51], s70 offen nt
    s_add_u32 s70, s70, 8192
    s_waitcnt vmcnt(2)
    buffer_load_dwordx4 v[16:19], v2, s[48:51], s70 offen nt
    s_add_u32 s70, s70, 8192
    s_waitcnt vmcnt(2)
    buffer_load_dwordx4 v[20:23], v2, s[48:51], s70 offen nt
    s_add_u32 s70, s70, 8192
    s_waitcnt vmcnt(2)
    buffer_load_dwordx4 v[24:27], v2, s[48:51], s70 offen nt
    s_add_u32 s70, s70, 8192
    s_waitcnt vmcnt(2)
    buffer_load_dwordx4 v[28:31], v2, s[48:51], s70 offen nt
    s_add_u32 s70, s70, 8192
    s_waitcnt vmcnt(2)
    buffer_load_dwordx4 v[32:35], v2, s[48:51], s70 offen nt
    s_add_u32 s70, s70, 8192
    s_waitcnt vmcnt(2)
    buffer_load_dwordx4 v[36:39], v2, s[48:51], s70 offen nt
    s_add_u32 s70, s70, 204800
    s_waitcnt vmcnt(2)
    buffer_load_dwordx4 v[104:107], v2, s[48:51], s70 offen nt
    s_add_u32 s70, s70, 8192
    s_waitcnt vmcnt(2)
    buffer_load_dwordx4 v[108:111], v2, s[48:51], s70 offen nt
    s_add_u32 s70, s70, 8192
    s_waitcnt vmcnt(2)
    buffer_load_dwordx4 v[112:115], v2, s[48:51], s70 offen nt
    s_add_u32 s70, s70, 8192
    s_waitcnt vmcnt(2)
    buffer_load_dwordx4 v[116:119], v2, s[48:51], s70 offen nt
    s_add_u32 s70, s70, 8192
    s_waitcnt vmcnt(2)
    buffer_load_dwordx4 v[120:123], v2, s[48:51], s70 offen nt
    s_add_u32 s70, s70, 8192
    s_waitcnt vmcnt(2)
    buffer_load_dwordx4 v[124:127], v2, s[48:51], s70 offen nt
    s_add_u32 s70, s70, 8192
    s_waitcnt vmcnt(2)
    buffer_load_dwordx4 v[128:131], v2, s[48:51], s70 offen nt
    s_add_u32 s70, s70, 8192
    s_waitcnt vmcnt(2)
    buffer_load_dwordx4 v[132:135], v2, s[48:51], s70 offen nt
    s_add_u32 s70, s70, 204800
    v_lshlrev_b32 v3, 4, v1
    v_add_u32 v3, 0x24800, v3
    v_lshrrev_b32 v4, 1, v160
    v_lshlrev_b32 v4, 18, v4
    v_lshl_add_u32 v4, v162, 4, v4
    v_and_b32 v163, 1, v1
    v_lshl_add_u32 v4, v163, 6, v4
    v_cmp_eq_u32 s[86:87], 1, v163
    s_lshl_b32 s7, s3, 5
    s_add_u32 s7, s7, s6
    s_lshl_b32 s7, s7, 7
    s_add_u32 s7, s7, 0x500000
    v_add_u32 v4, s7, v4
    s_lshl_b32 s7, s3, 11
    s_add_u32 s7, s7, 0x10000
    v_lshl_add_u32 v5, v1, 5, s7
    v_perm_b32 v40, v12, v8, s92
    v_perm_b32 v41, v20, v16, s92
    v_perm_b32 v42, v28, v24, s92
    v_perm_b32 v43, v36, v32, s92
    v_perm_b32 v44, v12, v8, s93
    v_perm_b32 v45, v20, v16, s93
    v_perm_b32 v46, v28, v24, s93
    v_perm_b32 v47, v36, v32, s93
    v_perm_b32 v48, v13, v9, s92
    v_perm_b32 v49, v21, v17, s92
    v_perm_b32 v50, v29, v25, s92
    v_perm_b32 v51, v37, v33, s92
    v_perm_b32 v52, v13, v9, s93
    v_perm_b32 v53, v21, v17, s93
    v_perm_b32 v54, v29, v25, s93
    v_perm_b32 v55, v37, v33, s93
    v_perm_b32 v56, v14, v10, s92
    v_perm_b32 v57, v22, v18, s92
    v_perm_b32 v58, v30, v26, s92
    v_perm_b32 v59, v38, v34, s92
    v_perm_b32 v60, v14, v10, s93
    v_perm_b32 v61, v22, v18, s93
    v_perm_b32 v62, v30, v26, s93
    v_perm_b32 v63, v38, v34, s93
    v_perm_b32 v64, v15, v11, s92
    v_perm_b32 v65, v23, v19, s92
    v_perm_b32 v66, v31, v27, s92
    v_perm_b32 v67, v39, v35, s92
    v_perm_b32 v68, v15, v11, s93
    v_perm_b32 v69, v23, v19, s93
    v_perm_b32 v70, v31, v27, s93
    v_perm_b32 v71, v39, v35, s93
    s_waitcnt vmcnt(0)
    v_perm_b32 v72, v108, v104, s92
    v_perm_b32 v73, v116, v112, s92
    v_perm_b32 v74, v124, v120, s92
    v_perm_b32 v75, v132, v128, s92
    v_perm_b32 v76, v108, v104, s93
    v_perm_b32 v77, v116, v112, s93
    v_perm_b32 v78, v124, v120, s93
    v_perm_b32 v79, v132, v128, s93
    v_perm_b32 v80, v109, v105, s92
    v_perm_b32 v81, v117, v113, s92
    v_perm_b32 v82, v125, v121, s92
    v_perm_b32 v83, v133, v129, s92
    v_perm_b32 v84, v109, v105, s93
    v_perm_b32 v85, v117, v113, s93
    v_perm_b32 v86, v125, v121, s93
    v_perm_b32 v87, v133, v129, s93
    v_perm_b32 v88, v110, v106, s92
    v_perm_b32 v89, v118, v114, s92
    v_perm_b32 v90, v126, v122, s92
    v_perm_b32 v91, v134, v130, s92
    v_perm_b32 v92, v110, v106, s93
    v_perm_b32 v93, v118, v114, s93
    v_perm_b32 v94, v126, v122, s93
    v_perm_b32 v95, v134, v130, s93
    v_perm_b32 v96, v111, v107, s92
    v_perm_b32 v97, v119, v115, s92
    v_perm_b32 v98, v127, v123, s92
    v_perm_b32 v99, v135, v131, s92
    v_perm_b32 v100, v111, v107, s93
    v_perm_b32 v101, v119, v115, s93
    v_perm_b32 v102, v127, v123, s93
    v_perm_b32 v103, v135, v131, s93
    v_mov_b32 v160, 0x2404c
    s_mov_b32 s80, 1600000
LW_52:
    ds_read_b32 v161, v160
    s_waitcnt lgkmcnt(0)
    v_readfirstlane_b32 s79, v161
    s_cmp_ge_u32 s79, 1
    s_cbranch_scc1 LWD_53
    s_sleep 2
    s_sub_u32 s80, s80, 1
    s_cmp_lg_u32 s80, 0
    s_cbranch_scc1 LW_52
LWD_53:
    v_mov_b32 v160, 0x24050
    ds_read_b64 v[162:163], v160
    s_waitcnt lgkmcnt(0)
    v_readfirstlane_b32 s94, v162
    v_readfirstlane_b32 s95, v163
    v_mov_b32 v160, 0x2401c
    s_mov_b32 s80, 1600000
LW_54:
    ds_read_b32 v161, v160
    s_waitcnt lgkmcnt(0)
    v_readfirstlane_b32 s79, v161
    s_cmp_ge_u32 s79, 1
    s_cbranch_scc1 LWD_55
    s_sleep 4
    s_sub_u32 s80, s80, 1
    s_cmp_lg_u32 s80, 0
    s_cbranch_scc1 LW_54
LWD_55:
    s_setprio 3
    s_mov_b64 s[88:89], 0
    s_mov_b32 s80, 1600000
UM_56:
    ds_read_b128 v[136:139], v3
    s_waitcnt lgkmcnt(0)
    v_cmp_ne_u64 vcc, s[94:95], v[138:139]
    s_or_b64 s[90:91], vcc, s[88:89]
    s_and_b32 s7, s90, 0x5555
    s_cbranch_scc1 UMS_58
    s_mov_b32 s70, 0
    buffer_load_dwordx4 v[8:11], v4, s[36:39], s70 offen sc1
    s_or_b32 s88, s88, 0x5555
UMS_58:
    s_and_b32 s7, s90, 0x55550000
    s_cbranch_scc1 UMS_59
    s_mov_b32 s70, 32768
    buffer_load_dwordx4 v[12:15], v4, s[36:39], s70 offen sc1
    s_or_b32 s88, s88, 0x55550000
UMS_59:
    s_and_b32 s7, s91, 0x5555
    s_cbranch_scc1 UMS_60
    s_mov_b32 s70, 65536
    buffer_load_dwordx4 v[16:19], v4, s[36:39], s70 offen sc1
    s_or_b32 s89, s89, 0x5555
UMS_60:
    s_and_b32 s7, s91, 0x55550000
    s_cbranch_scc1 UMS_61
    s_mov_b32 s70, 98304
    buffer_load_dwordx4 v[20:23], v4, s[36:39], s70 offen sc1
    s_or_b32 s89, s89, 0x55550000
UMS_61:
    s_and_b32 s7, s90, 0xaaaa
    s_cbranch_scc1 UMS_62
    s_mov_b32 s70, 131072
    buffer_load_dwordx4 v[24:27], v4, s[36:39], s70 offen sc1
    s_or_b32 s88, s88, 0xaaaa
UMS_62:
    s_and_b32 s7, s90, 0xaaaa0000
    s_cbranch_scc1 UMS_63
    s_mov_b32 s70, 163840
    buffer_load_dwordx4 v[28:31], v4, s[36:39], s70 offen sc1
    s_or_b32 s88, s88, 0xaaaa0000
UMS_63:
    s_and_b32 s7, s91, 0xaaaa
    s_cbranch_scc1 UMS_64
    s_mov_b32 s70, 196608
    buffer_load_dwordx4 v[32:35], v4, s[36:39], s70 offen sc1
    s_or_b32 s89, s89, 0xaaaa
UMS_64:
    s_and_b32 s7, s91, 0xaaaa0000
    s_cbranch_scc1 UMS_65
    s_mov_b32 s70, 229376
    buffer_load_dwordx4 v[36:39], v4, s[36:39], s70 offen sc1
    s_or_b32 s89, s89, 0xaaaa0000
UMS_65:
    s_cbranch_vccz UMD_57
    s_sleep 1
    s_sub_u32 s80, s80, 1
    s_cmp_lg_u32 s80, 0
    s_cbranch_scc1 UM_56
UMD_57:
    v_max_f32_dpp v138, v136, v136 quad_perm:[1,0,3,2] row_mask:0xf bank_mask:0xf
    s_nop 1
    v_max_f32_dpp v138, v138, v138 quad_perm:[2,3,0,1] row_mask:0xf bank_mask:0xf
    v_mov_b32 v139, v138
    s_nop 1
    v_permlane32_swap_b32 v138, v139
    v_max_f32 v138, v138, v139
    v_mov_b32 v139, v138
    s_nop 1
    v_permlane16_swap_b32 v138, v139
    v_max_f32 v138, v138, v139
    v_sub_f32 v136, v136, v138
    v_exp_f32 v136, v136
    s_nop 0
    v_mul_f32 v137, v137, v136
    s_nop 1
    v_add_f32_dpp v137, v137, v137 quad_perm:[1,0,3,2] row_mask:0xf bank_mask:0xf
    s_nop 1
    v_add_f32_dpp v137, v137, v137 quad_perm:[2,3,0,1] row_mask:0xf bank_mask:0xf
    v_mov_b32 v138, v137
    s_nop 1
    v_permlane32_swap_b32 v137, v138
    v_add_f32 v137, v137, v138
    v_mov_b32 v138, v137
    s_nop 1
    v_permlane16_swap_b32 v137, v138
    v_add_f32 v137, v137, v138
    v_rcp_f32 v137, v137
    s_nop 0
    v_mul_f32 v136, v136, v137
    v_mov_b32 v137, v136
    s_nop 1
    v_permlane16_swap_b32 v136, v137
    v_mov_b32 v138, v136
    v_mov_b32 v139, v137
    s_nop 0
    v_permlane32_swap_b32 v136, v138
    v_permlane32_swap_b32 v137, v139
    s_nop 0
    v_mov_b32_dpp v148, v136 quad_perm:[0,0,2,2] row_mask:0xf bank_mask:0xf
    v_mov_b32_dpp v149, v137 quad_perm:[0,0,2,2] row_mask:0xf bank_mask:0xf
    v_mov_b32_dpp v150, v138 quad_perm:[0,0,2,2] row_mask:0xf bank_mask:0xf
    v_mov_b32_dpp v151, v139 quad_perm:[0,0,2,2] row_mask:0xf bank_mask:0xf
    v_mov_b32_dpp v152, v136 quad_perm:[1,1,3,3] row_mask:0xf bank_mask:0xf
    v_mov_b32_dpp v153, v137 quad_perm:[1,1,3,3] row_mask:0xf bank_mask:0xf
    v_mov_b32_dpp v154, v138 quad_perm:[1,1,3,3] row_mask:0xf bank_mask:0xf
    v_mov_b32_dpp v155, v139 quad_perm:[1,1,3,3] row_mask:0xf bank_mask:0xf
    s_waitcnt vmcnt(0)
    v_lshlrev_b32 v104, 16, v8
    v_and_b32 v105, 0xffff0000, v8
    v_lshlrev_b32 v106, 16, v9
    v_and_b32 v107, 0xffff0000, v9
    v_lshlrev_b32 v108, 16, v10
    v_and_b32 v109, 0xffff0000, v10
    v_lshlrev_b32 v110, 16, v11
    v_and_b32 v111, 0xffff0000, v11
    v_mul_f32 v120, v104, v148
    v_mul_f32 v121, v105, v148
    v_mul_f32 v122, v106, v148
    v_mul_f32 v123, v107, v148
    v_mul_f32 v124, v108, v148
    v_mul_f32 v125, v109, v148
    v_mul_f32 v126, v110, v148
    v_mul_f32 v127, v111, v148
    v_lshlrev_b32 v112, 16, v12
    v_and_b32 v113, 0xffff0000, v12
    v_lshlrev_b32 v114, 16, v13
    v_and_b32 v115, 0xffff0000, v13
    v_lshlrev_b32 v116, 16, v14
    v_and_b32 v117, 0xffff0000, v14
    v_lshlrev_b32 v118, 16, v15
    v_and_b32 v119, 0xffff0000, v15
    v_fmac_f32 v120, v112, v149
    v_fmac_f32 v121, v113, v149
    v_fmac_f32 v122, v114, v149
    v_fmac_f32 v123, v115, v149
    v_fmac_f32 v124, v116, v149
    v_fmac_f32 v125, v117, v149
    v_fmac_f32 v126, v118, v149
    v_fmac_f32 v127, v119, v149
    v_lshlrev_b32 v104, 16, v16
    v_and_b32 v105, 0xffff0000, v16
    v_lshlrev_b32 v106, 16, v17
    v_and_b32 v107, 0xffff0000, v17
    v_lshlrev_b32 v108, 16, v18
    v_and_b32 v109, 0xffff0000, v18
    v_lshlrev_b32 v110, 16, v19
    v_and_b32 v111, 0xffff0000, v19
    v_fmac_f32 v120, v104, v150
    v_fmac_f32 v121, v105, v150
    v_fmac_f32 v122, v106, v150
    v_fmac_f32 v123, v107, v150
    v_fmac_f32 v124, v108, v150
    v_fmac_f32 v125, v109, v150
    v_fmac_f32 v126, v110, v150
    v_fmac_f32 v127, v111, v150
    v_lshlrev_b32 v112, 16, v20
    v_and_b32 v113, 0xffff0000, v20
    v_lshlrev_b32 v114, 16, v21
    v_and_b32 v115, 0xffff0000, v21
    v_lshlrev_b32 v116, 16, v22
    v_and_b32 v117, 0xffff0000, v22
    v_lshlrev_b32 v118, 16, v23
    v_and_b32 v119, 0xffff0000, v23
    v_fmac_f32 v120, v112, v151
    v_fmac_f32 v121, v113, v151
    v_fmac_f32 v122, v114, v151
    v_fmac_f32 v123, v115, v151
    v_fmac_f32 v124, v116, v151
    v_fmac_f32 v125, v117, v151
    v_fmac_f32 v126, v118, v151
    v_fmac_f32 v127, v119, v151
    v_lshlrev_b32 v104, 16, v24
    v_and_b32 v105, 0xffff0000, v24
    v_lshlrev_b32 v106, 16, v25
    v_and_b32 v107, 0xffff0000, v25
    v_lshlrev_b32 v108, 16, v26
    v_and_b32 v109, 0xffff0000, v26
    v_lshlrev_b32 v110, 16, v27
    v_and_b32 v111, 0xffff0000, v27
    v_fmac_f32 v120, v104, v152
    v_fmac_f32 v121, v105, v152
    v_fmac_f32 v122, v106, v152
    v_fmac_f32 v123, v107, v152
    v_fmac_f32 v124, v108, v152
    v_fmac_f32 v125, v109, v152
    v_fmac_f32 v126, v110, v152
    v_fmac_f32 v127, v111, v152
    v_lshlrev_b32 v112, 16, v28
    v_and_b32 v113, 0xffff0000, v28
    v_lshlrev_b32 v114, 16, v29
    v_and_b32 v115, 0xffff0000, v29
    v_lshlrev_b32 v116, 16, v30
    v_and_b32 v117, 0xffff0000, v30
    v_lshlrev_b32 v118, 16, v31
    v_and_b32 v119, 0xffff0000, v31
    v_fmac_f32 v120, v112, v153
    v_fmac_f32 v121, v113, v153
    v_fmac_f32 v122, v114, v153
    v_fmac_f32 v123, v115, v153
    v_fmac_f32 v124, v116, v153
    v_fmac_f32 v125, v117, v153
    v_fmac_f32 v126, v118, v153
    v_fmac_f32 v127, v119, v153
    v_lshlrev_b32 v104, 16, v32
    v_and_b32 v105, 0xffff0000, v32
    v_lshlrev_b32 v106, 16, v33
    v_and_b32 v107, 0xffff0000, v33
    v_lshlrev_b32 v108, 16, v34
    v_and_b32 v109, 0xffff0000, v34
    v_lshlrev_b32 v110, 16, v35
    v_and_b32 v111, 0xffff0000, v35
    v_fmac_f32 v120, v104, v154
    v_fmac_f32 v121, v105, v154
    v_fmac_f32 v122, v106, v154
    v_fmac_f32 v123, v107, v154
    v_fmac_f32 v124, v108, v154
    v_fmac_f32 v125, v109, v154
    v_fmac_f32 v126, v110, v154
    v_fmac_f32 v127, v111, v154
    v_lshlrev_b32 v112, 16, v36
    v_and_b32 v113, 0xffff0000, v36
    v_lshlrev_b32 v114, 16, v37
    v_and_b32 v115, 0xffff0000, v37
    v_lshlrev_b32 v116, 16, v38
    v_and_b32 v117, 0xffff0000, v38
    v_lshlrev_b32 v118, 16, v39
    v_and_b32 v119, 0xffff0000, v39
    v_fmac_f32 v120, v112, v155
    v_fmac_f32 v121, v113, v155
    v_fmac_f32 v122, v114, v155
    v_fmac_f32 v123, v115, v155
    v_fmac_f32 v124, v116, v155
    v_fmac_f32 v125, v117, v155
    v_fmac_f32 v126, v118, v155
    v_fmac_f32 v127, v119, v155
    v_cvt_pk_bf16_f32 v128, v120, v121
    v_cvt_pk_bf16_f32 v129, v122, v123
    v_cvt_pk_bf16_f32 v130, v124, v125
    v_cvt_pk_bf16_f32 v131, v126, v127
    v_cndmask_b32 v140, v128, 0, s[86:87]
    v_cndmask_b32 v144, 0, v128, s[86:87]
    v_cndmask_b32 v141, v129, 0, s[86:87]
    v_cndmask_b32 v145, 0, v129, s[86:87]
    v_cndmask_b32 v142, v130, 0, s[86:87]
    v_cndmask_b32 v146, 0, v130, s[86:87]
    v_cndmask_b32 v143, v131, 0, s[86:87]
    v_cndmask_b32 v147, 0, v131, s[86:87]
    s_nop 0
    v_mfma_f32_16x16x32_bf16 v[8:11], v[140:143], v[40:43], 0
    v_mfma_f32_16x16x32_bf16 v[12:15], v[140:143], v[44:47], 0
    v_mfma_f32_16x16x32_bf16 v[16:19], v[140:143], v[48:51], 0
    v_mfma_f32_16x16x32_bf16 v[20:23], v[140:143], v[52:55], 0
    v_mfma_f32_16x16x32_bf16 v[24:27], v[140:143], v[56:59], 0
    v_mfma_f32_16x16x32_bf16 v[28:31], v[140:143], v[60:63], 0
    v_mfma_f32_16x16x32_bf16 v[32:35], v[140:143], v[64:67], 0
    v_mfma_f32_16x16x32_bf16 v[36:39], v[140:143], v[68:71], 0
    v_mfma_f32_16x16x32_bf16 v[8:11], v[144:147], v[72:75], v[8:11]
    v_mfma_f32_16x16x32_bf16 v[12:15], v[144:147], v[76:79], v[12:15]
    v_mfma_f32_16x16x32_bf16 v[16:19], v[144:147], v[80:83], v[16:19]
    v_mfma_f32_16x16x32_bf16 v[20:23], v[144:147], v[84:87], v[20:23]
    v_mfma_f32_16x16x32_bf16 v[24:27], v[144:147], v[88:91], v[24:27]
    v_mfma_f32_16x16x32_bf16 v[28:31], v[144:147], v[92:95], v[28:31]
    v_mfma_f32_16x16x32_bf16 v[32:35], v[144:147], v[96:99], v[32:35]
    v_mfma_f32_16x16x32_bf16 v[36:39], v[144:147], v[100:103], v[36:39]
    s_nop 0
    v_add_f32 v8, v8, v10
    v_add_f32 v9, v9, v11
    v_add_f32 v12, v12, v14
    v_add_f32 v13, v13, v15
    v_add_f32 v16, v16, v18
    v_add_f32 v17, v17, v19
    v_add_f32 v20, v20, v22
    v_add_f32 v21, v21, v23
    v_add_f32 v24, v24, v26
    v_add_f32 v25, v25, v27
    v_add_f32 v28, v28, v30
    v_add_f32 v29, v29, v31
    v_add_f32 v32, v32, v34
    v_add_f32 v33, v33, v35
    v_add_f32 v36, v36, v38
    v_add_f32 v37, v37, v39
    v_add_f32 v104, v8, v9
    v_add_f32 v105, v12, v13
    v_add_f32 v106, v16, v17
    v_add_f32 v107, v20, v21
    v_add_f32 v108, v24, v25
    v_add_f32 v109, v28, v29
    v_add_f32 v110, v32, v33
    v_add_f32 v111, v36, v37
    ds_write_b128 v5, v[104:107]
    ds_write_b128 v5, v[108:111] offset:16
    v_and_b32 v160, 31, v1
    s_lshl_b32 s7, s3, 8
    s_add_u32 s7, s7, 0x10000
    v_lshl_add_u32 v5, v160, 3, s7
    s_lshl_b32 s7, s3, 7
    s_add_u32 s7, s7, 0x24400
    v_lshl_add_u32 v4, v160, 2, s7
    s_waitcnt lgkmcnt(0)
    s_barrier
    ds_read_b64 v[8:9], v5 offset:0
    ds_read_b64 v[10:11], v5 offset:2048
    ds_read_b64 v[12:13], v5 offset:4096
    ds_read_b64 v[14:15], v5 offset:6144
    ds_read_b64 v[16:17], v5 offset:8192
    ds_read_b64 v[18:19], v5 offset:10240
    ds_read_b64 v[20:21], v5 offset:12288
    ds_read_b64 v[22:23], v5 offset:14336
    s_waitcnt lgkmcnt(0)
    v_add_f32 v8, v8, v16
    v_add_f32 v9, v9, v17
    v_add_f32 v10, v10, v18
    v_add_f32 v11, v11, v19
    v_add_f32 v12, v12, v20
    v_add_f32 v13, v13, v21
    v_add_f32 v14, v14, v22
    v_add_f32 v15, v15, v23
    v_add_f32 v8, v8, v12
    v_add_f32 v9, v9, v13
    v_add_f32 v10, v10, v14
    v_add_f32 v11, v11, v15
    v_add_f32 v8, v8, v10
    v_add_f32 v9, v9, v11
    v_cvt_pk_bf16_f32 v8, v8, v9
    ds_write_b32 v4, v8
    s_waitcnt lgkmcnt(0)
    s_barrier
    s_endpgm
L_W2:
    v_and_b32 v1, 63, v0
    s_and_b32 s7, s5, 3
    s_lshl_b32 s6, s4, 2
    s_add_u32 s6, s6, s7
    s_mov_b32 s92, 0x05040100
    s_mov_b32 s93, 0x07060302
    s_cmp_lg_u32 s3, 11
    s_cbranch_scc1 Z_66
    v_lshlrev_b32 v2, 2, v1
    v_add_u32 v2, 0x24000, v2
    v_mov_b32 v3, 0
    ds_write_b32 v2, v3
Z_66:
    s_sub_u32 s62, s3, 8
    s_lshl_b32 s7, s5, 2
    s_add_u32 s7, s7, s62
    s_lshl_b32 s7, s7, 17
    s_lshl_b32 s70, s4, 10
    s_add_u32 s70, s70, s7
    s_lshl_b32 s71, s62, 14
    v_lshlrev_b32 v2, 4, v1
    s_lshl_b32 s7, s62, 6
    v_xor_b32 v4, s7, v2
    v_xor_b32 v5, 16, v4
    v_xor_b32 v6, 32, v4
    v_xor_b32 v7, 48, v4
    s_waitcnt lgkmcnt(0)
    s_mov_b32 s52, s24
    s_and_b32 s53, s25, 0xffff
    s_mov_b32 s54, 0x400000
    s_mov_b32 s55, 0x20000
    s_mov_b32 m0, s71
    s_nop 0
    buffer_load_dwordx4 v4, s[52:55], s70 offen nt lds
    s_add_u32 s70, s70, 8192
    s_add_u32 s71, s71, 1024
    s_mov_b32 m0, s71
    s_nop 0
    buffer_load_dwordx4 v4, s[52:55], s70 offen nt lds
    s_add_u32 s70, s70, 8192
    s_add_u32 s71, s71, 1024
    s_mov_b32 m0, s71
    s_nop 0
    buffer_load_dwordx4 v4, s[52:55], s70 offen nt lds
    s_add_u32 s70, s70, 8192
    s_add_u32 s71, s71, 1024
    s_mov_b32 m0, s71
    s_nop 0
    buffer_load_dwordx4 v4, s[52:55], s70 offen nt lds
    s_add_u32 s70, s70, 8192
    s_add_u32 s71, s71, 1024
    s_mov_b32 m0, s71
    s_nop 0
    buffer_load_dwordx4 v5, s[52:55], s70 offen nt lds
    s_add_u32 s70, s70, 8192
    s_add_u32 s71, s71, 1024
    s_mov_b32 m0, s71
    s_nop 0
    buffer_load_dwordx4 v5, s[52:55], s70 offen nt lds
    s_add_u32 s70, s70, 8192
    s_add_u32 s71, s71, 1024
    s_mov_b32 m0, s71
    s_nop 0
    buffer_load_dwordx4 v5, s[52:55], s70 offen nt lds
    s_add_u32 s70, s70, 8192
    s_add_u32 s71, s71, 1024
    s_mov_b32 m0, s71
    s_nop 0
    buffer_load_dwordx4 v5, s[52:55], s70 offen nt lds
    s_add_u32 s70, s70, 8192
    s_add_u32 s71, s71, 1024
    s_mov_b32 s36, s34
    s_and_b32 s37, s35, 0xffff
    s_mov_b32 s38, 0x1000000
    s_mov_b32 s39, 0x20000
    s_mov_b32 s40, s32
    s_and_b32 s41, s33, 0xffff
    s_mov_b32 s42, 0x100
    s_mov_b32 s43, 0x20000
    s_barrier
    s_mov_b32 m0, s71
    s_waitcnt vmcnt(7)
    buffer_load_dwordx4 v6, s[52:55], s70 offen nt lds
    s_add_u32 s70, s70, 8192
    s_add_u32 s71, s71, 1024
    s_mov_b32 m0, s71
    s_waitcnt vmcnt(7)
    buffer_load_dwordx4 v6, s[52:55], s70 offen nt lds
    s_add_u32 s70, s70, 8192
    s_add_u32 s71, s71, 1024
    s_mov_b32 m0, s71
    s_waitcnt vmcnt(7)
    buffer_load_dwordx4 v6, s[52:55], s70 offen nt lds
    s_add_u32 s70, s70, 8192
    s_add_u32 s71, s71, 1024
    s_mov_b32 m0, s71
    s_waitcnt vmcnt(7)
    buffer_load_dwordx4 v6, s[52:55], s70 offen nt lds
    s_add_u32 s70, s70, 8192
    s_add_u32 s71, s71, 1024
    s_mov_b32 m0, s71
    s_waitcnt vmcnt(7)
    buffer_load_dwordx4 v7, s[52:55], s70 offen nt lds
    s_add_u32 s70, s70, 8192
    s_add_u32 s71, s71, 1024
    s_mov_b32 m0, s71
    s_waitcnt vmcnt(7)
    buffer_load_dwordx4 v7, s[52:55], s70 offen nt lds
    s_add_u32 s70, s70, 8192
    s_add_u32 s71, s71, 1024
    s_mov_b32 m0, s71
    s_waitcnt vmcnt(7)
    buffer_load_dwordx4 v7, s[52:55], s70 offen nt lds
    s_add_u32 s70, s70, 8192
    s_add_u32 s71, s71, 1024
    s_mov_b32 m0, s71
    s_waitcnt vmcnt(7)
    buffer_load_dwordx4 v7, s[52:55], s70 offen nt lds
    s_add_u32 s70, s70, 8192
    s_add_u32 s71, s71, 1024
    s_cmp_lt_u32 s5, 4
    s_cselect_b32 s72, s28, s16
    s_cselect_b32 s73, s29, s17
    s_mov_b32 s56, s72
    s_and_b32 s57, s73, 0xffff
    s_mov_b32 s58, 0x400000
    s_mov_b32 s59, 0x20000
    v_lshrrev_b32 v4, 4, v1
    v_lshlrev_b32 v2, 13, v4
    v_and_b32 v4, 15, v1
    v_lshl_add_u32 v2, v4, 4, v2
    s_lshl_b32 s7, s6, 17
    s_lshl_b32 s70, s62, 8
    s_add_u32 s7, s7, s70
    v_add_u32 v2, s7, v2
    v_lshrrev_b32 v3, 4, v1
    v_lshlrev_b32 v3, 16, v3
    v_bfe_u32 v4, v1, 3, 1
    v_lshl_add_u32 v3, v4, 13, v3
    v_and_b32 v4, 7, v1
    v_lshl_add_u32 v3, v4, 4, v3
    s_cmp_lt_u32 s5, 4
    s_cselect_b32 s7, 0x800, 0x0
    s_add_u32 s7, s7, s6
    s_lshl_b32 s7, s7, 7
    s_add_u32 s7, s7, 0x100000
    v_add_u32 v3, s7, v3
    s_lshl_b32 s7, s62, 14
    v_add_u32 v3, s7, v3
    s_waitcnt vmcnt(0)
    v_mov_b32 v4, 0x24014
    v_mov_b32 v5, 1
    s_waitcnt lgkmcnt(0)
    s_mov_b64 exec, 1
    ds_add_u32 v4, v5
    s_mov_b64 exec, -1
    s_mov_b32 s70, 0
    v_mov_b32 v4, 0x24048
    s_mov_b32 s80, 1600000
LW_69:
    ds_read_b32 v5, v4
    s_waitcnt lgkmcnt(0)
    v_readfirstlane_b32 s79, v5
    s_cmp_ge_u32 s79, 4
    s_cbranch_scc1 LWD_70
    s_sleep 4
    s_sub_u32 s80, s80, 1
    s_cmp_lg_u32 s80, 0
    s_cbranch_scc1 LW_69
LWD_70:
    s_cmp_lt_u32 s5, 4
    s_cbranch_scc1 S2U_67
    v_mov_b32 v4, 0x2405c
    s_mov_b32 s80, 1600000
LW_71:
    ds_read_b32 v5, v4
    s_waitcnt lgkmcnt(0)
    v_readfirstlane_b32 s79, v5
    s_cmp_ge_u32 s79, 4
    s_cbranch_scc1 LWD_72
    s_sleep 8
    s_sub_u32 s80, s80, 1
    s_cmp_lg_u32 s80, 0
    s_cbranch_scc1 LW_71
LWD_72:
    buffer_load_dwordx4 v[40:43], v2, s[56:59], s70 offen offset:0 nt
    buffer_load_dwordx4 v[44:47], v2, s[56:59], s70 offen offset:1024 nt
    buffer_load_dwordx4 v[48:51], v2, s[56:59], s70 offen offset:2048 nt
    buffer_load_dwordx4 v[52:55], v2, s[56:59], s70 offen offset:3072 nt
    s_add_u32 s70, s70, 4096
    s_waitcnt vmcnt(2)
    buffer_load_dwordx4 v[56:59], v2, s[56:59], s70 offen offset:0 nt
    buffer_load_dwordx4 v[60:63], v2, s[56:59], s70 offen offset:1024 nt
    buffer_load_dwordx4 v[64:67], v2, s[56:59], s70 offen offset:2048 nt
    buffer_load_dwordx4 v[68:71], v2, s[56:59], s70 offen offset:3072 nt
    s_add_u32 s70, s70, 28672
    s_waitcnt vmcnt(2)
    buffer_load_dwordx4 v[72:75], v2, s[56:59], s70 offen offset:0 nt
    buffer_load_dwordx4 v[76:79], v2, s[56:59], s70 offen offset:1024 nt
    buffer_load_dwordx4 v[80:83], v2, s[56:59], s70 offen offset:2048 nt
    buffer_load_dwordx4 v[84:87], v2, s[56:59], s70 offen offset:3072 nt
    s_add_u32 s70, s70, 4096
    s_waitcnt vmcnt(2)
    buffer_load_dwordx4 v[88:91], v2, s[56:59], s70 offen offset:0 nt
    buffer_load_dwordx4 v[92:95], v2, s[56:59], s70 offen offset:1024 nt
    buffer_load_dwordx4 v[96:99], v2, s[56:59], s70 offen offset:2048 nt
    buffer_load_dwordx4 v[100:103], v2, s[56:59], s70 offen offset:3072 nt
    s_add_u32 s70, s70, 28672
    s_waitcnt vmcnt(2)
    buffer_load_dwordx4 v[104:107], v2, s[56:59], s70 offen offset:0 nt
    buffer_load_dwordx4 v[108:111], v2, s[56:59], s70 offen offset:1024 nt
    buffer_load_dwordx4 v[112:115], v2, s[56:59], s70 offen offset:2048 nt
    buffer_load_dwordx4 v[116:119], v2, s[56:59], s70 offen offset:3072 nt
    s_add_u32 s70, s70, 4096
    s_waitcnt vmcnt(2)
    buffer_load_dwordx4 v[120:123], v2, s[56:59], s70 offen offset:0 nt
    buffer_load_dwordx4 v[124:127], v2, s[56:59], s70 offen offset:1024 nt
    buffer_load_dwordx4 v[128:131], v2, s[56:59], s70 offen offset:2048 nt
    buffer_load_dwordx4 v[132:135], v2, s[56:59], s70 offen offset:3072 nt
    s_add_u32 s70, s70, 28672
    s_waitcnt vmcnt(2)
    buffer_load_dwordx4 v[136:139], v2, s[56:59], s70 offen offset:0 nt
    buffer_load_dwordx4 v[140:143], v2, s[56:59], s70 offen offset:1024 nt
    buffer_load_dwordx4 v[144:147], v2, s[56:59], s70 offen offset:2048 nt
    buffer_load_dwordx4 v[148:151], v2, s[56:59], s70 offen offset:3072 nt
    s_add_u32 s70, s70, 4096
    s_waitcnt vmcnt(2)
    buffer_load_dwordx4 v[152:155], v2, s[56:59], s70 offen offset:0 nt
    buffer_load_dwordx4 v[156:159], v2, s[56:59], s70 offen offset:1024 nt
    buffer_load_dwordx4 v[160:163], v2, s[56:59], s70 offen offset:2048 nt
    buffer_load_dwordx4 v[164:167], v2, s[56:59], s70 offen offset:3072 nt
    s_add_u32 s70, s70, 28672
    s_waitcnt vmcnt(0)
    s_branch S2J_68
S2U_67:
    buffer_load_dwordx4 v[40:43], v2, s[56:59], s70 offen offset:0 nt
    buffer_load_dwordx4 v[44:47], v2, s[56:59], s70 offen offset:1024 nt
    buffer_load_dwordx4 v[48:51], v2, s[56:59], s70 offen offset:2048 nt
    buffer_load_dwordx4 v[52:55], v2, s[56:59], s70 offen offset:3072 nt
    s_add_u32 s70, s70, 4096
    s_waitcnt vmcnt(2)
    buffer_load_dwordx4 v[56:59], v2, s[56:59], s70 offen offset:0 nt
    buffer_load_dwordx4 v[60:63], v2, s[56:59], s70 offen offset:1024 nt
    buffer_load_dwordx4 v[64:67], v2, s[56:59], s70 offen offset:2048 nt
    buffer_load_dwordx4 v[68:71], v2, s[56:59], s70 offen offset:3072 nt
    s_add_u32 s70, s70, 28672
    s_waitcnt vmcnt(2)
    buffer_load_dwordx4 v[72:75], v2, s[56:59], s70 offen offset:0 nt
    buffer_load_dwordx4 v[76:79], v2, s[56:59], s70 offen offset:1024 nt
    buffer_load_dwordx4 v[80:83], v2, s[56:59], s70 offen offset:2048 nt
    buffer_load_dwordx4 v[84:87], v2, s[56:59], s70 offen offset:3072 nt
    s_add_u32 s70, s70, 4096
    s_waitcnt vmcnt(2)
    buffer_load_dwordx4 v[88:91], v2, s[56:59], s70 offen offset:0 nt
    buffer_load_dwordx4 v[92:95], v2, s[56:59], s70 offen offset:1024 nt
    buffer_load_dwordx4 v[96:99], v2, s[56:59], s70 offen offset:2048 nt
    buffer_load_dwordx4 v[100:103], v2, s[56:59], s70 offen offset:3072 nt
    s_add_u32 s70, s70, 28672
    s_waitcnt vmcnt(2)
    buffer_load_dwordx4 v[104:107], v2, s[56:59], s70 offen offset:0 nt
    buffer_load_dwordx4 v[108:111], v2, s[56:59], s70 offen offset:1024 nt
    buffer_load_dwordx4 v[112:115], v2, s[56:59], s70 offen offset:2048 nt
    buffer_load_dwordx4 v[116:119], v2, s[56:59], s70 offen offset:3072 nt
    s_add_u32 s70, s70, 4096
    s_waitcnt vmcnt(2)
    buffer_load_dwordx4 v[120:123], v2, s[56:59], s70 offen offset:0 nt
    buffer_load_dwordx4 v[124:127], v2, s[56:59], s70 offen offset:1024 nt
    buffer_load_dwordx4 v[128:131], v2, s[56:59], s70 offen offset:2048 nt
    buffer_load_dwordx4 v[132:135], v2, s[56:59], s70 offen offset:3072 nt
    s_add_u32 s70, s70, 28672
    s_waitcnt vmcnt(2)
    buffer_load_dwordx4 v[136:139], v2, s[56:59], s70 offen offset:0 nt
    buffer_load_dwordx4 v[140:143], v2, s[56:59], s70 offen offset:1024 nt
    buffer_load_dwordx4 v[144:147], v2, s[56:59], s70 offen offset:2048 nt
    buffer_load_dwordx4 v[148:151], v2, s[56:59], s70 offen offset:3072 nt
    s_add_u32 s70, s70, 4096
    s_waitcnt vmcnt(2)
    buffer_load_dwordx4 v[152:155], v2, s[56:59], s70 offen offset:0 nt
    buffer_load_dwordx4 v[156:159], v2, s[56:59], s70 offen offset:1024 nt
    buffer_load_dwordx4 v[160:163], v2, s[56:59], s70 offen offset:2048 nt
    buffer_load_dwordx4 v[164:167], v2, s[56:59], s70 offen offset:3072 nt
    s_add_u32 s70, s70, 28672
    s_waitcnt vmcnt(0)
S2J_68:
    v_perm_b32 v8, v44, v40, s92
    v_perm_b32 v9, v52, v48, s92
    v_perm_b32 v10, v60, v56, s92
    v_perm_b32 v11, v68, v64, s92
    v_perm_b32 v12, v44, v40, s93
    v_perm_b32 v13, v52, v48, s93
    v_perm_b32 v14, v60, v56, s93
    v_perm_b32 v15, v68, v64, s93
    v_perm_b32 v16, v45, v41, s92
    v_perm_b32 v17, v53, v49, s92
    v_perm_b32 v18, v61, v57, s92
    v_perm_b32 v19, v69, v65, s92
    v_perm_b32 v20, v45, v41, s93
    v_perm_b32 v21, v53, v49, s93
    v_perm_b32 v22, v61, v57, s93
    v_perm_b32 v23, v69, v65, s93
    v_perm_b32 v24, v46, v42, s92
    v_perm_b32 v25, v54, v50, s92
    v_perm_b32 v26, v62, v58, s92
    v_perm_b32 v27, v70, v66, s92
    v_perm_b32 v28, v46, v42, s93
    v_perm_b32 v29, v54, v50, s93
    v_perm_b32 v30, v62, v58, s93
    v_perm_b32 v31, v70, v66, s93
    v_perm_b32 v32, v47, v43, s92
    v_perm_b32 v33, v55, v51, s92
    v_perm_b32 v34, v63, v59, s92
    v_perm_b32 v35, v71, v67, s92
    v_perm_b32 v36, v47, v43, s93
    v_perm_b32 v37, v55, v51, s93
    v_perm_b32 v38, v63, v59, s93
    v_perm_b32 v39, v71, v67, s93
    v_perm_b32 v40, v76, v72, s92
    v_perm_b32 v41, v84, v80, s92
    v_perm_b32 v42, v92, v88, s92
    v_perm_b32 v43, v100, v96, s92
    v_perm_b32 v44, v76, v72, s93
    v_perm_b32 v45, v84, v80, s93
    v_perm_b32 v46, v92, v88, s93
    v_perm_b32 v47, v100, v96, s93
    v_perm_b32 v48, v77, v73, s92
    v_perm_b32 v49, v85, v81, s92
    v_perm_b32 v50, v93, v89, s92
    v_perm_b32 v51, v101, v97, s92
    v_perm_b32 v52, v77, v73, s93
    v_perm_b32 v53, v85, v81, s93
    v_perm_b32 v54, v93, v89, s93
    v_perm_b32 v55, v101, v97, s93
    v_perm_b32 v56, v78, v74, s92
    v_perm_b32 v57, v86, v82, s92
    v_perm_b32 v58, v94, v90, s92
    v_perm_b32 v59, v102, v98, s92
    v_perm_b32 v60, v78, v74, s93
    v_perm_b32 v61, v86, v82, s93
    v_perm_b32 v62, v94, v90, s93
    v_perm_b32 v63, v102, v98, s93
    v_perm_b32 v64, v79, v75, s92
    v_perm_b32 v65, v87, v83, s92
    v_perm_b32 v66, v95, v91, s92
    v_perm_b32 v67, v103, v99, s92
    v_perm_b32 v68, v79, v75, s93
    v_perm_b32 v69, v87, v83, s93
    v_perm_b32 v70, v95, v91, s93
    v_perm_b32 v71, v103, v99, s93
    v_perm_b32 v72, v108, v104, s92
    v_perm_b32 v73, v116, v112, s92
    v_perm_b32 v74, v124, v120, s92
    v_perm_b32 v75, v132, v128, s92
    v_perm_b32 v76, v108, v104, s93
    v_perm_b32 v77, v116, v112, s93
    v_perm_b32 v78, v124, v120, s93
    v_perm_b32 v79, v132, v128, s93
    v_perm_b32 v80, v109, v105, s92
    v_perm_b32 v81, v117, v113, s92
    v_perm_b32 v82, v125, v121, s92
    v_perm_b32 v83, v133, v129, s92
    v_perm_b32 v84, v109, v105, s93
    v_perm_b32 v85, v117, v113, s93
    v_perm_b32 v86, v125, v121, s93
    v_perm_b32 v87, v133, v129, s93
    v_perm_b32 v88, v110, v106, s92
    v_perm_b32 v89, v118, v114, s92
    v_perm_b32 v90, v126, v122, s92
    v_perm_b32 v91, v134, v130, s92
    v_perm_b32 v92, v110, v106, s93
    v_perm_b32 v93, v118, v114, s93
    v_perm_b32 v94, v126, v122, s93
    v_perm_b32 v95, v134, v130, s93
    v_perm_b32 v96, v111, v107, s92
    v_perm_b32 v97, v119, v115, s92
    v_perm_b32 v98, v127, v123, s92
    v_perm_b32 v99, v135, v131, s92
    v_perm_b32 v100, v111, v107, s93
    v_perm_b32 v101, v119, v115, s93
    v_perm_b32 v102, v127, v123, s93
    v_perm_b32 v103, v135, v131, s93
    v_perm_b32 v104, v140, v136, s92
    v_perm_b32 v105, v148, v144, s92
    v_perm_b32 v106, v156, v152, s92
    v_perm_b32 v107, v164, v160, s92
    v_perm_b32 v108, v140, v136, s93
    v_perm_b32 v109, v148, v144, s93
    v_perm_b32 v110, v156, v152, s93
    v_perm_b32 v111, v164, v160, s93
    v_perm_b32 v112, v141, v137, s92
    v_perm_b32 v113, v149, v145, s92
    v_perm_b32 v114, v157, v153, s92
    v_perm_b32 v115, v165, v161, s92
    v_perm_b32 v116, v141, v137, s93
    v_perm_b32 v117, v149, v145, s93
    v_perm_b32 v118, v157, v153, s93
    v_perm_b32 v119, v165, v161, s93
    v_perm_b32 v120, v142, v138, s92
    v_perm_b32 v121, v150, v146, s92
    v_perm_b32 v122, v158, v154, s92
    v_perm_b32 v123, v166, v162, s92
    v_perm_b32 v124, v142, v138, s93
    v_perm_b32 v125, v150, v146, s93
    v_perm_b32 v126, v158, v154, s93
    v_perm_b32 v127, v166, v162, s93
    v_perm_b32 v128, v143, v139, s92
    v_perm_b32 v129, v151, v147, s92
    v_perm_b32 v130, v159, v155, s92
    v_perm_b32 v131, v167, v163, s92
    v_perm_b32 v132, v143, v139, s93
    v_perm_b32 v133, v151, v147, s93
    v_perm_b32 v134, v159, v155, s93
    v_perm_b32 v135, v167, v163, s93
    v_mov_b32 v160, 0x2404c
    s_mov_b32 s80, 1600000
LW_73:
    ds_read_b32 v161, v160
    s_waitcnt lgkmcnt(0)
    v_readfirstlane_b32 s79, v161
    s_cmp_ge_u32 s79, 1
    s_cbranch_scc1 LWD_74
    s_sleep 2
    s_sub_u32 s80, s80, 1
    s_cmp_lg_u32 s80, 0
    s_cbranch_scc1 LW_73
LWD_74:
    v_mov_b32 v160, 0x24050
    ds_read_b64 v[162:163], v160
    s_waitcnt lgkmcnt(0)
    v_readfirstlane_b32 s94, v162
    v_readfirstlane_b32 s95, v163
    v_bfe_u32 v4, v1, 2, 2
    v_lshlrev_b32 v4, 8, v4
    v_lshrrev_b32 v160, 4, v1
    v_lshl_add_u32 v4, v160, 4, v4
    s_mov_b32 s70, 4096
    s_cmp_ge_u32 s5, 4
    s_cbranch_scc1 S2X_75
    v_add_u32 v4, 0x24400, v4
    s_cmp_lg_u32 s3, 8
    s_cbranch_scc1 U8_77
    v_and_b32 v5, 15, v1
    v_lshl_add_u32 v5, v5, 2, v160
    s_lshl_b32 s7, s6, 4
    s_add_u32 s7, s7, 0xe0000
    v_lshl_add_u32 v5, v5, 9, s7
    v_lshlrev_b32 v6, 4, v1
    v_add_u32 v6, 0x24800, v6
    s_mov_b32 s80, 200000
PO_78:
    buffer_load_dwordx4 v[136:139], v5, s[36:39], 0 offen sc1
PO2_79:
    s_waitcnt vmcnt(0)
    v_cmp_ne_u64 vcc, s[94:95], v[138:139]
    s_cmp_lg_u64 vcc, -1
    s_cbranch_scc1 POD_80
    s_sleep 16
    s_sub_u32 s80, s80, 1
    s_cmp_lg_u32 s80, 0
    s_cbranch_scc1 PO_78
POD_80:
    s_setprio 3
    ds_write_b128 v6, v[136:139]
    v_mov_b32 v160, 0x2401c
    v_mov_b32 v161, 1
    s_waitcnt lgkmcnt(0)
    s_mov_b64 exec, 1
    ds_add_u32 v160, v161
    s_mov_b64 exec, -1
    s_cbranch_vccz U8D_82
    buffer_load_dwordx4 v[136:139], v5, s[36:39], 0 offen sc1
    s_sleep 4
    buffer_load_dwordx4 v[140:143], v5, s[36:39], 0 offen sc1
    s_sleep 4
    s_mov_b32 s80, 200000
U8P_81:
    s_waitcnt vmcnt(1)
    ds_write_b128 v6, v[136:139]
    v_cmp_ne_u64 vcc, s[94:95], v[138:139]
    s_cbranch_vccz U8D_82
    s_waitcnt lgkmcnt(0)
    buffer_load_dwordx4 v[136:139], v5, s[36:39], 0 offen sc1
    s_waitcnt vmcnt(1)
    ds_write_b128 v6, v[140:143]
    v_cmp_ne_u64 vcc, s[94:95], v[142:143]
    s_cbranch_vccz U8D_82
    s_waitcnt lgkmcnt(0)
    buffer_load_dwordx4 v[140:143], v5, s[36:39], 0 offen sc1
    s_sub_u32 s80, s80, 1
    s_cmp_lg_u32 s80, 0
    s_cbranch_scc1 U8P_81
U8D_82:
    s_waitcnt vmcnt(0)
U8_77:
    s_setprio 3
    s_barrier
    s_barrier
    ds_read_b128 v[136:139], v4 offset:0
    ds_read_b128 v[140:143], v4 offset:64
    ds_read_b128 v[144:147], v4 offset:128
    ds_read_b128 v[148:151], v4 offset:192
    s_waitcnt lgkmcnt(0)
    s_branch S2M_76
S2X_75:
    v_and_b32 v160, 3, v1
    v_lshl_add_u32 v4, v160, 6, v4
    s_lshl_b32 s7, s6, 11
    s_add_u32 s7, s7, 0xd0000
    v_add_u32 v4, s7, v4
    s_mov_b32 s80, 200000
PO_83:
    buffer_load_dwordx4 v[152:155], v4, s[36:39], 0 offen offset:0 sc1
PO2_84:
    s_waitcnt vmcnt(0)
    v_cmp_ne_u64 vcc, s[94:95], v[154:155]
    s_cmp_lg_u64 vcc, -1
    s_cbranch_scc1 POD_85
    s_sleep 2
    s_sub_u32 s80, s80, 1
    s_cmp_lg_u32 s80, 0
    s_cbranch_scc1 PO_83
POD_85:
    s_setprio 3
    buffer_load_dwordx4 v[152:155], v4, s[36:39], 0 offen offset:0 sc1
    buffer_load_dwordx4 v[156:159], v4, s[36:39], 0 offen offset:1024 sc1
    s_sleep 4
    buffer_load_dwordx4 v[160:163], v4, s[36:39], 0 offen offset:0 sc1
    buffer_load_dwordx4 v[164:167], v4, s[36:39], 0 offen offset:1024 sc1
    s_sleep 4
    s_mov_b32 s80, 200000
PP_86:
    s_waitcnt vmcnt(2)
    v_cmp_ne_u64 vcc, s[94:95], v[154:155]
    v_cmp_ne_u64 s[84:85], s[94:95], v[158:159]
    s_or_b64 vcc, vcc, s[84:85]
    s_cmp_eq_u64 vcc, 0
    s_cbranch_scc1 PPO_88
    buffer_load_dwordx4 v[152:155], v4, s[36:39], 0 offen offset:0 sc1
    buffer_load_dwordx4 v[156:159], v4, s[36:39], 0 offen offset:1024 sc1
    s_waitcnt vmcnt(2)
    v_cmp_ne_u64 vcc, s[94:95], v[162:163]
    v_cmp_ne_u64 s[84:85], s[94:95], v[166:167]
    s_or_b64 vcc, vcc, s[84:85]
    s_cmp_eq_u64 vcc, 0
    s_cbranch_scc1 PPO_89
    buffer_load_dwordx4 v[160:163], v4, s[36:39], 0 offen offset:0 sc1
    buffer_load_dwordx4 v[164:167], v4, s[36:39], 0 offen offset:1024 sc1
    s_sub_u32 s80, s80, 1
    s_cmp_lg_u32 s80, 0
    s_cbranch_scc1 PP_86
PPO_88:
    v_mov_b32_dpp v136, v152 quad_perm:[0,0,0,0] row_mask:0xf bank_mask:0xf
    v_mov_b32_dpp v137, v153 quad_perm:[0,0,0,0] row_mask:0xf bank_mask:0xf
    v_mov_b32_dpp v138, v156 quad_perm:[0,0,0,0] row_mask:0xf bank_mask:0xf
    v_mov_b32_dpp v139, v157 quad_perm:[0,0,0,0] row_mask:0xf bank_mask:0xf
    v_mov_b32_dpp v140, v152 quad_perm:[1,1,1,1] row_mask:0xf bank_mask:0xf
    v_mov_b32_dpp v141, v153 quad_perm:[1,1,1,1] row_mask:0xf bank_mask:0xf
    v_mov_b32_dpp v142, v156 quad_perm:[1,1,1,1] row_mask:0xf bank_mask:0xf
    v_mov_b32_dpp v143, v157 quad_perm:[1,1,1,1] row_mask:0xf bank_mask:0xf
    v_mov_b32_dpp v144, v152 quad_perm:[2,2,2,2] row_mask:0xf bank_mask:0xf
    v_mov_b32_dpp v145, v153 quad_perm:[2,2,2,2] row_mask:0xf bank_mask:0xf
    v_mov_b32_dpp v146, v156 quad_perm:[2,2,2,2] row_mask:0xf bank_mask:0xf
    v_mov_b32_dpp v147, v157 quad_perm:[2,2,2,2] row_mask:0xf bank_mask:0xf
    v_mov_b32_dpp v148, v152 quad_perm:[3,3,3,3] row_mask:0xf bank_mask:0xf
    v_mov_b32_dpp v149, v153 quad_perm:[3,3,3,3] row_mask:0xf bank_mask:0xf
    v_mov_b32_dpp v150, v156 quad_perm:[3,3,3,3] row_mask:0xf bank_mask:0xf
    v_mov_b32_dpp v151, v157 quad_perm:[3,3,3,3] row_mask:0xf bank_mask:0xf
    s_branch PPD_87
PPO_89:
    v_mov_b32_dpp v136, v160 quad_perm:[0,0,0,0] row_mask:0xf bank_mask:0xf
    v_mov_b32_dpp v137, v161 quad_perm:[0,0,0,0] row_mask:0xf bank_mask:0xf
    v_mov_b32_dpp v138, v164 quad_perm:[0,0,0,0] row_mask:0xf bank_mask:0xf
    v_mov_b32_dpp v139, v165 quad_perm:[0,0,0,0] row_mask:0xf bank_mask:0xf
    v_mov_b32_dpp v140, v160 quad_perm:[1,1,1,1] row_mask:0xf bank_mask:0xf
    v_mov_b32_dpp v141, v161 quad_perm:[1,1,1,1] row_mask:0xf bank_mask:0xf
    v_mov_b32_dpp v142, v164 quad_perm:[1,1,1,1] row_mask:0xf bank_mask:0xf
    v_mov_b32_dpp v143, v165 quad_perm:[1,1,1,1] row_mask:0xf bank_mask:0xf
    v_mov_b32_dpp v144, v160 quad_perm:[2,2,2,2] row_mask:0xf bank_mask:0xf
    v_mov_b32_dpp v145, v161 quad_perm:[2,2,2,2] row_mask:0xf bank_mask:0xf
    v_mov_b32_dpp v146, v164 quad_perm:[2,2,2,2] row_mask:0xf bank_mask:0xf
    v_mov_b32_dpp v147, v165 quad_perm:[2,2,2,2] row_mask:0xf bank_mask:0xf
    v_mov_b32_dpp v148, v160 quad_perm:[3,3,3,3] row_mask:0xf bank_mask:0xf
    v_mov_b32_dpp v149, v161 quad_perm:[3,3,3,3] row_mask:0xf bank_mask:0xf
    v_mov_b32_dpp v150, v164 quad_perm:[3,3,3,3] row_mask:0xf bank_mask:0xf
    v_mov_b32_dpp v151, v165 quad_perm:[3,3,3,3] row_mask:0xf bank_mask:0xf
PPD_87:
S2M_76:
    s_nop 1
    v_mfma_f32_16x16x32_bf16 v[4:7], v[136:139], v[8:11], 0
    v_mfma_f32_16x16x32_bf16 v[4:7], v[140:143], v[40:43], v[4:7]
    v_mfma_f32_16x16x32_bf16 v[4:7], v[144:147], v[72:75], v[4:7]
    v_mfma_f32_16x16x32_bf16 v[4:7], v[148:151], v[104:107], v[4:7]
    v_mfma_f32_16x16x32_bf16 v[8:11], v[136:139], v[12:15], 0
    v_mfma_f32_16x16x32_bf16 v[8:11], v[140:143], v[44:47], v[8:11]
    v_mfma_f32_16x16x32_bf16 v[8:11], v[144:147], v[76:79], v[8:11]
    v_mfma_f32_16x16x32_bf16 v[8:11], v[148:151], v[108:111], v[8:11]
    v_mfma_f32_16x16x32_bf16 v[12:15], v[136:139], v[16:19], 0
    v_mfma_f32_16x16x32_bf16 v[12:15], v[140:143], v[48:51], v[12:15]
    v_mfma_f32_16x16x32_bf16 v[12:15], v[144:147], v[80:83], v[12:15]
    v_mfma_f32_16x16x32_bf16 v[12:15], v[148:151], v[112:115], v[12:15]
    v_mfma_f32_16x16x32_bf16 v[16:19], v[136:139], v[20:23], 0
    v_mfma_f32_16x16x32_bf16 v[16:19], v[140:143], v[52:55], v[16:19]
    v_mfma_f32_16x16x32_bf16 v[16:19], v[144:147], v[84:87], v[16:19]
    v_mfma_f32_16x16x32_bf16 v[16:19], v[148:151], v[116:119], v[16:19]
    v_mfma_f32_16x16x32_bf16 v[20:23], v[136:139], v[24:27], 0
    v_mfma_f32_16x16x32_bf16 v[20:23], v[140:143], v[56:59], v[20:23]
    v_mfma_f32_16x16x32_bf16 v[20:23], v[144:147], v[88:91], v[20:23]
    v_mfma_f32_16x16x32_bf16 v[20:23], v[148:151], v[120:123], v[20:23]
    v_mfma_f32_16x16x32_bf16 v[24:27], v[136:139], v[28:31], 0
    v_mfma_f32_16x16x32_bf16 v[24:27], v[140:143], v[60:63], v[24:27]
    v_mfma_f32_16x16x32_bf16 v[24:27], v[144:147], v[92:95], v[24:27]
    v_mfma_f32_16x16x32_bf16 v[24:27], v[148:151], v[124:127], v[24:27]
    v_mfma_f32_16x16x32_bf16 v[28:31], v[136:139], v[32:35], 0
    v_mfma_f32_16x16x32_bf16 v[28:31], v[140:143], v[64:67], v[28:31]
    v_mfma_f32_16x16x32_bf16 v[28:31], v[144:147], v[96:99], v[28:31]
    v_mfma_f32_16x16x32_bf16 v[28:31], v[148:151], v[128:131], v[28:31]
    v_mfma_f32_16x16x32_bf16 v[32:35], v[136:139], v[36:39], 0
    v_mfma_f32_16x16x32_bf16 v[32:35], v[140:143], v[68:71], v[32:35]
    v_mfma_f32_16x16x32_bf16 v[32:35], v[144:147], v[100:103], v[32:35]
    v_mfma_f32_16x16x32_bf16 v[32:35], v[148:151], v[132:135], v[32:35]
    v_mov_b32 v42, s94
    v_mov_b32 v43, s95
    v_cvt_pk_bf16_f32 v40, v4, v8
    v_cvt_pk_bf16_f32 v41, v12, v16
    buffer_store_dwordx4 v[40:43], v3, s[36:39], 0 offen sc1
    v_mov_b32 v46, s94
    v_mov_b32 v47, s95
    v_cvt_pk_bf16_f32 v44, v20, v24
    v_cvt_pk_bf16_f32 v45, v28, v32
    buffer_store_dwordx4 v[44:47], v3, s[36:39], s70 offen sc1
    s_endpgm
L_C:
    v_and_b32 v1, 63, v0
    s_and_b32 s7, s5, 3
    s_lshl_b32 s6, s4, 2
    s_add_u32 s6, s6, s7
    s_mov_b32 s92, 0x05040100
    s_mov_b32 s93, 0x07060302
    s_lshl_b32 s60, s4, 3
    s_add_u32 s60, s60, s5
    s_sub_u32 s60, s60, 8
    s_lshr_b32 s64, s3, 1
    s_and_b32 s65, s3, 1
    s_mov_b32 s67, 0x3e0293ee
    v_lshlrev_b32 v160, 4, v1
    s_and_b32 s7, s3, 3
    s_lshl_b32 s7, s7, 2
    s_lshr_b32 s66, s3, 2
    s_or_b32 s7, s7, s66
    s_lshl_b32 s62, s7, 4
    v_xor_b32 v2, s62, v160
    v_xor_b32 v3, 32, v2
    s_lshl_b32 s70, s60, 18
    s_lshl_b32 s68, s3, 10
    s_add_u32 s61, s70, s68
    s_waitcnt lgkmcnt(0)
    s_mov_b32 s44, s20
    s_and_b32 s45, s21, 0xffff
    s_mov_b32 s46, 0x1000000
    s_mov_b32 s47, 0x20000
    s_mov_b32 m0, s68
    s_nop 0
    buffer_load_dwordx4 v2, s[44:47], s61 offen nt lds
    s_add_u32 s68, s68, 8192
    s_add_u32 s61, s61, 8192
    s_mov_b32 m0, s68
    s_nop 0
    buffer_load_dwordx4 v3, s[44:47], s61 offen nt lds
    s_add_u32 s68, s68, 8192
    s_add_u32 s61, s61, 8192
    s_mov_b32 m0, s68
    s_nop 0
    buffer_load_dwordx4 v2, s[44:47], s61 offen nt lds
    s_add_u32 s68, s68, 8192
    s_add_u32 s61, s61, 8192
    s_mov_b32 m0, s68
    s_nop 0
    buffer_load_dwordx4 v3, s[44:47], s61 offen nt lds
    s_add_u32 s68, s68, 8192
    s_mov_b32 s36, s34
    s_and_b32 s37, s35, 0xffff
    s_mov_b32 s38, 0x1000000
    s_mov_b32 s39, 0x20000
    s_mov_b32 s40, s32
    s_and_b32 s41, s33, 0xffff
    s_mov_b32 s42, 0x100
    s_mov_b32 s43, 0x20000
    s_barrier
    s_add_u32 s61, s61, 8192
    s_mov_b32 m0, s68
    s_waitcnt vmcnt(3)
    buffer_load_dwordx4 v2, s[44:47], s61 offen nt lds
    s_add_u32 s68, s68, 8192
    s_add_u32 s61, s61, 8192
    s_mov_b32 m0, s68
    s_waitcnt vmcnt(3)
    buffer_load_dwordx4 v3, s[44:47], s61 offen nt lds
    s_add_u32 s68, s68, 8192
    s_add_u32 s61, s61, 8192
    s_mov_b32 m0, s68
    s_waitcnt vmcnt(3)
    buffer_load_dwordx4 v2, s[44:47], s61 offen nt lds
    s_add_u32 s68, s68, 8192
    s_add_u32 s61, s61, 8192
    s_mov_b32 m0, s68
    s_waitcnt vmcnt(3)
    buffer_load_dwordx4 v3, s[44:47], s61 offen nt lds
    s_add_u32 s68, s68, 8192
    s_add_u32 s61, s61, 8192
    s_mov_b32 m0, s68
    s_waitcnt vmcnt(3)
    buffer_load_dwordx4 v2, s[44:47], s61 offen nt lds
    s_add_u32 s68, s68, 8192
    s_add_u32 s61, s61, 8192
    s_mov_b32 m0, s68
    s_waitcnt vmcnt(3)
    buffer_load_dwordx4 v3, s[44:47], s61 offen nt lds
    s_add_u32 s68, s68, 8192
    s_add_u32 s61, s61, 8192
    s_mov_b32 m0, s68
    s_waitcnt vmcnt(3)
    buffer_load_dwordx4 v2, s[44:47], s61 offen nt lds
    s_add_u32 s68, s68, 8192
    s_add_u32 s61, s61, 8192
    s_mov_b32 m0, s68
    s_waitcnt vmcnt(3)
    buffer_load_dwordx4 v3, s[44:47], s61 offen nt lds
    s_add_u32 s68, s68, 8192
    s_add_u32 s61, s61, 8192
    s_waitcnt vmcnt(3)
    buffer_load_dwordx4 v[128:131], v2, s[44:47], s61 offen nt
    s_add_u32 s61, s61, 8192
    s_waitcnt vmcnt(3)
    buffer_load_dwordx4 v[132:135], v3, s[44:47], s61 offen nt
    s_add_u32 s61, s61, 8192
    s_waitcnt vmcnt(3)
    buffer_load_dwordx4 v[136:139], v2, s[44:47], s61 offen nt
    s_add_u32 s61, s61, 8192
    s_waitcnt vmcnt(3)
    buffer_load_dwordx4 v[140:143], v3, s[44:47], s61 offen nt
    s_add_u32 s61, s61, 8192
    s_waitcnt vmcnt(3)
    buffer_load_dwordx4 v[96:99], v2, s[44:47], s61 offen nt
    s_add_u32 s61, s61, 8192
    s_waitcnt vmcnt(3)
    buffer_load_dwordx4 v[100:103], v3, s[44:47], s61 offen nt
    s_add_u32 s61, s61, 8192
    s_waitcnt vmcnt(3)
    buffer_load_dwordx4 v[104:107], v2, s[44:47], s61 offen nt
    s_add_u32 s61, s61, 8192
    s_waitcnt vmcnt(3)
    buffer_load_dwordx4 v[108:111], v3, s[44:47], s61 offen nt
    s_add_u32 s61, s61, 8192
    s_waitcnt vmcnt(3)
    buffer_load_dwordx4 v[112:115], v2, s[44:47], s61 offen nt
    s_add_u32 s61, s61, 8192
    s_waitcnt vmcnt(3)
    buffer_load_dwordx4 v[116:119], v3, s[44:47], s61 offen nt
    s_add_u32 s61, s61, 8192
    v_mov_b32 v160, 0x24018
    v_mov_b32 v161, 1
    s_waitcnt lgkmcnt(0)
    s_mov_b64 exec, 1
    ds_add_u32 v160, v161
    s_mov_b64 exec, -1
    s_waitcnt vmcnt(3)
    buffer_load_dwordx4 v[120:123], v2, s[44:47], s61 offen nt
    s_add_u32 s61, s61, 8192
    s_waitcnt vmcnt(3)
    buffer_load_dwordx4 v[124:127], v3, s[44:47], s61 offen nt
    s_add_u32 s61, s61, 8192
    v_and_b32 v160, 15, v1
    v_lshlrev_b32 v4, 10, v160
    v_lshrrev_b32 v161, 4, v1
    v_lshl_add_u32 v4, v161, 8, v4
    v_lshl_add_u32 v3, v160, 4, v4
    s_lshl_b32 s7, s65, 14
    s_add_u32 s7, s7, 0x18000
    v_add_u32 v3, s7, v3
    v_and_b32 v162, 3, v1
    v_lshl_add_u32 v4, v162, 6, v4
    v_bfe_u32 v162, v1, 2, 2
    v_lshl_add_u32 v4, v162, 4, v4
    s_lshl_b32 s7, s64, 14
    v_add_u32 v4, s7, v4
    v_add_u32 v2, 0x10000, v4
    s_lshl_b32 s7, s65, 6
    s_add_u32 s7, s7, 0x27200
    v_lshl_add_u32 v5, v160, 2, s7
    s_lshl_b32 s7, s64, 10
    s_lshl_b32 s66, s65, 9
    s_add_u32 s7, s7, s66
    s_add_u32 s7, s7, 0x25200
    v_lshl_add_u32 v6, v160, 5, s7
    v_lshl_add_u32 v6, v161, 3, v6
    v_and_b32 v162, 31, v1
    v_lshlrev_b32 v7, 5, v162
    v_lshrrev_b32 v163, 5, v1
    v_lshl_add_u32 v7, v163, 4, v7
    v_add_u32 v7, 0x25200, v7
    v_lshlrev_b32 v8, 2, v162
    v_add_u32 v8, 0x27e00, v8
    v_bfe_u32 v162, v1, 2, 2
    v_lshl_add_u32 v164, v163, 3, v162
    v_lshlrev_b32 v164, 10, v164
    v_and_b32 v165, 1, v1
    v_lshl_add_u32 v164, v165, 3, v164
    s_lshl_b32 s7, s64, 8
    v_add_u32 v164, s7, v164
    v_bfe_u32 v165, v1, 4, 1
    v_lshlrev_b32 v165, 1, v165
    v_bfe_u32 v160, v1, 1, 1
    v_or_b32 v165, v165, v160
    s_lshl_b32 s7, s65, 3
    v_or_b32 v165, s7, v165
    v_lshlrev_b32 v162, 2, v162
    v_xor_b32 v165, v165, v162
    v_lshlrev_b32 v163, 1, v163
    v_xor_b32 v165, v165, v163
    v_xor_b32 v160, 0, v165
    v_lshl_add_u32 v9, v160, 4, v164
    v_xor_b32 v160, 4, v165
    v_lshl_add_u32 v10, v160, 4, v164
    v_xor_b32 v160, 1, v165
    v_lshl_add_u32 v11, v160, 4, v164
    v_add_u32 v11, 0x1000, v11
    v_xor_b32 v160, 5, v165
    v_lshl_add_u32 v12, v160, 4, v164
    v_add_u32 v12, 0x1000, v12
    v_mov_b32 v13, 0xff800000
    v_mov_b32 v14, 0
    v_cmp_gt_u32 s[86:87], 16, v1
    s_cmp_eq_u32 s64, 0
    s_cselect_b32 s88, 0xffff, 0
    s_mov_b32 s89, 0
    s_barrier
    v_xor_b32 v160, 0x0, v3
    ds_read_b128 v[32:35], v160
    v_xor_b32 v161, 0x10, v3
    ds_read_b128 v[36:39], v161
    v_xor_b32 v160, 0x20, v3
    ds_read_b128 v[40:43], v160
    v_xor_b32 v161, 0x30, v3
    ds_read_b128 v[44:47], v161
    v_xor_b32 v160, 0x40, v3
    ds_read_b128 v[48:51], v160
    v_xor_b32 v161, 0x50, v3
    ds_read_b128 v[52:55], v161
    v_xor_b32 v160, 0x60, v3
    ds_read_b128 v[56:59], v160
    v_xor_b32 v161, 0x70, v3
    ds_read_b128 v[60:63], v161
    v_xor_b32 v160, 0x80, v3
    ds_read_b128 v[64:67], v160
    v_xor_b32 v161, 0x90, v3
    ds_read_b128 v[68:71], v161
    v_xor_b32 v160, 0xa0, v3
    ds_read_b128 v[72:75], v160
    v_xor_b32 v161, 0xb0, v3
    ds_read_b128 v[76:79], v161
    v_xor_b32 v160, 0xc0, v3
    ds_read_b128 v[80:83], v160
    v_xor_b32 v161, 0xd0, v3
    ds_read_b128 v[84:87], v161
    v_xor_b32 v160, 0xe0, v3
    ds_read_b128 v[88:91], v160
    v_xor_b32 v161, 0xf0, v3
    ds_read_b128 v[92:95], v161
    s_lshl_b32 s7, s3, 10
    s_add_u32 s7, s7, 0x18000
    v_lshl_add_u32 v3, v1, 4, s7
    s_waitcnt lgkmcnt(0)
    s_barrier
    ds_write_b128 v3, v[128:131] offset:0
    ds_write_b128 v3, v[132:135] offset:8192
    ds_write_b128 v3, v[136:139] offset:16384
    ds_write_b128 v3, v[140:143] offset:24576
    v_xor_b32 v160, 0x0, v4
    ds_read_b128 v[24:27], v160
    v_xor_b32 v161, 0x10, v4
    ds_read_b128 v[28:31], v161
    v_xor_b32 v162, 0x20, v4
    ds_read_b128 v[164:167], v162
    v_xor_b32 v160, 0x30, v4
    ds_read_b128 v[144:147], v160
    v_xor_b32 v161, 0x40, v4
    ds_read_b128 v[148:151], v161
    v_xor_b32 v162, 0x50, v4
    ds_read_b128 v[152:155], v162
    v_xor_b32 v160, 0x60, v4
    ds_read_b128 v[156:159], v160
    s_waitcnt lgkmcnt(6)
    v_mfma_f32_16x16x32_bf16 v[16:19], v[24:27], v[32:35], 0
    v_xor_b32 v161, 0x70, v4
    ds_read_b128 v[24:27], v161
    s_waitcnt lgkmcnt(6)
    v_mfma_f32_16x16x32_bf16 v[16:19], v[28:31], v[36:39], v[16:19]
    v_xor_b32 v162, 0x80, v4
    ds_read_b128 v[28:31], v162
    s_waitcnt lgkmcnt(6)
    v_mfma_f32_16x16x32_bf16 v[16:19], v[164:167], v[40:43], v[16:19]
    v_xor_b32 v160, 0x90, v4
    ds_read_b128 v[164:167], v160
    s_waitcnt lgkmcnt(6)
    v_mfma_f32_16x16x32_bf16 v[16:19], v[144:147], v[44:47], v[16:19]
    v_xor_b32 v161, 0xa0, v4
    ds_read_b128 v[144:147], v161
    s_waitcnt lgkmcnt(6)
    v_mfma_f32_16x16x32_bf16 v[16:19], v[148:151], v[48:51], v[16:19]
    v_xor_b32 v162, 0xb0, v4
    ds_read_b128 v[148:151], v162
    s_waitcnt lgkmcnt(6)
    v_mfma_f32_16x16x32_bf16 v[16:19], v[152:155], v[52:55], v[16:19]
    v_xor_b32 v160, 0xc0, v4
    ds_read_b128 v[152:155], v160
    s_waitcnt lgkmcnt(6)
    v_mfma_f32_16x16x32_bf16 v[16:19], v[156:159], v[56:59], v[16:19]
    v_xor_b32 v161, 0xd0, v4
    ds_read_b128 v[156:159], v161
    s_waitcnt lgkmcnt(6)
    v_mfma_f32_16x16x32_bf16 v[16:19], v[24:27], v[60:63], v[16:19]
    v_xor_b32 v162, 0xe0, v4
    ds_read_b128 v[24:27], v162
    s_waitcnt lgkmcnt(6)
    v_mfma_f32_16x16x32_bf16 v[16:19], v[28:31], v[64:67], v[16:19]
    v_xor_b32 v160, 0xf0, v4
    ds_read_b128 v[28:31], v160
    s_waitcnt lgkmcnt(6)
    v_mfma_f32_16x16x32_bf16 v[16:19], v[164:167], v[68:71], v[16:19]
    s_waitcnt lgkmcnt(5)
    v_mfma_f32_16x16x32_bf16 v[16:19], v[144:147], v[72:75], v[16:19]
    s_waitcnt lgkmcnt(4)
    v_mfma_f32_16x16x32_bf16 v[16:19], v[148:151], v[76:79], v[16:19]
    s_waitcnt lgkmcnt(3)
    v_mfma_f32_16x16x32_bf16 v[16:19], v[152:155], v[80:83], v[16:19]
    s_waitcnt lgkmcnt(2)
    v_mfma_f32_16x16x32_bf16 v[16:19], v[156:159], v[84:87], v[16:19]
    s_waitcnt lgkmcnt(1)
    v_mfma_f32_16x16x32_bf16 v[16:19], v[24:27], v[88:91], v[16:19]
    s_waitcnt lgkmcnt(0)
    v_mfma_f32_16x16x32_bf16 v[16:19], v[28:31], v[92:95], v[16:19]
    s_waitcnt lgkmcnt(0)
    s_barrier
    v_xor_b32 v160, 0x0, v2
    ds_read_b128 v[24:27], v160
    v_xor_b32 v161, 0x10, v2
    ds_read_b128 v[28:31], v161
    v_xor_b32 v162, 0x20, v2
    ds_read_b128 v[164:167], v162
    v_xor_b32 v160, 0x30, v2
    ds_read_b128 v[144:147], v160
    v_xor_b32 v161, 0x40, v2
    ds_read_b128 v[148:151], v161
    v_xor_b32 v162, 0x50, v2
    ds_read_b128 v[152:155], v162
    v_xor_b32 v160, 0x60, v2
    ds_read_b128 v[156:159], v160
    s_waitcnt lgkmcnt(6)
    v_mfma_f32_16x16x32_bf16 v[20:23], v[24:27], v[32:35], 0
    v_xor_b32 v161, 0x70, v2
    ds_read_b128 v[24:27], v161
    s_waitcnt lgkmcnt(6)
    v_mfma_f32_16x16x32_bf16 v[20:23], v[28:31], v[36:39], v[20:23]
    v_xor_b32 v162, 0x80, v2
    ds_read_b128 v[28:31], v162
    s_waitcnt lgkmcnt(6)
    v_mfma_f32_16x16x32_bf16 v[20:23], v[164:167], v[40:43], v[20:23]
    v_xor_b32 v160, 0x90, v2
    ds_read_b128 v[164:167], v160
    s_waitcnt lgkmcnt(6)
    v_mfma_f32_16x16x32_bf16 v[20:23], v[144:147], v[44:47], v[20:23]
    v_xor_b32 v161, 0xa0, v2
    ds_read_b128 v[144:147], v161
    s_waitcnt lgkmcnt(6)
    v_mfma_f32_16x16x32_bf16 v[20:23], v[148:151], v[48:51], v[20:23]
    v_xor_b32 v162, 0xb0, v2
    ds_read_b128 v[148:151], v162
    s_waitcnt lgkmcnt(6)
    v_mfma_f32_16x16x32_bf16 v[20:23], v[152:155], v[52:55], v[20:23]
    v_xor_b32 v160, 0xc0, v2
    ds_read_b128 v[152:155], v160
    s_waitcnt lgkmcnt(6)
    v_mfma_f32_16x16x32_bf16 v[20:23], v[156:159], v[56:59], v[20:23]
    v_xor_b32 v161, 0xd0, v2
    ds_read_b128 v[156:159], v161
    s_waitcnt lgkmcnt(6)
    v_mfma_f32_16x16x32_bf16 v[20:23], v[24:27], v[60:63], v[20:23]
    v_xor_b32 v162, 0xe0, v2
    ds_read_b128 v[24:27], v162
    s_waitcnt lgkmcnt(6)
    v_mfma_f32_16x16x32_bf16 v[20:23], v[28:31], v[64:67], v[20:23]
    v_xor_b32 v160, 0xf0, v2
    ds_read_b128 v[28:31], v160
    s_waitcnt lgkmcnt(6)
    v_mfma_f32_16x16x32_bf16 v[20:23], v[164:167], v[68:71], v[20:23]
    s_waitcnt lgkmcnt(5)
    v_mfma_f32_16x16x32_bf16 v[20:23], v[144:147], v[72:75], v[20:23]
    s_waitcnt lgkmcnt(4)
    v_mfma_f32_16x16x32_bf16 v[20:23], v[148:151], v[76:79], v[20:23]
    s_waitcnt lgkmcnt(3)
    v_mfma_f32_16x16x32_bf16 v[20:23], v[152:155], v[80:83], v[20:23]
    s_waitcnt lgkmcnt(2)
    v_mfma_f32_16x16x32_bf16 v[20:23], v[156:159], v[84:87], v[20:23]
    s_waitcnt lgkmcnt(1)
    v_mfma_f32_16x16x32_bf16 v[20:23], v[24:27], v[88:91], v[20:23]
    s_waitcnt lgkmcnt(0)
    v_mfma_f32_16x16x32_bf16 v[20:23], v[28:31], v[92:95], v[20:23]
    v_max3_f32 v160, v16, v17, v18
    s_nop 6
    v_max3_f32 v160, v160, v19, v20
    v_max3_f32 v160, v160, v21, v22
    v_max_f32 v160, v160, v23
    v_mov_b32 v161, v160
    s_nop 1
    v_permlane32_swap_b32 v160, v161
    v_max_f32 v160, v160, v161
    v_mov_b32 v161, v160
    s_nop 1
    v_permlane16_swap_b32 v160, v161
    v_max_f32 v160, v160, v161
    s_lshl_b32 s7, s64, 7
    v_add_u32 v161, s7, v5
    s_mov_b64 exec, s[86:87]
    ds_write_b32 v161, v160
    s_mov_b64 exec, -1
    s_waitcnt lgkmcnt(0)
    s_barrier
    ds_read_b32 v160, v5 offset:0
    ds_read_b32 v161, v5 offset:128
    ds_read_b32 v162, v5 offset:256
    ds_read_b32 v163, v5 offset:384
    s_waitcnt lgkmcnt(0)
    v_max3_f32 v160, v160, v161, v162
    v_max_f32 v160, v160, v163
    v_mul_f32 v160, s67, v160
    v_max_f32 v160, v160, v13
    v_sub_f32 v161, v13, v160
    v_exp_f32 v161, v161
    v_mov_b32 v13, v160
    v_fma_f32 v16, v16, s67, -v160
    v_fma_f32 v17, v17, s67, -v160
    v_fma_f32 v18, v18, s67, -v160
    v_fma_f32 v19, v19, s67, -v160
    v_fma_f32 v20, v20, s67, -v160
    v_fma_f32 v21, v21, s67, -v160
    v_fma_f32 v22, v22, s67, -v160
    v_fma_f32 v23, v23, s67, -v160
    v_exp_f32 v16, v16
    v_exp_f32 v17, v17
    v_exp_f32 v18, v18
    v_exp_f32 v19, v19
    v_exp_f32 v20, v20
    v_exp_f32 v21, v21
    v_exp_f32 v22, v22
    v_exp_f32 v23, v23
    v_cvt_pk_bf16_f32 v24, v16, v17
    v_cvt_pk_bf16_f32 v25, v18, v19
    v_cvt_pk_bf16_f32 v26, v20, v21
    v_cvt_pk_bf16_f32 v27, v22, v23
    ds_write_b64 v6, v[24:25]
    ds_write_b64 v6, v[26:27] offset:4096
    v_add_u32 v162, 0xc00, v5
    s_mov_b64 exec, s[88:89]
    ds_write_b32 v162, v161
    s_mov_b64 exec, -1
    v_mul_f32 v14, v14, v161
    v_add_f32 v16, v16, v20
    v_add_f32 v17, v17, v21
    v_add_f32 v18, v18, v22
    v_add_f32 v19, v19, v23
    v_add_f32 v16, v16, v18
    v_add_f32 v17, v17, v19
    v_add_f32 v16, v16, v17
    v_add_f32 v14, v14, v16
    v_lshlrev_b32 v3, 4, v1
    v_xor_b32 v3, s62, v3
    v_xor_b32 v15, 32, v3
    s_lshl_b32 s68, s3, 10
    s_waitcnt lgkmcnt(0)
    s_barrier
    ds_read_b128 v[16:19], v7 offset:0
    ds_read_b64_tr_b16 v[24:25], v9 offset:0
    ds_read_b64_tr_b16 v[26:27], v11 offset:0
    ds_read_b64_tr_b16 v[28:29], v10 offset:0
    ds_read_b64_tr_b16 v[30:31], v12 offset:0
    ds_read_b128 v[20:23], v7 offset:1024
    ds_read_b64_tr_b16 v[160:161], v9 offset:16384
    ds_read_b64_tr_b16 v[162:163], v11 offset:16384
    ds_read_b64_tr_b16 v[164:165], v10 offset:16384
    ds_read_b64_tr_b16 v[166:167], v12 offset:16384
    s_waitcnt lgkmcnt(7)
    v_mfma_f32_32x32x16_bf16 v[128:143], v[24:27], v[16:19], 0
    s_waitcnt lgkmcnt(5)
    v_mfma_f32_32x32x16_bf16 v[144:159], v[28:31], v[16:19], 0
    ds_read_b128 v[16:19], v7 offset:2048
    ds_read_b64_tr_b16 v[24:25], v9 offset:32768
    ds_read_b64_tr_b16 v[26:27], v11 offset:32768
    ds_read_b64_tr_b16 v[28:29], v10 offset:32768
    ds_read_b64_tr_b16 v[30:31], v12 offset:32768
    s_waitcnt lgkmcnt(7)
    v_mfma_f32_32x32x16_bf16 v[128:143], v[160:163], v[20:23], v[128:143]
    s_waitcnt lgkmcnt(5)
    v_mfma_f32_32x32x16_bf16 v[144:159], v[164:167], v[20:23], v[144:159]
    ds_read_b128 v[20:23], v7 offset:3072
    ds_read_b64_tr_b16 v[160:161], v9 offset:49152
    ds_read_b64_tr_b16 v[162:163], v11 offset:49152
    ds_read_b64_tr_b16 v[164:165], v10 offset:49152
    ds_read_b64_tr_b16 v[166:167], v12 offset:49152
    s_waitcnt lgkmcnt(7)
    v_mfma_f32_32x32x16_bf16 v[128:143], v[24:27], v[16:19], v[128:143]
    s_waitcnt lgkmcnt(5)
    v_mfma_f32_32x32x16_bf16 v[144:159], v[28:31], v[16:19], v[144:159]
    v_add_u32 v9, 0x10000, v9
    v_add_u32 v10, 0x10000, v10
    v_add_u32 v11, 0x10000, v11
    v_add_u32 v12, 0x10000, v12
    ds_read_b128 v[16:19], v7 offset:4096
    ds_read_b64_tr_b16 v[24:25], v9 offset:0
    ds_read_b64_tr_b16 v[26:27], v11 offset:0
    ds_read_b64_tr_b16 v[28:29], v10 offset:0
    ds_read_b64_tr_b16 v[30:31], v12 offset:0
    s_waitcnt lgkmcnt(7)
    v_mfma_f32_32x32x16_bf16 v[128:143], v[160:163], v[20:23], v[128:143]
    s_waitcnt lgkmcnt(5)
    v_mfma_f32_32x32x16_bf16 v[144:159], v[164:167], v[20:23], v[144:159]
    s_barrier
    s_mov_b32 m0, s68
    s_add_u32 s68, s68, 8192
    buffer_load_dwordx4 v3, s[44:47], s61 offen nt lds
    s_add_u32 s61, s61, 8192
    s_mov_b32 m0, s68
    s_add_u32 s68, s68, 8192
    buffer_load_dwordx4 v15, s[44:47], s61 offen nt lds
    s_add_u32 s61, s61, 8192
    s_mov_b32 m0, s68
    s_add_u32 s68, s68, 8192
    buffer_load_dwordx4 v3, s[44:47], s61 offen nt lds
    s_add_u32 s61, s61, 8192
    s_mov_b32 m0, s68
    s_add_u32 s68, s68, 8192
    buffer_load_dwordx4 v15, s[44:47], s61 offen nt lds
    s_add_u32 s61, s61, 8192
    ds_read_b128 v[20:23], v7 offset:5120
    ds_read_b64_tr_b16 v[160:161], v9 offset:16384
    ds_read_b64_tr_b16 v[162:163], v11 offset:16384
    ds_read_b64_tr_b16 v[164:165], v10 offset:16384
    ds_read_b64_tr_b16 v[166:167], v12 offset:16384
    s_waitcnt lgkmcnt(7)
    v_mfma_f32_32x32x16_bf16 v[128:143], v[24:27], v[16:19], v[128:143]
    s_waitcnt lgkmcnt(5)
    v_mfma_f32_32x32x16_bf16 v[144:159], v[28:31], v[16:19], v[144:159]
    s_mov_b32 m0, s68
    s_add_u32 s68, s68, 8192
    buffer_load_dwordx4 v3, s[44:47], s61 offen nt lds
    s_add_u32 s61, s61, 8192
    s_mov_b32 m0, s68
    s_add_u32 s68, s68, 8192
    buffer_load_dwordx4 v15, s[44:47], s61 offen nt lds
    s_add_u32 s61, s61, 8192
    s_mov_b32 m0, s68
    s_add_u32 s68, s68, 8192
    buffer_load_dwordx4 v3, s[44:47], s61 offen nt lds
    s_add_u32 s61, s61, 8192
    s_mov_b32 m0, s68
    s_add_u32 s68, s68, 8192
    buffer_load_dwordx4 v15, s[44:47], s61 offen nt lds
    s_add_u32 s61, s61, 8192
    ds_read_b128 v[16:19], v7 offset:6144
    ds_read_b64_tr_b16 v[24:25], v9 offset:32768
    ds_read_b64_tr_b16 v[26:27], v11 offset:32768
    ds_read_b64_tr_b16 v[28:29], v10 offset:32768
    ds_read_b64_tr_b16 v[30:31], v12 offset:32768
    s_waitcnt lgkmcnt(7)
    v_mfma_f32_32x32x16_bf16 v[128:143], v[160:163], v[20:23], v[128:143]
    s_waitcnt lgkmcnt(5)
    v_mfma_f32_32x32x16_bf16 v[144:159], v[164:167], v[20:23], v[144:159]
    ds_read_b128 v[20:23], v7 offset:7168
    ds_read_b64_tr_b16 v[160:161], v9 offset:49152
    ds_read_b64_tr_b16 v[162:163], v11 offset:49152
    ds_read_b64_tr_b16 v[164:165], v10 offset:49152
    ds_read_b64_tr_b16 v[166:167], v12 offset:49152
    s_waitcnt lgkmcnt(7)
    v_mfma_f32_32x32x16_bf16 v[128:143], v[24:27], v[16:19], v[128:143]
    s_waitcnt lgkmcnt(5)
    v_mfma_f32_32x32x16_bf16 v[144:159], v[28:31], v[16:19], v[144:159]
    s_waitcnt lgkmcnt(2)
    v_mfma_f32_32x32x16_bf16 v[128:143], v[160:163], v[20:23], v[128:143]
    s_waitcnt lgkmcnt(0)
    v_mfma_f32_32x32x16_bf16 v[144:159], v[164:167], v[20:23], v[144:159]
    v_add_u32 v9, 0xffff0000, v9
    v_add_u32 v10, 0xffff0000, v10
    v_add_u32 v11, 0xffff0000, v11
    v_add_u32 v12, 0xffff0000, v12
    s_lshl_b32 s7, s3, 10
    s_add_u32 s7, s7, 0x10000
    v_lshl_add_u32 v3, v1, 4, s7
    s_waitcnt vmcnt(8)
    s_barrier
    ds_write_b128 v3, v[96:99] offset:0
    ds_write_b128 v3, v[100:103] offset:8192
    ds_write_b128 v3, v[104:107] offset:16384
    ds_write_b128 v3, v[108:111] offset:24576
    ds_write_b128 v3, v[112:115] offset:32768
    ds_write_b128 v3, v[116:119] offset:40960
    ds_write_b128 v3, v[120:123] offset:49152
    ds_write_b128 v3, v[124:127] offset:57344
    s_waitcnt lgkmcnt(0)
    s_barrier
    v_xor_b32 v160, 0x0, v2
    ds_read_b128 v[24:27], v160
    v_xor_b32 v161, 0x10, v2
    ds_read_b128 v[28:31], v161
    v_xor_b32 v162, 0x20, v2
    ds_read_b128 v[164:167], v162
    v_xor_b32 v160, 0x30, v2
    ds_read_b128 v[96:99], v160
    v_xor_b32 v161, 0x40, v2
    ds_read_b128 v[100:103], v161
    v_xor_b32 v162, 0x50, v2
    ds_read_b128 v[104:107], v162
    v_xor_b32 v160, 0x60, v2
    ds_read_b128 v[108:111], v160
    s_waitcnt lgkmcnt(6)
    v_mfma_f32_16x16x32_bf16 v[20:23], v[24:27], v[32:35], 0
    v_xor_b32 v161, 0x70, v2
    ds_read_b128 v[24:27], v161
    s_waitcnt lgkmcnt(6)
    v_mfma_f32_16x16x32_bf16 v[20:23], v[28:31], v[36:39], v[20:23]
    v_xor_b32 v162, 0x80, v2
    ds_read_b128 v[28:31], v162
    s_waitcnt lgkmcnt(6)
    v_mfma_f32_16x16x32_bf16 v[20:23], v[164:167], v[40:43], v[20:23]
    v_xor_b32 v160, 0x90, v2
    ds_read_b128 v[164:167], v160
    s_waitcnt lgkmcnt(6)
    v_mfma_f32_16x16x32_bf16 v[20:23], v[96:99], v[44:47], v[20:23]
    v_xor_b32 v161, 0xa0, v2
    ds_read_b128 v[96:99], v161
    s_waitcnt lgkmcnt(6)
    v_mfma_f32_16x16x32_bf16 v[20:23], v[100:103], v[48:51], v[20:23]
    v_xor_b32 v162, 0xb0, v2
    ds_read_b128 v[100:103], v162
    s_waitcnt lgkmcnt(6)
    v_mfma_f32_16x16x32_bf16 v[20:23], v[104:107], v[52:55], v[20:23]
    v_xor_b32 v160, 0xc0, v2
    ds_read_b128 v[104:107], v160
    s_waitcnt lgkmcnt(6)
    v_mfma_f32_16x16x32_bf16 v[20:23], v[108:111], v[56:59], v[20:23]
    v_xor_b32 v161, 0xd0, v2
    ds_read_b128 v[108:111], v161
    s_waitcnt lgkmcnt(6)
    v_mfma_f32_16x16x32_bf16 v[20:23], v[24:27], v[60:63], v[20:23]
    v_xor_b32 v162, 0xe0, v2
    ds_read_b128 v[24:27], v162
    s_waitcnt lgkmcnt(6)
    v_mfma_f32_16x16x32_bf16 v[20:23], v[28:31], v[64:67], v[20:23]
    v_xor_b32 v160, 0xf0, v2
    ds_read_b128 v[28:31], v160
    s_waitcnt lgkmcnt(6)
    v_mfma_f32_16x16x32_bf16 v[20:23], v[164:167], v[68:71], v[20:23]
    s_waitcnt lgkmcnt(5)
    v_mfma_f32_16x16x32_bf16 v[20:23], v[96:99], v[72:75], v[20:23]
    s_waitcnt lgkmcnt(4)
    v_mfma_f32_16x16x32_bf16 v[20:23], v[100:103], v[76:79], v[20:23]
    s_waitcnt lgkmcnt(3)
    v_mfma_f32_16x16x32_bf16 v[20:23], v[104:107], v[80:83], v[20:23]
    s_waitcnt lgkmcnt(2)
    v_mfma_f32_16x16x32_bf16 v[20:23], v[108:111], v[84:87], v[20:23]
    s_waitcnt lgkmcnt(1)
    v_mfma_f32_16x16x32_bf16 v[20:23], v[24:27], v[88:91], v[20:23]
    s_waitcnt lgkmcnt(0)
    v_mfma_f32_16x16x32_bf16 v[20:23], v[28:31], v[92:95], v[20:23]
    s_waitcnt vmcnt(0)
    s_barrier
    v_xor_b32 v160, 0x0, v4
    ds_read_b128 v[24:27], v160
    v_xor_b32 v161, 0x10, v4
    ds_read_b128 v[28:31], v161
    v_xor_b32 v162, 0x20, v4
    ds_read_b128 v[164:167], v162
    v_xor_b32 v160, 0x30, v4
    ds_read_b128 v[96:99], v160
    v_xor_b32 v161, 0x40, v4
    ds_read_b128 v[100:103], v161
    v_xor_b32 v162, 0x50, v4
    ds_read_b128 v[104:107], v162
    v_xor_b32 v160, 0x60, v4
    ds_read_b128 v[108:111], v160
    s_waitcnt lgkmcnt(6)
    v_mfma_f32_16x16x32_bf16 v[16:19], v[24:27], v[32:35], 0
    v_xor_b32 v161, 0x70, v4
    ds_read_b128 v[24:27], v161
    s_waitcnt lgkmcnt(6)
    v_mfma_f32_16x16x32_bf16 v[16:19], v[28:31], v[36:39], v[16:19]
    v_xor_b32 v162, 0x80, v4
    ds_read_b128 v[28:31], v162
    s_waitcnt lgkmcnt(6)
    v_mfma_f32_16x16x32_bf16 v[16:19], v[164:167], v[40:43], v[16:19]
    v_xor_b32 v160, 0x90, v4
    ds_read_b128 v[164:167], v160
    s_waitcnt lgkmcnt(6)
    v_mfma_f32_16x16x32_bf16 v[16:19], v[96:99], v[44:47], v[16:19]
    v_xor_b32 v161, 0xa0, v4
    ds_read_b128 v[96:99], v161
    s_waitcnt lgkmcnt(6)
    v_mfma_f32_16x16x32_bf16 v[16:19], v[100:103], v[48:51], v[16:19]
    v_xor_b32 v162, 0xb0, v4
    ds_read_b128 v[100:103], v162
    s_waitcnt lgkmcnt(6)
    v_mfma_f32_16x16x32_bf16 v[16:19], v[104:107], v[52:55], v[16:19]
    v_xor_b32 v160, 0xc0, v4
    ds_read_b128 v[104:107], v160
    s_waitcnt lgkmcnt(6)
    v_mfma_f32_16x16x32_bf16 v[16:19], v[108:111], v[56:59], v[16:19]
    v_xor_b32 v161, 0xd0, v4
    ds_read_b128 v[108:111], v161
    s_waitcnt lgkmcnt(6)
    v_mfma_f32_16x16x32_bf16 v[16:19], v[24:27], v[60:63], v[16:19]
    v_xor_b32 v162, 0xe0, v4
    ds_read_b128 v[24:27], v162
    s_waitcnt lgkmcnt(6)
    v_mfma_f32_16x16x32_bf16 v[16:19], v[28:31], v[64:67], v[16:19]
    v_xor_b32 v160, 0xf0, v4
    ds_read_b128 v[28:31], v160
    s_waitcnt lgkmcnt(6)
    v_mfma_f32_16x16x32_bf16 v[16:19], v[164:167], v[68:71], v[16:19]
    s_waitcnt lgkmcnt(5)
    v_mfma_f32_16x16x32_bf16 v[16:19], v[96:99], v[72:75], v[16:19]
    s_waitcnt lgkmcnt(4)
    v_mfma_f32_16x16x32_bf16 v[16:19], v[100:103], v[76:79], v[16:19]
    s_waitcnt lgkmcnt(3)
    v_mfma_f32_16x16x32_bf16 v[16:19], v[104:107], v[80:83], v[16:19]
    s_waitcnt lgkmcnt(2)
    v_mfma_f32_16x16x32_bf16 v[16:19], v[108:111], v[84:87], v[16:19]
    s_waitcnt lgkmcnt(1)
    v_mfma_f32_16x16x32_bf16 v[16:19], v[24:27], v[88:91], v[16:19]
    s_waitcnt lgkmcnt(0)
    v_mfma_f32_16x16x32_bf16 v[16:19], v[28:31], v[92:95], v[16:19]
    s_nop 7
    v_max3_f32 v160, v16, v17, v18
    v_max3_f32 v160, v160, v19, v20
    v_max3_f32 v160, v160, v21, v22
    v_max_f32 v160, v160, v23
    v_mov_b32 v161, v160
    s_nop 1
    v_permlane32_swap_b32 v160, v161
    v_max_f32 v160, v160, v161
    v_mov_b32 v161, v160
    s_nop 1
    v_permlane16_swap_b32 v160, v161
    v_max_f32 v160, v160, v161
    s_lshl_b32 s7, s64, 7
    v_add_u32 v161, s7, v5
    s_mov_b64 exec, s[86:87]
    ds_write_b32 v161, v160
    s_mov_b64 exec, -1
    s_waitcnt lgkmcnt(0)
    s_barrier
    ds_read_b32 v160, v5 offset:0
    ds_read_b32 v161, v5 offset:128
    ds_read_b32 v162, v5 offset:256
    ds_read_b32 v163, v5 offset:384
    s_waitcnt lgkmcnt(0)
    v_max3_f32 v160, v160, v161, v162
    v_max_f32 v160, v160, v163
    v_mul_f32 v160, s67, v160
    v_max_f32 v160, v160, v13
    v_sub_f32 v161, v13, v160
    v_exp_f32 v161, v161
    v_mov_b32 v13, v160
    v_fma_f32 v16, v16, s67, -v160
    v_fma_f32 v17, v17, s67, -v160
    v_fma_f32 v18, v18, s67, -v160
    v_fma_f32 v19, v19, s67, -v160
    v_fma_f32 v20, v20, s67, -v160
    v_fma_f32 v21, v21, s67, -v160
    v_fma_f32 v22, v22, s67, -v160
    v_fma_f32 v23, v23, s67, -v160
    v_exp_f32 v16, v16
    v_exp_f32 v17, v17
    v_exp_f32 v18, v18
    v_exp_f32 v19, v19
    v_exp_f32 v20, v20
    v_exp_f32 v21, v21
    v_exp_f32 v22, v22
    v_exp_f32 v23, v23
    v_cvt_pk_bf16_f32 v24, v16, v17
    v_cvt_pk_bf16_f32 v25, v18, v19
    v_cvt_pk_bf16_f32 v26, v20, v21
    v_cvt_pk_bf16_f32 v27, v22, v23
    ds_write_b64 v6, v[24:25]
    ds_write_b64 v6, v[26:27] offset:4096
    v_add_u32 v162, 0xc00, v5
    s_mov_b64 exec, s[88:89]
    ds_write_b32 v162, v161
    s_mov_b64 exec, -1
    v_mul_f32 v14, v14, v161
    v_add_f32 v16, v16, v20
    v_add_f32 v17, v17, v21
    v_add_f32 v18, v18, v22
    v_add_f32 v19, v19, v23
    v_add_f32 v16, v16, v18
    v_add_f32 v17, v17, v19
    v_add_f32 v16, v16, v17
    v_add_f32 v14, v14, v16
    v_mov_b32 v160, v14
    s_nop 1
    v_permlane32_swap_b32 v14, v160
    v_add_f32 v14, v14, v160
    v_mov_b32 v160, v14
    s_nop 1
    v_permlane16_swap_b32 v14, v160
    v_add_f32 v14, v14, v160
    s_lshl_b32 s7, s64, 7
    s_add_u32 s7, s7, 0x200
    v_add_u32 v161, s7, v5
    v_add_u32 v162, 0xc80, v5
    s_mov_b64 exec, s[86:87]
    ds_write_b32 v161, v14
    s_mov_b64 exec, s[88:89]
    ds_write_b32 v162, v13
    s_mov_b64 exec, -1
    v_and_b32 v160, 31, v1
    v_lshlrev_b32 v98, 7, v160
    v_lshrrev_b32 v161, 5, v1
    v_and_b32 v160, 7, v1
    v_xor_b32 v161, v160, v161
    v_lshl_add_u32 v98, v161, 4, v98
    s_lshl_b32 s7, s3, 12
    v_add_u32 v98, s7, v98
    v_lshl_add_u32 v99, v1, 4, s7
    v_lshrrev_b32 v161, 3, v1
    v_xor_b32 v160, v160, v161
    v_lshlrev_b32 v100, 7, v161
    v_lshl_add_u32 v100, v160, 4, v100
    s_lshl_b32 s69, s60, 15
    s_add_u32 s69, s69, s7
    s_add_u32 s69, s69, 0x500000
    s_waitcnt lgkmcnt(0)
    s_barrier
    ds_read_b32 v15, v8
    ds_read_b128 v[16:19], v7 offset:0
    ds_read_b64_tr_b16 v[24:25], v9 offset:0
    ds_read_b64_tr_b16 v[26:27], v11 offset:0
    ds_read_b64_tr_b16 v[28:29], v10 offset:0
    ds_read_b64_tr_b16 v[30:31], v12 offset:0
    s_waitcnt lgkmcnt(5)
    v_mul_f32 v128, v15, v128
    v_mul_f32 v129, v15, v129
    v_mul_f32 v130, v15, v130
    v_mul_f32 v131, v15, v131
    v_mul_f32 v132, v15, v132
    v_mul_f32 v133, v15, v133
    v_mul_f32 v134, v15, v134
    v_mul_f32 v135, v15, v135
    v_mul_f32 v136, v15, v136
    v_mul_f32 v137, v15, v137
    v_mul_f32 v138, v15, v138
    v_mul_f32 v139, v15, v139
    v_mul_f32 v140, v15, v140
    v_mul_f32 v141, v15, v141
    v_mul_f32 v142, v15, v142
    v_mul_f32 v143, v15, v143
    v_mul_f32 v144, v15, v144
    v_mul_f32 v145, v15, v145
    v_mul_f32 v146, v15, v146
    v_mul_f32 v147, v15, v147
    v_mul_f32 v148, v15, v148
    v_mul_f32 v149, v15, v149
    v_mul_f32 v150, v15, v150
    v_mul_f32 v151, v15, v151
    v_mul_f32 v152, v15, v152
    v_mul_f32 v153, v15, v153
    v_mul_f32 v154, v15, v154
    v_mul_f32 v155, v15, v155
    v_mul_f32 v156, v15, v156
    v_mul_f32 v157, v15, v157
    v_mul_f32 v158, v15, v158
    v_mul_f32 v159, v15, v159
    ds_read_b128 v[20:23], v7 offset:1024
    ds_read_b64_tr_b16 v[160:161], v9 offset:16384
    ds_read_b64_tr_b16 v[162:163], v11 offset:16384
    ds_read_b64_tr_b16 v[164:165], v10 offset:16384
    ds_read_b64_tr_b16 v[166:167], v12 offset:16384
    s_waitcnt lgkmcnt(7)
    v_mfma_f32_32x32x16_bf16 v[128:143], v[24:27], v[16:19], v[128:143]
    s_waitcnt lgkmcnt(5)
    v_mfma_f32_32x32x16_bf16 v[144:159], v[28:31], v[16:19], v[144:159]
    ds_read_b128 v[16:19], v7 offset:2048
    ds_read_b64_tr_b16 v[24:25], v9 offset:32768
    ds_read_b64_tr_b16 v[26:27], v11 offset:32768
    ds_read_b64_tr_b16 v[28:29], v10 offset:32768
    ds_read_b64_tr_b16 v[30:31], v12 offset:32768
    s_waitcnt lgkmcnt(7)
    v_mfma_f32_32x32x16_bf16 v[128:143], v[160:163], v[20:23], v[128:143]
    s_waitcnt lgkmcnt(5)
    v_mfma_f32_32x32x16_bf16 v[144:159], v[164:167], v[20:23], v[144:159]
    ds_read_b128 v[20:23], v7 offset:3072
    ds_read_b64_tr_b16 v[160:161], v9 offset:49152
    ds_read_b64_tr_b16 v[162:163], v11 offset:49152
    ds_read_b64_tr_b16 v[164:165], v10 offset:49152
    ds_read_b64_tr_b16 v[166:167], v12 offset:49152
    s_waitcnt lgkmcnt(7)
    v_mfma_f32_32x32x16_bf16 v[128:143], v[24:27], v[16:19], v[128:143]
    s_waitcnt lgkmcnt(5)
    v_mfma_f32_32x32x16_bf16 v[144:159], v[28:31], v[16:19], v[144:159]
    v_add_u32 v9, 0x10000, v9
    v_add_u32 v10, 0x10000, v10
    v_add_u32 v11, 0x10000, v11
    v_add_u32 v12, 0x10000, v12
    ds_read_b128 v[16:19], v7 offset:4096
    ds_read_b64_tr_b16 v[24:25], v9 offset:0
    ds_read_b64_tr_b16 v[26:27], v11 offset:0
    ds_read_b64_tr_b16 v[28:29], v10 offset:0
    ds_read_b64_tr_b16 v[30:31], v12 offset:0
    s_waitcnt lgkmcnt(7)
    v_mfma_f32_32x32x16_bf16 v[128:143], v[160:163], v[20:23], v[128:143]
    s_waitcnt lgkmcnt(5)
    v_mfma_f32_32x32x16_bf16 v[144:159], v[164:167], v[20:23], v[144:159]
    s_barrier
    ds_read_b128 v[20:23], v7 offset:5120
    ds_read_b64_tr_b16 v[160:161], v9 offset:16384
    ds_read_b64_tr_b16 v[162:163], v11 offset:16384
    ds_read_b64_tr_b16 v[164:165], v10 offset:16384
    ds_read_b64_tr_b16 v[166:167], v12 offset:16384
    s_waitcnt lgkmcnt(7)
    v_mfma_f32_32x32x16_bf16 v[128:143], v[24:27], v[16:19], v[128:143]
    s_waitcnt lgkmcnt(5)
    v_mfma_f32_32x32x16_bf16 v[144:159], v[28:31], v[16:19], v[144:159]
    ds_read_b128 v[16:19], v7 offset:6144
    ds_read_b64_tr_b16 v[24:25], v9 offset:32768
    ds_read_b64_tr_b16 v[26:27], v11 offset:32768
    ds_read_b64_tr_b16 v[28:29], v10 offset:32768
    ds_read_b64_tr_b16 v[30:31], v12 offset:32768
    s_waitcnt lgkmcnt(7)
    v_mfma_f32_32x32x16_bf16 v[128:143], v[160:163], v[20:23], v[128:143]
    s_waitcnt lgkmcnt(5)
    v_mfma_f32_32x32x16_bf16 v[144:159], v[164:167], v[20:23], v[144:159]
    ds_read_b128 v[20:23], v7 offset:7168
    ds_read_b64_tr_b16 v[160:161], v9 offset:49152
    ds_read_b64_tr_b16 v[162:163], v11 offset:49152
    ds_read_b64_tr_b16 v[164:165], v10 offset:49152
    ds_read_b64_tr_b16 v[166:167], v12 offset:49152
    s_waitcnt lgkmcnt(7)
    v_mfma_f32_32x32x16_bf16 v[128:143], v[24:27], v[16:19], v[128:143]
    s_waitcnt lgkmcnt(5)
    v_mfma_f32_32x32x16_bf16 v[144:159], v[28:31], v[16:19], v[144:159]
    s_waitcnt lgkmcnt(2)
    v_mfma_f32_32x32x16_bf16 v[128:143], v[160:163], v[20:23], v[128:143]
    s_waitcnt lgkmcnt(0)
    v_mfma_f32_32x32x16_bf16 v[144:159], v[164:167], v[20:23], v[144:159]
    s_nop 9
    v_permlane32_swap_b32 v128, v132
    v_permlane32_swap_b32 v129, v133
    v_permlane32_swap_b32 v130, v134
    v_permlane32_swap_b32 v131, v135
    v_cvt_pk_bf16_f32 v16, v128, v129
    v_cvt_pk_bf16_f32 v17, v130, v131
    v_cvt_pk_bf16_f32 v18, v132, v133
    v_cvt_pk_bf16_f32 v19, v134, v135
    v_xor_b32 v160, 0x0, v98
    ds_write_b128 v160, v[16:19]
    v_permlane32_swap_b32 v136, v140
    v_permlane32_swap_b32 v137, v141
    v_permlane32_swap_b32 v138, v142
    v_permlane32_swap_b32 v139, v143
    v_cvt_pk_bf16_f32 v20, v136, v137
    v_cvt_pk_bf16_f32 v21, v138, v139
    v_cvt_pk_bf16_f32 v22, v140, v141
    v_cvt_pk_bf16_f32 v23, v142, v143
    v_xor_b32 v161, 0x20, v98
    ds_write_b128 v161, v[20:23]
    v_permlane32_swap_b32 v144, v148
    v_permlane32_swap_b32 v145, v149
    v_permlane32_swap_b32 v146, v150
    v_permlane32_swap_b32 v147, v151
    v_cvt_pk_bf16_f32 v24, v144, v145
    v_cvt_pk_bf16_f32 v25, v146, v147
    v_cvt_pk_bf16_f32 v26, v148, v149
    v_cvt_pk_bf16_f32 v27, v150, v151
    v_xor_b32 v160, 0x40, v98
    ds_write_b128 v160, v[24:27]
    v_permlane32_swap_b32 v152, v156
    v_permlane32_swap_b32 v153, v157
    v_permlane32_swap_b32 v154, v158
    v_permlane32_swap_b32 v155, v159
    v_cvt_pk_bf16_f32 v28, v152, v153
    v_cvt_pk_bf16_f32 v29, v154, v155
    v_cvt_pk_bf16_f32 v30, v156, v157
    v_cvt_pk_bf16_f32 v31, v158, v159
    v_xor_b32 v161, 0x60, v98
    ds_write_b128 v161, v[28:31]
    ds_read_b128 v[32:35], v99 offset:0
    ds_read_b128 v[36:39], v99 offset:1024
    ds_read_b128 v[40:43], v99 offset:2048
    ds_read_b128 v[44:47], v99 offset:3072
    s_waitcnt lgkmcnt(3)
    buffer_store_dwordx4 v[32:35], v100, s[36:39], s69 offen offset:0 sc1
    s_waitcnt lgkmcnt(2)
    buffer_store_dwordx4 v[36:39], v100, s[36:39], s69 offen offset:1024 sc1
    s_waitcnt lgkmcnt(1)
    buffer_store_dwordx4 v[40:43], v100, s[36:39], s69 offen offset:2048 sc1
    s_waitcnt lgkmcnt(0)
    buffer_store_dwordx4 v[44:47], v100, s[36:39], s69 offen offset:3072 sc1
    v_mov_b32 v160, 0x2404c
    s_mov_b32 s80, 1600000
LW_90:
    ds_read_b32 v161, v160
    s_waitcnt lgkmcnt(0)
    v_readfirstlane_b32 s79, v161
    s_cmp_ge_u32 s79, 1
    s_cbranch_scc1 LWD_91
    s_sleep 2
    s_sub_u32 s80, s80, 1
    s_cmp_lg_u32 s80, 0
    s_cbranch_scc1 LW_90
LWD_91:
    v_mov_b32 v160, 0x24050
    ds_read_b64 v[162:163], v160
    s_waitcnt lgkmcnt(0)
    v_readfirstlane_b32 s94, v162
    v_readfirstlane_b32 s95, v163
    v_and_b32 v160, 31, v1
    v_lshlrev_b32 v3, 2, v160
    v_add_u32 v3, 0x27400, v3
    s_lshl_b32 s7, s60, 9
    s_add_u32 s7, s7, 0xe0000
    s_cmp_eq_u32 s3, 0
    s_cselect_b32 s7, s7, 0x40000000
    v_lshl_add_u32 v4, v160, 4, s7
    v_mov_b32 v22, s94
    v_mov_b32 v23, s95
    ds_read_b32 v16, v3 offset:0
    ds_read_b32 v17, v3 offset:128
    ds_read_b32 v18, v3 offset:256
    ds_read_b32 v19, v3 offset:384
    ds_read_b32 v20, v3 offset:2688
    s_waitcnt lgkmcnt(0)
    v_add_f32 v16, v16, v17
    v_add_f32 v18, v18, v19
    v_add_f32 v21, v16, v18
    s_waitcnt vmcnt(0)
    s_barrier
    s_mov_b64 exec, 0xffffffff
    buffer_store_dwordx4 v[20:23], v4, s[36:39], 0 offen sc1
    s_mov_b64 exec, -1
    v_lshlrev_b32 v2, 4, v1
    s_mov_b32 s44, s12
    s_and_b32 s45, s13, 0xffff
    s_mov_b32 s46, 0x8000000
    s_mov_b32 s47, 0x20000
    s_bfe_u32 s7, s5, 0x10002
    s_lshl_b32 s7, s7, 6
    s_add_u32 s7, s7, s6
    s_lshl_b32 s7, s7, 20
    s_lshl_b32 s72, s3, 10
    s_add_u32 s72, s72, s7
    s_add_u32 s72, s72, 1040384
    s_add_u32 s73, s72, 0x2000000
    s_mov_b32 s74, 4
    s_sleep 60
PV_92:
    s_waitcnt vmcnt(3)
    buffer_load_dwordx4 v[8:11], v2, s[44:47], s72 offen
    s_sub_u32 s72, s72, 8192
    s_waitcnt vmcnt(3)
    buffer_load_dwordx4 v[8:11], v2, s[44:47], s73 offen
    s_sub_u32 s73, s73, 8192
    s_sub_u32 s74, s74, 1
    s_cmp_lg_u32 s74, 0
    s_cbranch_scc1 PV_92
    s_mov_b32 s52, s30
    s_and_b32 s53, s31, 0xffff
    s_mov_b32 s54, 0x2000
    s_mov_b32 s55, 0x20000
    s_lshl_b32 s7, s60, 3
    s_add_u32 s7, s7, s3
    s_lshl_b32 s7, s7, 10
    s_add_u32 s7, s7, 0x100000
    v_add_u32 v4, s7, v2
    s_bfe_u32 s7, s60, 0x20003
    s_lshl_b32 s7, s7, 11
    s_lshr_b32 s66, s60, 5
    s_lshl_b32 s66, s66, 10
    s_add_u32 s7, s7, s66
    s_and_b32 s66, s60, 7
    s_lshl_b32 s66, s66, 7
    s_add_u32 s7, s7, s66
    v_and_b32 v5, 7, v1
    v_lshl_add_u32 v5, v5, 4, s7
    v_lshrrev_b32 v6, 4, v1
    v_lshl_add_u32 v5, v6, 2, v5
    s_mov_b32 s90, 0x00ff00ff
    s_mov_b32 s91, 0x00ff00ff
    s_lshl_b32 s7, s3, 10
    s_add_u32 s7, s7, 0x25200
    v_add_u32 v6, s7, v2
    s_mov_b32 s80, 200000
PO_93:
    buffer_load_dwordx4 v[32:35], v4, s[36:39], 0 offen sc1
PO2_94:
    s_waitcnt vmcnt(0)
    v_cmp_ne_u64 vcc, s[94:95], v[34:35]
    s_cmp_lg_u64 vcc, -1
    s_cbranch_scc1 POD_95
    s_sleep 20
    s_sub_u32 s80, s80, 1
    s_cmp_lg_u32 s80, 0
    s_cbranch_scc1 PO_93
POD_95:
    v_lshlrev_b32 v64, 16, v32
    v_and_b32 v65, 0xffff0000, v32
    v_lshlrev_b32 v66, 16, v33
    v_and_b32 v67, 0xffff0000, v33
    s_cbranch_vccz RD_96
    buffer_load_dwordx4 v[32:35], v4, s[36:39], 0 offen sc1
    s_sleep 4
    buffer_load_dwordx4 v[36:39], v4, s[36:39], 0 offen sc1
    s_sleep 4
    s_mov_b32 s80, 200000
PP_97:
    s_waitcnt vmcnt(1)
    v_cmp_ne_u64 vcc, s[94:95], v[34:35]
    s_cmp_eq_u64 vcc, 0
    s_cbranch_scc1 PPO_99
    buffer_load_dwordx4 v[32:35], v4, s[36:39], 0 offen sc1
    s_waitcnt vmcnt(1)
    v_cmp_ne_u64 vcc, s[94:95], v[38:39]
    s_cmp_eq_u64 vcc, 0
    s_cbranch_scc1 PPO_100
    buffer_load_dwordx4 v[36:39], v4, s[36:39], 0 offen sc1
    s_sub_u32 s80, s80, 1
    s_cmp_lg_u32 s80, 0
    s_cbranch_scc1 PP_97
PPO_99:
    v_lshlrev_b32 v64, 16, v32
    v_and_b32 v65, 0xffff0000, v32
    v_lshlrev_b32 v66, 16, v33
    v_and_b32 v67, 0xffff0000, v33
    s_branch PPD_98
PPO_100:
    v_lshlrev_b32 v64, 16, v36
    v_and_b32 v65, 0xffff0000, v36
    v_lshlrev_b32 v66, 16, v37
    v_and_b32 v67, 0xffff0000, v37
PPD_98:
RD_96:
    ds_write_b128 v6, v[64:67]
    s_waitcnt lgkmcnt(0)
    s_barrier
    s_cmp_lg_u32 s3, 0
    s_cbranch_scc1 L_END
    ds_read_b128 v[64:67], v6 offset:0
    ds_read_b128 v[68:71], v6 offset:1024
    ds_read_b128 v[72:75], v6 offset:2048
    ds_read_b128 v[76:79], v6 offset:3072
    ds_read_b128 v[80:83], v6 offset:4096
    ds_read_b128 v[84:87], v6 offset:5120
    ds_read_b128 v[88:91], v6 offset:6144
    ds_read_b128 v[92:95], v6 offset:7168
    s_waitcnt lgkmcnt(4)
    v_pk_add_f32 v[64:65], v[64:65], v[72:73]
    v_pk_add_f32 v[66:67], v[66:67], v[74:75]
    v_pk_add_f32 v[68:69], v[68:69], v[76:77]
    v_pk_add_f32 v[70:71], v[70:71], v[78:79]
    v_pk_add_f32 v[64:65], v[64:65], v[68:69]
    v_pk_add_f32 v[66:67], v[66:67], v[70:71]
    s_waitcnt lgkmcnt(0)
    v_pk_add_f32 v[80:81], v[80:81], v[88:89]
    v_pk_add_f32 v[82:83], v[82:83], v[90:91]
    v_pk_add_f32 v[84:85], v[84:85], v[92:93]
    v_pk_add_f32 v[86:87], v[86:87], v[94:95]
    v_pk_add_f32 v[80:81], v[80:81], v[84:85]
    v_pk_add_f32 v[82:83], v[82:83], v[86:87]
    s_nop 0
    v_permlane32_swap_b32 v64, v80
    v_permlane32_swap_b32 v65, v81
    v_permlane32_swap_b32 v66, v82
    v_permlane32_swap_b32 v67, v83
    v_add_f32 v64, v64, v80
    v_add_f32 v65, v65, v81
    v_add_f32 v66, v66, v82
    v_add_f32 v67, v67, v83
    s_nop 0
    v_permlane16_swap_b32 v64, v66
    v_permlane16_swap_b32 v65, v67
    v_add_f32 v64, v64, v66
    v_add_f32 v65, v65, v67
    s_nop 0
    v_add_f32_dpp v64, v64, v64 row_ror:8 row_mask:0xf bank_mask:0xf
    v_add_f32_dpp v65, v65, v65 row_ror:8 row_mask:0xf bank_mask:0xf
    v_cvt_pk_bf16_f32 v8, v64, v65
    s_mov_b64 exec, s[90:91]
    buffer_store_dword v8, v5, s[52:55], 0 offen
    s_mov_b64 exec, -1
    s_endpgm
L_CSVC:
    v_and_b32 v1, 63, v0
    s_and_b32 s7, s5, 3
    s_lshl_b32 s6, s4, 2
    s_add_u32 s6, s6, s7
    s_mov_b32 s92, 0x05040100
    s_mov_b32 s93, 0x07060302
    s_cmp_lg_u32 s3, 11
    s_cbranch_scc1 Z_101
    v_lshlrev_b32 v2, 2, v1
    v_add_u32 v2, 0x24000, v2
    v_mov_b32 v3, 0
    ds_write_b32 v2, v3
Z_101:
    s_waitcnt lgkmcnt(0)
    s_mov_b32 s36, s34
    s_and_b32 s37, s35, 0xffff
    s_mov_b32 s38, 0x1000000
    s_mov_b32 s39, 0x20000
    s_mov_b32 s40, s32
    s_and_b32 s41, s33, 0xffff
    s_mov_b32 s42, 0x100
    s_mov_b32 s43, 0x20000
    s_setprio 3
    s_sub_u32 s60, s3, 8
    s_lshl_b32 s64, s4, 3
    s_add_u32 s64, s64, s5
    s_sub_u32 s64, s64, 8
    v_lshlrev_b32 v2, 4, v1
    s_barrier
    s_cmp_lg_u32 s60, 0
    s_cbranch_scc1 C8_102
    s_sleep 24
    v_mov_b32 v160, 0
    s_mov_b32 s80, 200000
NG_103:
    s_mov_b64 exec, 1
    buffer_load_dwordx2 v[162:163], v160, s[40:43], 0 offen sc1
    s_mov_b64 exec, -1
    s_waitcnt vmcnt(0)
    v_readfirstlane_b32 s94, v162
    v_readfirstlane_b32 s95, v163
    s_cmp_lg_u32 s95, 0
    s_cbranch_scc1 NGD_104
    s_sleep 4
    s_sub_u32 s80, s80, 1
    s_cmp_lg_u32 s80, 0
    s_cbranch_scc1 NG_103
NGD_104:
    v_mov_b32 v160, 0x24050
    v_mov_b32 v162, s94
    v_mov_b32 v163, s95
    ds_write_b64 v160, v[162:163]
    v_mov_b32 v160, 0x2404c
    v_mov_b32 v161, 1
    s_waitcnt lgkmcnt(0)
    s_mov_b64 exec, 1
    ds_add_u32 v160, v161
    s_mov_b64 exec, -1
C8_102:
    s_lshr_b32 s7, s64, 4
    s_lshl_b32 s7, s7, 16
    s_lshl_b32 s63, s60, 14
    s_add_u32 s7, s7, s63
    s_add_u32 s7, s7, 0x0
    v_lshl_add_u32 v4, v1, 4, s7
    s_and_b32 s7, s60, 1
    s_lshl_b32 s7, s7, 7
    v_lshlrev_b32 v3, 3, v1
    v_xor_b32 v3, s7, v3
    s_lshl_b32 s7, s60, 13
    s_add_u32 s7, s7, 0x18000
    v_add_u32 v3, s7, v3
    v_mov_b32 v160, 0x2404c
    s_mov_b32 s80, 1600000
LW_105:
    ds_read_b32 v161, v160
    s_waitcnt lgkmcnt(0)
    v_readfirstlane_b32 s79, v161
    s_cmp_ge_u32 s79, 1
    s_cbranch_scc1 LWD_106
    s_sleep 4
    s_sub_u32 s80, s80, 1
    s_cmp_lg_u32 s80, 0
    s_cbranch_scc1 LW_105
LWD_106:
    v_mov_b32 v160, 0x24050
    ds_read_b64 v[162:163], v160
    s_waitcnt lgkmcnt(0)
    v_readfirstlane_b32 s94, v162
    v_readfirstlane_b32 s95, v163
    v_mov_b32 v160, 0x24018
    s_mov_b32 s80, 1600000
LW_107:
    ds_read_b32 v161, v160
    s_waitcnt lgkmcnt(0)
    v_readfirstlane_b32 s79, v161
    s_cmp_ge_u32 s79, 8
    s_cbranch_scc1 LWD_108
    s_sleep 2
    s_sub_u32 s80, s80, 1
    s_cmp_lg_u32 s80, 0
    s_cbranch_scc1 LW_107
LWD_108:
    s_sleep 1
    s_mov_b32 s67, 4096
    s_mov_b32 s68, 8192
    s_mov_b32 s69, 12288
    buffer_load_dwordx4 v[96:99], v4, s[36:39], 0 offen offset:0 sc1
    buffer_load_dwordx4 v[100:103], v4, s[36:39], 0 offen offset:1024 sc1
    buffer_load_dwordx4 v[104:107], v4, s[36:39], 0 offen offset:2048 sc1
    buffer_load_dwordx4 v[108:111], v4, s[36:39], 0 offen offset:3072 sc1
    buffer_load_dwordx4 v[112:115], v4, s[36:39], s67 offen offset:0 sc1
    buffer_load_dwordx4 v[116:119], v4, s[36:39], s67 offen offset:1024 sc1
    buffer_load_dwordx4 v[120:123], v4, s[36:39], s67 offen offset:2048 sc1
    buffer_load_dwordx4 v[124:127], v4, s[36:39], s67 offen offset:3072 sc1
    buffer_load_dwordx4 v[128:131], v4, s[36:39], s68 offen offset:0 sc1
    buffer_load_dwordx4 v[132:135], v4, s[36:39], s68 offen offset:1024 sc1
    buffer_load_dwordx4 v[136:139], v4, s[36:39], s68 offen offset:2048 sc1
    buffer_load_dwordx4 v[140:143], v4, s[36:39], s68 offen offset:3072 sc1
    buffer_load_dwordx4 v[144:147], v4, s[36:39], s69 offen offset:0 sc1
    buffer_load_dwordx4 v[148:151], v4, s[36:39], s69 offen offset:1024 sc1
    buffer_load_dwordx4 v[152:155], v4, s[36:39], s69 offen offset:2048 sc1
    buffer_load_dwordx4 v[156:159], v4, s[36:39], s69 offen offset:3072 sc1
    s_mov_b32 s80, 200000
PS_109:
    s_waitcnt vmcnt(0)
    s_mov_b32 s78, 0
    v_cmp_ne_u64 vcc, s[94:95], v[98:99]
    s_cbranch_vccz PSS_111
    buffer_load_dwordx4 v[96:99], v4, s[36:39], 0 offen offset:0 sc1
    s_mov_b32 s78, 1
PSS_111:
    v_cmp_ne_u64 vcc, s[94:95], v[102:103]
    s_cbranch_vccz PSS_112
    buffer_load_dwordx4 v[100:103], v4, s[36:39], 0 offen offset:1024 sc1
    s_mov_b32 s78, 1
PSS_112:
    v_cmp_ne_u64 vcc, s[94:95], v[106:107]
    s_cbranch_vccz PSS_113
    buffer_load_dwordx4 v[104:107], v4, s[36:39], 0 offen offset:2048 sc1
    s_mov_b32 s78, 1
PSS_113:
    v_cmp_ne_u64 vcc, s[94:95], v[110:111]
    s_cbranch_vccz PSS_114
    buffer_load_dwordx4 v[108:111], v4, s[36:39], 0 offen offset:3072 sc1
    s_mov_b32 s78, 1
PSS_114:
    v_cmp_ne_u64 vcc, s[94:95], v[114:115]
    s_cbranch_vccz PSS_115
    buffer_load_dwordx4 v[112:115], v4, s[36:39], s67 offen offset:0 sc1
    s_mov_b32 s78, 1
PSS_115:
    v_cmp_ne_u64 vcc, s[94:95], v[118:119]
    s_cbranch_vccz PSS_116
    buffer_load_dwordx4 v[116:119], v4, s[36:39], s67 offen offset:1024 sc1
    s_mov_b32 s78, 1
PSS_116:
    v_cmp_ne_u64 vcc, s[94:95], v[122:123]
    s_cbranch_vccz PSS_117
    buffer_load_dwordx4 v[120:123], v4, s[36:39], s67 offen offset:2048 sc1
    s_mov_b32 s78, 1
PSS_117:
    v_cmp_ne_u64 vcc, s[94:95], v[126:127]
    s_cbranch_vccz PSS_118
    buffer_load_dwordx4 v[124:127], v4, s[36:39], s67 offen offset:3072 sc1
    s_mov_b32 s78, 1
PSS_118:
    v_cmp_ne_u64 vcc, s[94:95], v[130:131]
    s_cbranch_vccz PSS_119
    buffer_load_dwordx4 v[128:131], v4, s[36:39], s68 offen offset:0 sc1
    s_mov_b32 s78, 1
PSS_119:
    v_cmp_ne_u64 vcc, s[94:95], v[134:135]
    s_cbranch_vccz PSS_120
    buffer_load_dwordx4 v[132:135], v4, s[36:39], s68 offen offset:1024 sc1
    s_mov_b32 s78, 1
PSS_120:
    v_cmp_ne_u64 vcc, s[94:95], v[138:139]
    s_cbranch_vccz PSS_121
    buffer_load_dwordx4 v[136:139], v4, s[36:39], s68 offen offset:2048 sc1
    s_mov_b32 s78, 1
PSS_121:
    v_cmp_ne_u64 vcc, s[94:95], v[142:143]
    s_cbranch_vccz PSS_122
    buffer_load_dwordx4 v[140:143], v4, s[36:39], s68 offen offset:3072 sc1
    s_mov_b32 s78, 1
PSS_122:
    v_cmp_ne_u64 vcc, s[94:95], v[146:147]
    s_cbranch_vccz PSS_123
    buffer_load_dwordx4 v[144:147], v4, s[36:39], s69 offen offset:0 sc1
    s_mov_b32 s78, 1
PSS_123:
    v_cmp_ne_u64 vcc, s[94:95], v[150:151]
    s_cbranch_vccz PSS_124
    buffer_load_dwordx4 v[148:151], v4, s[36:39], s69 offen offset:1024 sc1
    s_mov_b32 s78, 1
PSS_124:
    v_cmp_ne_u64 vcc, s[94:95], v[154:155]
    s_cbranch_vccz PSS_125
    buffer_load_dwordx4 v[152:155], v4, s[36:39], s69 offen offset:2048 sc1
    s_mov_b32 s78, 1
PSS_125:
    v_cmp_ne_u64 vcc, s[94:95], v[158:159]
    s_cbranch_vccz PSS_126
    buffer_load_dwordx4 v[156:159], v4, s[36:39], s69 offen offset:3072 sc1
    s_mov_b32 s78, 1
PSS_126:
    s_cmp_eq_u32 s78, 0
    s_cbranch_scc1 PSD_110
    s_sub_u32 s80, s80, 1
    s_cmp_lg_u32 s80, 0
    s_cbranch_scc1 PS_109
    s_waitcnt vmcnt(0)
PSD_110:
    v_xor_b32 v6, 0x0, v3
    ds_write_b64 v6, v[96:97] offset:0
    ds_write_b64 v6, v[100:101] offset:512
    v_xor_b32 v7, 0x10, v3
    ds_write_b64 v7, v[104:105] offset:1024
    ds_write_b64 v7, v[108:109] offset:1536
    v_xor_b32 v6, 0x20, v3
    ds_write_b64 v6, v[112:113] offset:2048
    ds_write_b64 v6, v[116:117] offset:2560
    v_xor_b32 v7, 0x30, v3
    ds_write_b64 v7, v[120:121] offset:3072
    ds_write_b64 v7, v[124:125] offset:3584
    v_xor_b32 v6, 0x40, v3
    ds_write_b64 v6, v[128:129] offset:4096
    ds_write_b64 v6, v[132:133] offset:4608
    v_xor_b32 v7, 0x50, v3
    ds_write_b64 v7, v[136:137] offset:5120
    ds_write_b64 v7, v[140:141] offset:5632
    v_xor_b32 v6, 0x60, v3
    ds_write_b64 v6, v[144:145] offset:6144
    ds_write_b64 v6, v[148:149] offset:6656
    v_xor_b32 v7, 0x70, v3
    ds_write_b64 v7, v[152:153] offset:7168
    ds_write_b64 v7, v[156:157] offset:7680
L_CCUT:
    s_waitcnt lgkmcnt(0)
    s_barrier
    s_endpgm
L_END:
    s_endpgm
L_END0:
    s_endpgm
L_CODE_END:
.section .rodata,"a"
.p2align 6
.amdhsa_kernel concat_heads__sliding_block_cached__compressed_kv_cla__decode_kernel
  .amdhsa_next_free_vgpr 168
  .amdhsa_next_free_sgpr 102
  .amdhsa_accum_offset 168
  .amdhsa_group_segment_fixed_size 0
  .amdhsa_kernarg_size 112
  .amdhsa_user_sgpr_count 2
  .amdhsa_user_sgpr_kernarg_segment_ptr 1
  .amdhsa_system_sgpr_workgroup_id_x 1
  .amdhsa_float_denorm_mode_32 3
.end_amdhsa_kernel
```

```asm
; @launch grid=(256,1,1) block=(768,1,1) lds=163840
.amdgcn_target "amdgcn-amd-amdhsa--gfx950"
.text
.globl concat_heads__sliding_block_cached__compressed_kv_cla__decode_kernel
.p2align 12
.p2align 8
.type concat_heads__sliding_block_cached__compressed_kv_cla__decode_kernel,@function
concat_heads__sliding_block_cached__compressed_kv_cla__decode_kernel:
    s_load_dwordx16 s[8:23], s[0:1], 0
    s_load_dwordx8 s[24:31], s[0:1], 64
    s_load_dwordx4 s[32:35], s[0:1], 96
    v_lshrrev_b32 v1, 6, v0
    s_and_b32 s4, s2, 7
    v_readfirstlane_b32 s3, v1
    s_lshr_b32 s5, s2, 3
    v_and_b32 v1, 63, v0
    s_and_b32 s7, s5, 3
    s_lshl2_add_u32 s6, s4, s7
    s_cmp_ge_u32 s5, 32
    s_cbranch_scc1 L_END0
    s_cmp_ge_u32 s5, 16
    s_cbranch_scc1 EA_1
    s_cmp_ge_u32 s5, 8
    s_cbranch_scc1 EC_2
    s_cmp_ge_u32 s3, 8
    s_cbranch_scc1 L_W2
    s_cmp_ge_u32 s3, 4
    s_cbranch_scc1 L_W1
    s_branch L_W
EC_2:
    s_cmp_ge_u32 s3, 8
    s_cbranch_scc1 L_CSVC
    s_branch L_C
EA_1:
    s_cmp_eq_u32 s3, 11
    s_cbranch_scc1 L_ASVC
    s_branch L_AA
L_W2:
    s_sub_u32 s62, s3, 8
    s_lshl_b32 s7, s5, 2
    s_add_u32 s7, s7, s62
    s_lshl_b32 s7, s7, 17
    s_lshl_b32 s70, s4, 10
    s_add_u32 s70, s70, s7
    s_lshl_b32 s71, s62, 14
    v_lshlrev_b32 v2, 4, v1
    s_lshl_b32 s7, s62, 6
    v_xor_b32 v4, s7, v2
    v_xor_b32 v5, 16, v4
    v_xor_b32 v6, 32, v4
    v_xor_b32 v7, 48, v4
    s_waitcnt lgkmcnt(0)
    s_lshl_b32 s7, s2, 4
    s_add_u32 s7, s7, s3
    s_cmp_lg_u32 s7, 8
    s_cbranch_scc1 NM_64
    s_memrealtime s[94:95]
    s_mov_b32 s40, s32
    s_and_b32 s41, s33, 0xffff
    s_mov_b32 s42, 0x100
    s_mov_b32 s43, 0x20000
    v_mov_b32 v8, 0
    s_waitcnt lgkmcnt(0)
    s_or_b32 s95, s95, 0x80000000
    v_mov_b32 v10, s94
    v_mov_b32 v11, s95
    s_mov_b64 exec, 1
    buffer_store_dwordx2 v[10:11], v8, s[40:43], 0 offen sc1
    s_mov_b64 exec, -1
NM_64:
    s_mov_b32 s52, s24
    s_and_b32 s53, s25, 0xffff
    s_mov_b32 s54, 0x400000
    s_mov_b32 s55, 0x20000
    s_mov_b32 m0, s71
    s_nop 0
    buffer_load_dwordx4 v4, s[52:55], s70 offen nt lds
    s_addk_i32 s70, 8192
    s_addk_i32 s71, 1024
    s_mov_b32 m0, s71
    s_nop 0
    buffer_load_dwordx4 v4, s[52:55], s70 offen nt lds
    s_addk_i32 s70, 8192
    s_addk_i32 s71, 1024
    s_mov_b32 m0, s71
    s_nop 0
    buffer_load_dwordx4 v4, s[52:55], s70 offen nt lds
    s_addk_i32 s70, 8192
    s_addk_i32 s71, 1024
    s_mov_b32 m0, s71
    s_nop 0
    buffer_load_dwordx4 v4, s[52:55], s70 offen nt lds
    s_addk_i32 s70, 8192
    s_addk_i32 s71, 1024
    s_mov_b32 m0, s71
    s_nop 0
    buffer_load_dwordx4 v5, s[52:55], s70 offen nt lds
    s_addk_i32 s70, 8192
    s_addk_i32 s71, 1024
    s_mov_b32 m0, s71
    s_nop 0
    buffer_load_dwordx4 v5, s[52:55], s70 offen nt lds
    s_addk_i32 s70, 8192
    s_addk_i32 s71, 1024
    s_mov_b32 m0, s71
    s_nop 0
    buffer_load_dwordx4 v5, s[52:55], s70 offen nt lds
    s_addk_i32 s70, 8192
    s_addk_i32 s71, 1024
    s_mov_b32 m0, s71
    s_nop 0
    buffer_load_dwordx4 v5, s[52:55], s70 offen nt lds
    s_addk_i32 s70, 8192
    s_addk_i32 s71, 1024
    s_branch L_W2B
L_AA:
    s_cmp_ge_u32 s3, 8
    s_cbranch_scc1 AK_3
    s_and_b32 s7, s5, 12
    s_and_b32 s66, s3, 3
    s_add_u32 s7, s7, s66
    v_lshrrev_b32 v2, 4, v1
    v_lshlrev_b32 v3, 16, v2
    v_and_b32 v4, 15, v1
    v_lshl_add_u32 v3, v4, 4, v3
    s_lshl_b32 s66, s7, 18
    s_lshl_b32 s67, s6, 8
    s_add_u32 s66, s66, s67
    s_cmp_lt_u32 s3, 4
    s_cbranch_scc1 AP_5
    s_barrier
    s_sleep 26
AP_5:
    s_cmp_lt_u32 s3, 4
    s_waitcnt lgkmcnt(0)
    s_cselect_b32 s72, s22, s14
    s_cselect_b32 s73, s23, s15
    s_cselect_b32 s70, s18, s8
    s_cselect_b32 s71, s19, s9
    s_mov_b32 s56, s72
    s_and_b32 s57, s73, 0xffff
    s_mov_b32 s58, 0x400000
    s_mov_b32 s59, 0x20000
    buffer_load_dwordx4 v[128:131], v3, s[56:59], s66 offen nt
    s_addk_i32 s66, 8192
    buffer_load_dwordx4 v[132:135], v3, s[56:59], s66 offen nt
    s_addk_i32 s66, 8192
    buffer_load_dwordx4 v[136:139], v3, s[56:59], s66 offen nt
    s_addk_i32 s66, 8192
    buffer_load_dwordx4 v[140:143], v3, s[56:59], s66 offen nt
    s_addk_i32 s66, 8192
    buffer_load_dwordx4 v[144:147], v3, s[56:59], s66 offen nt
    s_addk_i32 s66, 8192
    buffer_load_dwordx4 v[148:151], v3, s[56:59], s66 offen nt
    s_addk_i32 s66, 8192
    buffer_load_dwordx4 v[152:155], v3, s[56:59], s66 offen nt
    s_addk_i32 s66, 8192
    buffer_load_dwordx4 v[156:159], v3, s[56:59], s66 offen nt
    s_addk_i32 s66, 8192
    s_branch L_AB
L_C:
    s_lshl_b32 s60, s4, 3
    s_add_u32 s60, s60, s5
    s_sub_u32 s60, s60, 8
    v_lshlrev_b32 v160, 4, v1
    s_and_b32 s7, s3, 3
    s_lshl_b32 s7, s7, 2
    s_lshr_b32 s66, s3, 2
    s_or_b32 s7, s7, s66
    s_lshl_b32 s62, s7, 4
    v_xor_b32 v2, s62, v160
    v_xor_b32 v3, 32, v2
    s_lshl_b32 s70, s60, 18
    s_lshl_b32 s68, s3, 10
    s_add_u32 s61, s70, s68
    s_waitcnt lgkmcnt(0)
    s_mov_b32 s44, s20
    s_and_b32 s45, s21, 0xffff
    s_mov_b32 s46, 0x1000000
    s_mov_b32 s47, 0x20000
    s_mov_b32 m0, s68
    s_nop 0
    buffer_load_dwordx4 v2, s[44:47], s61 offen nt lds
    s_addk_i32 s68, 8192
    s_addk_i32 s61, 8192
    s_mov_b32 m0, s68
    s_nop 0
    buffer_load_dwordx4 v3, s[44:47], s61 offen nt lds
    s_addk_i32 s68, 8192
    s_addk_i32 s61, 8192
    s_mov_b32 m0, s68
    s_nop 0
    buffer_load_dwordx4 v2, s[44:47], s61 offen nt lds
    s_addk_i32 s68, 8192
    s_addk_i32 s61, 8192
    s_mov_b32 m0, s68
    s_nop 0
    buffer_load_dwordx4 v3, s[44:47], s61 offen nt lds
    s_addk_i32 s68, 8192
    s_branch L_CB
L_AB:
    v_bfe_u32 v4, v1, 2, 2
    v_lshlrev_b32 v4, 10, v4
    v_lshl_add_u32 v4, v2, 4, v4
    s_lshl_b32 s67, s7, 6
    s_mov_b32 s52, s70
    s_and_b32 s53, s71, 0xffff
    s_mov_b32 s54, 0x1000
    s_mov_b32 s55, 0x20000
    buffer_load_dwordx4 v[160:163], v4, s[52:55], s67 offen
    s_mov_b32 s92, 0x05040100
    s_mov_b32 s93, 0x07060302
    s_mov_b32 s36, s34
    s_and_b32 s37, s35, 0xffff
    s_mov_b32 s38, 0x1000000
    s_mov_b32 s39, 0x20000
    s_mov_b32 s40, s32
    s_and_b32 s41, s33, 0xffff
    s_mov_b32 s42, 0x100
    s_mov_b32 s43, 0x20000
    s_mov_b32 s44, s10
    s_and_b32 s45, s11, 0xffff
    s_mov_b32 s46, 0x8000000
    s_mov_b32 s47, 0x20000
    s_mov_b32 s48, s12
    s_and_b32 s49, s13, 0xffff
    s_mov_b32 s50, 0x8000000
    s_mov_b32 s51, 0x20000
    s_lshr_b32 s7, s5, 2
    s_sub_u32 s7, s7, 4
    s_lshl_b32 s7, s7, 5
    s_add_u32 s7, s7, s6
    s_lshl_b32 s7, s7, 20
    s_add_u32 s7, s7, 0xC0000
    v_lshlrev_b32 v6, 4, v1
    v_add_u32 v6, s7, v6
    s_mov_b32 s64, 0x3e0293ee
    s_lshl_b32 s60, s3, 10
    s_mov_b32 s61, s60
    s_cmp_ge_u32 s3, 8
    s_cselect_b32 s7, 4096, 0
    s_sub_u32 s63, s60, s7
    s_add_u32 s63, s63, 247808
    s_add_u32 s65, s63, 7168
    s_and_b32 s7, s3, 12
    s_cmp_eq_u32 s7, 4
    s_cselect_b32 s62, 0xff800000, 0
    s_cmp_ge_u32 s3, 4
    s_cbranch_scc1 AP_6
    s_barrier
AP_6:
    s_lshl_b32 s7, s3, 11
    s_add_u32 s7, s7, 0x0
    v_lshl_add_u32 v2, v1, 5, s7
    s_cmp_lt_u32 s3, 4
    s_cselect_b32 s7, 0x44, 0x40
    s_add_u32 s7, s7, 0x24000
    v_mov_b32 v3, s7
    v_mov_b32 v4, 1
    s_waitcnt vmcnt(0)
    v_perm_b32 v96, v132, v128, s92
    v_perm_b32 v97, v140, v136, s92
    v_perm_b32 v98, v148, v144, s92
    v_perm_b32 v99, v156, v152, s92
    v_perm_b32 v100, v132, v128, s93
    v_perm_b32 v101, v140, v136, s93
    v_perm_b32 v102, v148, v144, s93
    v_perm_b32 v103, v156, v152, s93
    v_perm_b32 v104, v133, v129, s92
    v_perm_b32 v105, v141, v137, s92
    v_perm_b32 v106, v149, v145, s92
    v_perm_b32 v107, v157, v153, s92
    v_perm_b32 v108, v133, v129, s93
    v_perm_b32 v109, v141, v137, s93
    v_perm_b32 v110, v149, v145, s93
    v_perm_b32 v111, v157, v153, s93
    v_perm_b32 v112, v134, v130, s92
    v_perm_b32 v113, v142, v138, s92
    v_perm_b32 v114, v150, v146, s92
    v_perm_b32 v115, v158, v154, s92
    v_perm_b32 v116, v134, v130, s93
    v_perm_b32 v117, v142, v138, s93
    v_perm_b32 v118, v150, v146, s93
    v_perm_b32 v119, v158, v154, s93
    v_perm_b32 v120, v135, v131, s92
    v_perm_b32 v121, v143, v139, s92
    v_perm_b32 v122, v151, v147, s92
    v_perm_b32 v123, v159, v155, s92
    v_perm_b32 v124, v135, v131, s93
    v_perm_b32 v125, v143, v139, s93
    v_perm_b32 v126, v151, v147, s93
    v_perm_b32 v127, v159, v155, s93
    v_mfma_f32_16x16x32_bf16 v[64:67], v[160:163], v[96:99], 0
    v_mfma_f32_16x16x32_bf16 v[68:71], v[160:163], v[100:103], 0
    v_mfma_f32_16x16x32_bf16 v[72:75], v[160:163], v[104:107], 0
    v_mfma_f32_16x16x32_bf16 v[76:79], v[160:163], v[108:111], 0
    v_mfma_f32_16x16x32_bf16 v[80:83], v[160:163], v[112:115], 0
    v_mfma_f32_16x16x32_bf16 v[84:87], v[160:163], v[116:119], 0
    v_mfma_f32_16x16x32_bf16 v[88:91], v[160:163], v[120:123], 0
    v_mfma_f32_16x16x32_bf16 v[92:95], v[160:163], v[124:127], 0
    s_nop 0
    v_mov_b32 v128, v64
    v_mov_b32 v129, v68
    v_mov_b32 v130, v72
    v_mov_b32 v131, v76
    v_mov_b32 v132, v80
    v_mov_b32 v133, v84
    v_mov_b32 v134, v88
    v_mov_b32 v135, v92
    ds_write_b128 v2, v[128:131]
    ds_write_b128 v2, v[132:135] offset:16
    s_waitcnt lgkmcnt(0)
    s_mov_b64 exec, 1
    ds_add_u32 v3, v4
    s_mov_b64 exec, -1
    s_branch AJ_4
AK_3:
    s_waitcnt lgkmcnt(0)
    s_mov_b32 s92, 0x05040100
    s_mov_b32 s93, 0x07060302
    s_mov_b32 s36, s34
    s_and_b32 s37, s35, 0xffff
    s_mov_b32 s38, 0x1000000
    s_mov_b32 s39, 0x20000
    s_mov_b32 s40, s32
    s_and_b32 s41, s33, 0xffff
    s_mov_b32 s42, 0x100
    s_mov_b32 s43, 0x20000
    s_mov_b32 s44, s10
    s_and_b32 s45, s11, 0xffff
    s_mov_b32 s46, 0x8000000
    s_mov_b32 s47, 0x20000
    s_mov_b32 s48, s12
    s_and_b32 s49, s13, 0xffff
    s_mov_b32 s50, 0x8000000
    s_mov_b32 s51, 0x20000
    s_lshr_b32 s7, s5, 2
    s_sub_u32 s7, s7, 4
    s_lshl_b32 s7, s7, 5
    s_add_u32 s7, s7, s6
    s_lshl_b32 s7, s7, 20
    s_add_u32 s7, s7, 0xC0000
    v_lshlrev_b32 v6, 4, v1
    v_add_u32 v6, s7, v6
    s_mov_b32 s64, 0x3e0293ee
    s_lshl_b32 s60, s3, 10
    s_mov_b32 s61, s60
    s_cmp_ge_u32 s3, 8
    s_cselect_b32 s7, 4096, 0
    s_sub_u32 s63, s60, s7
    s_add_u32 s63, s63, 247808
    s_add_u32 s65, s63, 7168
    s_and_b32 s7, s3, 12
    s_cmp_eq_u32 s7, 4
    s_cselect_b32 s62, 0xff800000, 0
    s_barrier
    s_cmp_eq_u32 s3, 8
    s_cbranch_scc1 LT_AR
LR_AR:
    s_cmp_eq_u32 s3, 9
    s_cbranch_scc1 LT_AR2
LR_AR2:
    s_sleep 26
AJ_4:
    s_branch L_AR
L_W2B:
    s_cmp_lg_u32 s3, 11
    s_cbranch_scc1 Z_65
    v_lshlrev_b32 v2, 2, v1
    v_add_u32 v2, 0x24000, v2
    v_mov_b32 v3, 0
    ds_write_b32 v2, v3
Z_65:
    s_waitcnt lgkmcnt(0)
    s_mov_b32 s92, 0x05040100
    s_mov_b32 s93, 0x07060302
    s_mov_b32 s36, s34
    s_and_b32 s37, s35, 0xffff
    s_mov_b32 s38, 0x1000000
    s_mov_b32 s39, 0x20000
    s_mov_b32 s40, s32
    s_and_b32 s41, s33, 0xffff
    s_mov_b32 s42, 0x100
    s_mov_b32 s43, 0x20000
    s_barrier
    s_mov_b32 m0, s71
    s_waitcnt vmcnt(7)
    buffer_load_dwordx4 v6, s[52:55], s70 offen nt lds
    s_addk_i32 s70, 8192
    s_addk_i32 s71, 1024
    s_mov_b32 m0, s71
    s_waitcnt vmcnt(7)
    buffer_load_dwordx4 v6, s[52:55], s70 offen nt lds
    s_addk_i32 s70, 8192
    s_addk_i32 s71, 1024
    s_mov_b32 m0, s71
    s_waitcnt vmcnt(7)
    buffer_load_dwordx4 v6, s[52:55], s70 offen nt lds
    s_addk_i32 s70, 8192
    s_addk_i32 s71, 1024
    s_mov_b32 m0, s71
    s_waitcnt vmcnt(7)
    buffer_load_dwordx4 v6, s[52:55], s70 offen nt lds
    s_addk_i32 s70, 8192
    s_addk_i32 s71, 1024
    s_mov_b32 m0, s71
    s_waitcnt vmcnt(7)
    buffer_load_dwordx4 v7, s[52:55], s70 offen nt lds
    s_addk_i32 s70, 8192
    s_addk_i32 s71, 1024
    s_mov_b32 m0, s71
    s_waitcnt vmcnt(7)
    buffer_load_dwordx4 v7, s[52:55], s70 offen nt lds
    s_addk_i32 s70, 8192
    s_addk_i32 s71, 1024
    s_mov_b32 m0, s71
    s_waitcnt vmcnt(7)
    buffer_load_dwordx4 v7, s[52:55], s70 offen nt lds
    s_addk_i32 s70, 8192
    s_addk_i32 s71, 1024
    s_mov_b32 m0, s71
    s_waitcnt vmcnt(7)
    buffer_load_dwordx4 v7, s[52:55], s70 offen nt lds
    s_addk_i32 s70, 8192
    s_addk_i32 s71, 1024
    s_branch L_W2R
L_CB:
    s_mov_b32 s92, 0x05040100
    s_mov_b32 s93, 0x07060302
    s_mov_b32 s36, s34
    s_and_b32 s37, s35, 0xffff
    s_mov_b32 s38, 0x1000000
    s_mov_b32 s39, 0x20000
    s_mov_b32 s40, s32
    s_and_b32 s41, s33, 0xffff
    s_mov_b32 s42, 0x100
    s_mov_b32 s43, 0x20000
    s_lshr_b32 s64, s3, 1
    s_and_b32 s65, s3, 1
    s_mov_b32 s67, 0x3e0293ee
    s_barrier
    s_addk_i32 s61, 8192
    s_mov_b32 m0, s68
    s_waitcnt vmcnt(3)
    buffer_load_dwordx4 v2, s[44:47], s61 offen nt lds
    s_addk_i32 s68, 8192
    s_addk_i32 s61, 8192
    s_mov_b32 m0, s68
    s_waitcnt vmcnt(3)
    buffer_load_dwordx4 v3, s[44:47], s61 offen nt lds
    s_addk_i32 s68, 8192
    s_addk_i32 s61, 8192
    s_mov_b32 m0, s68
    s_waitcnt vmcnt(3)
    buffer_load_dwordx4 v2, s[44:47], s61 offen nt lds
    s_addk_i32 s68, 8192
    s_addk_i32 s61, 8192
    s_mov_b32 m0, s68
    s_waitcnt vmcnt(3)
    buffer_load_dwordx4 v3, s[44:47], s61 offen nt lds
    s_addk_i32 s68, 8192
    s_addk_i32 s61, 8192
    s_mov_b32 m0, s68
    s_waitcnt vmcnt(3)
    buffer_load_dwordx4 v2, s[44:47], s61 offen nt lds
    s_addk_i32 s68, 8192
    s_addk_i32 s61, 8192
    s_mov_b32 m0, s68
    s_waitcnt vmcnt(3)
    buffer_load_dwordx4 v3, s[44:47], s61 offen nt lds
    s_addk_i32 s68, 8192
    s_addk_i32 s61, 8192
    s_mov_b32 m0, s68
    s_waitcnt vmcnt(3)
    buffer_load_dwordx4 v2, s[44:47], s61 offen nt lds
    s_addk_i32 s68, 8192
    s_addk_i32 s61, 8192
    s_mov_b32 m0, s68
    s_waitcnt vmcnt(3)
    buffer_load_dwordx4 v3, s[44:47], s61 offen nt lds
    s_addk_i32 s68, 8192
    s_addk_i32 s61, 8192
    s_waitcnt vmcnt(3)
    buffer_load_dwordx4 v[128:131], v2, s[44:47], s61 offen nt
    s_addk_i32 s61, 8192
    s_waitcnt vmcnt(3)
    buffer_load_dwordx4 v[132:135], v3, s[44:47], s61 offen nt
    s_addk_i32 s61, 8192
    s_waitcnt vmcnt(3)
    buffer_load_dwordx4 v[136:139], v2, s[44:47], s61 offen nt
    s_addk_i32 s61, 8192
    s_waitcnt vmcnt(3)
    buffer_load_dwordx4 v[140:143], v3, s[44:47], s61 offen nt
    s_addk_i32 s61, 8192
    s_waitcnt vmcnt(3)
    buffer_load_dwordx4 v[96:99], v2, s[44:47], s61 offen nt
    s_addk_i32 s61, 8192
    s_waitcnt vmcnt(3)
    buffer_load_dwordx4 v[100:103], v3, s[44:47], s61 offen nt
    s_addk_i32 s61, 8192
    s_waitcnt vmcnt(3)
    buffer_load_dwordx4 v[104:107], v2, s[44:47], s61 offen nt
    s_addk_i32 s61, 8192
    s_waitcnt vmcnt(3)
    buffer_load_dwordx4 v[108:111], v3, s[44:47], s61 offen nt
    s_addk_i32 s61, 8192
    s_waitcnt vmcnt(3)
    buffer_load_dwordx4 v[112:115], v2, s[44:47], s61 offen nt
    s_addk_i32 s61, 8192
    s_waitcnt vmcnt(3)
    buffer_load_dwordx4 v[116:119], v3, s[44:47], s61 offen nt
    s_addk_i32 s61, 8192
    v_mov_b32 v160, 0x24018
    v_mov_b32 v161, 1
    s_waitcnt lgkmcnt(0)
    s_mov_b64 exec, 1
    ds_add_u32 v160, v161
    s_mov_b64 exec, -1
    s_waitcnt vmcnt(3)
    buffer_load_dwordx4 v[120:123], v2, s[44:47], s61 offen nt
    s_addk_i32 s61, 8192
    s_waitcnt vmcnt(3)
    buffer_load_dwordx4 v[124:127], v3, s[44:47], s61 offen nt
    s_addk_i32 s61, 8192
    s_branch L_CR
L_END:
    s_endpgm
L_END0:
    s_endpgm
.p2align 12
LT_AR:
    s_branch LR_AR
L_AR:
    v_mov_b32 v32, 0
    v_mov_b32 v33, 0
    v_mov_b32 v34, 0
    v_mov_b32 v35, 0
    v_mov_b32 v36, 0
    v_mov_b32 v37, 0
    v_mov_b32 v38, 0
    v_mov_b32 v39, 0
    s_cmp_lg_u32 s62, 0
    s_cbranch_scc1 L_AK2
    buffer_load_dwordx4 v[32:35], v6, s[44:47], s63 offen nt
    buffer_load_dwordx4 v[36:39], v6, s[44:47], s65 offen nt
L_AK2:
    buffer_load_dwordx4 v[40:43], v6, s[44:47], s60 offen nt
    s_add_u32 s60, s60, 11264
    s_waitcnt vmcnt(2)
    buffer_load_dwordx4 v[44:47], v6, s[44:47], s60 offen nt
    s_add_u32 s60, s60, 11264
    s_waitcnt vmcnt(2)
    buffer_load_dwordx4 v[48:51], v6, s[44:47], s60 offen nt
    s_add_u32 s60, s60, 11264
    s_waitcnt vmcnt(2)
    buffer_load_dwordx4 v[52:55], v6, s[44:47], s60 offen nt
    s_add_u32 s60, s60, 11264
    s_waitcnt vmcnt(2)
    buffer_load_dwordx4 v[56:59], v6, s[44:47], s60 offen nt
    s_add_u32 s60, s60, 11264
    s_waitcnt vmcnt(2)
    buffer_load_dwordx4 v[60:63], v6, s[44:47], s60 offen nt
    s_add_u32 s60, s60, 11264
    s_waitcnt vmcnt(2)
    buffer_load_dwordx4 v[64:67], v6, s[44:47], s60 offen nt
    s_add_u32 s60, s60, 11264
    s_waitcnt vmcnt(2)
    buffer_load_dwordx4 v[68:71], v6, s[44:47], s60 offen nt
    s_add_u32 s60, s60, 11264
    s_waitcnt vmcnt(2)
    buffer_load_dwordx4 v[72:75], v6, s[44:47], s60 offen nt
    s_add_u32 s60, s60, 11264
    s_waitcnt vmcnt(2)
    buffer_load_dwordx4 v[76:79], v6, s[44:47], s60 offen nt
    s_add_u32 s60, s60, 11264
    s_waitcnt vmcnt(2)
    buffer_load_dwordx4 v[80:83], v6, s[44:47], s60 offen nt
    s_add_u32 s60, s60, 11264
    s_waitcnt vmcnt(2)
    buffer_load_dwordx4 v[84:87], v6, s[44:47], s60 offen nt
    s_add_u32 s60, s60, 11264
    s_waitcnt vmcnt(2)
    buffer_load_dwordx4 v[88:91], v6, s[44:47], s60 offen nt
    s_add_u32 s60, s60, 11264
    s_waitcnt vmcnt(2)
    buffer_load_dwordx4 v[92:95], v6, s[44:47], s60 offen nt
    s_add_u32 s60, s60, 11264
    v_mov_b32 v160, 0x24004
    s_mov_b32 s80, 1600000
LW_7:
    ds_read_b32 v161, v160
    s_waitcnt lgkmcnt(0)
    v_readfirstlane_b32 s79, v161
    s_cmp_ge_u32 s79, 1
    s_cbranch_scc1 LWD_8
    s_sleep 4
    s_sub_u32 s80, s80, 1
    s_cmp_lg_u32 s80, 0
    s_cbranch_scc1 LW_7
LWD_8:
    v_and_b32 v160, 15, v1
    v_lshlrev_b32 v160, 4, v160
    v_add_u32 v160, 0x24100, v160
    ds_read_b128 v[2:5], v160
    s_waitcnt lgkmcnt(0)
    v_dot2_f32_bf16 v8, v32, v2, 0
    v_dot2_f32_bf16 v9, v36, v2, 0
    v_dot2_f32_bf16 v10, v40, v2, 0
    v_dot2_f32_bf16 v11, v44, v2, 0
    v_dot2_f32_bf16 v8, v33, v3, v8
    v_dot2_f32_bf16 v9, v37, v3, v9
    v_dot2_f32_bf16 v10, v41, v3, v10
    v_dot2_f32_bf16 v11, v45, v3, v11
    v_dot2_f32_bf16 v8, v34, v4, v8
    v_dot2_f32_bf16 v9, v38, v4, v9
    v_dot2_f32_bf16 v10, v42, v4, v10
    v_dot2_f32_bf16 v11, v46, v4, v11
    v_dot2_f32_bf16 v8, v35, v5, v8
    v_dot2_f32_bf16 v9, v39, v5, v9
    v_dot2_f32_bf16 v10, v43, v5, v10
    v_dot2_f32_bf16 v11, v47, v5, v11
    v_add_f32_dpp v8, v8, v8 row_ror:8 row_mask:0xf bank_mask:0xf
    v_add_f32_dpp v9, v9, v9 row_ror:8 row_mask:0xf bank_mask:0xf
    v_add_f32_dpp v10, v10, v10 row_ror:8 row_mask:0xf bank_mask:0xf
    v_add_f32_dpp v11, v11, v11 row_ror:8 row_mask:0xf bank_mask:0xf
    v_add_f32_dpp v8, v8, v8 row_ror:4 row_mask:0xf bank_mask:0xf
    v_add_f32_dpp v9, v9, v9 row_ror:4 row_mask:0xf bank_mask:0xf
    v_add_f32_dpp v10, v10, v10 row_ror:4 row_mask:0xf bank_mask:0xf
    v_add_f32_dpp v11, v11, v11 row_ror:4 row_mask:0xf bank_mask:0xf
    v_add_f32_dpp v8, v8, v8 row_ror:2 row_mask:0xf bank_mask:0xf
    v_add_f32_dpp v9, v9, v9 row_ror:2 row_mask:0xf bank_mask:0xf
    v_add_f32_dpp v10, v10, v10 row_ror:2 row_mask:0xf bank_mask:0xf
    v_add_f32_dpp v11, v11, v11 row_ror:2 row_mask:0xf bank_mask:0xf
    v_add_f32_dpp v8, v8, v8 row_ror:1 row_mask:0xf bank_mask:0xf
    v_add_f32_dpp v9, v9, v9 row_ror:1 row_mask:0xf bank_mask:0xf
    v_add_f32_dpp v10, v10, v10 row_ror:1 row_mask:0xf bank_mask:0xf
    v_add_f32_dpp v11, v11, v11 row_ror:1 row_mask:0xf bank_mask:0xf
    s_waitcnt vmcnt(2)
    buffer_load_dwordx4 v[96:99], v6, s[44:47], s60 offen nt
    s_add_u32 s60, s60, 11264
    s_waitcnt vmcnt(2)
    buffer_load_dwordx4 v[100:103], v6, s[44:47], s60 offen nt
    s_add_u32 s60, s60, 11264
    v_dot2_f32_bf16 v12, v48, v2, 0
    v_dot2_f32_bf16 v13, v52, v2, 0
    v_dot2_f32_bf16 v14, v56, v2, 0
    v_dot2_f32_bf16 v15, v60, v2, 0
    v_dot2_f32_bf16 v12, v49, v3, v12
    v_dot2_f32_bf16 v13, v53, v3, v13
    v_dot2_f32_bf16 v14, v57, v3, v14
    v_dot2_f32_bf16 v15, v61, v3, v15
    v_dot2_f32_bf16 v12, v50, v4, v12
    v_dot2_f32_bf16 v13, v54, v4, v13
    v_dot2_f32_bf16 v14, v58, v4, v14
    v_dot2_f32_bf16 v15, v62, v4, v15
    v_dot2_f32_bf16 v12, v51, v5, v12
    v_dot2_f32_bf16 v13, v55, v5, v13
    v_dot2_f32_bf16 v14, v59, v5, v14
    v_dot2_f32_bf16 v15, v63, v5, v15
    v_add_f32_dpp v12, v12, v12 row_ror:8 row_mask:0xf bank_mask:0xf
    v_add_f32_dpp v13, v13, v13 row_ror:8 row_mask:0xf bank_mask:0xf
    v_add_f32_dpp v14, v14, v14 row_ror:8 row_mask:0xf bank_mask:0xf
    v_add_f32_dpp v15, v15, v15 row_ror:8 row_mask:0xf bank_mask:0xf
    v_add_f32_dpp v12, v12, v12 row_ror:4 row_mask:0xf bank_mask:0xf
    v_add_f32_dpp v13, v13, v13 row_ror:4 row_mask:0xf bank_mask:0xf
    v_add_f32_dpp v14, v14, v14 row_ror:4 row_mask:0xf bank_mask:0xf
    v_add_f32_dpp v15, v15, v15 row_ror:4 row_mask:0xf bank_mask:0xf
    v_add_f32_dpp v12, v12, v12 row_ror:2 row_mask:0xf bank_mask:0xf
    v_add_f32_dpp v13, v13, v13 row_ror:2 row_mask:0xf bank_mask:0xf
    v_add_f32_dpp v14, v14, v14 row_ror:2 row_mask:0xf bank_mask:0xf
    v_add_f32_dpp v15, v15, v15 row_ror:2 row_mask:0xf bank_mask:0xf
    v_add_f32_dpp v12, v12, v12 row_ror:1 row_mask:0xf bank_mask:0xf
    v_add_f32_dpp v13, v13, v13 row_ror:1 row_mask:0xf bank_mask:0xf
    v_add_f32_dpp v14, v14, v14 row_ror:1 row_mask:0xf bank_mask:0xf
    v_add_f32_dpp v15, v15, v15 row_ror:1 row_mask:0xf bank_mask:0xf
    s_waitcnt vmcnt(2)
    buffer_load_dwordx4 v[104:107], v6, s[44:47], s60 offen nt
    s_add_u32 s60, s60, 11264
    s_waitcnt vmcnt(2)
    buffer_load_dwordx4 v[108:111], v6, s[44:47], s60 offen nt
    s_add_u32 s60, s60, 11264
    v_dot2_f32_bf16 v16, v64, v2, 0
    v_dot2_f32_bf16 v17, v68, v2, 0
    v_dot2_f32_bf16 v18, v72, v2, 0
    v_dot2_f32_bf16 v19, v76, v2, 0
    v_dot2_f32_bf16 v16, v65, v3, v16
    v_dot2_f32_bf16 v17, v69, v3, v17
    v_dot2_f32_bf16 v18, v73, v3, v18
    v_dot2_f32_bf16 v19, v77, v3, v19
    v_dot2_f32_bf16 v16, v66, v4, v16
    v_dot2_f32_bf16 v17, v70, v4, v17
    v_dot2_f32_bf16 v18, v74, v4, v18
    v_dot2_f32_bf16 v19, v78, v4, v19
    v_dot2_f32_bf16 v16, v67, v5, v16
    v_dot2_f32_bf16 v17, v71, v5, v17
    v_dot2_f32_bf16 v18, v75, v5, v18
    v_dot2_f32_bf16 v19, v79, v5, v19
    v_add_f32_dpp v16, v16, v16 row_ror:8 row_mask:0xf bank_mask:0xf
    v_add_f32_dpp v17, v17, v17 row_ror:8 row_mask:0xf bank_mask:0xf
    v_add_f32_dpp v18, v18, v18 row_ror:8 row_mask:0xf bank_mask:0xf
    v_add_f32_dpp v19, v19, v19 row_ror:8 row_mask:0xf bank_mask:0xf
    v_add_f32_dpp v16, v16, v16 row_ror:4 row_mask:0xf bank_mask:0xf
    v_add_f32_dpp v17, v17, v17 row_ror:4 row_mask:0xf bank_mask:0xf
    v_add_f32_dpp v18, v18, v18 row_ror:4 row_mask:0xf bank_mask:0xf
    v_add_f32_dpp v19, v19, v19 row_ror:4 row_mask:0xf bank_mask:0xf
    v_add_f32_dpp v16, v16, v16 row_ror:2 row_mask:0xf bank_mask:0xf
    v_add_f32_dpp v17, v17, v17 row_ror:2 row_mask:0xf bank_mask:0xf
    v_add_f32_dpp v18, v18, v18 row_ror:2 row_mask:0xf bank_mask:0xf
    v_add_f32_dpp v19, v19, v19 row_ror:2 row_mask:0xf bank_mask:0xf
    v_add_f32_dpp v16, v16, v16 row_ror:1 row_mask:0xf bank_mask:0xf
    v_add_f32_dpp v17, v17, v17 row_ror:1 row_mask:0xf bank_mask:0xf
    v_add_f32_dpp v18, v18, v18 row_ror:1 row_mask:0xf bank_mask:0xf
    v_add_f32_dpp v19, v19, v19 row_ror:1 row_mask:0xf bank_mask:0xf
    s_waitcnt vmcnt(2)
    buffer_load_dwordx4 v[112:115], v6, s[44:47], s60 offen nt
    s_add_u32 s60, s60, 11264
    s_waitcnt vmcnt(2)
    buffer_load_dwordx4 v[116:119], v6, s[44:47], s60 offen nt
    s_add_u32 s60, s60, 11264
    v_dot2_f32_bf16 v20, v80, v2, 0
    v_dot2_f32_bf16 v21, v84, v2, 0
    v_dot2_f32_bf16 v22, v88, v2, 0
    v_dot2_f32_bf16 v23, v92, v2, 0
    v_dot2_f32_bf16 v20, v81, v3, v20
    v_dot2_f32_bf16 v21, v85, v3, v21
    v_dot2_f32_bf16 v22, v89, v3, v22
    v_dot2_f32_bf16 v23, v93, v3, v23
    v_dot2_f32_bf16 v20, v82, v4, v20
    v_dot2_f32_bf16 v21, v86, v4, v21
    v_dot2_f32_bf16 v22, v90, v4, v22
    v_dot2_f32_bf16 v23, v94, v4, v23
    v_dot2_f32_bf16 v20, v83, v5, v20
    v_dot2_f32_bf16 v21, v87, v5, v21
    v_dot2_f32_bf16 v22, v91, v5, v22
    v_dot2_f32_bf16 v23, v95, v5, v23
    v_add_f32_dpp v20, v20, v20 row_ror:8 row_mask:0xf bank_mask:0xf
    v_add_f32_dpp v21, v21, v21 row_ror:8 row_mask:0xf bank_mask:0xf
    v_add_f32_dpp v22, v22, v22 row_ror:8 row_mask:0xf bank_mask:0xf
    v_add_f32_dpp v23, v23, v23 row_ror:8 row_mask:0xf bank_mask:0xf
    v_add_f32_dpp v20, v20, v20 row_ror:4 row_mask:0xf bank_mask:0xf
    v_add_f32_dpp v21, v21, v21 row_ror:4 row_mask:0xf bank_mask:0xf
    v_add_f32_dpp v22, v22, v22 row_ror:4 row_mask:0xf bank_mask:0xf
    v_add_f32_dpp v23, v23, v23 row_ror:4 row_mask:0xf bank_mask:0xf
    v_add_f32_dpp v20, v20, v20 row_ror:2 row_mask:0xf bank_mask:0xf
    v_add_f32_dpp v21, v21, v21 row_ror:2 row_mask:0xf bank_mask:0xf
    v_add_f32_dpp v22, v22, v22 row_ror:2 row_mask:0xf bank_mask:0xf
    v_add_f32_dpp v23, v23, v23 row_ror:2 row_mask:0xf bank_mask:0xf
    v_add_f32_dpp v20, v20, v20 row_ror:1 row_mask:0xf bank_mask:0xf
    v_add_f32_dpp v21, v21, v21 row_ror:1 row_mask:0xf bank_mask:0xf
    v_add_f32_dpp v22, v22, v22 row_ror:1 row_mask:0xf bank_mask:0xf
    v_add_f32_dpp v23, v23, v23 row_ror:1 row_mask:0xf bank_mask:0xf
    s_waitcnt vmcnt(2)
    buffer_load_dwordx4 v[120:123], v6, s[44:47], s60 offen nt
    s_add_u32 s60, s60, 11264
    s_waitcnt vmcnt(2)
    buffer_load_dwordx4 v[124:127], v6, s[44:47], s60 offen nt
    v_dot2_f32_bf16 v24, v96, v2, 0
    v_dot2_f32_bf16 v25, v100, v2, 0
    v_dot2_f32_bf16 v26, v104, v2, 0
    v_dot2_f32_bf16 v27, v108, v2, 0
    v_dot2_f32_bf16 v24, v97, v3, v24
    v_dot2_f32_bf16 v25, v101, v3, v25
    v_dot2_f32_bf16 v26, v105, v3, v26
    v_dot2_f32_bf16 v27, v109, v3, v27
    v_dot2_f32_bf16 v24, v98, v4, v24
    v_dot2_f32_bf16 v25, v102, v4, v25
    v_dot2_f32_bf16 v26, v106, v4, v26
    v_dot2_f32_bf16 v27, v110, v4, v27
    v_dot2_f32_bf16 v24, v99, v5, v24
    v_dot2_f32_bf16 v25, v103, v5, v25
    v_dot2_f32_bf16 v26, v107, v5, v26
    v_dot2_f32_bf16 v27, v111, v5, v27
    v_add_f32_dpp v24, v24, v24 row_ror:8 row_mask:0xf bank_mask:0xf
    v_add_f32_dpp v25, v25, v25 row_ror:8 row_mask:0xf bank_mask:0xf
    v_add_f32_dpp v26, v26, v26 row_ror:8 row_mask:0xf bank_mask:0xf
    v_add_f32_dpp v27, v27, v27 row_ror:8 row_mask:0xf bank_mask:0xf
    v_add_f32_dpp v24, v24, v24 row_ror:4 row_mask:0xf bank_mask:0xf
    v_add_f32_dpp v25, v25, v25 row_ror:4 row_mask:0xf bank_mask:0xf
    v_add_f32_dpp v26, v26, v26 row_ror:4 row_mask:0xf bank_mask:0xf
    v_add_f32_dpp v27, v27, v27 row_ror:4 row_mask:0xf bank_mask:0xf
    v_add_f32_dpp v24, v24, v24 row_ror:2 row_mask:0xf bank_mask:0xf
    v_add_f32_dpp v25, v25, v25 row_ror:2 row_mask:0xf bank_mask:0xf
    v_add_f32_dpp v26, v26, v26 row_ror:2 row_mask:0xf bank_mask:0xf
    v_add_f32_dpp v27, v27, v27 row_ror:2 row_mask:0xf bank_mask:0xf
    v_add_f32_dpp v24, v24, v24 row_ror:1 row_mask:0xf bank_mask:0xf
    v_add_f32_dpp v25, v25, v25 row_ror:1 row_mask:0xf bank_mask:0xf
    v_add_f32_dpp v26, v26, v26 row_ror:1 row_mask:0xf bank_mask:0xf
    v_add_f32_dpp v27, v27, v27 row_ror:1 row_mask:0xf bank_mask:0xf
    s_waitcnt vmcnt(2)
    buffer_load_dwordx4 v[128:131], v6, s[48:51], s61 offen nt
    s_add_u32 s61, s61, 11264
    s_waitcnt vmcnt(2)
    buffer_load_dwordx4 v[132:135], v6, s[48:51], s61 offen nt
    s_add_u32 s61, s61, 11264
    s_waitcnt vmcnt(2)
    buffer_load_dwordx4 v[136:139], v6, s[48:51], s61 offen nt
    s_add_u32 s61, s61, 11264
    v_dot2_f32_bf16 v28, v112, v2, 0
    v_dot2_f32_bf16 v29, v116, v2, 0
    v_dot2_f32_bf16 v30, v120, v2, 0
    v_dot2_f32_bf16 v31, v124, v2, 0
    v_dot2_f32_bf16 v28, v113, v3, v28
    v_dot2_f32_bf16 v29, v117, v3, v29
    v_dot2_f32_bf16 v30, v121, v3, v30
    v_dot2_f32_bf16 v31, v125, v3, v31
    v_dot2_f32_bf16 v28, v114, v4, v28
    v_dot2_f32_bf16 v29, v118, v4, v29
    v_dot2_f32_bf16 v30, v122, v4, v30
    v_dot2_f32_bf16 v31, v126, v4, v31
    v_dot2_f32_bf16 v28, v115, v5, v28
    v_dot2_f32_bf16 v29, v119, v5, v29
    v_dot2_f32_bf16 v30, v123, v5, v30
    v_dot2_f32_bf16 v31, v127, v5, v31
    v_add_f32_dpp v28, v28, v28 row_ror:8 row_mask:0xf bank_mask:0xf
    v_add_f32_dpp v29, v29, v29 row_ror:8 row_mask:0xf bank_mask:0xf
    v_add_f32_dpp v30, v30, v30 row_ror:8 row_mask:0xf bank_mask:0xf
    v_add_f32_dpp v31, v31, v31 row_ror:8 row_mask:0xf bank_mask:0xf
    v_add_f32_dpp v28, v28, v28 row_ror:4 row_mask:0xf bank_mask:0xf
    v_add_f32_dpp v29, v29, v29 row_ror:4 row_mask:0xf bank_mask:0xf
    v_add_f32_dpp v30, v30, v30 row_ror:4 row_mask:0xf bank_mask:0xf
    v_add_f32_dpp v31, v31, v31 row_ror:4 row_mask:0xf bank_mask:0xf
    v_add_f32_dpp v28, v28, v28 row_ror:2 row_mask:0xf bank_mask:0xf
    v_add_f32_dpp v29, v29, v29 row_ror:2 row_mask:0xf bank_mask:0xf
    v_add_f32_dpp v30, v30, v30 row_ror:2 row_mask:0xf bank_mask:0xf
    v_add_f32_dpp v31, v31, v31 row_ror:2 row_mask:0xf bank_mask:0xf
    v_add_f32_dpp v28, v28, v28 row_ror:1 row_mask:0xf bank_mask:0xf
    v_add_f32_dpp v29, v29, v29 row_ror:1 row_mask:0xf bank_mask:0xf
    v_add_f32_dpp v30, v30, v30 row_ror:1 row_mask:0xf bank_mask:0xf
    v_add_f32_dpp v31, v31, v31 row_ror:1 row_mask:0xf bank_mask:0xf
    s_waitcnt vmcnt(2)
    buffer_load_dwordx4 v[140:143], v6, s[48:51], s61 offen nt
    s_add_u32 s61, s61, 11264
    s_waitcnt vmcnt(2)
    buffer_load_dwordx4 v[144:147], v6, s[48:51], s61 offen nt
    s_add_u32 s61, s61, 11264
    v_add_f32 v8, s62, v8
    v_add_f32 v9, s62, v9
    v_max3_f32 v160, v8, v9, v10
    v_max3_f32 v160, v160, v11, v12
    v_max3_f32 v160, v160, v13, v14
    v_max3_f32 v160, v160, v15, v16
    v_max3_f32 v160, v160, v17, v18
    v_max3_f32 v160, v160, v19, v20
    v_max3_f32 v160, v160, v21, v22
    v_max3_f32 v160, v160, v23, v24
    v_max3_f32 v160, v160, v25, v26
    v_max3_f32 v160, v160, v27, v28
    v_max3_f32 v160, v160, v29, v30
    v_max_f32 v160, v160, v31
    v_mov_b32 v161, v160
    s_nop 1
    v_permlane32_swap_b32 v160, v161
    v_max_f32 v160, v160, v161
    v_mov_b32 v161, v160
    s_nop 1
    v_permlane16_swap_b32 v160, v161
    v_max_f32 v160, v160, v161
    v_mul_f32 v160, s64, v160
    v_fma_f32 v8, v8, s64, -v160
    v_fma_f32 v9, v9, s64, -v160
    v_fma_f32 v10, v10, s64, -v160
    v_fma_f32 v11, v11, s64, -v160
    v_fma_f32 v12, v12, s64, -v160
    v_fma_f32 v13, v13, s64, -v160
    v_fma_f32 v14, v14, s64, -v160
    v_fma_f32 v15, v15, s64, -v160
    v_fma_f32 v16, v16, s64, -v160
    v_fma_f32 v17, v17, s64, -v160
    v_fma_f32 v18, v18, s64, -v160
    v_fma_f32 v19, v19, s64, -v160
    v_fma_f32 v20, v20, s64, -v160
    v_fma_f32 v21, v21, s64, -v160
    v_fma_f32 v22, v22, s64, -v160
    v_fma_f32 v23, v23, s64, -v160
    v_fma_f32 v24, v24, s64, -v160
    v_fma_f32 v25, v25, s64, -v160
    v_fma_f32 v26, v26, s64, -v160
    v_fma_f32 v27, v27, s64, -v160
    v_fma_f32 v28, v28, s64, -v160
    v_fma_f32 v29, v29, s64, -v160
    v_fma_f32 v30, v30, s64, -v160
    v_fma_f32 v31, v31, s64, -v160
    v_exp_f32 v8, v8
    v_exp_f32 v9, v9
    v_exp_f32 v10, v10
    v_exp_f32 v11, v11
    v_exp_f32 v12, v12
    v_exp_f32 v13, v13
    v_exp_f32 v14, v14
    v_exp_f32 v15, v15
    v_exp_f32 v16, v16
    v_exp_f32 v17, v17
    v_exp_f32 v18, v18
    v_exp_f32 v19, v19
    v_exp_f32 v20, v20
    v_exp_f32 v21, v21
    v_exp_f32 v22, v22
    v_exp_f32 v23, v23
    v_exp_f32 v24, v24
    v_exp_f32 v25, v25
    v_exp_f32 v26, v26
    v_exp_f32 v27, v27
    v_exp_f32 v28, v28
    v_exp_f32 v29, v29
    v_exp_f32 v30, v30
    v_exp_f32 v31, v31
    s_waitcnt vmcnt(2)
    buffer_load_dwordx4 v[148:151], v6, s[48:51], s61 offen nt
    s_add_u32 s61, s61, 11264
    v_add_f32 v162, v8, v9
    v_add_f32 v163, v10, v11
    v_add_f32 v162, v162, v12
    v_add_f32 v163, v163, v13
    v_add_f32 v162, v162, v14
    v_add_f32 v163, v163, v15
    v_add_f32 v162, v162, v16
    v_add_f32 v163, v163, v17
    v_add_f32 v162, v162, v18
    v_add_f32 v163, v163, v19
    v_add_f32 v162, v162, v20
    v_add_f32 v163, v163, v21
    v_add_f32 v162, v162, v22
    v_add_f32 v163, v163, v23
    v_add_f32 v162, v162, v24
    v_add_f32 v163, v163, v25
    v_add_f32 v162, v162, v26
    v_add_f32 v163, v163, v27
    v_add_f32 v162, v162, v28
    v_add_f32 v163, v163, v29
    v_add_f32 v162, v162, v30
    v_add_f32 v163, v163, v31
    v_add_f32 v162, v162, v163
    v_mov_b32 v163, v162
    s_nop 1
    v_permlane32_swap_b32 v162, v163
    v_add_f32 v162, v162, v163
    v_mov_b32 v163, v162
    s_nop 1
    v_permlane16_swap_b32 v162, v163
    v_add_f32 v161, v162, v163
    s_lshl_b32 s7, s3, 3
    s_add_u32 s7, s7, 0x24200
    v_mov_b32 v164, s7
    ds_write_b64 v164, v[160:161]
    v_mov_b32 v164, 0x24008
    v_mov_b32 v165, 1
    s_waitcnt lgkmcnt(0)
    s_mov_b64 exec, 1
    ds_add_u32 v164, v165
    s_mov_b64 exec, -1
    v_and_b32 v2, 15, v1
    v_lshlrev_b32 v2, 5, v2
    v_bfe_u32 v3, v1, 5, 1
    v_lshl_add_u32 v2, v3, 4, v2
    v_bfe_u32 v3, v1, 4, 1
    v_lshl_add_u32 v2, v3, 3, v2
    s_lshl_b32 s7, s3, 9
    s_add_u32 s7, s7, 0x10000
    v_add_u32 v2, s7, v2
    s_waitcnt vmcnt(2)
    buffer_load_dwordx4 v[32:35], v6, s[48:51], s61 offen nt
    s_add_u32 s61, s61, 11264
    v_lshlrev_b32 v160, 16, v128
    v_and_b32 v161, 0xffff0000, v128
    v_lshlrev_b32 v162, 16, v129
    v_and_b32 v163, 0xffff0000, v129
    v_lshlrev_b32 v164, 16, v130
    v_and_b32 v165, 0xffff0000, v130
    v_lshlrev_b32 v166, 16, v131
    v_and_b32 v167, 0xffff0000, v131
    v_pk_mul_f32 v[152:153], v[160:161], v[10:11] op_sel_hi:[1,0]
    v_pk_mul_f32 v[154:155], v[162:163], v[10:11] op_sel_hi:[1,0]
    v_pk_mul_f32 v[156:157], v[164:165], v[10:11] op_sel_hi:[1,0]
    v_pk_mul_f32 v[158:159], v[166:167], v[10:11] op_sel_hi:[1,0]
    v_lshlrev_b32 v160, 16, v132
    v_and_b32 v161, 0xffff0000, v132
    v_lshlrev_b32 v162, 16, v133
    v_and_b32 v163, 0xffff0000, v133
    v_lshlrev_b32 v164, 16, v134
    v_and_b32 v165, 0xffff0000, v134
    v_lshlrev_b32 v166, 16, v135
    v_and_b32 v167, 0xffff0000, v135
    v_pk_fma_f32 v[152:153], v[160:161], v[10:11], v[152:153] op_sel:[0,1,0] op_sel_hi:[1,1,1]
    v_pk_fma_f32 v[154:155], v[162:163], v[10:11], v[154:155] op_sel:[0,1,0] op_sel_hi:[1,1,1]
    v_pk_fma_f32 v[156:157], v[164:165], v[10:11], v[156:157] op_sel:[0,1,0] op_sel_hi:[1,1,1]
    v_pk_fma_f32 v[158:159], v[166:167], v[10:11], v[158:159] op_sel:[0,1,0] op_sel_hi:[1,1,1]
    s_waitcnt vmcnt(2)
    buffer_load_dwordx4 v[36:39], v6, s[48:51], s61 offen nt
    s_add_u32 s61, s61, 11264
    v_lshlrev_b32 v160, 16, v136
    v_and_b32 v161, 0xffff0000, v136
    v_lshlrev_b32 v162, 16, v137
    v_and_b32 v163, 0xffff0000, v137
    v_lshlrev_b32 v164, 16, v138
    v_and_b32 v165, 0xffff0000, v138
    v_lshlrev_b32 v166, 16, v139
    v_and_b32 v167, 0xffff0000, v139
    v_pk_fma_f32 v[152:153], v[160:161], v[12:13], v[152:153] op_sel_hi:[1,0,1]
    v_pk_fma_f32 v[154:155], v[162:163], v[12:13], v[154:155] op_sel_hi:[1,0,1]
    v_pk_fma_f32 v[156:157], v[164:165], v[12:13], v[156:157] op_sel_hi:[1,0,1]
    v_pk_fma_f32 v[158:159], v[166:167], v[12:13], v[158:159] op_sel_hi:[1,0,1]
    v_lshlrev_b32 v160, 16, v140
    v_and_b32 v161, 0xffff0000, v140
    v_lshlrev_b32 v162, 16, v141
    v_and_b32 v163, 0xffff0000, v141
    v_lshlrev_b32 v164, 16, v142
    v_and_b32 v165, 0xffff0000, v142
    v_lshlrev_b32 v166, 16, v143
    v_and_b32 v167, 0xffff0000, v143
    v_pk_fma_f32 v[152:153], v[160:161], v[12:13], v[152:153] op_sel:[0,1,0] op_sel_hi:[1,1,1]
    v_pk_fma_f32 v[154:155], v[162:163], v[12:13], v[154:155] op_sel:[0,1,0] op_sel_hi:[1,1,1]
    v_pk_fma_f32 v[156:157], v[164:165], v[12:13], v[156:157] op_sel:[0,1,0] op_sel_hi:[1,1,1]
    v_pk_fma_f32 v[158:159], v[166:167], v[12:13], v[158:159] op_sel:[0,1,0] op_sel_hi:[1,1,1]
    s_waitcnt vmcnt(2)
    buffer_load_dwordx4 v[40:43], v6, s[48:51], s61 offen nt
    s_add_u32 s61, s61, 11264
    v_lshlrev_b32 v160, 16, v144
    v_and_b32 v161, 0xffff0000, v144
    v_lshlrev_b32 v162, 16, v145
    v_and_b32 v163, 0xffff0000, v145
    v_lshlrev_b32 v164, 16, v146
    v_and_b32 v165, 0xffff0000, v146
    v_lshlrev_b32 v166, 16, v147
    v_and_b32 v167, 0xffff0000, v147
    v_pk_fma_f32 v[152:153], v[160:161], v[14:15], v[152:153] op_sel_hi:[1,0,1]
    v_pk_fma_f32 v[154:155], v[162:163], v[14:15], v[154:155] op_sel_hi:[1,0,1]
    v_pk_fma_f32 v[156:157], v[164:165], v[14:15], v[156:157] op_sel_hi:[1,0,1]
    v_pk_fma_f32 v[158:159], v[166:167], v[14:15], v[158:159] op_sel_hi:[1,0,1]
    v_lshlrev_b32 v160, 16, v148
    v_and_b32 v161, 0xffff0000, v148
    v_lshlrev_b32 v162, 16, v149
    v_and_b32 v163, 0xffff0000, v149
    v_lshlrev_b32 v164, 16, v150
    v_and_b32 v165, 0xffff0000, v150
    v_lshlrev_b32 v166, 16, v151
    v_and_b32 v167, 0xffff0000, v151
    v_pk_fma_f32 v[152:153], v[160:161], v[14:15], v[152:153] op_sel:[0,1,0] op_sel_hi:[1,1,1]
    v_pk_fma_f32 v[154:155], v[162:163], v[14:15], v[154:155] op_sel:[0,1,0] op_sel_hi:[1,1,1]
    v_pk_fma_f32 v[156:157], v[164:165], v[14:15], v[156:157] op_sel:[0,1,0] op_sel_hi:[1,1,1]
    v_pk_fma_f32 v[158:159], v[166:167], v[14:15], v[158:159] op_sel:[0,1,0] op_sel_hi:[1,1,1]
    s_waitcnt vmcnt(2)
    buffer_load_dwordx4 v[44:47], v6, s[48:51], s61 offen nt
    s_add_u32 s61, s61, 11264
    v_lshlrev_b32 v160, 16, v32
    v_and_b32 v161, 0xffff0000, v32
    v_lshlrev_b32 v162, 16, v33
    v_and_b32 v163, 0xffff0000, v33
    v_lshlrev_b32 v164, 16, v34
    v_and_b32 v165, 0xffff0000, v34
    v_lshlrev_b32 v166, 16, v35
    v_and_b32 v167, 0xffff0000, v35
    v_pk_fma_f32 v[152:153], v[160:161], v[16:17], v[152:153] op_sel_hi:[1,0,1]
    v_pk_fma_f32 v[154:155], v[162:163], v[16:17], v[154:155] op_sel_hi:[1,0,1]
    v_pk_fma_f32 v[156:157], v[164:165], v[16:17], v[156:157] op_sel_hi:[1,0,1]
    v_pk_fma_f32 v[158:159], v[166:167], v[16:17], v[158:159] op_sel_hi:[1,0,1]
    s_waitcnt vmcnt(2)
    buffer_load_dwordx4 v[48:51], v6, s[48:51], s61 offen nt
    s_add_u32 s61, s61, 11264
    v_lshlrev_b32 v160, 16, v36
    v_and_b32 v161, 0xffff0000, v36
    v_lshlrev_b32 v162, 16, v37
    v_and_b32 v163, 0xffff0000, v37
    v_lshlrev_b32 v164, 16, v38
    v_and_b32 v165, 0xffff0000, v38
    v_lshlrev_b32 v166, 16, v39
    v_and_b32 v167, 0xffff0000, v39
    v_pk_fma_f32 v[152:153], v[160:161], v[16:17], v[152:153] op_sel:[0,1,0] op_sel_hi:[1,1,1]
    v_pk_fma_f32 v[154:155], v[162:163], v[16:17], v[154:155] op_sel:[0,1,0] op_sel_hi:[1,1,1]
    v_pk_fma_f32 v[156:157], v[164:165], v[16:17], v[156:157] op_sel:[0,1,0] op_sel_hi:[1,1,1]
    v_pk_fma_f32 v[158:159], v[166:167], v[16:17], v[158:159] op_sel:[0,1,0] op_sel_hi:[1,1,1]
    s_waitcnt vmcnt(2)
    buffer_load_dwordx4 v[52:55], v6, s[48:51], s61 offen nt
    s_add_u32 s61, s61, 11264
    v_lshlrev_b32 v160, 16, v40
    v_and_b32 v161, 0xffff0000, v40
    v_lshlrev_b32 v162, 16, v41
    v_and_b32 v163, 0xffff0000, v41
    v_lshlrev_b32 v164, 16, v42
    v_and_b32 v165, 0xffff0000, v42
    v_lshlrev_b32 v166, 16, v43
    v_and_b32 v167, 0xffff0000, v43
    v_pk_fma_f32 v[152:153], v[160:161], v[18:19], v[152:153] op_sel_hi:[1,0,1]
    v_pk_fma_f32 v[154:155], v[162:163], v[18:19], v[154:155] op_sel_hi:[1,0,1]
    v_pk_fma_f32 v[156:157], v[164:165], v[18:19], v[156:157] op_sel_hi:[1,0,1]
    v_pk_fma_f32 v[158:159], v[166:167], v[18:19], v[158:159] op_sel_hi:[1,0,1]
    s_waitcnt vmcnt(2)
    buffer_load_dwordx4 v[56:59], v6, s[48:51], s61 offen nt
    s_add_u32 s61, s61, 11264
    v_lshlrev_b32 v160, 16, v44
    v_and_b32 v161, 0xffff0000, v44
    v_lshlrev_b32 v162, 16, v45
    v_and_b32 v163, 0xffff0000, v45
    v_lshlrev_b32 v164, 16, v46
    v_and_b32 v165, 0xffff0000, v46
    v_lshlrev_b32 v166, 16, v47
    v_and_b32 v167, 0xffff0000, v47
    v_pk_fma_f32 v[152:153], v[160:161], v[18:19], v[152:153] op_sel:[0,1,0] op_sel_hi:[1,1,1]
    v_pk_fma_f32 v[154:155], v[162:163], v[18:19], v[154:155] op_sel:[0,1,0] op_sel_hi:[1,1,1]
    v_pk_fma_f32 v[156:157], v[164:165], v[18:19], v[156:157] op_sel:[0,1,0] op_sel_hi:[1,1,1]
    v_pk_fma_f32 v[158:159], v[166:167], v[18:19], v[158:159] op_sel:[0,1,0] op_sel_hi:[1,1,1]
    s_waitcnt vmcnt(2)
    buffer_load_dwordx4 v[60:63], v6, s[48:51], s61 offen nt
    s_add_u32 s61, s61, 11264
    v_lshlrev_b32 v160, 16, v48
    v_and_b32 v161, 0xffff0000, v48
    v_lshlrev_b32 v162, 16, v49
    v_and_b32 v163, 0xffff0000, v49
    v_lshlrev_b32 v164, 16, v50
    v_and_b32 v165, 0xffff0000, v50
    v_lshlrev_b32 v166, 16, v51
    v_and_b32 v167, 0xffff0000, v51
    v_pk_fma_f32 v[152:153], v[160:161], v[20:21], v[152:153] op_sel_hi:[1,0,1]
    v_pk_fma_f32 v[154:155], v[162:163], v[20:21], v[154:155] op_sel_hi:[1,0,1]
    v_pk_fma_f32 v[156:157], v[164:165], v[20:21], v[156:157] op_sel_hi:[1,0,1]
    v_pk_fma_f32 v[158:159], v[166:167], v[20:21], v[158:159] op_sel_hi:[1,0,1]
    s_waitcnt vmcnt(2)
    buffer_load_dwordx4 v[64:67], v6, s[48:51], s61 offen nt
    s_add_u32 s61, s61, 11264
    v_lshlrev_b32 v160, 16, v52
    v_and_b32 v161, 0xffff0000, v52
    v_lshlrev_b32 v162, 16, v53
    v_and_b32 v163, 0xffff0000, v53
    v_lshlrev_b32 v164, 16, v54
    v_and_b32 v165, 0xffff0000, v54
    v_lshlrev_b32 v166, 16, v55
    v_and_b32 v167, 0xffff0000, v55
    v_pk_fma_f32 v[152:153], v[160:161], v[20:21], v[152:153] op_sel:[0,1,0] op_sel_hi:[1,1,1]
    v_pk_fma_f32 v[154:155], v[162:163], v[20:21], v[154:155] op_sel:[0,1,0] op_sel_hi:[1,1,1]
    v_pk_fma_f32 v[156:157], v[164:165], v[20:21], v[156:157] op_sel:[0,1,0] op_sel_hi:[1,1,1]
    v_pk_fma_f32 v[158:159], v[166:167], v[20:21], v[158:159] op_sel:[0,1,0] op_sel_hi:[1,1,1]
    s_waitcnt vmcnt(2)
    buffer_load_dwordx4 v[68:71], v6, s[48:51], s61 offen nt
    s_add_u32 s61, s61, 11264
    v_lshlrev_b32 v160, 16, v56
    v_and_b32 v161, 0xffff0000, v56
    v_lshlrev_b32 v162, 16, v57
    v_and_b32 v163, 0xffff0000, v57
    v_lshlrev_b32 v164, 16, v58
    v_and_b32 v165, 0xffff0000, v58
    v_lshlrev_b32 v166, 16, v59
    s_branch LC_AR
.p2align 12
LT_AR2:
    s_branch LR_AR2
LC_AR:
    v_and_b32 v167, 0xffff0000, v59
    v_pk_fma_f32 v[152:153], v[160:161], v[22:23], v[152:153] op_sel_hi:[1,0,1]
    v_pk_fma_f32 v[154:155], v[162:163], v[22:23], v[154:155] op_sel_hi:[1,0,1]
    v_pk_fma_f32 v[156:157], v[164:165], v[22:23], v[156:157] op_sel_hi:[1,0,1]
    v_pk_fma_f32 v[158:159], v[166:167], v[22:23], v[158:159] op_sel_hi:[1,0,1]
    s_waitcnt vmcnt(2)
    buffer_load_dwordx4 v[72:75], v6, s[48:51], s61 offen nt
    s_add_u32 s61, s61, 11264
    v_lshlrev_b32 v160, 16, v60
    v_and_b32 v161, 0xffff0000, v60
    v_lshlrev_b32 v162, 16, v61
    v_and_b32 v163, 0xffff0000, v61
    v_lshlrev_b32 v164, 16, v62
    v_and_b32 v165, 0xffff0000, v62
    v_lshlrev_b32 v166, 16, v63
    v_and_b32 v167, 0xffff0000, v63
    v_pk_fma_f32 v[152:153], v[160:161], v[22:23], v[152:153] op_sel:[0,1,0] op_sel_hi:[1,1,1]
    v_pk_fma_f32 v[154:155], v[162:163], v[22:23], v[154:155] op_sel:[0,1,0] op_sel_hi:[1,1,1]
    v_pk_fma_f32 v[156:157], v[164:165], v[22:23], v[156:157] op_sel:[0,1,0] op_sel_hi:[1,1,1]
    v_pk_fma_f32 v[158:159], v[166:167], v[22:23], v[158:159] op_sel:[0,1,0] op_sel_hi:[1,1,1]
    s_waitcnt vmcnt(2)
    buffer_load_dwordx4 v[76:79], v6, s[48:51], s61 offen nt
    s_add_u32 s61, s61, 11264
    v_lshlrev_b32 v160, 16, v64
    v_and_b32 v161, 0xffff0000, v64
    v_lshlrev_b32 v162, 16, v65
    v_and_b32 v163, 0xffff0000, v65
    v_lshlrev_b32 v164, 16, v66
    v_and_b32 v165, 0xffff0000, v66
    v_lshlrev_b32 v166, 16, v67
    v_and_b32 v167, 0xffff0000, v67
    v_pk_fma_f32 v[152:153], v[160:161], v[24:25], v[152:153] op_sel_hi:[1,0,1]
    v_pk_fma_f32 v[154:155], v[162:163], v[24:25], v[154:155] op_sel_hi:[1,0,1]
    v_pk_fma_f32 v[156:157], v[164:165], v[24:25], v[156:157] op_sel_hi:[1,0,1]
    v_pk_fma_f32 v[158:159], v[166:167], v[24:25], v[158:159] op_sel_hi:[1,0,1]
    s_waitcnt vmcnt(2)
    buffer_load_dwordx4 v[80:83], v6, s[48:51], s61 offen nt
    s_add_u32 s61, s61, 11264
    v_lshlrev_b32 v160, 16, v68
    v_and_b32 v161, 0xffff0000, v68
    v_lshlrev_b32 v162, 16, v69
    v_and_b32 v163, 0xffff0000, v69
    v_lshlrev_b32 v164, 16, v70
    v_and_b32 v165, 0xffff0000, v70
    v_lshlrev_b32 v166, 16, v71
    v_and_b32 v167, 0xffff0000, v71
    v_pk_fma_f32 v[152:153], v[160:161], v[24:25], v[152:153] op_sel:[0,1,0] op_sel_hi:[1,1,1]
    v_pk_fma_f32 v[154:155], v[162:163], v[24:25], v[154:155] op_sel:[0,1,0] op_sel_hi:[1,1,1]
    v_pk_fma_f32 v[156:157], v[164:165], v[24:25], v[156:157] op_sel:[0,1,0] op_sel_hi:[1,1,1]
    v_pk_fma_f32 v[158:159], v[166:167], v[24:25], v[158:159] op_sel:[0,1,0] op_sel_hi:[1,1,1]
    s_waitcnt vmcnt(2)
    buffer_load_dwordx4 v[84:87], v6, s[48:51], s61 offen nt
    s_add_u32 s61, s61, 11264
    v_lshlrev_b32 v160, 16, v72
    v_and_b32 v161, 0xffff0000, v72
    v_lshlrev_b32 v162, 16, v73
    v_and_b32 v163, 0xffff0000, v73
    v_lshlrev_b32 v164, 16, v74
    v_and_b32 v165, 0xffff0000, v74
    v_lshlrev_b32 v166, 16, v75
    v_and_b32 v167, 0xffff0000, v75
    v_pk_fma_f32 v[152:153], v[160:161], v[26:27], v[152:153] op_sel_hi:[1,0,1]
    v_pk_fma_f32 v[154:155], v[162:163], v[26:27], v[154:155] op_sel_hi:[1,0,1]
    v_pk_fma_f32 v[156:157], v[164:165], v[26:27], v[156:157] op_sel_hi:[1,0,1]
    v_pk_fma_f32 v[158:159], v[166:167], v[26:27], v[158:159] op_sel_hi:[1,0,1]
    s_waitcnt vmcnt(2)
    buffer_load_dwordx4 v[88:91], v6, s[48:51], s61 offen nt
    s_add_u32 s61, s61, 11264
    v_lshlrev_b32 v160, 16, v76
    v_and_b32 v161, 0xffff0000, v76
    v_lshlrev_b32 v162, 16, v77
    v_and_b32 v163, 0xffff0000, v77
    v_lshlrev_b32 v164, 16, v78
    v_and_b32 v165, 0xffff0000, v78
    v_lshlrev_b32 v166, 16, v79
    v_and_b32 v167, 0xffff0000, v79
    v_pk_fma_f32 v[152:153], v[160:161], v[26:27], v[152:153] op_sel:[0,1,0] op_sel_hi:[1,1,1]
    v_pk_fma_f32 v[154:155], v[162:163], v[26:27], v[154:155] op_sel:[0,1,0] op_sel_hi:[1,1,1]
    v_pk_fma_f32 v[156:157], v[164:165], v[26:27], v[156:157] op_sel:[0,1,0] op_sel_hi:[1,1,1]
    v_pk_fma_f32 v[158:159], v[166:167], v[26:27], v[158:159] op_sel:[0,1,0] op_sel_hi:[1,1,1]
    s_waitcnt vmcnt(2)
    buffer_load_dwordx4 v[92:95], v6, s[48:51], s61 offen nt
    v_lshlrev_b32 v160, 16, v80
    v_and_b32 v161, 0xffff0000, v80
    v_lshlrev_b32 v162, 16, v81
    v_and_b32 v163, 0xffff0000, v81
    v_lshlrev_b32 v164, 16, v82
    v_and_b32 v165, 0xffff0000, v82
    v_lshlrev_b32 v166, 16, v83
    v_and_b32 v167, 0xffff0000, v83
    v_pk_fma_f32 v[152:153], v[160:161], v[28:29], v[152:153] op_sel_hi:[1,0,1]
    v_pk_fma_f32 v[154:155], v[162:163], v[28:29], v[154:155] op_sel_hi:[1,0,1]
    v_pk_fma_f32 v[156:157], v[164:165], v[28:29], v[156:157] op_sel_hi:[1,0,1]
    v_pk_fma_f32 v[158:159], v[166:167], v[28:29], v[158:159] op_sel_hi:[1,0,1]
    s_cmp_eq_u32 s62, 0
    s_cbranch_scc1 AL_9
    s_waitcnt vmcnt(2)
    v_lshlrev_b32 v160, 16, v84
    v_and_b32 v161, 0xffff0000, v84
    v_lshlrev_b32 v162, 16, v85
    v_and_b32 v163, 0xffff0000, v85
    v_lshlrev_b32 v164, 16, v86
    v_and_b32 v165, 0xffff0000, v86
    v_lshlrev_b32 v166, 16, v87
    v_and_b32 v167, 0xffff0000, v87
    v_pk_fma_f32 v[152:153], v[160:161], v[28:29], v[152:153] op_sel:[0,1,0] op_sel_hi:[1,1,1]
    v_pk_fma_f32 v[154:155], v[162:163], v[28:29], v[154:155] op_sel:[0,1,0] op_sel_hi:[1,1,1]
    v_pk_fma_f32 v[156:157], v[164:165], v[28:29], v[156:157] op_sel:[0,1,0] op_sel_hi:[1,1,1]
    v_pk_fma_f32 v[158:159], v[166:167], v[28:29], v[158:159] op_sel:[0,1,0] op_sel_hi:[1,1,1]
    s_waitcnt vmcnt(1)
    v_lshlrev_b32 v160, 16, v88
    v_and_b32 v161, 0xffff0000, v88
    v_lshlrev_b32 v162, 16, v89
    v_and_b32 v163, 0xffff0000, v89
    v_lshlrev_b32 v164, 16, v90
    v_and_b32 v165, 0xffff0000, v90
    v_lshlrev_b32 v166, 16, v91
    v_and_b32 v167, 0xffff0000, v91
    v_pk_fma_f32 v[152:153], v[160:161], v[30:31], v[152:153] op_sel_hi:[1,0,1]
    v_pk_fma_f32 v[154:155], v[162:163], v[30:31], v[154:155] op_sel_hi:[1,0,1]
    v_pk_fma_f32 v[156:157], v[164:165], v[30:31], v[156:157] op_sel_hi:[1,0,1]
    v_pk_fma_f32 v[158:159], v[166:167], v[30:31], v[158:159] op_sel_hi:[1,0,1]
    s_waitcnt vmcnt(0)
    v_lshlrev_b32 v160, 16, v92
    v_and_b32 v161, 0xffff0000, v92
    v_lshlrev_b32 v162, 16, v93
    v_and_b32 v163, 0xffff0000, v93
    v_lshlrev_b32 v164, 16, v94
    v_and_b32 v165, 0xffff0000, v94
    v_lshlrev_b32 v166, 16, v95
    v_and_b32 v167, 0xffff0000, v95
    v_pk_fma_f32 v[152:153], v[160:161], v[30:31], v[152:153] op_sel:[0,1,0] op_sel_hi:[1,1,1]
    v_pk_fma_f32 v[154:155], v[162:163], v[30:31], v[154:155] op_sel:[0,1,0] op_sel_hi:[1,1,1]
    v_pk_fma_f32 v[156:157], v[164:165], v[30:31], v[156:157] op_sel:[0,1,0] op_sel_hi:[1,1,1]
    v_pk_fma_f32 v[158:159], v[166:167], v[30:31], v[158:159] op_sel:[0,1,0] op_sel_hi:[1,1,1]
    s_branch L_AFIN
AL_9:
    s_waitcnt vmcnt(2)
    buffer_load_dwordx4 v[96:99], v6, s[48:51], s63 offen nt
    v_lshlrev_b32 v160, 16, v84
    v_and_b32 v161, 0xffff0000, v84
    v_lshlrev_b32 v162, 16, v85
    v_and_b32 v163, 0xffff0000, v85
    v_lshlrev_b32 v164, 16, v86
    v_and_b32 v165, 0xffff0000, v86
    v_lshlrev_b32 v166, 16, v87
    v_and_b32 v167, 0xffff0000, v87
    v_pk_fma_f32 v[152:153], v[160:161], v[28:29], v[152:153] op_sel:[0,1,0] op_sel_hi:[1,1,1]
    v_pk_fma_f32 v[154:155], v[162:163], v[28:29], v[154:155] op_sel:[0,1,0] op_sel_hi:[1,1,1]
    v_pk_fma_f32 v[156:157], v[164:165], v[28:29], v[156:157] op_sel:[0,1,0] op_sel_hi:[1,1,1]
    v_pk_fma_f32 v[158:159], v[166:167], v[28:29], v[158:159] op_sel:[0,1,0] op_sel_hi:[1,1,1]
    s_waitcnt vmcnt(2)
    buffer_load_dwordx4 v[100:103], v6, s[48:51], s65 offen nt
    v_lshlrev_b32 v160, 16, v88
    v_and_b32 v161, 0xffff0000, v88
    v_lshlrev_b32 v162, 16, v89
    v_and_b32 v163, 0xffff0000, v89
    v_lshlrev_b32 v164, 16, v90
    v_and_b32 v165, 0xffff0000, v90
    v_lshlrev_b32 v166, 16, v91
    v_and_b32 v167, 0xffff0000, v91
    v_pk_fma_f32 v[152:153], v[160:161], v[30:31], v[152:153] op_sel_hi:[1,0,1]
    v_pk_fma_f32 v[154:155], v[162:163], v[30:31], v[154:155] op_sel_hi:[1,0,1]
    v_pk_fma_f32 v[156:157], v[164:165], v[30:31], v[156:157] op_sel_hi:[1,0,1]
    v_pk_fma_f32 v[158:159], v[166:167], v[30:31], v[158:159] op_sel_hi:[1,0,1]
    s_waitcnt vmcnt(2)
    v_lshlrev_b32 v160, 16, v92
    v_and_b32 v161, 0xffff0000, v92
    v_lshlrev_b32 v162, 16, v93
    v_and_b32 v163, 0xffff0000, v93
    v_lshlrev_b32 v164, 16, v94
    v_and_b32 v165, 0xffff0000, v94
    v_lshlrev_b32 v166, 16, v95
    v_and_b32 v167, 0xffff0000, v95
    v_pk_fma_f32 v[152:153], v[160:161], v[30:31], v[152:153] op_sel:[0,1,0] op_sel_hi:[1,1,1]
    v_pk_fma_f32 v[154:155], v[162:163], v[30:31], v[154:155] op_sel:[0,1,0] op_sel_hi:[1,1,1]
    v_pk_fma_f32 v[156:157], v[164:165], v[30:31], v[156:157] op_sel:[0,1,0] op_sel_hi:[1,1,1]
    v_pk_fma_f32 v[158:159], v[166:167], v[30:31], v[158:159] op_sel:[0,1,0] op_sel_hi:[1,1,1]
    s_waitcnt vmcnt(1)
    v_lshlrev_b32 v160, 16, v96
    v_and_b32 v161, 0xffff0000, v96
    v_lshlrev_b32 v162, 16, v97
    v_and_b32 v163, 0xffff0000, v97
    v_lshlrev_b32 v164, 16, v98
    v_and_b32 v165, 0xffff0000, v98
    v_lshlrev_b32 v166, 16, v99
    v_and_b32 v167, 0xffff0000, v99
    v_pk_fma_f32 v[152:153], v[160:161], v[8:9], v[152:153] op_sel_hi:[1,0,1]
    v_pk_fma_f32 v[154:155], v[162:163], v[8:9], v[154:155] op_sel_hi:[1,0,1]
    v_pk_fma_f32 v[156:157], v[164:165], v[8:9], v[156:157] op_sel_hi:[1,0,1]
    v_pk_fma_f32 v[158:159], v[166:167], v[8:9], v[158:159] op_sel_hi:[1,0,1]
    s_waitcnt vmcnt(0)
    v_lshlrev_b32 v160, 16, v100
    v_and_b32 v161, 0xffff0000, v100
    v_lshlrev_b32 v162, 16, v101
    v_and_b32 v163, 0xffff0000, v101
    v_lshlrev_b32 v164, 16, v102
    v_and_b32 v165, 0xffff0000, v102
    v_lshlrev_b32 v166, 16, v103
    v_and_b32 v167, 0xffff0000, v103
    v_pk_fma_f32 v[152:153], v[160:161], v[8:9], v[152:153] op_sel:[0,1,0] op_sel_hi:[1,1,1]
    v_pk_fma_f32 v[154:155], v[162:163], v[8:9], v[154:155] op_sel:[0,1,0] op_sel_hi:[1,1,1]
    v_pk_fma_f32 v[156:157], v[164:165], v[8:9], v[156:157] op_sel:[0,1,0] op_sel_hi:[1,1,1]
    v_pk_fma_f32 v[158:159], v[166:167], v[8:9], v[158:159] op_sel:[0,1,0] op_sel_hi:[1,1,1]
L_AFIN:
    s_nop 1
    v_permlane32_swap_b32 v152, v156
    v_permlane32_swap_b32 v153, v157
    v_permlane32_swap_b32 v154, v158
    v_permlane32_swap_b32 v155, v159
    v_add_f32 v152, v152, v156
    v_add_f32 v153, v153, v157
    v_add_f32 v154, v154, v158
    v_add_f32 v155, v155, v159
    s_nop 0
    v_permlane16_swap_b32 v152, v154
    v_permlane16_swap_b32 v153, v155
    v_add_f32 v152, v152, v154
    v_add_f32 v153, v153, v155
    ds_write_b64 v2, v[152:153]
    s_waitcnt lgkmcnt(0)
    s_barrier
    s_endpgm
L_ASVC:
    s_cmp_lg_u32 s3, 11
    s_cbranch_scc1 Z_10
    v_lshlrev_b32 v2, 2, v1
    v_add_u32 v2, 0x24000, v2
    v_mov_b32 v3, 0
    ds_write_b32 v2, v3
Z_10:
    s_waitcnt lgkmcnt(0)
    s_mov_b32 s92, 0x05040100
    s_mov_b32 s93, 0x07060302
    s_mov_b32 s36, s34
    s_and_b32 s37, s35, 0xffff
    s_mov_b32 s38, 0x1000000
    s_mov_b32 s39, 0x20000
    s_mov_b32 s40, s32
    s_and_b32 s41, s33, 0xffff
    s_mov_b32 s42, 0x100
    s_mov_b32 s43, 0x20000
    s_setprio 3
    s_lshr_b32 s60, s5, 2
    s_sub_u32 s60, s60, 4
    s_barrier
    s_lshl_b32 s7, s6, 2
    s_add_u32 s7, s7, s60
    s_lshl_b32 s7, s7, 11
    v_lshl_add_u32 v3, v1, 4, s7
    v_add_u32 v5, 0x40000, v3
    v_add_u32 v3, 0x80000, v3
    s_lshl_b32 s7, s6, 5
    s_add_u32 s7, s7, s60
    s_lshl_b32 s7, s7, 8
    s_add_u32 s7, s7, 0x80000
    v_lshrrev_b32 v6, 4, v1
    v_lshlrev_b32 v6, 11, v6
    v_and_b32 v100, 15, v1
    v_lshl_add_u32 v6, v100, 4, v6
    v_add_u32 v6, s7, v6
    s_sleep 8
    v_mov_b32 v90, 0
    s_mov_b32 s80, 200000
    s_mov_b64 exec, 1
    buffer_load_dwordx2 v[94:95], v90, s[40:43], 0 offen sc1
    s_sleep 16
    buffer_load_dwordx2 v[92:93], v90, s[40:43], 0 offen sc1
    s_mov_b64 exec, -1
    s_waitcnt vmcnt(1)
    v_readfirstlane_b32 s94, v94
    v_readfirstlane_b32 s95, v95
    s_cmp_lg_u32 s95, 0
    s_cbranch_scc1 NGD_12
    s_branch NG2_13
NG_11:
    s_mov_b64 exec, 1
    buffer_load_dwordx2 v[92:93], v90, s[40:43], 0 offen sc1
    s_mov_b64 exec, -1
NG2_13:
    s_waitcnt vmcnt(0)
    v_readfirstlane_b32 s94, v92
    v_readfirstlane_b32 s95, v93
    s_cmp_lg_u32 s95, 0
    s_cbranch_scc1 NGD_12
    s_sleep 4
    s_sub_u32 s80, s80, 1
    s_cmp_lg_u32 s80, 0
    s_cbranch_scc1 NG_11
NGD_12:
    v_lshlrev_b32 v7, 5, v1
    v_mov_b32 v114, s94
    v_mov_b32 v115, s95
    v_mov_b32 v118, s94
    v_mov_b32 v119, s95
    v_mov_b32 v122, s94
    v_mov_b32 v123, s95
    v_mov_b32 v126, s94
    v_mov_b32 v127, s95
    v_mov_b32 v100, 0x24044
    s_mov_b32 s80, 1600000
LW_14:
    ds_read_b32 v101, v100
    s_waitcnt lgkmcnt(0)
    v_readfirstlane_b32 s79, v101
    s_cmp_ge_u32 s79, 4
    s_cbranch_scc1 LWD_15
    s_sub_u32 s80, s80, 1
    s_cmp_lg_u32 s80, 0
    s_cbranch_scc1 LW_14
LWD_15:
    ds_read_b128 v[16:19], v7 offset:0
    ds_read_b128 v[20:23], v7 offset:16
    ds_read_b128 v[24:27], v7 offset:2048
    ds_read_b128 v[28:31], v7 offset:2064
    ds_read_b128 v[32:35], v7 offset:4096
    ds_read_b128 v[36:39], v7 offset:4112
    ds_read_b128 v[40:43], v7 offset:6144
    ds_read_b128 v[44:47], v7 offset:6160
    s_waitcnt lgkmcnt(0)
    v_add_f32 v16, v16, v32
    v_add_f32 v17, v17, v33
    v_add_f32 v18, v18, v34
    v_add_f32 v19, v19, v35
    v_add_f32 v20, v20, v36
    v_add_f32 v21, v21, v37
    v_add_f32 v22, v22, v38
    v_add_f32 v23, v23, v39
    v_add_f32 v24, v24, v40
    v_add_f32 v25, v25, v41
    v_add_f32 v26, v26, v42
    v_add_f32 v27, v27, v43
    v_add_f32 v28, v28, v44
    v_add_f32 v29, v29, v45
    v_add_f32 v30, v30, v46
    v_add_f32 v31, v31, v47
    v_add_f32 v16, v16, v24
    v_add_f32 v17, v17, v25
    v_add_f32 v18, v18, v26
    v_add_f32 v19, v19, v27
    v_add_f32 v20, v20, v28
    v_add_f32 v21, v21, v29
    v_add_f32 v22, v22, v30
    v_add_f32 v23, v23, v31
    v_cvt_pk_bf16_f32 v112, v16, v17
    v_cvt_pk_bf16_f32 v113, v18, v19
    v_cvt_pk_bf16_f32 v116, v20, v21
    v_cvt_pk_bf16_f32 v117, v22, v23
    buffer_store_dwordx4 v[112:115], v5, s[36:39], 0 offen offset:0
    buffer_store_dwordx4 v[116:119], v5, s[36:39], 0 offen offset:1024
    v_mov_b32 v100, 0x24018
    v_mov_b32 v101, 1
    s_waitcnt lgkmcnt(0)
    s_mov_b64 exec, 1
    ds_add_u32 v100, v101
    s_mov_b64 exec, -1
    v_mov_b32 v100, 0x24040
    s_mov_b32 s80, 1600000
LW_16:
    ds_read_b32 v101, v100
    s_waitcnt lgkmcnt(0)
    v_readfirstlane_b32 s79, v101
    s_cmp_ge_u32 s79, 4
    s_cbranch_scc1 LWD_17
    s_sub_u32 s80, s80, 1
    s_cmp_lg_u32 s80, 0
    s_cbranch_scc1 LW_16
LWD_17:
    ds_read_b128 v[16:19], v7 offset:8192
    ds_read_b128 v[20:23], v7 offset:8208
    ds_read_b128 v[24:27], v7 offset:10240
    ds_read_b128 v[28:31], v7 offset:10256
    ds_read_b128 v[32:35], v7 offset:12288
    ds_read_b128 v[36:39], v7 offset:12304
    ds_read_b128 v[40:43], v7 offset:14336
    ds_read_b128 v[44:47], v7 offset:14352
    s_waitcnt lgkmcnt(0)
    v_add_f32 v16, v16, v32
    v_add_f32 v17, v17, v33
    v_add_f32 v18, v18, v34
    v_add_f32 v19, v19, v35
    v_add_f32 v20, v20, v36
    v_add_f32 v21, v21, v37
    v_add_f32 v22, v22, v38
    v_add_f32 v23, v23, v39
    v_add_f32 v24, v24, v40
    v_add_f32 v25, v25, v41
    v_add_f32 v26, v26, v42
    v_add_f32 v27, v27, v43
    v_add_f32 v28, v28, v44
    v_add_f32 v29, v29, v45
    v_add_f32 v30, v30, v46
    v_add_f32 v31, v31, v47
    v_add_f32 v16, v16, v24
    v_add_f32 v17, v17, v25
    v_add_f32 v18, v18, v26
    v_add_f32 v19, v19, v27
    v_add_f32 v20, v20, v28
    v_add_f32 v21, v21, v29
    v_add_f32 v22, v22, v30
    v_add_f32 v23, v23, v31
    v_cvt_pk_bf16_f32 v120, v16, v17
    v_cvt_pk_bf16_f32 v121, v18, v19
    v_cvt_pk_bf16_f32 v124, v20, v21
    v_cvt_pk_bf16_f32 v125, v22, v23
    buffer_store_dwordx4 v[120:123], v6, s[36:39], 0 offen offset:0
    buffer_store_dwordx4 v[124:127], v6, s[36:39], 0 offen offset:1024
    v_mov_b32 v100, 0x24018
    v_mov_b32 v101, 1
    s_waitcnt lgkmcnt(0)
    s_mov_b64 exec, 1
    ds_add_u32 v100, v101
    s_mov_b64 exec, -1
    v_mov_b32 v110, v5
    v_mov_b32 v111, v6
    s_getreg_b32 s96, hwreg(HW_REG_XCC_ID, 0, 4)
    s_lshl_b32 s7, s4, 5
    s_add_u32 s7, s7, s5
    s_lshl_b32 s7, s7, 4
    s_add_u32 s7, s7, 0xc0000
    v_mov_b32 v100, s7
    v_mov_b32 v102, s96
    v_mov_b32 v103, 0
    v_mov_b32 v104, s94
    v_mov_b32 v105, s95
    s_mov_b64 exec, 1
    buffer_store_dwordx4 v[102:105], v100, s[36:39], 0 offen
    s_mov_b64 exec, -1
    s_sleep 16
    buffer_load_dwordx4 v[32:35], v3, s[36:39], 0 offen offset:0 sc1
    buffer_load_dwordx4 v[36:39], v3, s[36:39], 0 offen offset:1024 sc1
    s_mov_b32 s80, 200000
PS_18:
    s_waitcnt vmcnt(0)
    s_mov_b32 s78, 0
    v_cmp_ne_u64 vcc, s[94:95], v[34:35]
    s_cbranch_vccz PSS_20
    buffer_load_dwordx4 v[32:35], v3, s[36:39], 0 offen offset:0 sc1
    s_mov_b32 s78, 1
PSS_20:
    v_cmp_ne_u64 vcc, s[94:95], v[38:39]
    s_cbranch_vccz PSS_21
    buffer_load_dwordx4 v[36:39], v3, s[36:39], 0 offen offset:1024 sc1
    s_mov_b32 s78, 1
PSS_21:
    s_cmp_eq_u32 s78, 0
    s_cbranch_scc1 PSD_19
    s_sleep 8
    s_cmp_lg_u32 s80, 199984
    s_cbranch_scc1 PSL_22
    buffer_store_dwordx4 v[112:115], v110, s[36:39], 0 offen offset:0 sc1
    buffer_store_dwordx4 v[116:119], v110, s[36:39], 0 offen offset:1024 sc1
    buffer_store_dwordx4 v[120:123], v111, s[36:39], 0 offen offset:0 sc1
    buffer_store_dwordx4 v[124:127], v111, s[36:39], 0 offen offset:1024 sc1
PSL_22:
    s_sub_u32 s80, s80, 1
    s_cmp_lg_u32 s80, 0
    s_cbranch_scc1 PS_18
    s_waitcnt vmcnt(0)
PSD_19:
    v_lshlrev_b32 v16, 16, v32
    v_and_b32 v17, 0xffff0000, v32
    v_lshlrev_b32 v18, 16, v33
    v_and_b32 v19, 0xffff0000, v33
    v_lshlrev_b32 v20, 16, v36
    v_and_b32 v21, 0xffff0000, v36
    v_lshlrev_b32 v22, 16, v37
    v_and_b32 v23, 0xffff0000, v37
    v_mov_b32 v24, v16
    v_mov_b32 v25, v17
    v_mov_b32 v26, v18
    v_mov_b32 v27, v19
    v_mov_b32 v28, v20
    v_mov_b32 v29, v21
    v_mov_b32 v30, v22
    v_mov_b32 v31, v23
    v_permlane32_swap_b32 v16, v24
    v_permlane32_swap_b32 v17, v25
    v_permlane32_swap_b32 v18, v26
    v_permlane32_swap_b32 v19, v27
    v_permlane32_swap_b32 v20, v28
    v_permlane32_swap_b32 v21, v29
    v_permlane32_swap_b32 v22, v30
    v_permlane32_swap_b32 v23, v31
    v_add_f32 v16, v16, v24
    v_add_f32 v17, v17, v25
    v_add_f32 v18, v18, v26
    v_add_f32 v19, v19, v27
    v_add_f32 v20, v20, v28
    v_add_f32 v21, v21, v29
    v_add_f32 v22, v22, v30
    v_add_f32 v23, v23, v31
    v_mov_b32 v24, v16
    v_mov_b32 v25, v17
    v_mov_b32 v26, v18
    v_mov_b32 v27, v19
    v_mov_b32 v28, v20
    v_mov_b32 v29, v21
    v_mov_b32 v30, v22
    v_mov_b32 v31, v23
    v_permlane16_swap_b32 v16, v24
    v_permlane16_swap_b32 v17, v25
    v_permlane16_swap_b32 v18, v26
    v_permlane16_swap_b32 v19, v27
    v_permlane16_swap_b32 v20, v28
    v_permlane16_swap_b32 v21, v29
    v_permlane16_swap_b32 v22, v30
    v_permlane16_swap_b32 v23, v31
    v_add_f32 v16, v16, v24
    v_add_f32 v17, v17, v25
    v_add_f32 v18, v18, v26
    v_add_f32 v19, v19, v27
    v_add_f32 v20, v20, v28
    v_add_f32 v21, v21, v29
    v_add_f32 v22, v22, v30
    v_add_f32 v23, v23, v31
    v_cvt_pk_bf16_f32 v8, v16, v17
    v_cvt_pk_bf16_f32 v9, v18, v19
    v_cvt_pk_bf16_f32 v10, v20, v21
    v_cvt_pk_bf16_f32 v11, v22, v23
    v_and_b32 v100, 15, v1
    v_lshlrev_b32 v100, 4, v100
    v_add_u32 v100, 0x24100, v100
    ds_write_b128 v100, v[8:11]
L_ACUT:
    v_mov_b32 v100, 0x24004
    v_mov_b32 v101, 1
    s_waitcnt lgkmcnt(0)
    s_mov_b64 exec, 1
    ds_add_u32 v100, v101
    s_mov_b64 exec, -1
    v_mov_b32 v100, 0x24008
    s_mov_b32 s80, 1600000
LW_23:
    ds_read_b32 v101, v100
    s_waitcnt lgkmcnt(0)
    v_readfirstlane_b32 s79, v101
    s_cmp_ge_u32 s79, 11
    s_cbranch_scc1 LWD_24
    s_sleep 8
    s_sub_u32 s80, s80, 1
    s_cmp_lg_u32 s80, 0
    s_cbranch_scc1 LW_23
LWD_24:
    v_and_b32 v100, 31, v1
    s_lshl_b32 s7, s4, 9
    s_add_u32 s7, s7, 0xc0000
    v_lshl_add_u32 v100, v100, 4, s7
    buffer_load_dwordx4 v[32:35], v100, s[36:39], 0 offen sc1
    s_waitcnt vmcnt(0)
    v_cmp_ne_u64 vcc, s[94:95], v[34:35]
    v_cmp_ne_u32 s[86:87], s96, v32
    s_or_b32 s97, vcc_lo, s86
    s_and_b32 s97, s97, 0xffff00ff
    s_cbranch_scc0 AF_25
    buffer_store_dwordx4 v[112:115], v110, s[36:39], 0 offen offset:0 sc1
    buffer_store_dwordx4 v[116:119], v110, s[36:39], 0 offen offset:1024 sc1
    buffer_store_dwordx4 v[120:123], v111, s[36:39], 0 offen offset:0 sc1
    buffer_store_dwordx4 v[124:127], v111, s[36:39], 0 offen offset:1024 sc1
AF_25:
    v_mov_b32 v100, 0x24200
    ds_read_b128 v[8:11], v100 offset:0
    ds_read_b128 v[12:15], v100 offset:16
    ds_read_b128 v[16:19], v100 offset:32
    ds_read_b128 v[20:23], v100 offset:48
    ds_read_b128 v[24:27], v100 offset:64
    ds_read_b128 v[28:31], v100 offset:80
    s_waitcnt lgkmcnt(0)
    v_max3_f32 v100, v8, v10, v12
    v_max3_f32 v100, v100, v14, v16
    v_max3_f32 v100, v100, v18, v20
    v_max3_f32 v100, v100, v22, v24
    v_max3_f32 v100, v100, v26, v28
    v_sub_f32 v8, v8, v100
    v_sub_f32 v10, v10, v100
    v_sub_f32 v12, v12, v100
    v_sub_f32 v14, v14, v100
    v_sub_f32 v16, v16, v100
    v_sub_f32 v18, v18, v100
    v_sub_f32 v20, v20, v100
    v_sub_f32 v22, v22, v100
    v_sub_f32 v24, v24, v100
    v_sub_f32 v26, v26, v100
    v_sub_f32 v28, v28, v100
    v_exp_f32 v8, v8
    v_exp_f32 v10, v10
    v_exp_f32 v12, v12
    v_exp_f32 v14, v14
    v_exp_f32 v16, v16
    v_exp_f32 v18, v18
    v_exp_f32 v20, v20
    v_exp_f32 v22, v22
    v_exp_f32 v24, v24
    v_exp_f32 v26, v26
    v_exp_f32 v28, v28
    v_mul_f32 v101, v8, v9
    v_fmac_f32 v101, v10, v11
    v_fmac_f32 v101, v12, v13
    v_fmac_f32 v101, v14, v15
    v_fmac_f32 v101, v16, v17
    v_fmac_f32 v101, v18, v19
    v_fmac_f32 v101, v20, v21
    v_fmac_f32 v101, v22, v23
    v_fmac_f32 v101, v24, v25
    v_fmac_f32 v101, v26, v27
    v_fmac_f32 v101, v28, v29
    v_rcp_f32 v101, v101
    s_nop 0
    v_mul_f32 v8, v8, v101
    v_mul_f32 v10, v10, v101
    v_mul_f32 v12, v12, v101
    v_mul_f32 v14, v14, v101
    v_mul_f32 v16, v16, v101
    v_mul_f32 v18, v18, v101
    v_mul_f32 v20, v20, v101
    v_mul_f32 v22, v22, v101
    v_mul_f32 v24, v24, v101
    v_mul_f32 v26, v26, v101
    v_mul_f32 v28, v28, v101
    v_and_b32 v100, 15, v1
    v_bfe_u32 v101, v1, 4, 1
    v_lshlrev_b32 v3, 5, v100
    v_lshl_add_u32 v3, v101, 4, v3
    v_add_u32 v3, 0x10000, v3
    s_lshl_b32 s7, s6, 3
    s_add_u32 s7, s7, s60
    s_lshl_b32 s7, s7, 8
    s_add_u32 s7, s7, 0xd0000
    v_lshlrev_b32 v2, 4, v100
    v_lshl_add_u32 v2, v101, 10, v2
    v_add_u32 v2, s7, v2
    v_mov_b32 v6, s94
    v_mov_b32 v7, s95
    s_barrier
    ds_read_b128 v[40:43], v3 offset:0
    ds_read_b128 v[44:47], v3 offset:512
    ds_read_b128 v[48:51], v3 offset:1024
    ds_read_b128 v[52:55], v3 offset:1536
    ds_read_b128 v[56:59], v3 offset:2048
    ds_read_b128 v[60:63], v3 offset:2560
    ds_read_b128 v[64:67], v3 offset:3072
    ds_read_b128 v[68:71], v3 offset:3584
    ds_read_b128 v[72:75], v3 offset:4096
    ds_read_b128 v[76:79], v3 offset:4608
    ds_read_b128 v[80:83], v3 offset:5120
    s_waitcnt lgkmcnt(10)
    v_pk_mul_f32 v[32:33], v[40:41], v[8:9] op_sel_hi:[1,0]
    v_pk_mul_f32 v[34:35], v[42:43], v[8:9] op_sel_hi:[1,0]
    s_waitcnt lgkmcnt(9)
    v_pk_mul_f32 v[36:37], v[44:45], v[10:11] op_sel_hi:[1,0]
    v_pk_mul_f32 v[38:39], v[46:47], v[10:11] op_sel_hi:[1,0]
    s_waitcnt lgkmcnt(8)
    v_pk_fma_f32 v[32:33], v[48:49], v[12:13], v[32:33] op_sel_hi:[1,0,1]
    v_pk_fma_f32 v[34:35], v[50:51], v[12:13], v[34:35] op_sel_hi:[1,0,1]
    s_waitcnt lgkmcnt(7)
    v_pk_fma_f32 v[36:37], v[52:53], v[14:15], v[36:37] op_sel_hi:[1,0,1]
    v_pk_fma_f32 v[38:39], v[54:55], v[14:15], v[38:39] op_sel_hi:[1,0,1]
    s_waitcnt lgkmcnt(6)
    v_pk_fma_f32 v[32:33], v[56:57], v[16:17], v[32:33] op_sel_hi:[1,0,1]
    v_pk_fma_f32 v[34:35], v[58:59], v[16:17], v[34:35] op_sel_hi:[1,0,1]
    s_waitcnt lgkmcnt(5)
    v_pk_fma_f32 v[36:37], v[60:61], v[18:19], v[36:37] op_sel_hi:[1,0,1]
    v_pk_fma_f32 v[38:39], v[62:63], v[18:19], v[38:39] op_sel_hi:[1,0,1]
    s_waitcnt lgkmcnt(4)
    v_pk_fma_f32 v[32:33], v[64:65], v[20:21], v[32:33] op_sel_hi:[1,0,1]
    v_pk_fma_f32 v[34:35], v[66:67], v[20:21], v[34:35] op_sel_hi:[1,0,1]
    s_waitcnt lgkmcnt(3)
    v_pk_fma_f32 v[36:37], v[68:69], v[22:23], v[36:37] op_sel_hi:[1,0,1]
    v_pk_fma_f32 v[38:39], v[70:71], v[22:23], v[38:39] op_sel_hi:[1,0,1]
    s_waitcnt lgkmcnt(2)
    v_pk_fma_f32 v[32:33], v[72:73], v[24:25], v[32:33] op_sel_hi:[1,0,1]
    v_pk_fma_f32 v[34:35], v[74:75], v[24:25], v[34:35] op_sel_hi:[1,0,1]
    s_waitcnt lgkmcnt(1)
    v_pk_fma_f32 v[36:37], v[76:77], v[26:27], v[36:37] op_sel_hi:[1,0,1]
    v_pk_fma_f32 v[38:39], v[78:79], v[26:27], v[38:39] op_sel_hi:[1,0,1]
    s_waitcnt lgkmcnt(0)
    v_pk_fma_f32 v[32:33], v[80:81], v[28:29], v[32:33] op_sel_hi:[1,0,1]
    v_pk_fma_f32 v[34:35], v[82:83], v[28:29], v[34:35] op_sel_hi:[1,0,1]
    v_pk_add_f32 v[32:33], v[32:33], v[36:37]
    v_pk_add_f32 v[34:35], v[34:35], v[38:39]
    v_cvt_pk_bf16_f32 v4, v32, v33
    v_cvt_pk_bf16_f32 v5, v34, v35
    s_mov_b64 exec, 0xffffffff
    buffer_store_dwordx4 v[4:7], v2, s[36:39], 0 offen
    s_cmp_eq_u32 s97, 0
    s_cbranch_scc1 AF_26
    buffer_store_dwordx4 v[4:7], v2, s[36:39], 0 offen sc1
AF_26:
    s_mov_b64 exec, -1
    s_endpgm
.p2align 12
L_W:
    s_waitcnt lgkmcnt(0)
    s_mov_b32 s92, 0x05040100
    s_mov_b32 s93, 0x07060302
    s_mov_b32 s36, s34
    s_and_b32 s37, s35, 0xffff
    s_mov_b32 s38, 0x1000000
    s_mov_b32 s39, 0x20000
    s_mov_b32 s40, s32
    s_and_b32 s41, s33, 0xffff
    s_mov_b32 s42, 0x100
    s_mov_b32 s43, 0x20000
    s_barrier
    s_cmp_eq_u32 s3, 0
    s_cbranch_scc1 LT_U1
LR_U1:
    s_cmp_eq_u32 s3, 1
    s_cbranch_scc1 LT_W2R
LR_W2R:
    s_cmp_ge_u32 s5, 4
    s_cbranch_scc1 L_PF
    v_mov_b32 v160, 0x24048
    s_mov_b32 s80, 1600000
LW_27:
    ds_read_b32 v161, v160
    s_waitcnt lgkmcnt(0)
    v_readfirstlane_b32 s79, v161
    s_cmp_ge_u32 s79, 4
    s_cbranch_scc1 LWD_28
    s_sleep 4
    s_sub_u32 s80, s80, 1
    s_cmp_lg_u32 s80, 0
    s_cbranch_scc1 LW_27
LWD_28:
    s_branch L_U1
L_PF:
    s_mov_b32 s44, s20
    s_and_b32 s45, s21, 0xffff
    s_mov_b32 s46, 0x1000000
    s_mov_b32 s47, 0x20000
    s_lshl_b32 s7, s4, 2
    s_add_u32 s7, s7, s5
    s_sub_u32 s7, s7, 4
    s_lshl_b32 s7, s7, 19
    s_lshl_b32 s60, s3, 10
    s_add_u32 s60, s60, s7
    s_add_u32 s60, s60, 196608
    s_add_u32 s61, s60, 0x40000
    v_lshlrev_b32 v2, 4, v1
    v_mov_b32 v160, 0x24048
    s_mov_b32 s80, 1600000
LW_29:
    ds_read_b32 v161, v160
    s_waitcnt lgkmcnt(0)
    v_readfirstlane_b32 s79, v161
    s_cmp_ge_u32 s79, 4
    s_cbranch_scc1 LWD_30
    s_sleep 4
    s_sub_u32 s80, s80, 1
    s_cmp_lg_u32 s80, 0
    s_cbranch_scc1 LW_29
LWD_30:
    s_mov_b32 s62, 16
PF_31:
    s_waitcnt vmcnt(7)
    buffer_load_dwordx4 v[4:7], v2, s[44:47], s60 offen
    s_add_u32 s60, s60, 4096
    s_waitcnt vmcnt(7)
    buffer_load_dwordx4 v[4:7], v2, s[44:47], s61 offen
    s_add_u32 s61, s61, 4096
    s_sub_u32 s62, s62, 1
    s_cmp_lg_u32 s62, 0
    s_cbranch_scc1 PF_31
    v_mov_b32 v160, 0x2405c
    v_mov_b32 v161, 1
    s_waitcnt lgkmcnt(0)
    s_mov_b64 exec, 1
    ds_add_u32 v160, v161
    s_mov_b64 exec, -1
    s_waitcnt vmcnt(0)
    s_branch L_END
L_W1:
    s_waitcnt lgkmcnt(0)
    s_mov_b32 s92, 0x05040100
    s_mov_b32 s93, 0x07060302
    s_mov_b32 s36, s34
    s_and_b32 s37, s35, 0xffff
    s_mov_b32 s38, 0x1000000
    s_mov_b32 s39, 0x20000
    s_mov_b32 s40, s32
    s_and_b32 s41, s33, 0xffff
    s_mov_b32 s42, 0x100
    s_mov_b32 s43, 0x20000
    s_setprio 3
    s_barrier
    s_cmp_lg_u32 s3, 4
    s_cbranch_scc1 W4_32
    s_sleep 8
    v_mov_b32 v152, 0
    s_mov_b32 s80, 200000
    s_mov_b64 exec, 1
    buffer_load_dwordx2 v[156:157], v152, s[40:43], 0 offen sc1
    s_sleep 16
    buffer_load_dwordx2 v[154:155], v152, s[40:43], 0 offen sc1
    s_mov_b64 exec, -1
    s_waitcnt vmcnt(1)
    v_readfirstlane_b32 s94, v156
    v_readfirstlane_b32 s95, v157
    s_cmp_lg_u32 s95, 0
    s_cbranch_scc1 NGD_34
    s_branch NG2_35
NG_33:
    s_mov_b64 exec, 1
    buffer_load_dwordx2 v[154:155], v152, s[40:43], 0 offen sc1
    s_mov_b64 exec, -1
NG2_35:
    s_waitcnt vmcnt(0)
    v_readfirstlane_b32 s94, v154
    v_readfirstlane_b32 s95, v155
    s_cmp_lg_u32 s95, 0
    s_cbranch_scc1 NGD_34
    s_sleep 4
    s_sub_u32 s80, s80, 1
    s_cmp_lg_u32 s80, 0
    s_cbranch_scc1 NG_33
NGD_34:
    v_mov_b32 v160, 0x24050
    v_mov_b32 v162, s94
    v_mov_b32 v163, s95
    ds_write_b64 v160, v[162:163]
    v_mov_b32 v160, 0x2404c
    v_mov_b32 v161, 1
    s_waitcnt lgkmcnt(0)
    s_mov_b64 exec, 1
    ds_add_u32 v160, v161
    s_mov_b64 exec, -1
    s_getreg_b32 s96, hwreg(HW_REG_XCC_ID, 0, 4)
    s_lshl_b32 s7, s4, 5
    s_add_u32 s7, s7, s5
    s_lshl_b32 s7, s7, 4
    s_add_u32 s7, s7, 0xc0000
    v_mov_b32 v160, s7
    v_mov_b32 v162, s96
    v_mov_b32 v163, 0
    v_mov_b32 v164, s94
    v_mov_b32 v165, s95
    s_mov_b64 exec, 1
    buffer_store_dwordx4 v[162:165], v160, s[36:39], 0 offen
    s_mov_b64 exec, -1
W4_32:
    s_sub_u32 s62, s3, 4
    s_lshl_b32 s61, s4, 2
    s_add_u32 s61, s61, s62
    v_lshrrev_b32 v162, 4, v1
    v_and_b32 v161, 15, v1
    v_lshlrev_b32 v2, 16, v162
    v_lshl_add_u32 v2, v161, 4, v2
    s_lshl_b32 s7, s61, 3
    s_add_u32 s7, s7, s5
    s_lshl_b32 s7, s7, 8
    s_add_u32 s7, s7, 0x0
    v_add_u32 v2, s7, v2
    v_lshlrev_b32 v3, 6, v161
    v_lshl_add_u32 v3, v162, 4, v3
    s_lshl_b32 s7, s61, 13
    s_add_u32 s7, s7, 0x40000
    v_add_u32 v3, s7, v3
    v_xor_b32 v5, v162, v161
    v_lshlrev_b32 v5, 4, v5
    v_lshl_add_u32 v4, v161, 12, v5
    s_lshl_b32 s7, s62, 8
    v_add_u32 v4, s7, v4
    v_mov_b32 v160, 0x2404c
    s_mov_b32 s80, 1600000
LW_36:
    ds_read_b32 v161, v160
    s_waitcnt lgkmcnt(0)
    v_readfirstlane_b32 s79, v161
    s_cmp_ge_u32 s79, 1
    s_cbranch_scc1 LWD_37
    s_sleep 2
    s_sub_u32 s80, s80, 1
    s_cmp_lg_u32 s80, 0
    s_cbranch_scc1 LW_36
LWD_37:
    v_mov_b32 v160, 0x24050
    ds_read_b64 v[162:163], v160
    s_waitcnt lgkmcnt(0)
    v_readfirstlane_b32 s94, v162
    v_readfirstlane_b32 s95, v163
    s_sleep 4
    s_mov_b32 s63, 4096
    buffer_load_dwordx4 v[72:75], v3, s[36:39], 0 offen offset:0 sc1
    buffer_load_dwordx4 v[76:79], v3, s[36:39], 0 offen offset:1024 sc1
    buffer_load_dwordx4 v[80:83], v3, s[36:39], 0 offen offset:2048 sc1
    buffer_load_dwordx4 v[84:87], v3, s[36:39], 0 offen offset:3072 sc1
    buffer_load_dwordx4 v[88:91], v3, s[36:39], s63 offen offset:0 sc1
    buffer_load_dwordx4 v[92:95], v3, s[36:39], s63 offen offset:1024 sc1
    buffer_load_dwordx4 v[96:99], v3, s[36:39], s63 offen offset:2048 sc1
    buffer_load_dwordx4 v[100:103], v3, s[36:39], s63 offen offset:3072 sc1
    v_mov_b32 v160, 0x24014
    s_mov_b32 s80, 1600000
LW_40:
    ds_read_b32 v161, v160
    s_waitcnt lgkmcnt(0)
    v_readfirstlane_b32 s79, v161
    s_cmp_ge_u32 s79, 4
    s_cbranch_scc1 LWD_41
    s_sleep 1
    s_sub_u32 s80, s80, 1
    s_cmp_lg_u32 s80, 0
    s_cbranch_scc1 LW_40
LWD_41:
    v_xor_b32 v160, 0x0, v4
    v_xor_b32 v161, 0x40, v4
    v_xor_b32 v162, 0x80, v4
    v_xor_b32 v163, 0xc0, v4
    ds_read_b128 v[8:11], v160 offset:0
    ds_read_b128 v[12:15], v161 offset:0
    ds_read_b128 v[16:19], v162 offset:0
    ds_read_b128 v[20:23], v163 offset:0
    ds_read_b128 v[24:27], v160 offset:1024
    ds_read_b128 v[28:31], v161 offset:1024
    ds_read_b128 v[32:35], v162 offset:1024
    ds_read_b128 v[36:39], v163 offset:1024
    ds_read_b128 v[40:43], v160 offset:2048
    ds_read_b128 v[44:47], v161 offset:2048
    ds_read_b128 v[48:51], v162 offset:2048
    ds_read_b128 v[52:55], v163 offset:2048
    ds_read_b128 v[56:59], v160 offset:3072
    ds_read_b128 v[60:63], v161 offset:3072
    ds_read_b128 v[64:67], v162 offset:3072
    ds_read_b128 v[68:71], v163 offset:3072
    s_mov_b32 s80, 200000
PS_38:
    s_waitcnt vmcnt(0)
    s_mov_b32 s78, 0
    v_cmp_ne_u64 vcc, s[94:95], v[74:75]
    s_cbranch_vccz PSS_42
    buffer_load_dwordx4 v[72:75], v3, s[36:39], 0 offen offset:0 sc1
    s_mov_b32 s78, 1
PSS_42:
    v_cmp_ne_u64 vcc, s[94:95], v[78:79]
    s_cbranch_vccz PSS_43
    buffer_load_dwordx4 v[76:79], v3, s[36:39], 0 offen offset:1024 sc1
    s_mov_b32 s78, 1
PSS_43:
    v_cmp_ne_u64 vcc, s[94:95], v[82:83]
    s_cbranch_vccz PSS_44
    buffer_load_dwordx4 v[80:83], v3, s[36:39], 0 offen offset:2048 sc1
    s_mov_b32 s78, 1
PSS_44:
    v_cmp_ne_u64 vcc, s[94:95], v[86:87]
    s_cbranch_vccz PSS_45
    buffer_load_dwordx4 v[84:87], v3, s[36:39], 0 offen offset:3072 sc1
    s_mov_b32 s78, 1
PSS_45:
    v_cmp_ne_u64 vcc, s[94:95], v[90:91]
    s_cbranch_vccz PSS_46
    buffer_load_dwordx4 v[88:91], v3, s[36:39], s63 offen offset:0 sc1
    s_mov_b32 s78, 1
PSS_46:
    v_cmp_ne_u64 vcc, s[94:95], v[94:95]
    s_cbranch_vccz PSS_47
    buffer_load_dwordx4 v[92:95], v3, s[36:39], s63 offen offset:1024 sc1
    s_mov_b32 s78, 1
PSS_47:
    v_cmp_ne_u64 vcc, s[94:95], v[98:99]
    s_cbranch_vccz PSS_48
    buffer_load_dwordx4 v[96:99], v3, s[36:39], s63 offen offset:2048 sc1
    s_mov_b32 s78, 1
PSS_48:
    v_cmp_ne_u64 vcc, s[94:95], v[102:103]
    s_cbranch_vccz PSS_49
    buffer_load_dwordx4 v[100:103], v3, s[36:39], s63 offen offset:3072 sc1
    s_mov_b32 s78, 1
PSS_49:
    s_cmp_eq_u32 s78, 0
    s_cbranch_scc1 PSD_39
    s_sub_u32 s80, s80, 1
    s_cmp_lg_u32 s80, 0
    s_cbranch_scc1 PS_38
    s_waitcnt vmcnt(0)
PSD_39:
    v_lshlrev_b32 v104, 16, v72
    v_and_b32 v105, 0xffff0000, v72
    v_lshlrev_b32 v106, 16, v73
    v_and_b32 v107, 0xffff0000, v73
    v_lshlrev_b32 v108, 16, v76
    v_and_b32 v109, 0xffff0000, v76
    v_lshlrev_b32 v110, 16, v77
    v_and_b32 v111, 0xffff0000, v77
    v_lshlrev_b32 v120, 16, v80
    v_and_b32 v121, 0xffff0000, v80
    v_lshlrev_b32 v122, 16, v81
    v_and_b32 v123, 0xffff0000, v81
    v_lshlrev_b32 v124, 16, v84
    v_and_b32 v125, 0xffff0000, v84
    v_lshlrev_b32 v126, 16, v85
    v_and_b32 v127, 0xffff0000, v85
    v_add_f32 v104, v104, v120
    v_add_f32 v105, v105, v121
    v_add_f32 v106, v106, v122
    v_add_f32 v107, v107, v123
    v_add_f32 v108, v108, v124
    v_add_f32 v109, v109, v125
    v_add_f32 v110, v110, v126
    v_add_f32 v111, v111, v127
    v_lshlrev_b32 v112, 16, v88
    v_and_b32 v113, 0xffff0000, v88
    v_lshlrev_b32 v114, 16, v89
    v_and_b32 v115, 0xffff0000, v89
    v_lshlrev_b32 v116, 16, v92
    v_and_b32 v117, 0xffff0000, v92
    v_lshlrev_b32 v118, 16, v93
    v_and_b32 v119, 0xffff0000, v93
    v_add_f32 v104, v104, v112
    v_add_f32 v105, v105, v113
    v_add_f32 v106, v106, v114
    v_add_f32 v107, v107, v115
    v_add_f32 v108, v108, v116
    v_add_f32 v109, v109, v117
    v_add_f32 v110, v110, v118
    v_add_f32 v111, v111, v119
    v_lshlrev_b32 v120, 16, v96
    v_and_b32 v121, 0xffff0000, v96
    v_lshlrev_b32 v122, 16, v97
    v_and_b32 v123, 0xffff0000, v97
    v_lshlrev_b32 v124, 16, v100
    v_and_b32 v125, 0xffff0000, v100
    v_lshlrev_b32 v126, 16, v101
    v_and_b32 v127, 0xffff0000, v101
    v_add_f32 v104, v104, v120
    v_add_f32 v105, v105, v121
    v_add_f32 v106, v106, v122
    v_add_f32 v107, v107, v123
    v_add_f32 v108, v108, v124
    v_add_f32 v109, v109, v125
    v_add_f32 v110, v110, v126
    v_add_f32 v111, v111, v127
    v_cvt_pk_bf16_f32 v136, v104, v105
    v_cvt_pk_bf16_f32 v137, v106, v107
    v_cvt_pk_bf16_f32 v138, v108, v109
    v_cvt_pk_bf16_f32 v139, v110, v111
    v_mov_b32_dpp v140, v136 quad_perm:[1,2,3,0] row_mask:0xf bank_mask:0xf
    v_mov_b32_dpp v141, v137 quad_perm:[1,2,3,0] row_mask:0xf bank_mask:0xf
    v_mov_b32_dpp v142, v138 quad_perm:[1,2,3,0] row_mask:0xf bank_mask:0xf
    v_mov_b32_dpp v143, v139 quad_perm:[1,2,3,0] row_mask:0xf bank_mask:0xf
    v_mov_b32_dpp v144, v136 quad_perm:[2,3,0,1] row_mask:0xf bank_mask:0xf
    v_mov_b32_dpp v145, v137 quad_perm:[2,3,0,1] row_mask:0xf bank_mask:0xf
    v_mov_b32_dpp v146, v138 quad_perm:[2,3,0,1] row_mask:0xf bank_mask:0xf
    v_mov_b32_dpp v147, v139 quad_perm:[2,3,0,1] row_mask:0xf bank_mask:0xf
    v_mov_b32_dpp v148, v136 quad_perm:[3,0,1,2] row_mask:0xf bank_mask:0xf
    v_mov_b32_dpp v149, v137 quad_perm:[3,0,1,2] row_mask:0xf bank_mask:0xf
    v_mov_b32_dpp v150, v138 quad_perm:[3,0,1,2] row_mask:0xf bank_mask:0xf
    v_mov_b32_dpp v151, v139 quad_perm:[3,0,1,2] row_mask:0xf bank_mask:0xf
    v_mov_b32 v74, s94
    v_mov_b32 v75, s95
    s_waitcnt lgkmcnt(0)
    v_mfma_f32_16x16x32_bf16 v[104:107], v[136:139], v[8:11], 0
    v_mfma_f32_16x16x32_bf16 v[108:111], v[136:139], v[28:31], 0
    v_mfma_f32_16x16x32_bf16 v[112:115], v[136:139], v[48:51], 0
    v_mfma_f32_16x16x32_bf16 v[116:119], v[136:139], v[68:71], 0
    v_mfma_f32_16x16x32_bf16 v[104:107], v[140:143], v[12:15], v[104:107]
    v_mfma_f32_16x16x32_bf16 v[108:111], v[140:143], v[32:35], v[108:111]
    v_mfma_f32_16x16x32_bf16 v[112:115], v[140:143], v[52:55], v[112:115]
    v_mfma_f32_16x16x32_bf16 v[116:119], v[140:143], v[56:59], v[116:119]
    v_mfma_f32_16x16x32_bf16 v[104:107], v[144:147], v[16:19], v[104:107]
    v_mfma_f32_16x16x32_bf16 v[108:111], v[144:147], v[36:39], v[108:111]
    v_mfma_f32_16x16x32_bf16 v[112:115], v[144:147], v[40:43], v[112:115]
    v_mfma_f32_16x16x32_bf16 v[116:119], v[144:147], v[60:63], v[116:119]
    v_mfma_f32_16x16x32_bf16 v[104:107], v[148:151], v[20:23], v[104:107]
    v_mfma_f32_16x16x32_bf16 v[108:111], v[148:151], v[24:27], v[108:111]
    v_mfma_f32_16x16x32_bf16 v[112:115], v[148:151], v[44:47], v[112:115]
    v_mfma_f32_16x16x32_bf16 v[116:119], v[148:151], v[64:67], v[116:119]
    s_nop 5
    v_cvt_pk_bf16_f32 v72, v104, v109
    s_nop 0
    v_cvt_pk_bf16_f32 v73, v114, v119
    buffer_store_dwordx4 v[72:75], v2, s[36:39], 0 offen sc1
    v_mov_b32 v160, 0x24048
    v_mov_b32 v161, 1
    s_waitcnt lgkmcnt(0)
    s_mov_b64 exec, 1
    ds_add_u32 v160, v161
    s_mov_b64 exec, -1
    s_setprio 0
    s_cmp_ge_u32 s5, 4
    s_cbranch_scc1 L_END
    s_branch L_U1
L_CSVC:
    s_cmp_lg_u32 s3, 11
    s_cbranch_scc1 Z_100
    v_lshlrev_b32 v2, 2, v1
    v_add_u32 v2, 0x24000, v2
    v_mov_b32 v3, 0
    ds_write_b32 v2, v3
Z_100:
    s_waitcnt lgkmcnt(0)
    s_mov_b32 s92, 0x05040100
    s_mov_b32 s93, 0x07060302
    s_mov_b32 s36, s34
    s_and_b32 s37, s35, 0xffff
    s_mov_b32 s38, 0x1000000
    s_mov_b32 s39, 0x20000
    s_mov_b32 s40, s32
    s_and_b32 s41, s33, 0xffff
    s_mov_b32 s42, 0x100
    s_mov_b32 s43, 0x20000
    s_setprio 3
    s_sub_u32 s60, s3, 8
    s_lshl_b32 s64, s4, 3
    s_add_u32 s64, s64, s5
    s_sub_u32 s64, s64, 8
    v_lshlrev_b32 v2, 4, v1
    s_barrier
    s_cmp_eq_u32 s3, 9
    s_cbranch_scc1 LT_CR
LR_CR:
    s_cmp_eq_u32 s3, 10
    s_cbranch_scc1 LT_CR2
LR_CR2:
    s_cmp_lg_u32 s60, 0
    s_cbranch_scc1 C8_101
    s_sleep 24
    v_mov_b32 v160, 0
    s_mov_b32 s80, 200000
NG_102:
    s_mov_b64 exec, 1
    buffer_load_dwordx2 v[162:163], v160, s[40:43], 0 offen sc1
    s_mov_b64 exec, -1
    s_waitcnt vmcnt(0)
    v_readfirstlane_b32 s94, v162
    v_readfirstlane_b32 s95, v163
    s_cmp_lg_u32 s95, 0
    s_cbranch_scc1 NGD_103
    s_sleep 4
    s_sub_u32 s80, s80, 1
    s_cmp_lg_u32 s80, 0
    s_cbranch_scc1 NG_102
NGD_103:
    v_mov_b32 v160, 0x24050
    v_mov_b32 v162, s94
    v_mov_b32 v163, s95
    ds_write_b64 v160, v[162:163]
    v_mov_b32 v160, 0x2404c
    v_mov_b32 v161, 1
    s_waitcnt lgkmcnt(0)
    s_mov_b64 exec, 1
    ds_add_u32 v160, v161
    s_mov_b64 exec, -1
C8_101:
    s_lshr_b32 s7, s64, 4
    s_lshl_b32 s7, s7, 16
    s_lshl_b32 s63, s60, 14
    s_add_u32 s7, s7, s63
    s_add_u32 s7, s7, 0x0
    v_lshl_add_u32 v4, v1, 4, s7
    s_and_b32 s7, s60, 1
    s_lshl_b32 s7, s7, 7
    v_lshlrev_b32 v3, 3, v1
    v_xor_b32 v3, s7, v3
    s_lshl_b32 s7, s60, 13
    s_add_u32 s7, s7, 0x18000
    v_add_u32 v3, s7, v3
    v_mov_b32 v160, 0x2404c
    s_mov_b32 s80, 1600000
LW_104:
    ds_read_b32 v161, v160
    s_waitcnt lgkmcnt(0)
    v_readfirstlane_b32 s79, v161
    s_cmp_ge_u32 s79, 1
    s_cbranch_scc1 LWD_105
    s_sleep 4
    s_sub_u32 s80, s80, 1
    s_cmp_lg_u32 s80, 0
    s_cbranch_scc1 LW_104
LWD_105:
    v_mov_b32 v160, 0x24050
    ds_read_b64 v[162:163], v160
    s_waitcnt lgkmcnt(0)
    v_readfirstlane_b32 s94, v162
    v_readfirstlane_b32 s95, v163
    v_mov_b32 v160, 0x24018
    s_mov_b32 s80, 1600000
LW_106:
    ds_read_b32 v161, v160
    s_waitcnt lgkmcnt(0)
    v_readfirstlane_b32 s79, v161
    s_cmp_ge_u32 s79, 8
    s_cbranch_scc1 LWD_107
    s_sleep 2
    s_sub_u32 s80, s80, 1
    s_cmp_lg_u32 s80, 0
    s_cbranch_scc1 LW_106
LWD_107:
    s_sleep 1
    s_mov_b32 s67, 4096
    s_mov_b32 s68, 8192
    s_mov_b32 s69, 12288
    buffer_load_dwordx4 v[96:99], v4, s[36:39], 0 offen offset:0 sc1
    buffer_load_dwordx4 v[100:103], v4, s[36:39], 0 offen offset:1024 sc1
    buffer_load_dwordx4 v[104:107], v4, s[36:39], 0 offen offset:2048 sc1
    buffer_load_dwordx4 v[108:111], v4, s[36:39], 0 offen offset:3072 sc1
    buffer_load_dwordx4 v[112:115], v4, s[36:39], s67 offen offset:0 sc1
    buffer_load_dwordx4 v[116:119], v4, s[36:39], s67 offen offset:1024 sc1
    buffer_load_dwordx4 v[120:123], v4, s[36:39], s67 offen offset:2048 sc1
    buffer_load_dwordx4 v[124:127], v4, s[36:39], s67 offen offset:3072 sc1
    buffer_load_dwordx4 v[128:131], v4, s[36:39], s68 offen offset:0 sc1
    buffer_load_dwordx4 v[132:135], v4, s[36:39], s68 offen offset:1024 sc1
    buffer_load_dwordx4 v[136:139], v4, s[36:39], s68 offen offset:2048 sc1
    buffer_load_dwordx4 v[140:143], v4, s[36:39], s68 offen offset:3072 sc1
    buffer_load_dwordx4 v[144:147], v4, s[36:39], s69 offen offset:0 sc1
    buffer_load_dwordx4 v[148:151], v4, s[36:39], s69 offen offset:1024 sc1
    buffer_load_dwordx4 v[152:155], v4, s[36:39], s69 offen offset:2048 sc1
    buffer_load_dwordx4 v[156:159], v4, s[36:39], s69 offen offset:3072 sc1
    s_mov_b32 s80, 200000
PS_108:
    s_waitcnt vmcnt(0)
    s_mov_b32 s78, 0
    v_cmp_ne_u64 vcc, s[94:95], v[98:99]
    s_cbranch_vccz PSS_110
    buffer_load_dwordx4 v[96:99], v4, s[36:39], 0 offen offset:0 sc1
    s_mov_b32 s78, 1
PSS_110:
    v_cmp_ne_u64 vcc, s[94:95], v[102:103]
    s_cbranch_vccz PSS_111
    buffer_load_dwordx4 v[100:103], v4, s[36:39], 0 offen offset:1024 sc1
    s_mov_b32 s78, 1
PSS_111:
    v_cmp_ne_u64 vcc, s[94:95], v[106:107]
    s_cbranch_vccz PSS_112
    buffer_load_dwordx4 v[104:107], v4, s[36:39], 0 offen offset:2048 sc1
    s_mov_b32 s78, 1
PSS_112:
    v_cmp_ne_u64 vcc, s[94:95], v[110:111]
    s_cbranch_vccz PSS_113
    buffer_load_dwordx4 v[108:111], v4, s[36:39], 0 offen offset:3072 sc1
    s_mov_b32 s78, 1
PSS_113:
    v_cmp_ne_u64 vcc, s[94:95], v[114:115]
    s_cbranch_vccz PSS_114
    buffer_load_dwordx4 v[112:115], v4, s[36:39], s67 offen offset:0 sc1
    s_mov_b32 s78, 1
PSS_114:
    v_cmp_ne_u64 vcc, s[94:95], v[118:119]
    s_cbranch_vccz PSS_115
    buffer_load_dwordx4 v[116:119], v4, s[36:39], s67 offen offset:1024 sc1
    s_mov_b32 s78, 1
PSS_115:
    v_cmp_ne_u64 vcc, s[94:95], v[122:123]
    s_cbranch_vccz PSS_116
    buffer_load_dwordx4 v[120:123], v4, s[36:39], s67 offen offset:2048 sc1
    s_mov_b32 s78, 1
PSS_116:
    v_cmp_ne_u64 vcc, s[94:95], v[126:127]
    s_cbranch_vccz PSS_117
    buffer_load_dwordx4 v[124:127], v4, s[36:39], s67 offen offset:3072 sc1
    s_mov_b32 s78, 1
PSS_117:
    v_cmp_ne_u64 vcc, s[94:95], v[130:131]
    s_cbranch_vccz PSS_118
    buffer_load_dwordx4 v[128:131], v4, s[36:39], s68 offen offset:0 sc1
    s_mov_b32 s78, 1
PSS_118:
    v_cmp_ne_u64 vcc, s[94:95], v[134:135]
    s_cbranch_vccz PSS_119
    buffer_load_dwordx4 v[132:135], v4, s[36:39], s68 offen offset:1024 sc1
    s_mov_b32 s78, 1
PSS_119:
    v_cmp_ne_u64 vcc, s[94:95], v[138:139]
    s_cbranch_vccz PSS_120
    buffer_load_dwordx4 v[136:139], v4, s[36:39], s68 offen offset:2048 sc1
    s_mov_b32 s78, 1
PSS_120:
    v_cmp_ne_u64 vcc, s[94:95], v[142:143]
    s_cbranch_vccz PSS_121
    buffer_load_dwordx4 v[140:143], v4, s[36:39], s68 offen offset:3072 sc1
    s_mov_b32 s78, 1
PSS_121:
    v_cmp_ne_u64 vcc, s[94:95], v[146:147]
    s_cbranch_vccz PSS_122
    buffer_load_dwordx4 v[144:147], v4, s[36:39], s69 offen offset:0 sc1
    s_mov_b32 s78, 1
PSS_122:
    v_cmp_ne_u64 vcc, s[94:95], v[150:151]
    s_cbranch_vccz PSS_123
    buffer_load_dwordx4 v[148:151], v4, s[36:39], s69 offen offset:1024 sc1
    s_mov_b32 s78, 1
PSS_123:
    v_cmp_ne_u64 vcc, s[94:95], v[154:155]
    s_cbranch_vccz PSS_124
    buffer_load_dwordx4 v[152:155], v4, s[36:39], s69 offen offset:2048 sc1
    s_mov_b32 s78, 1
PSS_124:
    v_cmp_ne_u64 vcc, s[94:95], v[158:159]
    s_cbranch_vccz PSS_125
    buffer_load_dwordx4 v[156:159], v4, s[36:39], s69 offen offset:3072 sc1
    s_mov_b32 s78, 1
PSS_125:
    s_cmp_eq_u32 s78, 0
    s_cbranch_scc1 PSD_109
    s_sub_u32 s80, s80, 1
    s_cmp_lg_u32 s80, 0
    s_cbranch_scc1 PS_108
    s_waitcnt vmcnt(0)
PSD_109:
    v_xor_b32 v6, 0x0, v3
    ds_write_b64 v6, v[96:97] offset:0
    ds_write_b64 v6, v[100:101] offset:512
    v_xor_b32 v7, 0x10, v3
    ds_write_b64 v7, v[104:105] offset:1024
    ds_write_b64 v7, v[108:109] offset:1536
    v_xor_b32 v6, 0x20, v3
    ds_write_b64 v6, v[112:113] offset:2048
    ds_write_b64 v6, v[116:117] offset:2560
    v_xor_b32 v7, 0x30, v3
    ds_write_b64 v7, v[120:121] offset:3072
    ds_write_b64 v7, v[124:125] offset:3584
    v_xor_b32 v6, 0x40, v3
    ds_write_b64 v6, v[128:129] offset:4096
    ds_write_b64 v6, v[132:133] offset:4608
    v_xor_b32 v7, 0x50, v3
    ds_write_b64 v7, v[136:137] offset:5120
    ds_write_b64 v7, v[140:141] offset:5632
    v_xor_b32 v6, 0x60, v3
    ds_write_b64 v6, v[144:145] offset:6144
    ds_write_b64 v6, v[148:149] offset:6656
    v_xor_b32 v7, 0x70, v3
    ds_write_b64 v7, v[152:153] offset:7168
    ds_write_b64 v7, v[156:157] offset:7680
L_CCUT:
    s_waitcnt lgkmcnt(0)
    s_barrier
    s_endpgm
.p2align 12
LT_U1:
    s_branch LR_U1
L_U1:
    s_mov_b32 s48, s26
    s_and_b32 s49, s27, 0xffff
    s_mov_b32 s50, 0x400000
    s_mov_b32 s51, 0x20000
    v_lshrrev_b32 v162, 4, v1
    v_lshlrev_b32 v2, 16, v162
    v_and_b32 v160, 15, v1
    v_lshl_add_u32 v2, v160, 4, v2
    s_lshl_b32 s7, s6, 8
    v_add_u32 v2, s7, v2
    s_lshl_b32 s70, s3, 19
    s_waitcnt vmcnt(2)
    buffer_load_dwordx4 v[8:11], v2, s[48:51], s70 offen nt
    s_add_u32 s70, s70, 8192
    s_waitcnt vmcnt(2)
    buffer_load_dwordx4 v[12:15], v2, s[48:51], s70 offen nt
    s_add_u32 s70, s70, 8192
    s_waitcnt vmcnt(2)
    buffer_load_dwordx4 v[16:19], v2, s[48:51], s70 offen nt
    s_add_u32 s70, s70, 8192
    s_waitcnt vmcnt(2)
    buffer_load_dwordx4 v[20:23], v2, s[48:51], s70 offen nt
    s_add_u32 s70, s70, 8192
    s_waitcnt vmcnt(2)
    buffer_load_dwordx4 v[24:27], v2, s[48:51], s70 offen nt
    s_add_u32 s70, s70, 8192
    s_waitcnt vmcnt(2)
    buffer_load_dwordx4 v[28:31], v2, s[48:51], s70 offen nt
    s_add_u32 s70, s70, 8192
    s_waitcnt vmcnt(2)
    buffer_load_dwordx4 v[32:35], v2, s[48:51], s70 offen nt
    s_add_u32 s70, s70, 8192
    s_waitcnt vmcnt(2)
    buffer_load_dwordx4 v[36:39], v2, s[48:51], s70 offen nt
    s_add_u32 s70, s70, 204800
    s_waitcnt vmcnt(2)
    buffer_load_dwordx4 v[104:107], v2, s[48:51], s70 offen nt
    s_add_u32 s70, s70, 8192
    s_waitcnt vmcnt(2)
    buffer_load_dwordx4 v[108:111], v2, s[48:51], s70 offen nt
    s_add_u32 s70, s70, 8192
    s_waitcnt vmcnt(2)
    buffer_load_dwordx4 v[112:115], v2, s[48:51], s70 offen nt
    s_add_u32 s70, s70, 8192
    s_waitcnt vmcnt(2)
    buffer_load_dwordx4 v[116:119], v2, s[48:51], s70 offen nt
    s_add_u32 s70, s70, 8192
    s_waitcnt vmcnt(2)
    buffer_load_dwordx4 v[120:123], v2, s[48:51], s70 offen nt
    s_add_u32 s70, s70, 8192
    s_waitcnt vmcnt(2)
    buffer_load_dwordx4 v[124:127], v2, s[48:51], s70 offen nt
    s_add_u32 s70, s70, 8192
    s_waitcnt vmcnt(2)
    buffer_load_dwordx4 v[128:131], v2, s[48:51], s70 offen nt
    s_add_u32 s70, s70, 8192
    s_waitcnt vmcnt(2)
    buffer_load_dwordx4 v[132:135], v2, s[48:51], s70 offen nt
    s_add_u32 s70, s70, 204800
    v_lshlrev_b32 v3, 4, v1
    v_add_u32 v3, 0x24800, v3
    v_lshrrev_b32 v4, 1, v160
    v_lshlrev_b32 v4, 18, v4
    v_lshl_add_u32 v4, v162, 4, v4
    v_and_b32 v163, 1, v1
    v_lshl_add_u32 v4, v163, 6, v4
    v_cmp_eq_u32 s[86:87], 1, v163
    s_lshl_b32 s7, s3, 5
    s_add_u32 s7, s7, s6
    s_lshl_b32 s7, s7, 7
    s_add_u32 s7, s7, 0x500000
    v_add_u32 v4, s7, v4
    s_lshl_b32 s7, s3, 11
    s_add_u32 s7, s7, 0x10000
    v_lshl_add_u32 v5, v1, 5, s7
    v_perm_b32 v40, v12, v8, s92
    v_perm_b32 v41, v20, v16, s92
    v_perm_b32 v42, v28, v24, s92
    v_perm_b32 v43, v36, v32, s92
    v_perm_b32 v44, v12, v8, s93
    v_perm_b32 v45, v20, v16, s93
    v_perm_b32 v46, v28, v24, s93
    v_perm_b32 v47, v36, v32, s93
    v_perm_b32 v48, v13, v9, s92
    v_perm_b32 v49, v21, v17, s92
    v_perm_b32 v50, v29, v25, s92
    v_perm_b32 v51, v37, v33, s92
    v_perm_b32 v52, v13, v9, s93
    v_perm_b32 v53, v21, v17, s93
    v_perm_b32 v54, v29, v25, s93
    v_perm_b32 v55, v37, v33, s93
    v_perm_b32 v56, v14, v10, s92
    v_perm_b32 v57, v22, v18, s92
    v_perm_b32 v58, v30, v26, s92
    v_perm_b32 v59, v38, v34, s92
    v_perm_b32 v60, v14, v10, s93
    v_perm_b32 v61, v22, v18, s93
    v_perm_b32 v62, v30, v26, s93
    v_perm_b32 v63, v38, v34, s93
    v_perm_b32 v64, v15, v11, s92
    v_perm_b32 v65, v23, v19, s92
    v_perm_b32 v66, v31, v27, s92
    v_perm_b32 v67, v39, v35, s92
    v_perm_b32 v68, v15, v11, s93
    v_perm_b32 v69, v23, v19, s93
    v_perm_b32 v70, v31, v27, s93
    v_perm_b32 v71, v39, v35, s93
    s_waitcnt vmcnt(0)
    v_perm_b32 v72, v108, v104, s92
    v_perm_b32 v73, v116, v112, s92
    v_perm_b32 v74, v124, v120, s92
    v_perm_b32 v75, v132, v128, s92
    v_perm_b32 v76, v108, v104, s93
    v_perm_b32 v77, v116, v112, s93
    v_perm_b32 v78, v124, v120, s93
    v_perm_b32 v79, v132, v128, s93
    v_perm_b32 v80, v109, v105, s92
    v_perm_b32 v81, v117, v113, s92
    v_perm_b32 v82, v125, v121, s92
    v_perm_b32 v83, v133, v129, s92
    v_perm_b32 v84, v109, v105, s93
    v_perm_b32 v85, v117, v113, s93
    v_perm_b32 v86, v125, v121, s93
    v_perm_b32 v87, v133, v129, s93
    v_perm_b32 v88, v110, v106, s92
    v_perm_b32 v89, v118, v114, s92
    v_perm_b32 v90, v126, v122, s92
    v_perm_b32 v91, v134, v130, s92
    v_perm_b32 v92, v110, v106, s93
    v_perm_b32 v93, v118, v114, s93
    v_perm_b32 v94, v126, v122, s93
    v_perm_b32 v95, v134, v130, s93
    v_perm_b32 v96, v111, v107, s92
    v_perm_b32 v97, v119, v115, s92
    v_perm_b32 v98, v127, v123, s92
    v_perm_b32 v99, v135, v131, s92
    v_perm_b32 v100, v111, v107, s93
    v_perm_b32 v101, v119, v115, s93
    v_perm_b32 v102, v127, v123, s93
    v_perm_b32 v103, v135, v131, s93
    v_mov_b32 v160, 0x2404c
    s_mov_b32 s80, 1600000
LW_50:
    ds_read_b32 v161, v160
    s_waitcnt lgkmcnt(0)
    v_readfirstlane_b32 s79, v161
    s_cmp_ge_u32 s79, 1
    s_cbranch_scc1 LWD_51
    s_sleep 2
    s_sub_u32 s80, s80, 1
    s_cmp_lg_u32 s80, 0
    s_cbranch_scc1 LW_50
LWD_51:
    v_mov_b32 v160, 0x24050
    ds_read_b64 v[162:163], v160
    s_waitcnt lgkmcnt(0)
    v_readfirstlane_b32 s94, v162
    v_readfirstlane_b32 s95, v163
    v_mov_b32 v160, 0x2401c
    s_mov_b32 s80, 1600000
LW_52:
    ds_read_b32 v161, v160
    s_waitcnt lgkmcnt(0)
    v_readfirstlane_b32 s79, v161
    s_cmp_ge_u32 s79, 1
    s_cbranch_scc1 LWD_53
    s_sleep 4
    s_sub_u32 s80, s80, 1
    s_cmp_lg_u32 s80, 0
    s_cbranch_scc1 LW_52
LWD_53:
    s_setprio 3
    s_mov_b64 s[88:89], 0
    s_mov_b32 s80, 1600000
UM_54:
    ds_read_b128 v[136:139], v3
    s_waitcnt lgkmcnt(0)
    v_cmp_ne_u64 vcc, s[94:95], v[138:139]
    s_or_b64 s[90:91], vcc, s[88:89]
    s_and_b32 s7, s90, 0x5555
    s_cbranch_scc1 UMS_56
    s_mov_b32 s70, 0
    buffer_load_dwordx4 v[8:11], v4, s[36:39], s70 offen sc1
    s_or_b32 s88, s88, 0x5555
UMS_56:
    s_and_b32 s7, s90, 0x55550000
    s_cbranch_scc1 UMS_57
    s_mov_b32 s70, 32768
    buffer_load_dwordx4 v[12:15], v4, s[36:39], s70 offen sc1
    s_or_b32 s88, s88, 0x55550000
UMS_57:
    s_and_b32 s7, s91, 0x5555
    s_cbranch_scc1 UMS_58
    s_mov_b32 s70, 65536
    buffer_load_dwordx4 v[16:19], v4, s[36:39], s70 offen sc1
    s_or_b32 s89, s89, 0x5555
UMS_58:
    s_and_b32 s7, s91, 0x55550000
    s_cbranch_scc1 UMS_59
    s_mov_b32 s70, 98304
    buffer_load_dwordx4 v[20:23], v4, s[36:39], s70 offen sc1
    s_or_b32 s89, s89, 0x55550000
UMS_59:
    s_and_b32 s7, s90, 0xaaaa
    s_cbranch_scc1 UMS_60
    s_mov_b32 s70, 131072
    buffer_load_dwordx4 v[24:27], v4, s[36:39], s70 offen sc1
    s_or_b32 s88, s88, 0xaaaa
UMS_60:
    s_and_b32 s7, s90, 0xaaaa0000
    s_cbranch_scc1 UMS_61
    s_mov_b32 s70, 163840
    buffer_load_dwordx4 v[28:31], v4, s[36:39], s70 offen sc1
    s_or_b32 s88, s88, 0xaaaa0000
UMS_61:
    s_and_b32 s7, s91, 0xaaaa
    s_cbranch_scc1 UMS_62
    s_mov_b32 s70, 196608
    buffer_load_dwordx4 v[32:35], v4, s[36:39], s70 offen sc1
    s_or_b32 s89, s89, 0xaaaa
UMS_62:
    s_and_b32 s7, s91, 0xaaaa0000
    s_cbranch_scc1 UMS_63
    s_mov_b32 s70, 229376
    buffer_load_dwordx4 v[36:39], v4, s[36:39], s70 offen sc1
    s_or_b32 s89, s89, 0xaaaa0000
UMS_63:
    s_cbranch_vccz UMD_55
    s_sleep 1
    s_sub_u32 s80, s80, 1
    s_cmp_lg_u32 s80, 0
    s_cbranch_scc1 UM_54
UMD_55:
    v_max_f32_dpp v138, v136, v136 quad_perm:[1,0,3,2] row_mask:0xf bank_mask:0xf
    s_nop 1
    v_max_f32_dpp v138, v138, v138 quad_perm:[2,3,0,1] row_mask:0xf bank_mask:0xf
    v_mov_b32 v139, v138
    s_nop 1
    v_permlane32_swap_b32 v138, v139
    v_max_f32 v138, v138, v139
    v_mov_b32 v139, v138
    s_nop 1
    v_permlane16_swap_b32 v138, v139
    v_max_f32 v138, v138, v139
    v_sub_f32 v136, v136, v138
    v_exp_f32 v136, v136
    s_nop 0
    v_mul_f32 v137, v137, v136
    s_nop 1
    v_add_f32_dpp v137, v137, v137 quad_perm:[1,0,3,2] row_mask:0xf bank_mask:0xf
    s_nop 1
    v_add_f32_dpp v137, v137, v137 quad_perm:[2,3,0,1] row_mask:0xf bank_mask:0xf
    v_mov_b32 v138, v137
    s_nop 1
    v_permlane32_swap_b32 v137, v138
    v_add_f32 v137, v137, v138
    v_mov_b32 v138, v137
    s_nop 1
    v_permlane16_swap_b32 v137, v138
    v_add_f32 v137, v137, v138
    v_rcp_f32 v137, v137
    s_nop 0
    v_mul_f32 v136, v136, v137
    v_mov_b32 v137, v136
    s_nop 1
    v_permlane16_swap_b32 v136, v137
    v_mov_b32 v138, v136
    v_mov_b32 v139, v137
    s_nop 0
    v_permlane32_swap_b32 v136, v138
    v_permlane32_swap_b32 v137, v139
    s_nop 0
    v_mov_b32_dpp v148, v136 quad_perm:[0,0,2,2] row_mask:0xf bank_mask:0xf
    v_mov_b32_dpp v149, v137 quad_perm:[0,0,2,2] row_mask:0xf bank_mask:0xf
    v_mov_b32_dpp v150, v138 quad_perm:[0,0,2,2] row_mask:0xf bank_mask:0xf
    v_mov_b32_dpp v151, v139 quad_perm:[0,0,2,2] row_mask:0xf bank_mask:0xf
    v_mov_b32_dpp v152, v136 quad_perm:[1,1,3,3] row_mask:0xf bank_mask:0xf
    v_mov_b32_dpp v153, v137 quad_perm:[1,1,3,3] row_mask:0xf bank_mask:0xf
    v_mov_b32_dpp v154, v138 quad_perm:[1,1,3,3] row_mask:0xf bank_mask:0xf
    v_mov_b32_dpp v155, v139 quad_perm:[1,1,3,3] row_mask:0xf bank_mask:0xf
    s_waitcnt vmcnt(0)
    v_lshlrev_b32 v104, 16, v8
    v_and_b32 v105, 0xffff0000, v8
    v_lshlrev_b32 v106, 16, v9
    v_and_b32 v107, 0xffff0000, v9
    v_lshlrev_b32 v108, 16, v10
    v_and_b32 v109, 0xffff0000, v10
    v_lshlrev_b32 v110, 16, v11
    v_and_b32 v111, 0xffff0000, v11
    v_mul_f32 v120, v104, v148
    v_mul_f32 v121, v105, v148
    v_mul_f32 v122, v106, v148
    v_mul_f32 v123, v107, v148
    v_mul_f32 v124, v108, v148
    v_mul_f32 v125, v109, v148
    v_mul_f32 v126, v110, v148
    v_mul_f32 v127, v111, v148
    v_lshlrev_b32 v112, 16, v12
    v_and_b32 v113, 0xffff0000, v12
    v_lshlrev_b32 v114, 16, v13
    v_and_b32 v115, 0xffff0000, v13
    v_lshlrev_b32 v116, 16, v14
    v_and_b32 v117, 0xffff0000, v14
    v_lshlrev_b32 v118, 16, v15
    v_and_b32 v119, 0xffff0000, v15
    v_fmac_f32 v120, v112, v149
    v_fmac_f32 v121, v113, v149
    v_fmac_f32 v122, v114, v149
    v_fmac_f32 v123, v115, v149
    v_fmac_f32 v124, v116, v149
    v_fmac_f32 v125, v117, v149
    v_fmac_f32 v126, v118, v149
    v_fmac_f32 v127, v119, v149
    v_lshlrev_b32 v104, 16, v16
    v_and_b32 v105, 0xffff0000, v16
    v_lshlrev_b32 v106, 16, v17
    v_and_b32 v107, 0xffff0000, v17
    v_lshlrev_b32 v108, 16, v18
    v_and_b32 v109, 0xffff0000, v18
    v_lshlrev_b32 v110, 16, v19
    v_and_b32 v111, 0xffff0000, v19
    v_fmac_f32 v120, v104, v150
    v_fmac_f32 v121, v105, v150
    v_fmac_f32 v122, v106, v150
    v_fmac_f32 v123, v107, v150
    v_fmac_f32 v124, v108, v150
    v_fmac_f32 v125, v109, v150
    v_fmac_f32 v126, v110, v150
    v_fmac_f32 v127, v111, v150
    v_lshlrev_b32 v112, 16, v20
    v_and_b32 v113, 0xffff0000, v20
    v_lshlrev_b32 v114, 16, v21
    v_and_b32 v115, 0xffff0000, v21
    v_lshlrev_b32 v116, 16, v22
    v_and_b32 v117, 0xffff0000, v22
    v_lshlrev_b32 v118, 16, v23
    v_and_b32 v119, 0xffff0000, v23
    v_fmac_f32 v120, v112, v151
    v_fmac_f32 v121, v113, v151
    v_fmac_f32 v122, v114, v151
    v_fmac_f32 v123, v115, v151
    v_fmac_f32 v124, v116, v151
    v_fmac_f32 v125, v117, v151
    v_fmac_f32 v126, v118, v151
    v_fmac_f32 v127, v119, v151
    v_lshlrev_b32 v104, 16, v24
    v_and_b32 v105, 0xffff0000, v24
    v_lshlrev_b32 v106, 16, v25
    v_and_b32 v107, 0xffff0000, v25
    v_lshlrev_b32 v108, 16, v26
    v_and_b32 v109, 0xffff0000, v26
    v_lshlrev_b32 v110, 16, v27
    v_and_b32 v111, 0xffff0000, v27
    v_fmac_f32 v120, v104, v152
    v_fmac_f32 v121, v105, v152
    v_fmac_f32 v122, v106, v152
    v_fmac_f32 v123, v107, v152
    v_fmac_f32 v124, v108, v152
    v_fmac_f32 v125, v109, v152
    v_fmac_f32 v126, v110, v152
    v_fmac_f32 v127, v111, v152
    v_lshlrev_b32 v112, 16, v28
    v_and_b32 v113, 0xffff0000, v28
    v_lshlrev_b32 v114, 16, v29
    v_and_b32 v115, 0xffff0000, v29
    v_lshlrev_b32 v116, 16, v30
    v_and_b32 v117, 0xffff0000, v30
    v_lshlrev_b32 v118, 16, v31
    v_and_b32 v119, 0xffff0000, v31
    v_fmac_f32 v120, v112, v153
    v_fmac_f32 v121, v113, v153
    v_fmac_f32 v122, v114, v153
    v_fmac_f32 v123, v115, v153
    v_fmac_f32 v124, v116, v153
    v_fmac_f32 v125, v117, v153
    v_fmac_f32 v126, v118, v153
    v_fmac_f32 v127, v119, v153
    v_lshlrev_b32 v104, 16, v32
    v_and_b32 v105, 0xffff0000, v32
    v_lshlrev_b32 v106, 16, v33
    v_and_b32 v107, 0xffff0000, v33
    v_lshlrev_b32 v108, 16, v34
    v_and_b32 v109, 0xffff0000, v34
    v_lshlrev_b32 v110, 16, v35
    v_and_b32 v111, 0xffff0000, v35
    v_fmac_f32 v120, v104, v154
    v_fmac_f32 v121, v105, v154
    v_fmac_f32 v122, v106, v154
    v_fmac_f32 v123, v107, v154
    v_fmac_f32 v124, v108, v154
    v_fmac_f32 v125, v109, v154
    v_fmac_f32 v126, v110, v154
    v_fmac_f32 v127, v111, v154
    v_lshlrev_b32 v112, 16, v36
    v_and_b32 v113, 0xffff0000, v36
    v_lshlrev_b32 v114, 16, v37
    v_and_b32 v115, 0xffff0000, v37
    v_lshlrev_b32 v116, 16, v38
    v_and_b32 v117, 0xffff0000, v38
    v_lshlrev_b32 v118, 16, v39
    v_and_b32 v119, 0xffff0000, v39
    v_fmac_f32 v120, v112, v155
    v_fmac_f32 v121, v113, v155
    v_fmac_f32 v122, v114, v155
    v_fmac_f32 v123, v115, v155
    v_fmac_f32 v124, v116, v155
    v_fmac_f32 v125, v117, v155
    v_fmac_f32 v126, v118, v155
    v_fmac_f32 v127, v119, v155
    v_cvt_pk_bf16_f32 v128, v120, v121
    v_cvt_pk_bf16_f32 v129, v122, v123
    v_cvt_pk_bf16_f32 v130, v124, v125
    v_cvt_pk_bf16_f32 v131, v126, v127
    v_cndmask_b32 v140, v128, 0, s[86:87]
    v_cndmask_b32 v144, 0, v128, s[86:87]
    v_cndmask_b32 v141, v129, 0, s[86:87]
    v_cndmask_b32 v145, 0, v129, s[86:87]
    v_cndmask_b32 v142, v130, 0, s[86:87]
    v_cndmask_b32 v146, 0, v130, s[86:87]
    v_cndmask_b32 v143, v131, 0, s[86:87]
    v_cndmask_b32 v147, 0, v131, s[86:87]
    s_nop 0
    v_mfma_f32_16x16x32_bf16 v[8:11], v[140:143], v[40:43], 0
    v_mfma_f32_16x16x32_bf16 v[12:15], v[140:143], v[44:47], 0
    v_mfma_f32_16x16x32_bf16 v[16:19], v[140:143], v[48:51], 0
    v_mfma_f32_16x16x32_bf16 v[20:23], v[140:143], v[52:55], 0
    v_mfma_f32_16x16x32_bf16 v[24:27], v[140:143], v[56:59], 0
    v_mfma_f32_16x16x32_bf16 v[28:31], v[140:143], v[60:63], 0
    v_mfma_f32_16x16x32_bf16 v[32:35], v[140:143], v[64:67], 0
    v_mfma_f32_16x16x32_bf16 v[36:39], v[140:143], v[68:71], 0
    v_mfma_f32_16x16x32_bf16 v[8:11], v[144:147], v[72:75], v[8:11]
    v_mfma_f32_16x16x32_bf16 v[12:15], v[144:147], v[76:79], v[12:15]
    v_mfma_f32_16x16x32_bf16 v[16:19], v[144:147], v[80:83], v[16:19]
    v_mfma_f32_16x16x32_bf16 v[20:23], v[144:147], v[84:87], v[20:23]
    v_mfma_f32_16x16x32_bf16 v[24:27], v[144:147], v[88:91], v[24:27]
    v_mfma_f32_16x16x32_bf16 v[28:31], v[144:147], v[92:95], v[28:31]
    v_mfma_f32_16x16x32_bf16 v[32:35], v[144:147], v[96:99], v[32:35]
    v_mfma_f32_16x16x32_bf16 v[36:39], v[144:147], v[100:103], v[36:39]
    s_nop 0
    v_add_f32 v8, v8, v10
    v_add_f32 v9, v9, v11
    v_add_f32 v12, v12, v14
    v_add_f32 v13, v13, v15
    v_add_f32 v16, v16, v18
    v_add_f32 v17, v17, v19
    v_add_f32 v20, v20, v22
    v_add_f32 v21, v21, v23
    v_add_f32 v24, v24, v26
    v_add_f32 v25, v25, v27
    v_add_f32 v28, v28, v30
    v_add_f32 v29, v29, v31
    v_add_f32 v32, v32, v34
    v_add_f32 v33, v33, v35
    v_add_f32 v36, v36, v38
    v_add_f32 v37, v37, v39
    v_add_f32 v104, v8, v9
    v_add_f32 v105, v12, v13
    v_add_f32 v106, v16, v17
    v_add_f32 v107, v20, v21
    v_add_f32 v108, v24, v25
    v_add_f32 v109, v28, v29
    v_add_f32 v110, v32, v33
    v_add_f32 v111, v36, v37
    ds_write_b128 v5, v[104:107]
    ds_write_b128 v5, v[108:111] offset:16
    v_and_b32 v160, 31, v1
    s_lshl_b32 s7, s3, 8
    s_add_u32 s7, s7, 0x10000
    v_lshl_add_u32 v5, v160, 3, s7
    s_lshl_b32 s7, s3, 7
    s_add_u32 s7, s7, 0x24400
    v_lshl_add_u32 v4, v160, 2, s7
    s_waitcnt lgkmcnt(0)
    s_barrier
    ds_read_b64 v[8:9], v5 offset:0
    ds_read_b64 v[10:11], v5 offset:2048
    ds_read_b64 v[12:13], v5 offset:4096
    ds_read_b64 v[14:15], v5 offset:6144
    ds_read_b64 v[16:17], v5 offset:8192
    ds_read_b64 v[18:19], v5 offset:10240
    ds_read_b64 v[20:21], v5 offset:12288
    ds_read_b64 v[22:23], v5 offset:14336
    s_waitcnt lgkmcnt(0)
    v_add_f32 v8, v8, v16
    v_add_f32 v9, v9, v17
    v_add_f32 v10, v10, v18
    v_add_f32 v11, v11, v19
    v_add_f32 v12, v12, v20
    v_add_f32 v13, v13, v21
    v_add_f32 v14, v14, v22
    v_add_f32 v15, v15, v23
    v_add_f32 v8, v8, v12
    v_add_f32 v9, v9, v13
    v_add_f32 v10, v10, v14
    v_add_f32 v11, v11, v15
    v_add_f32 v8, v8, v10
    v_add_f32 v9, v9, v11
    v_cvt_pk_bf16_f32 v8, v8, v9
    ds_write_b32 v4, v8
    s_waitcnt lgkmcnt(0)
    s_barrier
    s_endpgm
.p2align 12
LT_W2R:
    s_branch LR_W2R
L_W2R:
    s_cmp_lt_u32 s5, 4
    s_cselect_b32 s72, s28, s16
    s_cselect_b32 s73, s29, s17
    s_mov_b32 s56, s72
    s_and_b32 s57, s73, 0xffff
    s_mov_b32 s58, 0x400000
    s_mov_b32 s59, 0x20000
    v_lshrrev_b32 v4, 4, v1
    v_lshlrev_b32 v2, 13, v4
    v_and_b32 v4, 15, v1
    v_lshl_add_u32 v2, v4, 4, v2
    s_lshl_b32 s7, s6, 17
    s_lshl_b32 s70, s62, 8
    s_add_u32 s7, s7, s70
    v_add_u32 v2, s7, v2
    v_lshrrev_b32 v3, 4, v1
    v_lshlrev_b32 v3, 16, v3
    v_bfe_u32 v4, v1, 3, 1
    v_lshl_add_u32 v3, v4, 13, v3
    v_and_b32 v4, 7, v1
    v_lshl_add_u32 v3, v4, 4, v3
    s_cmp_lt_u32 s5, 4
    s_cselect_b32 s7, 0x800, 0x0
    s_add_u32 s7, s7, s6
    s_lshl_b32 s7, s7, 7
    s_add_u32 s7, s7, 0x100000
    v_add_u32 v3, s7, v3
    s_lshl_b32 s7, s62, 14
    v_add_u32 v3, s7, v3
    s_waitcnt vmcnt(0)
    v_mov_b32 v4, 0x24014
    v_mov_b32 v5, 1
    s_waitcnt lgkmcnt(0)
    s_mov_b64 exec, 1
    ds_add_u32 v4, v5
    s_mov_b64 exec, -1
    s_mov_b32 s70, 0
    v_mov_b32 v4, 0x24048
    s_mov_b32 s80, 1600000
LW_68:
    ds_read_b32 v5, v4
    s_waitcnt lgkmcnt(0)
    v_readfirstlane_b32 s79, v5
    s_cmp_ge_u32 s79, 4
    s_cbranch_scc1 LWD_69
    s_sleep 4
    s_sub_u32 s80, s80, 1
    s_cmp_lg_u32 s80, 0
    s_cbranch_scc1 LW_68
LWD_69:
    s_cmp_lt_u32 s5, 4
    s_cbranch_scc1 S2U_66
    v_mov_b32 v4, 0x2405c
    s_mov_b32 s80, 1600000
LW_70:
    ds_read_b32 v5, v4
    s_waitcnt lgkmcnt(0)
    v_readfirstlane_b32 s79, v5
    s_cmp_ge_u32 s79, 4
    s_cbranch_scc1 LWD_71
    s_sleep 8
    s_sub_u32 s80, s80, 1
    s_cmp_lg_u32 s80, 0
    s_cbranch_scc1 LW_70
LWD_71:
    buffer_load_dwordx4 v[40:43], v2, s[56:59], s70 offen offset:0 nt
    buffer_load_dwordx4 v[44:47], v2, s[56:59], s70 offen offset:1024 nt
    buffer_load_dwordx4 v[48:51], v2, s[56:59], s70 offen offset:2048 nt
    buffer_load_dwordx4 v[52:55], v2, s[56:59], s70 offen offset:3072 nt
    s_add_u32 s70, s70, 4096
    s_waitcnt vmcnt(2)
    buffer_load_dwordx4 v[56:59], v2, s[56:59], s70 offen offset:0 nt
    buffer_load_dwordx4 v[60:63], v2, s[56:59], s70 offen offset:1024 nt
    buffer_load_dwordx4 v[64:67], v2, s[56:59], s70 offen offset:2048 nt
    buffer_load_dwordx4 v[68:71], v2, s[56:59], s70 offen offset:3072 nt
    s_add_u32 s70, s70, 28672
    s_waitcnt vmcnt(2)
    buffer_load_dwordx4 v[72:75], v2, s[56:59], s70 offen offset:0 nt
    buffer_load_dwordx4 v[76:79], v2, s[56:59], s70 offen offset:1024 nt
    buffer_load_dwordx4 v[80:83], v2, s[56:59], s70 offen offset:2048 nt
    buffer_load_dwordx4 v[84:87], v2, s[56:59], s70 offen offset:3072 nt
    s_add_u32 s70, s70, 4096
    s_waitcnt vmcnt(2)
    buffer_load_dwordx4 v[88:91], v2, s[56:59], s70 offen offset:0 nt
    buffer_load_dwordx4 v[92:95], v2, s[56:59], s70 offen offset:1024 nt
    buffer_load_dwordx4 v[96:99], v2, s[56:59], s70 offen offset:2048 nt
    buffer_load_dwordx4 v[100:103], v2, s[56:59], s70 offen offset:3072 nt
    s_add_u32 s70, s70, 28672
    s_waitcnt vmcnt(2)
    buffer_load_dwordx4 v[104:107], v2, s[56:59], s70 offen offset:0 nt
    buffer_load_dwordx4 v[108:111], v2, s[56:59], s70 offen offset:1024 nt
    buffer_load_dwordx4 v[112:115], v2, s[56:59], s70 offen offset:2048 nt
    buffer_load_dwordx4 v[116:119], v2, s[56:59], s70 offen offset:3072 nt
    s_add_u32 s70, s70, 4096
    s_waitcnt vmcnt(2)
    buffer_load_dwordx4 v[120:123], v2, s[56:59], s70 offen offset:0 nt
    buffer_load_dwordx4 v[124:127], v2, s[56:59], s70 offen offset:1024 nt
    buffer_load_dwordx4 v[128:131], v2, s[56:59], s70 offen offset:2048 nt
    buffer_load_dwordx4 v[132:135], v2, s[56:59], s70 offen offset:3072 nt
    s_add_u32 s70, s70, 28672
    s_waitcnt vmcnt(2)
    buffer_load_dwordx4 v[136:139], v2, s[56:59], s70 offen offset:0 nt
    buffer_load_dwordx4 v[140:143], v2, s[56:59], s70 offen offset:1024 nt
    buffer_load_dwordx4 v[144:147], v2, s[56:59], s70 offen offset:2048 nt
    buffer_load_dwordx4 v[148:151], v2, s[56:59], s70 offen offset:3072 nt
    s_add_u32 s70, s70, 4096
    s_waitcnt vmcnt(2)
    buffer_load_dwordx4 v[152:155], v2, s[56:59], s70 offen offset:0 nt
    buffer_load_dwordx4 v[156:159], v2, s[56:59], s70 offen offset:1024 nt
    buffer_load_dwordx4 v[160:163], v2, s[56:59], s70 offen offset:2048 nt
    buffer_load_dwordx4 v[164:167], v2, s[56:59], s70 offen offset:3072 nt
    s_add_u32 s70, s70, 28672
    s_waitcnt vmcnt(0)
    s_branch S2J_67
S2U_66:
    buffer_load_dwordx4 v[40:43], v2, s[56:59], s70 offen offset:0 nt
    buffer_load_dwordx4 v[44:47], v2, s[56:59], s70 offen offset:1024 nt
    buffer_load_dwordx4 v[48:51], v2, s[56:59], s70 offen offset:2048 nt
    buffer_load_dwordx4 v[52:55], v2, s[56:59], s70 offen offset:3072 nt
    s_add_u32 s70, s70, 4096
    s_waitcnt vmcnt(2)
    buffer_load_dwordx4 v[56:59], v2, s[56:59], s70 offen offset:0 nt
    buffer_load_dwordx4 v[60:63], v2, s[56:59], s70 offen offset:1024 nt
    buffer_load_dwordx4 v[64:67], v2, s[56:59], s70 offen offset:2048 nt
    buffer_load_dwordx4 v[68:71], v2, s[56:59], s70 offen offset:3072 nt
    s_add_u32 s70, s70, 28672
    s_waitcnt vmcnt(2)
    buffer_load_dwordx4 v[72:75], v2, s[56:59], s70 offen offset:0 nt
    buffer_load_dwordx4 v[76:79], v2, s[56:59], s70 offen offset:1024 nt
    buffer_load_dwordx4 v[80:83], v2, s[56:59], s70 offen offset:2048 nt
    buffer_load_dwordx4 v[84:87], v2, s[56:59], s70 offen offset:3072 nt
    s_add_u32 s70, s70, 4096
    s_waitcnt vmcnt(2)
    buffer_load_dwordx4 v[88:91], v2, s[56:59], s70 offen offset:0 nt
    buffer_load_dwordx4 v[92:95], v2, s[56:59], s70 offen offset:1024 nt
    buffer_load_dwordx4 v[96:99], v2, s[56:59], s70 offen offset:2048 nt
    buffer_load_dwordx4 v[100:103], v2, s[56:59], s70 offen offset:3072 nt
    s_add_u32 s70, s70, 28672
    s_waitcnt vmcnt(2)
    buffer_load_dwordx4 v[104:107], v2, s[56:59], s70 offen offset:0 nt
    buffer_load_dwordx4 v[108:111], v2, s[56:59], s70 offen offset:1024 nt
    buffer_load_dwordx4 v[112:115], v2, s[56:59], s70 offen offset:2048 nt
    buffer_load_dwordx4 v[116:119], v2, s[56:59], s70 offen offset:3072 nt
    s_add_u32 s70, s70, 4096
    s_waitcnt vmcnt(2)
    buffer_load_dwordx4 v[120:123], v2, s[56:59], s70 offen offset:0 nt
    buffer_load_dwordx4 v[124:127], v2, s[56:59], s70 offen offset:1024 nt
    buffer_load_dwordx4 v[128:131], v2, s[56:59], s70 offen offset:2048 nt
    buffer_load_dwordx4 v[132:135], v2, s[56:59], s70 offen offset:3072 nt
    s_add_u32 s70, s70, 28672
    s_waitcnt vmcnt(2)
    buffer_load_dwordx4 v[136:139], v2, s[56:59], s70 offen offset:0 nt
    buffer_load_dwordx4 v[140:143], v2, s[56:59], s70 offen offset:1024 nt
    buffer_load_dwordx4 v[144:147], v2, s[56:59], s70 offen offset:2048 nt
    buffer_load_dwordx4 v[148:151], v2, s[56:59], s70 offen offset:3072 nt
    s_add_u32 s70, s70, 4096
    s_waitcnt vmcnt(2)
    buffer_load_dwordx4 v[152:155], v2, s[56:59], s70 offen offset:0 nt
    buffer_load_dwordx4 v[156:159], v2, s[56:59], s70 offen offset:1024 nt
    buffer_load_dwordx4 v[160:163], v2, s[56:59], s70 offen offset:2048 nt
    buffer_load_dwordx4 v[164:167], v2, s[56:59], s70 offen offset:3072 nt
    s_add_u32 s70, s70, 28672
    s_waitcnt vmcnt(0)
S2J_67:
    v_perm_b32 v8, v44, v40, s92
    v_perm_b32 v9, v52, v48, s92
    v_perm_b32 v10, v60, v56, s92
    v_perm_b32 v11, v68, v64, s92
    v_perm_b32 v12, v44, v40, s93
    v_perm_b32 v13, v52, v48, s93
    v_perm_b32 v14, v60, v56, s93
    v_perm_b32 v15, v68, v64, s93
    v_perm_b32 v16, v45, v41, s92
    v_perm_b32 v17, v53, v49, s92
    v_perm_b32 v18, v61, v57, s92
    v_perm_b32 v19, v69, v65, s92
    v_perm_b32 v20, v45, v41, s93
    v_perm_b32 v21, v53, v49, s93
    v_perm_b32 v22, v61, v57, s93
    v_perm_b32 v23, v69, v65, s93
    v_perm_b32 v24, v46, v42, s92
    v_perm_b32 v25, v54, v50, s92
    v_perm_b32 v26, v62, v58, s92
    v_perm_b32 v27, v70, v66, s92
    v_perm_b32 v28, v46, v42, s93
    v_perm_b32 v29, v54, v50, s93
    v_perm_b32 v30, v62, v58, s93
    v_perm_b32 v31, v70, v66, s93
    v_perm_b32 v32, v47, v43, s92
    v_perm_b32 v33, v55, v51, s92
    v_perm_b32 v34, v63, v59, s92
    v_perm_b32 v35, v71, v67, s92
    v_perm_b32 v36, v47, v43, s93
    v_perm_b32 v37, v55, v51, s93
    v_perm_b32 v38, v63, v59, s93
    v_perm_b32 v39, v71, v67, s93
    v_perm_b32 v40, v76, v72, s92
    v_perm_b32 v41, v84, v80, s92
    v_perm_b32 v42, v92, v88, s92
    v_perm_b32 v43, v100, v96, s92
    v_perm_b32 v44, v76, v72, s93
    v_perm_b32 v45, v84, v80, s93
    v_perm_b32 v46, v92, v88, s93
    v_perm_b32 v47, v100, v96, s93
    v_perm_b32 v48, v77, v73, s92
    v_perm_b32 v49, v85, v81, s92
    v_perm_b32 v50, v93, v89, s92
    v_perm_b32 v51, v101, v97, s92
    v_perm_b32 v52, v77, v73, s93
    v_perm_b32 v53, v85, v81, s93
    v_perm_b32 v54, v93, v89, s93
    v_perm_b32 v55, v101, v97, s93
    v_perm_b32 v56, v78, v74, s92
    v_perm_b32 v57, v86, v82, s92
    v_perm_b32 v58, v94, v90, s92
    v_perm_b32 v59, v102, v98, s92
    v_perm_b32 v60, v78, v74, s93
    v_perm_b32 v61, v86, v82, s93
    v_perm_b32 v62, v94, v90, s93
    v_perm_b32 v63, v102, v98, s93
    v_perm_b32 v64, v79, v75, s92
    v_perm_b32 v65, v87, v83, s92
    v_perm_b32 v66, v95, v91, s92
    v_perm_b32 v67, v103, v99, s92
    v_perm_b32 v68, v79, v75, s93
    v_perm_b32 v69, v87, v83, s93
    v_perm_b32 v70, v95, v91, s93
    v_perm_b32 v71, v103, v99, s93
    v_perm_b32 v72, v108, v104, s92
    v_perm_b32 v73, v116, v112, s92
    v_perm_b32 v74, v124, v120, s92
    v_perm_b32 v75, v132, v128, s92
    v_perm_b32 v76, v108, v104, s93
    v_perm_b32 v77, v116, v112, s93
    v_perm_b32 v78, v124, v120, s93
    v_perm_b32 v79, v132, v128, s93
    v_perm_b32 v80, v109, v105, s92
    v_perm_b32 v81, v117, v113, s92
    v_perm_b32 v82, v125, v121, s92
    v_perm_b32 v83, v133, v129, s92
    v_perm_b32 v84, v109, v105, s93
    v_perm_b32 v85, v117, v113, s93
    v_perm_b32 v86, v125, v121, s93
    v_perm_b32 v87, v133, v129, s93
    v_perm_b32 v88, v110, v106, s92
    v_perm_b32 v89, v118, v114, s92
    v_perm_b32 v90, v126, v122, s92
    v_perm_b32 v91, v134, v130, s92
    v_perm_b32 v92, v110, v106, s93
    v_perm_b32 v93, v118, v114, s93
    v_perm_b32 v94, v126, v122, s93
    v_perm_b32 v95, v134, v130, s93
    v_perm_b32 v96, v111, v107, s92
    v_perm_b32 v97, v119, v115, s92
    v_perm_b32 v98, v127, v123, s92
    v_perm_b32 v99, v135, v131, s92
    v_perm_b32 v100, v111, v107, s93
    v_perm_b32 v101, v119, v115, s93
    v_perm_b32 v102, v127, v123, s93
    v_perm_b32 v103, v135, v131, s93
    v_perm_b32 v104, v140, v136, s92
    v_perm_b32 v105, v148, v144, s92
    v_perm_b32 v106, v156, v152, s92
    v_perm_b32 v107, v164, v160, s92
    v_perm_b32 v108, v140, v136, s93
    v_perm_b32 v109, v148, v144, s93
    v_perm_b32 v110, v156, v152, s93
    v_perm_b32 v111, v164, v160, s93
    v_perm_b32 v112, v141, v137, s92
    v_perm_b32 v113, v149, v145, s92
    v_perm_b32 v114, v157, v153, s92
    v_perm_b32 v115, v165, v161, s92
    v_perm_b32 v116, v141, v137, s93
    v_perm_b32 v117, v149, v145, s93
    v_perm_b32 v118, v157, v153, s93
    v_perm_b32 v119, v165, v161, s93
    v_perm_b32 v120, v142, v138, s92
    v_perm_b32 v121, v150, v146, s92
    v_perm_b32 v122, v158, v154, s92
    v_perm_b32 v123, v166, v162, s92
    v_perm_b32 v124, v142, v138, s93
    v_perm_b32 v125, v150, v146, s93
    v_perm_b32 v126, v158, v154, s93
    v_perm_b32 v127, v166, v162, s93
    v_perm_b32 v128, v143, v139, s92
    v_perm_b32 v129, v151, v147, s92
    v_perm_b32 v130, v159, v155, s92
    v_perm_b32 v131, v167, v163, s92
    v_perm_b32 v132, v143, v139, s93
    v_perm_b32 v133, v151, v147, s93
    v_perm_b32 v134, v159, v155, s93
    v_perm_b32 v135, v167, v163, s93
    v_mov_b32 v160, 0x2404c
    s_mov_b32 s80, 1600000
LW_72:
    ds_read_b32 v161, v160
    s_waitcnt lgkmcnt(0)
    v_readfirstlane_b32 s79, v161
    s_cmp_ge_u32 s79, 1
    s_cbranch_scc1 LWD_73
    s_sleep 2
    s_sub_u32 s80, s80, 1
    s_cmp_lg_u32 s80, 0
    s_cbranch_scc1 LW_72
LWD_73:
    v_mov_b32 v160, 0x24050
    ds_read_b64 v[162:163], v160
    s_waitcnt lgkmcnt(0)
    v_readfirstlane_b32 s94, v162
    v_readfirstlane_b32 s95, v163
    v_bfe_u32 v4, v1, 2, 2
    v_lshlrev_b32 v4, 8, v4
    v_lshrrev_b32 v160, 4, v1
    v_lshl_add_u32 v4, v160, 4, v4
    s_mov_b32 s70, 4096
    s_cmp_ge_u32 s5, 4
    s_cbranch_scc1 S2X_74
    v_add_u32 v4, 0x24400, v4
    s_cmp_lg_u32 s3, 8
    s_cbranch_scc1 U8_76
    v_and_b32 v5, 15, v1
    v_lshl_add_u32 v5, v5, 2, v160
    s_lshl_b32 s7, s6, 4
    s_add_u32 s7, s7, 0xe0000
    v_lshl_add_u32 v5, v5, 9, s7
    v_lshlrev_b32 v6, 4, v1
    v_add_u32 v6, 0x24800, v6
    s_mov_b32 s80, 200000
PO_77:
    buffer_load_dwordx4 v[136:139], v5, s[36:39], 0 offen sc1
PO2_78:
    s_waitcnt vmcnt(0)
    v_cmp_ne_u64 vcc, s[94:95], v[138:139]
    s_cmp_lg_u64 vcc, -1
    s_cbranch_scc1 POD_79
    s_sleep 16
    s_sub_u32 s80, s80, 1
    s_cmp_lg_u32 s80, 0
    s_cbranch_scc1 PO_77
POD_79:
    s_setprio 3
    ds_write_b128 v6, v[136:139]
    v_mov_b32 v160, 0x2401c
    v_mov_b32 v161, 1
    s_waitcnt lgkmcnt(0)
    s_mov_b64 exec, 1
    ds_add_u32 v160, v161
    s_mov_b64 exec, -1
    s_cbranch_vccz U8D_81
    buffer_load_dwordx4 v[136:139], v5, s[36:39], 0 offen sc1
    s_sleep 4
    buffer_load_dwordx4 v[140:143], v5, s[36:39], 0 offen sc1
    s_sleep 4
    s_mov_b32 s80, 200000
U8P_80:
    s_waitcnt vmcnt(1)
    ds_write_b128 v6, v[136:139]
    v_cmp_ne_u64 vcc, s[94:95], v[138:139]
    s_cbranch_vccz U8D_81
    s_waitcnt lgkmcnt(0)
    buffer_load_dwordx4 v[136:139], v5, s[36:39], 0 offen sc1
    s_waitcnt vmcnt(1)
    ds_write_b128 v6, v[140:143]
    v_cmp_ne_u64 vcc, s[94:95], v[142:143]
    s_cbranch_vccz U8D_81
    s_waitcnt lgkmcnt(0)
    buffer_load_dwordx4 v[140:143], v5, s[36:39], 0 offen sc1
    s_sub_u32 s80, s80, 1
    s_cmp_lg_u32 s80, 0
    s_cbranch_scc1 U8P_80
U8D_81:
    s_waitcnt vmcnt(0)
U8_76:
    s_setprio 3
    s_barrier
    s_barrier
    ds_read_b128 v[136:139], v4 offset:0
    ds_read_b128 v[140:143], v4 offset:64
    ds_read_b128 v[144:147], v4 offset:128
    ds_read_b128 v[148:151], v4 offset:192
    s_waitcnt lgkmcnt(0)
    s_branch S2M_75
S2X_74:
    v_and_b32 v160, 3, v1
    v_lshl_add_u32 v4, v160, 6, v4
    s_lshl_b32 s7, s6, 11
    s_add_u32 s7, s7, 0xd0000
    v_add_u32 v4, s7, v4
    s_mov_b32 s80, 200000
PO_82:
    buffer_load_dwordx4 v[152:155], v4, s[36:39], 0 offen offset:0 sc1
PO2_83:
    s_waitcnt vmcnt(0)
    v_cmp_ne_u64 vcc, s[94:95], v[154:155]
    s_cmp_lg_u64 vcc, -1
    s_cbranch_scc1 POD_84
    s_sleep 2
    s_sub_u32 s80, s80, 1
    s_cmp_lg_u32 s80, 0
    s_cbranch_scc1 PO_82
POD_84:
    s_setprio 3
    buffer_load_dwordx4 v[152:155], v4, s[36:39], 0 offen offset:0 sc1
    buffer_load_dwordx4 v[156:159], v4, s[36:39], 0 offen offset:1024 sc1
    s_sleep 4
    buffer_load_dwordx4 v[160:163], v4, s[36:39], 0 offen offset:0 sc1
    buffer_load_dwordx4 v[164:167], v4, s[36:39], 0 offen offset:1024 sc1
    s_sleep 4
    s_mov_b32 s80, 200000
PP_85:
    s_waitcnt vmcnt(2)
    v_cmp_ne_u64 vcc, s[94:95], v[154:155]
    v_cmp_ne_u64 s[84:85], s[94:95], v[158:159]
    s_or_b64 vcc, vcc, s[84:85]
    s_cmp_eq_u64 vcc, 0
    s_cbranch_scc1 PPO_87
    buffer_load_dwordx4 v[152:155], v4, s[36:39], 0 offen offset:0 sc1
    buffer_load_dwordx4 v[156:159], v4, s[36:39], 0 offen offset:1024 sc1
    s_waitcnt vmcnt(2)
    v_cmp_ne_u64 vcc, s[94:95], v[162:163]
    v_cmp_ne_u64 s[84:85], s[94:95], v[166:167]
    s_or_b64 vcc, vcc, s[84:85]
    s_cmp_eq_u64 vcc, 0
    s_cbranch_scc1 PPO_88
    buffer_load_dwordx4 v[160:163], v4, s[36:39], 0 offen offset:0 sc1
    buffer_load_dwordx4 v[164:167], v4, s[36:39], 0 offen offset:1024 sc1
    s_sub_u32 s80, s80, 1
    s_cmp_lg_u32 s80, 0
    s_cbranch_scc1 PP_85
PPO_87:
    v_mov_b32_dpp v136, v152 quad_perm:[0,0,0,0] row_mask:0xf bank_mask:0xf
    v_mov_b32_dpp v137, v153 quad_perm:[0,0,0,0] row_mask:0xf bank_mask:0xf
    v_mov_b32_dpp v138, v156 quad_perm:[0,0,0,0] row_mask:0xf bank_mask:0xf
    v_mov_b32_dpp v139, v157 quad_perm:[0,0,0,0] row_mask:0xf bank_mask:0xf
    v_mov_b32_dpp v140, v152 quad_perm:[1,1,1,1] row_mask:0xf bank_mask:0xf
    v_mov_b32_dpp v141, v153 quad_perm:[1,1,1,1] row_mask:0xf bank_mask:0xf
    v_mov_b32_dpp v142, v156 quad_perm:[1,1,1,1] row_mask:0xf bank_mask:0xf
    v_mov_b32_dpp v143, v157 quad_perm:[1,1,1,1] row_mask:0xf bank_mask:0xf
    v_mov_b32_dpp v144, v152 quad_perm:[2,2,2,2] row_mask:0xf bank_mask:0xf
    v_mov_b32_dpp v145, v153 quad_perm:[2,2,2,2] row_mask:0xf bank_mask:0xf
    v_mov_b32_dpp v146, v156 quad_perm:[2,2,2,2] row_mask:0xf bank_mask:0xf
    v_mov_b32_dpp v147, v157 quad_perm:[2,2,2,2] row_mask:0xf bank_mask:0xf
    v_mov_b32_dpp v148, v152 quad_perm:[3,3,3,3] row_mask:0xf bank_mask:0xf
    v_mov_b32_dpp v149, v153 quad_perm:[3,3,3,3] row_mask:0xf bank_mask:0xf
    v_mov_b32_dpp v150, v156 quad_perm:[3,3,3,3] row_mask:0xf bank_mask:0xf
    v_mov_b32_dpp v151, v157 quad_perm:[3,3,3,3] row_mask:0xf bank_mask:0xf
    s_branch PPD_86
PPO_88:
    v_mov_b32_dpp v136, v160 quad_perm:[0,0,0,0] row_mask:0xf bank_mask:0xf
    v_mov_b32_dpp v137, v161 quad_perm:[0,0,0,0] row_mask:0xf bank_mask:0xf
    v_mov_b32_dpp v138, v164 quad_perm:[0,0,0,0] row_mask:0xf bank_mask:0xf
    v_mov_b32_dpp v139, v165 quad_perm:[0,0,0,0] row_mask:0xf bank_mask:0xf
    v_mov_b32_dpp v140, v160 quad_perm:[1,1,1,1] row_mask:0xf bank_mask:0xf
    v_mov_b32_dpp v141, v161 quad_perm:[1,1,1,1] row_mask:0xf bank_mask:0xf
    v_mov_b32_dpp v142, v164 quad_perm:[1,1,1,1] row_mask:0xf bank_mask:0xf
    v_mov_b32_dpp v143, v165 quad_perm:[1,1,1,1] row_mask:0xf bank_mask:0xf
    v_mov_b32_dpp v144, v160 quad_perm:[2,2,2,2] row_mask:0xf bank_mask:0xf
    v_mov_b32_dpp v145, v161 quad_perm:[2,2,2,2] row_mask:0xf bank_mask:0xf
    v_mov_b32_dpp v146, v164 quad_perm:[2,2,2,2] row_mask:0xf bank_mask:0xf
    v_mov_b32_dpp v147, v165 quad_perm:[2,2,2,2] row_mask:0xf bank_mask:0xf
    v_mov_b32_dpp v148, v160 quad_perm:[3,3,3,3] row_mask:0xf bank_mask:0xf
    v_mov_b32_dpp v149, v161 quad_perm:[3,3,3,3] row_mask:0xf bank_mask:0xf
    v_mov_b32_dpp v150, v164 quad_perm:[3,3,3,3] row_mask:0xf bank_mask:0xf
    v_mov_b32_dpp v151, v165 quad_perm:[3,3,3,3] row_mask:0xf bank_mask:0xf
PPD_86:
S2M_75:
    s_nop 1
    v_mfma_f32_16x16x32_bf16 v[4:7], v[136:139], v[8:11], 0
    v_mfma_f32_16x16x32_bf16 v[4:7], v[140:143], v[40:43], v[4:7]
    v_mfma_f32_16x16x32_bf16 v[4:7], v[144:147], v[72:75], v[4:7]
    v_mfma_f32_16x16x32_bf16 v[4:7], v[148:151], v[104:107], v[4:7]
    v_mfma_f32_16x16x32_bf16 v[8:11], v[136:139], v[12:15], 0
    v_mfma_f32_16x16x32_bf16 v[8:11], v[140:143], v[44:47], v[8:11]
    v_mfma_f32_16x16x32_bf16 v[8:11], v[144:147], v[76:79], v[8:11]
    v_mfma_f32_16x16x32_bf16 v[8:11], v[148:151], v[108:111], v[8:11]
    v_mfma_f32_16x16x32_bf16 v[12:15], v[136:139], v[16:19], 0
    v_mfma_f32_16x16x32_bf16 v[12:15], v[140:143], v[48:51], v[12:15]
    v_mfma_f32_16x16x32_bf16 v[12:15], v[144:147], v[80:83], v[12:15]
    v_mfma_f32_16x16x32_bf16 v[12:15], v[148:151], v[112:115], v[12:15]
    v_mfma_f32_16x16x32_bf16 v[16:19], v[136:139], v[20:23], 0
    v_mfma_f32_16x16x32_bf16 v[16:19], v[140:143], v[52:55], v[16:19]
    v_mfma_f32_16x16x32_bf16 v[16:19], v[144:147], v[84:87], v[16:19]
    v_mfma_f32_16x16x32_bf16 v[16:19], v[148:151], v[116:119], v[16:19]
    v_mfma_f32_16x16x32_bf16 v[20:23], v[136:139], v[24:27], 0
    v_mfma_f32_16x16x32_bf16 v[20:23], v[140:143], v[56:59], v[20:23]
    v_mfma_f32_16x16x32_bf16 v[20:23], v[144:147], v[88:91], v[20:23]
    v_mfma_f32_16x16x32_bf16 v[20:23], v[148:151], v[120:123], v[20:23]
    v_mfma_f32_16x16x32_bf16 v[24:27], v[136:139], v[28:31], 0
    v_mfma_f32_16x16x32_bf16 v[24:27], v[140:143], v[60:63], v[24:27]
    v_mfma_f32_16x16x32_bf16 v[24:27], v[144:147], v[92:95], v[24:27]
    v_mfma_f32_16x16x32_bf16 v[24:27], v[148:151], v[124:127], v[24:27]
    v_mfma_f32_16x16x32_bf16 v[28:31], v[136:139], v[32:35], 0
    v_mfma_f32_16x16x32_bf16 v[28:31], v[140:143], v[64:67], v[28:31]
    v_mfma_f32_16x16x32_bf16 v[28:31], v[144:147], v[96:99], v[28:31]
    v_mfma_f32_16x16x32_bf16 v[28:31], v[148:151], v[128:131], v[28:31]
    v_mfma_f32_16x16x32_bf16 v[32:35], v[136:139], v[36:39], 0
    v_mfma_f32_16x16x32_bf16 v[32:35], v[140:143], v[68:71], v[32:35]
    v_mfma_f32_16x16x32_bf16 v[32:35], v[144:147], v[100:103], v[32:35]
    v_mfma_f32_16x16x32_bf16 v[32:35], v[148:151], v[132:135], v[32:35]
    v_mov_b32 v42, s94
    v_mov_b32 v43, s95
    v_cvt_pk_bf16_f32 v40, v4, v8
    v_cvt_pk_bf16_f32 v41, v12, v16
    buffer_store_dwordx4 v[40:43], v3, s[36:39], 0 offen sc1
    v_mov_b32 v46, s94
    v_mov_b32 v47, s95
    v_cvt_pk_bf16_f32 v44, v20, v24
    v_cvt_pk_bf16_f32 v45, v28, v32
    buffer_store_dwordx4 v[44:47], v3, s[36:39], s70 offen sc1
    s_endpgm
.p2align 12
LT_CR:
    s_branch LR_CR
L_CR:
    v_and_b32 v160, 15, v1
    v_lshlrev_b32 v4, 10, v160
    v_lshrrev_b32 v161, 4, v1
    v_lshl_add_u32 v4, v161, 8, v4
    v_lshl_add_u32 v3, v160, 4, v4
    s_lshl_b32 s7, s65, 14
    s_add_u32 s7, s7, 0x18000
    v_add_u32 v3, s7, v3
    v_and_b32 v162, 3, v1
    v_lshl_add_u32 v4, v162, 6, v4
    v_bfe_u32 v162, v1, 2, 2
    v_lshl_add_u32 v4, v162, 4, v4
    s_lshl_b32 s7, s64, 14
    v_add_u32 v4, s7, v4
    v_add_u32 v2, 0x10000, v4
    s_lshl_b32 s7, s65, 6
    s_add_u32 s7, s7, 0x27200
    v_lshl_add_u32 v5, v160, 2, s7
    s_lshl_b32 s7, s64, 10
    s_lshl_b32 s66, s65, 9
    s_add_u32 s7, s7, s66
    s_add_u32 s7, s7, 0x25200
    v_lshl_add_u32 v6, v160, 5, s7
    v_lshl_add_u32 v6, v161, 3, v6
    v_and_b32 v162, 31, v1
    v_lshlrev_b32 v7, 5, v162
    v_lshrrev_b32 v163, 5, v1
    v_lshl_add_u32 v7, v163, 4, v7
    v_add_u32 v7, 0x25200, v7
    v_lshlrev_b32 v8, 2, v162
    v_add_u32 v8, 0x27e00, v8
    v_bfe_u32 v162, v1, 2, 2
    v_lshl_add_u32 v164, v163, 3, v162
    v_lshlrev_b32 v164, 10, v164
    v_and_b32 v165, 1, v1
    v_lshl_add_u32 v164, v165, 3, v164
    s_lshl_b32 s7, s64, 8
    v_add_u32 v164, s7, v164
    v_bfe_u32 v165, v1, 4, 1
    v_lshlrev_b32 v165, 1, v165
    v_bfe_u32 v160, v1, 1, 1
    v_or_b32 v165, v165, v160
    s_lshl_b32 s7, s65, 3
    v_or_b32 v165, s7, v165
    v_lshlrev_b32 v162, 2, v162
    v_xor_b32 v165, v165, v162
    v_lshlrev_b32 v163, 1, v163
    v_xor_b32 v165, v165, v163
    v_xor_b32 v160, 0, v165
    v_lshl_add_u32 v9, v160, 4, v164
    v_xor_b32 v160, 4, v165
    v_lshl_add_u32 v10, v160, 4, v164
    v_xor_b32 v160, 1, v165
    v_lshl_add_u32 v11, v160, 4, v164
    v_add_u32 v11, 0x1000, v11
    v_xor_b32 v160, 5, v165
    v_lshl_add_u32 v12, v160, 4, v164
    v_add_u32 v12, 0x1000, v12
    v_mov_b32 v13, 0xff800000
    v_mov_b32 v14, 0
    v_cmp_gt_u32 s[86:87], 16, v1
    s_cmp_eq_u32 s64, 0
    s_cselect_b32 s88, 0xffff, 0
    s_mov_b32 s89, 0
    s_barrier
    v_xor_b32 v160, 0x0, v3
    ds_read_b128 v[32:35], v160
    v_xor_b32 v161, 0x10, v3
    ds_read_b128 v[36:39], v161
    v_xor_b32 v160, 0x20, v3
    ds_read_b128 v[40:43], v160
    v_xor_b32 v161, 0x30, v3
    ds_read_b128 v[44:47], v161
    v_xor_b32 v160, 0x40, v3
    ds_read_b128 v[48:51], v160
    v_xor_b32 v161, 0x50, v3
    ds_read_b128 v[52:55], v161
    v_xor_b32 v160, 0x60, v3
    ds_read_b128 v[56:59], v160
    v_xor_b32 v161, 0x70, v3
    ds_read_b128 v[60:63], v161
    v_xor_b32 v160, 0x80, v3
    ds_read_b128 v[64:67], v160
    v_xor_b32 v161, 0x90, v3
    ds_read_b128 v[68:71], v161
    v_xor_b32 v160, 0xa0, v3
    ds_read_b128 v[72:75], v160
    v_xor_b32 v161, 0xb0, v3
    ds_read_b128 v[76:79], v161
    v_xor_b32 v160, 0xc0, v3
    ds_read_b128 v[80:83], v160
    v_xor_b32 v161, 0xd0, v3
    ds_read_b128 v[84:87], v161
    v_xor_b32 v160, 0xe0, v3
    ds_read_b128 v[88:91], v160
    v_xor_b32 v161, 0xf0, v3
    ds_read_b128 v[92:95], v161
    s_lshl_b32 s7, s3, 10
    s_add_u32 s7, s7, 0x18000
    v_lshl_add_u32 v3, v1, 4, s7
    s_waitcnt lgkmcnt(0)
    s_barrier
    ds_write_b128 v3, v[128:131] offset:0
    ds_write_b128 v3, v[132:135] offset:8192
    ds_write_b128 v3, v[136:139] offset:16384
    ds_write_b128 v3, v[140:143] offset:24576
    v_xor_b32 v160, 0x0, v4
    ds_read_b128 v[24:27], v160
    v_xor_b32 v161, 0x10, v4
    ds_read_b128 v[28:31], v161
    v_xor_b32 v162, 0x20, v4
    ds_read_b128 v[164:167], v162
    v_xor_b32 v160, 0x30, v4
    ds_read_b128 v[144:147], v160
    v_xor_b32 v161, 0x40, v4
    ds_read_b128 v[148:151], v161
    v_xor_b32 v162, 0x50, v4
    ds_read_b128 v[152:155], v162
    v_xor_b32 v160, 0x60, v4
    ds_read_b128 v[156:159], v160
    s_waitcnt lgkmcnt(6)
    v_mfma_f32_16x16x32_bf16 v[16:19], v[24:27], v[32:35], 0
    v_xor_b32 v161, 0x70, v4
    ds_read_b128 v[24:27], v161
    s_waitcnt lgkmcnt(6)
    v_mfma_f32_16x16x32_bf16 v[16:19], v[28:31], v[36:39], v[16:19]
    v_xor_b32 v162, 0x80, v4
    ds_read_b128 v[28:31], v162
    s_waitcnt lgkmcnt(6)
    v_mfma_f32_16x16x32_bf16 v[16:19], v[164:167], v[40:43], v[16:19]
    v_xor_b32 v160, 0x90, v4
    ds_read_b128 v[164:167], v160
    s_waitcnt lgkmcnt(6)
    v_mfma_f32_16x16x32_bf16 v[16:19], v[144:147], v[44:47], v[16:19]
    v_xor_b32 v161, 0xa0, v4
    ds_read_b128 v[144:147], v161
    s_waitcnt lgkmcnt(6)
    v_mfma_f32_16x16x32_bf16 v[16:19], v[148:151], v[48:51], v[16:19]
    v_xor_b32 v162, 0xb0, v4
    ds_read_b128 v[148:151], v162
    s_waitcnt lgkmcnt(6)
    v_mfma_f32_16x16x32_bf16 v[16:19], v[152:155], v[52:55], v[16:19]
    v_xor_b32 v160, 0xc0, v4
    ds_read_b128 v[152:155], v160
    s_waitcnt lgkmcnt(6)
    v_mfma_f32_16x16x32_bf16 v[16:19], v[156:159], v[56:59], v[16:19]
    v_xor_b32 v161, 0xd0, v4
    ds_read_b128 v[156:159], v161
    s_waitcnt lgkmcnt(6)
    v_mfma_f32_16x16x32_bf16 v[16:19], v[24:27], v[60:63], v[16:19]
    v_xor_b32 v162, 0xe0, v4
    ds_read_b128 v[24:27], v162
    s_waitcnt lgkmcnt(6)
    v_mfma_f32_16x16x32_bf16 v[16:19], v[28:31], v[64:67], v[16:19]
    v_xor_b32 v160, 0xf0, v4
    ds_read_b128 v[28:31], v160
    s_waitcnt lgkmcnt(6)
    v_mfma_f32_16x16x32_bf16 v[16:19], v[164:167], v[68:71], v[16:19]
    s_waitcnt lgkmcnt(5)
    v_mfma_f32_16x16x32_bf16 v[16:19], v[144:147], v[72:75], v[16:19]
    s_waitcnt lgkmcnt(4)
    v_mfma_f32_16x16x32_bf16 v[16:19], v[148:151], v[76:79], v[16:19]
    s_waitcnt lgkmcnt(3)
    v_mfma_f32_16x16x32_bf16 v[16:19], v[152:155], v[80:83], v[16:19]
    s_waitcnt lgkmcnt(2)
    v_mfma_f32_16x16x32_bf16 v[16:19], v[156:159], v[84:87], v[16:19]
    s_waitcnt lgkmcnt(1)
    v_mfma_f32_16x16x32_bf16 v[16:19], v[24:27], v[88:91], v[16:19]
    s_waitcnt lgkmcnt(0)
    v_mfma_f32_16x16x32_bf16 v[16:19], v[28:31], v[92:95], v[16:19]
    s_waitcnt lgkmcnt(0)
    s_barrier
    v_xor_b32 v160, 0x0, v2
    ds_read_b128 v[24:27], v160
    v_xor_b32 v161, 0x10, v2
    ds_read_b128 v[28:31], v161
    v_xor_b32 v162, 0x20, v2
    ds_read_b128 v[164:167], v162
    v_xor_b32 v160, 0x30, v2
    ds_read_b128 v[144:147], v160
    v_xor_b32 v161, 0x40, v2
    ds_read_b128 v[148:151], v161
    v_xor_b32 v162, 0x50, v2
    ds_read_b128 v[152:155], v162
    v_xor_b32 v160, 0x60, v2
    ds_read_b128 v[156:159], v160
    s_waitcnt lgkmcnt(6)
    v_mfma_f32_16x16x32_bf16 v[20:23], v[24:27], v[32:35], 0
    v_xor_b32 v161, 0x70, v2
    ds_read_b128 v[24:27], v161
    s_waitcnt lgkmcnt(6)
    v_mfma_f32_16x16x32_bf16 v[20:23], v[28:31], v[36:39], v[20:23]
    v_xor_b32 v162, 0x80, v2
    ds_read_b128 v[28:31], v162
    s_waitcnt lgkmcnt(6)
    v_mfma_f32_16x16x32_bf16 v[20:23], v[164:167], v[40:43], v[20:23]
    v_xor_b32 v160, 0x90, v2
    ds_read_b128 v[164:167], v160
    s_waitcnt lgkmcnt(6)
    v_mfma_f32_16x16x32_bf16 v[20:23], v[144:147], v[44:47], v[20:23]
    v_xor_b32 v161, 0xa0, v2
    ds_read_b128 v[144:147], v161
    s_waitcnt lgkmcnt(6)
    v_mfma_f32_16x16x32_bf16 v[20:23], v[148:151], v[48:51], v[20:23]
    v_xor_b32 v162, 0xb0, v2
    ds_read_b128 v[148:151], v162
    s_waitcnt lgkmcnt(6)
    v_mfma_f32_16x16x32_bf16 v[20:23], v[152:155], v[52:55], v[20:23]
    v_xor_b32 v160, 0xc0, v2
    ds_read_b128 v[152:155], v160
    s_waitcnt lgkmcnt(6)
    v_mfma_f32_16x16x32_bf16 v[20:23], v[156:159], v[56:59], v[20:23]
    v_xor_b32 v161, 0xd0, v2
    ds_read_b128 v[156:159], v161
    s_waitcnt lgkmcnt(6)
    v_mfma_f32_16x16x32_bf16 v[20:23], v[24:27], v[60:63], v[20:23]
    v_xor_b32 v162, 0xe0, v2
    ds_read_b128 v[24:27], v162
    s_waitcnt lgkmcnt(6)
    v_mfma_f32_16x16x32_bf16 v[20:23], v[28:31], v[64:67], v[20:23]
    v_xor_b32 v160, 0xf0, v2
    ds_read_b128 v[28:31], v160
    s_waitcnt lgkmcnt(6)
    v_mfma_f32_16x16x32_bf16 v[20:23], v[164:167], v[68:71], v[20:23]
    s_waitcnt lgkmcnt(5)
    v_mfma_f32_16x16x32_bf16 v[20:23], v[144:147], v[72:75], v[20:23]
    s_waitcnt lgkmcnt(4)
    v_mfma_f32_16x16x32_bf16 v[20:23], v[148:151], v[76:79], v[20:23]
    s_waitcnt lgkmcnt(3)
    v_mfma_f32_16x16x32_bf16 v[20:23], v[152:155], v[80:83], v[20:23]
    s_waitcnt lgkmcnt(2)
    v_mfma_f32_16x16x32_bf16 v[20:23], v[156:159], v[84:87], v[20:23]
    s_waitcnt lgkmcnt(1)
    v_mfma_f32_16x16x32_bf16 v[20:23], v[24:27], v[88:91], v[20:23]
    s_waitcnt lgkmcnt(0)
    v_mfma_f32_16x16x32_bf16 v[20:23], v[28:31], v[92:95], v[20:23]
    v_max3_f32 v160, v16, v17, v18
    s_nop 6
    v_max3_f32 v160, v160, v19, v20
    v_max3_f32 v160, v160, v21, v22
    v_max_f32 v160, v160, v23
    v_mov_b32 v161, v160
    s_nop 1
    v_permlane32_swap_b32 v160, v161
    v_max_f32 v160, v160, v161
    v_mov_b32 v161, v160
    s_nop 1
    v_permlane16_swap_b32 v160, v161
    v_max_f32 v160, v160, v161
    s_lshl_b32 s7, s64, 7
    v_add_u32 v161, s7, v5
    s_mov_b64 exec, s[86:87]
    ds_write_b32 v161, v160
    s_mov_b64 exec, -1
    s_waitcnt lgkmcnt(0)
    s_barrier
    ds_read_b32 v160, v5 offset:0
    ds_read_b32 v161, v5 offset:128
    ds_read_b32 v162, v5 offset:256
    ds_read_b32 v163, v5 offset:384
    s_waitcnt lgkmcnt(0)
    v_max3_f32 v160, v160, v161, v162
    v_max_f32 v160, v160, v163
    v_mul_f32 v160, s67, v160
    v_max_f32 v160, v160, v13
    v_sub_f32 v161, v13, v160
    v_exp_f32 v161, v161
    v_mov_b32 v13, v160
    v_fma_f32 v16, v16, s67, -v160
    v_fma_f32 v17, v17, s67, -v160
    v_fma_f32 v18, v18, s67, -v160
    v_fma_f32 v19, v19, s67, -v160
    v_fma_f32 v20, v20, s67, -v160
    v_fma_f32 v21, v21, s67, -v160
    v_fma_f32 v22, v22, s67, -v160
    v_fma_f32 v23, v23, s67, -v160
    v_exp_f32 v16, v16
    v_exp_f32 v17, v17
    v_exp_f32 v18, v18
    v_exp_f32 v19, v19
    v_exp_f32 v20, v20
    v_exp_f32 v21, v21
    v_exp_f32 v22, v22
    v_exp_f32 v23, v23
    v_cvt_pk_bf16_f32 v24, v16, v17
    v_cvt_pk_bf16_f32 v25, v18, v19
    v_cvt_pk_bf16_f32 v26, v20, v21
    v_cvt_pk_bf16_f32 v27, v22, v23
    ds_write_b64 v6, v[24:25]
    ds_write_b64 v6, v[26:27] offset:4096
    v_add_u32 v162, 0xc00, v5
    s_mov_b64 exec, s[88:89]
    ds_write_b32 v162, v161
    s_mov_b64 exec, -1
    v_mul_f32 v14, v14, v161
    v_add_f32 v16, v16, v20
    v_add_f32 v17, v17, v21
    v_add_f32 v18, v18, v22
    v_add_f32 v19, v19, v23
    v_add_f32 v16, v16, v18
    v_add_f32 v17, v17, v19
    v_add_f32 v16, v16, v17
    v_add_f32 v14, v14, v16
    v_lshlrev_b32 v3, 4, v1
    v_xor_b32 v3, s62, v3
    v_xor_b32 v15, 32, v3
    s_lshl_b32 s68, s3, 10
    s_waitcnt lgkmcnt(0)
    s_barrier
    ds_read_b128 v[16:19], v7 offset:0
    ds_read_b64_tr_b16 v[24:25], v9 offset:0
    ds_read_b64_tr_b16 v[26:27], v11 offset:0
    ds_read_b64_tr_b16 v[28:29], v10 offset:0
    ds_read_b64_tr_b16 v[30:31], v12 offset:0
    ds_read_b128 v[20:23], v7 offset:1024
    ds_read_b64_tr_b16 v[160:161], v9 offset:16384
    ds_read_b64_tr_b16 v[162:163], v11 offset:16384
    ds_read_b64_tr_b16 v[164:165], v10 offset:16384
    ds_read_b64_tr_b16 v[166:167], v12 offset:16384
    s_waitcnt lgkmcnt(7)
    v_mfma_f32_32x32x16_bf16 v[128:143], v[24:27], v[16:19], 0
    s_waitcnt lgkmcnt(5)
    v_mfma_f32_32x32x16_bf16 v[144:159], v[28:31], v[16:19], 0
    ds_read_b128 v[16:19], v7 offset:2048
    ds_read_b64_tr_b16 v[24:25], v9 offset:32768
    ds_read_b64_tr_b16 v[26:27], v11 offset:32768
    ds_read_b64_tr_b16 v[28:29], v10 offset:32768
    ds_read_b64_tr_b16 v[30:31], v12 offset:32768
    s_waitcnt lgkmcnt(7)
    v_mfma_f32_32x32x16_bf16 v[128:143], v[160:163], v[20:23], v[128:143]
    s_waitcnt lgkmcnt(5)
    v_mfma_f32_32x32x16_bf16 v[144:159], v[164:167], v[20:23], v[144:159]
    ds_read_b128 v[20:23], v7 offset:3072
    ds_read_b64_tr_b16 v[160:161], v9 offset:49152
    ds_read_b64_tr_b16 v[162:163], v11 offset:49152
    ds_read_b64_tr_b16 v[164:165], v10 offset:49152
    ds_read_b64_tr_b16 v[166:167], v12 offset:49152
    s_waitcnt lgkmcnt(7)
    v_mfma_f32_32x32x16_bf16 v[128:143], v[24:27], v[16:19], v[128:143]
    s_waitcnt lgkmcnt(5)
    v_mfma_f32_32x32x16_bf16 v[144:159], v[28:31], v[16:19], v[144:159]
    v_add_u32 v9, 0x10000, v9
    v_add_u32 v10, 0x10000, v10
    v_add_u32 v11, 0x10000, v11
    v_add_u32 v12, 0x10000, v12
    ds_read_b128 v[16:19], v7 offset:4096
    ds_read_b64_tr_b16 v[24:25], v9 offset:0
    ds_read_b64_tr_b16 v[26:27], v11 offset:0
    ds_read_b64_tr_b16 v[28:29], v10 offset:0
    ds_read_b64_tr_b16 v[30:31], v12 offset:0
    s_waitcnt lgkmcnt(7)
    v_mfma_f32_32x32x16_bf16 v[128:143], v[160:163], v[20:23], v[128:143]
    s_waitcnt lgkmcnt(5)
    v_mfma_f32_32x32x16_bf16 v[144:159], v[164:167], v[20:23], v[144:159]
    s_barrier
    s_mov_b32 m0, s68
    s_add_u32 s68, s68, 8192
    buffer_load_dwordx4 v3, s[44:47], s61 offen nt lds
    s_add_u32 s61, s61, 8192
    s_mov_b32 m0, s68
    s_add_u32 s68, s68, 8192
    buffer_load_dwordx4 v15, s[44:47], s61 offen nt lds
    s_add_u32 s61, s61, 8192
    s_mov_b32 m0, s68
    s_add_u32 s68, s68, 8192
    buffer_load_dwordx4 v3, s[44:47], s61 offen nt lds
    s_add_u32 s61, s61, 8192
    s_mov_b32 m0, s68
    s_add_u32 s68, s68, 8192
    buffer_load_dwordx4 v15, s[44:47], s61 offen nt lds
    s_add_u32 s61, s61, 8192
    ds_read_b128 v[20:23], v7 offset:5120
    ds_read_b64_tr_b16 v[160:161], v9 offset:16384
    ds_read_b64_tr_b16 v[162:163], v11 offset:16384
    ds_read_b64_tr_b16 v[164:165], v10 offset:16384
    ds_read_b64_tr_b16 v[166:167], v12 offset:16384
    s_waitcnt lgkmcnt(7)
    v_mfma_f32_32x32x16_bf16 v[128:143], v[24:27], v[16:19], v[128:143]
    s_waitcnt lgkmcnt(5)
    v_mfma_f32_32x32x16_bf16 v[144:159], v[28:31], v[16:19], v[144:159]
    s_mov_b32 m0, s68
    s_add_u32 s68, s68, 8192
    buffer_load_dwordx4 v3, s[44:47], s61 offen nt lds
    s_add_u32 s61, s61, 8192
    s_mov_b32 m0, s68
    s_add_u32 s68, s68, 8192
    buffer_load_dwordx4 v15, s[44:47], s61 offen nt lds
    s_add_u32 s61, s61, 8192
    s_mov_b32 m0, s68
    s_add_u32 s68, s68, 8192
    buffer_load_dwordx4 v3, s[44:47], s61 offen nt lds
    s_add_u32 s61, s61, 8192
    s_mov_b32 m0, s68
    s_add_u32 s68, s68, 8192
    buffer_load_dwordx4 v15, s[44:47], s61 offen nt lds
    s_add_u32 s61, s61, 8192
    ds_read_b128 v[16:19], v7 offset:6144
    ds_read_b64_tr_b16 v[24:25], v9 offset:32768
    ds_read_b64_tr_b16 v[26:27], v11 offset:32768
    ds_read_b64_tr_b16 v[28:29], v10 offset:32768
    ds_read_b64_tr_b16 v[30:31], v12 offset:32768
    s_waitcnt lgkmcnt(7)
    v_mfma_f32_32x32x16_bf16 v[128:143], v[160:163], v[20:23], v[128:143]
    s_waitcnt lgkmcnt(5)
    v_mfma_f32_32x32x16_bf16 v[144:159], v[164:167], v[20:23], v[144:159]
    ds_read_b128 v[20:23], v7 offset:7168
    ds_read_b64_tr_b16 v[160:161], v9 offset:49152
    ds_read_b64_tr_b16 v[162:163], v11 offset:49152
    ds_read_b64_tr_b16 v[164:165], v10 offset:49152
    ds_read_b64_tr_b16 v[166:167], v12 offset:49152
    s_waitcnt lgkmcnt(7)
    v_mfma_f32_32x32x16_bf16 v[128:143], v[24:27], v[16:19], v[128:143]
    s_waitcnt lgkmcnt(5)
    v_mfma_f32_32x32x16_bf16 v[144:159], v[28:31], v[16:19], v[144:159]
    s_waitcnt lgkmcnt(2)
    v_mfma_f32_32x32x16_bf16 v[128:143], v[160:163], v[20:23], v[128:143]
    s_waitcnt lgkmcnt(0)
    v_mfma_f32_32x32x16_bf16 v[144:159], v[164:167], v[20:23], v[144:159]
    v_add_u32 v9, 0xffff0000, v9
    v_add_u32 v10, 0xffff0000, v10
    v_add_u32 v11, 0xffff0000, v11
    v_add_u32 v12, 0xffff0000, v12
    s_lshl_b32 s7, s3, 10
    s_add_u32 s7, s7, 0x10000
    v_lshl_add_u32 v3, v1, 4, s7
    s_waitcnt vmcnt(8)
    s_barrier
    ds_write_b128 v3, v[96:99] offset:0
    ds_write_b128 v3, v[100:103] offset:8192
    ds_write_b128 v3, v[104:107] offset:16384
    ds_write_b128 v3, v[108:111] offset:24576
    ds_write_b128 v3, v[112:115] offset:32768
    ds_write_b128 v3, v[116:119] offset:40960
    ds_write_b128 v3, v[120:123] offset:49152
    ds_write_b128 v3, v[124:127] offset:57344
    s_waitcnt lgkmcnt(0)
    s_barrier
    v_xor_b32 v160, 0x0, v2
    ds_read_b128 v[24:27], v160
    v_xor_b32 v161, 0x10, v2
    ds_read_b128 v[28:31], v161
    v_xor_b32 v162, 0x20, v2
    ds_read_b128 v[164:167], v162
    v_xor_b32 v160, 0x30, v2
    ds_read_b128 v[96:99], v160
    v_xor_b32 v161, 0x40, v2
    ds_read_b128 v[100:103], v161
    v_xor_b32 v162, 0x50, v2
    ds_read_b128 v[104:107], v162
    v_xor_b32 v160, 0x60, v2
    ds_read_b128 v[108:111], v160
    s_waitcnt lgkmcnt(6)
    v_mfma_f32_16x16x32_bf16 v[20:23], v[24:27], v[32:35], 0
    v_xor_b32 v161, 0x70, v2
    ds_read_b128 v[24:27], v161
    s_waitcnt lgkmcnt(6)
    v_mfma_f32_16x16x32_bf16 v[20:23], v[28:31], v[36:39], v[20:23]
    v_xor_b32 v162, 0x80, v2
    ds_read_b128 v[28:31], v162
    s_waitcnt lgkmcnt(6)
    v_mfma_f32_16x16x32_bf16 v[20:23], v[164:167], v[40:43], v[20:23]
    v_xor_b32 v160, 0x90, v2
    ds_read_b128 v[164:167], v160
    s_waitcnt lgkmcnt(6)
    v_mfma_f32_16x16x32_bf16 v[20:23], v[96:99], v[44:47], v[20:23]
    v_xor_b32 v161, 0xa0, v2
    ds_read_b128 v[96:99], v161
    s_waitcnt lgkmcnt(6)
    v_mfma_f32_16x16x32_bf16 v[20:23], v[100:103], v[48:51], v[20:23]
    v_xor_b32 v162, 0xb0, v2
    ds_read_b128 v[100:103], v162
    s_waitcnt lgkmcnt(6)
    v_mfma_f32_16x16x32_bf16 v[20:23], v[104:107], v[52:55], v[20:23]
    v_xor_b32 v160, 0xc0, v2
    ds_read_b128 v[104:107], v160
    s_waitcnt lgkmcnt(6)
    v_mfma_f32_16x16x32_bf16 v[20:23], v[108:111], v[56:59], v[20:23]
    v_xor_b32 v161, 0xd0, v2
    ds_read_b128 v[108:111], v161
    s_waitcnt lgkmcnt(6)
    v_mfma_f32_16x16x32_bf16 v[20:23], v[24:27], v[60:63], v[20:23]
    v_xor_b32 v162, 0xe0, v2
    ds_read_b128 v[24:27], v162
    s_waitcnt lgkmcnt(6)
    v_mfma_f32_16x16x32_bf16 v[20:23], v[28:31], v[64:67], v[20:23]
    v_xor_b32 v160, 0xf0, v2
    ds_read_b128 v[28:31], v160
    s_waitcnt lgkmcnt(6)
    v_mfma_f32_16x16x32_bf16 v[20:23], v[164:167], v[68:71], v[20:23]
    s_waitcnt lgkmcnt(5)
    v_mfma_f32_16x16x32_bf16 v[20:23], v[96:99], v[72:75], v[20:23]
    s_waitcnt lgkmcnt(4)
    v_mfma_f32_16x16x32_bf16 v[20:23], v[100:103], v[76:79], v[20:23]
    s_waitcnt lgkmcnt(3)
    v_mfma_f32_16x16x32_bf16 v[20:23], v[104:107], v[80:83], v[20:23]
    s_waitcnt lgkmcnt(2)
    v_mfma_f32_16x16x32_bf16 v[20:23], v[108:111], v[84:87], v[20:23]
    s_waitcnt lgkmcnt(1)
    v_mfma_f32_16x16x32_bf16 v[20:23], v[24:27], v[88:91], v[20:23]
    s_waitcnt lgkmcnt(0)
    v_mfma_f32_16x16x32_bf16 v[20:23], v[28:31], v[92:95], v[20:23]
    s_waitcnt vmcnt(0)
    s_barrier
    v_xor_b32 v160, 0x0, v4
    ds_read_b128 v[24:27], v160
    v_xor_b32 v161, 0x10, v4
    ds_read_b128 v[28:31], v161
    v_xor_b32 v162, 0x20, v4
    ds_read_b128 v[164:167], v162
    v_xor_b32 v160, 0x30, v4
    ds_read_b128 v[96:99], v160
    v_xor_b32 v161, 0x40, v4
    ds_read_b128 v[100:103], v161
    v_xor_b32 v162, 0x50, v4
    ds_read_b128 v[104:107], v162
    v_xor_b32 v160, 0x60, v4
    ds_read_b128 v[108:111], v160
    s_waitcnt lgkmcnt(6)
    v_mfma_f32_16x16x32_bf16 v[16:19], v[24:27], v[32:35], 0
    v_xor_b32 v161, 0x70, v4
    ds_read_b128 v[24:27], v161
    s_waitcnt lgkmcnt(6)
    v_mfma_f32_16x16x32_bf16 v[16:19], v[28:31], v[36:39], v[16:19]
    v_xor_b32 v162, 0x80, v4
    ds_read_b128 v[28:31], v162
    s_waitcnt lgkmcnt(6)
    v_mfma_f32_16x16x32_bf16 v[16:19], v[164:167], v[40:43], v[16:19]
    v_xor_b32 v160, 0x90, v4
    ds_read_b128 v[164:167], v160
    s_waitcnt lgkmcnt(6)
    v_mfma_f32_16x16x32_bf16 v[16:19], v[96:99], v[44:47], v[16:19]
    v_xor_b32 v161, 0xa0, v4
    ds_read_b128 v[96:99], v161
    s_waitcnt lgkmcnt(6)
    v_mfma_f32_16x16x32_bf16 v[16:19], v[100:103], v[48:51], v[16:19]
    v_xor_b32 v162, 0xb0, v4
    ds_read_b128 v[100:103], v162
    s_waitcnt lgkmcnt(6)
    v_mfma_f32_16x16x32_bf16 v[16:19], v[104:107], v[52:55], v[16:19]
    v_xor_b32 v160, 0xc0, v4
    ds_read_b128 v[104:107], v160
    s_waitcnt lgkmcnt(6)
    v_mfma_f32_16x16x32_bf16 v[16:19], v[108:111], v[56:59], v[16:19]
    v_xor_b32 v161, 0xd0, v4
    ds_read_b128 v[108:111], v161
    s_waitcnt lgkmcnt(6)
    v_mfma_f32_16x16x32_bf16 v[16:19], v[24:27], v[60:63], v[16:19]
    v_xor_b32 v162, 0xe0, v4
    ds_read_b128 v[24:27], v162
    s_waitcnt lgkmcnt(6)
    v_mfma_f32_16x16x32_bf16 v[16:19], v[28:31], v[64:67], v[16:19]
    v_xor_b32 v160, 0xf0, v4
    ds_read_b128 v[28:31], v160
    s_waitcnt lgkmcnt(6)
    v_mfma_f32_16x16x32_bf16 v[16:19], v[164:167], v[68:71], v[16:19]
    s_waitcnt lgkmcnt(5)
    v_mfma_f32_16x16x32_bf16 v[16:19], v[96:99], v[72:75], v[16:19]
    s_waitcnt lgkmcnt(4)
    v_mfma_f32_16x16x32_bf16 v[16:19], v[100:103], v[76:79], v[16:19]
    s_waitcnt lgkmcnt(3)
    v_mfma_f32_16x16x32_bf16 v[16:19], v[104:107], v[80:83], v[16:19]
    s_waitcnt lgkmcnt(2)
    v_mfma_f32_16x16x32_bf16 v[16:19], v[108:111], v[84:87], v[16:19]
    s_waitcnt lgkmcnt(1)
    v_mfma_f32_16x16x32_bf16 v[16:19], v[24:27], v[88:91], v[16:19]
    s_waitcnt lgkmcnt(0)
    v_mfma_f32_16x16x32_bf16 v[16:19], v[28:31], v[92:95], v[16:19]
    s_nop 7
    v_max3_f32 v160, v16, v17, v18
    v_max3_f32 v160, v160, v19, v20
    v_max3_f32 v160, v160, v21, v22
    v_max_f32 v160, v160, v23
    v_mov_b32 v161, v160
    s_nop 1
    v_permlane32_swap_b32 v160, v161
    v_max_f32 v160, v160, v161
    v_mov_b32 v161, v160
    s_nop 1
    v_permlane16_swap_b32 v160, v161
    v_max_f32 v160, v160, v161
    s_lshl_b32 s7, s64, 7
    v_add_u32 v161, s7, v5
    s_mov_b64 exec, s[86:87]
    ds_write_b32 v161, v160
    s_mov_b64 exec, -1
    s_waitcnt lgkmcnt(0)
    s_barrier
    ds_read_b32 v160, v5 offset:0
    ds_read_b32 v161, v5 offset:128
    ds_read_b32 v162, v5 offset:256
    ds_read_b32 v163, v5 offset:384
    s_waitcnt lgkmcnt(0)
    v_max3_f32 v160, v160, v161, v162
    v_max_f32 v160, v160, v163
    v_mul_f32 v160, s67, v160
    v_max_f32 v160, v160, v13
    v_sub_f32 v161, v13, v160
    v_exp_f32 v161, v161
    v_mov_b32 v13, v160
    v_fma_f32 v16, v16, s67, -v160
    v_fma_f32 v17, v17, s67, -v160
    v_fma_f32 v18, v18, s67, -v160
    v_fma_f32 v19, v19, s67, -v160
    v_fma_f32 v20, v20, s67, -v160
    v_fma_f32 v21, v21, s67, -v160
    v_fma_f32 v22, v22, s67, -v160
    v_fma_f32 v23, v23, s67, -v160
    v_exp_f32 v16, v16
    v_exp_f32 v17, v17
    v_exp_f32 v18, v18
    v_exp_f32 v19, v19
    v_exp_f32 v20, v20
    v_exp_f32 v21, v21
    v_exp_f32 v22, v22
    v_exp_f32 v23, v23
    v_cvt_pk_bf16_f32 v24, v16, v17
    v_cvt_pk_bf16_f32 v25, v18, v19
    v_cvt_pk_bf16_f32 v26, v20, v21
    v_cvt_pk_bf16_f32 v27, v22, v23
    ds_write_b64 v6, v[24:25]
    ds_write_b64 v6, v[26:27] offset:4096
    v_add_u32 v162, 0xc00, v5
    s_mov_b64 exec, s[88:89]
    ds_write_b32 v162, v161
    s_mov_b64 exec, -1
    v_mul_f32 v14, v14, v161
    v_add_f32 v16, v16, v20
    v_add_f32 v17, v17, v21
    v_add_f32 v18, v18, v22
    v_add_f32 v19, v19, v23
    v_add_f32 v16, v16, v18
    v_add_f32 v17, v17, v19
    v_add_f32 v16, v16, v17
    v_add_f32 v14, v14, v16
    v_mov_b32 v160, v14
    s_nop 1
    v_permlane32_swap_b32 v14, v160
    v_add_f32 v14, v14, v160
    v_mov_b32 v160, v14
    s_nop 1
    s_branch LC_CR
.p2align 12
LT_CR2:
    s_branch LR_CR2
LC_CR:
    v_permlane16_swap_b32 v14, v160
    v_add_f32 v14, v14, v160
    s_lshl_b32 s7, s64, 7
    s_add_u32 s7, s7, 0x200
    v_add_u32 v161, s7, v5
    v_add_u32 v162, 0xc80, v5
    s_mov_b64 exec, s[86:87]
    ds_write_b32 v161, v14
    s_mov_b64 exec, s[88:89]
    ds_write_b32 v162, v13
    s_mov_b64 exec, -1
    v_and_b32 v160, 31, v1
    v_lshlrev_b32 v98, 7, v160
    v_lshrrev_b32 v161, 5, v1
    v_and_b32 v160, 7, v1
    v_xor_b32 v161, v160, v161
    v_lshl_add_u32 v98, v161, 4, v98
    s_lshl_b32 s7, s3, 12
    v_add_u32 v98, s7, v98
    v_lshl_add_u32 v99, v1, 4, s7
    v_lshrrev_b32 v161, 3, v1
    v_xor_b32 v160, v160, v161
    v_lshlrev_b32 v100, 7, v161
    v_lshl_add_u32 v100, v160, 4, v100
    s_lshl_b32 s69, s60, 15
    s_add_u32 s69, s69, s7
    s_add_u32 s69, s69, 0x500000
    s_waitcnt lgkmcnt(0)
    s_barrier
    ds_read_b32 v15, v8
    ds_read_b128 v[16:19], v7 offset:0
    ds_read_b64_tr_b16 v[24:25], v9 offset:0
    ds_read_b64_tr_b16 v[26:27], v11 offset:0
    ds_read_b64_tr_b16 v[28:29], v10 offset:0
    ds_read_b64_tr_b16 v[30:31], v12 offset:0
    s_waitcnt lgkmcnt(5)
    v_mul_f32 v128, v15, v128
    v_mul_f32 v129, v15, v129
    v_mul_f32 v130, v15, v130
    v_mul_f32 v131, v15, v131
    v_mul_f32 v132, v15, v132
    v_mul_f32 v133, v15, v133
    v_mul_f32 v134, v15, v134
    v_mul_f32 v135, v15, v135
    v_mul_f32 v136, v15, v136
    v_mul_f32 v137, v15, v137
    v_mul_f32 v138, v15, v138
    v_mul_f32 v139, v15, v139
    v_mul_f32 v140, v15, v140
    v_mul_f32 v141, v15, v141
    v_mul_f32 v142, v15, v142
    v_mul_f32 v143, v15, v143
    v_mul_f32 v144, v15, v144
    v_mul_f32 v145, v15, v145
    v_mul_f32 v146, v15, v146
    v_mul_f32 v147, v15, v147
    v_mul_f32 v148, v15, v148
    v_mul_f32 v149, v15, v149
    v_mul_f32 v150, v15, v150
    v_mul_f32 v151, v15, v151
    v_mul_f32 v152, v15, v152
    v_mul_f32 v153, v15, v153
    v_mul_f32 v154, v15, v154
    v_mul_f32 v155, v15, v155
    v_mul_f32 v156, v15, v156
    v_mul_f32 v157, v15, v157
    v_mul_f32 v158, v15, v158
    v_mul_f32 v159, v15, v159
    ds_read_b128 v[20:23], v7 offset:1024
    ds_read_b64_tr_b16 v[160:161], v9 offset:16384
    ds_read_b64_tr_b16 v[162:163], v11 offset:16384
    ds_read_b64_tr_b16 v[164:165], v10 offset:16384
    ds_read_b64_tr_b16 v[166:167], v12 offset:16384
    s_waitcnt lgkmcnt(7)
    v_mfma_f32_32x32x16_bf16 v[128:143], v[24:27], v[16:19], v[128:143]
    s_waitcnt lgkmcnt(5)
    v_mfma_f32_32x32x16_bf16 v[144:159], v[28:31], v[16:19], v[144:159]
    ds_read_b128 v[16:19], v7 offset:2048
    ds_read_b64_tr_b16 v[24:25], v9 offset:32768
    ds_read_b64_tr_b16 v[26:27], v11 offset:32768
    ds_read_b64_tr_b16 v[28:29], v10 offset:32768
    ds_read_b64_tr_b16 v[30:31], v12 offset:32768
    s_waitcnt lgkmcnt(7)
    v_mfma_f32_32x32x16_bf16 v[128:143], v[160:163], v[20:23], v[128:143]
    s_waitcnt lgkmcnt(5)
    v_mfma_f32_32x32x16_bf16 v[144:159], v[164:167], v[20:23], v[144:159]
    ds_read_b128 v[20:23], v7 offset:3072
    ds_read_b64_tr_b16 v[160:161], v9 offset:49152
    ds_read_b64_tr_b16 v[162:163], v11 offset:49152
    ds_read_b64_tr_b16 v[164:165], v10 offset:49152
    ds_read_b64_tr_b16 v[166:167], v12 offset:49152
    s_waitcnt lgkmcnt(7)
    v_mfma_f32_32x32x16_bf16 v[128:143], v[24:27], v[16:19], v[128:143]
    s_waitcnt lgkmcnt(5)
    v_mfma_f32_32x32x16_bf16 v[144:159], v[28:31], v[16:19], v[144:159]
    v_add_u32 v9, 0x10000, v9
    v_add_u32 v10, 0x10000, v10
    v_add_u32 v11, 0x10000, v11
    v_add_u32 v12, 0x10000, v12
    ds_read_b128 v[16:19], v7 offset:4096
    ds_read_b64_tr_b16 v[24:25], v9 offset:0
    ds_read_b64_tr_b16 v[26:27], v11 offset:0
    ds_read_b64_tr_b16 v[28:29], v10 offset:0
    ds_read_b64_tr_b16 v[30:31], v12 offset:0
    s_waitcnt lgkmcnt(7)
    v_mfma_f32_32x32x16_bf16 v[128:143], v[160:163], v[20:23], v[128:143]
    s_waitcnt lgkmcnt(5)
    v_mfma_f32_32x32x16_bf16 v[144:159], v[164:167], v[20:23], v[144:159]
    s_barrier
    ds_read_b128 v[20:23], v7 offset:5120
    ds_read_b64_tr_b16 v[160:161], v9 offset:16384
    ds_read_b64_tr_b16 v[162:163], v11 offset:16384
    ds_read_b64_tr_b16 v[164:165], v10 offset:16384
    ds_read_b64_tr_b16 v[166:167], v12 offset:16384
    s_waitcnt lgkmcnt(7)
    v_mfma_f32_32x32x16_bf16 v[128:143], v[24:27], v[16:19], v[128:143]
    s_waitcnt lgkmcnt(5)
    v_mfma_f32_32x32x16_bf16 v[144:159], v[28:31], v[16:19], v[144:159]
    ds_read_b128 v[16:19], v7 offset:6144
    ds_read_b64_tr_b16 v[24:25], v9 offset:32768
    ds_read_b64_tr_b16 v[26:27], v11 offset:32768
    ds_read_b64_tr_b16 v[28:29], v10 offset:32768
    ds_read_b64_tr_b16 v[30:31], v12 offset:32768
    s_waitcnt lgkmcnt(7)
    v_mfma_f32_32x32x16_bf16 v[128:143], v[160:163], v[20:23], v[128:143]
    s_waitcnt lgkmcnt(5)
    v_mfma_f32_32x32x16_bf16 v[144:159], v[164:167], v[20:23], v[144:159]
    ds_read_b128 v[20:23], v7 offset:7168
    ds_read_b64_tr_b16 v[160:161], v9 offset:49152
    ds_read_b64_tr_b16 v[162:163], v11 offset:49152
    ds_read_b64_tr_b16 v[164:165], v10 offset:49152
    ds_read_b64_tr_b16 v[166:167], v12 offset:49152
    s_waitcnt lgkmcnt(7)
    v_mfma_f32_32x32x16_bf16 v[128:143], v[24:27], v[16:19], v[128:143]
    s_waitcnt lgkmcnt(5)
    v_mfma_f32_32x32x16_bf16 v[144:159], v[28:31], v[16:19], v[144:159]
    s_waitcnt lgkmcnt(2)
    v_mfma_f32_32x32x16_bf16 v[128:143], v[160:163], v[20:23], v[128:143]
    s_waitcnt lgkmcnt(0)
    v_mfma_f32_32x32x16_bf16 v[144:159], v[164:167], v[20:23], v[144:159]
    s_nop 9
    v_permlane32_swap_b32 v128, v132
    v_permlane32_swap_b32 v129, v133
    v_permlane32_swap_b32 v130, v134
    v_permlane32_swap_b32 v131, v135
    v_cvt_pk_bf16_f32 v16, v128, v129
    v_cvt_pk_bf16_f32 v17, v130, v131
    v_cvt_pk_bf16_f32 v18, v132, v133
    v_cvt_pk_bf16_f32 v19, v134, v135
    v_xor_b32 v160, 0x0, v98
    ds_write_b128 v160, v[16:19]
    v_permlane32_swap_b32 v136, v140
    v_permlane32_swap_b32 v137, v141
    v_permlane32_swap_b32 v138, v142
    v_permlane32_swap_b32 v139, v143
    v_cvt_pk_bf16_f32 v20, v136, v137
    v_cvt_pk_bf16_f32 v21, v138, v139
    v_cvt_pk_bf16_f32 v22, v140, v141
    v_cvt_pk_bf16_f32 v23, v142, v143
    v_xor_b32 v161, 0x20, v98
    ds_write_b128 v161, v[20:23]
    v_permlane32_swap_b32 v144, v148
    v_permlane32_swap_b32 v145, v149
    v_permlane32_swap_b32 v146, v150
    v_permlane32_swap_b32 v147, v151
    v_cvt_pk_bf16_f32 v24, v144, v145
    v_cvt_pk_bf16_f32 v25, v146, v147
    v_cvt_pk_bf16_f32 v26, v148, v149
    v_cvt_pk_bf16_f32 v27, v150, v151
    v_xor_b32 v160, 0x40, v98
    ds_write_b128 v160, v[24:27]
    v_permlane32_swap_b32 v152, v156
    v_permlane32_swap_b32 v153, v157
    v_permlane32_swap_b32 v154, v158
    v_permlane32_swap_b32 v155, v159
    v_cvt_pk_bf16_f32 v28, v152, v153
    v_cvt_pk_bf16_f32 v29, v154, v155
    v_cvt_pk_bf16_f32 v30, v156, v157
    v_cvt_pk_bf16_f32 v31, v158, v159
    v_xor_b32 v161, 0x60, v98
    ds_write_b128 v161, v[28:31]
    ds_read_b128 v[32:35], v99 offset:0
    ds_read_b128 v[36:39], v99 offset:1024
    ds_read_b128 v[40:43], v99 offset:2048
    ds_read_b128 v[44:47], v99 offset:3072
    s_waitcnt lgkmcnt(3)
    buffer_store_dwordx4 v[32:35], v100, s[36:39], s69 offen offset:0 sc1
    s_waitcnt lgkmcnt(2)
    buffer_store_dwordx4 v[36:39], v100, s[36:39], s69 offen offset:1024 sc1
    s_waitcnt lgkmcnt(1)
    buffer_store_dwordx4 v[40:43], v100, s[36:39], s69 offen offset:2048 sc1
    s_waitcnt lgkmcnt(0)
    buffer_store_dwordx4 v[44:47], v100, s[36:39], s69 offen offset:3072 sc1
    v_mov_b32 v160, 0x2404c
    s_mov_b32 s80, 1600000
LW_89:
    ds_read_b32 v161, v160
    s_waitcnt lgkmcnt(0)
    v_readfirstlane_b32 s79, v161
    s_cmp_ge_u32 s79, 1
    s_cbranch_scc1 LWD_90
    s_sleep 2
    s_sub_u32 s80, s80, 1
    s_cmp_lg_u32 s80, 0
    s_cbranch_scc1 LW_89
LWD_90:
    v_mov_b32 v160, 0x24050
    ds_read_b64 v[162:163], v160
    s_waitcnt lgkmcnt(0)
    v_readfirstlane_b32 s94, v162
    v_readfirstlane_b32 s95, v163
    v_and_b32 v160, 31, v1
    v_lshlrev_b32 v3, 2, v160
    v_add_u32 v3, 0x27400, v3
    s_lshl_b32 s7, s60, 9
    s_add_u32 s7, s7, 0xe0000
    s_cmp_eq_u32 s3, 0
    s_cselect_b32 s7, s7, 0x40000000
    v_lshl_add_u32 v4, v160, 4, s7
    v_mov_b32 v22, s94
    v_mov_b32 v23, s95
    ds_read_b32 v16, v3 offset:0
    ds_read_b32 v17, v3 offset:128
    ds_read_b32 v18, v3 offset:256
    ds_read_b32 v19, v3 offset:384
    ds_read_b32 v20, v3 offset:2688
    s_waitcnt lgkmcnt(0)
    v_add_f32 v16, v16, v17
    v_add_f32 v18, v18, v19
    v_add_f32 v21, v16, v18
    s_waitcnt vmcnt(0)
    s_barrier
    s_mov_b64 exec, 0xffffffff
    buffer_store_dwordx4 v[20:23], v4, s[36:39], 0 offen sc1
    s_mov_b64 exec, -1
    v_lshlrev_b32 v2, 4, v1
    s_mov_b32 s44, s12
    s_and_b32 s45, s13, 0xffff
    s_mov_b32 s46, 0x8000000
    s_mov_b32 s47, 0x20000
    s_bfe_u32 s7, s5, 0x10002
    s_lshl_b32 s7, s7, 6
    s_add_u32 s7, s7, s6
    s_lshl_b32 s7, s7, 20
    s_lshl_b32 s72, s3, 10
    s_add_u32 s72, s72, s7
    s_add_u32 s72, s72, 1040384
    s_add_u32 s73, s72, 0x2000000
    s_mov_b32 s74, 4
    s_sleep 60
PV_91:
    s_waitcnt vmcnt(3)
    buffer_load_dwordx4 v[8:11], v2, s[44:47], s72 offen
    s_sub_u32 s72, s72, 8192
    s_waitcnt vmcnt(3)
    buffer_load_dwordx4 v[8:11], v2, s[44:47], s73 offen
    s_sub_u32 s73, s73, 8192
    s_sub_u32 s74, s74, 1
    s_cmp_lg_u32 s74, 0
    s_cbranch_scc1 PV_91
    s_mov_b32 s52, s30
    s_and_b32 s53, s31, 0xffff
    s_mov_b32 s54, 0x2000
    s_mov_b32 s55, 0x20000
    s_lshl_b32 s7, s60, 3
    s_add_u32 s7, s7, s3
    s_lshl_b32 s7, s7, 10
    s_add_u32 s7, s7, 0x100000
    v_add_u32 v4, s7, v2
    s_bfe_u32 s7, s60, 0x20003
    s_lshl_b32 s7, s7, 11
    s_lshr_b32 s66, s60, 5
    s_lshl_b32 s66, s66, 10
    s_add_u32 s7, s7, s66
    s_and_b32 s66, s60, 7
    s_lshl_b32 s66, s66, 7
    s_add_u32 s7, s7, s66
    v_and_b32 v5, 7, v1
    v_lshl_add_u32 v5, v5, 4, s7
    v_lshrrev_b32 v6, 4, v1
    v_lshl_add_u32 v5, v6, 2, v5
    s_mov_b32 s90, 0x00ff00ff
    s_mov_b32 s91, 0x00ff00ff
    s_lshl_b32 s7, s3, 10
    s_add_u32 s7, s7, 0x25200
    v_add_u32 v6, s7, v2
    s_mov_b32 s80, 200000
PO_92:
    buffer_load_dwordx4 v[32:35], v4, s[36:39], 0 offen sc1
PO2_93:
    s_waitcnt vmcnt(0)
    v_cmp_ne_u64 vcc, s[94:95], v[34:35]
    s_cmp_lg_u64 vcc, -1
    s_cbranch_scc1 POD_94
    s_sleep 20
    s_sub_u32 s80, s80, 1
    s_cmp_lg_u32 s80, 0
    s_cbranch_scc1 PO_92
POD_94:
    v_lshlrev_b32 v64, 16, v32
    v_and_b32 v65, 0xffff0000, v32
    v_lshlrev_b32 v66, 16, v33
    v_and_b32 v67, 0xffff0000, v33
    s_cbranch_vccz RD_95
    buffer_load_dwordx4 v[32:35], v4, s[36:39], 0 offen sc1
    s_sleep 4
    buffer_load_dwordx4 v[36:39], v4, s[36:39], 0 offen sc1
    s_sleep 4
    s_mov_b32 s80, 200000
PP_96:
    s_waitcnt vmcnt(1)
    v_cmp_ne_u64 vcc, s[94:95], v[34:35]
    s_cmp_eq_u64 vcc, 0
    s_cbranch_scc1 PPO_98
    buffer_load_dwordx4 v[32:35], v4, s[36:39], 0 offen sc1
    s_waitcnt vmcnt(1)
    v_cmp_ne_u64 vcc, s[94:95], v[38:39]
    s_cmp_eq_u64 vcc, 0
    s_cbranch_scc1 PPO_99
    buffer_load_dwordx4 v[36:39], v4, s[36:39], 0 offen sc1
    s_sub_u32 s80, s80, 1
    s_cmp_lg_u32 s80, 0
    s_cbranch_scc1 PP_96
PPO_98:
    v_lshlrev_b32 v64, 16, v32
    v_and_b32 v65, 0xffff0000, v32
    v_lshlrev_b32 v66, 16, v33
    v_and_b32 v67, 0xffff0000, v33
    s_branch PPD_97
PPO_99:
    v_lshlrev_b32 v64, 16, v36
    v_and_b32 v65, 0xffff0000, v36
    v_lshlrev_b32 v66, 16, v37
    v_and_b32 v67, 0xffff0000, v37
PPD_97:
RD_95:
    ds_write_b128 v6, v[64:67]
    s_waitcnt lgkmcnt(0)
    s_barrier
    s_cmp_lg_u32 s3, 0
    s_cbranch_scc1 L_END
    ds_read_b128 v[64:67], v6 offset:0
    ds_read_b128 v[68:71], v6 offset:1024
    ds_read_b128 v[72:75], v6 offset:2048
    ds_read_b128 v[76:79], v6 offset:3072
    ds_read_b128 v[80:83], v6 offset:4096
    ds_read_b128 v[84:87], v6 offset:5120
    ds_read_b128 v[88:91], v6 offset:6144
    ds_read_b128 v[92:95], v6 offset:7168
    s_waitcnt lgkmcnt(4)
    v_pk_add_f32 v[64:65], v[64:65], v[72:73]
    v_pk_add_f32 v[66:67], v[66:67], v[74:75]
    v_pk_add_f32 v[68:69], v[68:69], v[76:77]
    v_pk_add_f32 v[70:71], v[70:71], v[78:79]
    v_pk_add_f32 v[64:65], v[64:65], v[68:69]
    v_pk_add_f32 v[66:67], v[66:67], v[70:71]
    s_waitcnt lgkmcnt(0)
    v_pk_add_f32 v[80:81], v[80:81], v[88:89]
    v_pk_add_f32 v[82:83], v[82:83], v[90:91]
    v_pk_add_f32 v[84:85], v[84:85], v[92:93]
    v_pk_add_f32 v[86:87], v[86:87], v[94:95]
    v_pk_add_f32 v[80:81], v[80:81], v[84:85]
    v_pk_add_f32 v[82:83], v[82:83], v[86:87]
    s_nop 0
    v_permlane32_swap_b32 v64, v80
    v_permlane32_swap_b32 v65, v81
    v_permlane32_swap_b32 v66, v82
    v_permlane32_swap_b32 v67, v83
    v_add_f32 v64, v64, v80
    v_add_f32 v65, v65, v81
    v_add_f32 v66, v66, v82
    v_add_f32 v67, v67, v83
    s_nop 0
    v_permlane16_swap_b32 v64, v66
    v_permlane16_swap_b32 v65, v67
    v_add_f32 v64, v64, v66
    v_add_f32 v65, v65, v67
    s_nop 0
    v_add_f32_dpp v64, v64, v64 row_ror:8 row_mask:0xf bank_mask:0xf
    v_add_f32_dpp v65, v65, v65 row_ror:8 row_mask:0xf bank_mask:0xf
    v_cvt_pk_bf16_f32 v8, v64, v65
    s_mov_b64 exec, s[90:91]
    buffer_store_dword v8, v5, s[52:55], 0 offen
    s_mov_b64 exec, -1
    s_endpgm
L_CODE_END:
.section .rodata,"a"
.p2align 6
.amdhsa_kernel concat_heads__sliding_block_cached__compressed_kv_cla__decode_kernel
  .amdhsa_next_free_vgpr 168
  .amdhsa_next_free_sgpr 102
  .amdhsa_accum_offset 168
  .amdhsa_group_segment_fixed_size 0
  .amdhsa_kernarg_size 112
  .amdhsa_user_sgpr_count 2
  .amdhsa_user_sgpr_kernarg_segment_ptr 1
  .amdhsa_system_sgpr_workgroup_id_x 1
  .amdhsa_float_denorm_mode_32 3
.end_amdhsa_kernel
```

```asm
; @launch grid=(256,1,1) block=(768,1,1) lds=163840
.amdgcn_target "amdgcn-amd-amdhsa--gfx950"
.text
.globl concat_heads__sliding_block_cached__compressed_kv_cla__decode_kernel
.p2align 12
.p2align 8
.type concat_heads__sliding_block_cached__compressed_kv_cla__decode_kernel,@function
concat_heads__sliding_block_cached__compressed_kv_cla__decode_kernel:
    s_load_dwordx16 s[8:23], s[0:1], 0
    s_load_dwordx8 s[24:31], s[0:1], 64
    s_load_dwordx4 s[32:35], s[0:1], 96
    v_lshrrev_b32 v1, 6, v0
    s_and_b32 s4, s2, 7
    v_readfirstlane_b32 s3, v1
    s_lshr_b32 s5, s2, 3
    v_and_b32 v1, 63, v0
    s_and_b32 s7, s5, 3
    s_lshl2_add_u32 s6, s4, s7
    s_cmp_ge_u32 s5, 32
    s_cbranch_scc1 L_END0
    s_cmp_ge_u32 s5, 16
    s_cbranch_scc1 EA_1
    s_cmp_ge_u32 s5, 8
    s_cbranch_scc1 EC_2
    s_cmp_ge_u32 s3, 8
    s_cbranch_scc1 L_W2
    s_cmp_ge_u32 s3, 4
    s_cbranch_scc1 L_W1
    s_branch L_W
EC_2:
    s_cmp_ge_u32 s3, 8
    s_cbranch_scc1 L_CSVC
    s_branch L_C
EA_1:
    s_cmp_eq_u32 s3, 11
    s_cbranch_scc1 L_ASVC
    s_branch L_AA
L_W2:
    s_sub_u32 s62, s3, 8
    s_lshl_b32 s7, s5, 2
    s_add_u32 s7, s7, s62
    s_lshl_b32 s7, s7, 17
    s_lshl_b32 s70, s4, 10
    s_add_u32 s70, s70, s7
    s_lshl_b32 s71, s62, 14
    v_lshlrev_b32 v2, 4, v1
    s_lshl_b32 s7, s62, 6
    v_xor_b32 v4, s7, v2
    v_xor_b32 v5, 16, v4
    v_xor_b32 v6, 32, v4
    v_xor_b32 v7, 48, v4
    s_waitcnt lgkmcnt(0)
    s_lshl_b32 s7, s2, 4
    s_add_u32 s7, s7, s3
    s_cmp_lg_u32 s7, 8
    s_cbranch_scc1 NM_61
    s_memrealtime s[94:95]
    s_mov_b32 s40, s32
    s_and_b32 s41, s33, 0xffff
    s_mov_b32 s42, 0x100
    s_mov_b32 s43, 0x20000
    v_mov_b32 v8, 0
    s_waitcnt lgkmcnt(0)
    s_or_b32 s95, s95, 0x80000000
    v_mov_b32 v10, s94
    v_mov_b32 v11, s95
    s_mov_b64 exec, 1
    buffer_store_dwordx2 v[10:11], v8, s[40:43], 0 offen sc1
    s_mov_b64 exec, -1
NM_61:
    s_mov_b32 s52, s24
    s_and_b32 s53, s25, 0xffff
    s_mov_b32 s54, 0x400000
    s_mov_b32 s55, 0x20000
    s_mov_b32 m0, s71
    s_nop 0
    buffer_load_dwordx4 v4, s[52:55], s70 offen nt lds
    s_addk_i32 s70, 8192
    s_addk_i32 s71, 1024
    s_mov_b32 m0, s71
    s_nop 0
    buffer_load_dwordx4 v4, s[52:55], s70 offen nt lds
    s_addk_i32 s70, 8192
    s_addk_i32 s71, 1024
    s_mov_b32 m0, s71
    s_nop 0
    buffer_load_dwordx4 v4, s[52:55], s70 offen nt lds
    s_addk_i32 s70, 8192
    s_addk_i32 s71, 1024
    s_mov_b32 m0, s71
    s_nop 0
    buffer_load_dwordx4 v4, s[52:55], s70 offen nt lds
    s_addk_i32 s70, 8192
    s_addk_i32 s71, 1024
    s_mov_b32 m0, s71
    s_nop 0
    buffer_load_dwordx4 v5, s[52:55], s70 offen nt lds
    s_addk_i32 s70, 8192
    s_addk_i32 s71, 1024
    s_mov_b32 m0, s71
    s_nop 0
    buffer_load_dwordx4 v5, s[52:55], s70 offen nt lds
    s_addk_i32 s70, 8192
    s_addk_i32 s71, 1024
    s_mov_b32 m0, s71
    s_nop 0
    buffer_load_dwordx4 v5, s[52:55], s70 offen nt lds
    s_addk_i32 s70, 8192
    s_addk_i32 s71, 1024
    s_mov_b32 m0, s71
    s_nop 0
    buffer_load_dwordx4 v5, s[52:55], s70 offen nt lds
    s_addk_i32 s70, 8192
    s_addk_i32 s71, 1024
    s_branch L_W2B
L_AA:
    s_cmp_ge_u32 s3, 8
    s_cbranch_scc1 AK_3
    s_and_b32 s7, s5, 12
    s_and_b32 s66, s3, 3
    s_add_u32 s7, s7, s66
    v_lshrrev_b32 v2, 4, v1
    v_lshlrev_b32 v3, 16, v2
    v_and_b32 v4, 15, v1
    v_lshl_add_u32 v3, v4, 4, v3
    s_lshl_b32 s66, s7, 18
    s_lshl_b32 s67, s6, 8
    s_add_u32 s66, s66, s67
    s_cmp_lt_u32 s3, 4
    s_cbranch_scc1 AP_5
    s_barrier
    s_sleep 26
AP_5:
    s_cmp_lt_u32 s3, 4
    s_waitcnt lgkmcnt(0)
    s_cselect_b32 s72, s22, s14
    s_cselect_b32 s73, s23, s15
    s_cselect_b32 s70, s18, s8
    s_cselect_b32 s71, s19, s9
    s_mov_b32 s56, s72
    s_and_b32 s57, s73, 0xffff
    s_mov_b32 s58, 0x400000
    s_mov_b32 s59, 0x20000
    buffer_load_dwordx4 v[128:131], v3, s[56:59], s66 offen nt
    s_addk_i32 s66, 8192
    buffer_load_dwordx4 v[132:135], v3, s[56:59], s66 offen nt
    s_addk_i32 s66, 8192
    buffer_load_dwordx4 v[136:139], v3, s[56:59], s66 offen nt
    s_addk_i32 s66, 8192
    buffer_load_dwordx4 v[140:143], v3, s[56:59], s66 offen nt
    s_addk_i32 s66, 8192
    buffer_load_dwordx4 v[144:147], v3, s[56:59], s66 offen nt
    s_addk_i32 s66, 8192
    buffer_load_dwordx4 v[148:151], v3, s[56:59], s66 offen nt
    s_addk_i32 s66, 8192
    buffer_load_dwordx4 v[152:155], v3, s[56:59], s66 offen nt
    s_addk_i32 s66, 8192
    buffer_load_dwordx4 v[156:159], v3, s[56:59], s66 offen nt
    s_addk_i32 s66, 8192
    s_branch L_AB
L_C:
    s_lshl_b32 s60, s4, 3
    s_add_u32 s60, s60, s5
    s_sub_u32 s60, s60, 8
    v_lshlrev_b32 v160, 4, v1
    s_and_b32 s7, s3, 3
    s_lshl_b32 s7, s7, 2
    s_lshr_b32 s66, s3, 2
    s_or_b32 s7, s7, s66
    s_lshl_b32 s62, s7, 4
    v_xor_b32 v2, s62, v160
    v_xor_b32 v3, 32, v2
    s_lshl_b32 s70, s60, 18
    s_lshl_b32 s68, s3, 10
    s_add_u32 s61, s70, s68
    s_waitcnt lgkmcnt(0)
    s_mov_b32 s44, s20
    s_and_b32 s45, s21, 0xffff
    s_mov_b32 s46, 0x1000000
    s_mov_b32 s47, 0x20000
    s_mov_b32 m0, s68
    s_nop 0
    buffer_load_dwordx4 v2, s[44:47], s61 offen nt lds
    s_addk_i32 s68, 8192
    s_addk_i32 s61, 8192
    s_mov_b32 m0, s68
    s_nop 0
    buffer_load_dwordx4 v3, s[44:47], s61 offen nt lds
    s_addk_i32 s68, 8192
    s_addk_i32 s61, 8192
    s_mov_b32 m0, s68
    s_nop 0
    buffer_load_dwordx4 v2, s[44:47], s61 offen nt lds
    s_addk_i32 s68, 8192
    s_addk_i32 s61, 8192
    s_mov_b32 m0, s68
    s_nop 0
    buffer_load_dwordx4 v3, s[44:47], s61 offen nt lds
    s_addk_i32 s68, 8192
    s_branch L_CB
L_AB:
    v_bfe_u32 v4, v1, 2, 2
    v_lshlrev_b32 v4, 10, v4
    v_lshl_add_u32 v4, v2, 4, v4
    s_lshl_b32 s67, s7, 6
    s_mov_b32 s52, s70
    s_and_b32 s53, s71, 0xffff
    s_mov_b32 s54, 0x1000
    s_mov_b32 s55, 0x20000
    buffer_load_dwordx4 v[160:163], v4, s[52:55], s67 offen
    s_mov_b32 s92, 0x05040100
    s_mov_b32 s93, 0x07060302
    s_mov_b32 s36, s34
    s_and_b32 s37, s35, 0xffff
    s_mov_b32 s38, 0x1000000
    s_mov_b32 s39, 0x20000
    s_mov_b32 s40, s32
    s_and_b32 s41, s33, 0xffff
    s_mov_b32 s42, 0x100
    s_mov_b32 s43, 0x20000
    s_mov_b32 s44, s10
    s_and_b32 s45, s11, 0xffff
    s_mov_b32 s46, 0x8000000
    s_mov_b32 s47, 0x20000
    s_mov_b32 s48, s12
    s_and_b32 s49, s13, 0xffff
    s_mov_b32 s50, 0x8000000
    s_mov_b32 s51, 0x20000
    s_lshr_b32 s7, s5, 2
    s_sub_u32 s7, s7, 4
    s_lshl_b32 s7, s7, 5
    s_add_u32 s7, s7, s6
    s_lshl_b32 s7, s7, 20
    s_add_u32 s7, s7, 0xC0000
    v_lshlrev_b32 v6, 4, v1
    v_add_u32 v6, s7, v6
    s_mov_b32 s64, 0x3e0293ee
    s_lshl_b32 s60, s3, 10
    s_mov_b32 s61, s60
    s_cmp_ge_u32 s3, 8
    s_cselect_b32 s7, 4096, 0
    s_sub_u32 s63, s60, s7
    s_add_u32 s63, s63, 247808
    s_add_u32 s65, s63, 7168
    s_and_b32 s7, s3, 12
    s_cmp_eq_u32 s7, 4
    s_cselect_b32 s62, 0xff800000, 0
    s_cmp_ge_u32 s3, 4
    s_cbranch_scc1 AP_6
    s_barrier
AP_6:
    s_lshl_b32 s7, s3, 11
    s_add_u32 s7, s7, 0x0
    v_lshl_add_u32 v2, v1, 5, s7
    s_cmp_lt_u32 s3, 4
    s_cselect_b32 s7, 0x44, 0x40
    s_add_u32 s7, s7, 0x24000
    v_mov_b32 v3, s7
    v_mov_b32 v4, 1
    s_waitcnt vmcnt(0)
    v_perm_b32 v96, v132, v128, s92
    v_perm_b32 v97, v140, v136, s92
    v_perm_b32 v98, v148, v144, s92
    v_perm_b32 v99, v156, v152, s92
    v_perm_b32 v100, v132, v128, s93
    v_perm_b32 v101, v140, v136, s93
    v_perm_b32 v102, v148, v144, s93
    v_perm_b32 v103, v156, v152, s93
    v_perm_b32 v104, v133, v129, s92
    v_perm_b32 v105, v141, v137, s92
    v_perm_b32 v106, v149, v145, s92
    v_perm_b32 v107, v157, v153, s92
    v_perm_b32 v108, v133, v129, s93
    v_perm_b32 v109, v141, v137, s93
    v_perm_b32 v110, v149, v145, s93
    v_perm_b32 v111, v157, v153, s93
    v_perm_b32 v112, v134, v130, s92
    v_perm_b32 v113, v142, v138, s92
    v_perm_b32 v114, v150, v146, s92
    v_perm_b32 v115, v158, v154, s92
    v_perm_b32 v116, v134, v130, s93
    v_perm_b32 v117, v142, v138, s93
    v_perm_b32 v118, v150, v146, s93
    v_perm_b32 v119, v158, v154, s93
    v_perm_b32 v120, v135, v131, s92
    v_perm_b32 v121, v143, v139, s92
    v_perm_b32 v122, v151, v147, s92
    v_perm_b32 v123, v159, v155, s92
    v_perm_b32 v124, v135, v131, s93
    v_perm_b32 v125, v143, v139, s93
    v_perm_b32 v126, v151, v147, s93
    v_perm_b32 v127, v159, v155, s93
    v_mfma_f32_16x16x32_bf16 v[64:67], v[160:163], v[96:99], 0
    v_mfma_f32_16x16x32_bf16 v[68:71], v[160:163], v[100:103], 0
    v_mfma_f32_16x16x32_bf16 v[72:75], v[160:163], v[104:107], 0
    v_mfma_f32_16x16x32_bf16 v[76:79], v[160:163], v[108:111], 0
    v_mfma_f32_16x16x32_bf16 v[80:83], v[160:163], v[112:115], 0
    v_mfma_f32_16x16x32_bf16 v[84:87], v[160:163], v[116:119], 0
    v_mfma_f32_16x16x32_bf16 v[88:91], v[160:163], v[120:123], 0
    v_mfma_f32_16x16x32_bf16 v[92:95], v[160:163], v[124:127], 0
    s_nop 0
    v_mov_b32 v128, v64
    v_mov_b32 v129, v68
    v_mov_b32 v130, v72
    v_mov_b32 v131, v76
    v_mov_b32 v132, v80
    v_mov_b32 v133, v84
    v_mov_b32 v134, v88
    v_mov_b32 v135, v92
    ds_write_b128 v2, v[128:131]
    ds_write_b128 v2, v[132:135] offset:16
    s_waitcnt lgkmcnt(0)
    s_mov_b64 exec, 1
    ds_add_u32 v3, v4
    s_mov_b64 exec, -1
    s_branch AJ_4
AK_3:
    s_waitcnt lgkmcnt(0)
    s_mov_b32 s92, 0x05040100
    s_mov_b32 s93, 0x07060302
    s_mov_b32 s36, s34
    s_and_b32 s37, s35, 0xffff
    s_mov_b32 s38, 0x1000000
    s_mov_b32 s39, 0x20000
    s_mov_b32 s40, s32
    s_and_b32 s41, s33, 0xffff
    s_mov_b32 s42, 0x100
    s_mov_b32 s43, 0x20000
    s_mov_b32 s44, s10
    s_and_b32 s45, s11, 0xffff
    s_mov_b32 s46, 0x8000000
    s_mov_b32 s47, 0x20000
    s_mov_b32 s48, s12
    s_and_b32 s49, s13, 0xffff
    s_mov_b32 s50, 0x8000000
    s_mov_b32 s51, 0x20000
    s_lshr_b32 s7, s5, 2
    s_sub_u32 s7, s7, 4
    s_lshl_b32 s7, s7, 5
    s_add_u32 s7, s7, s6
    s_lshl_b32 s7, s7, 20
    s_add_u32 s7, s7, 0xC0000
    v_lshlrev_b32 v6, 4, v1
    v_add_u32 v6, s7, v6
    s_mov_b32 s64, 0x3e0293ee
    s_lshl_b32 s60, s3, 10
    s_mov_b32 s61, s60
    s_cmp_ge_u32 s3, 8
    s_cselect_b32 s7, 4096, 0
    s_sub_u32 s63, s60, s7
    s_add_u32 s63, s63, 247808
    s_add_u32 s65, s63, 7168
    s_and_b32 s7, s3, 12
    s_cmp_eq_u32 s7, 4
    s_cselect_b32 s62, 0xff800000, 0
    s_barrier
    s_cmp_eq_u32 s3, 8
    s_cbranch_scc1 LT_AR
LR_AR:
    s_cmp_eq_u32 s3, 9
    s_cbranch_scc1 LT_AR2
LR_AR2:
    s_sleep 26
AJ_4:
    s_branch L_AR
L_W2B:
    s_cmp_lg_u32 s3, 11
    s_cbranch_scc1 Z_62
    v_lshlrev_b32 v2, 2, v1
    v_add_u32 v2, 0x24000, v2
    v_mov_b32 v3, 0
    ds_write_b32 v2, v3
Z_62:
    s_waitcnt lgkmcnt(0)
    s_mov_b32 s92, 0x05040100
    s_mov_b32 s93, 0x07060302
    s_mov_b32 s36, s34
    s_and_b32 s37, s35, 0xffff
    s_mov_b32 s38, 0x1000000
    s_mov_b32 s39, 0x20000
    s_mov_b32 s40, s32
    s_and_b32 s41, s33, 0xffff
    s_mov_b32 s42, 0x100
    s_mov_b32 s43, 0x20000
    s_barrier
    s_mov_b32 m0, s71
    s_waitcnt vmcnt(7)
    buffer_load_dwordx4 v6, s[52:55], s70 offen nt lds
    s_addk_i32 s70, 8192
    s_addk_i32 s71, 1024
    s_mov_b32 m0, s71
    s_waitcnt vmcnt(7)
    buffer_load_dwordx4 v6, s[52:55], s70 offen nt lds
    s_addk_i32 s70, 8192
    s_addk_i32 s71, 1024
    s_mov_b32 m0, s71
    s_waitcnt vmcnt(7)
    buffer_load_dwordx4 v6, s[52:55], s70 offen nt lds
    s_addk_i32 s70, 8192
    s_addk_i32 s71, 1024
    s_mov_b32 m0, s71
    s_waitcnt vmcnt(7)
    buffer_load_dwordx4 v6, s[52:55], s70 offen nt lds
    s_addk_i32 s70, 8192
    s_addk_i32 s71, 1024
    s_mov_b32 m0, s71
    s_waitcnt vmcnt(7)
    buffer_load_dwordx4 v7, s[52:55], s70 offen nt lds
    s_addk_i32 s70, 8192
    s_addk_i32 s71, 1024
    s_mov_b32 m0, s71
    s_waitcnt vmcnt(7)
    buffer_load_dwordx4 v7, s[52:55], s70 offen nt lds
    s_addk_i32 s70, 8192
    s_addk_i32 s71, 1024
    s_mov_b32 m0, s71
    s_waitcnt vmcnt(7)
    buffer_load_dwordx4 v7, s[52:55], s70 offen nt lds
    s_addk_i32 s70, 8192
    s_addk_i32 s71, 1024
    s_mov_b32 m0, s71
    s_waitcnt vmcnt(7)
    buffer_load_dwordx4 v7, s[52:55], s70 offen nt lds
    s_addk_i32 s70, 8192
    s_addk_i32 s71, 1024
    s_branch L_W2R
L_CB:
    s_mov_b32 s92, 0x05040100
    s_mov_b32 s93, 0x07060302
    s_mov_b32 s36, s34
    s_and_b32 s37, s35, 0xffff
    s_mov_b32 s38, 0x1000000
    s_mov_b32 s39, 0x20000
    s_mov_b32 s40, s32
    s_and_b32 s41, s33, 0xffff
    s_mov_b32 s42, 0x100
    s_mov_b32 s43, 0x20000
    s_lshr_b32 s64, s3, 1
    s_and_b32 s65, s3, 1
    s_mov_b32 s67, 0x3e0293ee
    s_barrier
    s_addk_i32 s61, 8192
    s_mov_b32 m0, s68
    s_waitcnt vmcnt(3)
    buffer_load_dwordx4 v2, s[44:47], s61 offen nt lds
    s_addk_i32 s68, 8192
    s_addk_i32 s61, 8192
    s_mov_b32 m0, s68
    s_waitcnt vmcnt(3)
    buffer_load_dwordx4 v3, s[44:47], s61 offen nt lds
    s_addk_i32 s68, 8192
    s_addk_i32 s61, 8192
    s_mov_b32 m0, s68
    s_waitcnt vmcnt(3)
    buffer_load_dwordx4 v2, s[44:47], s61 offen nt lds
    s_addk_i32 s68, 8192
    s_addk_i32 s61, 8192
    s_mov_b32 m0, s68
    s_waitcnt vmcnt(3)
    buffer_load_dwordx4 v3, s[44:47], s61 offen nt lds
    s_addk_i32 s68, 8192
    s_addk_i32 s61, 8192
    s_mov_b32 m0, s68
    s_waitcnt vmcnt(3)
    buffer_load_dwordx4 v2, s[44:47], s61 offen nt lds
    s_addk_i32 s68, 8192
    s_addk_i32 s61, 8192
    s_mov_b32 m0, s68
    s_waitcnt vmcnt(3)
    buffer_load_dwordx4 v3, s[44:47], s61 offen nt lds
    s_addk_i32 s68, 8192
    s_addk_i32 s61, 8192
    s_mov_b32 m0, s68
    s_waitcnt vmcnt(3)
    buffer_load_dwordx4 v2, s[44:47], s61 offen nt lds
    s_addk_i32 s68, 8192
    s_addk_i32 s61, 8192
    s_mov_b32 m0, s68
    s_waitcnt vmcnt(3)
    buffer_load_dwordx4 v3, s[44:47], s61 offen nt lds
    s_addk_i32 s68, 8192
    s_addk_i32 s61, 8192
    s_waitcnt vmcnt(3)
    buffer_load_dwordx4 v[128:131], v2, s[44:47], s61 offen nt
    s_addk_i32 s61, 8192
    s_waitcnt vmcnt(3)
    buffer_load_dwordx4 v[132:135], v3, s[44:47], s61 offen nt
    s_addk_i32 s61, 8192
    s_waitcnt vmcnt(3)
    buffer_load_dwordx4 v[136:139], v2, s[44:47], s61 offen nt
    s_addk_i32 s61, 8192
    s_waitcnt vmcnt(3)
    buffer_load_dwordx4 v[140:143], v3, s[44:47], s61 offen nt
    s_addk_i32 s61, 8192
    s_waitcnt vmcnt(3)
    buffer_load_dwordx4 v[96:99], v2, s[44:47], s61 offen nt
    s_addk_i32 s61, 8192
    s_waitcnt vmcnt(3)
    buffer_load_dwordx4 v[100:103], v3, s[44:47], s61 offen nt
    s_addk_i32 s61, 8192
    s_waitcnt vmcnt(3)
    buffer_load_dwordx4 v[104:107], v2, s[44:47], s61 offen nt
    s_addk_i32 s61, 8192
    s_waitcnt vmcnt(3)
    buffer_load_dwordx4 v[108:111], v3, s[44:47], s61 offen nt
    s_addk_i32 s61, 8192
    s_waitcnt vmcnt(3)
    buffer_load_dwordx4 v[112:115], v2, s[44:47], s61 offen nt
    s_addk_i32 s61, 8192
    s_waitcnt vmcnt(3)
    buffer_load_dwordx4 v[116:119], v3, s[44:47], s61 offen nt
    s_addk_i32 s61, 8192
    v_mov_b32 v160, 0x24018
    v_mov_b32 v161, 1
    s_waitcnt lgkmcnt(0)
    s_mov_b64 exec, 1
    ds_add_u32 v160, v161
    s_mov_b64 exec, -1
    s_waitcnt vmcnt(3)
    buffer_load_dwordx4 v[120:123], v2, s[44:47], s61 offen nt
    s_addk_i32 s61, 8192
    s_waitcnt vmcnt(3)
    buffer_load_dwordx4 v[124:127], v3, s[44:47], s61 offen nt
    s_addk_i32 s61, 8192
    s_branch L_CR
L_END:
    s_endpgm
L_END0:
    s_endpgm
.p2align 12
LT_AR:
    s_branch LR_AR
L_AR:
    v_mov_b32 v32, 0
    v_mov_b32 v33, 0
    v_mov_b32 v34, 0
    v_mov_b32 v35, 0
    v_mov_b32 v36, 0
    v_mov_b32 v37, 0
    v_mov_b32 v38, 0
    v_mov_b32 v39, 0
    s_cmp_lg_u32 s62, 0
    s_cbranch_scc1 L_AK2
    buffer_load_dwordx4 v[32:35], v6, s[44:47], s63 offen nt
    buffer_load_dwordx4 v[36:39], v6, s[44:47], s65 offen nt
L_AK2:
    buffer_load_dwordx4 v[40:43], v6, s[44:47], s60 offen nt
    s_add_u32 s60, s60, 11264
    s_waitcnt vmcnt(2)
    buffer_load_dwordx4 v[44:47], v6, s[44:47], s60 offen nt
    s_add_u32 s60, s60, 11264
    s_waitcnt vmcnt(2)
    buffer_load_dwordx4 v[48:51], v6, s[44:47], s60 offen nt
    s_add_u32 s60, s60, 11264
    s_waitcnt vmcnt(2)
    buffer_load_dwordx4 v[52:55], v6, s[44:47], s60 offen nt
    s_add_u32 s60, s60, 11264
    s_waitcnt vmcnt(2)
    buffer_load_dwordx4 v[56:59], v6, s[44:47], s60 offen nt
    s_add_u32 s60, s60, 11264
    s_waitcnt vmcnt(2)
    buffer_load_dwordx4 v[60:63], v6, s[44:47], s60 offen nt
    s_add_u32 s60, s60, 11264
    s_waitcnt vmcnt(2)
    buffer_load_dwordx4 v[64:67], v6, s[44:47], s60 offen nt
    s_add_u32 s60, s60, 11264
    s_waitcnt vmcnt(2)
    buffer_load_dwordx4 v[68:71], v6, s[44:47], s60 offen nt
    s_add_u32 s60, s60, 11264
    s_waitcnt vmcnt(2)
    buffer_load_dwordx4 v[72:75], v6, s[44:47], s60 offen nt
    s_add_u32 s60, s60, 11264
    s_waitcnt vmcnt(2)
    buffer_load_dwordx4 v[76:79], v6, s[44:47], s60 offen nt
    s_add_u32 s60, s60, 11264
    s_waitcnt vmcnt(2)
    buffer_load_dwordx4 v[80:83], v6, s[44:47], s60 offen nt
    s_add_u32 s60, s60, 11264
    s_waitcnt vmcnt(2)
    buffer_load_dwordx4 v[84:87], v6, s[44:47], s60 offen nt
    s_add_u32 s60, s60, 11264
    s_waitcnt vmcnt(2)
    buffer_load_dwordx4 v[88:91], v6, s[44:47], s60 offen nt
    s_add_u32 s60, s60, 11264
    s_waitcnt vmcnt(2)
    buffer_load_dwordx4 v[92:95], v6, s[44:47], s60 offen nt
    s_add_u32 s60, s60, 11264
    v_mov_b32 v160, 0x24004
    s_mov_b32 s80, 1600000
LW_7:
    ds_read_b32 v161, v160
    s_waitcnt lgkmcnt(0)
    v_readfirstlane_b32 s79, v161
    s_cmp_ge_u32 s79, 1
    s_cbranch_scc1 LWD_8
    s_sleep 4
    s_sub_u32 s80, s80, 1
    s_cmp_lg_u32 s80, 0
    s_cbranch_scc1 LW_7
LWD_8:
    v_and_b32 v160, 15, v1
    v_lshlrev_b32 v160, 4, v160
    v_add_u32 v160, 0x24100, v160
    ds_read_b128 v[2:5], v160
    s_waitcnt lgkmcnt(0)
    v_dot2_f32_bf16 v8, v32, v2, 0
    v_dot2_f32_bf16 v9, v36, v2, 0
    v_dot2_f32_bf16 v10, v40, v2, 0
    v_dot2_f32_bf16 v11, v44, v2, 0
    v_dot2_f32_bf16 v8, v33, v3, v8
    v_dot2_f32_bf16 v9, v37, v3, v9
    v_dot2_f32_bf16 v10, v41, v3, v10
    v_dot2_f32_bf16 v11, v45, v3, v11
    v_dot2_f32_bf16 v8, v34, v4, v8
    v_dot2_f32_bf16 v9, v38, v4, v9
    v_dot2_f32_bf16 v10, v42, v4, v10
    v_dot2_f32_bf16 v11, v46, v4, v11
    v_dot2_f32_bf16 v8, v35, v5, v8
    v_dot2_f32_bf16 v9, v39, v5, v9
    v_dot2_f32_bf16 v10, v43, v5, v10
    v_dot2_f32_bf16 v11, v47, v5, v11
    v_add_f32_dpp v8, v8, v8 row_ror:8 row_mask:0xf bank_mask:0xf
    v_add_f32_dpp v9, v9, v9 row_ror:8 row_mask:0xf bank_mask:0xf
    v_add_f32_dpp v10, v10, v10 row_ror:8 row_mask:0xf bank_mask:0xf
    v_add_f32_dpp v11, v11, v11 row_ror:8 row_mask:0xf bank_mask:0xf
    v_add_f32_dpp v8, v8, v8 row_ror:4 row_mask:0xf bank_mask:0xf
    v_add_f32_dpp v9, v9, v9 row_ror:4 row_mask:0xf bank_mask:0xf
    v_add_f32_dpp v10, v10, v10 row_ror:4 row_mask:0xf bank_mask:0xf
    v_add_f32_dpp v11, v11, v11 row_ror:4 row_mask:0xf bank_mask:0xf
    v_add_f32_dpp v8, v8, v8 row_ror:2 row_mask:0xf bank_mask:0xf
    v_add_f32_dpp v9, v9, v9 row_ror:2 row_mask:0xf bank_mask:0xf
    v_add_f32_dpp v10, v10, v10 row_ror:2 row_mask:0xf bank_mask:0xf
    v_add_f32_dpp v11, v11, v11 row_ror:2 row_mask:0xf bank_mask:0xf
    v_add_f32_dpp v8, v8, v8 row_ror:1 row_mask:0xf bank_mask:0xf
    v_add_f32_dpp v9, v9, v9 row_ror:1 row_mask:0xf bank_mask:0xf
    v_add_f32_dpp v10, v10, v10 row_ror:1 row_mask:0xf bank_mask:0xf
    v_add_f32_dpp v11, v11, v11 row_ror:1 row_mask:0xf bank_mask:0xf
    s_waitcnt vmcnt(2)
    buffer_load_dwordx4 v[96:99], v6, s[44:47], s60 offen nt
    s_add_u32 s60, s60, 11264
    s_waitcnt vmcnt(2)
    buffer_load_dwordx4 v[100:103], v6, s[44:47], s60 offen nt
    s_add_u32 s60, s60, 11264
    v_dot2_f32_bf16 v12, v48, v2, 0
    v_dot2_f32_bf16 v13, v52, v2, 0
    v_dot2_f32_bf16 v14, v56, v2, 0
    v_dot2_f32_bf16 v15, v60, v2, 0
    v_dot2_f32_bf16 v12, v49, v3, v12
    v_dot2_f32_bf16 v13, v53, v3, v13
    v_dot2_f32_bf16 v14, v57, v3, v14
    v_dot2_f32_bf16 v15, v61, v3, v15
    v_dot2_f32_bf16 v12, v50, v4, v12
    v_dot2_f32_bf16 v13, v54, v4, v13
    v_dot2_f32_bf16 v14, v58, v4, v14
    v_dot2_f32_bf16 v15, v62, v4, v15
    v_dot2_f32_bf16 v12, v51, v5, v12
    v_dot2_f32_bf16 v13, v55, v5, v13
    v_dot2_f32_bf16 v14, v59, v5, v14
    v_dot2_f32_bf16 v15, v63, v5, v15
    v_add_f32_dpp v12, v12, v12 row_ror:8 row_mask:0xf bank_mask:0xf
    v_add_f32_dpp v13, v13, v13 row_ror:8 row_mask:0xf bank_mask:0xf
    v_add_f32_dpp v14, v14, v14 row_ror:8 row_mask:0xf bank_mask:0xf
    v_add_f32_dpp v15, v15, v15 row_ror:8 row_mask:0xf bank_mask:0xf
    v_add_f32_dpp v12, v12, v12 row_ror:4 row_mask:0xf bank_mask:0xf
    v_add_f32_dpp v13, v13, v13 row_ror:4 row_mask:0xf bank_mask:0xf
    v_add_f32_dpp v14, v14, v14 row_ror:4 row_mask:0xf bank_mask:0xf
    v_add_f32_dpp v15, v15, v15 row_ror:4 row_mask:0xf bank_mask:0xf
    v_add_f32_dpp v12, v12, v12 row_ror:2 row_mask:0xf bank_mask:0xf
    v_add_f32_dpp v13, v13, v13 row_ror:2 row_mask:0xf bank_mask:0xf
    v_add_f32_dpp v14, v14, v14 row_ror:2 row_mask:0xf bank_mask:0xf
    v_add_f32_dpp v15, v15, v15 row_ror:2 row_mask:0xf bank_mask:0xf
    v_add_f32_dpp v12, v12, v12 row_ror:1 row_mask:0xf bank_mask:0xf
    v_add_f32_dpp v13, v13, v13 row_ror:1 row_mask:0xf bank_mask:0xf
    v_add_f32_dpp v14, v14, v14 row_ror:1 row_mask:0xf bank_mask:0xf
    v_add_f32_dpp v15, v15, v15 row_ror:1 row_mask:0xf bank_mask:0xf
    s_waitcnt vmcnt(2)
    buffer_load_dwordx4 v[104:107], v6, s[44:47], s60 offen nt
    s_add_u32 s60, s60, 11264
    s_waitcnt vmcnt(2)
    buffer_load_dwordx4 v[108:111], v6, s[44:47], s60 offen nt
    s_add_u32 s60, s60, 11264
    v_dot2_f32_bf16 v16, v64, v2, 0
    v_dot2_f32_bf16 v17, v68, v2, 0
    v_dot2_f32_bf16 v18, v72, v2, 0
    v_dot2_f32_bf16 v19, v76, v2, 0
    v_dot2_f32_bf16 v16, v65, v3, v16
    v_dot2_f32_bf16 v17, v69, v3, v17
    v_dot2_f32_bf16 v18, v73, v3, v18
    v_dot2_f32_bf16 v19, v77, v3, v19
    v_dot2_f32_bf16 v16, v66, v4, v16
    v_dot2_f32_bf16 v17, v70, v4, v17
    v_dot2_f32_bf16 v18, v74, v4, v18
    v_dot2_f32_bf16 v19, v78, v4, v19
    v_dot2_f32_bf16 v16, v67, v5, v16
    v_dot2_f32_bf16 v17, v71, v5, v17
    v_dot2_f32_bf16 v18, v75, v5, v18
    v_dot2_f32_bf16 v19, v79, v5, v19
    v_add_f32_dpp v16, v16, v16 row_ror:8 row_mask:0xf bank_mask:0xf
    v_add_f32_dpp v17, v17, v17 row_ror:8 row_mask:0xf bank_mask:0xf
    v_add_f32_dpp v18, v18, v18 row_ror:8 row_mask:0xf bank_mask:0xf
    v_add_f32_dpp v19, v19, v19 row_ror:8 row_mask:0xf bank_mask:0xf
    v_add_f32_dpp v16, v16, v16 row_ror:4 row_mask:0xf bank_mask:0xf
    v_add_f32_dpp v17, v17, v17 row_ror:4 row_mask:0xf bank_mask:0xf
    v_add_f32_dpp v18, v18, v18 row_ror:4 row_mask:0xf bank_mask:0xf
    v_add_f32_dpp v19, v19, v19 row_ror:4 row_mask:0xf bank_mask:0xf
    v_add_f32_dpp v16, v16, v16 row_ror:2 row_mask:0xf bank_mask:0xf
    v_add_f32_dpp v17, v17, v17 row_ror:2 row_mask:0xf bank_mask:0xf
    v_add_f32_dpp v18, v18, v18 row_ror:2 row_mask:0xf bank_mask:0xf
    v_add_f32_dpp v19, v19, v19 row_ror:2 row_mask:0xf bank_mask:0xf
    v_add_f32_dpp v16, v16, v16 row_ror:1 row_mask:0xf bank_mask:0xf
    v_add_f32_dpp v17, v17, v17 row_ror:1 row_mask:0xf bank_mask:0xf
    v_add_f32_dpp v18, v18, v18 row_ror:1 row_mask:0xf bank_mask:0xf
    v_add_f32_dpp v19, v19, v19 row_ror:1 row_mask:0xf bank_mask:0xf
    s_waitcnt vmcnt(2)
    buffer_load_dwordx4 v[112:115], v6, s[44:47], s60 offen nt
    s_add_u32 s60, s60, 11264
    s_waitcnt vmcnt(2)
    buffer_load_dwordx4 v[116:119], v6, s[44:47], s60 offen nt
    s_add_u32 s60, s60, 11264
    v_dot2_f32_bf16 v20, v80, v2, 0
    v_dot2_f32_bf16 v21, v84, v2, 0
    v_dot2_f32_bf16 v22, v88, v2, 0
    v_dot2_f32_bf16 v23, v92, v2, 0
    v_dot2_f32_bf16 v20, v81, v3, v20
    v_dot2_f32_bf16 v21, v85, v3, v21
    v_dot2_f32_bf16 v22, v89, v3, v22
    v_dot2_f32_bf16 v23, v93, v3, v23
    v_dot2_f32_bf16 v20, v82, v4, v20
    v_dot2_f32_bf16 v21, v86, v4, v21
    v_dot2_f32_bf16 v22, v90, v4, v22
    v_dot2_f32_bf16 v23, v94, v4, v23
    v_dot2_f32_bf16 v20, v83, v5, v20
    v_dot2_f32_bf16 v21, v87, v5, v21
    v_dot2_f32_bf16 v22, v91, v5, v22
    v_dot2_f32_bf16 v23, v95, v5, v23
    v_add_f32_dpp v20, v20, v20 row_ror:8 row_mask:0xf bank_mask:0xf
    v_add_f32_dpp v21, v21, v21 row_ror:8 row_mask:0xf bank_mask:0xf
    v_add_f32_dpp v22, v22, v22 row_ror:8 row_mask:0xf bank_mask:0xf
    v_add_f32_dpp v23, v23, v23 row_ror:8 row_mask:0xf bank_mask:0xf
    v_add_f32_dpp v20, v20, v20 row_ror:4 row_mask:0xf bank_mask:0xf
    v_add_f32_dpp v21, v21, v21 row_ror:4 row_mask:0xf bank_mask:0xf
    v_add_f32_dpp v22, v22, v22 row_ror:4 row_mask:0xf bank_mask:0xf
    v_add_f32_dpp v23, v23, v23 row_ror:4 row_mask:0xf bank_mask:0xf
    v_add_f32_dpp v20, v20, v20 row_ror:2 row_mask:0xf bank_mask:0xf
    v_add_f32_dpp v21, v21, v21 row_ror:2 row_mask:0xf bank_mask:0xf
    v_add_f32_dpp v22, v22, v22 row_ror:2 row_mask:0xf bank_mask:0xf
    v_add_f32_dpp v23, v23, v23 row_ror:2 row_mask:0xf bank_mask:0xf
    v_add_f32_dpp v20, v20, v20 row_ror:1 row_mask:0xf bank_mask:0xf
    v_add_f32_dpp v21, v21, v21 row_ror:1 row_mask:0xf bank_mask:0xf
    v_add_f32_dpp v22, v22, v22 row_ror:1 row_mask:0xf bank_mask:0xf
    v_add_f32_dpp v23, v23, v23 row_ror:1 row_mask:0xf bank_mask:0xf
    s_waitcnt vmcnt(2)
    buffer_load_dwordx4 v[120:123], v6, s[44:47], s60 offen nt
    s_add_u32 s60, s60, 11264
    s_waitcnt vmcnt(2)
    buffer_load_dwordx4 v[124:127], v6, s[44:47], s60 offen nt
    v_dot2_f32_bf16 v24, v96, v2, 0
    v_dot2_f32_bf16 v25, v100, v2, 0
    v_dot2_f32_bf16 v26, v104, v2, 0
    v_dot2_f32_bf16 v27, v108, v2, 0
    v_dot2_f32_bf16 v24, v97, v3, v24
    v_dot2_f32_bf16 v25, v101, v3, v25
    v_dot2_f32_bf16 v26, v105, v3, v26
    v_dot2_f32_bf16 v27, v109, v3, v27
    v_dot2_f32_bf16 v24, v98, v4, v24
    v_dot2_f32_bf16 v25, v102, v4, v25
    v_dot2_f32_bf16 v26, v106, v4, v26
    v_dot2_f32_bf16 v27, v110, v4, v27
    v_dot2_f32_bf16 v24, v99, v5, v24
    v_dot2_f32_bf16 v25, v103, v5, v25
    v_dot2_f32_bf16 v26, v107, v5, v26
    v_dot2_f32_bf16 v27, v111, v5, v27
    v_add_f32_dpp v24, v24, v24 row_ror:8 row_mask:0xf bank_mask:0xf
    v_add_f32_dpp v25, v25, v25 row_ror:8 row_mask:0xf bank_mask:0xf
    v_add_f32_dpp v26, v26, v26 row_ror:8 row_mask:0xf bank_mask:0xf
    v_add_f32_dpp v27, v27, v27 row_ror:8 row_mask:0xf bank_mask:0xf
    v_add_f32_dpp v24, v24, v24 row_ror:4 row_mask:0xf bank_mask:0xf
    v_add_f32_dpp v25, v25, v25 row_ror:4 row_mask:0xf bank_mask:0xf
    v_add_f32_dpp v26, v26, v26 row_ror:4 row_mask:0xf bank_mask:0xf
    v_add_f32_dpp v27, v27, v27 row_ror:4 row_mask:0xf bank_mask:0xf
    v_add_f32_dpp v24, v24, v24 row_ror:2 row_mask:0xf bank_mask:0xf
    v_add_f32_dpp v25, v25, v25 row_ror:2 row_mask:0xf bank_mask:0xf
    v_add_f32_dpp v26, v26, v26 row_ror:2 row_mask:0xf bank_mask:0xf
    v_add_f32_dpp v27, v27, v27 row_ror:2 row_mask:0xf bank_mask:0xf
    v_add_f32_dpp v24, v24, v24 row_ror:1 row_mask:0xf bank_mask:0xf
    v_add_f32_dpp v25, v25, v25 row_ror:1 row_mask:0xf bank_mask:0xf
    v_add_f32_dpp v26, v26, v26 row_ror:1 row_mask:0xf bank_mask:0xf
    v_add_f32_dpp v27, v27, v27 row_ror:1 row_mask:0xf bank_mask:0xf
    s_waitcnt vmcnt(2)
    buffer_load_dwordx4 v[128:131], v6, s[48:51], s61 offen nt
    s_add_u32 s61, s61, 11264
    s_waitcnt vmcnt(2)
    buffer_load_dwordx4 v[132:135], v6, s[48:51], s61 offen nt
    s_add_u32 s61, s61, 11264
    s_waitcnt vmcnt(2)
    buffer_load_dwordx4 v[136:139], v6, s[48:51], s61 offen nt
    s_add_u32 s61, s61, 11264
    v_dot2_f32_bf16 v28, v112, v2, 0
    v_dot2_f32_bf16 v29, v116, v2, 0
    v_dot2_f32_bf16 v30, v120, v2, 0
    v_dot2_f32_bf16 v31, v124, v2, 0
    v_dot2_f32_bf16 v28, v113, v3, v28
    v_dot2_f32_bf16 v29, v117, v3, v29
    v_dot2_f32_bf16 v30, v121, v3, v30
    v_dot2_f32_bf16 v31, v125, v3, v31
    v_dot2_f32_bf16 v28, v114, v4, v28
    v_dot2_f32_bf16 v29, v118, v4, v29
    v_dot2_f32_bf16 v30, v122, v4, v30
    v_dot2_f32_bf16 v31, v126, v4, v31
    v_dot2_f32_bf16 v28, v115, v5, v28
    v_dot2_f32_bf16 v29, v119, v5, v29
    v_dot2_f32_bf16 v30, v123, v5, v30
    v_dot2_f32_bf16 v31, v127, v5, v31
    v_add_f32_dpp v28, v28, v28 row_ror:8 row_mask:0xf bank_mask:0xf
    v_add_f32_dpp v29, v29, v29 row_ror:8 row_mask:0xf bank_mask:0xf
    v_add_f32_dpp v30, v30, v30 row_ror:8 row_mask:0xf bank_mask:0xf
    v_add_f32_dpp v31, v31, v31 row_ror:8 row_mask:0xf bank_mask:0xf
    v_add_f32_dpp v28, v28, v28 row_ror:4 row_mask:0xf bank_mask:0xf
    v_add_f32_dpp v29, v29, v29 row_ror:4 row_mask:0xf bank_mask:0xf
    v_add_f32_dpp v30, v30, v30 row_ror:4 row_mask:0xf bank_mask:0xf
    v_add_f32_dpp v31, v31, v31 row_ror:4 row_mask:0xf bank_mask:0xf
    v_add_f32_dpp v28, v28, v28 row_ror:2 row_mask:0xf bank_mask:0xf
    v_add_f32_dpp v29, v29, v29 row_ror:2 row_mask:0xf bank_mask:0xf
    v_add_f32_dpp v30, v30, v30 row_ror:2 row_mask:0xf bank_mask:0xf
    v_add_f32_dpp v31, v31, v31 row_ror:2 row_mask:0xf bank_mask:0xf
    v_add_f32_dpp v28, v28, v28 row_ror:1 row_mask:0xf bank_mask:0xf
    v_add_f32_dpp v29, v29, v29 row_ror:1 row_mask:0xf bank_mask:0xf
    v_add_f32_dpp v30, v30, v30 row_ror:1 row_mask:0xf bank_mask:0xf
    v_add_f32_dpp v31, v31, v31 row_ror:1 row_mask:0xf bank_mask:0xf
    s_waitcnt vmcnt(2)
    buffer_load_dwordx4 v[140:143], v6, s[48:51], s61 offen nt
    s_add_u32 s61, s61, 11264
    s_waitcnt vmcnt(2)
    buffer_load_dwordx4 v[144:147], v6, s[48:51], s61 offen nt
    s_add_u32 s61, s61, 11264
    v_add_f32 v8, s62, v8
    v_add_f32 v9, s62, v9
    v_max3_f32 v160, v8, v9, v10
    v_max3_f32 v160, v160, v11, v12
    v_max3_f32 v160, v160, v13, v14
    v_max3_f32 v160, v160, v15, v16
    v_max3_f32 v160, v160, v17, v18
    v_max3_f32 v160, v160, v19, v20
    v_max3_f32 v160, v160, v21, v22
    v_max3_f32 v160, v160, v23, v24
    v_max3_f32 v160, v160, v25, v26
    v_max3_f32 v160, v160, v27, v28
    v_max3_f32 v160, v160, v29, v30
    v_max_f32 v160, v160, v31
    v_mov_b32 v161, v160
    s_nop 1
    v_permlane32_swap_b32 v160, v161
    v_max_f32 v160, v160, v161
    v_mov_b32 v161, v160
    s_nop 1
    v_permlane16_swap_b32 v160, v161
    v_max_f32 v160, v160, v161
    v_mul_f32 v160, s64, v160
    v_fma_f32 v8, v8, s64, -v160
    v_fma_f32 v9, v9, s64, -v160
    v_fma_f32 v10, v10, s64, -v160
    v_fma_f32 v11, v11, s64, -v160
    v_fma_f32 v12, v12, s64, -v160
    v_fma_f32 v13, v13, s64, -v160
    v_fma_f32 v14, v14, s64, -v160
    v_fma_f32 v15, v15, s64, -v160
    v_fma_f32 v16, v16, s64, -v160
    v_fma_f32 v17, v17, s64, -v160
    v_fma_f32 v18, v18, s64, -v160
    v_fma_f32 v19, v19, s64, -v160
    v_fma_f32 v20, v20, s64, -v160
    v_fma_f32 v21, v21, s64, -v160
    v_fma_f32 v22, v22, s64, -v160
    v_fma_f32 v23, v23, s64, -v160
    v_fma_f32 v24, v24, s64, -v160
    v_fma_f32 v25, v25, s64, -v160
    v_fma_f32 v26, v26, s64, -v160
    v_fma_f32 v27, v27, s64, -v160
    v_fma_f32 v28, v28, s64, -v160
    v_fma_f32 v29, v29, s64, -v160
    v_fma_f32 v30, v30, s64, -v160
    v_fma_f32 v31, v31, s64, -v160
    v_exp_f32 v8, v8
    v_exp_f32 v9, v9
    v_exp_f32 v10, v10
    v_exp_f32 v11, v11
    v_exp_f32 v12, v12
    v_exp_f32 v13, v13
    v_exp_f32 v14, v14
    v_exp_f32 v15, v15
    v_exp_f32 v16, v16
    v_exp_f32 v17, v17
    v_exp_f32 v18, v18
    v_exp_f32 v19, v19
    v_exp_f32 v20, v20
    v_exp_f32 v21, v21
    v_exp_f32 v22, v22
    v_exp_f32 v23, v23
    v_exp_f32 v24, v24
    v_exp_f32 v25, v25
    v_exp_f32 v26, v26
    v_exp_f32 v27, v27
    v_exp_f32 v28, v28
    v_exp_f32 v29, v29
    v_exp_f32 v30, v30
    v_exp_f32 v31, v31
    s_waitcnt vmcnt(2)
    buffer_load_dwordx4 v[148:151], v6, s[48:51], s61 offen nt
    s_add_u32 s61, s61, 11264
    v_add_f32 v162, v8, v9
    v_add_f32 v163, v10, v11
    v_add_f32 v162, v162, v12
    v_add_f32 v163, v163, v13
    v_add_f32 v162, v162, v14
    v_add_f32 v163, v163, v15
    v_add_f32 v162, v162, v16
    v_add_f32 v163, v163, v17
    v_add_f32 v162, v162, v18
    v_add_f32 v163, v163, v19
    v_add_f32 v162, v162, v20
    v_add_f32 v163, v163, v21
    v_add_f32 v162, v162, v22
    v_add_f32 v163, v163, v23
    v_add_f32 v162, v162, v24
    v_add_f32 v163, v163, v25
    v_add_f32 v162, v162, v26
    v_add_f32 v163, v163, v27
    v_add_f32 v162, v162, v28
    v_add_f32 v163, v163, v29
    v_add_f32 v162, v162, v30
    v_add_f32 v163, v163, v31
    v_add_f32 v162, v162, v163
    v_mov_b32 v163, v162
    s_nop 1
    v_permlane32_swap_b32 v162, v163
    v_add_f32 v162, v162, v163
    v_mov_b32 v163, v162
    s_nop 1
    v_permlane16_swap_b32 v162, v163
    v_add_f32 v161, v162, v163
    s_lshl_b32 s7, s3, 3
    s_add_u32 s7, s7, 0x24200
    v_mov_b32 v164, s7
    ds_write_b64 v164, v[160:161]
    v_mov_b32 v164, 0x24008
    v_mov_b32 v165, 1
    s_waitcnt lgkmcnt(0)
    s_mov_b64 exec, 1
    ds_add_u32 v164, v165
    s_mov_b64 exec, -1
    v_and_b32 v2, 15, v1
    v_lshlrev_b32 v2, 5, v2
    v_bfe_u32 v3, v1, 5, 1
    v_lshl_add_u32 v2, v3, 4, v2
    v_bfe_u32 v3, v1, 4, 1
    v_lshl_add_u32 v2, v3, 3, v2
    s_lshl_b32 s7, s3, 9
    s_add_u32 s7, s7, 0x10000
    v_add_u32 v2, s7, v2
    s_waitcnt vmcnt(2)
    buffer_load_dwordx4 v[32:35], v6, s[48:51], s61 offen nt
    s_add_u32 s61, s61, 11264
    v_lshlrev_b32 v160, 16, v128
    v_and_b32 v161, 0xffff0000, v128
    v_lshlrev_b32 v162, 16, v129
    v_and_b32 v163, 0xffff0000, v129
    v_lshlrev_b32 v164, 16, v130
    v_and_b32 v165, 0xffff0000, v130
    v_lshlrev_b32 v166, 16, v131
    v_and_b32 v167, 0xffff0000, v131
    v_pk_mul_f32 v[152:153], v[160:161], v[10:11] op_sel_hi:[1,0]
    v_pk_mul_f32 v[154:155], v[162:163], v[10:11] op_sel_hi:[1,0]
    v_pk_mul_f32 v[156:157], v[164:165], v[10:11] op_sel_hi:[1,0]
    v_pk_mul_f32 v[158:159], v[166:167], v[10:11] op_sel_hi:[1,0]
    v_lshlrev_b32 v160, 16, v132
    v_and_b32 v161, 0xffff0000, v132
    v_lshlrev_b32 v162, 16, v133
    v_and_b32 v163, 0xffff0000, v133
    v_lshlrev_b32 v164, 16, v134
    v_and_b32 v165, 0xffff0000, v134
    v_lshlrev_b32 v166, 16, v135
    v_and_b32 v167, 0xffff0000, v135
    v_pk_fma_f32 v[152:153], v[160:161], v[10:11], v[152:153] op_sel:[0,1,0] op_sel_hi:[1,1,1]
    v_pk_fma_f32 v[154:155], v[162:163], v[10:11], v[154:155] op_sel:[0,1,0] op_sel_hi:[1,1,1]
    v_pk_fma_f32 v[156:157], v[164:165], v[10:11], v[156:157] op_sel:[0,1,0] op_sel_hi:[1,1,1]
    v_pk_fma_f32 v[158:159], v[166:167], v[10:11], v[158:159] op_sel:[0,1,0] op_sel_hi:[1,1,1]
    s_waitcnt vmcnt(2)
    buffer_load_dwordx4 v[36:39], v6, s[48:51], s61 offen nt
    s_add_u32 s61, s61, 11264
    v_lshlrev_b32 v160, 16, v136
    v_and_b32 v161, 0xffff0000, v136
    v_lshlrev_b32 v162, 16, v137
    v_and_b32 v163, 0xffff0000, v137
    v_lshlrev_b32 v164, 16, v138
    v_and_b32 v165, 0xffff0000, v138
    v_lshlrev_b32 v166, 16, v139
    v_and_b32 v167, 0xffff0000, v139
    v_pk_fma_f32 v[152:153], v[160:161], v[12:13], v[152:153] op_sel_hi:[1,0,1]
    v_pk_fma_f32 v[154:155], v[162:163], v[12:13], v[154:155] op_sel_hi:[1,0,1]
    v_pk_fma_f32 v[156:157], v[164:165], v[12:13], v[156:157] op_sel_hi:[1,0,1]
    v_pk_fma_f32 v[158:159], v[166:167], v[12:13], v[158:159] op_sel_hi:[1,0,1]
    v_lshlrev_b32 v160, 16, v140
    v_and_b32 v161, 0xffff0000, v140
    v_lshlrev_b32 v162, 16, v141
    v_and_b32 v163, 0xffff0000, v141
    v_lshlrev_b32 v164, 16, v142
    v_and_b32 v165, 0xffff0000, v142
    v_lshlrev_b32 v166, 16, v143
    v_and_b32 v167, 0xffff0000, v143
    v_pk_fma_f32 v[152:153], v[160:161], v[12:13], v[152:153] op_sel:[0,1,0] op_sel_hi:[1,1,1]
    v_pk_fma_f32 v[154:155], v[162:163], v[12:13], v[154:155] op_sel:[0,1,0] op_sel_hi:[1,1,1]
    v_pk_fma_f32 v[156:157], v[164:165], v[12:13], v[156:157] op_sel:[0,1,0] op_sel_hi:[1,1,1]
    v_pk_fma_f32 v[158:159], v[166:167], v[12:13], v[158:159] op_sel:[0,1,0] op_sel_hi:[1,1,1]
    s_waitcnt vmcnt(2)
    buffer_load_dwordx4 v[40:43], v6, s[48:51], s61 offen nt
    s_add_u32 s61, s61, 11264
    v_lshlrev_b32 v160, 16, v144
    v_and_b32 v161, 0xffff0000, v144
    v_lshlrev_b32 v162, 16, v145
    v_and_b32 v163, 0xffff0000, v145
    v_lshlrev_b32 v164, 16, v146
    v_and_b32 v165, 0xffff0000, v146
    v_lshlrev_b32 v166, 16, v147
    v_and_b32 v167, 0xffff0000, v147
    v_pk_fma_f32 v[152:153], v[160:161], v[14:15], v[152:153] op_sel_hi:[1,0,1]
    v_pk_fma_f32 v[154:155], v[162:163], v[14:15], v[154:155] op_sel_hi:[1,0,1]
    v_pk_fma_f32 v[156:157], v[164:165], v[14:15], v[156:157] op_sel_hi:[1,0,1]
    v_pk_fma_f32 v[158:159], v[166:167], v[14:15], v[158:159] op_sel_hi:[1,0,1]
    v_lshlrev_b32 v160, 16, v148
    v_and_b32 v161, 0xffff0000, v148
    v_lshlrev_b32 v162, 16, v149
    v_and_b32 v163, 0xffff0000, v149
    v_lshlrev_b32 v164, 16, v150
    v_and_b32 v165, 0xffff0000, v150
    v_lshlrev_b32 v166, 16, v151
    v_and_b32 v167, 0xffff0000, v151
    v_pk_fma_f32 v[152:153], v[160:161], v[14:15], v[152:153] op_sel:[0,1,0] op_sel_hi:[1,1,1]
    v_pk_fma_f32 v[154:155], v[162:163], v[14:15], v[154:155] op_sel:[0,1,0] op_sel_hi:[1,1,1]
    v_pk_fma_f32 v[156:157], v[164:165], v[14:15], v[156:157] op_sel:[0,1,0] op_sel_hi:[1,1,1]
    v_pk_fma_f32 v[158:159], v[166:167], v[14:15], v[158:159] op_sel:[0,1,0] op_sel_hi:[1,1,1]
    s_waitcnt vmcnt(2)
    buffer_load_dwordx4 v[44:47], v6, s[48:51], s61 offen nt
    s_add_u32 s61, s61, 11264
    v_lshlrev_b32 v160, 16, v32
    v_and_b32 v161, 0xffff0000, v32
    v_lshlrev_b32 v162, 16, v33
    v_and_b32 v163, 0xffff0000, v33
    v_lshlrev_b32 v164, 16, v34
    v_and_b32 v165, 0xffff0000, v34
    v_lshlrev_b32 v166, 16, v35
    v_and_b32 v167, 0xffff0000, v35
    v_pk_fma_f32 v[152:153], v[160:161], v[16:17], v[152:153] op_sel_hi:[1,0,1]
    v_pk_fma_f32 v[154:155], v[162:163], v[16:17], v[154:155] op_sel_hi:[1,0,1]
    v_pk_fma_f32 v[156:157], v[164:165], v[16:17], v[156:157] op_sel_hi:[1,0,1]
    v_pk_fma_f32 v[158:159], v[166:167], v[16:17], v[158:159] op_sel_hi:[1,0,1]
    s_waitcnt vmcnt(2)
    buffer_load_dwordx4 v[48:51], v6, s[48:51], s61 offen nt
    s_add_u32 s61, s61, 11264
    v_lshlrev_b32 v160, 16, v36
    v_and_b32 v161, 0xffff0000, v36
    v_lshlrev_b32 v162, 16, v37
    v_and_b32 v163, 0xffff0000, v37
    v_lshlrev_b32 v164, 16, v38
    v_and_b32 v165, 0xffff0000, v38
    v_lshlrev_b32 v166, 16, v39
    v_and_b32 v167, 0xffff0000, v39
    v_pk_fma_f32 v[152:153], v[160:161], v[16:17], v[152:153] op_sel:[0,1,0] op_sel_hi:[1,1,1]
    v_pk_fma_f32 v[154:155], v[162:163], v[16:17], v[154:155] op_sel:[0,1,0] op_sel_hi:[1,1,1]
    v_pk_fma_f32 v[156:157], v[164:165], v[16:17], v[156:157] op_sel:[0,1,0] op_sel_hi:[1,1,1]
    v_pk_fma_f32 v[158:159], v[166:167], v[16:17], v[158:159] op_sel:[0,1,0] op_sel_hi:[1,1,1]
    s_waitcnt vmcnt(2)
    buffer_load_dwordx4 v[52:55], v6, s[48:51], s61 offen nt
    s_add_u32 s61, s61, 11264
    v_lshlrev_b32 v160, 16, v40
    v_and_b32 v161, 0xffff0000, v40
    v_lshlrev_b32 v162, 16, v41
    v_and_b32 v163, 0xffff0000, v41
    v_lshlrev_b32 v164, 16, v42
    v_and_b32 v165, 0xffff0000, v42
    v_lshlrev_b32 v166, 16, v43
    v_and_b32 v167, 0xffff0000, v43
    v_pk_fma_f32 v[152:153], v[160:161], v[18:19], v[152:153] op_sel_hi:[1,0,1]
    v_pk_fma_f32 v[154:155], v[162:163], v[18:19], v[154:155] op_sel_hi:[1,0,1]
    v_pk_fma_f32 v[156:157], v[164:165], v[18:19], v[156:157] op_sel_hi:[1,0,1]
    v_pk_fma_f32 v[158:159], v[166:167], v[18:19], v[158:159] op_sel_hi:[1,0,1]
    s_waitcnt vmcnt(2)
    buffer_load_dwordx4 v[56:59], v6, s[48:51], s61 offen nt
    s_add_u32 s61, s61, 11264
    v_lshlrev_b32 v160, 16, v44
    v_and_b32 v161, 0xffff0000, v44
    v_lshlrev_b32 v162, 16, v45
    v_and_b32 v163, 0xffff0000, v45
    v_lshlrev_b32 v164, 16, v46
    v_and_b32 v165, 0xffff0000, v46
    v_lshlrev_b32 v166, 16, v47
    v_and_b32 v167, 0xffff0000, v47
    v_pk_fma_f32 v[152:153], v[160:161], v[18:19], v[152:153] op_sel:[0,1,0] op_sel_hi:[1,1,1]
    v_pk_fma_f32 v[154:155], v[162:163], v[18:19], v[154:155] op_sel:[0,1,0] op_sel_hi:[1,1,1]
    v_pk_fma_f32 v[156:157], v[164:165], v[18:19], v[156:157] op_sel:[0,1,0] op_sel_hi:[1,1,1]
    v_pk_fma_f32 v[158:159], v[166:167], v[18:19], v[158:159] op_sel:[0,1,0] op_sel_hi:[1,1,1]
    s_waitcnt vmcnt(2)
    buffer_load_dwordx4 v[60:63], v6, s[48:51], s61 offen nt
    s_add_u32 s61, s61, 11264
    v_lshlrev_b32 v160, 16, v48
    v_and_b32 v161, 0xffff0000, v48
    v_lshlrev_b32 v162, 16, v49
    v_and_b32 v163, 0xffff0000, v49
    v_lshlrev_b32 v164, 16, v50
    v_and_b32 v165, 0xffff0000, v50
    v_lshlrev_b32 v166, 16, v51
    v_and_b32 v167, 0xffff0000, v51
    v_pk_fma_f32 v[152:153], v[160:161], v[20:21], v[152:153] op_sel_hi:[1,0,1]
    v_pk_fma_f32 v[154:155], v[162:163], v[20:21], v[154:155] op_sel_hi:[1,0,1]
    v_pk_fma_f32 v[156:157], v[164:165], v[20:21], v[156:157] op_sel_hi:[1,0,1]
    v_pk_fma_f32 v[158:159], v[166:167], v[20:21], v[158:159] op_sel_hi:[1,0,1]
    s_waitcnt vmcnt(2)
    buffer_load_dwordx4 v[64:67], v6, s[48:51], s61 offen nt
    s_add_u32 s61, s61, 11264
    v_lshlrev_b32 v160, 16, v52
    v_and_b32 v161, 0xffff0000, v52
    v_lshlrev_b32 v162, 16, v53
    v_and_b32 v163, 0xffff0000, v53
    v_lshlrev_b32 v164, 16, v54
    v_and_b32 v165, 0xffff0000, v54
    v_lshlrev_b32 v166, 16, v55
    v_and_b32 v167, 0xffff0000, v55
    v_pk_fma_f32 v[152:153], v[160:161], v[20:21], v[152:153] op_sel:[0,1,0] op_sel_hi:[1,1,1]
    v_pk_fma_f32 v[154:155], v[162:163], v[20:21], v[154:155] op_sel:[0,1,0] op_sel_hi:[1,1,1]
    v_pk_fma_f32 v[156:157], v[164:165], v[20:21], v[156:157] op_sel:[0,1,0] op_sel_hi:[1,1,1]
    v_pk_fma_f32 v[158:159], v[166:167], v[20:21], v[158:159] op_sel:[0,1,0] op_sel_hi:[1,1,1]
    s_waitcnt vmcnt(2)
    buffer_load_dwordx4 v[68:71], v6, s[48:51], s61 offen nt
    s_add_u32 s61, s61, 11264
    v_lshlrev_b32 v160, 16, v56
    v_and_b32 v161, 0xffff0000, v56
    v_lshlrev_b32 v162, 16, v57
    v_and_b32 v163, 0xffff0000, v57
    v_lshlrev_b32 v164, 16, v58
    v_and_b32 v165, 0xffff0000, v58
    v_lshlrev_b32 v166, 16, v59
    s_branch LC_AR
.p2align 12
LT_AR2:
    s_branch LR_AR2
LC_AR:
    v_and_b32 v167, 0xffff0000, v59
    v_pk_fma_f32 v[152:153], v[160:161], v[22:23], v[152:153] op_sel_hi:[1,0,1]
    v_pk_fma_f32 v[154:155], v[162:163], v[22:23], v[154:155] op_sel_hi:[1,0,1]
    v_pk_fma_f32 v[156:157], v[164:165], v[22:23], v[156:157] op_sel_hi:[1,0,1]
    v_pk_fma_f32 v[158:159], v[166:167], v[22:23], v[158:159] op_sel_hi:[1,0,1]
    s_waitcnt vmcnt(2)
    buffer_load_dwordx4 v[72:75], v6, s[48:51], s61 offen nt
    s_add_u32 s61, s61, 11264
    v_lshlrev_b32 v160, 16, v60
    v_and_b32 v161, 0xffff0000, v60
    v_lshlrev_b32 v162, 16, v61
    v_and_b32 v163, 0xffff0000, v61
    v_lshlrev_b32 v164, 16, v62
    v_and_b32 v165, 0xffff0000, v62
    v_lshlrev_b32 v166, 16, v63
    v_and_b32 v167, 0xffff0000, v63
    v_pk_fma_f32 v[152:153], v[160:161], v[22:23], v[152:153] op_sel:[0,1,0] op_sel_hi:[1,1,1]
    v_pk_fma_f32 v[154:155], v[162:163], v[22:23], v[154:155] op_sel:[0,1,0] op_sel_hi:[1,1,1]
    v_pk_fma_f32 v[156:157], v[164:165], v[22:23], v[156:157] op_sel:[0,1,0] op_sel_hi:[1,1,1]
    v_pk_fma_f32 v[158:159], v[166:167], v[22:23], v[158:159] op_sel:[0,1,0] op_sel_hi:[1,1,1]
    s_waitcnt vmcnt(2)
    buffer_load_dwordx4 v[76:79], v6, s[48:51], s61 offen nt
    s_add_u32 s61, s61, 11264
    v_lshlrev_b32 v160, 16, v64
    v_and_b32 v161, 0xffff0000, v64
    v_lshlrev_b32 v162, 16, v65
    v_and_b32 v163, 0xffff0000, v65
    v_lshlrev_b32 v164, 16, v66
    v_and_b32 v165, 0xffff0000, v66
    v_lshlrev_b32 v166, 16, v67
    v_and_b32 v167, 0xffff0000, v67
    v_pk_fma_f32 v[152:153], v[160:161], v[24:25], v[152:153] op_sel_hi:[1,0,1]
    v_pk_fma_f32 v[154:155], v[162:163], v[24:25], v[154:155] op_sel_hi:[1,0,1]
    v_pk_fma_f32 v[156:157], v[164:165], v[24:25], v[156:157] op_sel_hi:[1,0,1]
    v_pk_fma_f32 v[158:159], v[166:167], v[24:25], v[158:159] op_sel_hi:[1,0,1]
    s_waitcnt vmcnt(2)
    buffer_load_dwordx4 v[80:83], v6, s[48:51], s61 offen nt
    s_add_u32 s61, s61, 11264
    v_lshlrev_b32 v160, 16, v68
    v_and_b32 v161, 0xffff0000, v68
    v_lshlrev_b32 v162, 16, v69
    v_and_b32 v163, 0xffff0000, v69
    v_lshlrev_b32 v164, 16, v70
    v_and_b32 v165, 0xffff0000, v70
    v_lshlrev_b32 v166, 16, v71
    v_and_b32 v167, 0xffff0000, v71
    v_pk_fma_f32 v[152:153], v[160:161], v[24:25], v[152:153] op_sel:[0,1,0] op_sel_hi:[1,1,1]
    v_pk_fma_f32 v[154:155], v[162:163], v[24:25], v[154:155] op_sel:[0,1,0] op_sel_hi:[1,1,1]
    v_pk_fma_f32 v[156:157], v[164:165], v[24:25], v[156:157] op_sel:[0,1,0] op_sel_hi:[1,1,1]
    v_pk_fma_f32 v[158:159], v[166:167], v[24:25], v[158:159] op_sel:[0,1,0] op_sel_hi:[1,1,1]
    s_waitcnt vmcnt(2)
    buffer_load_dwordx4 v[84:87], v6, s[48:51], s61 offen nt
    s_add_u32 s61, s61, 11264
    v_lshlrev_b32 v160, 16, v72
    v_and_b32 v161, 0xffff0000, v72
    v_lshlrev_b32 v162, 16, v73
    v_and_b32 v163, 0xffff0000, v73
    v_lshlrev_b32 v164, 16, v74
    v_and_b32 v165, 0xffff0000, v74
    v_lshlrev_b32 v166, 16, v75
    v_and_b32 v167, 0xffff0000, v75
    v_pk_fma_f32 v[152:153], v[160:161], v[26:27], v[152:153] op_sel_hi:[1,0,1]
    v_pk_fma_f32 v[154:155], v[162:163], v[26:27], v[154:155] op_sel_hi:[1,0,1]
    v_pk_fma_f32 v[156:157], v[164:165], v[26:27], v[156:157] op_sel_hi:[1,0,1]
    v_pk_fma_f32 v[158:159], v[166:167], v[26:27], v[158:159] op_sel_hi:[1,0,1]
    s_waitcnt vmcnt(2)
    buffer_load_dwordx4 v[88:91], v6, s[48:51], s61 offen nt
    s_add_u32 s61, s61, 11264
    v_lshlrev_b32 v160, 16, v76
    v_and_b32 v161, 0xffff0000, v76
    v_lshlrev_b32 v162, 16, v77
    v_and_b32 v163, 0xffff0000, v77
    v_lshlrev_b32 v164, 16, v78
    v_and_b32 v165, 0xffff0000, v78
    v_lshlrev_b32 v166, 16, v79
    v_and_b32 v167, 0xffff0000, v79
    v_pk_fma_f32 v[152:153], v[160:161], v[26:27], v[152:153] op_sel:[0,1,0] op_sel_hi:[1,1,1]
    v_pk_fma_f32 v[154:155], v[162:163], v[26:27], v[154:155] op_sel:[0,1,0] op_sel_hi:[1,1,1]
    v_pk_fma_f32 v[156:157], v[164:165], v[26:27], v[156:157] op_sel:[0,1,0] op_sel_hi:[1,1,1]
    v_pk_fma_f32 v[158:159], v[166:167], v[26:27], v[158:159] op_sel:[0,1,0] op_sel_hi:[1,1,1]
    s_waitcnt vmcnt(2)
    buffer_load_dwordx4 v[92:95], v6, s[48:51], s61 offen nt
    v_lshlrev_b32 v160, 16, v80
    v_and_b32 v161, 0xffff0000, v80
    v_lshlrev_b32 v162, 16, v81
    v_and_b32 v163, 0xffff0000, v81
    v_lshlrev_b32 v164, 16, v82
    v_and_b32 v165, 0xffff0000, v82
    v_lshlrev_b32 v166, 16, v83
    v_and_b32 v167, 0xffff0000, v83
    v_pk_fma_f32 v[152:153], v[160:161], v[28:29], v[152:153] op_sel_hi:[1,0,1]
    v_pk_fma_f32 v[154:155], v[162:163], v[28:29], v[154:155] op_sel_hi:[1,0,1]
    v_pk_fma_f32 v[156:157], v[164:165], v[28:29], v[156:157] op_sel_hi:[1,0,1]
    v_pk_fma_f32 v[158:159], v[166:167], v[28:29], v[158:159] op_sel_hi:[1,0,1]
    s_cmp_eq_u32 s62, 0
    s_cbranch_scc1 AL_9
    s_waitcnt vmcnt(2)
    v_lshlrev_b32 v160, 16, v84
    v_and_b32 v161, 0xffff0000, v84
    v_lshlrev_b32 v162, 16, v85
    v_and_b32 v163, 0xffff0000, v85
    v_lshlrev_b32 v164, 16, v86
    v_and_b32 v165, 0xffff0000, v86
    v_lshlrev_b32 v166, 16, v87
    v_and_b32 v167, 0xffff0000, v87
    v_pk_fma_f32 v[152:153], v[160:161], v[28:29], v[152:153] op_sel:[0,1,0] op_sel_hi:[1,1,1]
    v_pk_fma_f32 v[154:155], v[162:163], v[28:29], v[154:155] op_sel:[0,1,0] op_sel_hi:[1,1,1]
    v_pk_fma_f32 v[156:157], v[164:165], v[28:29], v[156:157] op_sel:[0,1,0] op_sel_hi:[1,1,1]
    v_pk_fma_f32 v[158:159], v[166:167], v[28:29], v[158:159] op_sel:[0,1,0] op_sel_hi:[1,1,1]
    s_waitcnt vmcnt(1)
    v_lshlrev_b32 v160, 16, v88
    v_and_b32 v161, 0xffff0000, v88
    v_lshlrev_b32 v162, 16, v89
    v_and_b32 v163, 0xffff0000, v89
    v_lshlrev_b32 v164, 16, v90
    v_and_b32 v165, 0xffff0000, v90
    v_lshlrev_b32 v166, 16, v91
    v_and_b32 v167, 0xffff0000, v91
    v_pk_fma_f32 v[152:153], v[160:161], v[30:31], v[152:153] op_sel_hi:[1,0,1]
    v_pk_fma_f32 v[154:155], v[162:163], v[30:31], v[154:155] op_sel_hi:[1,0,1]
    v_pk_fma_f32 v[156:157], v[164:165], v[30:31], v[156:157] op_sel_hi:[1,0,1]
    v_pk_fma_f32 v[158:159], v[166:167], v[30:31], v[158:159] op_sel_hi:[1,0,1]
    s_waitcnt vmcnt(0)
    v_lshlrev_b32 v160, 16, v92
    v_and_b32 v161, 0xffff0000, v92
    v_lshlrev_b32 v162, 16, v93
    v_and_b32 v163, 0xffff0000, v93
    v_lshlrev_b32 v164, 16, v94
    v_and_b32 v165, 0xffff0000, v94
    v_lshlrev_b32 v166, 16, v95
    v_and_b32 v167, 0xffff0000, v95
    v_pk_fma_f32 v[152:153], v[160:161], v[30:31], v[152:153] op_sel:[0,1,0] op_sel_hi:[1,1,1]
    v_pk_fma_f32 v[154:155], v[162:163], v[30:31], v[154:155] op_sel:[0,1,0] op_sel_hi:[1,1,1]
    v_pk_fma_f32 v[156:157], v[164:165], v[30:31], v[156:157] op_sel:[0,1,0] op_sel_hi:[1,1,1]
    v_pk_fma_f32 v[158:159], v[166:167], v[30:31], v[158:159] op_sel:[0,1,0] op_sel_hi:[1,1,1]
    s_branch L_AFIN
AL_9:
    s_waitcnt vmcnt(2)
    buffer_load_dwordx4 v[96:99], v6, s[48:51], s63 offen nt
    v_lshlrev_b32 v160, 16, v84
    v_and_b32 v161, 0xffff0000, v84
    v_lshlrev_b32 v162, 16, v85
    v_and_b32 v163, 0xffff0000, v85
    v_lshlrev_b32 v164, 16, v86
    v_and_b32 v165, 0xffff0000, v86
    v_lshlrev_b32 v166, 16, v87
    v_and_b32 v167, 0xffff0000, v87
    v_pk_fma_f32 v[152:153], v[160:161], v[28:29], v[152:153] op_sel:[0,1,0] op_sel_hi:[1,1,1]
    v_pk_fma_f32 v[154:155], v[162:163], v[28:29], v[154:155] op_sel:[0,1,0] op_sel_hi:[1,1,1]
    v_pk_fma_f32 v[156:157], v[164:165], v[28:29], v[156:157] op_sel:[0,1,0] op_sel_hi:[1,1,1]
    v_pk_fma_f32 v[158:159], v[166:167], v[28:29], v[158:159] op_sel:[0,1,0] op_sel_hi:[1,1,1]
    s_waitcnt vmcnt(2)
    buffer_load_dwordx4 v[100:103], v6, s[48:51], s65 offen nt
    v_lshlrev_b32 v160, 16, v88
    v_and_b32 v161, 0xffff0000, v88
    v_lshlrev_b32 v162, 16, v89
    v_and_b32 v163, 0xffff0000, v89
    v_lshlrev_b32 v164, 16, v90
    v_and_b32 v165, 0xffff0000, v90
    v_lshlrev_b32 v166, 16, v91
    v_and_b32 v167, 0xffff0000, v91
    v_pk_fma_f32 v[152:153], v[160:161], v[30:31], v[152:153] op_sel_hi:[1,0,1]
    v_pk_fma_f32 v[154:155], v[162:163], v[30:31], v[154:155] op_sel_hi:[1,0,1]
    v_pk_fma_f32 v[156:157], v[164:165], v[30:31], v[156:157] op_sel_hi:[1,0,1]
    v_pk_fma_f32 v[158:159], v[166:167], v[30:31], v[158:159] op_sel_hi:[1,0,1]
    s_waitcnt vmcnt(2)
    v_lshlrev_b32 v160, 16, v92
    v_and_b32 v161, 0xffff0000, v92
    v_lshlrev_b32 v162, 16, v93
    v_and_b32 v163, 0xffff0000, v93
    v_lshlrev_b32 v164, 16, v94
    v_and_b32 v165, 0xffff0000, v94
    v_lshlrev_b32 v166, 16, v95
    v_and_b32 v167, 0xffff0000, v95
    v_pk_fma_f32 v[152:153], v[160:161], v[30:31], v[152:153] op_sel:[0,1,0] op_sel_hi:[1,1,1]
    v_pk_fma_f32 v[154:155], v[162:163], v[30:31], v[154:155] op_sel:[0,1,0] op_sel_hi:[1,1,1]
    v_pk_fma_f32 v[156:157], v[164:165], v[30:31], v[156:157] op_sel:[0,1,0] op_sel_hi:[1,1,1]
    v_pk_fma_f32 v[158:159], v[166:167], v[30:31], v[158:159] op_sel:[0,1,0] op_sel_hi:[1,1,1]
    s_waitcnt vmcnt(1)
    v_lshlrev_b32 v160, 16, v96
    v_and_b32 v161, 0xffff0000, v96
    v_lshlrev_b32 v162, 16, v97
    v_and_b32 v163, 0xffff0000, v97
    v_lshlrev_b32 v164, 16, v98
    v_and_b32 v165, 0xffff0000, v98
    v_lshlrev_b32 v166, 16, v99
    v_and_b32 v167, 0xffff0000, v99
    v_pk_fma_f32 v[152:153], v[160:161], v[8:9], v[152:153] op_sel_hi:[1,0,1]
    v_pk_fma_f32 v[154:155], v[162:163], v[8:9], v[154:155] op_sel_hi:[1,0,1]
    v_pk_fma_f32 v[156:157], v[164:165], v[8:9], v[156:157] op_sel_hi:[1,0,1]
    v_pk_fma_f32 v[158:159], v[166:167], v[8:9], v[158:159] op_sel_hi:[1,0,1]
    s_waitcnt vmcnt(0)
    v_lshlrev_b32 v160, 16, v100
    v_and_b32 v161, 0xffff0000, v100
    v_lshlrev_b32 v162, 16, v101
    v_and_b32 v163, 0xffff0000, v101
    v_lshlrev_b32 v164, 16, v102
    v_and_b32 v165, 0xffff0000, v102
    v_lshlrev_b32 v166, 16, v103
    v_and_b32 v167, 0xffff0000, v103
    v_pk_fma_f32 v[152:153], v[160:161], v[8:9], v[152:153] op_sel:[0,1,0] op_sel_hi:[1,1,1]
    v_pk_fma_f32 v[154:155], v[162:163], v[8:9], v[154:155] op_sel:[0,1,0] op_sel_hi:[1,1,1]
    v_pk_fma_f32 v[156:157], v[164:165], v[8:9], v[156:157] op_sel:[0,1,0] op_sel_hi:[1,1,1]
    v_pk_fma_f32 v[158:159], v[166:167], v[8:9], v[158:159] op_sel:[0,1,0] op_sel_hi:[1,1,1]
L_AFIN:
    s_nop 1
    v_permlane32_swap_b32 v152, v156
    v_permlane32_swap_b32 v153, v157
    v_permlane32_swap_b32 v154, v158
    v_permlane32_swap_b32 v155, v159
    v_add_f32 v152, v152, v156
    v_add_f32 v153, v153, v157
    v_add_f32 v154, v154, v158
    v_add_f32 v155, v155, v159
    s_nop 0
    v_permlane16_swap_b32 v152, v154
    v_permlane16_swap_b32 v153, v155
    v_add_f32 v152, v152, v154
    v_add_f32 v153, v153, v155
    ds_write_b64 v2, v[152:153]
    s_waitcnt lgkmcnt(0)
    s_barrier
    s_endpgm
L_ASVC:
    s_cmp_lg_u32 s3, 11
    s_cbranch_scc1 Z_10
    v_lshlrev_b32 v2, 2, v1
    v_add_u32 v2, 0x24000, v2
    v_mov_b32 v3, 0
    ds_write_b32 v2, v3
Z_10:
    s_waitcnt lgkmcnt(0)
    s_mov_b32 s92, 0x05040100
    s_mov_b32 s93, 0x07060302
    s_mov_b32 s36, s34
    s_and_b32 s37, s35, 0xffff
    s_mov_b32 s38, 0x1000000
    s_mov_b32 s39, 0x20000
    s_mov_b32 s40, s32
    s_and_b32 s41, s33, 0xffff
    s_mov_b32 s42, 0x100
    s_mov_b32 s43, 0x20000
    s_setprio 3
    s_lshr_b32 s60, s5, 2
    s_sub_u32 s60, s60, 4
    s_barrier
    s_lshl_b32 s7, s6, 2
    s_add_u32 s7, s7, s60
    s_lshl_b32 s7, s7, 11
    v_lshl_add_u32 v3, v1, 4, s7
    v_add_u32 v5, 0x40000, v3
    v_add_u32 v3, 0x80000, v3
    s_lshl_b32 s7, s6, 5
    s_add_u32 s7, s7, s60
    s_lshl_b32 s7, s7, 8
    s_add_u32 s7, s7, 0x80000
    v_lshrrev_b32 v6, 4, v1
    v_lshlrev_b32 v6, 11, v6
    v_and_b32 v100, 15, v1
    v_lshl_add_u32 v6, v100, 4, v6
    v_add_u32 v6, s7, v6
    s_sleep 8
    v_mov_b32 v90, 0
    s_mov_b32 s80, 200000
    s_mov_b64 exec, 1
    buffer_load_dwordx2 v[94:95], v90, s[40:43], 0 offen sc1
    s_sleep 16
    buffer_load_dwordx2 v[92:93], v90, s[40:43], 0 offen sc1
    s_mov_b64 exec, -1
    s_waitcnt vmcnt(1)
    v_readfirstlane_b32 s94, v94
    v_readfirstlane_b32 s95, v95
    s_cmp_lg_u32 s95, 0
    s_cbranch_scc1 NGD_12
    s_branch NG2_13
NG_11:
    s_mov_b64 exec, 1
    buffer_load_dwordx2 v[92:93], v90, s[40:43], 0 offen sc1
    s_mov_b64 exec, -1
NG2_13:
    s_waitcnt vmcnt(0)
    v_readfirstlane_b32 s94, v92
    v_readfirstlane_b32 s95, v93
    s_cmp_lg_u32 s95, 0
    s_cbranch_scc1 NGD_12
    s_sleep 4
    s_sub_u32 s80, s80, 1
    s_cmp_lg_u32 s80, 0
    s_cbranch_scc1 NG_11
NGD_12:
    v_lshlrev_b32 v7, 5, v1
    v_mov_b32 v114, s94
    v_mov_b32 v115, s95
    v_mov_b32 v118, s94
    v_mov_b32 v119, s95
    v_mov_b32 v122, s94
    v_mov_b32 v123, s95
    v_mov_b32 v126, s94
    v_mov_b32 v127, s95
    v_mov_b32 v100, 0x24044
    s_mov_b32 s80, 1600000
LW_14:
    ds_read_b32 v101, v100
    s_waitcnt lgkmcnt(0)
    v_readfirstlane_b32 s79, v101
    s_cmp_ge_u32 s79, 4
    s_cbranch_scc1 LWD_15
    s_sub_u32 s80, s80, 1
    s_cmp_lg_u32 s80, 0
    s_cbranch_scc1 LW_14
LWD_15:
    ds_read_b128 v[16:19], v7 offset:0
    ds_read_b128 v[20:23], v7 offset:16
    ds_read_b128 v[24:27], v7 offset:2048
    ds_read_b128 v[28:31], v7 offset:2064
    ds_read_b128 v[32:35], v7 offset:4096
    ds_read_b128 v[36:39], v7 offset:4112
    ds_read_b128 v[40:43], v7 offset:6144
    ds_read_b128 v[44:47], v7 offset:6160
    s_waitcnt lgkmcnt(0)
    v_add_f32 v16, v16, v32
    v_add_f32 v17, v17, v33
    v_add_f32 v18, v18, v34
    v_add_f32 v19, v19, v35
    v_add_f32 v20, v20, v36
    v_add_f32 v21, v21, v37
    v_add_f32 v22, v22, v38
    v_add_f32 v23, v23, v39
    v_add_f32 v24, v24, v40
    v_add_f32 v25, v25, v41
    v_add_f32 v26, v26, v42
    v_add_f32 v27, v27, v43
    v_add_f32 v28, v28, v44
    v_add_f32 v29, v29, v45
    v_add_f32 v30, v30, v46
    v_add_f32 v31, v31, v47
    v_add_f32 v16, v16, v24
    v_add_f32 v17, v17, v25
    v_add_f32 v18, v18, v26
    v_add_f32 v19, v19, v27
    v_add_f32 v20, v20, v28
    v_add_f32 v21, v21, v29
    v_add_f32 v22, v22, v30
    v_add_f32 v23, v23, v31
    v_cvt_pk_bf16_f32 v112, v16, v17
    v_cvt_pk_bf16_f32 v113, v18, v19
    v_cvt_pk_bf16_f32 v116, v20, v21
    v_cvt_pk_bf16_f32 v117, v22, v23
    buffer_store_dwordx4 v[112:115], v5, s[36:39], 0 offen offset:0
    buffer_store_dwordx4 v[116:119], v5, s[36:39], 0 offen offset:1024
    v_mov_b32 v100, 0x24018
    v_mov_b32 v101, 1
    s_waitcnt lgkmcnt(0)
    s_mov_b64 exec, 1
    ds_add_u32 v100, v101
    s_mov_b64 exec, -1
    v_mov_b32 v100, 0x24040
    s_mov_b32 s80, 1600000
LW_16:
    ds_read_b32 v101, v100
    s_waitcnt lgkmcnt(0)
    v_readfirstlane_b32 s79, v101
    s_cmp_ge_u32 s79, 4
    s_cbranch_scc1 LWD_17
    s_sub_u32 s80, s80, 1
    s_cmp_lg_u32 s80, 0
    s_cbranch_scc1 LW_16
LWD_17:
    ds_read_b128 v[16:19], v7 offset:8192
    ds_read_b128 v[20:23], v7 offset:8208
    ds_read_b128 v[24:27], v7 offset:10240
    ds_read_b128 v[28:31], v7 offset:10256
    ds_read_b128 v[32:35], v7 offset:12288
    ds_read_b128 v[36:39], v7 offset:12304
    ds_read_b128 v[40:43], v7 offset:14336
    ds_read_b128 v[44:47], v7 offset:14352
    s_waitcnt lgkmcnt(0)
    v_add_f32 v16, v16, v32
    v_add_f32 v17, v17, v33
    v_add_f32 v18, v18, v34
    v_add_f32 v19, v19, v35
    v_add_f32 v20, v20, v36
    v_add_f32 v21, v21, v37
    v_add_f32 v22, v22, v38
    v_add_f32 v23, v23, v39
    v_add_f32 v24, v24, v40
    v_add_f32 v25, v25, v41
    v_add_f32 v26, v26, v42
    v_add_f32 v27, v27, v43
    v_add_f32 v28, v28, v44
    v_add_f32 v29, v29, v45
    v_add_f32 v30, v30, v46
    v_add_f32 v31, v31, v47
    v_add_f32 v16, v16, v24
    v_add_f32 v17, v17, v25
    v_add_f32 v18, v18, v26
    v_add_f32 v19, v19, v27
    v_add_f32 v20, v20, v28
    v_add_f32 v21, v21, v29
    v_add_f32 v22, v22, v30
    v_add_f32 v23, v23, v31
    v_cvt_pk_bf16_f32 v120, v16, v17
    v_cvt_pk_bf16_f32 v121, v18, v19
    v_cvt_pk_bf16_f32 v124, v20, v21
    v_cvt_pk_bf16_f32 v125, v22, v23
    buffer_store_dwordx4 v[120:123], v6, s[36:39], 0 offen offset:0
    buffer_store_dwordx4 v[124:127], v6, s[36:39], 0 offen offset:1024
    v_mov_b32 v100, 0x24018
    v_mov_b32 v101, 1
    s_waitcnt lgkmcnt(0)
    s_mov_b64 exec, 1
    ds_add_u32 v100, v101
    s_mov_b64 exec, -1
    v_mov_b32 v110, v5
    v_mov_b32 v111, v6
    s_getreg_b32 s96, hwreg(HW_REG_XCC_ID, 0, 4)
    s_lshl_b32 s7, s4, 5
    s_add_u32 s7, s7, s5
    s_lshl_b32 s7, s7, 4
    s_add_u32 s7, s7, 0xc0000
    v_mov_b32 v100, s7
    v_mov_b32 v102, s96
    v_mov_b32 v103, 0
    v_mov_b32 v104, s94
    v_mov_b32 v105, s95
    s_mov_b64 exec, 1
    buffer_store_dwordx4 v[102:105], v100, s[36:39], 0 offen
    s_mov_b64 exec, -1
    s_sleep 16
    buffer_load_dwordx4 v[32:35], v3, s[36:39], 0 offen offset:0 sc1
    buffer_load_dwordx4 v[36:39], v3, s[36:39], 0 offen offset:1024 sc1
    s_mov_b32 s80, 200000
PS_18:
    s_waitcnt vmcnt(0)
    s_mov_b32 s78, 0
    v_cmp_ne_u64 vcc, s[94:95], v[34:35]
    s_cbranch_vccz PSS_20
    buffer_load_dwordx4 v[32:35], v3, s[36:39], 0 offen offset:0 sc1
    s_mov_b32 s78, 1
PSS_20:
    v_cmp_ne_u64 vcc, s[94:95], v[38:39]
    s_cbranch_vccz PSS_21
    buffer_load_dwordx4 v[36:39], v3, s[36:39], 0 offen offset:1024 sc1
    s_mov_b32 s78, 1
PSS_21:
    s_cmp_eq_u32 s78, 0
    s_cbranch_scc1 PSD_19
    s_sleep 8
    s_cmp_lg_u32 s80, 199984
    s_cbranch_scc1 PSL_22
    buffer_store_dwordx4 v[112:115], v110, s[36:39], 0 offen offset:0 sc1
    buffer_store_dwordx4 v[116:119], v110, s[36:39], 0 offen offset:1024 sc1
    buffer_store_dwordx4 v[120:123], v111, s[36:39], 0 offen offset:0 sc1
    buffer_store_dwordx4 v[124:127], v111, s[36:39], 0 offen offset:1024 sc1
PSL_22:
    s_sub_u32 s80, s80, 1
    s_cmp_lg_u32 s80, 0
    s_cbranch_scc1 PS_18
    s_waitcnt vmcnt(0)
PSD_19:
    v_lshlrev_b32 v16, 16, v32
    v_and_b32 v17, 0xffff0000, v32
    v_lshlrev_b32 v18, 16, v33
    v_and_b32 v19, 0xffff0000, v33
    v_lshlrev_b32 v20, 16, v36
    v_and_b32 v21, 0xffff0000, v36
    v_lshlrev_b32 v22, 16, v37
    v_and_b32 v23, 0xffff0000, v37
    v_mov_b32 v24, v16
    v_mov_b32 v25, v17
    v_mov_b32 v26, v18
    v_mov_b32 v27, v19
    v_mov_b32 v28, v20
    v_mov_b32 v29, v21
    v_mov_b32 v30, v22
    v_mov_b32 v31, v23
    v_permlane32_swap_b32 v16, v24
    v_permlane32_swap_b32 v17, v25
    v_permlane32_swap_b32 v18, v26
    v_permlane32_swap_b32 v19, v27
    v_permlane32_swap_b32 v20, v28
    v_permlane32_swap_b32 v21, v29
    v_permlane32_swap_b32 v22, v30
    v_permlane32_swap_b32 v23, v31
    v_add_f32 v16, v16, v24
    v_add_f32 v17, v17, v25
    v_add_f32 v18, v18, v26
    v_add_f32 v19, v19, v27
    v_add_f32 v20, v20, v28
    v_add_f32 v21, v21, v29
    v_add_f32 v22, v22, v30
    v_add_f32 v23, v23, v31
    v_mov_b32 v24, v16
    v_mov_b32 v25, v17
    v_mov_b32 v26, v18
    v_mov_b32 v27, v19
    v_mov_b32 v28, v20
    v_mov_b32 v29, v21
    v_mov_b32 v30, v22
    v_mov_b32 v31, v23
    v_permlane16_swap_b32 v16, v24
    v_permlane16_swap_b32 v17, v25
    v_permlane16_swap_b32 v18, v26
    v_permlane16_swap_b32 v19, v27
    v_permlane16_swap_b32 v20, v28
    v_permlane16_swap_b32 v21, v29
    v_permlane16_swap_b32 v22, v30
    v_permlane16_swap_b32 v23, v31
    v_add_f32 v16, v16, v24
    v_add_f32 v17, v17, v25
    v_add_f32 v18, v18, v26
    v_add_f32 v19, v19, v27
    v_add_f32 v20, v20, v28
    v_add_f32 v21, v21, v29
    v_add_f32 v22, v22, v30
    v_add_f32 v23, v23, v31
    v_cvt_pk_bf16_f32 v8, v16, v17
    v_cvt_pk_bf16_f32 v9, v18, v19
    v_cvt_pk_bf16_f32 v10, v20, v21
    v_cvt_pk_bf16_f32 v11, v22, v23
    v_and_b32 v100, 15, v1
    v_lshlrev_b32 v100, 4, v100
    v_add_u32 v100, 0x24100, v100
    ds_write_b128 v100, v[8:11]
L_ACUT:
    v_mov_b32 v100, 0x24004
    v_mov_b32 v101, 1
    s_waitcnt lgkmcnt(0)
    s_mov_b64 exec, 1
    ds_add_u32 v100, v101
    s_mov_b64 exec, -1
    v_mov_b32 v100, 0x24008
    s_mov_b32 s80, 1600000
LW_23:
    ds_read_b32 v101, v100
    s_waitcnt lgkmcnt(0)
    v_readfirstlane_b32 s79, v101
    s_cmp_ge_u32 s79, 11
    s_cbranch_scc1 LWD_24
    s_sleep 8
    s_sub_u32 s80, s80, 1
    s_cmp_lg_u32 s80, 0
    s_cbranch_scc1 LW_23
LWD_24:
    v_and_b32 v100, 31, v1
    s_lshl_b32 s7, s4, 9
    s_add_u32 s7, s7, 0xc0000
    v_lshl_add_u32 v100, v100, 4, s7
    buffer_load_dwordx4 v[32:35], v100, s[36:39], 0 offen sc1
    s_waitcnt vmcnt(0)
    v_cmp_ne_u64 vcc, s[94:95], v[34:35]
    v_cmp_ne_u32 s[86:87], s96, v32
    s_or_b32 s97, vcc_lo, s86
    s_and_b32 s97, s97, 0xffff00ff
    s_cbranch_scc0 AF_25
    buffer_store_dwordx4 v[112:115], v110, s[36:39], 0 offen offset:0 sc1
    buffer_store_dwordx4 v[116:119], v110, s[36:39], 0 offen offset:1024 sc1
    buffer_store_dwordx4 v[120:123], v111, s[36:39], 0 offen offset:0 sc1
    buffer_store_dwordx4 v[124:127], v111, s[36:39], 0 offen offset:1024 sc1
AF_25:
    v_mov_b32 v100, 0x24200
    ds_read_b128 v[8:11], v100 offset:0
    ds_read_b128 v[12:15], v100 offset:16
    ds_read_b128 v[16:19], v100 offset:32
    ds_read_b128 v[20:23], v100 offset:48
    ds_read_b128 v[24:27], v100 offset:64
    ds_read_b128 v[28:31], v100 offset:80
    s_waitcnt lgkmcnt(0)
    v_max3_f32 v100, v8, v10, v12
    v_max3_f32 v100, v100, v14, v16
    v_max3_f32 v100, v100, v18, v20
    v_max3_f32 v100, v100, v22, v24
    v_max3_f32 v100, v100, v26, v28
    v_sub_f32 v8, v8, v100
    v_sub_f32 v10, v10, v100
    v_sub_f32 v12, v12, v100
    v_sub_f32 v14, v14, v100
    v_sub_f32 v16, v16, v100
    v_sub_f32 v18, v18, v100
    v_sub_f32 v20, v20, v100
    v_sub_f32 v22, v22, v100
    v_sub_f32 v24, v24, v100
    v_sub_f32 v26, v26, v100
    v_sub_f32 v28, v28, v100
    v_exp_f32 v8, v8
    v_exp_f32 v10, v10
    v_exp_f32 v12, v12
    v_exp_f32 v14, v14
    v_exp_f32 v16, v16
    v_exp_f32 v18, v18
    v_exp_f32 v20, v20
    v_exp_f32 v22, v22
    v_exp_f32 v24, v24
    v_exp_f32 v26, v26
    v_exp_f32 v28, v28
    v_mul_f32 v101, v8, v9
    v_fmac_f32 v101, v10, v11
    v_fmac_f32 v101, v12, v13
    v_fmac_f32 v101, v14, v15
    v_fmac_f32 v101, v16, v17
    v_fmac_f32 v101, v18, v19
    v_fmac_f32 v101, v20, v21
    v_fmac_f32 v101, v22, v23
    v_fmac_f32 v101, v24, v25
    v_fmac_f32 v101, v26, v27
    v_fmac_f32 v101, v28, v29
    v_rcp_f32 v101, v101
    s_nop 0
    v_mul_f32 v8, v8, v101
    v_mul_f32 v10, v10, v101
    v_mul_f32 v12, v12, v101
    v_mul_f32 v14, v14, v101
    v_mul_f32 v16, v16, v101
    v_mul_f32 v18, v18, v101
    v_mul_f32 v20, v20, v101
    v_mul_f32 v22, v22, v101
    v_mul_f32 v24, v24, v101
    v_mul_f32 v26, v26, v101
    v_mul_f32 v28, v28, v101
    v_and_b32 v100, 15, v1
    v_bfe_u32 v101, v1, 4, 1
    v_lshlrev_b32 v3, 5, v100
    v_lshl_add_u32 v3, v101, 4, v3
    v_add_u32 v3, 0x10000, v3
    s_lshl_b32 s7, s6, 3
    s_add_u32 s7, s7, s60
    s_lshl_b32 s7, s7, 8
    s_add_u32 s7, s7, 0xd0000
    v_lshlrev_b32 v2, 4, v100
    v_lshl_add_u32 v2, v101, 10, v2
    v_add_u32 v2, s7, v2
    v_mov_b32 v6, s94
    v_mov_b32 v7, s95
    s_barrier
    ds_read_b128 v[40:43], v3 offset:0
    ds_read_b128 v[44:47], v3 offset:512
    ds_read_b128 v[48:51], v3 offset:1024
    ds_read_b128 v[52:55], v3 offset:1536
    ds_read_b128 v[56:59], v3 offset:2048
    ds_read_b128 v[60:63], v3 offset:2560
    ds_read_b128 v[64:67], v3 offset:3072
    ds_read_b128 v[68:71], v3 offset:3584
    ds_read_b128 v[72:75], v3 offset:4096
    ds_read_b128 v[76:79], v3 offset:4608
    ds_read_b128 v[80:83], v3 offset:5120
    s_waitcnt lgkmcnt(10)
    v_pk_mul_f32 v[32:33], v[40:41], v[8:9] op_sel_hi:[1,0]
    v_pk_mul_f32 v[34:35], v[42:43], v[8:9] op_sel_hi:[1,0]
    s_waitcnt lgkmcnt(9)
    v_pk_mul_f32 v[36:37], v[44:45], v[10:11] op_sel_hi:[1,0]
    v_pk_mul_f32 v[38:39], v[46:47], v[10:11] op_sel_hi:[1,0]
    s_waitcnt lgkmcnt(8)
    v_pk_fma_f32 v[32:33], v[48:49], v[12:13], v[32:33] op_sel_hi:[1,0,1]
    v_pk_fma_f32 v[34:35], v[50:51], v[12:13], v[34:35] op_sel_hi:[1,0,1]
    s_waitcnt lgkmcnt(7)
    v_pk_fma_f32 v[36:37], v[52:53], v[14:15], v[36:37] op_sel_hi:[1,0,1]
    v_pk_fma_f32 v[38:39], v[54:55], v[14:15], v[38:39] op_sel_hi:[1,0,1]
    s_waitcnt lgkmcnt(6)
    v_pk_fma_f32 v[32:33], v[56:57], v[16:17], v[32:33] op_sel_hi:[1,0,1]
    v_pk_fma_f32 v[34:35], v[58:59], v[16:17], v[34:35] op_sel_hi:[1,0,1]
    s_waitcnt lgkmcnt(5)
    v_pk_fma_f32 v[36:37], v[60:61], v[18:19], v[36:37] op_sel_hi:[1,0,1]
    v_pk_fma_f32 v[38:39], v[62:63], v[18:19], v[38:39] op_sel_hi:[1,0,1]
    s_waitcnt lgkmcnt(4)
    v_pk_fma_f32 v[32:33], v[64:65], v[20:21], v[32:33] op_sel_hi:[1,0,1]
    v_pk_fma_f32 v[34:35], v[66:67], v[20:21], v[34:35] op_sel_hi:[1,0,1]
    s_waitcnt lgkmcnt(3)
    v_pk_fma_f32 v[36:37], v[68:69], v[22:23], v[36:37] op_sel_hi:[1,0,1]
    v_pk_fma_f32 v[38:39], v[70:71], v[22:23], v[38:39] op_sel_hi:[1,0,1]
    s_waitcnt lgkmcnt(2)
    v_pk_fma_f32 v[32:33], v[72:73], v[24:25], v[32:33] op_sel_hi:[1,0,1]
    v_pk_fma_f32 v[34:35], v[74:75], v[24:25], v[34:35] op_sel_hi:[1,0,1]
    s_waitcnt lgkmcnt(1)
    v_pk_fma_f32 v[36:37], v[76:77], v[26:27], v[36:37] op_sel_hi:[1,0,1]
    v_pk_fma_f32 v[38:39], v[78:79], v[26:27], v[38:39] op_sel_hi:[1,0,1]
    s_waitcnt lgkmcnt(0)
    v_pk_fma_f32 v[32:33], v[80:81], v[28:29], v[32:33] op_sel_hi:[1,0,1]
    v_pk_fma_f32 v[34:35], v[82:83], v[28:29], v[34:35] op_sel_hi:[1,0,1]
    v_pk_add_f32 v[32:33], v[32:33], v[36:37]
    v_pk_add_f32 v[34:35], v[34:35], v[38:39]
    v_cvt_pk_bf16_f32 v4, v32, v33
    v_cvt_pk_bf16_f32 v5, v34, v35
    s_mov_b64 exec, 0xffffffff
    buffer_store_dwordx4 v[4:7], v2, s[36:39], 0 offen
    s_cmp_eq_u32 s97, 0
    s_cbranch_scc1 AF_26
    buffer_store_dwordx4 v[4:7], v2, s[36:39], 0 offen sc1
AF_26:
    s_mov_b64 exec, -1
    s_endpgm
.p2align 12
L_W:
    s_waitcnt lgkmcnt(0)
    s_mov_b32 s92, 0x05040100
    s_mov_b32 s93, 0x07060302
    s_mov_b32 s36, s34
    s_and_b32 s37, s35, 0xffff
    s_mov_b32 s38, 0x1000000
    s_mov_b32 s39, 0x20000
    s_mov_b32 s40, s32
    s_and_b32 s41, s33, 0xffff
    s_mov_b32 s42, 0x100
    s_mov_b32 s43, 0x20000
    s_barrier
    s_cmp_eq_u32 s3, 0
    s_cbranch_scc1 LT_U1
LR_U1:
    s_cmp_eq_u32 s3, 1
    s_cbranch_scc1 LT_W2R
LR_W2R:
    s_cmp_ge_u32 s5, 4
    s_cbranch_scc1 L_END
    v_mov_b32 v160, 0x24048
    s_mov_b32 s80, 1600000
LW_27:
    ds_read_b32 v161, v160
    s_waitcnt lgkmcnt(0)
    v_readfirstlane_b32 s79, v161
    s_cmp_ge_u32 s79, 4
    s_cbranch_scc1 LWD_28
    s_sleep 4
    s_sub_u32 s80, s80, 1
    s_cmp_lg_u32 s80, 0
    s_cbranch_scc1 LW_27
LWD_28:
    s_branch L_U1
L_W1:
    s_waitcnt lgkmcnt(0)
    s_mov_b32 s92, 0x05040100
    s_mov_b32 s93, 0x07060302
    s_mov_b32 s36, s34
    s_and_b32 s37, s35, 0xffff
    s_mov_b32 s38, 0x1000000
    s_mov_b32 s39, 0x20000
    s_mov_b32 s40, s32
    s_and_b32 s41, s33, 0xffff
    s_mov_b32 s42, 0x100
    s_mov_b32 s43, 0x20000
    s_setprio 3
    s_barrier
    s_cmp_lg_u32 s3, 4
    s_cbranch_scc1 W4_29
    s_sleep 8
    v_mov_b32 v152, 0
    s_mov_b32 s80, 200000
    s_mov_b64 exec, 1
    buffer_load_dwordx2 v[156:157], v152, s[40:43], 0 offen sc1
    s_sleep 16
    buffer_load_dwordx2 v[154:155], v152, s[40:43], 0 offen sc1
    s_mov_b64 exec, -1
    s_waitcnt vmcnt(1)
    v_readfirstlane_b32 s94, v156
    v_readfirstlane_b32 s95, v157
    s_cmp_lg_u32 s95, 0
    s_cbranch_scc1 NGD_31
    s_branch NG2_32
NG_30:
    s_mov_b64 exec, 1
    buffer_load_dwordx2 v[154:155], v152, s[40:43], 0 offen sc1
    s_mov_b64 exec, -1
NG2_32:
    s_waitcnt vmcnt(0)
    v_readfirstlane_b32 s94, v154
    v_readfirstlane_b32 s95, v155
    s_cmp_lg_u32 s95, 0
    s_cbranch_scc1 NGD_31
    s_sleep 4
    s_sub_u32 s80, s80, 1
    s_cmp_lg_u32 s80, 0
    s_cbranch_scc1 NG_30
NGD_31:
    v_mov_b32 v160, 0x24050
    v_mov_b32 v162, s94
    v_mov_b32 v163, s95
    ds_write_b64 v160, v[162:163]
    v_mov_b32 v160, 0x2404c
    v_mov_b32 v161, 1
    s_waitcnt lgkmcnt(0)
    s_mov_b64 exec, 1
    ds_add_u32 v160, v161
    s_mov_b64 exec, -1
    s_getreg_b32 s96, hwreg(HW_REG_XCC_ID, 0, 4)
    s_lshl_b32 s7, s4, 5
    s_add_u32 s7, s7, s5
    s_lshl_b32 s7, s7, 4
    s_add_u32 s7, s7, 0xc0000
    v_mov_b32 v160, s7
    v_mov_b32 v162, s96
    v_mov_b32 v163, 0
    v_mov_b32 v164, s94
    v_mov_b32 v165, s95
    s_mov_b64 exec, 1
    buffer_store_dwordx4 v[162:165], v160, s[36:39], 0 offen
    s_mov_b64 exec, -1
W4_29:
    s_sub_u32 s62, s3, 4
    s_lshl_b32 s61, s4, 2
    s_add_u32 s61, s61, s62
    v_lshrrev_b32 v162, 4, v1
    v_and_b32 v161, 15, v1
    v_lshlrev_b32 v2, 16, v162
    v_lshl_add_u32 v2, v161, 4, v2
    s_lshl_b32 s7, s61, 3
    s_add_u32 s7, s7, s5
    s_lshl_b32 s7, s7, 8
    s_add_u32 s7, s7, 0x0
    v_add_u32 v2, s7, v2
    v_lshlrev_b32 v3, 6, v161
    v_lshl_add_u32 v3, v162, 4, v3
    s_lshl_b32 s7, s61, 13
    s_add_u32 s7, s7, 0x40000
    v_add_u32 v3, s7, v3
    v_xor_b32 v5, v162, v161
    v_lshlrev_b32 v5, 4, v5
    v_lshl_add_u32 v4, v161, 12, v5
    s_lshl_b32 s7, s62, 8
    v_add_u32 v4, s7, v4
    v_mov_b32 v160, 0x2404c
    s_mov_b32 s80, 1600000
LW_33:
    ds_read_b32 v161, v160
    s_waitcnt lgkmcnt(0)
    v_readfirstlane_b32 s79, v161
    s_cmp_ge_u32 s79, 1
    s_cbranch_scc1 LWD_34
    s_sleep 2
    s_sub_u32 s80, s80, 1
    s_cmp_lg_u32 s80, 0
    s_cbranch_scc1 LW_33
LWD_34:
    v_mov_b32 v160, 0x24050
    ds_read_b64 v[162:163], v160
    s_waitcnt lgkmcnt(0)
    v_readfirstlane_b32 s94, v162
    v_readfirstlane_b32 s95, v163
    s_sleep 4
    s_mov_b32 s63, 4096
    buffer_load_dwordx4 v[72:75], v3, s[36:39], 0 offen offset:0 sc1
    buffer_load_dwordx4 v[76:79], v3, s[36:39], 0 offen offset:1024 sc1
    buffer_load_dwordx4 v[80:83], v3, s[36:39], 0 offen offset:2048 sc1
    buffer_load_dwordx4 v[84:87], v3, s[36:39], 0 offen offset:3072 sc1
    buffer_load_dwordx4 v[88:91], v3, s[36:39], s63 offen offset:0 sc1
    buffer_load_dwordx4 v[92:95], v3, s[36:39], s63 offen offset:1024 sc1
    buffer_load_dwordx4 v[96:99], v3, s[36:39], s63 offen offset:2048 sc1
    buffer_load_dwordx4 v[100:103], v3, s[36:39], s63 offen offset:3072 sc1
    v_mov_b32 v160, 0x24014
    s_mov_b32 s80, 1600000
LW_37:
    ds_read_b32 v161, v160
    s_waitcnt lgkmcnt(0)
    v_readfirstlane_b32 s79, v161
    s_cmp_ge_u32 s79, 4
    s_cbranch_scc1 LWD_38
    s_sleep 1
    s_sub_u32 s80, s80, 1
    s_cmp_lg_u32 s80, 0
    s_cbranch_scc1 LW_37
LWD_38:
    v_xor_b32 v160, 0x0, v4
    v_xor_b32 v161, 0x40, v4
    v_xor_b32 v162, 0x80, v4
    v_xor_b32 v163, 0xc0, v4
    ds_read_b128 v[8:11], v160 offset:0
    ds_read_b128 v[12:15], v161 offset:0
    ds_read_b128 v[16:19], v162 offset:0
    ds_read_b128 v[20:23], v163 offset:0
    ds_read_b128 v[24:27], v160 offset:1024
    ds_read_b128 v[28:31], v161 offset:1024
    ds_read_b128 v[32:35], v162 offset:1024
    ds_read_b128 v[36:39], v163 offset:1024
    ds_read_b128 v[40:43], v160 offset:2048
    ds_read_b128 v[44:47], v161 offset:2048
    ds_read_b128 v[48:51], v162 offset:2048
    ds_read_b128 v[52:55], v163 offset:2048
    ds_read_b128 v[56:59], v160 offset:3072
    ds_read_b128 v[60:63], v161 offset:3072
    ds_read_b128 v[64:67], v162 offset:3072
    ds_read_b128 v[68:71], v163 offset:3072
    s_mov_b32 s80, 200000
PS_35:
    s_waitcnt vmcnt(0)
    s_mov_b32 s78, 0
    v_cmp_ne_u64 vcc, s[94:95], v[74:75]
    s_cbranch_vccz PSS_39
    buffer_load_dwordx4 v[72:75], v3, s[36:39], 0 offen offset:0 sc1
    s_mov_b32 s78, 1
PSS_39:
    v_cmp_ne_u64 vcc, s[94:95], v[78:79]
    s_cbranch_vccz PSS_40
    buffer_load_dwordx4 v[76:79], v3, s[36:39], 0 offen offset:1024 sc1
    s_mov_b32 s78, 1
PSS_40:
    v_cmp_ne_u64 vcc, s[94:95], v[82:83]
    s_cbranch_vccz PSS_41
    buffer_load_dwordx4 v[80:83], v3, s[36:39], 0 offen offset:2048 sc1
    s_mov_b32 s78, 1
PSS_41:
    v_cmp_ne_u64 vcc, s[94:95], v[86:87]
    s_cbranch_vccz PSS_42
    buffer_load_dwordx4 v[84:87], v3, s[36:39], 0 offen offset:3072 sc1
    s_mov_b32 s78, 1
PSS_42:
    v_cmp_ne_u64 vcc, s[94:95], v[90:91]
    s_cbranch_vccz PSS_43
    buffer_load_dwordx4 v[88:91], v3, s[36:39], s63 offen offset:0 sc1
    s_mov_b32 s78, 1
PSS_43:
    v_cmp_ne_u64 vcc, s[94:95], v[94:95]
    s_cbranch_vccz PSS_44
    buffer_load_dwordx4 v[92:95], v3, s[36:39], s63 offen offset:1024 sc1
    s_mov_b32 s78, 1
PSS_44:
    v_cmp_ne_u64 vcc, s[94:95], v[98:99]
    s_cbranch_vccz PSS_45
    buffer_load_dwordx4 v[96:99], v3, s[36:39], s63 offen offset:2048 sc1
    s_mov_b32 s78, 1
PSS_45:
    v_cmp_ne_u64 vcc, s[94:95], v[102:103]
    s_cbranch_vccz PSS_46
    buffer_load_dwordx4 v[100:103], v3, s[36:39], s63 offen offset:3072 sc1
    s_mov_b32 s78, 1
PSS_46:
    s_cmp_eq_u32 s78, 0
    s_cbranch_scc1 PSD_36
    s_sub_u32 s80, s80, 1
    s_cmp_lg_u32 s80, 0
    s_cbranch_scc1 PS_35
    s_waitcnt vmcnt(0)
PSD_36:
    v_lshlrev_b32 v104, 16, v72
    v_and_b32 v105, 0xffff0000, v72
    v_lshlrev_b32 v106, 16, v73
    v_and_b32 v107, 0xffff0000, v73
    v_lshlrev_b32 v108, 16, v76
    v_and_b32 v109, 0xffff0000, v76
    v_lshlrev_b32 v110, 16, v77
    v_and_b32 v111, 0xffff0000, v77
    v_lshlrev_b32 v120, 16, v80
    v_and_b32 v121, 0xffff0000, v80
    v_lshlrev_b32 v122, 16, v81
    v_and_b32 v123, 0xffff0000, v81
    v_lshlrev_b32 v124, 16, v84
    v_and_b32 v125, 0xffff0000, v84
    v_lshlrev_b32 v126, 16, v85
    v_and_b32 v127, 0xffff0000, v85
    v_add_f32 v104, v104, v120
    v_add_f32 v105, v105, v121
    v_add_f32 v106, v106, v122
    v_add_f32 v107, v107, v123
    v_add_f32 v108, v108, v124
    v_add_f32 v109, v109, v125
    v_add_f32 v110, v110, v126
    v_add_f32 v111, v111, v127
    v_lshlrev_b32 v112, 16, v88
    v_and_b32 v113, 0xffff0000, v88
    v_lshlrev_b32 v114, 16, v89
    v_and_b32 v115, 0xffff0000, v89
    v_lshlrev_b32 v116, 16, v92
    v_and_b32 v117, 0xffff0000, v92
    v_lshlrev_b32 v118, 16, v93
    v_and_b32 v119, 0xffff0000, v93
    v_add_f32 v104, v104, v112
    v_add_f32 v105, v105, v113
    v_add_f32 v106, v106, v114
    v_add_f32 v107, v107, v115
    v_add_f32 v108, v108, v116
    v_add_f32 v109, v109, v117
    v_add_f32 v110, v110, v118
    v_add_f32 v111, v111, v119
    v_lshlrev_b32 v120, 16, v96
    v_and_b32 v121, 0xffff0000, v96
    v_lshlrev_b32 v122, 16, v97
    v_and_b32 v123, 0xffff0000, v97
    v_lshlrev_b32 v124, 16, v100
    v_and_b32 v125, 0xffff0000, v100
    v_lshlrev_b32 v126, 16, v101
    v_and_b32 v127, 0xffff0000, v101
    v_add_f32 v104, v104, v120
    v_add_f32 v105, v105, v121
    v_add_f32 v106, v106, v122
    v_add_f32 v107, v107, v123
    v_add_f32 v108, v108, v124
    v_add_f32 v109, v109, v125
    v_add_f32 v110, v110, v126
    v_add_f32 v111, v111, v127
    v_cvt_pk_bf16_f32 v136, v104, v105
    v_cvt_pk_bf16_f32 v137, v106, v107
    v_cvt_pk_bf16_f32 v138, v108, v109
    v_cvt_pk_bf16_f32 v139, v110, v111
    v_mov_b32_dpp v140, v136 quad_perm:[1,2,3,0] row_mask:0xf bank_mask:0xf
    v_mov_b32_dpp v141, v137 quad_perm:[1,2,3,0] row_mask:0xf bank_mask:0xf
    v_mov_b32_dpp v142, v138 quad_perm:[1,2,3,0] row_mask:0xf bank_mask:0xf
    v_mov_b32_dpp v143, v139 quad_perm:[1,2,3,0] row_mask:0xf bank_mask:0xf
    v_mov_b32_dpp v144, v136 quad_perm:[2,3,0,1] row_mask:0xf bank_mask:0xf
    v_mov_b32_dpp v145, v137 quad_perm:[2,3,0,1] row_mask:0xf bank_mask:0xf
    v_mov_b32_dpp v146, v138 quad_perm:[2,3,0,1] row_mask:0xf bank_mask:0xf
    v_mov_b32_dpp v147, v139 quad_perm:[2,3,0,1] row_mask:0xf bank_mask:0xf
    v_mov_b32_dpp v148, v136 quad_perm:[3,0,1,2] row_mask:0xf bank_mask:0xf
    v_mov_b32_dpp v149, v137 quad_perm:[3,0,1,2] row_mask:0xf bank_mask:0xf
    v_mov_b32_dpp v150, v138 quad_perm:[3,0,1,2] row_mask:0xf bank_mask:0xf
    v_mov_b32_dpp v151, v139 quad_perm:[3,0,1,2] row_mask:0xf bank_mask:0xf
    v_mov_b32 v74, s94
    v_mov_b32 v75, s95
    s_waitcnt lgkmcnt(0)
    v_mfma_f32_16x16x32_bf16 v[104:107], v[136:139], v[8:11], 0
    v_mfma_f32_16x16x32_bf16 v[108:111], v[136:139], v[28:31], 0
    v_mfma_f32_16x16x32_bf16 v[112:115], v[136:139], v[48:51], 0
    v_mfma_f32_16x16x32_bf16 v[116:119], v[136:139], v[68:71], 0
    v_mfma_f32_16x16x32_bf16 v[104:107], v[140:143], v[12:15], v[104:107]
    v_mfma_f32_16x16x32_bf16 v[108:111], v[140:143], v[32:35], v[108:111]
    v_mfma_f32_16x16x32_bf16 v[112:115], v[140:143], v[52:55], v[112:115]
    v_mfma_f32_16x16x32_bf16 v[116:119], v[140:143], v[56:59], v[116:119]
    v_mfma_f32_16x16x32_bf16 v[104:107], v[144:147], v[16:19], v[104:107]
    v_mfma_f32_16x16x32_bf16 v[108:111], v[144:147], v[36:39], v[108:111]
    v_mfma_f32_16x16x32_bf16 v[112:115], v[144:147], v[40:43], v[112:115]
    v_mfma_f32_16x16x32_bf16 v[116:119], v[144:147], v[60:63], v[116:119]
    v_mfma_f32_16x16x32_bf16 v[104:107], v[148:151], v[20:23], v[104:107]
    v_mfma_f32_16x16x32_bf16 v[108:111], v[148:151], v[24:27], v[108:111]
    v_mfma_f32_16x16x32_bf16 v[112:115], v[148:151], v[44:47], v[112:115]
    v_mfma_f32_16x16x32_bf16 v[116:119], v[148:151], v[64:67], v[116:119]
    s_nop 5
    v_cvt_pk_bf16_f32 v72, v104, v109
    s_nop 0
    v_cvt_pk_bf16_f32 v73, v114, v119
    buffer_store_dwordx4 v[72:75], v2, s[36:39], 0 offen sc1
    v_mov_b32 v160, 0x24048
    v_mov_b32 v161, 1
    s_waitcnt lgkmcnt(0)
    s_mov_b64 exec, 1
    ds_add_u32 v160, v161
    s_mov_b64 exec, -1
    s_setprio 0
    s_cmp_ge_u32 s5, 4
    s_cbranch_scc1 L_END
    s_branch L_U1
L_CSVC:
    s_cmp_lg_u32 s3, 11
    s_cbranch_scc1 Z_95
    v_lshlrev_b32 v2, 2, v1
    v_add_u32 v2, 0x24000, v2
    v_mov_b32 v3, 0
    ds_write_b32 v2, v3
Z_95:
    s_waitcnt lgkmcnt(0)
    s_mov_b32 s92, 0x05040100
    s_mov_b32 s93, 0x07060302
    s_mov_b32 s36, s34
    s_and_b32 s37, s35, 0xffff
    s_mov_b32 s38, 0x1000000
    s_mov_b32 s39, 0x20000
    s_mov_b32 s40, s32
    s_and_b32 s41, s33, 0xffff
    s_mov_b32 s42, 0x100
    s_mov_b32 s43, 0x20000
    s_setprio 3
    s_sub_u32 s60, s3, 8
    s_lshl_b32 s64, s4, 3
    s_add_u32 s64, s64, s5
    s_sub_u32 s64, s64, 8
    v_lshlrev_b32 v2, 4, v1
    s_barrier
    s_cmp_eq_u32 s3, 9
    s_cbranch_scc1 LT_CR
LR_CR:
    s_cmp_eq_u32 s3, 10
    s_cbranch_scc1 LT_CR2
LR_CR2:
    s_cmp_lg_u32 s60, 0
    s_cbranch_scc1 C8_96
    s_sleep 24
    v_mov_b32 v160, 0
    s_mov_b32 s80, 200000
NG_97:
    s_mov_b64 exec, 1
    buffer_load_dwordx2 v[162:163], v160, s[40:43], 0 offen sc1
    s_mov_b64 exec, -1
    s_waitcnt vmcnt(0)
    v_readfirstlane_b32 s94, v162
    v_readfirstlane_b32 s95, v163
    s_cmp_lg_u32 s95, 0
    s_cbranch_scc1 NGD_98
    s_sleep 4
    s_sub_u32 s80, s80, 1
    s_cmp_lg_u32 s80, 0
    s_cbranch_scc1 NG_97
NGD_98:
    v_mov_b32 v160, 0x24050
    v_mov_b32 v162, s94
    v_mov_b32 v163, s95
    ds_write_b64 v160, v[162:163]
    v_mov_b32 v160, 0x2404c
    v_mov_b32 v161, 1
    s_waitcnt lgkmcnt(0)
    s_mov_b64 exec, 1
    ds_add_u32 v160, v161
    s_mov_b64 exec, -1
C8_96:
    s_lshr_b32 s7, s64, 4
    s_lshl_b32 s7, s7, 16
    s_lshl_b32 s63, s60, 14
    s_add_u32 s7, s7, s63
    s_add_u32 s7, s7, 0x0
    v_lshl_add_u32 v4, v1, 4, s7
    s_and_b32 s7, s60, 1
    s_lshl_b32 s7, s7, 7
    v_lshlrev_b32 v3, 3, v1
    v_xor_b32 v3, s7, v3
    s_lshl_b32 s7, s60, 13
    s_add_u32 s7, s7, 0x18000
    v_add_u32 v3, s7, v3
    s_mov_b32 s44, s20
    s_and_b32 s45, s21, 0xffff
    s_mov_b32 s46, 0x1000000
    s_mov_b32 s47, 0x20000
    s_lshl_b32 s7, s64, 18
    s_lshl_b32 s65, s60, 10
    s_add_u32 s65, s65, s7
    s_add_u32 s65, s65, 196608
    s_lshl_b32 s7, s60, 6
    v_xor_b32 v12, s7, v2
    v_xor_b32 v13, 16, v12
    v_xor_b32 v14, 32, v12
    v_xor_b32 v15, 48, v12
    v_mov_b32 v160, 0x2404c
    s_mov_b32 s80, 1600000
LW_99:
    ds_read_b32 v161, v160
    s_waitcnt lgkmcnt(0)
    v_readfirstlane_b32 s79, v161
    s_cmp_ge_u32 s79, 1
    s_cbranch_scc1 LWD_100
    s_sleep 4
    s_sub_u32 s80, s80, 1
    s_cmp_lg_u32 s80, 0
    s_cbranch_scc1 LW_99
LWD_100:
    v_mov_b32 v160, 0x24050
    ds_read_b64 v[162:163], v160
    s_waitcnt lgkmcnt(0)
    v_readfirstlane_b32 s94, v162
    v_readfirstlane_b32 s95, v163
    v_mov_b32 v160, 0x24018
    s_mov_b32 s80, 1600000
LW_101:
    ds_read_b32 v161, v160
    s_waitcnt lgkmcnt(0)
    v_readfirstlane_b32 s79, v161
    s_cmp_ge_u32 s79, 8
    s_cbranch_scc1 LWD_102
    s_sleep 2
    s_sub_u32 s80, s80, 1
    s_cmp_lg_u32 s80, 0
    s_cbranch_scc1 LW_101
LWD_102:
    s_sleep 1
    s_mov_b32 s67, 4096
    s_mov_b32 s68, 8192
    s_mov_b32 s69, 12288
    buffer_load_dwordx4 v[96:99], v4, s[36:39], 0 offen offset:0 sc1
    buffer_load_dwordx4 v[100:103], v4, s[36:39], 0 offen offset:1024 sc1
    buffer_load_dwordx4 v[104:107], v4, s[36:39], 0 offen offset:2048 sc1
    buffer_load_dwordx4 v[108:111], v4, s[36:39], 0 offen offset:3072 sc1
    buffer_load_dwordx4 v[112:115], v4, s[36:39], s67 offen offset:0 sc1
    buffer_load_dwordx4 v[116:119], v4, s[36:39], s67 offen offset:1024 sc1
    buffer_load_dwordx4 v[120:123], v4, s[36:39], s67 offen offset:2048 sc1
    buffer_load_dwordx4 v[124:127], v4, s[36:39], s67 offen offset:3072 sc1
    buffer_load_dwordx4 v[128:131], v4, s[36:39], s68 offen offset:0 sc1
    buffer_load_dwordx4 v[132:135], v4, s[36:39], s68 offen offset:1024 sc1
    buffer_load_dwordx4 v[136:139], v4, s[36:39], s68 offen offset:2048 sc1
    buffer_load_dwordx4 v[140:143], v4, s[36:39], s68 offen offset:3072 sc1
    buffer_load_dwordx4 v[144:147], v4, s[36:39], s69 offen offset:0 sc1
    buffer_load_dwordx4 v[148:151], v4, s[36:39], s69 offen offset:1024 sc1
    buffer_load_dwordx4 v[152:155], v4, s[36:39], s69 offen offset:2048 sc1
    buffer_load_dwordx4 v[156:159], v4, s[36:39], s69 offen offset:3072 sc1
    s_mov_b32 s80, 200000
PS_103:
    s_waitcnt vmcnt(0)
    s_mov_b32 s78, 0
    v_cmp_ne_u64 vcc, s[94:95], v[98:99]
    s_cbranch_vccz PSS_105
    buffer_load_dwordx4 v[96:99], v4, s[36:39], 0 offen offset:0 sc1
    s_mov_b32 s78, 1
PSS_105:
    v_cmp_ne_u64 vcc, s[94:95], v[102:103]
    s_cbranch_vccz PSS_106
    buffer_load_dwordx4 v[100:103], v4, s[36:39], 0 offen offset:1024 sc1
    s_mov_b32 s78, 1
PSS_106:
    v_cmp_ne_u64 vcc, s[94:95], v[106:107]
    s_cbranch_vccz PSS_107
    buffer_load_dwordx4 v[104:107], v4, s[36:39], 0 offen offset:2048 sc1
    s_mov_b32 s78, 1
PSS_107:
    v_cmp_ne_u64 vcc, s[94:95], v[110:111]
    s_cbranch_vccz PSS_108
    buffer_load_dwordx4 v[108:111], v4, s[36:39], 0 offen offset:3072 sc1
    s_mov_b32 s78, 1
PSS_108:
    v_cmp_ne_u64 vcc, s[94:95], v[114:115]
    s_cbranch_vccz PSS_109
    buffer_load_dwordx4 v[112:115], v4, s[36:39], s67 offen offset:0 sc1
    s_mov_b32 s78, 1
PSS_109:
    v_cmp_ne_u64 vcc, s[94:95], v[118:119]
    s_cbranch_vccz PSS_110
    buffer_load_dwordx4 v[116:119], v4, s[36:39], s67 offen offset:1024 sc1
    s_mov_b32 s78, 1
PSS_110:
    v_cmp_ne_u64 vcc, s[94:95], v[122:123]
    s_cbranch_vccz PSS_111
    buffer_load_dwordx4 v[120:123], v4, s[36:39], s67 offen offset:2048 sc1
    s_mov_b32 s78, 1
PSS_111:
    v_cmp_ne_u64 vcc, s[94:95], v[126:127]
    s_cbranch_vccz PSS_112
    buffer_load_dwordx4 v[124:127], v4, s[36:39], s67 offen offset:3072 sc1
    s_mov_b32 s78, 1
PSS_112:
    v_cmp_ne_u64 vcc, s[94:95], v[130:131]
    s_cbranch_vccz PSS_113
    buffer_load_dwordx4 v[128:131], v4, s[36:39], s68 offen offset:0 sc1
    s_mov_b32 s78, 1
PSS_113:
    v_cmp_ne_u64 vcc, s[94:95], v[134:135]
    s_cbranch_vccz PSS_114
    buffer_load_dwordx4 v[132:135], v4, s[36:39], s68 offen offset:1024 sc1
    s_mov_b32 s78, 1
PSS_114:
    v_cmp_ne_u64 vcc, s[94:95], v[138:139]
    s_cbranch_vccz PSS_115
    buffer_load_dwordx4 v[136:139], v4, s[36:39], s68 offen offset:2048 sc1
    s_mov_b32 s78, 1
PSS_115:
    v_cmp_ne_u64 vcc, s[94:95], v[142:143]
    s_cbranch_vccz PSS_116
    buffer_load_dwordx4 v[140:143], v4, s[36:39], s68 offen offset:3072 sc1
    s_mov_b32 s78, 1
PSS_116:
    v_cmp_ne_u64 vcc, s[94:95], v[146:147]
    s_cbranch_vccz PSS_117
    buffer_load_dwordx4 v[144:147], v4, s[36:39], s69 offen offset:0 sc1
    s_mov_b32 s78, 1
PSS_117:
    v_cmp_ne_u64 vcc, s[94:95], v[150:151]
    s_cbranch_vccz PSS_118
    buffer_load_dwordx4 v[148:151], v4, s[36:39], s69 offen offset:1024 sc1
    s_mov_b32 s78, 1
PSS_118:
    v_cmp_ne_u64 vcc, s[94:95], v[154:155]
    s_cbranch_vccz PSS_119
    buffer_load_dwordx4 v[152:155], v4, s[36:39], s69 offen offset:2048 sc1
    s_mov_b32 s78, 1
PSS_119:
    v_cmp_ne_u64 vcc, s[94:95], v[158:159]
    s_cbranch_vccz PSS_120
    buffer_load_dwordx4 v[156:159], v4, s[36:39], s69 offen offset:3072 sc1
    s_mov_b32 s78, 1
PSS_120:
    s_cmp_eq_u32 s78, 0
    s_cbranch_scc1 PSD_104
    s_sub_u32 s80, s80, 1
    s_cmp_lg_u32 s80, 0
    s_cbranch_scc1 PS_103
    s_waitcnt vmcnt(0)
PSD_104:
    buffer_load_dwordx4 v[32:35], v12, s[44:47], s65 offen nt
    s_addk_i32 s65, 4096
    buffer_load_dwordx4 v[36:39], v13, s[44:47], s65 offen nt
    s_addk_i32 s65, 4096
    buffer_load_dwordx4 v[40:43], v14, s[44:47], s65 offen nt
    s_addk_i32 s65, 4096
    buffer_load_dwordx4 v[44:47], v15, s[44:47], s65 offen nt
    s_addk_i32 s65, 4096
    buffer_load_dwordx4 v[48:51], v12, s[44:47], s65 offen nt
    s_addk_i32 s65, 4096
    buffer_load_dwordx4 v[52:55], v13, s[44:47], s65 offen nt
    s_addk_i32 s65, 4096
    buffer_load_dwordx4 v[56:59], v14, s[44:47], s65 offen nt
    s_addk_i32 s65, 4096
    buffer_load_dwordx4 v[60:63], v15, s[44:47], s65 offen nt
    s_addk_i32 s65, 4096
    v_xor_b32 v6, 0x0, v3
    ds_write_b64 v6, v[96:97] offset:0
    ds_write_b64 v6, v[100:101] offset:512
    v_xor_b32 v7, 0x10, v3
    ds_write_b64 v7, v[104:105] offset:1024
    ds_write_b64 v7, v[108:109] offset:1536
    v_xor_b32 v6, 0x20, v3
    ds_write_b64 v6, v[112:113] offset:2048
    ds_write_b64 v6, v[116:117] offset:2560
    v_xor_b32 v7, 0x30, v3
    ds_write_b64 v7, v[120:121] offset:3072
    ds_write_b64 v7, v[124:125] offset:3584
    v_xor_b32 v6, 0x40, v3
    ds_write_b64 v6, v[128:129] offset:4096
    ds_write_b64 v6, v[132:133] offset:4608
    v_xor_b32 v7, 0x50, v3
    ds_write_b64 v7, v[136:137] offset:5120
    ds_write_b64 v7, v[140:141] offset:5632
    v_xor_b32 v6, 0x60, v3
    ds_write_b64 v6, v[144:145] offset:6144
    ds_write_b64 v6, v[148:149] offset:6656
    v_xor_b32 v7, 0x70, v3
    ds_write_b64 v7, v[152:153] offset:7168
    ds_write_b64 v7, v[156:157] offset:7680
L_CCUT:
    s_waitcnt lgkmcnt(0)
    s_barrier
    s_setprio 0
    s_barrier
    s_barrier
    buffer_load_dwordx4 v[64:67], v12, s[44:47], s65 offen nt
    s_addk_i32 s65, 4096
    buffer_load_dwordx4 v[68:71], v13, s[44:47], s65 offen nt
    s_addk_i32 s65, 4096
    buffer_load_dwordx4 v[72:75], v14, s[44:47], s65 offen nt
    s_addk_i32 s65, 4096
    buffer_load_dwordx4 v[76:79], v15, s[44:47], s65 offen nt
    s_addk_i32 s65, 4096
    buffer_load_dwordx4 v[80:83], v12, s[44:47], s65 offen nt
    s_addk_i32 s65, 4096
    buffer_load_dwordx4 v[84:87], v13, s[44:47], s65 offen nt
    s_addk_i32 s65, 4096
    buffer_load_dwordx4 v[88:91], v14, s[44:47], s65 offen nt
    s_addk_i32 s65, 4096
    buffer_load_dwordx4 v[92:95], v15, s[44:47], s65 offen nt
    s_addk_i32 s65, 4096
    s_barrier
    s_barrier
    s_barrier
    s_setprio 3
    s_lshl_b32 s7, s60, 10
    v_add_u32 v3, s7, v2
    s_waitcnt vmcnt(15)
    ds_write_b128 v3, v[32:35] offset:0
    s_waitcnt vmcnt(14)
    ds_write_b128 v3, v[36:39] offset:4096
    s_waitcnt vmcnt(13)
    ds_write_b128 v3, v[40:43] offset:8192
    s_waitcnt vmcnt(12)
    ds_write_b128 v3, v[44:47] offset:12288
    s_waitcnt vmcnt(11)
    ds_write_b128 v3, v[48:51] offset:16384
    s_waitcnt vmcnt(10)
    ds_write_b128 v3, v[52:55] offset:20480
    s_waitcnt vmcnt(9)
    ds_write_b128 v3, v[56:59] offset:24576
    s_waitcnt vmcnt(8)
    ds_write_b128 v3, v[60:63] offset:28672
    s_waitcnt vmcnt(7)
    ds_write_b128 v3, v[64:67] offset:32768
    s_waitcnt vmcnt(6)
    ds_write_b128 v3, v[68:71] offset:36864
    s_waitcnt vmcnt(5)
    ds_write_b128 v3, v[72:75] offset:40960
    s_waitcnt vmcnt(4)
    ds_write_b128 v3, v[76:79] offset:45056
    s_waitcnt vmcnt(3)
    ds_write_b128 v3, v[80:83] offset:49152
    s_waitcnt vmcnt(2)
    ds_write_b128 v3, v[84:87] offset:53248
    s_waitcnt vmcnt(1)
    ds_write_b128 v3, v[88:91] offset:57344
    s_waitcnt vmcnt(0)
    ds_write_b128 v3, v[92:95] offset:61440
    s_waitcnt lgkmcnt(0)
    s_endpgm
.p2align 12
LT_U1:
    s_branch LR_U1
L_U1:
    s_mov_b32 s48, s26
    s_and_b32 s49, s27, 0xffff
    s_mov_b32 s50, 0x400000
    s_mov_b32 s51, 0x20000
    v_lshrrev_b32 v162, 4, v1
    v_lshlrev_b32 v2, 16, v162
    v_and_b32 v160, 15, v1
    v_lshl_add_u32 v2, v160, 4, v2
    s_lshl_b32 s7, s6, 8
    v_add_u32 v2, s7, v2
    s_lshl_b32 s70, s3, 19
    s_waitcnt vmcnt(2)
    buffer_load_dwordx4 v[8:11], v2, s[48:51], s70 offen nt
    s_add_u32 s70, s70, 8192
    s_waitcnt vmcnt(2)
    buffer_load_dwordx4 v[12:15], v2, s[48:51], s70 offen nt
    s_add_u32 s70, s70, 8192
    s_waitcnt vmcnt(2)
    buffer_load_dwordx4 v[16:19], v2, s[48:51], s70 offen nt
    s_add_u32 s70, s70, 8192
    s_waitcnt vmcnt(2)
    buffer_load_dwordx4 v[20:23], v2, s[48:51], s70 offen nt
    s_add_u32 s70, s70, 8192
    s_waitcnt vmcnt(2)
    buffer_load_dwordx4 v[24:27], v2, s[48:51], s70 offen nt
    s_add_u32 s70, s70, 8192
    s_waitcnt vmcnt(2)
    buffer_load_dwordx4 v[28:31], v2, s[48:51], s70 offen nt
    s_add_u32 s70, s70, 8192
    s_waitcnt vmcnt(2)
    buffer_load_dwordx4 v[32:35], v2, s[48:51], s70 offen nt
    s_add_u32 s70, s70, 8192
    s_waitcnt vmcnt(2)
    buffer_load_dwordx4 v[36:39], v2, s[48:51], s70 offen nt
    s_add_u32 s70, s70, 204800
    s_waitcnt vmcnt(2)
    buffer_load_dwordx4 v[104:107], v2, s[48:51], s70 offen nt
    s_add_u32 s70, s70, 8192
    s_waitcnt vmcnt(2)
    buffer_load_dwordx4 v[108:111], v2, s[48:51], s70 offen nt
    s_add_u32 s70, s70, 8192
    s_waitcnt vmcnt(2)
    buffer_load_dwordx4 v[112:115], v2, s[48:51], s70 offen nt
    s_add_u32 s70, s70, 8192
    s_waitcnt vmcnt(2)
    buffer_load_dwordx4 v[116:119], v2, s[48:51], s70 offen nt
    s_add_u32 s70, s70, 8192
    s_waitcnt vmcnt(2)
    buffer_load_dwordx4 v[120:123], v2, s[48:51], s70 offen nt
    s_add_u32 s70, s70, 8192
    s_waitcnt vmcnt(2)
    buffer_load_dwordx4 v[124:127], v2, s[48:51], s70 offen nt
    s_add_u32 s70, s70, 8192
    s_waitcnt vmcnt(2)
    buffer_load_dwordx4 v[128:131], v2, s[48:51], s70 offen nt
    s_add_u32 s70, s70, 8192
    s_waitcnt vmcnt(2)
    buffer_load_dwordx4 v[132:135], v2, s[48:51], s70 offen nt
    s_add_u32 s70, s70, 204800
    v_lshlrev_b32 v3, 4, v1
    v_add_u32 v3, 0x24800, v3
    v_lshrrev_b32 v4, 1, v160
    v_lshlrev_b32 v4, 18, v4
    v_lshl_add_u32 v4, v162, 4, v4
    v_and_b32 v163, 1, v1
    v_lshl_add_u32 v4, v163, 6, v4
    v_cmp_eq_u32 s[86:87], 1, v163
    s_lshl_b32 s7, s3, 5
    s_add_u32 s7, s7, s6
    s_lshl_b32 s7, s7, 7
    s_add_u32 s7, s7, 0x500000
    v_add_u32 v4, s7, v4
    s_lshl_b32 s7, s3, 11
    s_add_u32 s7, s7, 0x10000
    v_lshl_add_u32 v5, v1, 5, s7
    v_perm_b32 v40, v12, v8, s92
    v_perm_b32 v41, v20, v16, s92
    v_perm_b32 v42, v28, v24, s92
    v_perm_b32 v43, v36, v32, s92
    v_perm_b32 v44, v12, v8, s93
    v_perm_b32 v45, v20, v16, s93
    v_perm_b32 v46, v28, v24, s93
    v_perm_b32 v47, v36, v32, s93
    v_perm_b32 v48, v13, v9, s92
    v_perm_b32 v49, v21, v17, s92
    v_perm_b32 v50, v29, v25, s92
    v_perm_b32 v51, v37, v33, s92
    v_perm_b32 v52, v13, v9, s93
    v_perm_b32 v53, v21, v17, s93
    v_perm_b32 v54, v29, v25, s93
    v_perm_b32 v55, v37, v33, s93
    v_perm_b32 v56, v14, v10, s92
    v_perm_b32 v57, v22, v18, s92
    v_perm_b32 v58, v30, v26, s92
    v_perm_b32 v59, v38, v34, s92
    v_perm_b32 v60, v14, v10, s93
    v_perm_b32 v61, v22, v18, s93
    v_perm_b32 v62, v30, v26, s93
    v_perm_b32 v63, v38, v34, s93
    v_perm_b32 v64, v15, v11, s92
    v_perm_b32 v65, v23, v19, s92
    v_perm_b32 v66, v31, v27, s92
    v_perm_b32 v67, v39, v35, s92
    v_perm_b32 v68, v15, v11, s93
    v_perm_b32 v69, v23, v19, s93
    v_perm_b32 v70, v31, v27, s93
    v_perm_b32 v71, v39, v35, s93
    s_waitcnt vmcnt(0)
    v_perm_b32 v72, v108, v104, s92
    v_perm_b32 v73, v116, v112, s92
    v_perm_b32 v74, v124, v120, s92
    v_perm_b32 v75, v132, v128, s92
    v_perm_b32 v76, v108, v104, s93
    v_perm_b32 v77, v116, v112, s93
    v_perm_b32 v78, v124, v120, s93
    v_perm_b32 v79, v132, v128, s93
    v_perm_b32 v80, v109, v105, s92
    v_perm_b32 v81, v117, v113, s92
    v_perm_b32 v82, v125, v121, s92
    v_perm_b32 v83, v133, v129, s92
    v_perm_b32 v84, v109, v105, s93
    v_perm_b32 v85, v117, v113, s93
    v_perm_b32 v86, v125, v121, s93
    v_perm_b32 v87, v133, v129, s93
    v_perm_b32 v88, v110, v106, s92
    v_perm_b32 v89, v118, v114, s92
    v_perm_b32 v90, v126, v122, s92
    v_perm_b32 v91, v134, v130, s92
    v_perm_b32 v92, v110, v106, s93
    v_perm_b32 v93, v118, v114, s93
    v_perm_b32 v94, v126, v122, s93
    v_perm_b32 v95, v134, v130, s93
    v_perm_b32 v96, v111, v107, s92
    v_perm_b32 v97, v119, v115, s92
    v_perm_b32 v98, v127, v123, s92
    v_perm_b32 v99, v135, v131, s92
    v_perm_b32 v100, v111, v107, s93
    v_perm_b32 v101, v119, v115, s93
    v_perm_b32 v102, v127, v123, s93
    v_perm_b32 v103, v135, v131, s93
    v_mov_b32 v160, 0x2404c
    s_mov_b32 s80, 1600000
LW_47:
    ds_read_b32 v161, v160
    s_waitcnt lgkmcnt(0)
    v_readfirstlane_b32 s79, v161
    s_cmp_ge_u32 s79, 1
    s_cbranch_scc1 LWD_48
    s_sleep 2
    s_sub_u32 s80, s80, 1
    s_cmp_lg_u32 s80, 0
    s_cbranch_scc1 LW_47
LWD_48:
    v_mov_b32 v160, 0x24050
    ds_read_b64 v[162:163], v160
    s_waitcnt lgkmcnt(0)
    v_readfirstlane_b32 s94, v162
    v_readfirstlane_b32 s95, v163
    v_mov_b32 v160, 0x2401c
    s_mov_b32 s80, 1600000
LW_49:
    ds_read_b32 v161, v160
    s_waitcnt lgkmcnt(0)
    v_readfirstlane_b32 s79, v161
    s_cmp_ge_u32 s79, 1
    s_cbranch_scc1 LWD_50
    s_sleep 4
    s_sub_u32 s80, s80, 1
    s_cmp_lg_u32 s80, 0
    s_cbranch_scc1 LW_49
LWD_50:
    s_setprio 3
    s_mov_b64 s[88:89], 0
    s_mov_b32 s80, 1600000
UM_51:
    ds_read_b128 v[136:139], v3
    s_waitcnt lgkmcnt(0)
    v_cmp_ne_u64 vcc, s[94:95], v[138:139]
    s_or_b64 s[90:91], vcc, s[88:89]
    s_and_b32 s7, s90, 0x5555
    s_cbranch_scc1 UMS_53
    s_mov_b32 s70, 0
    buffer_load_dwordx4 v[8:11], v4, s[36:39], s70 offen sc1
    s_or_b32 s88, s88, 0x5555
UMS_53:
    s_and_b32 s7, s90, 0x55550000
    s_cbranch_scc1 UMS_54
    s_mov_b32 s70, 32768
    buffer_load_dwordx4 v[12:15], v4, s[36:39], s70 offen sc1
    s_or_b32 s88, s88, 0x55550000
UMS_54:
    s_and_b32 s7, s91, 0x5555
    s_cbranch_scc1 UMS_55
    s_mov_b32 s70, 65536
    buffer_load_dwordx4 v[16:19], v4, s[36:39], s70 offen sc1
    s_or_b32 s89, s89, 0x5555
UMS_55:
    s_and_b32 s7, s91, 0x55550000
    s_cbranch_scc1 UMS_56
    s_mov_b32 s70, 98304
    buffer_load_dwordx4 v[20:23], v4, s[36:39], s70 offen sc1
    s_or_b32 s89, s89, 0x55550000
UMS_56:
    s_and_b32 s7, s90, 0xaaaa
    s_cbranch_scc1 UMS_57
    s_mov_b32 s70, 131072
    buffer_load_dwordx4 v[24:27], v4, s[36:39], s70 offen sc1
    s_or_b32 s88, s88, 0xaaaa
UMS_57:
    s_and_b32 s7, s90, 0xaaaa0000
    s_cbranch_scc1 UMS_58
    s_mov_b32 s70, 163840
    buffer_load_dwordx4 v[28:31], v4, s[36:39], s70 offen sc1
    s_or_b32 s88, s88, 0xaaaa0000
UMS_58:
    s_and_b32 s7, s91, 0xaaaa
    s_cbranch_scc1 UMS_59
    s_mov_b32 s70, 196608
    buffer_load_dwordx4 v[32:35], v4, s[36:39], s70 offen sc1
    s_or_b32 s89, s89, 0xaaaa
UMS_59:
    s_and_b32 s7, s91, 0xaaaa0000
    s_cbranch_scc1 UMS_60
    s_mov_b32 s70, 229376
    buffer_load_dwordx4 v[36:39], v4, s[36:39], s70 offen sc1
    s_or_b32 s89, s89, 0xaaaa0000
UMS_60:
    s_cbranch_vccz UMD_52
    s_sleep 1
    s_sub_u32 s80, s80, 1
    s_cmp_lg_u32 s80, 0
    s_cbranch_scc1 UM_51
UMD_52:
    v_max_f32_dpp v138, v136, v136 quad_perm:[1,0,3,2] row_mask:0xf bank_mask:0xf
    s_nop 1
    v_max_f32_dpp v138, v138, v138 quad_perm:[2,3,0,1] row_mask:0xf bank_mask:0xf
    v_mov_b32 v139, v138
    s_nop 1
    v_permlane32_swap_b32 v138, v139
    v_max_f32 v138, v138, v139
    v_mov_b32 v139, v138
    s_nop 1
    v_permlane16_swap_b32 v138, v139
    v_max_f32 v138, v138, v139
    v_sub_f32 v136, v136, v138
    v_exp_f32 v136, v136
    s_nop 0
    v_mul_f32 v137, v137, v136
    s_nop 1
    v_add_f32_dpp v137, v137, v137 quad_perm:[1,0,3,2] row_mask:0xf bank_mask:0xf
    s_nop 1
    v_add_f32_dpp v137, v137, v137 quad_perm:[2,3,0,1] row_mask:0xf bank_mask:0xf
    v_mov_b32 v138, v137
    s_nop 1
    v_permlane32_swap_b32 v137, v138
    v_add_f32 v137, v137, v138
    v_mov_b32 v138, v137
    s_nop 1
    v_permlane16_swap_b32 v137, v138
    v_add_f32 v137, v137, v138
    v_rcp_f32 v137, v137
    s_nop 0
    v_mul_f32 v136, v136, v137
    v_mov_b32 v137, v136
    s_nop 1
    v_permlane16_swap_b32 v136, v137
    v_mov_b32 v138, v136
    v_mov_b32 v139, v137
    s_nop 0
    v_permlane32_swap_b32 v136, v138
    v_permlane32_swap_b32 v137, v139
    s_nop 0
    v_mov_b32_dpp v148, v136 quad_perm:[0,0,2,2] row_mask:0xf bank_mask:0xf
    v_mov_b32_dpp v149, v137 quad_perm:[0,0,2,2] row_mask:0xf bank_mask:0xf
    v_mov_b32_dpp v150, v138 quad_perm:[0,0,2,2] row_mask:0xf bank_mask:0xf
    v_mov_b32_dpp v151, v139 quad_perm:[0,0,2,2] row_mask:0xf bank_mask:0xf
    v_mov_b32_dpp v152, v136 quad_perm:[1,1,3,3] row_mask:0xf bank_mask:0xf
    v_mov_b32_dpp v153, v137 quad_perm:[1,1,3,3] row_mask:0xf bank_mask:0xf
    v_mov_b32_dpp v154, v138 quad_perm:[1,1,3,3] row_mask:0xf bank_mask:0xf
    v_mov_b32_dpp v155, v139 quad_perm:[1,1,3,3] row_mask:0xf bank_mask:0xf
    s_waitcnt vmcnt(0)
    v_lshlrev_b32 v104, 16, v8
    v_and_b32 v105, 0xffff0000, v8
    v_lshlrev_b32 v106, 16, v9
    v_and_b32 v107, 0xffff0000, v9
    v_lshlrev_b32 v108, 16, v10
    v_and_b32 v109, 0xffff0000, v10
    v_lshlrev_b32 v110, 16, v11
    v_and_b32 v111, 0xffff0000, v11
    v_mul_f32 v120, v104, v148
    v_mul_f32 v121, v105, v148
    v_mul_f32 v122, v106, v148
    v_mul_f32 v123, v107, v148
    v_mul_f32 v124, v108, v148
    v_mul_f32 v125, v109, v148
    v_mul_f32 v126, v110, v148
    v_mul_f32 v127, v111, v148
    v_lshlrev_b32 v112, 16, v12
    v_and_b32 v113, 0xffff0000, v12
    v_lshlrev_b32 v114, 16, v13
    v_and_b32 v115, 0xffff0000, v13
    v_lshlrev_b32 v116, 16, v14
    v_and_b32 v117, 0xffff0000, v14
    v_lshlrev_b32 v118, 16, v15
    v_and_b32 v119, 0xffff0000, v15
    v_fmac_f32 v120, v112, v149
    v_fmac_f32 v121, v113, v149
    v_fmac_f32 v122, v114, v149
    v_fmac_f32 v123, v115, v149
    v_fmac_f32 v124, v116, v149
    v_fmac_f32 v125, v117, v149
    v_fmac_f32 v126, v118, v149
    v_fmac_f32 v127, v119, v149
    v_lshlrev_b32 v104, 16, v16
    v_and_b32 v105, 0xffff0000, v16
    v_lshlrev_b32 v106, 16, v17
    v_and_b32 v107, 0xffff0000, v17
    v_lshlrev_b32 v108, 16, v18
    v_and_b32 v109, 0xffff0000, v18
    v_lshlrev_b32 v110, 16, v19
    v_and_b32 v111, 0xffff0000, v19
    v_fmac_f32 v120, v104, v150
    v_fmac_f32 v121, v105, v150
    v_fmac_f32 v122, v106, v150
    v_fmac_f32 v123, v107, v150
    v_fmac_f32 v124, v108, v150
    v_fmac_f32 v125, v109, v150
    v_fmac_f32 v126, v110, v150
    v_fmac_f32 v127, v111, v150
    v_lshlrev_b32 v112, 16, v20
    v_and_b32 v113, 0xffff0000, v20
    v_lshlrev_b32 v114, 16, v21
    v_and_b32 v115, 0xffff0000, v21
    v_lshlrev_b32 v116, 16, v22
    v_and_b32 v117, 0xffff0000, v22
    v_lshlrev_b32 v118, 16, v23
    v_and_b32 v119, 0xffff0000, v23
    v_fmac_f32 v120, v112, v151
    v_fmac_f32 v121, v113, v151
    v_fmac_f32 v122, v114, v151
    v_fmac_f32 v123, v115, v151
    v_fmac_f32 v124, v116, v151
    v_fmac_f32 v125, v117, v151
    v_fmac_f32 v126, v118, v151
    v_fmac_f32 v127, v119, v151
    v_lshlrev_b32 v104, 16, v24
    v_and_b32 v105, 0xffff0000, v24
    v_lshlrev_b32 v106, 16, v25
    v_and_b32 v107, 0xffff0000, v25
    v_lshlrev_b32 v108, 16, v26
    v_and_b32 v109, 0xffff0000, v26
    v_lshlrev_b32 v110, 16, v27
    v_and_b32 v111, 0xffff0000, v27
    v_fmac_f32 v120, v104, v152
    v_fmac_f32 v121, v105, v152
    v_fmac_f32 v122, v106, v152
    v_fmac_f32 v123, v107, v152
    v_fmac_f32 v124, v108, v152
    v_fmac_f32 v125, v109, v152
    v_fmac_f32 v126, v110, v152
    v_fmac_f32 v127, v111, v152
    v_lshlrev_b32 v112, 16, v28
    v_and_b32 v113, 0xffff0000, v28
    v_lshlrev_b32 v114, 16, v29
    v_and_b32 v115, 0xffff0000, v29
    v_lshlrev_b32 v116, 16, v30
    v_and_b32 v117, 0xffff0000, v30
    v_lshlrev_b32 v118, 16, v31
    v_and_b32 v119, 0xffff0000, v31
    v_fmac_f32 v120, v112, v153
    v_fmac_f32 v121, v113, v153
    v_fmac_f32 v122, v114, v153
    v_fmac_f32 v123, v115, v153
    v_fmac_f32 v124, v116, v153
    v_fmac_f32 v125, v117, v153
    v_fmac_f32 v126, v118, v153
    v_fmac_f32 v127, v119, v153
    v_lshlrev_b32 v104, 16, v32
    v_and_b32 v105, 0xffff0000, v32
    v_lshlrev_b32 v106, 16, v33
    v_and_b32 v107, 0xffff0000, v33
    v_lshlrev_b32 v108, 16, v34
    v_and_b32 v109, 0xffff0000, v34
    v_lshlrev_b32 v110, 16, v35
    v_and_b32 v111, 0xffff0000, v35
    v_fmac_f32 v120, v104, v154
    v_fmac_f32 v121, v105, v154
    v_fmac_f32 v122, v106, v154
    v_fmac_f32 v123, v107, v154
    v_fmac_f32 v124, v108, v154
    v_fmac_f32 v125, v109, v154
    v_fmac_f32 v126, v110, v154
    v_fmac_f32 v127, v111, v154
    v_lshlrev_b32 v112, 16, v36
    v_and_b32 v113, 0xffff0000, v36
    v_lshlrev_b32 v114, 16, v37
    v_and_b32 v115, 0xffff0000, v37
    v_lshlrev_b32 v116, 16, v38
    v_and_b32 v117, 0xffff0000, v38
    v_lshlrev_b32 v118, 16, v39
    v_and_b32 v119, 0xffff0000, v39
    v_fmac_f32 v120, v112, v155
    v_fmac_f32 v121, v113, v155
    v_fmac_f32 v122, v114, v155
    v_fmac_f32 v123, v115, v155
    v_fmac_f32 v124, v116, v155
    v_fmac_f32 v125, v117, v155
    v_fmac_f32 v126, v118, v155
    v_fmac_f32 v127, v119, v155
    v_cvt_pk_bf16_f32 v128, v120, v121
    v_cvt_pk_bf16_f32 v129, v122, v123
    v_cvt_pk_bf16_f32 v130, v124, v125
    v_cvt_pk_bf16_f32 v131, v126, v127
    v_cndmask_b32 v140, v128, 0, s[86:87]
    v_cndmask_b32 v144, 0, v128, s[86:87]
    v_cndmask_b32 v141, v129, 0, s[86:87]
    v_cndmask_b32 v145, 0, v129, s[86:87]
    v_cndmask_b32 v142, v130, 0, s[86:87]
    v_cndmask_b32 v146, 0, v130, s[86:87]
    v_cndmask_b32 v143, v131, 0, s[86:87]
    v_cndmask_b32 v147, 0, v131, s[86:87]
    s_nop 0
    v_mfma_f32_16x16x32_bf16 v[8:11], v[140:143], v[40:43], 0
    v_mfma_f32_16x16x32_bf16 v[12:15], v[140:143], v[44:47], 0
    v_mfma_f32_16x16x32_bf16 v[16:19], v[140:143], v[48:51], 0
    v_mfma_f32_16x16x32_bf16 v[20:23], v[140:143], v[52:55], 0
    v_mfma_f32_16x16x32_bf16 v[24:27], v[140:143], v[56:59], 0
    v_mfma_f32_16x16x32_bf16 v[28:31], v[140:143], v[60:63], 0
    v_mfma_f32_16x16x32_bf16 v[32:35], v[140:143], v[64:67], 0
    v_mfma_f32_16x16x32_bf16 v[36:39], v[140:143], v[68:71], 0
    v_mfma_f32_16x16x32_bf16 v[8:11], v[144:147], v[72:75], v[8:11]
    v_mfma_f32_16x16x32_bf16 v[12:15], v[144:147], v[76:79], v[12:15]
    v_mfma_f32_16x16x32_bf16 v[16:19], v[144:147], v[80:83], v[16:19]
    v_mfma_f32_16x16x32_bf16 v[20:23], v[144:147], v[84:87], v[20:23]
    v_mfma_f32_16x16x32_bf16 v[24:27], v[144:147], v[88:91], v[24:27]
    v_mfma_f32_16x16x32_bf16 v[28:31], v[144:147], v[92:95], v[28:31]
    v_mfma_f32_16x16x32_bf16 v[32:35], v[144:147], v[96:99], v[32:35]
    v_mfma_f32_16x16x32_bf16 v[36:39], v[144:147], v[100:103], v[36:39]
    s_nop 0
    v_add_f32 v8, v8, v10
    v_add_f32 v9, v9, v11
    v_add_f32 v12, v12, v14
    v_add_f32 v13, v13, v15
    v_add_f32 v16, v16, v18
    v_add_f32 v17, v17, v19
    v_add_f32 v20, v20, v22
    v_add_f32 v21, v21, v23
    v_add_f32 v24, v24, v26
    v_add_f32 v25, v25, v27
    v_add_f32 v28, v28, v30
    v_add_f32 v29, v29, v31
    v_add_f32 v32, v32, v34
    v_add_f32 v33, v33, v35
    v_add_f32 v36, v36, v38
    v_add_f32 v37, v37, v39
    v_add_f32 v104, v8, v9
    v_add_f32 v105, v12, v13
    v_add_f32 v106, v16, v17
    v_add_f32 v107, v20, v21
    v_add_f32 v108, v24, v25
    v_add_f32 v109, v28, v29
    v_add_f32 v110, v32, v33
    v_add_f32 v111, v36, v37
    ds_write_b128 v5, v[104:107]
    ds_write_b128 v5, v[108:111] offset:16
    v_and_b32 v160, 31, v1
    s_lshl_b32 s7, s3, 8
    s_add_u32 s7, s7, 0x10000
    v_lshl_add_u32 v5, v160, 3, s7
    s_lshl_b32 s7, s3, 7
    s_add_u32 s7, s7, 0x24400
    v_lshl_add_u32 v4, v160, 2, s7
    s_waitcnt lgkmcnt(0)
    s_barrier
    ds_read_b64 v[8:9], v5 offset:0
    ds_read_b64 v[10:11], v5 offset:2048
    ds_read_b64 v[12:13], v5 offset:4096
    ds_read_b64 v[14:15], v5 offset:6144
    ds_read_b64 v[16:17], v5 offset:8192
    ds_read_b64 v[18:19], v5 offset:10240
    ds_read_b64 v[20:21], v5 offset:12288
    ds_read_b64 v[22:23], v5 offset:14336
    s_waitcnt lgkmcnt(0)
    v_add_f32 v8, v8, v16
    v_add_f32 v9, v9, v17
    v_add_f32 v10, v10, v18
    v_add_f32 v11, v11, v19
    v_add_f32 v12, v12, v20
    v_add_f32 v13, v13, v21
    v_add_f32 v14, v14, v22
    v_add_f32 v15, v15, v23
    v_add_f32 v8, v8, v12
    v_add_f32 v9, v9, v13
    v_add_f32 v10, v10, v14
    v_add_f32 v11, v11, v15
    v_add_f32 v8, v8, v10
    v_add_f32 v9, v9, v11
    v_cvt_pk_bf16_f32 v8, v8, v9
    ds_write_b32 v4, v8
    s_waitcnt lgkmcnt(0)
    s_barrier
    s_endpgm
.p2align 12
LT_W2R:
    s_branch LR_W2R
L_W2R:
    s_cmp_lt_u32 s5, 4
    s_cselect_b32 s72, s28, s16
    s_cselect_b32 s73, s29, s17
    s_mov_b32 s56, s72
    s_and_b32 s57, s73, 0xffff
    s_mov_b32 s58, 0x400000
    s_mov_b32 s59, 0x20000
    v_lshrrev_b32 v4, 4, v1
    v_lshlrev_b32 v2, 13, v4
    v_and_b32 v4, 15, v1
    v_lshl_add_u32 v2, v4, 4, v2
    s_lshl_b32 s7, s6, 17
    s_lshl_b32 s70, s62, 8
    s_add_u32 s7, s7, s70
    v_add_u32 v2, s7, v2
    v_lshrrev_b32 v3, 4, v1
    v_lshlrev_b32 v3, 16, v3
    v_bfe_u32 v4, v1, 3, 1
    v_lshl_add_u32 v3, v4, 13, v3
    v_and_b32 v4, 7, v1
    v_lshl_add_u32 v3, v4, 4, v3
    s_cmp_lt_u32 s5, 4
    s_cselect_b32 s7, 0x800, 0x0
    s_add_u32 s7, s7, s6
    s_lshl_b32 s7, s7, 7
    s_add_u32 s7, s7, 0x100000
    v_add_u32 v3, s7, v3
    s_lshl_b32 s7, s62, 14
    v_add_u32 v3, s7, v3
    s_waitcnt vmcnt(0)
    v_mov_b32 v4, 0x24014
    v_mov_b32 v5, 1
    s_waitcnt lgkmcnt(0)
    s_mov_b64 exec, 1
    ds_add_u32 v4, v5
    s_mov_b64 exec, -1
    s_mov_b32 s70, 0
    v_mov_b32 v4, 0x24048
    s_mov_b32 s80, 1600000
LW_65:
    ds_read_b32 v5, v4
    s_waitcnt lgkmcnt(0)
    v_readfirstlane_b32 s79, v5
    s_cmp_ge_u32 s79, 4
    s_cbranch_scc1 LWD_66
    s_sleep 4
    s_sub_u32 s80, s80, 1
    s_cmp_lg_u32 s80, 0
    s_cbranch_scc1 LW_65
LWD_66:
    s_cmp_lt_u32 s5, 4
    s_cbranch_scc1 S2U_63
    buffer_load_dwordx4 v[40:43], v2, s[56:59], s70 offen offset:0 nt
    buffer_load_dwordx4 v[44:47], v2, s[56:59], s70 offen offset:1024 nt
    buffer_load_dwordx4 v[48:51], v2, s[56:59], s70 offen offset:2048 nt
    buffer_load_dwordx4 v[52:55], v2, s[56:59], s70 offen offset:3072 nt
    s_add_u32 s70, s70, 4096
    s_waitcnt vmcnt(0)
    buffer_load_dwordx4 v[56:59], v2, s[56:59], s70 offen offset:0 nt
    buffer_load_dwordx4 v[60:63], v2, s[56:59], s70 offen offset:1024 nt
    buffer_load_dwordx4 v[64:67], v2, s[56:59], s70 offen offset:2048 nt
    buffer_load_dwordx4 v[68:71], v2, s[56:59], s70 offen offset:3072 nt
    s_add_u32 s70, s70, 28672
    s_waitcnt vmcnt(0)
    buffer_load_dwordx4 v[72:75], v2, s[56:59], s70 offen offset:0 nt
    buffer_load_dwordx4 v[76:79], v2, s[56:59], s70 offen offset:1024 nt
    buffer_load_dwordx4 v[80:83], v2, s[56:59], s70 offen offset:2048 nt
    buffer_load_dwordx4 v[84:87], v2, s[56:59], s70 offen offset:3072 nt
    s_add_u32 s70, s70, 4096
    s_waitcnt vmcnt(0)
    buffer_load_dwordx4 v[88:91], v2, s[56:59], s70 offen offset:0 nt
    buffer_load_dwordx4 v[92:95], v2, s[56:59], s70 offen offset:1024 nt
    buffer_load_dwordx4 v[96:99], v2, s[56:59], s70 offen offset:2048 nt
    buffer_load_dwordx4 v[100:103], v2, s[56:59], s70 offen offset:3072 nt
    s_add_u32 s70, s70, 28672
    s_waitcnt vmcnt(0)
    buffer_load_dwordx4 v[104:107], v2, s[56:59], s70 offen offset:0 nt
    buffer_load_dwordx4 v[108:111], v2, s[56:59], s70 offen offset:1024 nt
    buffer_load_dwordx4 v[112:115], v2, s[56:59], s70 offen offset:2048 nt
    buffer_load_dwordx4 v[116:119], v2, s[56:59], s70 offen offset:3072 nt
    s_add_u32 s70, s70, 4096
    s_waitcnt vmcnt(0)
    buffer_load_dwordx4 v[120:123], v2, s[56:59], s70 offen offset:0 nt
    buffer_load_dwordx4 v[124:127], v2, s[56:59], s70 offen offset:1024 nt
    buffer_load_dwordx4 v[128:131], v2, s[56:59], s70 offen offset:2048 nt
    buffer_load_dwordx4 v[132:135], v2, s[56:59], s70 offen offset:3072 nt
    s_add_u32 s70, s70, 28672
    s_waitcnt vmcnt(0)
    buffer_load_dwordx4 v[136:139], v2, s[56:59], s70 offen offset:0 nt
    buffer_load_dwordx4 v[140:143], v2, s[56:59], s70 offen offset:1024 nt
    buffer_load_dwordx4 v[144:147], v2, s[56:59], s70 offen offset:2048 nt
    buffer_load_dwordx4 v[148:151], v2, s[56:59], s70 offen offset:3072 nt
    s_add_u32 s70, s70, 4096
    s_waitcnt vmcnt(0)
    buffer_load_dwordx4 v[152:155], v2, s[56:59], s70 offen offset:0 nt
    buffer_load_dwordx4 v[156:159], v2, s[56:59], s70 offen offset:1024 nt
    buffer_load_dwordx4 v[160:163], v2, s[56:59], s70 offen offset:2048 nt
    buffer_load_dwordx4 v[164:167], v2, s[56:59], s70 offen offset:3072 nt
    s_add_u32 s70, s70, 28672
    s_waitcnt vmcnt(0)
    s_branch S2J_64
S2U_63:
    buffer_load_dwordx4 v[40:43], v2, s[56:59], s70 offen offset:0 nt
    buffer_load_dwordx4 v[44:47], v2, s[56:59], s70 offen offset:1024 nt
    buffer_load_dwordx4 v[48:51], v2, s[56:59], s70 offen offset:2048 nt
    buffer_load_dwordx4 v[52:55], v2, s[56:59], s70 offen offset:3072 nt
    s_add_u32 s70, s70, 4096
    s_waitcnt vmcnt(2)
    buffer_load_dwordx4 v[56:59], v2, s[56:59], s70 offen offset:0 nt
    buffer_load_dwordx4 v[60:63], v2, s[56:59], s70 offen offset:1024 nt
    buffer_load_dwordx4 v[64:67], v2, s[56:59], s70 offen offset:2048 nt
    buffer_load_dwordx4 v[68:71], v2, s[56:59], s70 offen offset:3072 nt
    s_add_u32 s70, s70, 28672
    s_waitcnt vmcnt(2)
    buffer_load_dwordx4 v[72:75], v2, s[56:59], s70 offen offset:0 nt
    buffer_load_dwordx4 v[76:79], v2, s[56:59], s70 offen offset:1024 nt
    buffer_load_dwordx4 v[80:83], v2, s[56:59], s70 offen offset:2048 nt
    buffer_load_dwordx4 v[84:87], v2, s[56:59], s70 offen offset:3072 nt
    s_add_u32 s70, s70, 4096
    s_waitcnt vmcnt(2)
    buffer_load_dwordx4 v[88:91], v2, s[56:59], s70 offen offset:0 nt
    buffer_load_dwordx4 v[92:95], v2, s[56:59], s70 offen offset:1024 nt
    buffer_load_dwordx4 v[96:99], v2, s[56:59], s70 offen offset:2048 nt
    buffer_load_dwordx4 v[100:103], v2, s[56:59], s70 offen offset:3072 nt
    s_add_u32 s70, s70, 28672
    s_waitcnt vmcnt(2)
    buffer_load_dwordx4 v[104:107], v2, s[56:59], s70 offen offset:0 nt
    buffer_load_dwordx4 v[108:111], v2, s[56:59], s70 offen offset:1024 nt
    buffer_load_dwordx4 v[112:115], v2, s[56:59], s70 offen offset:2048 nt
    buffer_load_dwordx4 v[116:119], v2, s[56:59], s70 offen offset:3072 nt
    s_add_u32 s70, s70, 4096
    s_waitcnt vmcnt(2)
    buffer_load_dwordx4 v[120:123], v2, s[56:59], s70 offen offset:0 nt
    buffer_load_dwordx4 v[124:127], v2, s[56:59], s70 offen offset:1024 nt
    buffer_load_dwordx4 v[128:131], v2, s[56:59], s70 offen offset:2048 nt
    buffer_load_dwordx4 v[132:135], v2, s[56:59], s70 offen offset:3072 nt
    s_add_u32 s70, s70, 28672
    s_waitcnt vmcnt(2)
    buffer_load_dwordx4 v[136:139], v2, s[56:59], s70 offen offset:0 nt
    buffer_load_dwordx4 v[140:143], v2, s[56:59], s70 offen offset:1024 nt
    buffer_load_dwordx4 v[144:147], v2, s[56:59], s70 offen offset:2048 nt
    buffer_load_dwordx4 v[148:151], v2, s[56:59], s70 offen offset:3072 nt
    s_add_u32 s70, s70, 4096
    s_waitcnt vmcnt(2)
    buffer_load_dwordx4 v[152:155], v2, s[56:59], s70 offen offset:0 nt
    buffer_load_dwordx4 v[156:159], v2, s[56:59], s70 offen offset:1024 nt
    buffer_load_dwordx4 v[160:163], v2, s[56:59], s70 offen offset:2048 nt
    buffer_load_dwordx4 v[164:167], v2, s[56:59], s70 offen offset:3072 nt
    s_add_u32 s70, s70, 28672
    s_waitcnt vmcnt(0)
S2J_64:
    v_perm_b32 v8, v44, v40, s92
    v_perm_b32 v9, v52, v48, s92
    v_perm_b32 v10, v60, v56, s92
    v_perm_b32 v11, v68, v64, s92
    v_perm_b32 v12, v44, v40, s93
    v_perm_b32 v13, v52, v48, s93
    v_perm_b32 v14, v60, v56, s93
    v_perm_b32 v15, v68, v64, s93
    v_perm_b32 v16, v45, v41, s92
    v_perm_b32 v17, v53, v49, s92
    v_perm_b32 v18, v61, v57, s92
    v_perm_b32 v19, v69, v65, s92
    v_perm_b32 v20, v45, v41, s93
    v_perm_b32 v21, v53, v49, s93
    v_perm_b32 v22, v61, v57, s93
    v_perm_b32 v23, v69, v65, s93
    v_perm_b32 v24, v46, v42, s92
    v_perm_b32 v25, v54, v50, s92
    v_perm_b32 v26, v62, v58, s92
    v_perm_b32 v27, v70, v66, s92
    v_perm_b32 v28, v46, v42, s93
    v_perm_b32 v29, v54, v50, s93
    v_perm_b32 v30, v62, v58, s93
    v_perm_b32 v31, v70, v66, s93
    v_perm_b32 v32, v47, v43, s92
    v_perm_b32 v33, v55, v51, s92
    v_perm_b32 v34, v63, v59, s92
    v_perm_b32 v35, v71, v67, s92
    v_perm_b32 v36, v47, v43, s93
    v_perm_b32 v37, v55, v51, s93
    v_perm_b32 v38, v63, v59, s93
    v_perm_b32 v39, v71, v67, s93
    v_perm_b32 v40, v76, v72, s92
    v_perm_b32 v41, v84, v80, s92
    v_perm_b32 v42, v92, v88, s92
    v_perm_b32 v43, v100, v96, s92
    v_perm_b32 v44, v76, v72, s93
    v_perm_b32 v45, v84, v80, s93
    v_perm_b32 v46, v92, v88, s93
    v_perm_b32 v47, v100, v96, s93
    v_perm_b32 v48, v77, v73, s92
    v_perm_b32 v49, v85, v81, s92
    v_perm_b32 v50, v93, v89, s92
    v_perm_b32 v51, v101, v97, s92
    v_perm_b32 v52, v77, v73, s93
    v_perm_b32 v53, v85, v81, s93
    v_perm_b32 v54, v93, v89, s93
    v_perm_b32 v55, v101, v97, s93
    v_perm_b32 v56, v78, v74, s92
    v_perm_b32 v57, v86, v82, s92
    v_perm_b32 v58, v94, v90, s92
    v_perm_b32 v59, v102, v98, s92
    v_perm_b32 v60, v78, v74, s93
    v_perm_b32 v61, v86, v82, s93
    v_perm_b32 v62, v94, v90, s93
    v_perm_b32 v63, v102, v98, s93
    v_perm_b32 v64, v79, v75, s92
    v_perm_b32 v65, v87, v83, s92
    v_perm_b32 v66, v95, v91, s92
    v_perm_b32 v67, v103, v99, s92
    v_perm_b32 v68, v79, v75, s93
    v_perm_b32 v69, v87, v83, s93
    v_perm_b32 v70, v95, v91, s93
    v_perm_b32 v71, v103, v99, s93
    v_perm_b32 v72, v108, v104, s92
    v_perm_b32 v73, v116, v112, s92
    v_perm_b32 v74, v124, v120, s92
    v_perm_b32 v75, v132, v128, s92
    v_perm_b32 v76, v108, v104, s93
    v_perm_b32 v77, v116, v112, s93
    v_perm_b32 v78, v124, v120, s93
    v_perm_b32 v79, v132, v128, s93
    v_perm_b32 v80, v109, v105, s92
    v_perm_b32 v81, v117, v113, s92
    v_perm_b32 v82, v125, v121, s92
    v_perm_b32 v83, v133, v129, s92
    v_perm_b32 v84, v109, v105, s93
    v_perm_b32 v85, v117, v113, s93
    v_perm_b32 v86, v125, v121, s93
    v_perm_b32 v87, v133, v129, s93
    v_perm_b32 v88, v110, v106, s92
    v_perm_b32 v89, v118, v114, s92
    v_perm_b32 v90, v126, v122, s92
    v_perm_b32 v91, v134, v130, s92
    v_perm_b32 v92, v110, v106, s93
    v_perm_b32 v93, v118, v114, s93
    v_perm_b32 v94, v126, v122, s93
    v_perm_b32 v95, v134, v130, s93
    v_perm_b32 v96, v111, v107, s92
    v_perm_b32 v97, v119, v115, s92
    v_perm_b32 v98, v127, v123, s92
    v_perm_b32 v99, v135, v131, s92
    v_perm_b32 v100, v111, v107, s93
    v_perm_b32 v101, v119, v115, s93
    v_perm_b32 v102, v127, v123, s93
    v_perm_b32 v103, v135, v131, s93
    v_perm_b32 v104, v140, v136, s92
    v_perm_b32 v105, v148, v144, s92
    v_perm_b32 v106, v156, v152, s92
    v_perm_b32 v107, v164, v160, s92
    v_perm_b32 v108, v140, v136, s93
    v_perm_b32 v109, v148, v144, s93
    v_perm_b32 v110, v156, v152, s93
    v_perm_b32 v111, v164, v160, s93
    v_perm_b32 v112, v141, v137, s92
    v_perm_b32 v113, v149, v145, s92
    v_perm_b32 v114, v157, v153, s92
    v_perm_b32 v115, v165, v161, s92
    v_perm_b32 v116, v141, v137, s93
    v_perm_b32 v117, v149, v145, s93
    v_perm_b32 v118, v157, v153, s93
    v_perm_b32 v119, v165, v161, s93
    v_perm_b32 v120, v142, v138, s92
    v_perm_b32 v121, v150, v146, s92
    v_perm_b32 v122, v158, v154, s92
    v_perm_b32 v123, v166, v162, s92
    v_perm_b32 v124, v142, v138, s93
    v_perm_b32 v125, v150, v146, s93
    v_perm_b32 v126, v158, v154, s93
    v_perm_b32 v127, v166, v162, s93
    v_perm_b32 v128, v143, v139, s92
    v_perm_b32 v129, v151, v147, s92
    v_perm_b32 v130, v159, v155, s92
    v_perm_b32 v131, v167, v163, s92
    v_perm_b32 v132, v143, v139, s93
    v_perm_b32 v133, v151, v147, s93
    v_perm_b32 v134, v159, v155, s93
    v_perm_b32 v135, v167, v163, s93
    v_mov_b32 v160, 0x2404c
    s_mov_b32 s80, 1600000
LW_67:
    ds_read_b32 v161, v160
    s_waitcnt lgkmcnt(0)
    v_readfirstlane_b32 s79, v161
    s_cmp_ge_u32 s79, 1
    s_cbranch_scc1 LWD_68
    s_sleep 2
    s_sub_u32 s80, s80, 1
    s_cmp_lg_u32 s80, 0
    s_cbranch_scc1 LW_67
LWD_68:
    v_mov_b32 v160, 0x24050
    ds_read_b64 v[162:163], v160
    s_waitcnt lgkmcnt(0)
    v_readfirstlane_b32 s94, v162
    v_readfirstlane_b32 s95, v163
    v_bfe_u32 v4, v1, 2, 2
    v_lshlrev_b32 v4, 8, v4
    v_lshrrev_b32 v160, 4, v1
    v_lshl_add_u32 v4, v160, 4, v4
    s_mov_b32 s70, 4096
    s_cmp_ge_u32 s5, 4
    s_cbranch_scc1 S2X_69
    v_add_u32 v4, 0x24400, v4
    s_cmp_lg_u32 s3, 8
    s_cbranch_scc1 U8_71
    v_and_b32 v5, 15, v1
    v_lshl_add_u32 v5, v5, 2, v160
    s_lshl_b32 s7, s6, 4
    s_add_u32 s7, s7, 0xe0000
    v_lshl_add_u32 v5, v5, 9, s7
    v_lshlrev_b32 v6, 4, v1
    v_add_u32 v6, 0x24800, v6
    s_mov_b32 s80, 200000
PO_72:
    buffer_load_dwordx4 v[136:139], v5, s[36:39], 0 offen sc1
PO2_73:
    s_waitcnt vmcnt(0)
    v_cmp_ne_u64 vcc, s[94:95], v[138:139]
    s_cmp_lg_u64 vcc, -1
    s_cbranch_scc1 POD_74
    s_sleep 16
    s_sub_u32 s80, s80, 1
    s_cmp_lg_u32 s80, 0
    s_cbranch_scc1 PO_72
POD_74:
    s_setprio 3
    ds_write_b128 v6, v[136:139]
    v_mov_b32 v160, 0x2401c
    v_mov_b32 v161, 1
    s_waitcnt lgkmcnt(0)
    s_mov_b64 exec, 1
    ds_add_u32 v160, v161
    s_mov_b64 exec, -1
    s_cbranch_vccz U8D_76
    buffer_load_dwordx4 v[136:139], v5, s[36:39], 0 offen sc1
    s_sleep 4
    buffer_load_dwordx4 v[140:143], v5, s[36:39], 0 offen sc1
    s_sleep 4
    s_mov_b32 s80, 200000
U8P_75:
    s_waitcnt vmcnt(1)
    ds_write_b128 v6, v[136:139]
    v_cmp_ne_u64 vcc, s[94:95], v[138:139]
    s_cbranch_vccz U8D_76
    s_waitcnt lgkmcnt(0)
    buffer_load_dwordx4 v[136:139], v5, s[36:39], 0 offen sc1
    s_waitcnt vmcnt(1)
    ds_write_b128 v6, v[140:143]
    v_cmp_ne_u64 vcc, s[94:95], v[142:143]
    s_cbranch_vccz U8D_76
    s_waitcnt lgkmcnt(0)
    buffer_load_dwordx4 v[140:143], v5, s[36:39], 0 offen sc1
    s_sub_u32 s80, s80, 1
    s_cmp_lg_u32 s80, 0
    s_cbranch_scc1 U8P_75
U8D_76:
    s_waitcnt vmcnt(0)
U8_71:
    s_setprio 3
    s_barrier
    s_barrier
    ds_read_b128 v[136:139], v4 offset:0
    ds_read_b128 v[140:143], v4 offset:64
    ds_read_b128 v[144:147], v4 offset:128
    ds_read_b128 v[148:151], v4 offset:192
    s_waitcnt lgkmcnt(0)
    s_branch S2M_70
S2X_69:
    v_and_b32 v160, 3, v1
    v_lshl_add_u32 v4, v160, 6, v4
    s_lshl_b32 s7, s6, 11
    s_add_u32 s7, s7, 0xd0000
    v_add_u32 v4, s7, v4
    s_mov_b32 s80, 200000
PO_77:
    buffer_load_dwordx4 v[152:155], v4, s[36:39], 0 offen offset:0 sc1
PO2_78:
    s_waitcnt vmcnt(0)
    v_cmp_ne_u64 vcc, s[94:95], v[154:155]
    s_cmp_lg_u64 vcc, -1
    s_cbranch_scc1 POD_79
    s_sleep 2
    s_sub_u32 s80, s80, 1
    s_cmp_lg_u32 s80, 0
    s_cbranch_scc1 PO_77
POD_79:
    s_setprio 3
    buffer_load_dwordx4 v[152:155], v4, s[36:39], 0 offen offset:0 sc1
    buffer_load_dwordx4 v[156:159], v4, s[36:39], 0 offen offset:1024 sc1
    s_sleep 4
    buffer_load_dwordx4 v[160:163], v4, s[36:39], 0 offen offset:0 sc1
    buffer_load_dwordx4 v[164:167], v4, s[36:39], 0 offen offset:1024 sc1
    s_sleep 4
    s_mov_b32 s80, 200000
PP_80:
    s_waitcnt vmcnt(2)
    v_cmp_ne_u64 vcc, s[94:95], v[154:155]
    v_cmp_ne_u64 s[84:85], s[94:95], v[158:159]
    s_or_b64 vcc, vcc, s[84:85]
    s_cmp_eq_u64 vcc, 0
    s_cbranch_scc1 PPO_82
    buffer_load_dwordx4 v[152:155], v4, s[36:39], 0 offen offset:0 sc1
    buffer_load_dwordx4 v[156:159], v4, s[36:39], 0 offen offset:1024 sc1
    s_waitcnt vmcnt(2)
    v_cmp_ne_u64 vcc, s[94:95], v[162:163]
    v_cmp_ne_u64 s[84:85], s[94:95], v[166:167]
    s_or_b64 vcc, vcc, s[84:85]
    s_cmp_eq_u64 vcc, 0
    s_cbranch_scc1 PPO_83
    buffer_load_dwordx4 v[160:163], v4, s[36:39], 0 offen offset:0 sc1
    buffer_load_dwordx4 v[164:167], v4, s[36:39], 0 offen offset:1024 sc1
    s_sub_u32 s80, s80, 1
    s_cmp_lg_u32 s80, 0
    s_cbranch_scc1 PP_80
PPO_82:
    v_mov_b32_dpp v136, v152 quad_perm:[0,0,0,0] row_mask:0xf bank_mask:0xf
    v_mov_b32_dpp v137, v153 quad_perm:[0,0,0,0] row_mask:0xf bank_mask:0xf
    v_mov_b32_dpp v138, v156 quad_perm:[0,0,0,0] row_mask:0xf bank_mask:0xf
    v_mov_b32_dpp v139, v157 quad_perm:[0,0,0,0] row_mask:0xf bank_mask:0xf
    v_mov_b32_dpp v140, v152 quad_perm:[1,1,1,1] row_mask:0xf bank_mask:0xf
    v_mov_b32_dpp v141, v153 quad_perm:[1,1,1,1] row_mask:0xf bank_mask:0xf
    v_mov_b32_dpp v142, v156 quad_perm:[1,1,1,1] row_mask:0xf bank_mask:0xf
    v_mov_b32_dpp v143, v157 quad_perm:[1,1,1,1] row_mask:0xf bank_mask:0xf
    v_mov_b32_dpp v144, v152 quad_perm:[2,2,2,2] row_mask:0xf bank_mask:0xf
    v_mov_b32_dpp v145, v153 quad_perm:[2,2,2,2] row_mask:0xf bank_mask:0xf
    v_mov_b32_dpp v146, v156 quad_perm:[2,2,2,2] row_mask:0xf bank_mask:0xf
    v_mov_b32_dpp v147, v157 quad_perm:[2,2,2,2] row_mask:0xf bank_mask:0xf
    v_mov_b32_dpp v148, v152 quad_perm:[3,3,3,3] row_mask:0xf bank_mask:0xf
    v_mov_b32_dpp v149, v153 quad_perm:[3,3,3,3] row_mask:0xf bank_mask:0xf
    v_mov_b32_dpp v150, v156 quad_perm:[3,3,3,3] row_mask:0xf bank_mask:0xf
    v_mov_b32_dpp v151, v157 quad_perm:[3,3,3,3] row_mask:0xf bank_mask:0xf
    s_branch PPD_81
PPO_83:
    v_mov_b32_dpp v136, v160 quad_perm:[0,0,0,0] row_mask:0xf bank_mask:0xf
    v_mov_b32_dpp v137, v161 quad_perm:[0,0,0,0] row_mask:0xf bank_mask:0xf
    v_mov_b32_dpp v138, v164 quad_perm:[0,0,0,0] row_mask:0xf bank_mask:0xf
    v_mov_b32_dpp v139, v165 quad_perm:[0,0,0,0] row_mask:0xf bank_mask:0xf
    v_mov_b32_dpp v140, v160 quad_perm:[1,1,1,1] row_mask:0xf bank_mask:0xf
    v_mov_b32_dpp v141, v161 quad_perm:[1,1,1,1] row_mask:0xf bank_mask:0xf
    v_mov_b32_dpp v142, v164 quad_perm:[1,1,1,1] row_mask:0xf bank_mask:0xf
    v_mov_b32_dpp v143, v165 quad_perm:[1,1,1,1] row_mask:0xf bank_mask:0xf
    v_mov_b32_dpp v144, v160 quad_perm:[2,2,2,2] row_mask:0xf bank_mask:0xf
    v_mov_b32_dpp v145, v161 quad_perm:[2,2,2,2] row_mask:0xf bank_mask:0xf
    v_mov_b32_dpp v146, v164 quad_perm:[2,2,2,2] row_mask:0xf bank_mask:0xf
    v_mov_b32_dpp v147, v165 quad_perm:[2,2,2,2] row_mask:0xf bank_mask:0xf
    v_mov_b32_dpp v148, v160 quad_perm:[3,3,3,3] row_mask:0xf bank_mask:0xf
    v_mov_b32_dpp v149, v161 quad_perm:[3,3,3,3] row_mask:0xf bank_mask:0xf
    v_mov_b32_dpp v150, v164 quad_perm:[3,3,3,3] row_mask:0xf bank_mask:0xf
    v_mov_b32_dpp v151, v165 quad_perm:[3,3,3,3] row_mask:0xf bank_mask:0xf
PPD_81:
S2M_70:
    s_nop 1
    v_mfma_f32_16x16x32_bf16 v[4:7], v[136:139], v[8:11], 0
    v_mfma_f32_16x16x32_bf16 v[4:7], v[140:143], v[40:43], v[4:7]
    v_mfma_f32_16x16x32_bf16 v[4:7], v[144:147], v[72:75], v[4:7]
    v_mfma_f32_16x16x32_bf16 v[4:7], v[148:151], v[104:107], v[4:7]
    v_mfma_f32_16x16x32_bf16 v[8:11], v[136:139], v[12:15], 0
    v_mfma_f32_16x16x32_bf16 v[8:11], v[140:143], v[44:47], v[8:11]
    v_mfma_f32_16x16x32_bf16 v[8:11], v[144:147], v[76:79], v[8:11]
    v_mfma_f32_16x16x32_bf16 v[8:11], v[148:151], v[108:111], v[8:11]
    v_mfma_f32_16x16x32_bf16 v[12:15], v[136:139], v[16:19], 0
    v_mfma_f32_16x16x32_bf16 v[12:15], v[140:143], v[48:51], v[12:15]
    v_mfma_f32_16x16x32_bf16 v[12:15], v[144:147], v[80:83], v[12:15]
    v_mfma_f32_16x16x32_bf16 v[12:15], v[148:151], v[112:115], v[12:15]
    v_mfma_f32_16x16x32_bf16 v[16:19], v[136:139], v[20:23], 0
    v_mfma_f32_16x16x32_bf16 v[16:19], v[140:143], v[52:55], v[16:19]
    v_mfma_f32_16x16x32_bf16 v[16:19], v[144:147], v[84:87], v[16:19]
    v_mfma_f32_16x16x32_bf16 v[16:19], v[148:151], v[116:119], v[16:19]
    v_mfma_f32_16x16x32_bf16 v[20:23], v[136:139], v[24:27], 0
    v_mfma_f32_16x16x32_bf16 v[20:23], v[140:143], v[56:59], v[20:23]
    v_mfma_f32_16x16x32_bf16 v[20:23], v[144:147], v[88:91], v[20:23]
    v_mfma_f32_16x16x32_bf16 v[20:23], v[148:151], v[120:123], v[20:23]
    v_mfma_f32_16x16x32_bf16 v[24:27], v[136:139], v[28:31], 0
    v_mfma_f32_16x16x32_bf16 v[24:27], v[140:143], v[60:63], v[24:27]
    v_mfma_f32_16x16x32_bf16 v[24:27], v[144:147], v[92:95], v[24:27]
    v_mfma_f32_16x16x32_bf16 v[24:27], v[148:151], v[124:127], v[24:27]
    v_mfma_f32_16x16x32_bf16 v[28:31], v[136:139], v[32:35], 0
    v_mfma_f32_16x16x32_bf16 v[28:31], v[140:143], v[64:67], v[28:31]
    v_mfma_f32_16x16x32_bf16 v[28:31], v[144:147], v[96:99], v[28:31]
    v_mfma_f32_16x16x32_bf16 v[28:31], v[148:151], v[128:131], v[28:31]
    v_mfma_f32_16x16x32_bf16 v[32:35], v[136:139], v[36:39], 0
    v_mfma_f32_16x16x32_bf16 v[32:35], v[140:143], v[68:71], v[32:35]
    v_mfma_f32_16x16x32_bf16 v[32:35], v[144:147], v[100:103], v[32:35]
    v_mfma_f32_16x16x32_bf16 v[32:35], v[148:151], v[132:135], v[32:35]
    v_mov_b32 v42, s94
    v_mov_b32 v43, s95
    v_cvt_pk_bf16_f32 v40, v4, v8
    v_cvt_pk_bf16_f32 v41, v12, v16
    buffer_store_dwordx4 v[40:43], v3, s[36:39], 0 offen sc1
    v_mov_b32 v46, s94
    v_mov_b32 v47, s95
    v_cvt_pk_bf16_f32 v44, v20, v24
    v_cvt_pk_bf16_f32 v45, v28, v32
    buffer_store_dwordx4 v[44:47], v3, s[36:39], s70 offen sc1
    s_endpgm
.p2align 12
LT_CR:
    s_branch LR_CR
L_CR:
    v_and_b32 v160, 15, v1
    v_lshlrev_b32 v4, 10, v160
    v_lshrrev_b32 v161, 4, v1
    v_lshl_add_u32 v4, v161, 8, v4
    v_lshl_add_u32 v3, v160, 4, v4
    s_lshl_b32 s7, s65, 14
    s_add_u32 s7, s7, 0x18000
    v_add_u32 v3, s7, v3
    v_and_b32 v162, 3, v1
    v_lshl_add_u32 v4, v162, 6, v4
    v_bfe_u32 v162, v1, 2, 2
    v_lshl_add_u32 v4, v162, 4, v4
    s_lshl_b32 s7, s64, 14
    v_add_u32 v4, s7, v4
    v_add_u32 v2, 0x10000, v4
    s_lshl_b32 s7, s65, 6
    s_add_u32 s7, s7, 0x27200
    v_lshl_add_u32 v5, v160, 2, s7
    s_lshl_b32 s7, s64, 10
    s_lshl_b32 s66, s65, 9
    s_add_u32 s7, s7, s66
    s_add_u32 s7, s7, 0x25200
    v_lshl_add_u32 v6, v160, 5, s7
    v_lshl_add_u32 v6, v161, 3, v6
    v_and_b32 v162, 31, v1
    v_lshlrev_b32 v7, 5, v162
    v_lshrrev_b32 v163, 5, v1
    v_lshl_add_u32 v7, v163, 4, v7
    v_add_u32 v7, 0x25200, v7
    v_lshlrev_b32 v8, 2, v162
    v_add_u32 v8, 0x27e00, v8
    v_bfe_u32 v162, v1, 2, 2
    v_lshl_add_u32 v164, v163, 3, v162
    v_lshlrev_b32 v164, 10, v164
    v_and_b32 v165, 1, v1
    v_lshl_add_u32 v164, v165, 3, v164
    s_lshl_b32 s7, s64, 8
    v_add_u32 v164, s7, v164
    v_bfe_u32 v165, v1, 4, 1
    v_lshlrev_b32 v165, 1, v165
    v_bfe_u32 v160, v1, 1, 1
    v_or_b32 v165, v165, v160
    s_lshl_b32 s7, s65, 3
    v_or_b32 v165, s7, v165
    v_lshlrev_b32 v162, 2, v162
    v_xor_b32 v165, v165, v162
    v_lshlrev_b32 v163, 1, v163
    v_xor_b32 v165, v165, v163
    v_xor_b32 v160, 0, v165
    v_lshl_add_u32 v9, v160, 4, v164
    v_xor_b32 v160, 4, v165
    v_lshl_add_u32 v10, v160, 4, v164
    v_xor_b32 v160, 1, v165
    v_lshl_add_u32 v11, v160, 4, v164
    v_add_u32 v11, 0x1000, v11
    v_xor_b32 v160, 5, v165
    v_lshl_add_u32 v12, v160, 4, v164
    v_add_u32 v12, 0x1000, v12
    v_mov_b32 v13, 0xff800000
    v_mov_b32 v14, 0
    v_cmp_gt_u32 s[86:87], 16, v1
    s_cmp_eq_u32 s64, 0
    s_cselect_b32 s88, 0xffff, 0
    s_mov_b32 s89, 0
    s_barrier
    v_xor_b32 v160, 0x0, v3
    ds_read_b128 v[32:35], v160
    v_xor_b32 v161, 0x10, v3
    ds_read_b128 v[36:39], v161
    v_xor_b32 v160, 0x20, v3
    ds_read_b128 v[40:43], v160
    v_xor_b32 v161, 0x30, v3
    ds_read_b128 v[44:47], v161
    v_xor_b32 v160, 0x40, v3
    ds_read_b128 v[48:51], v160
    v_xor_b32 v161, 0x50, v3
    ds_read_b128 v[52:55], v161
    v_xor_b32 v160, 0x60, v3
    ds_read_b128 v[56:59], v160
    v_xor_b32 v161, 0x70, v3
    ds_read_b128 v[60:63], v161
    v_xor_b32 v160, 0x80, v3
    ds_read_b128 v[64:67], v160
    v_xor_b32 v161, 0x90, v3
    ds_read_b128 v[68:71], v161
    v_xor_b32 v160, 0xa0, v3
    ds_read_b128 v[72:75], v160
    v_xor_b32 v161, 0xb0, v3
    ds_read_b128 v[76:79], v161
    v_xor_b32 v160, 0xc0, v3
    ds_read_b128 v[80:83], v160
    v_xor_b32 v161, 0xd0, v3
    ds_read_b128 v[84:87], v161
    v_xor_b32 v160, 0xe0, v3
    ds_read_b128 v[88:91], v160
    v_xor_b32 v161, 0xf0, v3
    ds_read_b128 v[92:95], v161
    s_lshl_b32 s7, s3, 10
    s_add_u32 s7, s7, 0x18000
    v_lshl_add_u32 v3, v1, 4, s7
    s_waitcnt lgkmcnt(0)
    s_barrier
    ds_write_b128 v3, v[128:131] offset:0
    ds_write_b128 v3, v[132:135] offset:8192
    ds_write_b128 v3, v[136:139] offset:16384
    ds_write_b128 v3, v[140:143] offset:24576
    v_xor_b32 v160, 0x0, v4
    ds_read_b128 v[24:27], v160
    v_xor_b32 v161, 0x10, v4
    ds_read_b128 v[28:31], v161
    v_xor_b32 v162, 0x20, v4
    ds_read_b128 v[164:167], v162
    v_xor_b32 v160, 0x30, v4
    ds_read_b128 v[144:147], v160
    v_xor_b32 v161, 0x40, v4
    ds_read_b128 v[148:151], v161
    v_xor_b32 v162, 0x50, v4
    ds_read_b128 v[152:155], v162
    v_xor_b32 v160, 0x60, v4
    ds_read_b128 v[156:159], v160
    s_waitcnt lgkmcnt(6)
    v_mfma_f32_16x16x32_bf16 v[16:19], v[24:27], v[32:35], 0
    v_xor_b32 v161, 0x70, v4
    ds_read_b128 v[24:27], v161
    s_waitcnt lgkmcnt(6)
    v_mfma_f32_16x16x32_bf16 v[16:19], v[28:31], v[36:39], v[16:19]
    v_xor_b32 v162, 0x80, v4
    ds_read_b128 v[28:31], v162
    s_waitcnt lgkmcnt(6)
    v_mfma_f32_16x16x32_bf16 v[16:19], v[164:167], v[40:43], v[16:19]
    v_xor_b32 v160, 0x90, v4
    ds_read_b128 v[164:167], v160
    s_waitcnt lgkmcnt(6)
    v_mfma_f32_16x16x32_bf16 v[16:19], v[144:147], v[44:47], v[16:19]
    v_xor_b32 v161, 0xa0, v4
    ds_read_b128 v[144:147], v161
    s_waitcnt lgkmcnt(6)
    v_mfma_f32_16x16x32_bf16 v[16:19], v[148:151], v[48:51], v[16:19]
    v_xor_b32 v162, 0xb0, v4
    ds_read_b128 v[148:151], v162
    s_waitcnt lgkmcnt(6)
    v_mfma_f32_16x16x32_bf16 v[16:19], v[152:155], v[52:55], v[16:19]
    v_xor_b32 v160, 0xc0, v4
    ds_read_b128 v[152:155], v160
    s_waitcnt lgkmcnt(6)
    v_mfma_f32_16x16x32_bf16 v[16:19], v[156:159], v[56:59], v[16:19]
    v_xor_b32 v161, 0xd0, v4
    ds_read_b128 v[156:159], v161
    s_waitcnt lgkmcnt(6)
    v_mfma_f32_16x16x32_bf16 v[16:19], v[24:27], v[60:63], v[16:19]
    v_xor_b32 v162, 0xe0, v4
    ds_read_b128 v[24:27], v162
    s_waitcnt lgkmcnt(6)
    v_mfma_f32_16x16x32_bf16 v[16:19], v[28:31], v[64:67], v[16:19]
    v_xor_b32 v160, 0xf0, v4
    ds_read_b128 v[28:31], v160
    s_waitcnt lgkmcnt(6)
    v_mfma_f32_16x16x32_bf16 v[16:19], v[164:167], v[68:71], v[16:19]
    s_waitcnt lgkmcnt(5)
    v_mfma_f32_16x16x32_bf16 v[16:19], v[144:147], v[72:75], v[16:19]
    s_waitcnt lgkmcnt(4)
    v_mfma_f32_16x16x32_bf16 v[16:19], v[148:151], v[76:79], v[16:19]
    s_waitcnt lgkmcnt(3)
    v_mfma_f32_16x16x32_bf16 v[16:19], v[152:155], v[80:83], v[16:19]
    s_waitcnt lgkmcnt(2)
    v_mfma_f32_16x16x32_bf16 v[16:19], v[156:159], v[84:87], v[16:19]
    s_waitcnt lgkmcnt(1)
    v_mfma_f32_16x16x32_bf16 v[16:19], v[24:27], v[88:91], v[16:19]
    s_waitcnt lgkmcnt(0)
    v_mfma_f32_16x16x32_bf16 v[16:19], v[28:31], v[92:95], v[16:19]
    s_waitcnt lgkmcnt(0)
    s_barrier
    v_xor_b32 v160, 0x0, v2
    ds_read_b128 v[24:27], v160
    v_xor_b32 v161, 0x10, v2
    ds_read_b128 v[28:31], v161
    v_xor_b32 v162, 0x20, v2
    ds_read_b128 v[164:167], v162
    v_xor_b32 v160, 0x30, v2
    ds_read_b128 v[144:147], v160
    v_xor_b32 v161, 0x40, v2
    ds_read_b128 v[148:151], v161
    v_xor_b32 v162, 0x50, v2
    ds_read_b128 v[152:155], v162
    v_xor_b32 v160, 0x60, v2
    ds_read_b128 v[156:159], v160
    s_waitcnt lgkmcnt(6)
    v_mfma_f32_16x16x32_bf16 v[20:23], v[24:27], v[32:35], 0
    v_xor_b32 v161, 0x70, v2
    ds_read_b128 v[24:27], v161
    s_waitcnt lgkmcnt(6)
    v_mfma_f32_16x16x32_bf16 v[20:23], v[28:31], v[36:39], v[20:23]
    v_xor_b32 v162, 0x80, v2
    ds_read_b128 v[28:31], v162
    s_waitcnt lgkmcnt(6)
    v_mfma_f32_16x16x32_bf16 v[20:23], v[164:167], v[40:43], v[20:23]
    v_xor_b32 v160, 0x90, v2
    ds_read_b128 v[164:167], v160
    s_waitcnt lgkmcnt(6)
    v_mfma_f32_16x16x32_bf16 v[20:23], v[144:147], v[44:47], v[20:23]
    v_xor_b32 v161, 0xa0, v2
    ds_read_b128 v[144:147], v161
    s_waitcnt lgkmcnt(6)
    v_mfma_f32_16x16x32_bf16 v[20:23], v[148:151], v[48:51], v[20:23]
    v_xor_b32 v162, 0xb0, v2
    ds_read_b128 v[148:151], v162
    s_waitcnt lgkmcnt(6)
    v_mfma_f32_16x16x32_bf16 v[20:23], v[152:155], v[52:55], v[20:23]
    v_xor_b32 v160, 0xc0, v2
    ds_read_b128 v[152:155], v160
    s_waitcnt lgkmcnt(6)
    v_mfma_f32_16x16x32_bf16 v[20:23], v[156:159], v[56:59], v[20:23]
    v_xor_b32 v161, 0xd0, v2
    ds_read_b128 v[156:159], v161
    s_waitcnt lgkmcnt(6)
    v_mfma_f32_16x16x32_bf16 v[20:23], v[24:27], v[60:63], v[20:23]
    v_xor_b32 v162, 0xe0, v2
    ds_read_b128 v[24:27], v162
    s_waitcnt lgkmcnt(6)
    v_mfma_f32_16x16x32_bf16 v[20:23], v[28:31], v[64:67], v[20:23]
    v_xor_b32 v160, 0xf0, v2
    ds_read_b128 v[28:31], v160
    s_waitcnt lgkmcnt(6)
    v_mfma_f32_16x16x32_bf16 v[20:23], v[164:167], v[68:71], v[20:23]
    s_waitcnt lgkmcnt(5)
    v_mfma_f32_16x16x32_bf16 v[20:23], v[144:147], v[72:75], v[20:23]
    s_waitcnt lgkmcnt(4)
    v_mfma_f32_16x16x32_bf16 v[20:23], v[148:151], v[76:79], v[20:23]
    s_waitcnt lgkmcnt(3)
    v_mfma_f32_16x16x32_bf16 v[20:23], v[152:155], v[80:83], v[20:23]
    s_waitcnt lgkmcnt(2)
    v_mfma_f32_16x16x32_bf16 v[20:23], v[156:159], v[84:87], v[20:23]
    s_waitcnt lgkmcnt(1)
    v_mfma_f32_16x16x32_bf16 v[20:23], v[24:27], v[88:91], v[20:23]
    s_waitcnt lgkmcnt(0)
    v_mfma_f32_16x16x32_bf16 v[20:23], v[28:31], v[92:95], v[20:23]
    v_max3_f32 v160, v16, v17, v18
    s_nop 6
    v_max3_f32 v160, v160, v19, v20
    v_max3_f32 v160, v160, v21, v22
    v_max_f32 v160, v160, v23
    v_mov_b32 v161, v160
    s_nop 1
    v_permlane32_swap_b32 v160, v161
    v_max_f32 v160, v160, v161
    v_mov_b32 v161, v160
    s_nop 1
    v_permlane16_swap_b32 v160, v161
    v_max_f32 v160, v160, v161
    s_lshl_b32 s7, s64, 7
    v_add_u32 v161, s7, v5
    s_mov_b64 exec, s[86:87]
    ds_write_b32 v161, v160
    s_mov_b64 exec, -1
    s_waitcnt lgkmcnt(0)
    s_barrier
    ds_read_b32 v160, v5 offset:0
    ds_read_b32 v161, v5 offset:128
    ds_read_b32 v162, v5 offset:256
    ds_read_b32 v163, v5 offset:384
    s_waitcnt lgkmcnt(0)
    v_max3_f32 v160, v160, v161, v162
    v_max_f32 v160, v160, v163
    v_mul_f32 v160, s67, v160
    v_max_f32 v160, v160, v13
    v_sub_f32 v161, v13, v160
    v_exp_f32 v161, v161
    v_mov_b32 v13, v160
    v_fma_f32 v16, v16, s67, -v160
    v_fma_f32 v17, v17, s67, -v160
    v_fma_f32 v18, v18, s67, -v160
    v_fma_f32 v19, v19, s67, -v160
    v_fma_f32 v20, v20, s67, -v160
    v_fma_f32 v21, v21, s67, -v160
    v_fma_f32 v22, v22, s67, -v160
    v_fma_f32 v23, v23, s67, -v160
    v_exp_f32 v16, v16
    v_exp_f32 v17, v17
    v_exp_f32 v18, v18
    v_exp_f32 v19, v19
    v_exp_f32 v20, v20
    v_exp_f32 v21, v21
    v_exp_f32 v22, v22
    v_exp_f32 v23, v23
    v_cvt_pk_bf16_f32 v24, v16, v17
    v_cvt_pk_bf16_f32 v25, v18, v19
    v_cvt_pk_bf16_f32 v26, v20, v21
    v_cvt_pk_bf16_f32 v27, v22, v23
    ds_write_b64 v6, v[24:25]
    ds_write_b64 v6, v[26:27] offset:4096
    v_add_u32 v162, 0xc00, v5
    s_mov_b64 exec, s[88:89]
    ds_write_b32 v162, v161
    s_mov_b64 exec, -1
    v_mul_f32 v14, v14, v161
    v_add_f32 v16, v16, v20
    v_add_f32 v17, v17, v21
    v_add_f32 v18, v18, v22
    v_add_f32 v19, v19, v23
    v_add_f32 v16, v16, v18
    v_add_f32 v17, v17, v19
    v_add_f32 v16, v16, v17
    v_add_f32 v14, v14, v16
    v_lshlrev_b32 v3, 4, v1
    v_xor_b32 v3, s62, v3
    v_xor_b32 v15, 32, v3
    s_lshl_b32 s68, s3, 10
    s_waitcnt lgkmcnt(0)
    s_barrier
    ds_read_b128 v[16:19], v7 offset:0
    ds_read_b64_tr_b16 v[24:25], v9 offset:0
    ds_read_b64_tr_b16 v[26:27], v11 offset:0
    ds_read_b64_tr_b16 v[28:29], v10 offset:0
    ds_read_b64_tr_b16 v[30:31], v12 offset:0
    ds_read_b128 v[20:23], v7 offset:1024
    ds_read_b64_tr_b16 v[160:161], v9 offset:16384
    ds_read_b64_tr_b16 v[162:163], v11 offset:16384
    ds_read_b64_tr_b16 v[164:165], v10 offset:16384
    ds_read_b64_tr_b16 v[166:167], v12 offset:16384
    s_waitcnt lgkmcnt(7)
    v_mfma_f32_32x32x16_bf16 v[128:143], v[24:27], v[16:19], 0
    s_waitcnt lgkmcnt(5)
    v_mfma_f32_32x32x16_bf16 v[144:159], v[28:31], v[16:19], 0
    ds_read_b128 v[16:19], v7 offset:2048
    ds_read_b64_tr_b16 v[24:25], v9 offset:32768
    ds_read_b64_tr_b16 v[26:27], v11 offset:32768
    ds_read_b64_tr_b16 v[28:29], v10 offset:32768
    ds_read_b64_tr_b16 v[30:31], v12 offset:32768
    s_waitcnt lgkmcnt(7)
    v_mfma_f32_32x32x16_bf16 v[128:143], v[160:163], v[20:23], v[128:143]
    s_waitcnt lgkmcnt(5)
    v_mfma_f32_32x32x16_bf16 v[144:159], v[164:167], v[20:23], v[144:159]
    ds_read_b128 v[20:23], v7 offset:3072
    ds_read_b64_tr_b16 v[160:161], v9 offset:49152
    ds_read_b64_tr_b16 v[162:163], v11 offset:49152
    ds_read_b64_tr_b16 v[164:165], v10 offset:49152
    ds_read_b64_tr_b16 v[166:167], v12 offset:49152
    s_waitcnt lgkmcnt(7)
    v_mfma_f32_32x32x16_bf16 v[128:143], v[24:27], v[16:19], v[128:143]
    s_waitcnt lgkmcnt(5)
    v_mfma_f32_32x32x16_bf16 v[144:159], v[28:31], v[16:19], v[144:159]
    v_add_u32 v9, 0x10000, v9
    v_add_u32 v10, 0x10000, v10
    v_add_u32 v11, 0x10000, v11
    v_add_u32 v12, 0x10000, v12
    ds_read_b128 v[16:19], v7 offset:4096
    ds_read_b64_tr_b16 v[24:25], v9 offset:0
    ds_read_b64_tr_b16 v[26:27], v11 offset:0
    ds_read_b64_tr_b16 v[28:29], v10 offset:0
    ds_read_b64_tr_b16 v[30:31], v12 offset:0
    s_waitcnt lgkmcnt(7)
    v_mfma_f32_32x32x16_bf16 v[128:143], v[160:163], v[20:23], v[128:143]
    s_waitcnt lgkmcnt(5)
    v_mfma_f32_32x32x16_bf16 v[144:159], v[164:167], v[20:23], v[144:159]
    s_barrier
    ds_read_b128 v[20:23], v7 offset:5120
    ds_read_b64_tr_b16 v[160:161], v9 offset:16384
    ds_read_b64_tr_b16 v[162:163], v11 offset:16384
    ds_read_b64_tr_b16 v[164:165], v10 offset:16384
    ds_read_b64_tr_b16 v[166:167], v12 offset:16384
    s_waitcnt lgkmcnt(7)
    v_mfma_f32_32x32x16_bf16 v[128:143], v[24:27], v[16:19], v[128:143]
    s_waitcnt lgkmcnt(5)
    v_mfma_f32_32x32x16_bf16 v[144:159], v[28:31], v[16:19], v[144:159]
    ds_read_b128 v[16:19], v7 offset:6144
    ds_read_b64_tr_b16 v[24:25], v9 offset:32768
    ds_read_b64_tr_b16 v[26:27], v11 offset:32768
    ds_read_b64_tr_b16 v[28:29], v10 offset:32768
    ds_read_b64_tr_b16 v[30:31], v12 offset:32768
    s_waitcnt lgkmcnt(7)
    v_mfma_f32_32x32x16_bf16 v[128:143], v[160:163], v[20:23], v[128:143]
    s_waitcnt lgkmcnt(5)
    v_mfma_f32_32x32x16_bf16 v[144:159], v[164:167], v[20:23], v[144:159]
    ds_read_b128 v[20:23], v7 offset:7168
    ds_read_b64_tr_b16 v[160:161], v9 offset:49152
    ds_read_b64_tr_b16 v[162:163], v11 offset:49152
    ds_read_b64_tr_b16 v[164:165], v10 offset:49152
    ds_read_b64_tr_b16 v[166:167], v12 offset:49152
    s_waitcnt lgkmcnt(7)
    v_mfma_f32_32x32x16_bf16 v[128:143], v[24:27], v[16:19], v[128:143]
    s_waitcnt lgkmcnt(5)
    v_mfma_f32_32x32x16_bf16 v[144:159], v[28:31], v[16:19], v[144:159]
    s_waitcnt lgkmcnt(2)
    v_mfma_f32_32x32x16_bf16 v[128:143], v[160:163], v[20:23], v[128:143]
    s_waitcnt lgkmcnt(0)
    v_mfma_f32_32x32x16_bf16 v[144:159], v[164:167], v[20:23], v[144:159]
    v_add_u32 v9, 0xffff0000, v9
    v_add_u32 v10, 0xffff0000, v10
    v_add_u32 v11, 0xffff0000, v11
    v_add_u32 v12, 0xffff0000, v12
    s_lshl_b32 s7, s3, 10
    s_add_u32 s7, s7, 0x10000
    v_lshl_add_u32 v3, v1, 4, s7
    s_waitcnt vmcnt(0)
    s_barrier
    ds_write_b128 v3, v[96:99] offset:0
    ds_write_b128 v3, v[100:103] offset:8192
    ds_write_b128 v3, v[104:107] offset:16384
    ds_write_b128 v3, v[108:111] offset:24576
    ds_write_b128 v3, v[112:115] offset:32768
    ds_write_b128 v3, v[116:119] offset:40960
    ds_write_b128 v3, v[120:123] offset:49152
    ds_write_b128 v3, v[124:127] offset:57344
    s_waitcnt lgkmcnt(4)
    v_xor_b32 v160, 0x0, v4
    ds_read_b128 v[24:27], v160
    v_xor_b32 v161, 0x10, v4
    ds_read_b128 v[28:31], v161
    v_xor_b32 v162, 0x20, v4
    ds_read_b128 v[164:167], v162
    v_xor_b32 v160, 0x30, v4
    ds_read_b128 v[96:99], v160
    v_xor_b32 v161, 0x40, v4
    ds_read_b128 v[100:103], v161
    v_xor_b32 v162, 0x50, v4
    ds_read_b128 v[104:107], v162
    v_xor_b32 v160, 0x60, v4
    ds_read_b128 v[108:111], v160
    s_waitcnt lgkmcnt(6)
    v_mfma_f32_16x16x32_bf16 v[16:19], v[24:27], v[32:35], 0
    v_xor_b32 v161, 0x70, v4
    ds_read_b128 v[24:27], v161
    s_waitcnt lgkmcnt(6)
    v_mfma_f32_16x16x32_bf16 v[16:19], v[28:31], v[36:39], v[16:19]
    v_xor_b32 v162, 0x80, v4
    ds_read_b128 v[28:31], v162
    s_waitcnt lgkmcnt(6)
    v_mfma_f32_16x16x32_bf16 v[16:19], v[164:167], v[40:43], v[16:19]
    v_xor_b32 v160, 0x90, v4
    ds_read_b128 v[164:167], v160
    s_waitcnt lgkmcnt(6)
    v_mfma_f32_16x16x32_bf16 v[16:19], v[96:99], v[44:47], v[16:19]
    v_xor_b32 v161, 0xa0, v4
    ds_read_b128 v[96:99], v161
    s_waitcnt lgkmcnt(6)
    v_mfma_f32_16x16x32_bf16 v[16:19], v[100:103], v[48:51], v[16:19]
    v_xor_b32 v162, 0xb0, v4
    ds_read_b128 v[100:103], v162
    s_waitcnt lgkmcnt(6)
    v_mfma_f32_16x16x32_bf16 v[16:19], v[104:107], v[52:55], v[16:19]
    v_xor_b32 v160, 0xc0, v4
    ds_read_b128 v[104:107], v160
    s_waitcnt lgkmcnt(6)
    v_mfma_f32_16x16x32_bf16 v[16:19], v[108:111], v[56:59], v[16:19]
    v_xor_b32 v161, 0xd0, v4
    ds_read_b128 v[108:111], v161
    s_waitcnt lgkmcnt(6)
    v_mfma_f32_16x16x32_bf16 v[16:19], v[24:27], v[60:63], v[16:19]
    v_xor_b32 v162, 0xe0, v4
    ds_read_b128 v[24:27], v162
    s_waitcnt lgkmcnt(6)
    v_mfma_f32_16x16x32_bf16 v[16:19], v[28:31], v[64:67], v[16:19]
    v_xor_b32 v160, 0xf0, v4
    ds_read_b128 v[28:31], v160
    s_waitcnt lgkmcnt(6)
    v_mfma_f32_16x16x32_bf16 v[16:19], v[164:167], v[68:71], v[16:19]
    s_waitcnt lgkmcnt(5)
    v_mfma_f32_16x16x32_bf16 v[16:19], v[96:99], v[72:75], v[16:19]
    s_waitcnt lgkmcnt(4)
    v_mfma_f32_16x16x32_bf16 v[16:19], v[100:103], v[76:79], v[16:19]
    s_waitcnt lgkmcnt(3)
    v_mfma_f32_16x16x32_bf16 v[16:19], v[104:107], v[80:83], v[16:19]
    s_waitcnt lgkmcnt(2)
    v_mfma_f32_16x16x32_bf16 v[16:19], v[108:111], v[84:87], v[16:19]
    s_waitcnt lgkmcnt(1)
    v_mfma_f32_16x16x32_bf16 v[16:19], v[24:27], v[88:91], v[16:19]
    s_waitcnt lgkmcnt(0)
    v_mfma_f32_16x16x32_bf16 v[16:19], v[28:31], v[92:95], v[16:19]
    s_barrier
    v_xor_b32 v160, 0x0, v2
    ds_read_b128 v[24:27], v160
    v_xor_b32 v161, 0x10, v2
    ds_read_b128 v[28:31], v161
    v_xor_b32 v162, 0x20, v2
    ds_read_b128 v[164:167], v162
    v_xor_b32 v160, 0x30, v2
    ds_read_b128 v[96:99], v160
    v_xor_b32 v161, 0x40, v2
    ds_read_b128 v[100:103], v161
    v_xor_b32 v162, 0x50, v2
    ds_read_b128 v[104:107], v162
    v_xor_b32 v160, 0x60, v2
    ds_read_b128 v[108:111], v160
    s_waitcnt lgkmcnt(6)
    v_mfma_f32_16x16x32_bf16 v[20:23], v[24:27], v[32:35], 0
    v_xor_b32 v161, 0x70, v2
    ds_read_b128 v[24:27], v161
    s_waitcnt lgkmcnt(6)
    v_mfma_f32_16x16x32_bf16 v[20:23], v[28:31], v[36:39], v[20:23]
    v_xor_b32 v162, 0x80, v2
    ds_read_b128 v[28:31], v162
    s_waitcnt lgkmcnt(6)
    v_mfma_f32_16x16x32_bf16 v[20:23], v[164:167], v[40:43], v[20:23]
    v_xor_b32 v160, 0x90, v2
    ds_read_b128 v[164:167], v160
    s_waitcnt lgkmcnt(6)
    v_mfma_f32_16x16x32_bf16 v[20:23], v[96:99], v[44:47], v[20:23]
    v_xor_b32 v161, 0xa0, v2
    ds_read_b128 v[96:99], v161
    s_waitcnt lgkmcnt(6)
    v_mfma_f32_16x16x32_bf16 v[20:23], v[100:103], v[48:51], v[20:23]
    v_xor_b32 v162, 0xb0, v2
    ds_read_b128 v[100:103], v162
    s_waitcnt lgkmcnt(6)
    v_mfma_f32_16x16x32_bf16 v[20:23], v[104:107], v[52:55], v[20:23]
    v_xor_b32 v160, 0xc0, v2
    ds_read_b128 v[104:107], v160
    s_waitcnt lgkmcnt(6)
    v_mfma_f32_16x16x32_bf16 v[20:23], v[108:111], v[56:59], v[20:23]
    v_xor_b32 v161, 0xd0, v2
    ds_read_b128 v[108:111], v161
    s_waitcnt lgkmcnt(6)
    v_mfma_f32_16x16x32_bf16 v[20:23], v[24:27], v[60:63], v[20:23]
    v_xor_b32 v162, 0xe0, v2
    ds_read_b128 v[24:27], v162
    s_waitcnt lgkmcnt(6)
    v_mfma_f32_16x16x32_bf16 v[20:23], v[28:31], v[64:67], v[20:23]
    v_xor_b32 v160, 0xf0, v2
    ds_read_b128 v[28:31], v160
    s_waitcnt lgkmcnt(6)
    v_mfma_f32_16x16x32_bf16 v[20:23], v[164:167], v[68:71], v[20:23]
    s_waitcnt lgkmcnt(5)
    v_mfma_f32_16x16x32_bf16 v[20:23], v[96:99], v[72:75], v[20:23]
    s_waitcnt lgkmcnt(4)
    v_mfma_f32_16x16x32_bf16 v[20:23], v[100:103], v[76:79], v[20:23]
    s_waitcnt lgkmcnt(3)
    v_mfma_f32_16x16x32_bf16 v[20:23], v[104:107], v[80:83], v[20:23]
    s_waitcnt lgkmcnt(2)
    v_mfma_f32_16x16x32_bf16 v[20:23], v[108:111], v[84:87], v[20:23]
    s_waitcnt lgkmcnt(1)
    v_mfma_f32_16x16x32_bf16 v[20:23], v[24:27], v[88:91], v[20:23]
    s_waitcnt lgkmcnt(0)
    v_mfma_f32_16x16x32_bf16 v[20:23], v[28:31], v[92:95], v[20:23]
    v_max3_f32 v160, v16, v17, v18
    s_nop 6
    v_max3_f32 v160, v160, v19, v20
    v_max3_f32 v160, v160, v21, v22
    v_max_f32 v160, v160, v23
    v_mov_b32 v161, v160
    s_nop 1
    v_permlane32_swap_b32 v160, v161
    v_max_f32 v160, v160, v161
    v_mov_b32 v161, v160
    s_nop 1
    v_permlane16_swap_b32 v160, v161
    v_max_f32 v160, v160, v161
    s_lshl_b32 s7, s64, 7
    v_add_u32 v161, s7, v5
    s_mov_b64 exec, s[86:87]
    ds_write_b32 v161, v160
    s_mov_b64 exec, -1
    s_waitcnt lgkmcnt(0)
    s_barrier
    ds_read_b32 v160, v5 offset:0
    ds_read_b32 v161, v5 offset:128
    ds_read_b32 v162, v5 offset:256
    ds_read_b32 v163, v5 offset:384
    s_waitcnt lgkmcnt(0)
    v_max3_f32 v160, v160, v161, v162
    v_max_f32 v160, v160, v163
    v_mul_f32 v160, s67, v160
    v_max_f32 v160, v160, v13
    v_sub_f32 v161, v13, v160
    v_exp_f32 v161, v161
    v_mov_b32 v13, v160
    v_fma_f32 v16, v16, s67, -v160
    v_fma_f32 v17, v17, s67, -v160
    v_fma_f32 v18, v18, s67, -v160
    v_fma_f32 v19, v19, s67, -v160
    v_fma_f32 v20, v20, s67, -v160
    v_fma_f32 v21, v21, s67, -v160
    v_fma_f32 v22, v22, s67, -v160
    v_fma_f32 v23, v23, s67, -v160
    v_exp_f32 v16, v16
    v_exp_f32 v17, v17
    v_exp_f32 v18, v18
    v_exp_f32 v19, v19
    v_exp_f32 v20, v20
    v_exp_f32 v21, v21
    v_exp_f32 v22, v22
    v_exp_f32 v23, v23
    v_cvt_pk_bf16_f32 v24, v16, v17
    v_cvt_pk_bf16_f32 v25, v18, v19
    v_cvt_pk_bf16_f32 v26, v20, v21
    v_cvt_pk_bf16_f32 v27, v22, v23
    ds_write_b64 v6, v[24:25]
    ds_write_b64 v6, v[26:27] offset:4096
    v_add_u32 v162, 0xc00, v5
    s_mov_b64 exec, s[88:89]
    ds_write_b32 v162, v161
    s_mov_b64 exec, -1
    v_mul_f32 v14, v14, v161
    v_add_f32 v16, v16, v20
    v_add_f32 v17, v17, v21
    v_add_f32 v18, v18, v22
    v_add_f32 v19, v19, v23
    v_add_f32 v16, v16, v18
    v_add_f32 v17, v17, v19
    v_add_f32 v16, v16, v17
    v_add_f32 v14, v14, v16
    v_mov_b32 v160, v14
    s_nop 1
    v_permlane32_swap_b32 v14, v160
    v_add_f32 v14, v14, v160
    v_mov_b32 v160, v14
    s_nop 1
    v_permlane16_swap_b32 v14, v160
    v_add_f32 v14, v14, v160
    s_lshl_b32 s7, s64, 7
    s_add_u32 s7, s7, 0x200
    v_add_u32 v161, s7, v5
    v_add_u32 v162, 0xc80, v5
    s_mov_b64 exec, s[86:87]
    ds_write_b32 v161, v14
    s_mov_b64 exec, s[88:89]
    ds_write_b32 v162, v13
    s_mov_b64 exec, -1
    v_and_b32 v160, 31, v1
    v_lshlrev_b32 v98, 7, v160
    v_lshrrev_b32 v161, 5, v1
    v_and_b32 v160, 7, v1
    v_xor_b32 v161, v160, v161
    v_lshl_add_u32 v98, v161, 4, v98
    s_lshl_b32 s7, s3, 12
    v_add_u32 v98, s7, v98
    v_lshl_add_u32 v99, v1, 4, s7
    v_lshrrev_b32 v161, 3, v1
    v_xor_b32 v160, v160, v161
    v_lshlrev_b32 v100, 7, v161
    v_lshl_add_u32 v100, v160, 4, v100
    s_lshl_b32 s69, s60, 15
    s_add_u32 s69, s69, s7
    s_add_u32 s69, s69, 0x500000
    s_waitcnt lgkmcnt(0)
    s_barrier
    ds_read_b32 v15, v8
    ds_read_b128 v[16:19], v7 offset:0
    ds_read_b64_tr_b16 v[24:25], v9 offset:0
    ds_read_b64_tr_b16 v[26:27], v11 offset:0
    ds_read_b64_tr_b16 v[28:29], v10 offset:0
    ds_read_b64_tr_b16 v[30:31], v12 offset:0
    s_waitcnt lgkmcnt(5)
    v_mul_f32 v128, v15, v128
    v_mul_f32 v129, v15, v129
    v_mul_f32 v130, v15, v130
    v_mul_f32 v131, v15, v131
    v_mul_f32 v132, v15, v132
    v_mul_f32 v133, v15, v133
    v_mul_f32 v134, v15, v134
    v_mul_f32 v135, v15, v135
    s_branch LC_CR
.p2align 12
LT_CR2:
    s_branch LR_CR2
LC_CR:
    v_mul_f32 v136, v15, v136
    v_mul_f32 v137, v15, v137
    v_mul_f32 v138, v15, v138
    v_mul_f32 v139, v15, v139
    v_mul_f32 v140, v15, v140
    v_mul_f32 v141, v15, v141
    v_mul_f32 v142, v15, v142
    v_mul_f32 v143, v15, v143
    v_mul_f32 v144, v15, v144
    v_mul_f32 v145, v15, v145
    v_mul_f32 v146, v15, v146
    v_mul_f32 v147, v15, v147
    v_mul_f32 v148, v15, v148
    v_mul_f32 v149, v15, v149
    v_mul_f32 v150, v15, v150
    v_mul_f32 v151, v15, v151
    v_mul_f32 v152, v15, v152
    v_mul_f32 v153, v15, v153
    v_mul_f32 v154, v15, v154
    v_mul_f32 v155, v15, v155
    v_mul_f32 v156, v15, v156
    v_mul_f32 v157, v15, v157
    v_mul_f32 v158, v15, v158
    v_mul_f32 v159, v15, v159
    ds_read_b128 v[20:23], v7 offset:1024
    ds_read_b64_tr_b16 v[160:161], v9 offset:16384
    ds_read_b64_tr_b16 v[162:163], v11 offset:16384
    ds_read_b64_tr_b16 v[164:165], v10 offset:16384
    ds_read_b64_tr_b16 v[166:167], v12 offset:16384
    s_waitcnt lgkmcnt(7)
    v_mfma_f32_32x32x16_bf16 v[128:143], v[24:27], v[16:19], v[128:143]
    s_waitcnt lgkmcnt(5)
    v_mfma_f32_32x32x16_bf16 v[144:159], v[28:31], v[16:19], v[144:159]
    ds_read_b128 v[16:19], v7 offset:2048
    ds_read_b64_tr_b16 v[24:25], v9 offset:32768
    ds_read_b64_tr_b16 v[26:27], v11 offset:32768
    ds_read_b64_tr_b16 v[28:29], v10 offset:32768
    ds_read_b64_tr_b16 v[30:31], v12 offset:32768
    s_waitcnt lgkmcnt(7)
    v_mfma_f32_32x32x16_bf16 v[128:143], v[160:163], v[20:23], v[128:143]
    s_waitcnt lgkmcnt(5)
    v_mfma_f32_32x32x16_bf16 v[144:159], v[164:167], v[20:23], v[144:159]
    ds_read_b128 v[20:23], v7 offset:3072
    ds_read_b64_tr_b16 v[160:161], v9 offset:49152
    ds_read_b64_tr_b16 v[162:163], v11 offset:49152
    ds_read_b64_tr_b16 v[164:165], v10 offset:49152
    ds_read_b64_tr_b16 v[166:167], v12 offset:49152
    s_waitcnt lgkmcnt(7)
    v_mfma_f32_32x32x16_bf16 v[128:143], v[24:27], v[16:19], v[128:143]
    s_waitcnt lgkmcnt(5)
    v_mfma_f32_32x32x16_bf16 v[144:159], v[28:31], v[16:19], v[144:159]
    v_add_u32 v9, 0x10000, v9
    v_add_u32 v10, 0x10000, v10
    v_add_u32 v11, 0x10000, v11
    v_add_u32 v12, 0x10000, v12
    ds_read_b128 v[16:19], v7 offset:4096
    ds_read_b64_tr_b16 v[24:25], v9 offset:0
    ds_read_b64_tr_b16 v[26:27], v11 offset:0
    ds_read_b64_tr_b16 v[28:29], v10 offset:0
    ds_read_b64_tr_b16 v[30:31], v12 offset:0
    s_waitcnt lgkmcnt(7)
    v_mfma_f32_32x32x16_bf16 v[128:143], v[160:163], v[20:23], v[128:143]
    s_waitcnt lgkmcnt(5)
    v_mfma_f32_32x32x16_bf16 v[144:159], v[164:167], v[20:23], v[144:159]
    s_barrier
    ds_read_b128 v[20:23], v7 offset:5120
    ds_read_b64_tr_b16 v[160:161], v9 offset:16384
    ds_read_b64_tr_b16 v[162:163], v11 offset:16384
    ds_read_b64_tr_b16 v[164:165], v10 offset:16384
    ds_read_b64_tr_b16 v[166:167], v12 offset:16384
    s_waitcnt lgkmcnt(7)
    v_mfma_f32_32x32x16_bf16 v[128:143], v[24:27], v[16:19], v[128:143]
    s_waitcnt lgkmcnt(5)
    v_mfma_f32_32x32x16_bf16 v[144:159], v[28:31], v[16:19], v[144:159]
    ds_read_b128 v[16:19], v7 offset:6144
    ds_read_b64_tr_b16 v[24:25], v9 offset:32768
    ds_read_b64_tr_b16 v[26:27], v11 offset:32768
    ds_read_b64_tr_b16 v[28:29], v10 offset:32768
    ds_read_b64_tr_b16 v[30:31], v12 offset:32768
    s_waitcnt lgkmcnt(7)
    v_mfma_f32_32x32x16_bf16 v[128:143], v[160:163], v[20:23], v[128:143]
    s_waitcnt lgkmcnt(5)
    v_mfma_f32_32x32x16_bf16 v[144:159], v[164:167], v[20:23], v[144:159]
    ds_read_b128 v[20:23], v7 offset:7168
    ds_read_b64_tr_b16 v[160:161], v9 offset:49152
    ds_read_b64_tr_b16 v[162:163], v11 offset:49152
    ds_read_b64_tr_b16 v[164:165], v10 offset:49152
    ds_read_b64_tr_b16 v[166:167], v12 offset:49152
    s_waitcnt lgkmcnt(7)
    v_mfma_f32_32x32x16_bf16 v[128:143], v[24:27], v[16:19], v[128:143]
    s_waitcnt lgkmcnt(5)
    v_mfma_f32_32x32x16_bf16 v[144:159], v[28:31], v[16:19], v[144:159]
    s_waitcnt lgkmcnt(2)
    v_mfma_f32_32x32x16_bf16 v[128:143], v[160:163], v[20:23], v[128:143]
    s_waitcnt lgkmcnt(0)
    v_mfma_f32_32x32x16_bf16 v[144:159], v[164:167], v[20:23], v[144:159]
    s_nop 9
    v_permlane32_swap_b32 v128, v132
    v_permlane32_swap_b32 v129, v133
    v_permlane32_swap_b32 v130, v134
    v_permlane32_swap_b32 v131, v135
    v_cvt_pk_bf16_f32 v16, v128, v129
    v_cvt_pk_bf16_f32 v17, v130, v131
    v_cvt_pk_bf16_f32 v18, v132, v133
    v_cvt_pk_bf16_f32 v19, v134, v135
    v_xor_b32 v160, 0x0, v98
    ds_write_b128 v160, v[16:19]
    v_permlane32_swap_b32 v136, v140
    v_permlane32_swap_b32 v137, v141
    v_permlane32_swap_b32 v138, v142
    v_permlane32_swap_b32 v139, v143
    v_cvt_pk_bf16_f32 v20, v136, v137
    v_cvt_pk_bf16_f32 v21, v138, v139
    v_cvt_pk_bf16_f32 v22, v140, v141
    v_cvt_pk_bf16_f32 v23, v142, v143
    v_xor_b32 v161, 0x20, v98
    ds_write_b128 v161, v[20:23]
    v_permlane32_swap_b32 v144, v148
    v_permlane32_swap_b32 v145, v149
    v_permlane32_swap_b32 v146, v150
    v_permlane32_swap_b32 v147, v151
    v_cvt_pk_bf16_f32 v24, v144, v145
    v_cvt_pk_bf16_f32 v25, v146, v147
    v_cvt_pk_bf16_f32 v26, v148, v149
    v_cvt_pk_bf16_f32 v27, v150, v151
    v_xor_b32 v160, 0x40, v98
    ds_write_b128 v160, v[24:27]
    v_permlane32_swap_b32 v152, v156
    v_permlane32_swap_b32 v153, v157
    v_permlane32_swap_b32 v154, v158
    v_permlane32_swap_b32 v155, v159
    v_cvt_pk_bf16_f32 v28, v152, v153
    v_cvt_pk_bf16_f32 v29, v154, v155
    v_cvt_pk_bf16_f32 v30, v156, v157
    v_cvt_pk_bf16_f32 v31, v158, v159
    v_xor_b32 v161, 0x60, v98
    ds_write_b128 v161, v[28:31]
    ds_read_b128 v[32:35], v99 offset:0
    ds_read_b128 v[36:39], v99 offset:1024
    ds_read_b128 v[40:43], v99 offset:2048
    ds_read_b128 v[44:47], v99 offset:3072
    s_waitcnt lgkmcnt(3)
    buffer_store_dwordx4 v[32:35], v100, s[36:39], s69 offen offset:0 sc1
    s_waitcnt lgkmcnt(2)
    buffer_store_dwordx4 v[36:39], v100, s[36:39], s69 offen offset:1024 sc1
    s_waitcnt lgkmcnt(1)
    buffer_store_dwordx4 v[40:43], v100, s[36:39], s69 offen offset:2048 sc1
    s_waitcnt lgkmcnt(0)
    buffer_store_dwordx4 v[44:47], v100, s[36:39], s69 offen offset:3072 sc1
    v_mov_b32 v160, 0x2404c
    s_mov_b32 s80, 1600000
LW_84:
    ds_read_b32 v161, v160
    s_waitcnt lgkmcnt(0)
    v_readfirstlane_b32 s79, v161
    s_cmp_ge_u32 s79, 1
    s_cbranch_scc1 LWD_85
    s_sleep 2
    s_sub_u32 s80, s80, 1
    s_cmp_lg_u32 s80, 0
    s_cbranch_scc1 LW_84
LWD_85:
    v_mov_b32 v160, 0x24050
    ds_read_b64 v[162:163], v160
    s_waitcnt lgkmcnt(0)
    v_readfirstlane_b32 s94, v162
    v_readfirstlane_b32 s95, v163
    v_and_b32 v160, 31, v1
    v_lshlrev_b32 v3, 2, v160
    v_add_u32 v3, 0x27400, v3
    s_lshl_b32 s7, s60, 9
    s_add_u32 s7, s7, 0xe0000
    s_cmp_eq_u32 s3, 0
    s_cselect_b32 s7, s7, 0x40000000
    v_lshl_add_u32 v4, v160, 4, s7
    v_mov_b32 v22, s94
    v_mov_b32 v23, s95
    ds_read_b32 v16, v3 offset:0
    ds_read_b32 v17, v3 offset:128
    ds_read_b32 v18, v3 offset:256
    ds_read_b32 v19, v3 offset:384
    ds_read_b32 v20, v3 offset:2688
    s_waitcnt lgkmcnt(0)
    v_add_f32 v16, v16, v17
    v_add_f32 v18, v18, v19
    v_add_f32 v21, v16, v18
    s_waitcnt vmcnt(0)
    s_barrier
    s_mov_b64 exec, 0xffffffff
    buffer_store_dwordx4 v[20:23], v4, s[36:39], 0 offen sc1
    s_mov_b64 exec, -1
    v_lshlrev_b32 v2, 4, v1
    s_mov_b32 s44, s12
    s_and_b32 s45, s13, 0xffff
    s_mov_b32 s46, 0x8000000
    s_mov_b32 s47, 0x20000
    s_bfe_u32 s7, s5, 0x10002
    s_lshl_b32 s7, s7, 6
    s_add_u32 s7, s7, s6
    s_lshl_b32 s7, s7, 20
    s_lshl_b32 s72, s3, 10
    s_add_u32 s72, s72, s7
    s_add_u32 s72, s72, 1040384
    s_add_u32 s73, s72, 0x2000000
    s_mov_b32 s74, 4
    s_sleep 60
PV_86:
    s_waitcnt vmcnt(3)
    buffer_load_dwordx4 v[8:11], v2, s[44:47], s72 offen
    s_sub_u32 s72, s72, 8192
    s_waitcnt vmcnt(3)
    buffer_load_dwordx4 v[8:11], v2, s[44:47], s73 offen
    s_sub_u32 s73, s73, 8192
    s_sub_u32 s74, s74, 1
    s_cmp_lg_u32 s74, 0
    s_cbranch_scc1 PV_86
    s_mov_b32 s52, s30
    s_and_b32 s53, s31, 0xffff
    s_mov_b32 s54, 0x2000
    s_mov_b32 s55, 0x20000
    s_lshl_b32 s7, s60, 3
    s_add_u32 s7, s7, s3
    s_lshl_b32 s7, s7, 10
    s_add_u32 s7, s7, 0x100000
    v_add_u32 v4, s7, v2
    s_bfe_u32 s7, s60, 0x20003
    s_lshl_b32 s7, s7, 11
    s_lshr_b32 s66, s60, 5
    s_lshl_b32 s66, s66, 10
    s_add_u32 s7, s7, s66
    s_and_b32 s66, s60, 7
    s_lshl_b32 s66, s66, 7
    s_add_u32 s7, s7, s66
    v_and_b32 v5, 7, v1
    v_lshl_add_u32 v5, v5, 4, s7
    v_lshrrev_b32 v6, 4, v1
    v_lshl_add_u32 v5, v6, 2, v5
    s_mov_b32 s90, 0x00ff00ff
    s_mov_b32 s91, 0x00ff00ff
    s_lshl_b32 s7, s3, 10
    s_add_u32 s7, s7, 0x25200
    v_add_u32 v6, s7, v2
    s_mov_b32 s80, 200000
PO_87:
    buffer_load_dwordx4 v[32:35], v4, s[36:39], 0 offen sc1
PO2_88:
    s_waitcnt vmcnt(0)
    v_cmp_ne_u64 vcc, s[94:95], v[34:35]
    s_cmp_lg_u64 vcc, -1
    s_cbranch_scc1 POD_89
    s_sleep 20
    s_sub_u32 s80, s80, 1
    s_cmp_lg_u32 s80, 0
    s_cbranch_scc1 PO_87
POD_89:
    v_lshlrev_b32 v64, 16, v32
    v_and_b32 v65, 0xffff0000, v32
    v_lshlrev_b32 v66, 16, v33
    v_and_b32 v67, 0xffff0000, v33
    s_cbranch_vccz RD_90
    buffer_load_dwordx4 v[32:35], v4, s[36:39], 0 offen sc1
    s_sleep 4
    buffer_load_dwordx4 v[36:39], v4, s[36:39], 0 offen sc1
    s_sleep 4
    s_mov_b32 s80, 200000
PP_91:
    s_waitcnt vmcnt(1)
    v_cmp_ne_u64 vcc, s[94:95], v[34:35]
    s_cmp_eq_u64 vcc, 0
    s_cbranch_scc1 PPO_93
    buffer_load_dwordx4 v[32:35], v4, s[36:39], 0 offen sc1
    s_waitcnt vmcnt(1)
    v_cmp_ne_u64 vcc, s[94:95], v[38:39]
    s_cmp_eq_u64 vcc, 0
    s_cbranch_scc1 PPO_94
    buffer_load_dwordx4 v[36:39], v4, s[36:39], 0 offen sc1
    s_sub_u32 s80, s80, 1
    s_cmp_lg_u32 s80, 0
    s_cbranch_scc1 PP_91
PPO_93:
    v_lshlrev_b32 v64, 16, v32
    v_and_b32 v65, 0xffff0000, v32
    v_lshlrev_b32 v66, 16, v33
    v_and_b32 v67, 0xffff0000, v33
    s_branch PPD_92
PPO_94:
    v_lshlrev_b32 v64, 16, v36
    v_and_b32 v65, 0xffff0000, v36
    v_lshlrev_b32 v66, 16, v37
    v_and_b32 v67, 0xffff0000, v37
PPD_92:
RD_90:
    ds_write_b128 v6, v[64:67]
    s_waitcnt lgkmcnt(0)
    s_barrier
    s_cmp_lg_u32 s3, 0
    s_cbranch_scc1 L_END
    ds_read_b128 v[64:67], v6 offset:0
    ds_read_b128 v[68:71], v6 offset:1024
    ds_read_b128 v[72:75], v6 offset:2048
    ds_read_b128 v[76:79], v6 offset:3072
    ds_read_b128 v[80:83], v6 offset:4096
    ds_read_b128 v[84:87], v6 offset:5120
    ds_read_b128 v[88:91], v6 offset:6144
    ds_read_b128 v[92:95], v6 offset:7168
    s_waitcnt lgkmcnt(4)
    v_pk_add_f32 v[64:65], v[64:65], v[72:73]
    v_pk_add_f32 v[66:67], v[66:67], v[74:75]
    v_pk_add_f32 v[68:69], v[68:69], v[76:77]
    v_pk_add_f32 v[70:71], v[70:71], v[78:79]
    v_pk_add_f32 v[64:65], v[64:65], v[68:69]
    v_pk_add_f32 v[66:67], v[66:67], v[70:71]
    s_waitcnt lgkmcnt(0)
    v_pk_add_f32 v[80:81], v[80:81], v[88:89]
    v_pk_add_f32 v[82:83], v[82:83], v[90:91]
    v_pk_add_f32 v[84:85], v[84:85], v[92:93]
    v_pk_add_f32 v[86:87], v[86:87], v[94:95]
    v_pk_add_f32 v[80:81], v[80:81], v[84:85]
    v_pk_add_f32 v[82:83], v[82:83], v[86:87]
    s_nop 0
    v_permlane32_swap_b32 v64, v80
    v_permlane32_swap_b32 v65, v81
    v_permlane32_swap_b32 v66, v82
    v_permlane32_swap_b32 v67, v83
    v_add_f32 v64, v64, v80
    v_add_f32 v65, v65, v81
    v_add_f32 v66, v66, v82
    v_add_f32 v67, v67, v83
    s_nop 0
    v_permlane16_swap_b32 v64, v66
    v_permlane16_swap_b32 v65, v67
    v_add_f32 v64, v64, v66
    v_add_f32 v65, v65, v67
    s_nop 0
    v_add_f32_dpp v64, v64, v64 row_ror:8 row_mask:0xf bank_mask:0xf
    v_add_f32_dpp v65, v65, v65 row_ror:8 row_mask:0xf bank_mask:0xf
    v_cvt_pk_bf16_f32 v8, v64, v65
    s_mov_b64 exec, s[90:91]
    buffer_store_dword v8, v5, s[52:55], 0 offen
    s_mov_b64 exec, -1
    s_endpgm
L_CODE_END:
.section .rodata,"a"
.p2align 6
.amdhsa_kernel concat_heads__sliding_block_cached__compressed_kv_cla__decode_kernel
  .amdhsa_next_free_vgpr 168
  .amdhsa_next_free_sgpr 102
  .amdhsa_accum_offset 168
  .amdhsa_group_segment_fixed_size 0
  .amdhsa_kernarg_size 112
  .amdhsa_user_sgpr_count 2
  .amdhsa_user_sgpr_kernarg_segment_ptr 1
  .amdhsa_system_sgpr_workgroup_id_x 1
  .amdhsa_float_denorm_mode_32 3
.end_amdhsa_kernel
```

```asm
; @launch grid=(256,1,1) block=(768,1,1) lds=163840
.amdgcn_target "amdgcn-amd-amdhsa--gfx950"
.text
.globl concat_heads__sliding_block_cached__compressed_kv_cla__decode_kernel
.p2align 12
.p2align 8
.type concat_heads__sliding_block_cached__compressed_kv_cla__decode_kernel,@function
concat_heads__sliding_block_cached__compressed_kv_cla__decode_kernel:
    s_load_dwordx16 s[8:23], s[0:1], 0
    s_load_dwordx8 s[24:31], s[0:1], 64
    s_load_dwordx4 s[32:35], s[0:1], 96
    v_lshrrev_b32 v1, 6, v0
    s_and_b32 s4, s2, 7
    v_readfirstlane_b32 s3, v1
    s_lshr_b32 s5, s2, 3
    v_and_b32 v1, 63, v0
    s_and_b32 s7, s5, 3
    s_lshl2_add_u32 s6, s4, s7
    s_cmp_ge_u32 s5, 32
    s_cbranch_scc1 L_END0
    s_cmp_ge_u32 s5, 16
    s_cbranch_scc1 EA_1
    s_cmp_ge_u32 s5, 8
    s_cbranch_scc1 EC_2
    s_cmp_ge_u32 s3, 8
    s_cbranch_scc1 L_W2
    s_cmp_ge_u32 s3, 4
    s_cbranch_scc1 L_W1
    s_branch L_W
EC_2:
    s_cmp_ge_u32 s3, 8
    s_cbranch_scc1 L_CSVC
    s_branch L_C
EA_1:
    s_cmp_eq_u32 s3, 11
    s_cbranch_scc1 L_ASVC
    s_branch L_AA
L_W2:
    s_sub_u32 s62, s3, 8
    s_lshl_b32 s7, s5, 2
    s_add_u32 s7, s7, s62
    s_lshl_b32 s7, s7, 17
    s_lshl_b32 s70, s4, 10
    s_add_u32 s70, s70, s7
    s_lshl_b32 s71, s62, 14
    v_lshlrev_b32 v2, 4, v1
    s_lshl_b32 s7, s62, 6
    v_xor_b32 v4, s7, v2
    v_xor_b32 v5, 16, v4
    v_xor_b32 v6, 32, v4
    v_xor_b32 v7, 48, v4
    s_waitcnt lgkmcnt(0)
    s_lshl_b32 s7, s2, 4
    s_add_u32 s7, s7, s3
    s_cmp_lg_u32 s7, 8
    s_cbranch_scc1 NM_61
    s_memrealtime s[94:95]
    s_mov_b32 s40, s32
    s_and_b32 s41, s33, 0xffff
    s_mov_b32 s42, 0x100
    s_mov_b32 s43, 0x20000
    v_mov_b32 v8, 0
    s_waitcnt lgkmcnt(0)
    s_or_b32 s95, s95, 0x80000000
    v_mov_b32 v10, s94
    v_mov_b32 v11, s95
    s_mov_b64 exec, 1
    buffer_store_dwordx2 v[10:11], v8, s[40:43], 0 offen sc1
    s_mov_b64 exec, -1
NM_61:
    s_mov_b32 s52, s24
    s_and_b32 s53, s25, 0xffff
    s_mov_b32 s54, 0x400000
    s_mov_b32 s55, 0x20000
    s_mov_b32 m0, s71
    s_nop 0
    buffer_load_dwordx4 v4, s[52:55], s70 offen nt lds
    s_addk_i32 s70, 8192
    s_addk_i32 s71, 1024
    s_mov_b32 m0, s71
    s_nop 0
    buffer_load_dwordx4 v4, s[52:55], s70 offen nt lds
    s_addk_i32 s70, 8192
    s_addk_i32 s71, 1024
    s_mov_b32 m0, s71
    s_nop 0
    buffer_load_dwordx4 v4, s[52:55], s70 offen nt lds
    s_addk_i32 s70, 8192
    s_addk_i32 s71, 1024
    s_mov_b32 m0, s71
    s_nop 0
    buffer_load_dwordx4 v4, s[52:55], s70 offen nt lds
    s_addk_i32 s70, 8192
    s_addk_i32 s71, 1024
    s_mov_b32 m0, s71
    s_nop 0
    buffer_load_dwordx4 v5, s[52:55], s70 offen nt lds
    s_addk_i32 s70, 8192
    s_addk_i32 s71, 1024
    s_mov_b32 m0, s71
    s_nop 0
    buffer_load_dwordx4 v5, s[52:55], s70 offen nt lds
    s_addk_i32 s70, 8192
    s_addk_i32 s71, 1024
    s_mov_b32 m0, s71
    s_nop 0
    buffer_load_dwordx4 v5, s[52:55], s70 offen nt lds
    s_addk_i32 s70, 8192
    s_addk_i32 s71, 1024
    s_mov_b32 m0, s71
    s_nop 0
    buffer_load_dwordx4 v5, s[52:55], s70 offen nt lds
    s_addk_i32 s70, 8192
    s_addk_i32 s71, 1024
    s_branch L_W2B
L_AA:
    s_cmp_ge_u32 s3, 8
    s_cbranch_scc1 AK_3
    s_and_b32 s7, s5, 12
    s_and_b32 s66, s3, 3
    s_add_u32 s7, s7, s66
    v_lshrrev_b32 v2, 4, v1
    v_lshlrev_b32 v3, 16, v2
    v_and_b32 v4, 15, v1
    v_lshl_add_u32 v3, v4, 4, v3
    s_lshl_b32 s66, s7, 18
    s_lshl_b32 s67, s6, 8
    s_add_u32 s66, s66, s67
    s_cmp_lt_u32 s3, 4
    s_cbranch_scc1 AP_5
    s_barrier
    s_sleep 26
AP_5:
    s_cmp_lt_u32 s3, 4
    s_waitcnt lgkmcnt(0)
    s_cselect_b32 s72, s22, s14
    s_cselect_b32 s73, s23, s15
    s_cselect_b32 s70, s18, s8
    s_cselect_b32 s71, s19, s9
    s_mov_b32 s56, s72
    s_and_b32 s57, s73, 0xffff
    s_mov_b32 s58, 0x400000
    s_mov_b32 s59, 0x20000
    buffer_load_dwordx4 v[128:131], v3, s[56:59], s66 offen nt
    s_addk_i32 s66, 8192
    buffer_load_dwordx4 v[132:135], v3, s[56:59], s66 offen nt
    s_addk_i32 s66, 8192
    buffer_load_dwordx4 v[136:139], v3, s[56:59], s66 offen nt
    s_addk_i32 s66, 8192
    buffer_load_dwordx4 v[140:143], v3, s[56:59], s66 offen nt
    s_addk_i32 s66, 8192
    buffer_load_dwordx4 v[144:147], v3, s[56:59], s66 offen nt
    s_addk_i32 s66, 8192
    buffer_load_dwordx4 v[148:151], v3, s[56:59], s66 offen nt
    s_addk_i32 s66, 8192
    buffer_load_dwordx4 v[152:155], v3, s[56:59], s66 offen nt
    s_addk_i32 s66, 8192
    buffer_load_dwordx4 v[156:159], v3, s[56:59], s66 offen nt
    s_addk_i32 s66, 8192
    s_branch L_AB
L_C:
    s_lshl_b32 s60, s4, 3
    s_add_u32 s60, s60, s5
    s_sub_u32 s60, s60, 8
    v_lshlrev_b32 v160, 4, v1
    s_and_b32 s7, s3, 3
    s_lshl_b32 s7, s7, 2
    s_lshr_b32 s66, s3, 2
    s_or_b32 s7, s7, s66
    s_lshl_b32 s62, s7, 4
    v_xor_b32 v2, s62, v160
    v_xor_b32 v3, 32, v2
    s_lshl_b32 s70, s60, 18
    s_lshl_b32 s68, s3, 10
    s_add_u32 s61, s70, s68
    s_waitcnt lgkmcnt(0)
    s_mov_b32 s44, s20
    s_and_b32 s45, s21, 0xffff
    s_mov_b32 s46, 0x1000000
    s_mov_b32 s47, 0x20000
    s_mov_b32 m0, s68
    s_nop 0
    buffer_load_dwordx4 v2, s[44:47], s61 offen nt lds
    s_addk_i32 s68, 8192
    s_addk_i32 s61, 8192
    s_mov_b32 m0, s68
    s_nop 0
    buffer_load_dwordx4 v3, s[44:47], s61 offen nt lds
    s_addk_i32 s68, 8192
    s_addk_i32 s61, 8192
    s_mov_b32 m0, s68
    s_nop 0
    buffer_load_dwordx4 v2, s[44:47], s61 offen nt lds
    s_addk_i32 s68, 8192
    s_addk_i32 s61, 8192
    s_mov_b32 m0, s68
    s_nop 0
    buffer_load_dwordx4 v3, s[44:47], s61 offen nt lds
    s_addk_i32 s68, 8192
    s_branch L_CB
L_AB:
    v_bfe_u32 v4, v1, 2, 2
    v_lshlrev_b32 v4, 10, v4
    v_lshl_add_u32 v4, v2, 4, v4
    s_lshl_b32 s67, s7, 6
    s_mov_b32 s52, s70
    s_and_b32 s53, s71, 0xffff
    s_mov_b32 s54, 0x1000
    s_mov_b32 s55, 0x20000
    buffer_load_dwordx4 v[160:163], v4, s[52:55], s67 offen
    s_mov_b32 s92, 0x05040100
    s_mov_b32 s93, 0x07060302
    s_mov_b32 s36, s34
    s_and_b32 s37, s35, 0xffff
    s_mov_b32 s38, 0x1000000
    s_mov_b32 s39, 0x20000
    s_mov_b32 s40, s32
    s_and_b32 s41, s33, 0xffff
    s_mov_b32 s42, 0x100
    s_mov_b32 s43, 0x20000
    s_mov_b32 s44, s10
    s_and_b32 s45, s11, 0xffff
    s_mov_b32 s46, 0x8000000
    s_mov_b32 s47, 0x20000
    s_mov_b32 s48, s12
    s_and_b32 s49, s13, 0xffff
    s_mov_b32 s50, 0x8000000
    s_mov_b32 s51, 0x20000
    s_lshr_b32 s7, s5, 2
    s_sub_u32 s7, s7, 4
    s_lshl_b32 s7, s7, 5
    s_add_u32 s7, s7, s6
    s_lshl_b32 s7, s7, 20
    s_add_u32 s7, s7, 0xC0000
    v_lshlrev_b32 v6, 4, v1
    v_add_u32 v6, s7, v6
    s_mov_b32 s64, 0x3e0293ee
    s_lshl_b32 s60, s3, 10
    s_mov_b32 s61, s60
    s_cmp_ge_u32 s3, 8
    s_cselect_b32 s7, 4096, 0
    s_sub_u32 s63, s60, s7
    s_add_u32 s63, s63, 247808
    s_add_u32 s65, s63, 7168
    s_and_b32 s7, s3, 12
    s_cmp_eq_u32 s7, 4
    s_cselect_b32 s62, 0xff800000, 0
    s_cmp_ge_u32 s3, 4
    s_cbranch_scc1 AP_6
    s_barrier
AP_6:
    s_lshl_b32 s7, s3, 11
    s_add_u32 s7, s7, 0x0
    v_lshl_add_u32 v2, v1, 5, s7
    s_cmp_lt_u32 s3, 4
    s_cselect_b32 s7, 0x44, 0x40
    s_add_u32 s7, s7, 0x24000
    v_mov_b32 v3, s7
    v_mov_b32 v4, 1
    s_waitcnt vmcnt(0)
    v_perm_b32 v96, v132, v128, s92
    v_perm_b32 v97, v140, v136, s92
    v_perm_b32 v98, v148, v144, s92
    v_perm_b32 v99, v156, v152, s92
    v_perm_b32 v100, v132, v128, s93
    v_perm_b32 v101, v140, v136, s93
    v_perm_b32 v102, v148, v144, s93
    v_perm_b32 v103, v156, v152, s93
    v_perm_b32 v104, v133, v129, s92
    v_perm_b32 v105, v141, v137, s92
    v_perm_b32 v106, v149, v145, s92
    v_perm_b32 v107, v157, v153, s92
    v_perm_b32 v108, v133, v129, s93
    v_perm_b32 v109, v141, v137, s93
    v_perm_b32 v110, v149, v145, s93
    v_perm_b32 v111, v157, v153, s93
    v_perm_b32 v112, v134, v130, s92
    v_perm_b32 v113, v142, v138, s92
    v_perm_b32 v114, v150, v146, s92
    v_perm_b32 v115, v158, v154, s92
    v_perm_b32 v116, v134, v130, s93
    v_perm_b32 v117, v142, v138, s93
    v_perm_b32 v118, v150, v146, s93
    v_perm_b32 v119, v158, v154, s93
    v_perm_b32 v120, v135, v131, s92
    v_perm_b32 v121, v143, v139, s92
    v_perm_b32 v122, v151, v147, s92
    v_perm_b32 v123, v159, v155, s92
    v_perm_b32 v124, v135, v131, s93
    v_perm_b32 v125, v143, v139, s93
    v_perm_b32 v126, v151, v147, s93
    v_perm_b32 v127, v159, v155, s93
    v_mfma_f32_16x16x32_bf16 v[64:67], v[160:163], v[96:99], 0
    v_mfma_f32_16x16x32_bf16 v[68:71], v[160:163], v[100:103], 0
    v_mfma_f32_16x16x32_bf16 v[72:75], v[160:163], v[104:107], 0
    v_mfma_f32_16x16x32_bf16 v[76:79], v[160:163], v[108:111], 0
    v_mfma_f32_16x16x32_bf16 v[80:83], v[160:163], v[112:115], 0
    v_mfma_f32_16x16x32_bf16 v[84:87], v[160:163], v[116:119], 0
    v_mfma_f32_16x16x32_bf16 v[88:91], v[160:163], v[120:123], 0
    v_mfma_f32_16x16x32_bf16 v[92:95], v[160:163], v[124:127], 0
    s_nop 0
    v_mov_b32 v128, v64
    v_mov_b32 v129, v68
    v_mov_b32 v130, v72
    v_mov_b32 v131, v76
    v_mov_b32 v132, v80
    v_mov_b32 v133, v84
    v_mov_b32 v134, v88
    v_mov_b32 v135, v92
    ds_write_b128 v2, v[128:131]
    ds_write_b128 v2, v[132:135] offset:16
    s_waitcnt lgkmcnt(0)
    s_mov_b64 exec, 1
    ds_add_u32 v3, v4
    s_mov_b64 exec, -1
    s_branch AJ_4
AK_3:
    s_waitcnt lgkmcnt(0)
    s_mov_b32 s92, 0x05040100
    s_mov_b32 s93, 0x07060302
    s_mov_b32 s36, s34
    s_and_b32 s37, s35, 0xffff
    s_mov_b32 s38, 0x1000000
    s_mov_b32 s39, 0x20000
    s_mov_b32 s40, s32
    s_and_b32 s41, s33, 0xffff
    s_mov_b32 s42, 0x100
    s_mov_b32 s43, 0x20000
    s_mov_b32 s44, s10
    s_and_b32 s45, s11, 0xffff
    s_mov_b32 s46, 0x8000000
    s_mov_b32 s47, 0x20000
    s_mov_b32 s48, s12
    s_and_b32 s49, s13, 0xffff
    s_mov_b32 s50, 0x8000000
    s_mov_b32 s51, 0x20000
    s_lshr_b32 s7, s5, 2
    s_sub_u32 s7, s7, 4
    s_lshl_b32 s7, s7, 5
    s_add_u32 s7, s7, s6
    s_lshl_b32 s7, s7, 20
    s_add_u32 s7, s7, 0xC0000
    v_lshlrev_b32 v6, 4, v1
    v_add_u32 v6, s7, v6
    s_mov_b32 s64, 0x3e0293ee
    s_lshl_b32 s60, s3, 10
    s_mov_b32 s61, s60
    s_cmp_ge_u32 s3, 8
    s_cselect_b32 s7, 4096, 0
    s_sub_u32 s63, s60, s7
    s_add_u32 s63, s63, 247808
    s_add_u32 s65, s63, 7168
    s_and_b32 s7, s3, 12
    s_cmp_eq_u32 s7, 4
    s_cselect_b32 s62, 0xff800000, 0
    s_barrier
    s_cmp_eq_u32 s3, 8
    s_cbranch_scc1 LT_AR
LR_AR:
    s_cmp_eq_u32 s3, 9
    s_cbranch_scc1 LT_AR2
LR_AR2:
    s_sleep 26
AJ_4:
    s_branch L_AR
L_W2B:
    s_cmp_lg_u32 s3, 11
    s_cbranch_scc1 Z_62
    v_lshlrev_b32 v2, 2, v1
    v_add_u32 v2, 0x24000, v2
    v_mov_b32 v3, 0
    ds_write_b32 v2, v3
Z_62:
    s_waitcnt lgkmcnt(0)
    s_mov_b32 s92, 0x05040100
    s_mov_b32 s93, 0x07060302
    s_mov_b32 s36, s34
    s_and_b32 s37, s35, 0xffff
    s_mov_b32 s38, 0x1000000
    s_mov_b32 s39, 0x20000
    s_mov_b32 s40, s32
    s_and_b32 s41, s33, 0xffff
    s_mov_b32 s42, 0x100
    s_mov_b32 s43, 0x20000
    s_barrier
    s_mov_b32 m0, s71
    s_waitcnt vmcnt(7)
    buffer_load_dwordx4 v6, s[52:55], s70 offen nt lds
    s_addk_i32 s70, 8192
    s_addk_i32 s71, 1024
    s_mov_b32 m0, s71
    s_waitcnt vmcnt(7)
    buffer_load_dwordx4 v6, s[52:55], s70 offen nt lds
    s_addk_i32 s70, 8192
    s_addk_i32 s71, 1024
    s_mov_b32 m0, s71
    s_waitcnt vmcnt(7)
    buffer_load_dwordx4 v6, s[52:55], s70 offen nt lds
    s_addk_i32 s70, 8192
    s_addk_i32 s71, 1024
    s_mov_b32 m0, s71
    s_waitcnt vmcnt(7)
    buffer_load_dwordx4 v6, s[52:55], s70 offen nt lds
    s_addk_i32 s70, 8192
    s_addk_i32 s71, 1024
    s_mov_b32 m0, s71
    s_waitcnt vmcnt(7)
    buffer_load_dwordx4 v7, s[52:55], s70 offen nt lds
    s_addk_i32 s70, 8192
    s_addk_i32 s71, 1024
    s_mov_b32 m0, s71
    s_waitcnt vmcnt(7)
    buffer_load_dwordx4 v7, s[52:55], s70 offen nt lds
    s_addk_i32 s70, 8192
    s_addk_i32 s71, 1024
    s_mov_b32 m0, s71
    s_waitcnt vmcnt(7)
    buffer_load_dwordx4 v7, s[52:55], s70 offen nt lds
    s_addk_i32 s70, 8192
    s_addk_i32 s71, 1024
    s_mov_b32 m0, s71
    s_waitcnt vmcnt(7)
    buffer_load_dwordx4 v7, s[52:55], s70 offen nt lds
    s_addk_i32 s70, 8192
    s_addk_i32 s71, 1024
    s_branch L_W2R
L_CB:
    s_mov_b32 s92, 0x05040100
    s_mov_b32 s93, 0x07060302
    s_mov_b32 s36, s34
    s_and_b32 s37, s35, 0xffff
    s_mov_b32 s38, 0x1000000
    s_mov_b32 s39, 0x20000
    s_mov_b32 s40, s32
    s_and_b32 s41, s33, 0xffff
    s_mov_b32 s42, 0x100
    s_mov_b32 s43, 0x20000
    s_lshr_b32 s64, s3, 1
    s_and_b32 s65, s3, 1
    s_mov_b32 s67, 0x3e0293ee
    s_barrier
    s_addk_i32 s61, 8192
    s_mov_b32 m0, s68
    s_waitcnt vmcnt(3)
    buffer_load_dwordx4 v2, s[44:47], s61 offen nt lds
    s_addk_i32 s68, 8192
    s_addk_i32 s61, 8192
    s_mov_b32 m0, s68
    s_waitcnt vmcnt(3)
    buffer_load_dwordx4 v3, s[44:47], s61 offen nt lds
    s_addk_i32 s68, 8192
    s_addk_i32 s61, 8192
    s_mov_b32 m0, s68
    s_waitcnt vmcnt(3)
    buffer_load_dwordx4 v2, s[44:47], s61 offen nt lds
    s_addk_i32 s68, 8192
    s_addk_i32 s61, 8192
    s_mov_b32 m0, s68
    s_waitcnt vmcnt(3)
    buffer_load_dwordx4 v3, s[44:47], s61 offen nt lds
    s_addk_i32 s68, 8192
    s_addk_i32 s61, 8192
    s_mov_b32 m0, s68
    s_waitcnt vmcnt(3)
    buffer_load_dwordx4 v2, s[44:47], s61 offen nt lds
    s_addk_i32 s68, 8192
    s_addk_i32 s61, 8192
    s_mov_b32 m0, s68
    s_waitcnt vmcnt(3)
    buffer_load_dwordx4 v3, s[44:47], s61 offen nt lds
    s_addk_i32 s68, 8192
    s_addk_i32 s61, 8192
    s_mov_b32 m0, s68
    s_waitcnt vmcnt(3)
    buffer_load_dwordx4 v2, s[44:47], s61 offen nt lds
    s_addk_i32 s68, 8192
    s_addk_i32 s61, 8192
    s_mov_b32 m0, s68
    s_waitcnt vmcnt(3)
    buffer_load_dwordx4 v3, s[44:47], s61 offen nt lds
    s_addk_i32 s68, 8192
    s_addk_i32 s61, 8192
    s_waitcnt vmcnt(3)
    buffer_load_dwordx4 v[128:131], v2, s[44:47], s61 offen nt
    s_addk_i32 s61, 8192
    s_waitcnt vmcnt(3)
    buffer_load_dwordx4 v[132:135], v3, s[44:47], s61 offen nt
    s_addk_i32 s61, 8192
    s_waitcnt vmcnt(3)
    buffer_load_dwordx4 v[136:139], v2, s[44:47], s61 offen nt
    s_addk_i32 s61, 8192
    s_waitcnt vmcnt(3)
    buffer_load_dwordx4 v[140:143], v3, s[44:47], s61 offen nt
    s_addk_i32 s61, 8192
    s_waitcnt vmcnt(3)
    buffer_load_dwordx4 v[96:99], v2, s[44:47], s61 offen nt
    s_addk_i32 s61, 8192
    s_waitcnt vmcnt(3)
    buffer_load_dwordx4 v[100:103], v3, s[44:47], s61 offen nt
    s_addk_i32 s61, 8192
    s_waitcnt vmcnt(3)
    buffer_load_dwordx4 v[104:107], v2, s[44:47], s61 offen nt
    s_addk_i32 s61, 8192
    s_waitcnt vmcnt(3)
    buffer_load_dwordx4 v[108:111], v3, s[44:47], s61 offen nt
    s_addk_i32 s61, 8192
    s_waitcnt vmcnt(3)
    buffer_load_dwordx4 v[112:115], v2, s[44:47], s61 offen nt
    s_addk_i32 s61, 8192
    s_waitcnt vmcnt(3)
    buffer_load_dwordx4 v[116:119], v3, s[44:47], s61 offen nt
    s_addk_i32 s61, 8192
    v_mov_b32 v160, 0x24018
    v_mov_b32 v161, 1
    s_waitcnt lgkmcnt(0)
    s_mov_b64 exec, 1
    ds_add_u32 v160, v161
    s_mov_b64 exec, -1
    s_waitcnt vmcnt(3)
    buffer_load_dwordx4 v[120:123], v2, s[44:47], s61 offen nt
    s_addk_i32 s61, 8192
    s_waitcnt vmcnt(3)
    buffer_load_dwordx4 v[124:127], v3, s[44:47], s61 offen nt
    s_addk_i32 s61, 8192
    s_branch L_CR
L_END:
    s_endpgm
L_END0:
    s_endpgm
.p2align 12
LT_AR:
    s_branch LR_AR
L_AR:
    v_mov_b32 v32, 0
    v_mov_b32 v33, 0
    v_mov_b32 v34, 0
    v_mov_b32 v35, 0
    v_mov_b32 v36, 0
    v_mov_b32 v37, 0
    v_mov_b32 v38, 0
    v_mov_b32 v39, 0
    s_cmp_lg_u32 s62, 0
    s_cbranch_scc1 L_AK2
    buffer_load_dwordx4 v[32:35], v6, s[44:47], s63 offen nt
    buffer_load_dwordx4 v[36:39], v6, s[44:47], s65 offen nt
L_AK2:
    buffer_load_dwordx4 v[40:43], v6, s[44:47], s60 offen nt
    s_add_u32 s60, s60, 11264
    s_waitcnt vmcnt(2)
    buffer_load_dwordx4 v[44:47], v6, s[44:47], s60 offen nt
    s_add_u32 s60, s60, 11264
    s_waitcnt vmcnt(2)
    buffer_load_dwordx4 v[48:51], v6, s[44:47], s60 offen nt
    s_add_u32 s60, s60, 11264
    s_waitcnt vmcnt(2)
    buffer_load_dwordx4 v[52:55], v6, s[44:47], s60 offen nt
    s_add_u32 s60, s60, 11264
    s_waitcnt vmcnt(2)
    buffer_load_dwordx4 v[56:59], v6, s[44:47], s60 offen nt
    s_add_u32 s60, s60, 11264
    s_waitcnt vmcnt(2)
    buffer_load_dwordx4 v[60:63], v6, s[44:47], s60 offen nt
    s_add_u32 s60, s60, 11264
    s_waitcnt vmcnt(2)
    buffer_load_dwordx4 v[64:67], v6, s[44:47], s60 offen nt
    s_add_u32 s60, s60, 11264
    s_waitcnt vmcnt(2)
    buffer_load_dwordx4 v[68:71], v6, s[44:47], s60 offen nt
    s_add_u32 s60, s60, 11264
    s_waitcnt vmcnt(2)
    buffer_load_dwordx4 v[72:75], v6, s[44:47], s60 offen nt
    s_add_u32 s60, s60, 11264
    s_waitcnt vmcnt(2)
    buffer_load_dwordx4 v[76:79], v6, s[44:47], s60 offen nt
    s_add_u32 s60, s60, 11264
    s_waitcnt vmcnt(2)
    buffer_load_dwordx4 v[80:83], v6, s[44:47], s60 offen nt
    s_add_u32 s60, s60, 11264
    s_waitcnt vmcnt(2)
    buffer_load_dwordx4 v[84:87], v6, s[44:47], s60 offen nt
    s_add_u32 s60, s60, 11264
    s_waitcnt vmcnt(2)
    buffer_load_dwordx4 v[88:91], v6, s[44:47], s60 offen nt
    s_add_u32 s60, s60, 11264
    s_waitcnt vmcnt(2)
    buffer_load_dwordx4 v[92:95], v6, s[44:47], s60 offen nt
    s_add_u32 s60, s60, 11264
    v_mov_b32 v160, 0x24004
    s_mov_b32 s80, 1600000
LW_7:
    ds_read_b32 v161, v160
    s_waitcnt lgkmcnt(0)
    v_readfirstlane_b32 s79, v161
    s_cmp_ge_u32 s79, 1
    s_cbranch_scc1 LWD_8
    s_sleep 4
    s_sub_u32 s80, s80, 1
    s_cmp_lg_u32 s80, 0
    s_cbranch_scc1 LW_7
LWD_8:
    v_and_b32 v160, 15, v1
    v_lshlrev_b32 v160, 4, v160
    v_add_u32 v160, 0x24100, v160
    ds_read_b128 v[2:5], v160
    s_waitcnt lgkmcnt(0)
    v_dot2_f32_bf16 v8, v32, v2, 0
    v_dot2_f32_bf16 v9, v36, v2, 0
    v_dot2_f32_bf16 v10, v40, v2, 0
    v_dot2_f32_bf16 v11, v44, v2, 0
    v_dot2_f32_bf16 v8, v33, v3, v8
    v_dot2_f32_bf16 v9, v37, v3, v9
    v_dot2_f32_bf16 v10, v41, v3, v10
    v_dot2_f32_bf16 v11, v45, v3, v11
    v_dot2_f32_bf16 v8, v34, v4, v8
    v_dot2_f32_bf16 v9, v38, v4, v9
    v_dot2_f32_bf16 v10, v42, v4, v10
    v_dot2_f32_bf16 v11, v46, v4, v11
    v_dot2_f32_bf16 v8, v35, v5, v8
    v_dot2_f32_bf16 v9, v39, v5, v9
    v_dot2_f32_bf16 v10, v43, v5, v10
    v_dot2_f32_bf16 v11, v47, v5, v11
    v_add_f32_dpp v8, v8, v8 row_ror:8 row_mask:0xf bank_mask:0xf
    v_add_f32_dpp v9, v9, v9 row_ror:8 row_mask:0xf bank_mask:0xf
    v_add_f32_dpp v10, v10, v10 row_ror:8 row_mask:0xf bank_mask:0xf
    v_add_f32_dpp v11, v11, v11 row_ror:8 row_mask:0xf bank_mask:0xf
    v_add_f32_dpp v8, v8, v8 row_ror:4 row_mask:0xf bank_mask:0xf
    v_add_f32_dpp v9, v9, v9 row_ror:4 row_mask:0xf bank_mask:0xf
    v_add_f32_dpp v10, v10, v10 row_ror:4 row_mask:0xf bank_mask:0xf
    v_add_f32_dpp v11, v11, v11 row_ror:4 row_mask:0xf bank_mask:0xf
    v_add_f32_dpp v8, v8, v8 row_ror:2 row_mask:0xf bank_mask:0xf
    v_add_f32_dpp v9, v9, v9 row_ror:2 row_mask:0xf bank_mask:0xf
    v_add_f32_dpp v10, v10, v10 row_ror:2 row_mask:0xf bank_mask:0xf
    v_add_f32_dpp v11, v11, v11 row_ror:2 row_mask:0xf bank_mask:0xf
    v_add_f32_dpp v8, v8, v8 row_ror:1 row_mask:0xf bank_mask:0xf
    v_add_f32_dpp v9, v9, v9 row_ror:1 row_mask:0xf bank_mask:0xf
    v_add_f32_dpp v10, v10, v10 row_ror:1 row_mask:0xf bank_mask:0xf
    v_add_f32_dpp v11, v11, v11 row_ror:1 row_mask:0xf bank_mask:0xf
    s_waitcnt vmcnt(2)
    buffer_load_dwordx4 v[96:99], v6, s[44:47], s60 offen nt
    s_add_u32 s60, s60, 11264
    s_waitcnt vmcnt(2)
    buffer_load_dwordx4 v[100:103], v6, s[44:47], s60 offen nt
    s_add_u32 s60, s60, 11264
    v_dot2_f32_bf16 v12, v48, v2, 0
    v_dot2_f32_bf16 v13, v52, v2, 0
    v_dot2_f32_bf16 v14, v56, v2, 0
    v_dot2_f32_bf16 v15, v60, v2, 0
    v_dot2_f32_bf16 v12, v49, v3, v12
    v_dot2_f32_bf16 v13, v53, v3, v13
    v_dot2_f32_bf16 v14, v57, v3, v14
    v_dot2_f32_bf16 v15, v61, v3, v15
    v_dot2_f32_bf16 v12, v50, v4, v12
    v_dot2_f32_bf16 v13, v54, v4, v13
    v_dot2_f32_bf16 v14, v58, v4, v14
    v_dot2_f32_bf16 v15, v62, v4, v15
    v_dot2_f32_bf16 v12, v51, v5, v12
    v_dot2_f32_bf16 v13, v55, v5, v13
    v_dot2_f32_bf16 v14, v59, v5, v14
    v_dot2_f32_bf16 v15, v63, v5, v15
    v_add_f32_dpp v12, v12, v12 row_ror:8 row_mask:0xf bank_mask:0xf
    v_add_f32_dpp v13, v13, v13 row_ror:8 row_mask:0xf bank_mask:0xf
    v_add_f32_dpp v14, v14, v14 row_ror:8 row_mask:0xf bank_mask:0xf
    v_add_f32_dpp v15, v15, v15 row_ror:8 row_mask:0xf bank_mask:0xf
    v_add_f32_dpp v12, v12, v12 row_ror:4 row_mask:0xf bank_mask:0xf
    v_add_f32_dpp v13, v13, v13 row_ror:4 row_mask:0xf bank_mask:0xf
    v_add_f32_dpp v14, v14, v14 row_ror:4 row_mask:0xf bank_mask:0xf
    v_add_f32_dpp v15, v15, v15 row_ror:4 row_mask:0xf bank_mask:0xf
    v_add_f32_dpp v12, v12, v12 row_ror:2 row_mask:0xf bank_mask:0xf
    v_add_f32_dpp v13, v13, v13 row_ror:2 row_mask:0xf bank_mask:0xf
    v_add_f32_dpp v14, v14, v14 row_ror:2 row_mask:0xf bank_mask:0xf
    v_add_f32_dpp v15, v15, v15 row_ror:2 row_mask:0xf bank_mask:0xf
    v_add_f32_dpp v12, v12, v12 row_ror:1 row_mask:0xf bank_mask:0xf
    v_add_f32_dpp v13, v13, v13 row_ror:1 row_mask:0xf bank_mask:0xf
    v_add_f32_dpp v14, v14, v14 row_ror:1 row_mask:0xf bank_mask:0xf
    v_add_f32_dpp v15, v15, v15 row_ror:1 row_mask:0xf bank_mask:0xf
    s_waitcnt vmcnt(2)
    buffer_load_dwordx4 v[104:107], v6, s[44:47], s60 offen nt
    s_add_u32 s60, s60, 11264
    s_waitcnt vmcnt(2)
    buffer_load_dwordx4 v[108:111], v6, s[44:47], s60 offen nt
    s_add_u32 s60, s60, 11264
    v_dot2_f32_bf16 v16, v64, v2, 0
    v_dot2_f32_bf16 v17, v68, v2, 0
    v_dot2_f32_bf16 v18, v72, v2, 0
    v_dot2_f32_bf16 v19, v76, v2, 0
    v_dot2_f32_bf16 v16, v65, v3, v16
    v_dot2_f32_bf16 v17, v69, v3, v17
    v_dot2_f32_bf16 v18, v73, v3, v18
    v_dot2_f32_bf16 v19, v77, v3, v19
    v_dot2_f32_bf16 v16, v66, v4, v16
    v_dot2_f32_bf16 v17, v70, v4, v17
    v_dot2_f32_bf16 v18, v74, v4, v18
    v_dot2_f32_bf16 v19, v78, v4, v19
    v_dot2_f32_bf16 v16, v67, v5, v16
    v_dot2_f32_bf16 v17, v71, v5, v17
    v_dot2_f32_bf16 v18, v75, v5, v18
    v_dot2_f32_bf16 v19, v79, v5, v19
    v_add_f32_dpp v16, v16, v16 row_ror:8 row_mask:0xf bank_mask:0xf
    v_add_f32_dpp v17, v17, v17 row_ror:8 row_mask:0xf bank_mask:0xf
    v_add_f32_dpp v18, v18, v18 row_ror:8 row_mask:0xf bank_mask:0xf
    v_add_f32_dpp v19, v19, v19 row_ror:8 row_mask:0xf bank_mask:0xf
    v_add_f32_dpp v16, v16, v16 row_ror:4 row_mask:0xf bank_mask:0xf
    v_add_f32_dpp v17, v17, v17 row_ror:4 row_mask:0xf bank_mask:0xf
    v_add_f32_dpp v18, v18, v18 row_ror:4 row_mask:0xf bank_mask:0xf
    v_add_f32_dpp v19, v19, v19 row_ror:4 row_mask:0xf bank_mask:0xf
    v_add_f32_dpp v16, v16, v16 row_ror:2 row_mask:0xf bank_mask:0xf
    v_add_f32_dpp v17, v17, v17 row_ror:2 row_mask:0xf bank_mask:0xf
    v_add_f32_dpp v18, v18, v18 row_ror:2 row_mask:0xf bank_mask:0xf
    v_add_f32_dpp v19, v19, v19 row_ror:2 row_mask:0xf bank_mask:0xf
    v_add_f32_dpp v16, v16, v16 row_ror:1 row_mask:0xf bank_mask:0xf
    v_add_f32_dpp v17, v17, v17 row_ror:1 row_mask:0xf bank_mask:0xf
    v_add_f32_dpp v18, v18, v18 row_ror:1 row_mask:0xf bank_mask:0xf
    v_add_f32_dpp v19, v19, v19 row_ror:1 row_mask:0xf bank_mask:0xf
    s_waitcnt vmcnt(2)
    buffer_load_dwordx4 v[112:115], v6, s[44:47], s60 offen nt
    s_add_u32 s60, s60, 11264
    s_waitcnt vmcnt(2)
    buffer_load_dwordx4 v[116:119], v6, s[44:47], s60 offen nt
    s_add_u32 s60, s60, 11264
    v_dot2_f32_bf16 v20, v80, v2, 0
    v_dot2_f32_bf16 v21, v84, v2, 0
    v_dot2_f32_bf16 v22, v88, v2, 0
    v_dot2_f32_bf16 v23, v92, v2, 0
    v_dot2_f32_bf16 v20, v81, v3, v20
    v_dot2_f32_bf16 v21, v85, v3, v21
    v_dot2_f32_bf16 v22, v89, v3, v22
    v_dot2_f32_bf16 v23, v93, v3, v23
    v_dot2_f32_bf16 v20, v82, v4, v20
    v_dot2_f32_bf16 v21, v86, v4, v21
    v_dot2_f32_bf16 v22, v90, v4, v22
    v_dot2_f32_bf16 v23, v94, v4, v23
    v_dot2_f32_bf16 v20, v83, v5, v20
    v_dot2_f32_bf16 v21, v87, v5, v21
    v_dot2_f32_bf16 v22, v91, v5, v22
    v_dot2_f32_bf16 v23, v95, v5, v23
    v_add_f32_dpp v20, v20, v20 row_ror:8 row_mask:0xf bank_mask:0xf
    v_add_f32_dpp v21, v21, v21 row_ror:8 row_mask:0xf bank_mask:0xf
    v_add_f32_dpp v22, v22, v22 row_ror:8 row_mask:0xf bank_mask:0xf
    v_add_f32_dpp v23, v23, v23 row_ror:8 row_mask:0xf bank_mask:0xf
    v_add_f32_dpp v20, v20, v20 row_ror:4 row_mask:0xf bank_mask:0xf
    v_add_f32_dpp v21, v21, v21 row_ror:4 row_mask:0xf bank_mask:0xf
    v_add_f32_dpp v22, v22, v22 row_ror:4 row_mask:0xf bank_mask:0xf
    v_add_f32_dpp v23, v23, v23 row_ror:4 row_mask:0xf bank_mask:0xf
    v_add_f32_dpp v20, v20, v20 row_ror:2 row_mask:0xf bank_mask:0xf
    v_add_f32_dpp v21, v21, v21 row_ror:2 row_mask:0xf bank_mask:0xf
    v_add_f32_dpp v22, v22, v22 row_ror:2 row_mask:0xf bank_mask:0xf
    v_add_f32_dpp v23, v23, v23 row_ror:2 row_mask:0xf bank_mask:0xf
    v_add_f32_dpp v20, v20, v20 row_ror:1 row_mask:0xf bank_mask:0xf
    v_add_f32_dpp v21, v21, v21 row_ror:1 row_mask:0xf bank_mask:0xf
    v_add_f32_dpp v22, v22, v22 row_ror:1 row_mask:0xf bank_mask:0xf
    v_add_f32_dpp v23, v23, v23 row_ror:1 row_mask:0xf bank_mask:0xf
    s_waitcnt vmcnt(2)
    buffer_load_dwordx4 v[120:123], v6, s[44:47], s60 offen nt
    s_add_u32 s60, s60, 11264
    s_waitcnt vmcnt(2)
    buffer_load_dwordx4 v[124:127], v6, s[44:47], s60 offen nt
    v_dot2_f32_bf16 v24, v96, v2, 0
    v_dot2_f32_bf16 v25, v100, v2, 0
    v_dot2_f32_bf16 v26, v104, v2, 0
    v_dot2_f32_bf16 v27, v108, v2, 0
    v_dot2_f32_bf16 v24, v97, v3, v24
    v_dot2_f32_bf16 v25, v101, v3, v25
    v_dot2_f32_bf16 v26, v105, v3, v26
    v_dot2_f32_bf16 v27, v109, v3, v27
    v_dot2_f32_bf16 v24, v98, v4, v24
    v_dot2_f32_bf16 v25, v102, v4, v25
    v_dot2_f32_bf16 v26, v106, v4, v26
    v_dot2_f32_bf16 v27, v110, v4, v27
    v_dot2_f32_bf16 v24, v99, v5, v24
    v_dot2_f32_bf16 v25, v103, v5, v25
    v_dot2_f32_bf16 v26, v107, v5, v26
    v_dot2_f32_bf16 v27, v111, v5, v27
    v_add_f32_dpp v24, v24, v24 row_ror:8 row_mask:0xf bank_mask:0xf
    v_add_f32_dpp v25, v25, v25 row_ror:8 row_mask:0xf bank_mask:0xf
    v_add_f32_dpp v26, v26, v26 row_ror:8 row_mask:0xf bank_mask:0xf
    v_add_f32_dpp v27, v27, v27 row_ror:8 row_mask:0xf bank_mask:0xf
    v_add_f32_dpp v24, v24, v24 row_ror:4 row_mask:0xf bank_mask:0xf
    v_add_f32_dpp v25, v25, v25 row_ror:4 row_mask:0xf bank_mask:0xf
    v_add_f32_dpp v26, v26, v26 row_ror:4 row_mask:0xf bank_mask:0xf
    v_add_f32_dpp v27, v27, v27 row_ror:4 row_mask:0xf bank_mask:0xf
    v_add_f32_dpp v24, v24, v24 row_ror:2 row_mask:0xf bank_mask:0xf
    v_add_f32_dpp v25, v25, v25 row_ror:2 row_mask:0xf bank_mask:0xf
    v_add_f32_dpp v26, v26, v26 row_ror:2 row_mask:0xf bank_mask:0xf
    v_add_f32_dpp v27, v27, v27 row_ror:2 row_mask:0xf bank_mask:0xf
    v_add_f32_dpp v24, v24, v24 row_ror:1 row_mask:0xf bank_mask:0xf
    v_add_f32_dpp v25, v25, v25 row_ror:1 row_mask:0xf bank_mask:0xf
    v_add_f32_dpp v26, v26, v26 row_ror:1 row_mask:0xf bank_mask:0xf
    v_add_f32_dpp v27, v27, v27 row_ror:1 row_mask:0xf bank_mask:0xf
    s_waitcnt vmcnt(2)
    buffer_load_dwordx4 v[128:131], v6, s[48:51], s61 offen nt
    s_add_u32 s61, s61, 11264
    s_waitcnt vmcnt(2)
    buffer_load_dwordx4 v[132:135], v6, s[48:51], s61 offen nt
    s_add_u32 s61, s61, 11264
    s_waitcnt vmcnt(2)
    buffer_load_dwordx4 v[136:139], v6, s[48:51], s61 offen nt
    s_add_u32 s61, s61, 11264
    v_dot2_f32_bf16 v28, v112, v2, 0
    v_dot2_f32_bf16 v29, v116, v2, 0
    v_dot2_f32_bf16 v30, v120, v2, 0
    v_dot2_f32_bf16 v31, v124, v2, 0
    v_dot2_f32_bf16 v28, v113, v3, v28
    v_dot2_f32_bf16 v29, v117, v3, v29
    v_dot2_f32_bf16 v30, v121, v3, v30
    v_dot2_f32_bf16 v31, v125, v3, v31
    v_dot2_f32_bf16 v28, v114, v4, v28
    v_dot2_f32_bf16 v29, v118, v4, v29
    v_dot2_f32_bf16 v30, v122, v4, v30
    v_dot2_f32_bf16 v31, v126, v4, v31
    v_dot2_f32_bf16 v28, v115, v5, v28
    v_dot2_f32_bf16 v29, v119, v5, v29
    v_dot2_f32_bf16 v30, v123, v5, v30
    v_dot2_f32_bf16 v31, v127, v5, v31
    v_add_f32_dpp v28, v28, v28 row_ror:8 row_mask:0xf bank_mask:0xf
    v_add_f32_dpp v29, v29, v29 row_ror:8 row_mask:0xf bank_mask:0xf
    v_add_f32_dpp v30, v30, v30 row_ror:8 row_mask:0xf bank_mask:0xf
    v_add_f32_dpp v31, v31, v31 row_ror:8 row_mask:0xf bank_mask:0xf
    v_add_f32_dpp v28, v28, v28 row_ror:4 row_mask:0xf bank_mask:0xf
    v_add_f32_dpp v29, v29, v29 row_ror:4 row_mask:0xf bank_mask:0xf
    v_add_f32_dpp v30, v30, v30 row_ror:4 row_mask:0xf bank_mask:0xf
    v_add_f32_dpp v31, v31, v31 row_ror:4 row_mask:0xf bank_mask:0xf
    v_add_f32_dpp v28, v28, v28 row_ror:2 row_mask:0xf bank_mask:0xf
    v_add_f32_dpp v29, v29, v29 row_ror:2 row_mask:0xf bank_mask:0xf
    v_add_f32_dpp v30, v30, v30 row_ror:2 row_mask:0xf bank_mask:0xf
    v_add_f32_dpp v31, v31, v31 row_ror:2 row_mask:0xf bank_mask:0xf
    v_add_f32_dpp v28, v28, v28 row_ror:1 row_mask:0xf bank_mask:0xf
    v_add_f32_dpp v29, v29, v29 row_ror:1 row_mask:0xf bank_mask:0xf
    v_add_f32_dpp v30, v30, v30 row_ror:1 row_mask:0xf bank_mask:0xf
    v_add_f32_dpp v31, v31, v31 row_ror:1 row_mask:0xf bank_mask:0xf
    s_waitcnt vmcnt(2)
    buffer_load_dwordx4 v[140:143], v6, s[48:51], s61 offen nt
    s_add_u32 s61, s61, 11264
    s_waitcnt vmcnt(2)
    buffer_load_dwordx4 v[144:147], v6, s[48:51], s61 offen nt
    s_add_u32 s61, s61, 11264
    v_add_f32 v8, s62, v8
    v_add_f32 v9, s62, v9
    v_max3_f32 v160, v8, v9, v10
    v_max3_f32 v160, v160, v11, v12
    v_max3_f32 v160, v160, v13, v14
    v_max3_f32 v160, v160, v15, v16
    v_max3_f32 v160, v160, v17, v18
    v_max3_f32 v160, v160, v19, v20
    v_max3_f32 v160, v160, v21, v22
    v_max3_f32 v160, v160, v23, v24
    v_max3_f32 v160, v160, v25, v26
    v_max3_f32 v160, v160, v27, v28
    v_max3_f32 v160, v160, v29, v30
    v_max_f32 v160, v160, v31
    v_mov_b32 v161, v160
    s_nop 1
    v_permlane32_swap_b32 v160, v161
    v_max_f32 v160, v160, v161
    v_mov_b32 v161, v160
    s_nop 1
    v_permlane16_swap_b32 v160, v161
    v_max_f32 v160, v160, v161
    v_mul_f32 v160, s64, v160
    v_fma_f32 v8, v8, s64, -v160
    v_fma_f32 v9, v9, s64, -v160
    v_fma_f32 v10, v10, s64, -v160
    v_fma_f32 v11, v11, s64, -v160
    v_fma_f32 v12, v12, s64, -v160
    v_fma_f32 v13, v13, s64, -v160
    v_fma_f32 v14, v14, s64, -v160
    v_fma_f32 v15, v15, s64, -v160
    v_fma_f32 v16, v16, s64, -v160
    v_fma_f32 v17, v17, s64, -v160
    v_fma_f32 v18, v18, s64, -v160
    v_fma_f32 v19, v19, s64, -v160
    v_fma_f32 v20, v20, s64, -v160
    v_fma_f32 v21, v21, s64, -v160
    v_fma_f32 v22, v22, s64, -v160
    v_fma_f32 v23, v23, s64, -v160
    v_fma_f32 v24, v24, s64, -v160
    v_fma_f32 v25, v25, s64, -v160
    v_fma_f32 v26, v26, s64, -v160
    v_fma_f32 v27, v27, s64, -v160
    v_fma_f32 v28, v28, s64, -v160
    v_fma_f32 v29, v29, s64, -v160
    v_fma_f32 v30, v30, s64, -v160
    v_fma_f32 v31, v31, s64, -v160
    v_exp_f32 v8, v8
    v_exp_f32 v9, v9
    v_exp_f32 v10, v10
    v_exp_f32 v11, v11
    v_exp_f32 v12, v12
    v_exp_f32 v13, v13
    v_exp_f32 v14, v14
    v_exp_f32 v15, v15
    v_exp_f32 v16, v16
    v_exp_f32 v17, v17
    v_exp_f32 v18, v18
    v_exp_f32 v19, v19
    v_exp_f32 v20, v20
    v_exp_f32 v21, v21
    v_exp_f32 v22, v22
    v_exp_f32 v23, v23
    v_exp_f32 v24, v24
    v_exp_f32 v25, v25
    v_exp_f32 v26, v26
    v_exp_f32 v27, v27
    v_exp_f32 v28, v28
    v_exp_f32 v29, v29
    v_exp_f32 v30, v30
    v_exp_f32 v31, v31
    s_waitcnt vmcnt(2)
    buffer_load_dwordx4 v[148:151], v6, s[48:51], s61 offen nt
    s_add_u32 s61, s61, 11264
    v_add_f32 v162, v8, v9
    v_add_f32 v163, v10, v11
    v_add_f32 v162, v162, v12
    v_add_f32 v163, v163, v13
    v_add_f32 v162, v162, v14
    v_add_f32 v163, v163, v15
    v_add_f32 v162, v162, v16
    v_add_f32 v163, v163, v17
    v_add_f32 v162, v162, v18
    v_add_f32 v163, v163, v19
    v_add_f32 v162, v162, v20
    v_add_f32 v163, v163, v21
    v_add_f32 v162, v162, v22
    v_add_f32 v163, v163, v23
    v_add_f32 v162, v162, v24
    v_add_f32 v163, v163, v25
    v_add_f32 v162, v162, v26
    v_add_f32 v163, v163, v27
    v_add_f32 v162, v162, v28
    v_add_f32 v163, v163, v29
    v_add_f32 v162, v162, v30
    v_add_f32 v163, v163, v31
    v_add_f32 v162, v162, v163
    v_mov_b32 v163, v162
    s_nop 1
    v_permlane32_swap_b32 v162, v163
    v_add_f32 v162, v162, v163
    v_mov_b32 v163, v162
    s_nop 1
    v_permlane16_swap_b32 v162, v163
    v_add_f32 v161, v162, v163
    s_lshl_b32 s7, s3, 3
    s_add_u32 s7, s7, 0x24200
    v_mov_b32 v164, s7
    ds_write_b64 v164, v[160:161]
    v_mov_b32 v164, 0x24008
    v_mov_b32 v165, 1
    s_waitcnt lgkmcnt(0)
    s_mov_b64 exec, 1
    ds_add_u32 v164, v165
    s_mov_b64 exec, -1
    v_and_b32 v2, 15, v1
    v_lshlrev_b32 v2, 5, v2
    v_bfe_u32 v3, v1, 5, 1
    v_lshl_add_u32 v2, v3, 4, v2
    v_bfe_u32 v3, v1, 4, 1
    v_lshl_add_u32 v2, v3, 3, v2
    s_lshl_b32 s7, s3, 9
    s_add_u32 s7, s7, 0x10000
    v_add_u32 v2, s7, v2
    s_waitcnt vmcnt(2)
    buffer_load_dwordx4 v[32:35], v6, s[48:51], s61 offen nt
    s_add_u32 s61, s61, 11264
    v_lshlrev_b32 v160, 16, v128
    v_and_b32 v161, 0xffff0000, v128
    v_lshlrev_b32 v162, 16, v129
    v_and_b32 v163, 0xffff0000, v129
    v_lshlrev_b32 v164, 16, v130
    v_and_b32 v165, 0xffff0000, v130
    v_lshlrev_b32 v166, 16, v131
    v_and_b32 v167, 0xffff0000, v131
    v_pk_mul_f32 v[152:153], v[160:161], v[10:11] op_sel_hi:[1,0]
    v_pk_mul_f32 v[154:155], v[162:163], v[10:11] op_sel_hi:[1,0]
    v_pk_mul_f32 v[156:157], v[164:165], v[10:11] op_sel_hi:[1,0]
    v_pk_mul_f32 v[158:159], v[166:167], v[10:11] op_sel_hi:[1,0]
    v_lshlrev_b32 v160, 16, v132
    v_and_b32 v161, 0xffff0000, v132
    v_lshlrev_b32 v162, 16, v133
    v_and_b32 v163, 0xffff0000, v133
    v_lshlrev_b32 v164, 16, v134
    v_and_b32 v165, 0xffff0000, v134
    v_lshlrev_b32 v166, 16, v135
    v_and_b32 v167, 0xffff0000, v135
    v_pk_fma_f32 v[152:153], v[160:161], v[10:11], v[152:153] op_sel:[0,1,0] op_sel_hi:[1,1,1]
    v_pk_fma_f32 v[154:155], v[162:163], v[10:11], v[154:155] op_sel:[0,1,0] op_sel_hi:[1,1,1]
    v_pk_fma_f32 v[156:157], v[164:165], v[10:11], v[156:157] op_sel:[0,1,0] op_sel_hi:[1,1,1]
    v_pk_fma_f32 v[158:159], v[166:167], v[10:11], v[158:159] op_sel:[0,1,0] op_sel_hi:[1,1,1]
    s_waitcnt vmcnt(2)
    buffer_load_dwordx4 v[36:39], v6, s[48:51], s61 offen nt
    s_add_u32 s61, s61, 11264
    v_lshlrev_b32 v160, 16, v136
    v_and_b32 v161, 0xffff0000, v136
    v_lshlrev_b32 v162, 16, v137
    v_and_b32 v163, 0xffff0000, v137
    v_lshlrev_b32 v164, 16, v138
    v_and_b32 v165, 0xffff0000, v138
    v_lshlrev_b32 v166, 16, v139
    v_and_b32 v167, 0xffff0000, v139
    v_pk_fma_f32 v[152:153], v[160:161], v[12:13], v[152:153] op_sel_hi:[1,0,1]
    v_pk_fma_f32 v[154:155], v[162:163], v[12:13], v[154:155] op_sel_hi:[1,0,1]
    v_pk_fma_f32 v[156:157], v[164:165], v[12:13], v[156:157] op_sel_hi:[1,0,1]
    v_pk_fma_f32 v[158:159], v[166:167], v[12:13], v[158:159] op_sel_hi:[1,0,1]
    v_lshlrev_b32 v160, 16, v140
    v_and_b32 v161, 0xffff0000, v140
    v_lshlrev_b32 v162, 16, v141
    v_and_b32 v163, 0xffff0000, v141
    v_lshlrev_b32 v164, 16, v142
    v_and_b32 v165, 0xffff0000, v142
    v_lshlrev_b32 v166, 16, v143
    v_and_b32 v167, 0xffff0000, v143
    v_pk_fma_f32 v[152:153], v[160:161], v[12:13], v[152:153] op_sel:[0,1,0] op_sel_hi:[1,1,1]
    v_pk_fma_f32 v[154:155], v[162:163], v[12:13], v[154:155] op_sel:[0,1,0] op_sel_hi:[1,1,1]
    v_pk_fma_f32 v[156:157], v[164:165], v[12:13], v[156:157] op_sel:[0,1,0] op_sel_hi:[1,1,1]
    v_pk_fma_f32 v[158:159], v[166:167], v[12:13], v[158:159] op_sel:[0,1,0] op_sel_hi:[1,1,1]
    s_waitcnt vmcnt(2)
    buffer_load_dwordx4 v[40:43], v6, s[48:51], s61 offen nt
    s_add_u32 s61, s61, 11264
    v_lshlrev_b32 v160, 16, v144
    v_and_b32 v161, 0xffff0000, v144
    v_lshlrev_b32 v162, 16, v145
    v_and_b32 v163, 0xffff0000, v145
    v_lshlrev_b32 v164, 16, v146
    v_and_b32 v165, 0xffff0000, v146
    v_lshlrev_b32 v166, 16, v147
    v_and_b32 v167, 0xffff0000, v147
    v_pk_fma_f32 v[152:153], v[160:161], v[14:15], v[152:153] op_sel_hi:[1,0,1]
    v_pk_fma_f32 v[154:155], v[162:163], v[14:15], v[154:155] op_sel_hi:[1,0,1]
    v_pk_fma_f32 v[156:157], v[164:165], v[14:15], v[156:157] op_sel_hi:[1,0,1]
    v_pk_fma_f32 v[158:159], v[166:167], v[14:15], v[158:159] op_sel_hi:[1,0,1]
    v_lshlrev_b32 v160, 16, v148
    v_and_b32 v161, 0xffff0000, v148
    v_lshlrev_b32 v162, 16, v149
    v_and_b32 v163, 0xffff0000, v149
    v_lshlrev_b32 v164, 16, v150
    v_and_b32 v165, 0xffff0000, v150
    v_lshlrev_b32 v166, 16, v151
    v_and_b32 v167, 0xffff0000, v151
    v_pk_fma_f32 v[152:153], v[160:161], v[14:15], v[152:153] op_sel:[0,1,0] op_sel_hi:[1,1,1]
    v_pk_fma_f32 v[154:155], v[162:163], v[14:15], v[154:155] op_sel:[0,1,0] op_sel_hi:[1,1,1]
    v_pk_fma_f32 v[156:157], v[164:165], v[14:15], v[156:157] op_sel:[0,1,0] op_sel_hi:[1,1,1]
    v_pk_fma_f32 v[158:159], v[166:167], v[14:15], v[158:159] op_sel:[0,1,0] op_sel_hi:[1,1,1]
    s_waitcnt vmcnt(2)
    buffer_load_dwordx4 v[44:47], v6, s[48:51], s61 offen nt
    s_add_u32 s61, s61, 11264
    v_lshlrev_b32 v160, 16, v32
    v_and_b32 v161, 0xffff0000, v32
    v_lshlrev_b32 v162, 16, v33
    v_and_b32 v163, 0xffff0000, v33
    v_lshlrev_b32 v164, 16, v34
    v_and_b32 v165, 0xffff0000, v34
    v_lshlrev_b32 v166, 16, v35
    v_and_b32 v167, 0xffff0000, v35
    v_pk_fma_f32 v[152:153], v[160:161], v[16:17], v[152:153] op_sel_hi:[1,0,1]
    v_pk_fma_f32 v[154:155], v[162:163], v[16:17], v[154:155] op_sel_hi:[1,0,1]
    v_pk_fma_f32 v[156:157], v[164:165], v[16:17], v[156:157] op_sel_hi:[1,0,1]
    v_pk_fma_f32 v[158:159], v[166:167], v[16:17], v[158:159] op_sel_hi:[1,0,1]
    s_waitcnt vmcnt(2)
    buffer_load_dwordx4 v[48:51], v6, s[48:51], s61 offen nt
    s_add_u32 s61, s61, 11264
    v_lshlrev_b32 v160, 16, v36
    v_and_b32 v161, 0xffff0000, v36
    v_lshlrev_b32 v162, 16, v37
    v_and_b32 v163, 0xffff0000, v37
    v_lshlrev_b32 v164, 16, v38
    v_and_b32 v165, 0xffff0000, v38
    v_lshlrev_b32 v166, 16, v39
    v_and_b32 v167, 0xffff0000, v39
    v_pk_fma_f32 v[152:153], v[160:161], v[16:17], v[152:153] op_sel:[0,1,0] op_sel_hi:[1,1,1]
    v_pk_fma_f32 v[154:155], v[162:163], v[16:17], v[154:155] op_sel:[0,1,0] op_sel_hi:[1,1,1]
    v_pk_fma_f32 v[156:157], v[164:165], v[16:17], v[156:157] op_sel:[0,1,0] op_sel_hi:[1,1,1]
    v_pk_fma_f32 v[158:159], v[166:167], v[16:17], v[158:159] op_sel:[0,1,0] op_sel_hi:[1,1,1]
    s_waitcnt vmcnt(2)
    buffer_load_dwordx4 v[52:55], v6, s[48:51], s61 offen nt
    s_add_u32 s61, s61, 11264
    v_lshlrev_b32 v160, 16, v40
    v_and_b32 v161, 0xffff0000, v40
    v_lshlrev_b32 v162, 16, v41
    v_and_b32 v163, 0xffff0000, v41
    v_lshlrev_b32 v164, 16, v42
    v_and_b32 v165, 0xffff0000, v42
    v_lshlrev_b32 v166, 16, v43
    v_and_b32 v167, 0xffff0000, v43
    v_pk_fma_f32 v[152:153], v[160:161], v[18:19], v[152:153] op_sel_hi:[1,0,1]
    v_pk_fma_f32 v[154:155], v[162:163], v[18:19], v[154:155] op_sel_hi:[1,0,1]
    v_pk_fma_f32 v[156:157], v[164:165], v[18:19], v[156:157] op_sel_hi:[1,0,1]
    v_pk_fma_f32 v[158:159], v[166:167], v[18:19], v[158:159] op_sel_hi:[1,0,1]
    s_waitcnt vmcnt(2)
    buffer_load_dwordx4 v[56:59], v6, s[48:51], s61 offen nt
    s_add_u32 s61, s61, 11264
    v_lshlrev_b32 v160, 16, v44
    v_and_b32 v161, 0xffff0000, v44
    v_lshlrev_b32 v162, 16, v45
    v_and_b32 v163, 0xffff0000, v45
    v_lshlrev_b32 v164, 16, v46
    v_and_b32 v165, 0xffff0000, v46
    v_lshlrev_b32 v166, 16, v47
    v_and_b32 v167, 0xffff0000, v47
    v_pk_fma_f32 v[152:153], v[160:161], v[18:19], v[152:153] op_sel:[0,1,0] op_sel_hi:[1,1,1]
    v_pk_fma_f32 v[154:155], v[162:163], v[18:19], v[154:155] op_sel:[0,1,0] op_sel_hi:[1,1,1]
    v_pk_fma_f32 v[156:157], v[164:165], v[18:19], v[156:157] op_sel:[0,1,0] op_sel_hi:[1,1,1]
    v_pk_fma_f32 v[158:159], v[166:167], v[18:19], v[158:159] op_sel:[0,1,0] op_sel_hi:[1,1,1]
    s_waitcnt vmcnt(2)
    buffer_load_dwordx4 v[60:63], v6, s[48:51], s61 offen nt
    s_add_u32 s61, s61, 11264
    v_lshlrev_b32 v160, 16, v48
    v_and_b32 v161, 0xffff0000, v48
    v_lshlrev_b32 v162, 16, v49
    v_and_b32 v163, 0xffff0000, v49
    v_lshlrev_b32 v164, 16, v50
    v_and_b32 v165, 0xffff0000, v50
    v_lshlrev_b32 v166, 16, v51
    v_and_b32 v167, 0xffff0000, v51
    v_pk_fma_f32 v[152:153], v[160:161], v[20:21], v[152:153] op_sel_hi:[1,0,1]
    v_pk_fma_f32 v[154:155], v[162:163], v[20:21], v[154:155] op_sel_hi:[1,0,1]
    v_pk_fma_f32 v[156:157], v[164:165], v[20:21], v[156:157] op_sel_hi:[1,0,1]
    v_pk_fma_f32 v[158:159], v[166:167], v[20:21], v[158:159] op_sel_hi:[1,0,1]
    s_waitcnt vmcnt(2)
    buffer_load_dwordx4 v[64:67], v6, s[48:51], s61 offen nt
    s_add_u32 s61, s61, 11264
    v_lshlrev_b32 v160, 16, v52
    v_and_b32 v161, 0xffff0000, v52
    v_lshlrev_b32 v162, 16, v53
    v_and_b32 v163, 0xffff0000, v53
    v_lshlrev_b32 v164, 16, v54
    v_and_b32 v165, 0xffff0000, v54
    v_lshlrev_b32 v166, 16, v55
    v_and_b32 v167, 0xffff0000, v55
    v_pk_fma_f32 v[152:153], v[160:161], v[20:21], v[152:153] op_sel:[0,1,0] op_sel_hi:[1,1,1]
    v_pk_fma_f32 v[154:155], v[162:163], v[20:21], v[154:155] op_sel:[0,1,0] op_sel_hi:[1,1,1]
    v_pk_fma_f32 v[156:157], v[164:165], v[20:21], v[156:157] op_sel:[0,1,0] op_sel_hi:[1,1,1]
    v_pk_fma_f32 v[158:159], v[166:167], v[20:21], v[158:159] op_sel:[0,1,0] op_sel_hi:[1,1,1]
    s_waitcnt vmcnt(2)
    buffer_load_dwordx4 v[68:71], v6, s[48:51], s61 offen nt
    s_add_u32 s61, s61, 11264
    v_lshlrev_b32 v160, 16, v56
    v_and_b32 v161, 0xffff0000, v56
    v_lshlrev_b32 v162, 16, v57
    v_and_b32 v163, 0xffff0000, v57
    v_lshlrev_b32 v164, 16, v58
    v_and_b32 v165, 0xffff0000, v58
    v_lshlrev_b32 v166, 16, v59
    s_branch LC_AR
.p2align 12
LT_AR2:
    s_branch LR_AR2
LC_AR:
    v_and_b32 v167, 0xffff0000, v59
    v_pk_fma_f32 v[152:153], v[160:161], v[22:23], v[152:153] op_sel_hi:[1,0,1]
    v_pk_fma_f32 v[154:155], v[162:163], v[22:23], v[154:155] op_sel_hi:[1,0,1]
    v_pk_fma_f32 v[156:157], v[164:165], v[22:23], v[156:157] op_sel_hi:[1,0,1]
    v_pk_fma_f32 v[158:159], v[166:167], v[22:23], v[158:159] op_sel_hi:[1,0,1]
    s_waitcnt vmcnt(2)
    buffer_load_dwordx4 v[72:75], v6, s[48:51], s61 offen nt
    s_add_u32 s61, s61, 11264
    v_lshlrev_b32 v160, 16, v60
    v_and_b32 v161, 0xffff0000, v60
    v_lshlrev_b32 v162, 16, v61
    v_and_b32 v163, 0xffff0000, v61
    v_lshlrev_b32 v164, 16, v62
    v_and_b32 v165, 0xffff0000, v62
    v_lshlrev_b32 v166, 16, v63
    v_and_b32 v167, 0xffff0000, v63
    v_pk_fma_f32 v[152:153], v[160:161], v[22:23], v[152:153] op_sel:[0,1,0] op_sel_hi:[1,1,1]
    v_pk_fma_f32 v[154:155], v[162:163], v[22:23], v[154:155] op_sel:[0,1,0] op_sel_hi:[1,1,1]
    v_pk_fma_f32 v[156:157], v[164:165], v[22:23], v[156:157] op_sel:[0,1,0] op_sel_hi:[1,1,1]
    v_pk_fma_f32 v[158:159], v[166:167], v[22:23], v[158:159] op_sel:[0,1,0] op_sel_hi:[1,1,1]
    s_waitcnt vmcnt(2)
    buffer_load_dwordx4 v[76:79], v6, s[48:51], s61 offen nt
    s_add_u32 s61, s61, 11264
    v_lshlrev_b32 v160, 16, v64
    v_and_b32 v161, 0xffff0000, v64
    v_lshlrev_b32 v162, 16, v65
    v_and_b32 v163, 0xffff0000, v65
    v_lshlrev_b32 v164, 16, v66
    v_and_b32 v165, 0xffff0000, v66
    v_lshlrev_b32 v166, 16, v67
    v_and_b32 v167, 0xffff0000, v67
    v_pk_fma_f32 v[152:153], v[160:161], v[24:25], v[152:153] op_sel_hi:[1,0,1]
    v_pk_fma_f32 v[154:155], v[162:163], v[24:25], v[154:155] op_sel_hi:[1,0,1]
    v_pk_fma_f32 v[156:157], v[164:165], v[24:25], v[156:157] op_sel_hi:[1,0,1]
    v_pk_fma_f32 v[158:159], v[166:167], v[24:25], v[158:159] op_sel_hi:[1,0,1]
    s_waitcnt vmcnt(2)
    buffer_load_dwordx4 v[80:83], v6, s[48:51], s61 offen nt
    s_add_u32 s61, s61, 11264
    v_lshlrev_b32 v160, 16, v68
    v_and_b32 v161, 0xffff0000, v68
    v_lshlrev_b32 v162, 16, v69
    v_and_b32 v163, 0xffff0000, v69
    v_lshlrev_b32 v164, 16, v70
    v_and_b32 v165, 0xffff0000, v70
    v_lshlrev_b32 v166, 16, v71
    v_and_b32 v167, 0xffff0000, v71
    v_pk_fma_f32 v[152:153], v[160:161], v[24:25], v[152:153] op_sel:[0,1,0] op_sel_hi:[1,1,1]
    v_pk_fma_f32 v[154:155], v[162:163], v[24:25], v[154:155] op_sel:[0,1,0] op_sel_hi:[1,1,1]
    v_pk_fma_f32 v[156:157], v[164:165], v[24:25], v[156:157] op_sel:[0,1,0] op_sel_hi:[1,1,1]
    v_pk_fma_f32 v[158:159], v[166:167], v[24:25], v[158:159] op_sel:[0,1,0] op_sel_hi:[1,1,1]
    s_waitcnt vmcnt(2)
    buffer_load_dwordx4 v[84:87], v6, s[48:51], s61 offen nt
    s_add_u32 s61, s61, 11264
    v_lshlrev_b32 v160, 16, v72
    v_and_b32 v161, 0xffff0000, v72
    v_lshlrev_b32 v162, 16, v73
    v_and_b32 v163, 0xffff0000, v73
    v_lshlrev_b32 v164, 16, v74
    v_and_b32 v165, 0xffff0000, v74
    v_lshlrev_b32 v166, 16, v75
    v_and_b32 v167, 0xffff0000, v75
    v_pk_fma_f32 v[152:153], v[160:161], v[26:27], v[152:153] op_sel_hi:[1,0,1]
    v_pk_fma_f32 v[154:155], v[162:163], v[26:27], v[154:155] op_sel_hi:[1,0,1]
    v_pk_fma_f32 v[156:157], v[164:165], v[26:27], v[156:157] op_sel_hi:[1,0,1]
    v_pk_fma_f32 v[158:159], v[166:167], v[26:27], v[158:159] op_sel_hi:[1,0,1]
    s_waitcnt vmcnt(2)
    buffer_load_dwordx4 v[88:91], v6, s[48:51], s61 offen nt
    s_add_u32 s61, s61, 11264
    v_lshlrev_b32 v160, 16, v76
    v_and_b32 v161, 0xffff0000, v76
    v_lshlrev_b32 v162, 16, v77
    v_and_b32 v163, 0xffff0000, v77
    v_lshlrev_b32 v164, 16, v78
    v_and_b32 v165, 0xffff0000, v78
    v_lshlrev_b32 v166, 16, v79
    v_and_b32 v167, 0xffff0000, v79
    v_pk_fma_f32 v[152:153], v[160:161], v[26:27], v[152:153] op_sel:[0,1,0] op_sel_hi:[1,1,1]
    v_pk_fma_f32 v[154:155], v[162:163], v[26:27], v[154:155] op_sel:[0,1,0] op_sel_hi:[1,1,1]
    v_pk_fma_f32 v[156:157], v[164:165], v[26:27], v[156:157] op_sel:[0,1,0] op_sel_hi:[1,1,1]
    v_pk_fma_f32 v[158:159], v[166:167], v[26:27], v[158:159] op_sel:[0,1,0] op_sel_hi:[1,1,1]
    s_waitcnt vmcnt(2)
    buffer_load_dwordx4 v[92:95], v6, s[48:51], s61 offen nt
    v_lshlrev_b32 v160, 16, v80
    v_and_b32 v161, 0xffff0000, v80
    v_lshlrev_b32 v162, 16, v81
    v_and_b32 v163, 0xffff0000, v81
    v_lshlrev_b32 v164, 16, v82
    v_and_b32 v165, 0xffff0000, v82
    v_lshlrev_b32 v166, 16, v83
    v_and_b32 v167, 0xffff0000, v83
    v_pk_fma_f32 v[152:153], v[160:161], v[28:29], v[152:153] op_sel_hi:[1,0,1]
    v_pk_fma_f32 v[154:155], v[162:163], v[28:29], v[154:155] op_sel_hi:[1,0,1]
    v_pk_fma_f32 v[156:157], v[164:165], v[28:29], v[156:157] op_sel_hi:[1,0,1]
    v_pk_fma_f32 v[158:159], v[166:167], v[28:29], v[158:159] op_sel_hi:[1,0,1]
    s_cmp_eq_u32 s62, 0
    s_cbranch_scc1 AL_9
    s_waitcnt vmcnt(2)
    v_lshlrev_b32 v160, 16, v84
    v_and_b32 v161, 0xffff0000, v84
    v_lshlrev_b32 v162, 16, v85
    v_and_b32 v163, 0xffff0000, v85
    v_lshlrev_b32 v164, 16, v86
    v_and_b32 v165, 0xffff0000, v86
    v_lshlrev_b32 v166, 16, v87
    v_and_b32 v167, 0xffff0000, v87
    v_pk_fma_f32 v[152:153], v[160:161], v[28:29], v[152:153] op_sel:[0,1,0] op_sel_hi:[1,1,1]
    v_pk_fma_f32 v[154:155], v[162:163], v[28:29], v[154:155] op_sel:[0,1,0] op_sel_hi:[1,1,1]
    v_pk_fma_f32 v[156:157], v[164:165], v[28:29], v[156:157] op_sel:[0,1,0] op_sel_hi:[1,1,1]
    v_pk_fma_f32 v[158:159], v[166:167], v[28:29], v[158:159] op_sel:[0,1,0] op_sel_hi:[1,1,1]
    s_waitcnt vmcnt(1)
    v_lshlrev_b32 v160, 16, v88
    v_and_b32 v161, 0xffff0000, v88
    v_lshlrev_b32 v162, 16, v89
    v_and_b32 v163, 0xffff0000, v89
    v_lshlrev_b32 v164, 16, v90
    v_and_b32 v165, 0xffff0000, v90
    v_lshlrev_b32 v166, 16, v91
    v_and_b32 v167, 0xffff0000, v91
    v_pk_fma_f32 v[152:153], v[160:161], v[30:31], v[152:153] op_sel_hi:[1,0,1]
    v_pk_fma_f32 v[154:155], v[162:163], v[30:31], v[154:155] op_sel_hi:[1,0,1]
    v_pk_fma_f32 v[156:157], v[164:165], v[30:31], v[156:157] op_sel_hi:[1,0,1]
    v_pk_fma_f32 v[158:159], v[166:167], v[30:31], v[158:159] op_sel_hi:[1,0,1]
    s_waitcnt vmcnt(0)
    v_lshlrev_b32 v160, 16, v92
    v_and_b32 v161, 0xffff0000, v92
    v_lshlrev_b32 v162, 16, v93
    v_and_b32 v163, 0xffff0000, v93
    v_lshlrev_b32 v164, 16, v94
    v_and_b32 v165, 0xffff0000, v94
    v_lshlrev_b32 v166, 16, v95
    v_and_b32 v167, 0xffff0000, v95
    v_pk_fma_f32 v[152:153], v[160:161], v[30:31], v[152:153] op_sel:[0,1,0] op_sel_hi:[1,1,1]
    v_pk_fma_f32 v[154:155], v[162:163], v[30:31], v[154:155] op_sel:[0,1,0] op_sel_hi:[1,1,1]
    v_pk_fma_f32 v[156:157], v[164:165], v[30:31], v[156:157] op_sel:[0,1,0] op_sel_hi:[1,1,1]
    v_pk_fma_f32 v[158:159], v[166:167], v[30:31], v[158:159] op_sel:[0,1,0] op_sel_hi:[1,1,1]
    s_branch L_AFIN
AL_9:
    s_waitcnt vmcnt(2)
    buffer_load_dwordx4 v[96:99], v6, s[48:51], s63 offen nt
    v_lshlrev_b32 v160, 16, v84
    v_and_b32 v161, 0xffff0000, v84
    v_lshlrev_b32 v162, 16, v85
    v_and_b32 v163, 0xffff0000, v85
    v_lshlrev_b32 v164, 16, v86
    v_and_b32 v165, 0xffff0000, v86
    v_lshlrev_b32 v166, 16, v87
    v_and_b32 v167, 0xffff0000, v87
    v_pk_fma_f32 v[152:153], v[160:161], v[28:29], v[152:153] op_sel:[0,1,0] op_sel_hi:[1,1,1]
    v_pk_fma_f32 v[154:155], v[162:163], v[28:29], v[154:155] op_sel:[0,1,0] op_sel_hi:[1,1,1]
    v_pk_fma_f32 v[156:157], v[164:165], v[28:29], v[156:157] op_sel:[0,1,0] op_sel_hi:[1,1,1]
    v_pk_fma_f32 v[158:159], v[166:167], v[28:29], v[158:159] op_sel:[0,1,0] op_sel_hi:[1,1,1]
    s_waitcnt vmcnt(2)
    buffer_load_dwordx4 v[100:103], v6, s[48:51], s65 offen nt
    v_lshlrev_b32 v160, 16, v88
    v_and_b32 v161, 0xffff0000, v88
    v_lshlrev_b32 v162, 16, v89
    v_and_b32 v163, 0xffff0000, v89
    v_lshlrev_b32 v164, 16, v90
    v_and_b32 v165, 0xffff0000, v90
    v_lshlrev_b32 v166, 16, v91
    v_and_b32 v167, 0xffff0000, v91
    v_pk_fma_f32 v[152:153], v[160:161], v[30:31], v[152:153] op_sel_hi:[1,0,1]
    v_pk_fma_f32 v[154:155], v[162:163], v[30:31], v[154:155] op_sel_hi:[1,0,1]
    v_pk_fma_f32 v[156:157], v[164:165], v[30:31], v[156:157] op_sel_hi:[1,0,1]
    v_pk_fma_f32 v[158:159], v[166:167], v[30:31], v[158:159] op_sel_hi:[1,0,1]
    s_waitcnt vmcnt(2)
    v_lshlrev_b32 v160, 16, v92
    v_and_b32 v161, 0xffff0000, v92
    v_lshlrev_b32 v162, 16, v93
    v_and_b32 v163, 0xffff0000, v93
    v_lshlrev_b32 v164, 16, v94
    v_and_b32 v165, 0xffff0000, v94
    v_lshlrev_b32 v166, 16, v95
    v_and_b32 v167, 0xffff0000, v95
    v_pk_fma_f32 v[152:153], v[160:161], v[30:31], v[152:153] op_sel:[0,1,0] op_sel_hi:[1,1,1]
    v_pk_fma_f32 v[154:155], v[162:163], v[30:31], v[154:155] op_sel:[0,1,0] op_sel_hi:[1,1,1]
    v_pk_fma_f32 v[156:157], v[164:165], v[30:31], v[156:157] op_sel:[0,1,0] op_sel_hi:[1,1,1]
    v_pk_fma_f32 v[158:159], v[166:167], v[30:31], v[158:159] op_sel:[0,1,0] op_sel_hi:[1,1,1]
    s_waitcnt vmcnt(1)
    v_lshlrev_b32 v160, 16, v96
    v_and_b32 v161, 0xffff0000, v96
    v_lshlrev_b32 v162, 16, v97
    v_and_b32 v163, 0xffff0000, v97
    v_lshlrev_b32 v164, 16, v98
    v_and_b32 v165, 0xffff0000, v98
    v_lshlrev_b32 v166, 16, v99
    v_and_b32 v167, 0xffff0000, v99
    v_pk_fma_f32 v[152:153], v[160:161], v[8:9], v[152:153] op_sel_hi:[1,0,1]
    v_pk_fma_f32 v[154:155], v[162:163], v[8:9], v[154:155] op_sel_hi:[1,0,1]
    v_pk_fma_f32 v[156:157], v[164:165], v[8:9], v[156:157] op_sel_hi:[1,0,1]
    v_pk_fma_f32 v[158:159], v[166:167], v[8:9], v[158:159] op_sel_hi:[1,0,1]
    s_waitcnt vmcnt(0)
    v_lshlrev_b32 v160, 16, v100
    v_and_b32 v161, 0xffff0000, v100
    v_lshlrev_b32 v162, 16, v101
    v_and_b32 v163, 0xffff0000, v101
    v_lshlrev_b32 v164, 16, v102
    v_and_b32 v165, 0xffff0000, v102
    v_lshlrev_b32 v166, 16, v103
    v_and_b32 v167, 0xffff0000, v103
    v_pk_fma_f32 v[152:153], v[160:161], v[8:9], v[152:153] op_sel:[0,1,0] op_sel_hi:[1,1,1]
    v_pk_fma_f32 v[154:155], v[162:163], v[8:9], v[154:155] op_sel:[0,1,0] op_sel_hi:[1,1,1]
    v_pk_fma_f32 v[156:157], v[164:165], v[8:9], v[156:157] op_sel:[0,1,0] op_sel_hi:[1,1,1]
    v_pk_fma_f32 v[158:159], v[166:167], v[8:9], v[158:159] op_sel:[0,1,0] op_sel_hi:[1,1,1]
L_AFIN:
    s_nop 1
    v_permlane32_swap_b32 v152, v156
    v_permlane32_swap_b32 v153, v157
    v_permlane32_swap_b32 v154, v158
    v_permlane32_swap_b32 v155, v159
    v_add_f32 v152, v152, v156
    v_add_f32 v153, v153, v157
    v_add_f32 v154, v154, v158
    v_add_f32 v155, v155, v159
    s_nop 0
    v_permlane16_swap_b32 v152, v154
    v_permlane16_swap_b32 v153, v155
    v_add_f32 v152, v152, v154
    v_add_f32 v153, v153, v155
    ds_write_b64 v2, v[152:153]
    s_waitcnt lgkmcnt(0)
    s_barrier
    s_endpgm
L_ASVC:
    s_cmp_lg_u32 s3, 11
    s_cbranch_scc1 Z_10
    v_lshlrev_b32 v2, 2, v1
    v_add_u32 v2, 0x24000, v2
    v_mov_b32 v3, 0
    ds_write_b32 v2, v3
Z_10:
    s_waitcnt lgkmcnt(0)
    s_mov_b32 s92, 0x05040100
    s_mov_b32 s93, 0x07060302
    s_mov_b32 s36, s34
    s_and_b32 s37, s35, 0xffff
    s_mov_b32 s38, 0x1000000
    s_mov_b32 s39, 0x20000
    s_mov_b32 s40, s32
    s_and_b32 s41, s33, 0xffff
    s_mov_b32 s42, 0x100
    s_mov_b32 s43, 0x20000
    s_setprio 3
    s_lshr_b32 s60, s5, 2
    s_sub_u32 s60, s60, 4
    s_barrier
    s_lshl_b32 s7, s6, 2
    s_add_u32 s7, s7, s60
    s_lshl_b32 s7, s7, 11
    v_lshl_add_u32 v3, v1, 4, s7
    v_add_u32 v5, 0x40000, v3
    v_add_u32 v3, 0x80000, v3
    s_lshl_b32 s7, s6, 5
    s_add_u32 s7, s7, s60
    s_lshl_b32 s7, s7, 8
    s_add_u32 s7, s7, 0x80000
    v_lshrrev_b32 v6, 4, v1
    v_lshlrev_b32 v6, 11, v6
    v_and_b32 v100, 15, v1
    v_lshl_add_u32 v6, v100, 4, v6
    v_add_u32 v6, s7, v6
    s_sleep 8
    v_mov_b32 v90, 0
    s_mov_b32 s80, 200000
    s_mov_b64 exec, 1
    buffer_load_dwordx2 v[94:95], v90, s[40:43], 0 offen sc1
    s_sleep 16
    buffer_load_dwordx2 v[92:93], v90, s[40:43], 0 offen sc1
    s_mov_b64 exec, -1
    s_waitcnt vmcnt(1)
    v_readfirstlane_b32 s94, v94
    v_readfirstlane_b32 s95, v95
    s_cmp_lg_u32 s95, 0
    s_cbranch_scc1 NGD_12
    s_branch NG2_13
NG_11:
    s_mov_b64 exec, 1
    buffer_load_dwordx2 v[92:93], v90, s[40:43], 0 offen sc1
    s_mov_b64 exec, -1
NG2_13:
    s_waitcnt vmcnt(0)
    v_readfirstlane_b32 s94, v92
    v_readfirstlane_b32 s95, v93
    s_cmp_lg_u32 s95, 0
    s_cbranch_scc1 NGD_12
    s_sleep 4
    s_sub_u32 s80, s80, 1
    s_cmp_lg_u32 s80, 0
    s_cbranch_scc1 NG_11
NGD_12:
    v_lshlrev_b32 v7, 5, v1
    v_mov_b32 v114, s94
    v_mov_b32 v115, s95
    v_mov_b32 v118, s94
    v_mov_b32 v119, s95
    v_mov_b32 v122, s94
    v_mov_b32 v123, s95
    v_mov_b32 v126, s94
    v_mov_b32 v127, s95
    v_mov_b32 v100, 0x24044
    s_mov_b32 s80, 1600000
LW_14:
    ds_read_b32 v101, v100
    s_waitcnt lgkmcnt(0)
    v_readfirstlane_b32 s79, v101
    s_cmp_ge_u32 s79, 4
    s_cbranch_scc1 LWD_15
    s_sub_u32 s80, s80, 1
    s_cmp_lg_u32 s80, 0
    s_cbranch_scc1 LW_14
LWD_15:
    ds_read_b128 v[16:19], v7 offset:0
    ds_read_b128 v[20:23], v7 offset:16
    ds_read_b128 v[24:27], v7 offset:2048
    ds_read_b128 v[28:31], v7 offset:2064
    ds_read_b128 v[32:35], v7 offset:4096
    ds_read_b128 v[36:39], v7 offset:4112
    ds_read_b128 v[40:43], v7 offset:6144
    ds_read_b128 v[44:47], v7 offset:6160
    s_waitcnt lgkmcnt(0)
    v_add_f32 v16, v16, v32
    v_add_f32 v17, v17, v33
    v_add_f32 v18, v18, v34
    v_add_f32 v19, v19, v35
    v_add_f32 v20, v20, v36
    v_add_f32 v21, v21, v37
    v_add_f32 v22, v22, v38
    v_add_f32 v23, v23, v39
    v_add_f32 v24, v24, v40
    v_add_f32 v25, v25, v41
    v_add_f32 v26, v26, v42
    v_add_f32 v27, v27, v43
    v_add_f32 v28, v28, v44
    v_add_f32 v29, v29, v45
    v_add_f32 v30, v30, v46
    v_add_f32 v31, v31, v47
    v_add_f32 v16, v16, v24
    v_add_f32 v17, v17, v25
    v_add_f32 v18, v18, v26
    v_add_f32 v19, v19, v27
    v_add_f32 v20, v20, v28
    v_add_f32 v21, v21, v29
    v_add_f32 v22, v22, v30
    v_add_f32 v23, v23, v31
    v_cvt_pk_bf16_f32 v112, v16, v17
    v_cvt_pk_bf16_f32 v113, v18, v19
    v_cvt_pk_bf16_f32 v116, v20, v21
    v_cvt_pk_bf16_f32 v117, v22, v23
    buffer_store_dwordx4 v[112:115], v5, s[36:39], 0 offen offset:0
    buffer_store_dwordx4 v[116:119], v5, s[36:39], 0 offen offset:1024
    v_mov_b32 v100, 0x24018
    v_mov_b32 v101, 1
    s_waitcnt lgkmcnt(0)
    s_mov_b64 exec, 1
    ds_add_u32 v100, v101
    s_mov_b64 exec, -1
    v_mov_b32 v100, 0x24040
    s_mov_b32 s80, 1600000
LW_16:
    ds_read_b32 v101, v100
    s_waitcnt lgkmcnt(0)
    v_readfirstlane_b32 s79, v101
    s_cmp_ge_u32 s79, 4
    s_cbranch_scc1 LWD_17
    s_sub_u32 s80, s80, 1
    s_cmp_lg_u32 s80, 0
    s_cbranch_scc1 LW_16
LWD_17:
    ds_read_b128 v[16:19], v7 offset:8192
    ds_read_b128 v[20:23], v7 offset:8208
    ds_read_b128 v[24:27], v7 offset:10240
    ds_read_b128 v[28:31], v7 offset:10256
    ds_read_b128 v[32:35], v7 offset:12288
    ds_read_b128 v[36:39], v7 offset:12304
    ds_read_b128 v[40:43], v7 offset:14336
    ds_read_b128 v[44:47], v7 offset:14352
    s_waitcnt lgkmcnt(0)
    v_add_f32 v16, v16, v32
    v_add_f32 v17, v17, v33
    v_add_f32 v18, v18, v34
    v_add_f32 v19, v19, v35
    v_add_f32 v20, v20, v36
    v_add_f32 v21, v21, v37
    v_add_f32 v22, v22, v38
    v_add_f32 v23, v23, v39
    v_add_f32 v24, v24, v40
    v_add_f32 v25, v25, v41
    v_add_f32 v26, v26, v42
    v_add_f32 v27, v27, v43
    v_add_f32 v28, v28, v44
    v_add_f32 v29, v29, v45
    v_add_f32 v30, v30, v46
    v_add_f32 v31, v31, v47
    v_add_f32 v16, v16, v24
    v_add_f32 v17, v17, v25
    v_add_f32 v18, v18, v26
    v_add_f32 v19, v19, v27
    v_add_f32 v20, v20, v28
    v_add_f32 v21, v21, v29
    v_add_f32 v22, v22, v30
    v_add_f32 v23, v23, v31
    v_cvt_pk_bf16_f32 v120, v16, v17
    v_cvt_pk_bf16_f32 v121, v18, v19
    v_cvt_pk_bf16_f32 v124, v20, v21
    v_cvt_pk_bf16_f32 v125, v22, v23
    buffer_store_dwordx4 v[120:123], v6, s[36:39], 0 offen offset:0
    buffer_store_dwordx4 v[124:127], v6, s[36:39], 0 offen offset:1024
    v_mov_b32 v100, 0x24018
    v_mov_b32 v101, 1
    s_waitcnt lgkmcnt(0)
    s_mov_b64 exec, 1
    ds_add_u32 v100, v101
    s_mov_b64 exec, -1
    v_mov_b32 v110, v5
    v_mov_b32 v111, v6
    s_getreg_b32 s96, hwreg(HW_REG_XCC_ID, 0, 4)
    s_lshl_b32 s7, s4, 5
    s_add_u32 s7, s7, s5
    s_lshl_b32 s7, s7, 4
    s_add_u32 s7, s7, 0xc0000
    v_mov_b32 v100, s7
    v_mov_b32 v102, s96
    v_mov_b32 v103, 0
    v_mov_b32 v104, s94
    v_mov_b32 v105, s95
    s_mov_b64 exec, 1
    buffer_store_dwordx4 v[102:105], v100, s[36:39], 0 offen
    s_mov_b64 exec, -1
    s_sleep 16
    buffer_load_dwordx4 v[32:35], v3, s[36:39], 0 offen offset:0 sc1
    buffer_load_dwordx4 v[36:39], v3, s[36:39], 0 offen offset:1024 sc1
    s_mov_b32 s80, 200000
PS_18:
    s_waitcnt vmcnt(0)
    s_mov_b32 s78, 0
    v_cmp_ne_u64 vcc, s[94:95], v[34:35]
    s_cbranch_vccz PSS_20
    buffer_load_dwordx4 v[32:35], v3, s[36:39], 0 offen offset:0 sc1
    s_mov_b32 s78, 1
PSS_20:
    v_cmp_ne_u64 vcc, s[94:95], v[38:39]
    s_cbranch_vccz PSS_21
    buffer_load_dwordx4 v[36:39], v3, s[36:39], 0 offen offset:1024 sc1
    s_mov_b32 s78, 1
PSS_21:
    s_cmp_eq_u32 s78, 0
    s_cbranch_scc1 PSD_19
    s_sleep 8
    s_cmp_lg_u32 s80, 199984
    s_cbranch_scc1 PSL_22
    buffer_store_dwordx4 v[112:115], v110, s[36:39], 0 offen offset:0 sc1
    buffer_store_dwordx4 v[116:119], v110, s[36:39], 0 offen offset:1024 sc1
    buffer_store_dwordx4 v[120:123], v111, s[36:39], 0 offen offset:0 sc1
    buffer_store_dwordx4 v[124:127], v111, s[36:39], 0 offen offset:1024 sc1
PSL_22:
    s_sub_u32 s80, s80, 1
    s_cmp_lg_u32 s80, 0
    s_cbranch_scc1 PS_18
    s_waitcnt vmcnt(0)
PSD_19:
    v_lshlrev_b32 v16, 16, v32
    v_and_b32 v17, 0xffff0000, v32
    v_lshlrev_b32 v18, 16, v33
    v_and_b32 v19, 0xffff0000, v33
    v_lshlrev_b32 v20, 16, v36
    v_and_b32 v21, 0xffff0000, v36
    v_lshlrev_b32 v22, 16, v37
    v_and_b32 v23, 0xffff0000, v37
    v_mov_b32 v24, v16
    v_mov_b32 v25, v17
    v_mov_b32 v26, v18
    v_mov_b32 v27, v19
    v_mov_b32 v28, v20
    v_mov_b32 v29, v21
    v_mov_b32 v30, v22
    v_mov_b32 v31, v23
    v_permlane32_swap_b32 v16, v24
    v_permlane32_swap_b32 v17, v25
    v_permlane32_swap_b32 v18, v26
    v_permlane32_swap_b32 v19, v27
    v_permlane32_swap_b32 v20, v28
    v_permlane32_swap_b32 v21, v29
    v_permlane32_swap_b32 v22, v30
    v_permlane32_swap_b32 v23, v31
    v_add_f32 v16, v16, v24
    v_add_f32 v17, v17, v25
    v_add_f32 v18, v18, v26
    v_add_f32 v19, v19, v27
    v_add_f32 v20, v20, v28
    v_add_f32 v21, v21, v29
    v_add_f32 v22, v22, v30
    v_add_f32 v23, v23, v31
    v_mov_b32 v24, v16
    v_mov_b32 v25, v17
    v_mov_b32 v26, v18
    v_mov_b32 v27, v19
    v_mov_b32 v28, v20
    v_mov_b32 v29, v21
    v_mov_b32 v30, v22
    v_mov_b32 v31, v23
    v_permlane16_swap_b32 v16, v24
    v_permlane16_swap_b32 v17, v25
    v_permlane16_swap_b32 v18, v26
    v_permlane16_swap_b32 v19, v27
    v_permlane16_swap_b32 v20, v28
    v_permlane16_swap_b32 v21, v29
    v_permlane16_swap_b32 v22, v30
    v_permlane16_swap_b32 v23, v31
    v_add_f32 v16, v16, v24
    v_add_f32 v17, v17, v25
    v_add_f32 v18, v18, v26
    v_add_f32 v19, v19, v27
    v_add_f32 v20, v20, v28
    v_add_f32 v21, v21, v29
    v_add_f32 v22, v22, v30
    v_add_f32 v23, v23, v31
    v_cvt_pk_bf16_f32 v8, v16, v17
    v_cvt_pk_bf16_f32 v9, v18, v19
    v_cvt_pk_bf16_f32 v10, v20, v21
    v_cvt_pk_bf16_f32 v11, v22, v23
    v_and_b32 v100, 15, v1
    v_lshlrev_b32 v100, 4, v100
    v_add_u32 v100, 0x24100, v100
    ds_write_b128 v100, v[8:11]
L_ACUT:
    v_mov_b32 v100, 0x24004
    v_mov_b32 v101, 1
    s_waitcnt lgkmcnt(0)
    s_mov_b64 exec, 1
    ds_add_u32 v100, v101
    s_mov_b64 exec, -1
    s_sleep 100
    v_and_b32 v100, 31, v1
    s_lshl_b32 s7, s4, 9
    s_add_u32 s7, s7, 0xc0000
    v_lshl_add_u32 v100, v100, 4, s7
    buffer_load_dwordx4 v[32:35], v100, s[36:39], 0 offen sc1
    s_waitcnt vmcnt(0)
    v_cmp_ne_u64 vcc, s[94:95], v[34:35]
    v_cmp_ne_u32 s[86:87], s96, v32
    s_or_b32 s97, vcc_lo, s86
    s_and_b32 s97, s97, 0xffff00ff
    s_cbranch_scc0 AF_23
    buffer_store_dwordx4 v[112:115], v110, s[36:39], 0 offen offset:0 sc1
    buffer_store_dwordx4 v[116:119], v110, s[36:39], 0 offen offset:1024 sc1
    buffer_store_dwordx4 v[120:123], v111, s[36:39], 0 offen offset:0 sc1
    buffer_store_dwordx4 v[124:127], v111, s[36:39], 0 offen offset:1024 sc1
AF_23:
    v_mov_b32 v100, 0x24008
    s_mov_b32 s80, 1600000
LW_24:
    ds_read_b32 v101, v100
    s_waitcnt lgkmcnt(0)
    v_readfirstlane_b32 s79, v101
    s_cmp_ge_u32 s79, 11
    s_cbranch_scc1 LWD_25
    s_sleep 2
    s_sub_u32 s80, s80, 1
    s_cmp_lg_u32 s80, 0
    s_cbranch_scc1 LW_24
LWD_25:
    v_mov_b32 v100, 0x24200
    ds_read_b128 v[8:11], v100 offset:0
    ds_read_b128 v[12:15], v100 offset:16
    ds_read_b128 v[16:19], v100 offset:32
    ds_read_b128 v[20:23], v100 offset:48
    ds_read_b128 v[24:27], v100 offset:64
    ds_read_b128 v[28:31], v100 offset:80
    s_waitcnt lgkmcnt(0)
    v_max3_f32 v100, v8, v10, v12
    v_max3_f32 v100, v100, v14, v16
    v_max3_f32 v100, v100, v18, v20
    v_max3_f32 v100, v100, v22, v24
    v_max3_f32 v100, v100, v26, v28
    v_sub_f32 v8, v8, v100
    v_sub_f32 v10, v10, v100
    v_sub_f32 v12, v12, v100
    v_sub_f32 v14, v14, v100
    v_sub_f32 v16, v16, v100
    v_sub_f32 v18, v18, v100
    v_sub_f32 v20, v20, v100
    v_sub_f32 v22, v22, v100
    v_sub_f32 v24, v24, v100
    v_sub_f32 v26, v26, v100
    v_sub_f32 v28, v28, v100
    v_exp_f32 v8, v8
    v_exp_f32 v10, v10
    v_exp_f32 v12, v12
    v_exp_f32 v14, v14
    v_exp_f32 v16, v16
    v_exp_f32 v18, v18
    v_exp_f32 v20, v20
    v_exp_f32 v22, v22
    v_exp_f32 v24, v24
    v_exp_f32 v26, v26
    v_exp_f32 v28, v28
    v_mul_f32 v101, v8, v9
    v_fmac_f32 v101, v10, v11
    v_fmac_f32 v101, v12, v13
    v_fmac_f32 v101, v14, v15
    v_fmac_f32 v101, v16, v17
    v_fmac_f32 v101, v18, v19
    v_fmac_f32 v101, v20, v21
    v_fmac_f32 v101, v22, v23
    v_fmac_f32 v101, v24, v25
    v_fmac_f32 v101, v26, v27
    v_fmac_f32 v101, v28, v29
    v_rcp_f32 v101, v101
    s_nop 0
    v_mul_f32 v8, v8, v101
    v_mul_f32 v10, v10, v101
    v_mul_f32 v12, v12, v101
    v_mul_f32 v14, v14, v101
    v_mul_f32 v16, v16, v101
    v_mul_f32 v18, v18, v101
    v_mul_f32 v20, v20, v101
    v_mul_f32 v22, v22, v101
    v_mul_f32 v24, v24, v101
    v_mul_f32 v26, v26, v101
    v_mul_f32 v28, v28, v101
    v_and_b32 v100, 15, v1
    v_bfe_u32 v101, v1, 4, 1
    v_lshlrev_b32 v3, 5, v100
    v_lshl_add_u32 v3, v101, 4, v3
    v_add_u32 v3, 0x10000, v3
    s_lshl_b32 s7, s6, 3
    s_add_u32 s7, s7, s60
    s_lshl_b32 s7, s7, 8
    s_add_u32 s7, s7, 0xd0000
    v_lshlrev_b32 v2, 4, v100
    v_lshl_add_u32 v2, v101, 10, v2
    v_add_u32 v2, s7, v2
    v_mov_b32 v6, s94
    v_mov_b32 v7, s95
    s_barrier
    ds_read_b128 v[40:43], v3 offset:0
    ds_read_b128 v[44:47], v3 offset:512
    ds_read_b128 v[48:51], v3 offset:1024
    ds_read_b128 v[52:55], v3 offset:1536
    ds_read_b128 v[56:59], v3 offset:2048
    ds_read_b128 v[60:63], v3 offset:2560
    ds_read_b128 v[64:67], v3 offset:3072
    ds_read_b128 v[68:71], v3 offset:3584
    ds_read_b128 v[72:75], v3 offset:4096
    ds_read_b128 v[76:79], v3 offset:4608
    ds_read_b128 v[80:83], v3 offset:5120
    s_waitcnt lgkmcnt(10)
    v_pk_mul_f32 v[32:33], v[40:41], v[8:9] op_sel_hi:[1,0]
    v_pk_mul_f32 v[34:35], v[42:43], v[8:9] op_sel_hi:[1,0]
    s_waitcnt lgkmcnt(9)
    v_pk_mul_f32 v[36:37], v[44:45], v[10:11] op_sel_hi:[1,0]
    v_pk_mul_f32 v[38:39], v[46:47], v[10:11] op_sel_hi:[1,0]
    s_waitcnt lgkmcnt(8)
    v_pk_fma_f32 v[32:33], v[48:49], v[12:13], v[32:33] op_sel_hi:[1,0,1]
    v_pk_fma_f32 v[34:35], v[50:51], v[12:13], v[34:35] op_sel_hi:[1,0,1]
    s_waitcnt lgkmcnt(7)
    v_pk_fma_f32 v[36:37], v[52:53], v[14:15], v[36:37] op_sel_hi:[1,0,1]
    v_pk_fma_f32 v[38:39], v[54:55], v[14:15], v[38:39] op_sel_hi:[1,0,1]
    s_waitcnt lgkmcnt(6)
    v_pk_fma_f32 v[32:33], v[56:57], v[16:17], v[32:33] op_sel_hi:[1,0,1]
    v_pk_fma_f32 v[34:35], v[58:59], v[16:17], v[34:35] op_sel_hi:[1,0,1]
    s_waitcnt lgkmcnt(5)
    v_pk_fma_f32 v[36:37], v[60:61], v[18:19], v[36:37] op_sel_hi:[1,0,1]
    v_pk_fma_f32 v[38:39], v[62:63], v[18:19], v[38:39] op_sel_hi:[1,0,1]
    s_waitcnt lgkmcnt(4)
    v_pk_fma_f32 v[32:33], v[64:65], v[20:21], v[32:33] op_sel_hi:[1,0,1]
    v_pk_fma_f32 v[34:35], v[66:67], v[20:21], v[34:35] op_sel_hi:[1,0,1]
    s_waitcnt lgkmcnt(3)
    v_pk_fma_f32 v[36:37], v[68:69], v[22:23], v[36:37] op_sel_hi:[1,0,1]
    v_pk_fma_f32 v[38:39], v[70:71], v[22:23], v[38:39] op_sel_hi:[1,0,1]
    s_waitcnt lgkmcnt(2)
    v_pk_fma_f32 v[32:33], v[72:73], v[24:25], v[32:33] op_sel_hi:[1,0,1]
    v_pk_fma_f32 v[34:35], v[74:75], v[24:25], v[34:35] op_sel_hi:[1,0,1]
    s_waitcnt lgkmcnt(1)
    v_pk_fma_f32 v[36:37], v[76:77], v[26:27], v[36:37] op_sel_hi:[1,0,1]
    v_pk_fma_f32 v[38:39], v[78:79], v[26:27], v[38:39] op_sel_hi:[1,0,1]
    s_waitcnt lgkmcnt(0)
    v_pk_fma_f32 v[32:33], v[80:81], v[28:29], v[32:33] op_sel_hi:[1,0,1]
    v_pk_fma_f32 v[34:35], v[82:83], v[28:29], v[34:35] op_sel_hi:[1,0,1]
    v_pk_add_f32 v[32:33], v[32:33], v[36:37]
    v_pk_add_f32 v[34:35], v[34:35], v[38:39]
    v_cvt_pk_bf16_f32 v4, v32, v33
    v_cvt_pk_bf16_f32 v5, v34, v35
    s_mov_b64 exec, 0xffffffff
    buffer_store_dwordx4 v[4:7], v2, s[36:39], 0 offen
    s_cmp_eq_u32 s97, 0
    s_cbranch_scc1 AF_26
    buffer_store_dwordx4 v[4:7], v2, s[36:39], 0 offen sc1
AF_26:
    s_mov_b64 exec, -1
    s_endpgm
.p2align 12
L_W:
    s_waitcnt lgkmcnt(0)
    s_mov_b32 s92, 0x05040100
    s_mov_b32 s93, 0x07060302
    s_mov_b32 s36, s34
    s_and_b32 s37, s35, 0xffff
    s_mov_b32 s38, 0x1000000
    s_mov_b32 s39, 0x20000
    s_mov_b32 s40, s32
    s_and_b32 s41, s33, 0xffff
    s_mov_b32 s42, 0x100
    s_mov_b32 s43, 0x20000
    s_barrier
    s_cmp_eq_u32 s3, 0
    s_cbranch_scc1 LT_U1
LR_U1:
    s_cmp_eq_u32 s3, 1
    s_cbranch_scc1 LT_W2R
LR_W2R:
    s_cmp_ge_u32 s5, 4
    s_cbranch_scc1 L_END
    v_mov_b32 v160, 0x24048
    s_mov_b32 s80, 1600000
LW_27:
    ds_read_b32 v161, v160
    s_waitcnt lgkmcnt(0)
    v_readfirstlane_b32 s79, v161
    s_cmp_ge_u32 s79, 4
    s_cbranch_scc1 LWD_28
    s_sleep 4
    s_sub_u32 s80, s80, 1
    s_cmp_lg_u32 s80, 0
    s_cbranch_scc1 LW_27
LWD_28:
    s_branch L_U1
L_W1:
    s_waitcnt lgkmcnt(0)
    s_mov_b32 s92, 0x05040100
    s_mov_b32 s93, 0x07060302
    s_mov_b32 s36, s34
    s_and_b32 s37, s35, 0xffff
    s_mov_b32 s38, 0x1000000
    s_mov_b32 s39, 0x20000
    s_mov_b32 s40, s32
    s_and_b32 s41, s33, 0xffff
    s_mov_b32 s42, 0x100
    s_mov_b32 s43, 0x20000
    s_setprio 3
    s_barrier
    s_cmp_lg_u32 s3, 4
    s_cbranch_scc1 W4_29
    s_sleep 8
    v_mov_b32 v152, 0
    s_mov_b32 s80, 200000
    s_mov_b64 exec, 1
    buffer_load_dwordx2 v[156:157], v152, s[40:43], 0 offen sc1
    s_sleep 16
    buffer_load_dwordx2 v[154:155], v152, s[40:43], 0 offen sc1
    s_mov_b64 exec, -1
    s_waitcnt vmcnt(1)
    v_readfirstlane_b32 s94, v156
    v_readfirstlane_b32 s95, v157
    s_cmp_lg_u32 s95, 0
    s_cbranch_scc1 NGD_31
    s_branch NG2_32
NG_30:
    s_mov_b64 exec, 1
    buffer_load_dwordx2 v[154:155], v152, s[40:43], 0 offen sc1
    s_mov_b64 exec, -1
NG2_32:
    s_waitcnt vmcnt(0)
    v_readfirstlane_b32 s94, v154
    v_readfirstlane_b32 s95, v155
    s_cmp_lg_u32 s95, 0
    s_cbranch_scc1 NGD_31
    s_sleep 4
    s_sub_u32 s80, s80, 1
    s_cmp_lg_u32 s80, 0
    s_cbranch_scc1 NG_30
NGD_31:
    v_mov_b32 v160, 0x24050
    v_mov_b32 v162, s94
    v_mov_b32 v163, s95
    ds_write_b64 v160, v[162:163]
    v_mov_b32 v160, 0x2404c
    v_mov_b32 v161, 1
    s_waitcnt lgkmcnt(0)
    s_mov_b64 exec, 1
    ds_add_u32 v160, v161
    s_mov_b64 exec, -1
    s_getreg_b32 s96, hwreg(HW_REG_XCC_ID, 0, 4)
    s_lshl_b32 s7, s4, 5
    s_add_u32 s7, s7, s5
    s_lshl_b32 s7, s7, 4
    s_add_u32 s7, s7, 0xc0000
    v_mov_b32 v160, s7
    v_mov_b32 v162, s96
    v_mov_b32 v163, 0
    v_mov_b32 v164, s94
    v_mov_b32 v165, s95
    s_mov_b64 exec, 1
    buffer_store_dwordx4 v[162:165], v160, s[36:39], 0 offen
    s_mov_b64 exec, -1
W4_29:
    s_sub_u32 s62, s3, 4
    s_lshl_b32 s61, s4, 2
    s_add_u32 s61, s61, s62
    v_lshrrev_b32 v162, 4, v1
    v_and_b32 v161, 15, v1
    v_lshlrev_b32 v2, 16, v162
    v_lshl_add_u32 v2, v161, 4, v2
    s_lshl_b32 s7, s61, 3
    s_add_u32 s7, s7, s5
    s_lshl_b32 s7, s7, 8
    s_add_u32 s7, s7, 0x0
    v_add_u32 v2, s7, v2
    v_lshlrev_b32 v3, 6, v161
    v_lshl_add_u32 v3, v162, 4, v3
    s_lshl_b32 s7, s61, 13
    s_add_u32 s7, s7, 0x40000
    v_add_u32 v3, s7, v3
    v_xor_b32 v5, v162, v161
    v_lshlrev_b32 v5, 4, v5
    v_lshl_add_u32 v4, v161, 12, v5
    s_lshl_b32 s7, s62, 8
    v_add_u32 v4, s7, v4
    v_mov_b32 v160, 0x2404c
    s_mov_b32 s80, 1600000
LW_33:
    ds_read_b32 v161, v160
    s_waitcnt lgkmcnt(0)
    v_readfirstlane_b32 s79, v161
    s_cmp_ge_u32 s79, 1
    s_cbranch_scc1 LWD_34
    s_sleep 2
    s_sub_u32 s80, s80, 1
    s_cmp_lg_u32 s80, 0
    s_cbranch_scc1 LW_33
LWD_34:
    v_mov_b32 v160, 0x24050
    ds_read_b64 v[162:163], v160
    s_waitcnt lgkmcnt(0)
    v_readfirstlane_b32 s94, v162
    v_readfirstlane_b32 s95, v163
    s_sleep 4
    s_mov_b32 s63, 4096
    buffer_load_dwordx4 v[72:75], v3, s[36:39], 0 offen offset:0 sc1
    buffer_load_dwordx4 v[76:79], v3, s[36:39], 0 offen offset:1024 sc1
    buffer_load_dwordx4 v[80:83], v3, s[36:39], 0 offen offset:2048 sc1
    buffer_load_dwordx4 v[84:87], v3, s[36:39], 0 offen offset:3072 sc1
    buffer_load_dwordx4 v[88:91], v3, s[36:39], s63 offen offset:0 sc1
    buffer_load_dwordx4 v[92:95], v3, s[36:39], s63 offen offset:1024 sc1
    buffer_load_dwordx4 v[96:99], v3, s[36:39], s63 offen offset:2048 sc1
    buffer_load_dwordx4 v[100:103], v3, s[36:39], s63 offen offset:3072 sc1
    v_mov_b32 v160, 0x24014
    s_mov_b32 s80, 1600000
LW_37:
    ds_read_b32 v161, v160
    s_waitcnt lgkmcnt(0)
    v_readfirstlane_b32 s79, v161
    s_cmp_ge_u32 s79, 4
    s_cbranch_scc1 LWD_38
    s_sleep 1
    s_sub_u32 s80, s80, 1
    s_cmp_lg_u32 s80, 0
    s_cbranch_scc1 LW_37
LWD_38:
    v_xor_b32 v160, 0x0, v4
    v_xor_b32 v161, 0x40, v4
    v_xor_b32 v162, 0x80, v4
    v_xor_b32 v163, 0xc0, v4
    ds_read_b128 v[8:11], v160 offset:0
    ds_read_b128 v[12:15], v161 offset:0
    ds_read_b128 v[16:19], v162 offset:0
    ds_read_b128 v[20:23], v163 offset:0
    ds_read_b128 v[24:27], v160 offset:1024
    ds_read_b128 v[28:31], v161 offset:1024
    ds_read_b128 v[32:35], v162 offset:1024
    ds_read_b128 v[36:39], v163 offset:1024
    ds_read_b128 v[40:43], v160 offset:2048
    ds_read_b128 v[44:47], v161 offset:2048
    ds_read_b128 v[48:51], v162 offset:2048
    ds_read_b128 v[52:55], v163 offset:2048
    ds_read_b128 v[56:59], v160 offset:3072
    ds_read_b128 v[60:63], v161 offset:3072
    ds_read_b128 v[64:67], v162 offset:3072
    ds_read_b128 v[68:71], v163 offset:3072
    s_mov_b32 s80, 200000
PS_35:
    s_waitcnt vmcnt(0)
    s_mov_b32 s78, 0
    v_cmp_ne_u64 vcc, s[94:95], v[74:75]
    s_cbranch_vccz PSS_39
    buffer_load_dwordx4 v[72:75], v3, s[36:39], 0 offen offset:0 sc1
    s_mov_b32 s78, 1
PSS_39:
    v_cmp_ne_u64 vcc, s[94:95], v[78:79]
    s_cbranch_vccz PSS_40
    buffer_load_dwordx4 v[76:79], v3, s[36:39], 0 offen offset:1024 sc1
    s_mov_b32 s78, 1
PSS_40:
    v_cmp_ne_u64 vcc, s[94:95], v[82:83]
    s_cbranch_vccz PSS_41
    buffer_load_dwordx4 v[80:83], v3, s[36:39], 0 offen offset:2048 sc1
    s_mov_b32 s78, 1
PSS_41:
    v_cmp_ne_u64 vcc, s[94:95], v[86:87]
    s_cbranch_vccz PSS_42
    buffer_load_dwordx4 v[84:87], v3, s[36:39], 0 offen offset:3072 sc1
    s_mov_b32 s78, 1
PSS_42:
    v_cmp_ne_u64 vcc, s[94:95], v[90:91]
    s_cbranch_vccz PSS_43
    buffer_load_dwordx4 v[88:91], v3, s[36:39], s63 offen offset:0 sc1
    s_mov_b32 s78, 1
PSS_43:
    v_cmp_ne_u64 vcc, s[94:95], v[94:95]
    s_cbranch_vccz PSS_44
    buffer_load_dwordx4 v[92:95], v3, s[36:39], s63 offen offset:1024 sc1
    s_mov_b32 s78, 1
PSS_44:
    v_cmp_ne_u64 vcc, s[94:95], v[98:99]
    s_cbranch_vccz PSS_45
    buffer_load_dwordx4 v[96:99], v3, s[36:39], s63 offen offset:2048 sc1
    s_mov_b32 s78, 1
PSS_45:
    v_cmp_ne_u64 vcc, s[94:95], v[102:103]
    s_cbranch_vccz PSS_46
    buffer_load_dwordx4 v[100:103], v3, s[36:39], s63 offen offset:3072 sc1
    s_mov_b32 s78, 1
PSS_46:
    s_cmp_eq_u32 s78, 0
    s_cbranch_scc1 PSD_36
    s_sub_u32 s80, s80, 1
    s_cmp_lg_u32 s80, 0
    s_cbranch_scc1 PS_35
    s_waitcnt vmcnt(0)
PSD_36:
    v_lshlrev_b32 v104, 16, v72
    v_and_b32 v105, 0xffff0000, v72
    v_lshlrev_b32 v106, 16, v73
    v_and_b32 v107, 0xffff0000, v73
    v_lshlrev_b32 v108, 16, v76
    v_and_b32 v109, 0xffff0000, v76
    v_lshlrev_b32 v110, 16, v77
    v_and_b32 v111, 0xffff0000, v77
    v_lshlrev_b32 v120, 16, v80
    v_and_b32 v121, 0xffff0000, v80
    v_lshlrev_b32 v122, 16, v81
    v_and_b32 v123, 0xffff0000, v81
    v_lshlrev_b32 v124, 16, v84
    v_and_b32 v125, 0xffff0000, v84
    v_lshlrev_b32 v126, 16, v85
    v_and_b32 v127, 0xffff0000, v85
    v_add_f32 v104, v104, v120
    v_add_f32 v105, v105, v121
    v_add_f32 v106, v106, v122
    v_add_f32 v107, v107, v123
    v_add_f32 v108, v108, v124
    v_add_f32 v109, v109, v125
    v_add_f32 v110, v110, v126
    v_add_f32 v111, v111, v127
    v_lshlrev_b32 v112, 16, v88
    v_and_b32 v113, 0xffff0000, v88
    v_lshlrev_b32 v114, 16, v89
    v_and_b32 v115, 0xffff0000, v89
    v_lshlrev_b32 v116, 16, v92
    v_and_b32 v117, 0xffff0000, v92
    v_lshlrev_b32 v118, 16, v93
    v_and_b32 v119, 0xffff0000, v93
    v_add_f32 v104, v104, v112
    v_add_f32 v105, v105, v113
    v_add_f32 v106, v106, v114
    v_add_f32 v107, v107, v115
    v_add_f32 v108, v108, v116
    v_add_f32 v109, v109, v117
    v_add_f32 v110, v110, v118
    v_add_f32 v111, v111, v119
    v_lshlrev_b32 v120, 16, v96
    v_and_b32 v121, 0xffff0000, v96
    v_lshlrev_b32 v122, 16, v97
    v_and_b32 v123, 0xffff0000, v97
    v_lshlrev_b32 v124, 16, v100
    v_and_b32 v125, 0xffff0000, v100
    v_lshlrev_b32 v126, 16, v101
    v_and_b32 v127, 0xffff0000, v101
    v_add_f32 v104, v104, v120
    v_add_f32 v105, v105, v121
    v_add_f32 v106, v106, v122
    v_add_f32 v107, v107, v123
    v_add_f32 v108, v108, v124
    v_add_f32 v109, v109, v125
    v_add_f32 v110, v110, v126
    v_add_f32 v111, v111, v127
    v_cvt_pk_bf16_f32 v136, v104, v105
    v_cvt_pk_bf16_f32 v137, v106, v107
    v_cvt_pk_bf16_f32 v138, v108, v109
    v_cvt_pk_bf16_f32 v139, v110, v111
    v_mov_b32_dpp v140, v136 quad_perm:[1,2,3,0] row_mask:0xf bank_mask:0xf
    v_mov_b32_dpp v141, v137 quad_perm:[1,2,3,0] row_mask:0xf bank_mask:0xf
    v_mov_b32_dpp v142, v138 quad_perm:[1,2,3,0] row_mask:0xf bank_mask:0xf
    v_mov_b32_dpp v143, v139 quad_perm:[1,2,3,0] row_mask:0xf bank_mask:0xf
    v_mov_b32_dpp v144, v136 quad_perm:[2,3,0,1] row_mask:0xf bank_mask:0xf
    v_mov_b32_dpp v145, v137 quad_perm:[2,3,0,1] row_mask:0xf bank_mask:0xf
    v_mov_b32_dpp v146, v138 quad_perm:[2,3,0,1] row_mask:0xf bank_mask:0xf
    v_mov_b32_dpp v147, v139 quad_perm:[2,3,0,1] row_mask:0xf bank_mask:0xf
    v_mov_b32_dpp v148, v136 quad_perm:[3,0,1,2] row_mask:0xf bank_mask:0xf
    v_mov_b32_dpp v149, v137 quad_perm:[3,0,1,2] row_mask:0xf bank_mask:0xf
    v_mov_b32_dpp v150, v138 quad_perm:[3,0,1,2] row_mask:0xf bank_mask:0xf
    v_mov_b32_dpp v151, v139 quad_perm:[3,0,1,2] row_mask:0xf bank_mask:0xf
    v_mov_b32 v74, s94
    v_mov_b32 v75, s95
    s_waitcnt lgkmcnt(0)
    v_mfma_f32_16x16x32_bf16 v[104:107], v[136:139], v[8:11], 0
    v_mfma_f32_16x16x32_bf16 v[108:111], v[136:139], v[28:31], 0
    v_mfma_f32_16x16x32_bf16 v[112:115], v[136:139], v[48:51], 0
    v_mfma_f32_16x16x32_bf16 v[116:119], v[136:139], v[68:71], 0
    v_mfma_f32_16x16x32_bf16 v[104:107], v[140:143], v[12:15], v[104:107]
    v_mfma_f32_16x16x32_bf16 v[108:111], v[140:143], v[32:35], v[108:111]
    v_mfma_f32_16x16x32_bf16 v[112:115], v[140:143], v[52:55], v[112:115]
    v_mfma_f32_16x16x32_bf16 v[116:119], v[140:143], v[56:59], v[116:119]
    v_mfma_f32_16x16x32_bf16 v[104:107], v[144:147], v[16:19], v[104:107]
    v_mfma_f32_16x16x32_bf16 v[108:111], v[144:147], v[36:39], v[108:111]
    v_mfma_f32_16x16x32_bf16 v[112:115], v[144:147], v[40:43], v[112:115]
    v_mfma_f32_16x16x32_bf16 v[116:119], v[144:147], v[60:63], v[116:119]
    v_mfma_f32_16x16x32_bf16 v[104:107], v[148:151], v[20:23], v[104:107]
    v_mfma_f32_16x16x32_bf16 v[108:111], v[148:151], v[24:27], v[108:111]
    v_mfma_f32_16x16x32_bf16 v[112:115], v[148:151], v[44:47], v[112:115]
    v_mfma_f32_16x16x32_bf16 v[116:119], v[148:151], v[64:67], v[116:119]
    s_nop 5
    v_cvt_pk_bf16_f32 v72, v104, v109
    s_nop 0
    v_cvt_pk_bf16_f32 v73, v114, v119
    buffer_store_dwordx4 v[72:75], v2, s[36:39], 0 offen sc1
    v_mov_b32 v160, 0x24048
    v_mov_b32 v161, 1
    s_waitcnt lgkmcnt(0)
    s_mov_b64 exec, 1
    ds_add_u32 v160, v161
    s_mov_b64 exec, -1
    s_setprio 0
    s_cmp_ge_u32 s5, 4
    s_cbranch_scc1 L_END
    s_branch L_U1
L_CSVC:
    s_cmp_lg_u32 s3, 11
    s_cbranch_scc1 Z_95
    v_lshlrev_b32 v2, 2, v1
    v_add_u32 v2, 0x24000, v2
    v_mov_b32 v3, 0
    ds_write_b32 v2, v3
Z_95:
    s_waitcnt lgkmcnt(0)
    s_mov_b32 s92, 0x05040100
    s_mov_b32 s93, 0x07060302
    s_mov_b32 s36, s34
    s_and_b32 s37, s35, 0xffff
    s_mov_b32 s38, 0x1000000
    s_mov_b32 s39, 0x20000
    s_mov_b32 s40, s32
    s_and_b32 s41, s33, 0xffff
    s_mov_b32 s42, 0x100
    s_mov_b32 s43, 0x20000
    s_setprio 3
    s_sub_u32 s60, s3, 8
    s_lshl_b32 s64, s4, 3
    s_add_u32 s64, s64, s5
    s_sub_u32 s64, s64, 8
    v_lshlrev_b32 v2, 4, v1
    s_barrier
    s_cmp_eq_u32 s3, 9
    s_cbranch_scc1 LT_CR
LR_CR:
    s_cmp_eq_u32 s3, 10
    s_cbranch_scc1 LT_CR2
LR_CR2:
    s_cmp_lg_u32 s60, 0
    s_cbranch_scc1 C8_96
    s_sleep 24
    v_mov_b32 v160, 0
    s_mov_b32 s80, 200000
NG_97:
    s_mov_b64 exec, 1
    buffer_load_dwordx2 v[162:163], v160, s[40:43], 0 offen sc1
    s_mov_b64 exec, -1
    s_waitcnt vmcnt(0)
    v_readfirstlane_b32 s94, v162
    v_readfirstlane_b32 s95, v163
    s_cmp_lg_u32 s95, 0
    s_cbranch_scc1 NGD_98
    s_sleep 4
    s_sub_u32 s80, s80, 1
    s_cmp_lg_u32 s80, 0
    s_cbranch_scc1 NG_97
NGD_98:
    v_mov_b32 v160, 0x24050
    v_mov_b32 v162, s94
    v_mov_b32 v163, s95
    ds_write_b64 v160, v[162:163]
    v_mov_b32 v160, 0x2404c
    v_mov_b32 v161, 1
    s_waitcnt lgkmcnt(0)
    s_mov_b64 exec, 1
    ds_add_u32 v160, v161
    s_mov_b64 exec, -1
C8_96:
    s_lshr_b32 s7, s64, 4
    s_lshl_b32 s7, s7, 16
    s_lshl_b32 s63, s60, 14
    s_add_u32 s7, s7, s63
    s_add_u32 s7, s7, 0x0
    v_lshl_add_u32 v4, v1, 4, s7
    s_and_b32 s7, s60, 1
    s_lshl_b32 s7, s7, 7
    v_lshlrev_b32 v3, 3, v1
    v_xor_b32 v3, s7, v3
    s_lshl_b32 s7, s60, 13
    s_add_u32 s7, s7, 0x18000
    v_add_u32 v3, s7, v3
    s_mov_b32 s44, s20
    s_and_b32 s45, s21, 0xffff
    s_mov_b32 s46, 0x1000000
    s_mov_b32 s47, 0x20000
    s_lshl_b32 s7, s64, 18
    s_lshl_b32 s65, s60, 10
    s_add_u32 s65, s65, s7
    s_add_u32 s65, s65, 196608
    s_lshl_b32 s7, s60, 6
    v_xor_b32 v12, s7, v2
    v_xor_b32 v13, 16, v12
    v_xor_b32 v14, 32, v12
    v_xor_b32 v15, 48, v12
    v_mov_b32 v160, 0x2404c
    s_mov_b32 s80, 1600000
LW_99:
    ds_read_b32 v161, v160
    s_waitcnt lgkmcnt(0)
    v_readfirstlane_b32 s79, v161
    s_cmp_ge_u32 s79, 1
    s_cbranch_scc1 LWD_100
    s_sleep 4
    s_sub_u32 s80, s80, 1
    s_cmp_lg_u32 s80, 0
    s_cbranch_scc1 LW_99
LWD_100:
    v_mov_b32 v160, 0x24050
    ds_read_b64 v[162:163], v160
    s_waitcnt lgkmcnt(0)
    v_readfirstlane_b32 s94, v162
    v_readfirstlane_b32 s95, v163
    v_mov_b32 v160, 0x24018
    s_mov_b32 s80, 1600000
LW_101:
    ds_read_b32 v161, v160
    s_waitcnt lgkmcnt(0)
    v_readfirstlane_b32 s79, v161
    s_cmp_ge_u32 s79, 8
    s_cbranch_scc1 LWD_102
    s_sleep 2
    s_sub_u32 s80, s80, 1
    s_cmp_lg_u32 s80, 0
    s_cbranch_scc1 LW_101
LWD_102:
    s_sleep 1
    s_mov_b32 s67, 4096
    s_mov_b32 s68, 8192
    s_mov_b32 s69, 12288
    buffer_load_dwordx4 v[96:99], v4, s[36:39], 0 offen offset:0 sc1
    buffer_load_dwordx4 v[100:103], v4, s[36:39], 0 offen offset:1024 sc1
    buffer_load_dwordx4 v[104:107], v4, s[36:39], 0 offen offset:2048 sc1
    buffer_load_dwordx4 v[108:111], v4, s[36:39], 0 offen offset:3072 sc1
    buffer_load_dwordx4 v[112:115], v4, s[36:39], s67 offen offset:0 sc1
    buffer_load_dwordx4 v[116:119], v4, s[36:39], s67 offen offset:1024 sc1
    buffer_load_dwordx4 v[120:123], v4, s[36:39], s67 offen offset:2048 sc1
    buffer_load_dwordx4 v[124:127], v4, s[36:39], s67 offen offset:3072 sc1
    buffer_load_dwordx4 v[128:131], v4, s[36:39], s68 offen offset:0 sc1
    buffer_load_dwordx4 v[132:135], v4, s[36:39], s68 offen offset:1024 sc1
    buffer_load_dwordx4 v[136:139], v4, s[36:39], s68 offen offset:2048 sc1
    buffer_load_dwordx4 v[140:143], v4, s[36:39], s68 offen offset:3072 sc1
    buffer_load_dwordx4 v[144:147], v4, s[36:39], s69 offen offset:0 sc1
    buffer_load_dwordx4 v[148:151], v4, s[36:39], s69 offen offset:1024 sc1
    buffer_load_dwordx4 v[152:155], v4, s[36:39], s69 offen offset:2048 sc1
    buffer_load_dwordx4 v[156:159], v4, s[36:39], s69 offen offset:3072 sc1
    s_mov_b32 s80, 200000
PS_103:
    s_waitcnt vmcnt(0)
    s_mov_b32 s78, 0
    v_cmp_ne_u64 vcc, s[94:95], v[98:99]
    s_cbranch_vccz PSS_105
    buffer_load_dwordx4 v[96:99], v4, s[36:39], 0 offen offset:0 sc1
    s_mov_b32 s78, 1
PSS_105:
    v_cmp_ne_u64 vcc, s[94:95], v[102:103]
    s_cbranch_vccz PSS_106
    buffer_load_dwordx4 v[100:103], v4, s[36:39], 0 offen offset:1024 sc1
    s_mov_b32 s78, 1
PSS_106:
    v_cmp_ne_u64 vcc, s[94:95], v[106:107]
    s_cbranch_vccz PSS_107
    buffer_load_dwordx4 v[104:107], v4, s[36:39], 0 offen offset:2048 sc1
    s_mov_b32 s78, 1
PSS_107:
    v_cmp_ne_u64 vcc, s[94:95], v[110:111]
    s_cbranch_vccz PSS_108
    buffer_load_dwordx4 v[108:111], v4, s[36:39], 0 offen offset:3072 sc1
    s_mov_b32 s78, 1
PSS_108:
    v_cmp_ne_u64 vcc, s[94:95], v[114:115]
    s_cbranch_vccz PSS_109
    buffer_load_dwordx4 v[112:115], v4, s[36:39], s67 offen offset:0 sc1
    s_mov_b32 s78, 1
PSS_109:
    v_cmp_ne_u64 vcc, s[94:95], v[118:119]
    s_cbranch_vccz PSS_110
    buffer_load_dwordx4 v[116:119], v4, s[36:39], s67 offen offset:1024 sc1
    s_mov_b32 s78, 1
PSS_110:
    v_cmp_ne_u64 vcc, s[94:95], v[122:123]
    s_cbranch_vccz PSS_111
    buffer_load_dwordx4 v[120:123], v4, s[36:39], s67 offen offset:2048 sc1
    s_mov_b32 s78, 1
PSS_111:
    v_cmp_ne_u64 vcc, s[94:95], v[126:127]
    s_cbranch_vccz PSS_112
    buffer_load_dwordx4 v[124:127], v4, s[36:39], s67 offen offset:3072 sc1
    s_mov_b32 s78, 1
PSS_112:
    v_cmp_ne_u64 vcc, s[94:95], v[130:131]
    s_cbranch_vccz PSS_113
    buffer_load_dwordx4 v[128:131], v4, s[36:39], s68 offen offset:0 sc1
    s_mov_b32 s78, 1
PSS_113:
    v_cmp_ne_u64 vcc, s[94:95], v[134:135]
    s_cbranch_vccz PSS_114
    buffer_load_dwordx4 v[132:135], v4, s[36:39], s68 offen offset:1024 sc1
    s_mov_b32 s78, 1
PSS_114:
    v_cmp_ne_u64 vcc, s[94:95], v[138:139]
    s_cbranch_vccz PSS_115
    buffer_load_dwordx4 v[136:139], v4, s[36:39], s68 offen offset:2048 sc1
    s_mov_b32 s78, 1
PSS_115:
    v_cmp_ne_u64 vcc, s[94:95], v[142:143]
    s_cbranch_vccz PSS_116
    buffer_load_dwordx4 v[140:143], v4, s[36:39], s68 offen offset:3072 sc1
    s_mov_b32 s78, 1
PSS_116:
    v_cmp_ne_u64 vcc, s[94:95], v[146:147]
    s_cbranch_vccz PSS_117
    buffer_load_dwordx4 v[144:147], v4, s[36:39], s69 offen offset:0 sc1
    s_mov_b32 s78, 1
PSS_117:
    v_cmp_ne_u64 vcc, s[94:95], v[150:151]
    s_cbranch_vccz PSS_118
    buffer_load_dwordx4 v[148:151], v4, s[36:39], s69 offen offset:1024 sc1
    s_mov_b32 s78, 1
PSS_118:
    v_cmp_ne_u64 vcc, s[94:95], v[154:155]
    s_cbranch_vccz PSS_119
    buffer_load_dwordx4 v[152:155], v4, s[36:39], s69 offen offset:2048 sc1
    s_mov_b32 s78, 1
PSS_119:
    v_cmp_ne_u64 vcc, s[94:95], v[158:159]
    s_cbranch_vccz PSS_120
    buffer_load_dwordx4 v[156:159], v4, s[36:39], s69 offen offset:3072 sc1
    s_mov_b32 s78, 1
PSS_120:
    s_cmp_eq_u32 s78, 0
    s_cbranch_scc1 PSD_104
    s_sub_u32 s80, s80, 1
    s_cmp_lg_u32 s80, 0
    s_cbranch_scc1 PS_103
    s_waitcnt vmcnt(0)
PSD_104:
    buffer_load_dwordx4 v[32:35], v12, s[44:47], s65 offen nt
    s_addk_i32 s65, 4096
    buffer_load_dwordx4 v[36:39], v13, s[44:47], s65 offen nt
    s_addk_i32 s65, 4096
    buffer_load_dwordx4 v[40:43], v14, s[44:47], s65 offen nt
    s_addk_i32 s65, 4096
    buffer_load_dwordx4 v[44:47], v15, s[44:47], s65 offen nt
    s_addk_i32 s65, 4096
    buffer_load_dwordx4 v[48:51], v12, s[44:47], s65 offen nt
    s_addk_i32 s65, 4096
    buffer_load_dwordx4 v[52:55], v13, s[44:47], s65 offen nt
    s_addk_i32 s65, 4096
    buffer_load_dwordx4 v[56:59], v14, s[44:47], s65 offen nt
    s_addk_i32 s65, 4096
    buffer_load_dwordx4 v[60:63], v15, s[44:47], s65 offen nt
    s_addk_i32 s65, 4096
    v_xor_b32 v6, 0x0, v3
    ds_write_b64 v6, v[96:97] offset:0
    ds_write_b64 v6, v[100:101] offset:512
    v_xor_b32 v7, 0x10, v3
    ds_write_b64 v7, v[104:105] offset:1024
    ds_write_b64 v7, v[108:109] offset:1536
    v_xor_b32 v6, 0x20, v3
    ds_write_b64 v6, v[112:113] offset:2048
    ds_write_b64 v6, v[116:117] offset:2560
    v_xor_b32 v7, 0x30, v3
    ds_write_b64 v7, v[120:121] offset:3072
    ds_write_b64 v7, v[124:125] offset:3584
    v_xor_b32 v6, 0x40, v3
    ds_write_b64 v6, v[128:129] offset:4096
    ds_write_b64 v6, v[132:133] offset:4608
    v_xor_b32 v7, 0x50, v3
    ds_write_b64 v7, v[136:137] offset:5120
    ds_write_b64 v7, v[140:141] offset:5632
    v_xor_b32 v6, 0x60, v3
    ds_write_b64 v6, v[144:145] offset:6144
    ds_write_b64 v6, v[148:149] offset:6656
    v_xor_b32 v7, 0x70, v3
    ds_write_b64 v7, v[152:153] offset:7168
    ds_write_b64 v7, v[156:157] offset:7680
L_CCUT:
    s_waitcnt lgkmcnt(0)
    s_barrier
    s_setprio 0
    s_barrier
    s_barrier
    buffer_load_dwordx4 v[64:67], v12, s[44:47], s65 offen nt
    s_addk_i32 s65, 4096
    buffer_load_dwordx4 v[68:71], v13, s[44:47], s65 offen nt
    s_addk_i32 s65, 4096
    buffer_load_dwordx4 v[72:75], v14, s[44:47], s65 offen nt
    s_addk_i32 s65, 4096
    buffer_load_dwordx4 v[76:79], v15, s[44:47], s65 offen nt
    s_addk_i32 s65, 4096
    buffer_load_dwordx4 v[80:83], v12, s[44:47], s65 offen nt
    s_addk_i32 s65, 4096
    buffer_load_dwordx4 v[84:87], v13, s[44:47], s65 offen nt
    s_addk_i32 s65, 4096
    buffer_load_dwordx4 v[88:91], v14, s[44:47], s65 offen nt
    s_addk_i32 s65, 4096
    buffer_load_dwordx4 v[92:95], v15, s[44:47], s65 offen nt
    s_addk_i32 s65, 4096
    s_barrier
    s_barrier
    s_barrier
    s_setprio 3
    s_lshl_b32 s7, s60, 10
    v_add_u32 v3, s7, v2
    s_waitcnt vmcnt(15)
    ds_write_b128 v3, v[32:35] offset:0
    s_waitcnt vmcnt(14)
    ds_write_b128 v3, v[36:39] offset:4096
    s_waitcnt vmcnt(13)
    ds_write_b128 v3, v[40:43] offset:8192
    s_waitcnt vmcnt(12)
    ds_write_b128 v3, v[44:47] offset:12288
    s_waitcnt vmcnt(11)
    ds_write_b128 v3, v[48:51] offset:16384
    s_waitcnt vmcnt(10)
    ds_write_b128 v3, v[52:55] offset:20480
    s_waitcnt vmcnt(9)
    ds_write_b128 v3, v[56:59] offset:24576
    s_waitcnt vmcnt(8)
    ds_write_b128 v3, v[60:63] offset:28672
    s_waitcnt vmcnt(7)
    ds_write_b128 v3, v[64:67] offset:32768
    s_waitcnt vmcnt(6)
    ds_write_b128 v3, v[68:71] offset:36864
    s_waitcnt vmcnt(5)
    ds_write_b128 v3, v[72:75] offset:40960
    s_waitcnt vmcnt(4)
    ds_write_b128 v3, v[76:79] offset:45056
    s_waitcnt vmcnt(3)
    ds_write_b128 v3, v[80:83] offset:49152
    s_waitcnt vmcnt(2)
    ds_write_b128 v3, v[84:87] offset:53248
    s_waitcnt vmcnt(1)
    ds_write_b128 v3, v[88:91] offset:57344
    s_waitcnt vmcnt(0)
    ds_write_b128 v3, v[92:95] offset:61440
    s_waitcnt lgkmcnt(0)
    s_endpgm
.p2align 12
LT_U1:
    s_branch LR_U1
L_U1:
    s_mov_b32 s48, s26
    s_and_b32 s49, s27, 0xffff
    s_mov_b32 s50, 0x400000
    s_mov_b32 s51, 0x20000
    v_lshrrev_b32 v162, 4, v1
    v_lshlrev_b32 v2, 16, v162
    v_and_b32 v160, 15, v1
    v_lshl_add_u32 v2, v160, 4, v2
    s_lshl_b32 s7, s6, 8
    v_add_u32 v2, s7, v2
    s_lshl_b32 s70, s3, 19
    s_waitcnt vmcnt(2)
    buffer_load_dwordx4 v[8:11], v2, s[48:51], s70 offen nt
    s_add_u32 s70, s70, 8192
    s_waitcnt vmcnt(2)
    buffer_load_dwordx4 v[12:15], v2, s[48:51], s70 offen nt
    s_add_u32 s70, s70, 8192
    s_waitcnt vmcnt(2)
    buffer_load_dwordx4 v[16:19], v2, s[48:51], s70 offen nt
    s_add_u32 s70, s70, 8192
    s_waitcnt vmcnt(2)
    buffer_load_dwordx4 v[20:23], v2, s[48:51], s70 offen nt
    s_add_u32 s70, s70, 8192
    s_waitcnt vmcnt(2)
    buffer_load_dwordx4 v[24:27], v2, s[48:51], s70 offen nt
    s_add_u32 s70, s70, 8192
    s_waitcnt vmcnt(2)
    buffer_load_dwordx4 v[28:31], v2, s[48:51], s70 offen nt
    s_add_u32 s70, s70, 8192
    s_waitcnt vmcnt(2)
    buffer_load_dwordx4 v[32:35], v2, s[48:51], s70 offen nt
    s_add_u32 s70, s70, 8192
    s_waitcnt vmcnt(2)
    buffer_load_dwordx4 v[36:39], v2, s[48:51], s70 offen nt
    s_add_u32 s70, s70, 204800
    s_waitcnt vmcnt(2)
    buffer_load_dwordx4 v[104:107], v2, s[48:51], s70 offen nt
    s_add_u32 s70, s70, 8192
    s_waitcnt vmcnt(2)
    buffer_load_dwordx4 v[108:111], v2, s[48:51], s70 offen nt
    s_add_u32 s70, s70, 8192
    s_waitcnt vmcnt(2)
    buffer_load_dwordx4 v[112:115], v2, s[48:51], s70 offen nt
    s_add_u32 s70, s70, 8192
    s_waitcnt vmcnt(2)
    buffer_load_dwordx4 v[116:119], v2, s[48:51], s70 offen nt
    s_add_u32 s70, s70, 8192
    s_waitcnt vmcnt(2)
    buffer_load_dwordx4 v[120:123], v2, s[48:51], s70 offen nt
    s_add_u32 s70, s70, 8192
    s_waitcnt vmcnt(2)
    buffer_load_dwordx4 v[124:127], v2, s[48:51], s70 offen nt
    s_add_u32 s70, s70, 8192
    s_waitcnt vmcnt(2)
    buffer_load_dwordx4 v[128:131], v2, s[48:51], s70 offen nt
    s_add_u32 s70, s70, 8192
    s_waitcnt vmcnt(2)
    buffer_load_dwordx4 v[132:135], v2, s[48:51], s70 offen nt
    s_add_u32 s70, s70, 204800
    v_lshlrev_b32 v3, 4, v1
    v_add_u32 v3, 0x24800, v3
    v_lshrrev_b32 v4, 1, v160
    v_lshlrev_b32 v4, 18, v4
    v_lshl_add_u32 v4, v162, 4, v4
    v_and_b32 v163, 1, v1
    v_lshl_add_u32 v4, v163, 6, v4
    v_cmp_eq_u32 s[86:87], 1, v163
    s_lshl_b32 s7, s3, 5
    s_add_u32 s7, s7, s6
    s_lshl_b32 s7, s7, 7
    s_add_u32 s7, s7, 0x500000
    v_add_u32 v4, s7, v4
    s_lshl_b32 s7, s3, 11
    s_add_u32 s7, s7, 0x10000
    v_lshl_add_u32 v5, v1, 5, s7
    v_perm_b32 v40, v12, v8, s92
    v_perm_b32 v41, v20, v16, s92
    v_perm_b32 v42, v28, v24, s92
    v_perm_b32 v43, v36, v32, s92
    v_perm_b32 v44, v12, v8, s93
    v_perm_b32 v45, v20, v16, s93
    v_perm_b32 v46, v28, v24, s93
    v_perm_b32 v47, v36, v32, s93
    v_perm_b32 v48, v13, v9, s92
    v_perm_b32 v49, v21, v17, s92
    v_perm_b32 v50, v29, v25, s92
    v_perm_b32 v51, v37, v33, s92
    v_perm_b32 v52, v13, v9, s93
    v_perm_b32 v53, v21, v17, s93
    v_perm_b32 v54, v29, v25, s93
    v_perm_b32 v55, v37, v33, s93
    v_perm_b32 v56, v14, v10, s92
    v_perm_b32 v57, v22, v18, s92
    v_perm_b32 v58, v30, v26, s92
    v_perm_b32 v59, v38, v34, s92
    v_perm_b32 v60, v14, v10, s93
    v_perm_b32 v61, v22, v18, s93
    v_perm_b32 v62, v30, v26, s93
    v_perm_b32 v63, v38, v34, s93
    v_perm_b32 v64, v15, v11, s92
    v_perm_b32 v65, v23, v19, s92
    v_perm_b32 v66, v31, v27, s92
    v_perm_b32 v67, v39, v35, s92
    v_perm_b32 v68, v15, v11, s93
    v_perm_b32 v69, v23, v19, s93
    v_perm_b32 v70, v31, v27, s93
    v_perm_b32 v71, v39, v35, s93
    s_waitcnt vmcnt(0)
    v_perm_b32 v72, v108, v104, s92
    v_perm_b32 v73, v116, v112, s92
    v_perm_b32 v74, v124, v120, s92
    v_perm_b32 v75, v132, v128, s92
    v_perm_b32 v76, v108, v104, s93
    v_perm_b32 v77, v116, v112, s93
    v_perm_b32 v78, v124, v120, s93
    v_perm_b32 v79, v132, v128, s93
    v_perm_b32 v80, v109, v105, s92
    v_perm_b32 v81, v117, v113, s92
    v_perm_b32 v82, v125, v121, s92
    v_perm_b32 v83, v133, v129, s92
    v_perm_b32 v84, v109, v105, s93
    v_perm_b32 v85, v117, v113, s93
    v_perm_b32 v86, v125, v121, s93
    v_perm_b32 v87, v133, v129, s93
    v_perm_b32 v88, v110, v106, s92
    v_perm_b32 v89, v118, v114, s92
    v_perm_b32 v90, v126, v122, s92
    v_perm_b32 v91, v134, v130, s92
    v_perm_b32 v92, v110, v106, s93
    v_perm_b32 v93, v118, v114, s93
    v_perm_b32 v94, v126, v122, s93
    v_perm_b32 v95, v134, v130, s93
    v_perm_b32 v96, v111, v107, s92
    v_perm_b32 v97, v119, v115, s92
    v_perm_b32 v98, v127, v123, s92
    v_perm_b32 v99, v135, v131, s92
    v_perm_b32 v100, v111, v107, s93
    v_perm_b32 v101, v119, v115, s93
    v_perm_b32 v102, v127, v123, s93
    v_perm_b32 v103, v135, v131, s93
    v_mov_b32 v160, 0x2404c
    s_mov_b32 s80, 1600000
LW_47:
    ds_read_b32 v161, v160
    s_waitcnt lgkmcnt(0)
    v_readfirstlane_b32 s79, v161
    s_cmp_ge_u32 s79, 1
    s_cbranch_scc1 LWD_48
    s_sleep 2
    s_sub_u32 s80, s80, 1
    s_cmp_lg_u32 s80, 0
    s_cbranch_scc1 LW_47
LWD_48:
    v_mov_b32 v160, 0x24050
    ds_read_b64 v[162:163], v160
    s_waitcnt lgkmcnt(0)
    v_readfirstlane_b32 s94, v162
    v_readfirstlane_b32 s95, v163
    v_mov_b32 v160, 0x2401c
    s_mov_b32 s80, 1600000
LW_49:
    ds_read_b32 v161, v160
    s_waitcnt lgkmcnt(0)
    v_readfirstlane_b32 s79, v161
    s_cmp_ge_u32 s79, 1
    s_cbranch_scc1 LWD_50
    s_sleep 4
    s_sub_u32 s80, s80, 1
    s_cmp_lg_u32 s80, 0
    s_cbranch_scc1 LW_49
LWD_50:
    s_setprio 3
    s_mov_b64 s[88:89], 0
    s_mov_b32 s80, 1600000
UM_51:
    ds_read_b128 v[136:139], v3
    s_waitcnt lgkmcnt(0)
    v_cmp_ne_u64 vcc, s[94:95], v[138:139]
    s_or_b64 s[90:91], vcc, s[88:89]
    s_and_b32 s7, s90, 0x5555
    s_cbranch_scc1 UMS_53
    s_mov_b32 s70, 0
    buffer_load_dwordx4 v[8:11], v4, s[36:39], s70 offen sc1
    s_or_b32 s88, s88, 0x5555
UMS_53:
    s_and_b32 s7, s90, 0x55550000
    s_cbranch_scc1 UMS_54
    s_mov_b32 s70, 32768
    buffer_load_dwordx4 v[12:15], v4, s[36:39], s70 offen sc1
    s_or_b32 s88, s88, 0x55550000
UMS_54:
    s_and_b32 s7, s91, 0x5555
    s_cbranch_scc1 UMS_55
    s_mov_b32 s70, 65536
    buffer_load_dwordx4 v[16:19], v4, s[36:39], s70 offen sc1
    s_or_b32 s89, s89, 0x5555
UMS_55:
    s_and_b32 s7, s91, 0x55550000
    s_cbranch_scc1 UMS_56
    s_mov_b32 s70, 98304
    buffer_load_dwordx4 v[20:23], v4, s[36:39], s70 offen sc1
    s_or_b32 s89, s89, 0x55550000
UMS_56:
    s_and_b32 s7, s90, 0xaaaa
    s_cbranch_scc1 UMS_57
    s_mov_b32 s70, 131072
    buffer_load_dwordx4 v[24:27], v4, s[36:39], s70 offen sc1
    s_or_b32 s88, s88, 0xaaaa
UMS_57:
    s_and_b32 s7, s90, 0xaaaa0000
    s_cbranch_scc1 UMS_58
    s_mov_b32 s70, 163840
    buffer_load_dwordx4 v[28:31], v4, s[36:39], s70 offen sc1
    s_or_b32 s88, s88, 0xaaaa0000
UMS_58:
    s_and_b32 s7, s91, 0xaaaa
    s_cbranch_scc1 UMS_59
    s_mov_b32 s70, 196608
    buffer_load_dwordx4 v[32:35], v4, s[36:39], s70 offen sc1
    s_or_b32 s89, s89, 0xaaaa
UMS_59:
    s_and_b32 s7, s91, 0xaaaa0000
    s_cbranch_scc1 UMS_60
    s_mov_b32 s70, 229376
    buffer_load_dwordx4 v[36:39], v4, s[36:39], s70 offen sc1
    s_or_b32 s89, s89, 0xaaaa0000
UMS_60:
    s_cbranch_vccz UMD_52
    s_sleep 1
    s_sub_u32 s80, s80, 1
    s_cmp_lg_u32 s80, 0
    s_cbranch_scc1 UM_51
UMD_52:
    v_max_f32_dpp v138, v136, v136 quad_perm:[1,0,3,2] row_mask:0xf bank_mask:0xf
    s_nop 1
    v_max_f32_dpp v138, v138, v138 quad_perm:[2,3,0,1] row_mask:0xf bank_mask:0xf
    v_mov_b32 v139, v138
    s_nop 1
    v_permlane32_swap_b32 v138, v139
    v_max_f32 v138, v138, v139
    v_mov_b32 v139, v138
    s_nop 1
    v_permlane16_swap_b32 v138, v139
    v_max_f32 v138, v138, v139
    v_sub_f32 v136, v136, v138
    v_exp_f32 v136, v136
    s_nop 0
    v_mul_f32 v137, v137, v136
    s_nop 1
    v_add_f32_dpp v137, v137, v137 quad_perm:[1,0,3,2] row_mask:0xf bank_mask:0xf
    s_nop 1
    v_add_f32_dpp v137, v137, v137 quad_perm:[2,3,0,1] row_mask:0xf bank_mask:0xf
    v_mov_b32 v138, v137
    s_nop 1
    v_permlane32_swap_b32 v137, v138
    v_add_f32 v137, v137, v138
    v_mov_b32 v138, v137
    s_nop 1
    v_permlane16_swap_b32 v137, v138
    v_add_f32 v137, v137, v138
    v_rcp_f32 v137, v137
    s_nop 0
    v_mul_f32 v136, v136, v137
    v_mov_b32 v137, v136
    s_nop 1
    v_permlane16_swap_b32 v136, v137
    v_mov_b32 v138, v136
    v_mov_b32 v139, v137
    s_nop 0
    v_permlane32_swap_b32 v136, v138
    v_permlane32_swap_b32 v137, v139
    s_nop 0
    v_mov_b32_dpp v148, v136 quad_perm:[0,0,2,2] row_mask:0xf bank_mask:0xf
    v_mov_b32_dpp v149, v137 quad_perm:[0,0,2,2] row_mask:0xf bank_mask:0xf
    v_mov_b32_dpp v150, v138 quad_perm:[0,0,2,2] row_mask:0xf bank_mask:0xf
    v_mov_b32_dpp v151, v139 quad_perm:[0,0,2,2] row_mask:0xf bank_mask:0xf
    v_mov_b32_dpp v152, v136 quad_perm:[1,1,3,3] row_mask:0xf bank_mask:0xf
    v_mov_b32_dpp v153, v137 quad_perm:[1,1,3,3] row_mask:0xf bank_mask:0xf
    v_mov_b32_dpp v154, v138 quad_perm:[1,1,3,3] row_mask:0xf bank_mask:0xf
    v_mov_b32_dpp v155, v139 quad_perm:[1,1,3,3] row_mask:0xf bank_mask:0xf
    s_waitcnt vmcnt(0)
    v_lshlrev_b32 v104, 16, v8
    v_and_b32 v105, 0xffff0000, v8
    v_lshlrev_b32 v106, 16, v9
    v_and_b32 v107, 0xffff0000, v9
    v_lshlrev_b32 v108, 16, v10
    v_and_b32 v109, 0xffff0000, v10
    v_lshlrev_b32 v110, 16, v11
    v_and_b32 v111, 0xffff0000, v11
    v_mul_f32 v120, v104, v148
    v_mul_f32 v121, v105, v148
    v_mul_f32 v122, v106, v148
    v_mul_f32 v123, v107, v148
    v_mul_f32 v124, v108, v148
    v_mul_f32 v125, v109, v148
    v_mul_f32 v126, v110, v148
    v_mul_f32 v127, v111, v148
    v_lshlrev_b32 v112, 16, v12
    v_and_b32 v113, 0xffff0000, v12
    v_lshlrev_b32 v114, 16, v13
    v_and_b32 v115, 0xffff0000, v13
    v_lshlrev_b32 v116, 16, v14
    v_and_b32 v117, 0xffff0000, v14
    v_lshlrev_b32 v118, 16, v15
    v_and_b32 v119, 0xffff0000, v15
    v_fmac_f32 v120, v112, v149
    v_fmac_f32 v121, v113, v149
    v_fmac_f32 v122, v114, v149
    v_fmac_f32 v123, v115, v149
    v_fmac_f32 v124, v116, v149
    v_fmac_f32 v125, v117, v149
    v_fmac_f32 v126, v118, v149
    v_fmac_f32 v127, v119, v149
    v_lshlrev_b32 v104, 16, v16
    v_and_b32 v105, 0xffff0000, v16
    v_lshlrev_b32 v106, 16, v17
    v_and_b32 v107, 0xffff0000, v17
    v_lshlrev_b32 v108, 16, v18
    v_and_b32 v109, 0xffff0000, v18
    v_lshlrev_b32 v110, 16, v19
    v_and_b32 v111, 0xffff0000, v19
    v_fmac_f32 v120, v104, v150
    v_fmac_f32 v121, v105, v150
    v_fmac_f32 v122, v106, v150
    v_fmac_f32 v123, v107, v150
    v_fmac_f32 v124, v108, v150
    v_fmac_f32 v125, v109, v150
    v_fmac_f32 v126, v110, v150
    v_fmac_f32 v127, v111, v150
    v_lshlrev_b32 v112, 16, v20
    v_and_b32 v113, 0xffff0000, v20
    v_lshlrev_b32 v114, 16, v21
    v_and_b32 v115, 0xffff0000, v21
    v_lshlrev_b32 v116, 16, v22
    v_and_b32 v117, 0xffff0000, v22
    v_lshlrev_b32 v118, 16, v23
    v_and_b32 v119, 0xffff0000, v23
    v_fmac_f32 v120, v112, v151
    v_fmac_f32 v121, v113, v151
    v_fmac_f32 v122, v114, v151
    v_fmac_f32 v123, v115, v151
    v_fmac_f32 v124, v116, v151
    v_fmac_f32 v125, v117, v151
    v_fmac_f32 v126, v118, v151
    v_fmac_f32 v127, v119, v151
    v_lshlrev_b32 v104, 16, v24
    v_and_b32 v105, 0xffff0000, v24
    v_lshlrev_b32 v106, 16, v25
    v_and_b32 v107, 0xffff0000, v25
    v_lshlrev_b32 v108, 16, v26
    v_and_b32 v109, 0xffff0000, v26
    v_lshlrev_b32 v110, 16, v27
    v_and_b32 v111, 0xffff0000, v27
    v_fmac_f32 v120, v104, v152
    v_fmac_f32 v121, v105, v152
    v_fmac_f32 v122, v106, v152
    v_fmac_f32 v123, v107, v152
    v_fmac_f32 v124, v108, v152
    v_fmac_f32 v125, v109, v152
    v_fmac_f32 v126, v110, v152
    v_fmac_f32 v127, v111, v152
    v_lshlrev_b32 v112, 16, v28
    v_and_b32 v113, 0xffff0000, v28
    v_lshlrev_b32 v114, 16, v29
    v_and_b32 v115, 0xffff0000, v29
    v_lshlrev_b32 v116, 16, v30
    v_and_b32 v117, 0xffff0000, v30
    v_lshlrev_b32 v118, 16, v31
    v_and_b32 v119, 0xffff0000, v31
    v_fmac_f32 v120, v112, v153
    v_fmac_f32 v121, v113, v153
    v_fmac_f32 v122, v114, v153
    v_fmac_f32 v123, v115, v153
    v_fmac_f32 v124, v116, v153
    v_fmac_f32 v125, v117, v153
    v_fmac_f32 v126, v118, v153
    v_fmac_f32 v127, v119, v153
    v_lshlrev_b32 v104, 16, v32
    v_and_b32 v105, 0xffff0000, v32
    v_lshlrev_b32 v106, 16, v33
    v_and_b32 v107, 0xffff0000, v33
    v_lshlrev_b32 v108, 16, v34
    v_and_b32 v109, 0xffff0000, v34
    v_lshlrev_b32 v110, 16, v35
    v_and_b32 v111, 0xffff0000, v35
    v_fmac_f32 v120, v104, v154
    v_fmac_f32 v121, v105, v154
    v_fmac_f32 v122, v106, v154
    v_fmac_f32 v123, v107, v154
    v_fmac_f32 v124, v108, v154
    v_fmac_f32 v125, v109, v154
    v_fmac_f32 v126, v110, v154
    v_fmac_f32 v127, v111, v154
    v_lshlrev_b32 v112, 16, v36
    v_and_b32 v113, 0xffff0000, v36
    v_lshlrev_b32 v114, 16, v37
    v_and_b32 v115, 0xffff0000, v37
    v_lshlrev_b32 v116, 16, v38
    v_and_b32 v117, 0xffff0000, v38
    v_lshlrev_b32 v118, 16, v39
    v_and_b32 v119, 0xffff0000, v39
    v_fmac_f32 v120, v112, v155
    v_fmac_f32 v121, v113, v155
    v_fmac_f32 v122, v114, v155
    v_fmac_f32 v123, v115, v155
    v_fmac_f32 v124, v116, v155
    v_fmac_f32 v125, v117, v155
    v_fmac_f32 v126, v118, v155
    v_fmac_f32 v127, v119, v155
    v_cvt_pk_bf16_f32 v128, v120, v121
    v_cvt_pk_bf16_f32 v129, v122, v123
    v_cvt_pk_bf16_f32 v130, v124, v125
    v_cvt_pk_bf16_f32 v131, v126, v127
    v_cndmask_b32 v140, v128, 0, s[86:87]
    v_cndmask_b32 v144, 0, v128, s[86:87]
    v_cndmask_b32 v141, v129, 0, s[86:87]
    v_cndmask_b32 v145, 0, v129, s[86:87]
    v_cndmask_b32 v142, v130, 0, s[86:87]
    v_cndmask_b32 v146, 0, v130, s[86:87]
    v_cndmask_b32 v143, v131, 0, s[86:87]
    v_cndmask_b32 v147, 0, v131, s[86:87]
    s_nop 0
    v_mfma_f32_16x16x32_bf16 v[8:11], v[140:143], v[40:43], 0
    v_mfma_f32_16x16x32_bf16 v[12:15], v[140:143], v[44:47], 0
    v_mfma_f32_16x16x32_bf16 v[16:19], v[140:143], v[48:51], 0
    v_mfma_f32_16x16x32_bf16 v[20:23], v[140:143], v[52:55], 0
    v_mfma_f32_16x16x32_bf16 v[24:27], v[140:143], v[56:59], 0
    v_mfma_f32_16x16x32_bf16 v[28:31], v[140:143], v[60:63], 0
    v_mfma_f32_16x16x32_bf16 v[32:35], v[140:143], v[64:67], 0
    v_mfma_f32_16x16x32_bf16 v[36:39], v[140:143], v[68:71], 0
    v_mfma_f32_16x16x32_bf16 v[8:11], v[144:147], v[72:75], v[8:11]
    v_mfma_f32_16x16x32_bf16 v[12:15], v[144:147], v[76:79], v[12:15]
    v_mfma_f32_16x16x32_bf16 v[16:19], v[144:147], v[80:83], v[16:19]
    v_mfma_f32_16x16x32_bf16 v[20:23], v[144:147], v[84:87], v[20:23]
    v_mfma_f32_16x16x32_bf16 v[24:27], v[144:147], v[88:91], v[24:27]
    v_mfma_f32_16x16x32_bf16 v[28:31], v[144:147], v[92:95], v[28:31]
    v_mfma_f32_16x16x32_bf16 v[32:35], v[144:147], v[96:99], v[32:35]
    v_mfma_f32_16x16x32_bf16 v[36:39], v[144:147], v[100:103], v[36:39]
    s_nop 0
    v_add_f32 v8, v8, v10
    v_add_f32 v9, v9, v11
    v_add_f32 v12, v12, v14
    v_add_f32 v13, v13, v15
    v_add_f32 v16, v16, v18
    v_add_f32 v17, v17, v19
    v_add_f32 v20, v20, v22
    v_add_f32 v21, v21, v23
    v_add_f32 v24, v24, v26
    v_add_f32 v25, v25, v27
    v_add_f32 v28, v28, v30
    v_add_f32 v29, v29, v31
    v_add_f32 v32, v32, v34
    v_add_f32 v33, v33, v35
    v_add_f32 v36, v36, v38
    v_add_f32 v37, v37, v39
    v_add_f32 v104, v8, v9
    v_add_f32 v105, v12, v13
    v_add_f32 v106, v16, v17
    v_add_f32 v107, v20, v21
    v_add_f32 v108, v24, v25
    v_add_f32 v109, v28, v29
    v_add_f32 v110, v32, v33
    v_add_f32 v111, v36, v37
    ds_write_b128 v5, v[104:107]
    ds_write_b128 v5, v[108:111] offset:16
    v_and_b32 v160, 31, v1
    s_lshl_b32 s7, s3, 8
    s_add_u32 s7, s7, 0x10000
    v_lshl_add_u32 v5, v160, 3, s7
    s_lshl_b32 s7, s3, 7
    s_add_u32 s7, s7, 0x24400
    v_lshl_add_u32 v4, v160, 2, s7
    s_waitcnt lgkmcnt(0)
    s_barrier
    ds_read_b64 v[8:9], v5 offset:0
    ds_read_b64 v[10:11], v5 offset:2048
    ds_read_b64 v[12:13], v5 offset:4096
    ds_read_b64 v[14:15], v5 offset:6144
    ds_read_b64 v[16:17], v5 offset:8192
    ds_read_b64 v[18:19], v5 offset:10240
    ds_read_b64 v[20:21], v5 offset:12288
    ds_read_b64 v[22:23], v5 offset:14336
    s_waitcnt lgkmcnt(0)
    v_add_f32 v8, v8, v16
    v_add_f32 v9, v9, v17
    v_add_f32 v10, v10, v18
    v_add_f32 v11, v11, v19
    v_add_f32 v12, v12, v20
    v_add_f32 v13, v13, v21
    v_add_f32 v14, v14, v22
    v_add_f32 v15, v15, v23
    v_add_f32 v8, v8, v12
    v_add_f32 v9, v9, v13
    v_add_f32 v10, v10, v14
    v_add_f32 v11, v11, v15
    v_add_f32 v8, v8, v10
    v_add_f32 v9, v9, v11
    v_cvt_pk_bf16_f32 v8, v8, v9
    ds_write_b32 v4, v8
    s_waitcnt lgkmcnt(0)
    s_barrier
    s_endpgm
.p2align 12
LT_W2R:
    s_branch LR_W2R
L_W2R:
    s_cmp_lt_u32 s5, 4
    s_cselect_b32 s72, s28, s16
    s_cselect_b32 s73, s29, s17
    s_mov_b32 s56, s72
    s_and_b32 s57, s73, 0xffff
    s_mov_b32 s58, 0x400000
    s_mov_b32 s59, 0x20000
    v_lshrrev_b32 v4, 4, v1
    v_lshlrev_b32 v2, 13, v4
    v_and_b32 v4, 15, v1
    v_lshl_add_u32 v2, v4, 4, v2
    s_lshl_b32 s7, s6, 17
    s_lshl_b32 s70, s62, 8
    s_add_u32 s7, s7, s70
    v_add_u32 v2, s7, v2
    v_lshrrev_b32 v3, 4, v1
    v_lshlrev_b32 v3, 16, v3
    v_bfe_u32 v4, v1, 3, 1
    v_lshl_add_u32 v3, v4, 13, v3
    v_and_b32 v4, 7, v1
    v_lshl_add_u32 v3, v4, 4, v3
    s_cmp_lt_u32 s5, 4
    s_cselect_b32 s7, 0x800, 0x0
    s_add_u32 s7, s7, s6
    s_lshl_b32 s7, s7, 7
    s_add_u32 s7, s7, 0x100000
    v_add_u32 v3, s7, v3
    s_lshl_b32 s7, s62, 14
    v_add_u32 v3, s7, v3
    s_waitcnt vmcnt(0)
    v_mov_b32 v4, 0x24014
    v_mov_b32 v5, 1
    s_waitcnt lgkmcnt(0)
    s_mov_b64 exec, 1
    ds_add_u32 v4, v5
    s_mov_b64 exec, -1
    s_mov_b32 s70, 0
    v_mov_b32 v4, 0x24048
    s_mov_b32 s80, 1600000
LW_65:
    ds_read_b32 v5, v4
    s_waitcnt lgkmcnt(0)
    v_readfirstlane_b32 s79, v5
    s_cmp_ge_u32 s79, 4
    s_cbranch_scc1 LWD_66
    s_sleep 4
    s_sub_u32 s80, s80, 1
    s_cmp_lg_u32 s80, 0
    s_cbranch_scc1 LW_65
LWD_66:
    s_cmp_lt_u32 s5, 4
    s_cbranch_scc1 S2U_63
    s_sleep 36
    s_sleep 36
    s_sleep 36
    buffer_load_dwordx4 v[40:43], v2, s[56:59], s70 offen offset:0 nt
    buffer_load_dwordx4 v[44:47], v2, s[56:59], s70 offen offset:1024 nt
    buffer_load_dwordx4 v[48:51], v2, s[56:59], s70 offen offset:2048 nt
    buffer_load_dwordx4 v[52:55], v2, s[56:59], s70 offen offset:3072 nt
    s_add_u32 s70, s70, 4096
    s_waitcnt vmcnt(0)
    buffer_load_dwordx4 v[56:59], v2, s[56:59], s70 offen offset:0 nt
    buffer_load_dwordx4 v[60:63], v2, s[56:59], s70 offen offset:1024 nt
    buffer_load_dwordx4 v[64:67], v2, s[56:59], s70 offen offset:2048 nt
    buffer_load_dwordx4 v[68:71], v2, s[56:59], s70 offen offset:3072 nt
    s_add_u32 s70, s70, 28672
    s_waitcnt vmcnt(0)
    buffer_load_dwordx4 v[72:75], v2, s[56:59], s70 offen offset:0 nt
    buffer_load_dwordx4 v[76:79], v2, s[56:59], s70 offen offset:1024 nt
    buffer_load_dwordx4 v[80:83], v2, s[56:59], s70 offen offset:2048 nt
    buffer_load_dwordx4 v[84:87], v2, s[56:59], s70 offen offset:3072 nt
    s_add_u32 s70, s70, 4096
    s_waitcnt vmcnt(0)
    buffer_load_dwordx4 v[88:91], v2, s[56:59], s70 offen offset:0 nt
    buffer_load_dwordx4 v[92:95], v2, s[56:59], s70 offen offset:1024 nt
    buffer_load_dwordx4 v[96:99], v2, s[56:59], s70 offen offset:2048 nt
    buffer_load_dwordx4 v[100:103], v2, s[56:59], s70 offen offset:3072 nt
    s_add_u32 s70, s70, 28672
    s_waitcnt vmcnt(0)
    buffer_load_dwordx4 v[104:107], v2, s[56:59], s70 offen offset:0 nt
    buffer_load_dwordx4 v[108:111], v2, s[56:59], s70 offen offset:1024 nt
    buffer_load_dwordx4 v[112:115], v2, s[56:59], s70 offen offset:2048 nt
    buffer_load_dwordx4 v[116:119], v2, s[56:59], s70 offen offset:3072 nt
    s_add_u32 s70, s70, 4096
    s_waitcnt vmcnt(0)
    buffer_load_dwordx4 v[120:123], v2, s[56:59], s70 offen offset:0 nt
    buffer_load_dwordx4 v[124:127], v2, s[56:59], s70 offen offset:1024 nt
    buffer_load_dwordx4 v[128:131], v2, s[56:59], s70 offen offset:2048 nt
    buffer_load_dwordx4 v[132:135], v2, s[56:59], s70 offen offset:3072 nt
    s_add_u32 s70, s70, 28672
    s_waitcnt vmcnt(0)
    buffer_load_dwordx4 v[136:139], v2, s[56:59], s70 offen offset:0 nt
    buffer_load_dwordx4 v[140:143], v2, s[56:59], s70 offen offset:1024 nt
    buffer_load_dwordx4 v[144:147], v2, s[56:59], s70 offen offset:2048 nt
    buffer_load_dwordx4 v[148:151], v2, s[56:59], s70 offen offset:3072 nt
    s_add_u32 s70, s70, 4096
    s_waitcnt vmcnt(0)
    buffer_load_dwordx4 v[152:155], v2, s[56:59], s70 offen offset:0 nt
    buffer_load_dwordx4 v[156:159], v2, s[56:59], s70 offen offset:1024 nt
    buffer_load_dwordx4 v[160:163], v2, s[56:59], s70 offen offset:2048 nt
    buffer_load_dwordx4 v[164:167], v2, s[56:59], s70 offen offset:3072 nt
    s_add_u32 s70, s70, 28672
    s_waitcnt vmcnt(0)
    s_branch S2J_64
S2U_63:
    buffer_load_dwordx4 v[40:43], v2, s[56:59], s70 offen offset:0 nt
    buffer_load_dwordx4 v[44:47], v2, s[56:59], s70 offen offset:1024 nt
    buffer_load_dwordx4 v[48:51], v2, s[56:59], s70 offen offset:2048 nt
    buffer_load_dwordx4 v[52:55], v2, s[56:59], s70 offen offset:3072 nt
    s_add_u32 s70, s70, 4096
    s_waitcnt vmcnt(2)
    buffer_load_dwordx4 v[56:59], v2, s[56:59], s70 offen offset:0 nt
    buffer_load_dwordx4 v[60:63], v2, s[56:59], s70 offen offset:1024 nt
    buffer_load_dwordx4 v[64:67], v2, s[56:59], s70 offen offset:2048 nt
    buffer_load_dwordx4 v[68:71], v2, s[56:59], s70 offen offset:3072 nt
    s_add_u32 s70, s70, 28672
    s_waitcnt vmcnt(2)
    buffer_load_dwordx4 v[72:75], v2, s[56:59], s70 offen offset:0 nt
    buffer_load_dwordx4 v[76:79], v2, s[56:59], s70 offen offset:1024 nt
    buffer_load_dwordx4 v[80:83], v2, s[56:59], s70 offen offset:2048 nt
    buffer_load_dwordx4 v[84:87], v2, s[56:59], s70 offen offset:3072 nt
    s_add_u32 s70, s70, 4096
    s_waitcnt vmcnt(2)
    buffer_load_dwordx4 v[88:91], v2, s[56:59], s70 offen offset:0 nt
    buffer_load_dwordx4 v[92:95], v2, s[56:59], s70 offen offset:1024 nt
    buffer_load_dwordx4 v[96:99], v2, s[56:59], s70 offen offset:2048 nt
    buffer_load_dwordx4 v[100:103], v2, s[56:59], s70 offen offset:3072 nt
    s_add_u32 s70, s70, 28672
    s_waitcnt vmcnt(2)
    buffer_load_dwordx4 v[104:107], v2, s[56:59], s70 offen offset:0 nt
    buffer_load_dwordx4 v[108:111], v2, s[56:59], s70 offen offset:1024 nt
    buffer_load_dwordx4 v[112:115], v2, s[56:59], s70 offen offset:2048 nt
    buffer_load_dwordx4 v[116:119], v2, s[56:59], s70 offen offset:3072 nt
    s_add_u32 s70, s70, 4096
    s_waitcnt vmcnt(2)
    buffer_load_dwordx4 v[120:123], v2, s[56:59], s70 offen offset:0 nt
    buffer_load_dwordx4 v[124:127], v2, s[56:59], s70 offen offset:1024 nt
    buffer_load_dwordx4 v[128:131], v2, s[56:59], s70 offen offset:2048 nt
    buffer_load_dwordx4 v[132:135], v2, s[56:59], s70 offen offset:3072 nt
    s_add_u32 s70, s70, 28672
    s_waitcnt vmcnt(2)
    buffer_load_dwordx4 v[136:139], v2, s[56:59], s70 offen offset:0 nt
    buffer_load_dwordx4 v[140:143], v2, s[56:59], s70 offen offset:1024 nt
    buffer_load_dwordx4 v[144:147], v2, s[56:59], s70 offen offset:2048 nt
    buffer_load_dwordx4 v[148:151], v2, s[56:59], s70 offen offset:3072 nt
    s_add_u32 s70, s70, 4096
    s_waitcnt vmcnt(2)
    buffer_load_dwordx4 v[152:155], v2, s[56:59], s70 offen offset:0 nt
    buffer_load_dwordx4 v[156:159], v2, s[56:59], s70 offen offset:1024 nt
    buffer_load_dwordx4 v[160:163], v2, s[56:59], s70 offen offset:2048 nt
    buffer_load_dwordx4 v[164:167], v2, s[56:59], s70 offen offset:3072 nt
    s_add_u32 s70, s70, 28672
    s_waitcnt vmcnt(0)
S2J_64:
    v_perm_b32 v8, v44, v40, s92
    v_perm_b32 v9, v52, v48, s92
    v_perm_b32 v10, v60, v56, s92
    v_perm_b32 v11, v68, v64, s92
    v_perm_b32 v12, v44, v40, s93
    v_perm_b32 v13, v52, v48, s93
    v_perm_b32 v14, v60, v56, s93
    v_perm_b32 v15, v68, v64, s93
    v_perm_b32 v16, v45, v41, s92
    v_perm_b32 v17, v53, v49, s92
    v_perm_b32 v18, v61, v57, s92
    v_perm_b32 v19, v69, v65, s92
    v_perm_b32 v20, v45, v41, s93
    v_perm_b32 v21, v53, v49, s93
    v_perm_b32 v22, v61, v57, s93
    v_perm_b32 v23, v69, v65, s93
    v_perm_b32 v24, v46, v42, s92
    v_perm_b32 v25, v54, v50, s92
    v_perm_b32 v26, v62, v58, s92
    v_perm_b32 v27, v70, v66, s92
    v_perm_b32 v28, v46, v42, s93
    v_perm_b32 v29, v54, v50, s93
    v_perm_b32 v30, v62, v58, s93
    v_perm_b32 v31, v70, v66, s93
    v_perm_b32 v32, v47, v43, s92
    v_perm_b32 v33, v55, v51, s92
    v_perm_b32 v34, v63, v59, s92
    v_perm_b32 v35, v71, v67, s92
    v_perm_b32 v36, v47, v43, s93
    v_perm_b32 v37, v55, v51, s93
    v_perm_b32 v38, v63, v59, s93
    v_perm_b32 v39, v71, v67, s93
    v_perm_b32 v40, v76, v72, s92
    v_perm_b32 v41, v84, v80, s92
    v_perm_b32 v42, v92, v88, s92
    v_perm_b32 v43, v100, v96, s92
    v_perm_b32 v44, v76, v72, s93
    v_perm_b32 v45, v84, v80, s93
    v_perm_b32 v46, v92, v88, s93
    v_perm_b32 v47, v100, v96, s93
    v_perm_b32 v48, v77, v73, s92
    v_perm_b32 v49, v85, v81, s92
    v_perm_b32 v50, v93, v89, s92
    v_perm_b32 v51, v101, v97, s92
    v_perm_b32 v52, v77, v73, s93
    v_perm_b32 v53, v85, v81, s93
    v_perm_b32 v54, v93, v89, s93
    v_perm_b32 v55, v101, v97, s93
    v_perm_b32 v56, v78, v74, s92
    v_perm_b32 v57, v86, v82, s92
    v_perm_b32 v58, v94, v90, s92
    v_perm_b32 v59, v102, v98, s92
    v_perm_b32 v60, v78, v74, s93
    v_perm_b32 v61, v86, v82, s93
    v_perm_b32 v62, v94, v90, s93
    v_perm_b32 v63, v102, v98, s93
    v_perm_b32 v64, v79, v75, s92
    v_perm_b32 v65, v87, v83, s92
    v_perm_b32 v66, v95, v91, s92
    v_perm_b32 v67, v103, v99, s92
    v_perm_b32 v68, v79, v75, s93
    v_perm_b32 v69, v87, v83, s93
    v_perm_b32 v70, v95, v91, s93
    v_perm_b32 v71, v103, v99, s93
    v_perm_b32 v72, v108, v104, s92
    v_perm_b32 v73, v116, v112, s92
    v_perm_b32 v74, v124, v120, s92
    v_perm_b32 v75, v132, v128, s92
    v_perm_b32 v76, v108, v104, s93
    v_perm_b32 v77, v116, v112, s93
    v_perm_b32 v78, v124, v120, s93
    v_perm_b32 v79, v132, v128, s93
    v_perm_b32 v80, v109, v105, s92
    v_perm_b32 v81, v117, v113, s92
    v_perm_b32 v82, v125, v121, s92
    v_perm_b32 v83, v133, v129, s92
    v_perm_b32 v84, v109, v105, s93
    v_perm_b32 v85, v117, v113, s93
    v_perm_b32 v86, v125, v121, s93
    v_perm_b32 v87, v133, v129, s93
    v_perm_b32 v88, v110, v106, s92
    v_perm_b32 v89, v118, v114, s92
    v_perm_b32 v90, v126, v122, s92
    v_perm_b32 v91, v134, v130, s92
    v_perm_b32 v92, v110, v106, s93
    v_perm_b32 v93, v118, v114, s93
    v_perm_b32 v94, v126, v122, s93
    v_perm_b32 v95, v134, v130, s93
    v_perm_b32 v96, v111, v107, s92
    v_perm_b32 v97, v119, v115, s92
    v_perm_b32 v98, v127, v123, s92
    v_perm_b32 v99, v135, v131, s92
    v_perm_b32 v100, v111, v107, s93
    v_perm_b32 v101, v119, v115, s93
    v_perm_b32 v102, v127, v123, s93
    v_perm_b32 v103, v135, v131, s93
    v_perm_b32 v104, v140, v136, s92
    v_perm_b32 v105, v148, v144, s92
    v_perm_b32 v106, v156, v152, s92
    v_perm_b32 v107, v164, v160, s92
    v_perm_b32 v108, v140, v136, s93
    v_perm_b32 v109, v148, v144, s93
    v_perm_b32 v110, v156, v152, s93
    v_perm_b32 v111, v164, v160, s93
    v_perm_b32 v112, v141, v137, s92
    v_perm_b32 v113, v149, v145, s92
    v_perm_b32 v114, v157, v153, s92
    v_perm_b32 v115, v165, v161, s92
    v_perm_b32 v116, v141, v137, s93
    v_perm_b32 v117, v149, v145, s93
    v_perm_b32 v118, v157, v153, s93
    v_perm_b32 v119, v165, v161, s93
    v_perm_b32 v120, v142, v138, s92
    v_perm_b32 v121, v150, v146, s92
    v_perm_b32 v122, v158, v154, s92
    v_perm_b32 v123, v166, v162, s92
    v_perm_b32 v124, v142, v138, s93
    v_perm_b32 v125, v150, v146, s93
    v_perm_b32 v126, v158, v154, s93
    v_perm_b32 v127, v166, v162, s93
    v_perm_b32 v128, v143, v139, s92
    v_perm_b32 v129, v151, v147, s92
    v_perm_b32 v130, v159, v155, s92
    v_perm_b32 v131, v167, v163, s92
    v_perm_b32 v132, v143, v139, s93
    v_perm_b32 v133, v151, v147, s93
    v_perm_b32 v134, v159, v155, s93
    v_perm_b32 v135, v167, v163, s93
    v_mov_b32 v160, 0x2404c
    s_mov_b32 s80, 1600000
LW_67:
    ds_read_b32 v161, v160
    s_waitcnt lgkmcnt(0)
    v_readfirstlane_b32 s79, v161
    s_cmp_ge_u32 s79, 1
    s_cbranch_scc1 LWD_68
    s_sleep 2
    s_sub_u32 s80, s80, 1
    s_cmp_lg_u32 s80, 0
    s_cbranch_scc1 LW_67
LWD_68:
    v_mov_b32 v160, 0x24050
    ds_read_b64 v[162:163], v160
    s_waitcnt lgkmcnt(0)
    v_readfirstlane_b32 s94, v162
    v_readfirstlane_b32 s95, v163
    v_bfe_u32 v4, v1, 2, 2
    v_lshlrev_b32 v4, 8, v4
    v_lshrrev_b32 v160, 4, v1
    v_lshl_add_u32 v4, v160, 4, v4
    s_mov_b32 s70, 4096
    s_cmp_ge_u32 s5, 4
    s_cbranch_scc1 S2X_69
    v_add_u32 v4, 0x24400, v4
    s_cmp_lg_u32 s3, 8
    s_cbranch_scc1 U8_71
    v_and_b32 v5, 15, v1
    v_lshl_add_u32 v5, v5, 2, v160
    s_lshl_b32 s7, s6, 4
    s_add_u32 s7, s7, 0xe0000
    v_lshl_add_u32 v5, v5, 9, s7
    v_lshlrev_b32 v6, 4, v1
    v_add_u32 v6, 0x24800, v6
    s_mov_b32 s80, 200000
PO_72:
    buffer_load_dwordx4 v[136:139], v5, s[36:39], 0 offen sc1
PO2_73:
    s_waitcnt vmcnt(0)
    v_cmp_ne_u64 vcc, s[94:95], v[138:139]
    s_cmp_lg_u64 vcc, -1
    s_cbranch_scc1 POD_74
    s_sleep 16
    s_sub_u32 s80, s80, 1
    s_cmp_lg_u32 s80, 0
    s_cbranch_scc1 PO_72
POD_74:
    s_setprio 3
    ds_write_b128 v6, v[136:139]
    v_mov_b32 v160, 0x2401c
    v_mov_b32 v161, 1
    s_waitcnt lgkmcnt(0)
    s_mov_b64 exec, 1
    ds_add_u32 v160, v161
    s_mov_b64 exec, -1
    s_cbranch_vccz U8D_76
    buffer_load_dwordx4 v[136:139], v5, s[36:39], 0 offen sc1
    s_sleep 4
    buffer_load_dwordx4 v[140:143], v5, s[36:39], 0 offen sc1
    s_sleep 4
    s_mov_b32 s80, 200000
U8P_75:
    s_waitcnt vmcnt(1)
    ds_write_b128 v6, v[136:139]
    v_cmp_ne_u64 vcc, s[94:95], v[138:139]
    s_cbranch_vccz U8D_76
    s_waitcnt lgkmcnt(0)
    buffer_load_dwordx4 v[136:139], v5, s[36:39], 0 offen sc1
    s_waitcnt vmcnt(1)
    ds_write_b128 v6, v[140:143]
    v_cmp_ne_u64 vcc, s[94:95], v[142:143]
    s_cbranch_vccz U8D_76
    s_waitcnt lgkmcnt(0)
    buffer_load_dwordx4 v[140:143], v5, s[36:39], 0 offen sc1
    s_sub_u32 s80, s80, 1
    s_cmp_lg_u32 s80, 0
    s_cbranch_scc1 U8P_75
U8D_76:
    s_waitcnt vmcnt(0)
U8_71:
    s_setprio 3
    s_barrier
    s_barrier
    ds_read_b128 v[136:139], v4 offset:0
    ds_read_b128 v[140:143], v4 offset:64
    ds_read_b128 v[144:147], v4 offset:128
    ds_read_b128 v[148:151], v4 offset:192
    s_waitcnt lgkmcnt(0)
    s_branch S2M_70
S2X_69:
    v_and_b32 v160, 3, v1
    v_lshl_add_u32 v4, v160, 6, v4
    s_lshl_b32 s7, s6, 11
    s_add_u32 s7, s7, 0xd0000
    v_add_u32 v4, s7, v4
    s_mov_b32 s80, 200000
PO_77:
    buffer_load_dwordx4 v[152:155], v4, s[36:39], 0 offen offset:0 sc1
PO2_78:
    s_waitcnt vmcnt(0)
    v_cmp_ne_u64 vcc, s[94:95], v[154:155]
    s_cmp_lg_u64 vcc, -1
    s_cbranch_scc1 POD_79
    s_sleep 2
    s_sub_u32 s80, s80, 1
    s_cmp_lg_u32 s80, 0
    s_cbranch_scc1 PO_77
POD_79:
    s_setprio 3
    buffer_load_dwordx4 v[152:155], v4, s[36:39], 0 offen offset:0 sc1
    buffer_load_dwordx4 v[156:159], v4, s[36:39], 0 offen offset:1024 sc1
    s_sleep 4
    buffer_load_dwordx4 v[160:163], v4, s[36:39], 0 offen offset:0 sc1
    buffer_load_dwordx4 v[164:167], v4, s[36:39], 0 offen offset:1024 sc1
    s_sleep 4
    s_mov_b32 s80, 200000
PP_80:
    s_waitcnt vmcnt(2)
    v_cmp_ne_u64 vcc, s[94:95], v[154:155]
    v_cmp_ne_u64 s[84:85], s[94:95], v[158:159]
    s_or_b64 vcc, vcc, s[84:85]
    s_cmp_eq_u64 vcc, 0
    s_cbranch_scc1 PPO_82
    buffer_load_dwordx4 v[152:155], v4, s[36:39], 0 offen offset:0 sc1
    buffer_load_dwordx4 v[156:159], v4, s[36:39], 0 offen offset:1024 sc1
    s_waitcnt vmcnt(2)
    v_cmp_ne_u64 vcc, s[94:95], v[162:163]
    v_cmp_ne_u64 s[84:85], s[94:95], v[166:167]
    s_or_b64 vcc, vcc, s[84:85]
    s_cmp_eq_u64 vcc, 0
    s_cbranch_scc1 PPO_83
    buffer_load_dwordx4 v[160:163], v4, s[36:39], 0 offen offset:0 sc1
    buffer_load_dwordx4 v[164:167], v4, s[36:39], 0 offen offset:1024 sc1
    s_sub_u32 s80, s80, 1
    s_cmp_lg_u32 s80, 0
    s_cbranch_scc1 PP_80
PPO_82:
    v_mov_b32_dpp v136, v152 quad_perm:[0,0,0,0] row_mask:0xf bank_mask:0xf
    v_mov_b32_dpp v137, v153 quad_perm:[0,0,0,0] row_mask:0xf bank_mask:0xf
    v_mov_b32_dpp v138, v156 quad_perm:[0,0,0,0] row_mask:0xf bank_mask:0xf
    v_mov_b32_dpp v139, v157 quad_perm:[0,0,0,0] row_mask:0xf bank_mask:0xf
    v_mov_b32_dpp v140, v152 quad_perm:[1,1,1,1] row_mask:0xf bank_mask:0xf
    v_mov_b32_dpp v141, v153 quad_perm:[1,1,1,1] row_mask:0xf bank_mask:0xf
    v_mov_b32_dpp v142, v156 quad_perm:[1,1,1,1] row_mask:0xf bank_mask:0xf
    v_mov_b32_dpp v143, v157 quad_perm:[1,1,1,1] row_mask:0xf bank_mask:0xf
    v_mov_b32_dpp v144, v152 quad_perm:[2,2,2,2] row_mask:0xf bank_mask:0xf
    v_mov_b32_dpp v145, v153 quad_perm:[2,2,2,2] row_mask:0xf bank_mask:0xf
    v_mov_b32_dpp v146, v156 quad_perm:[2,2,2,2] row_mask:0xf bank_mask:0xf
    v_mov_b32_dpp v147, v157 quad_perm:[2,2,2,2] row_mask:0xf bank_mask:0xf
    v_mov_b32_dpp v148, v152 quad_perm:[3,3,3,3] row_mask:0xf bank_mask:0xf
    v_mov_b32_dpp v149, v153 quad_perm:[3,3,3,3] row_mask:0xf bank_mask:0xf
    v_mov_b32_dpp v150, v156 quad_perm:[3,3,3,3] row_mask:0xf bank_mask:0xf
    v_mov_b32_dpp v151, v157 quad_perm:[3,3,3,3] row_mask:0xf bank_mask:0xf
    s_branch PPD_81
PPO_83:
    v_mov_b32_dpp v136, v160 quad_perm:[0,0,0,0] row_mask:0xf bank_mask:0xf
    v_mov_b32_dpp v137, v161 quad_perm:[0,0,0,0] row_mask:0xf bank_mask:0xf
    v_mov_b32_dpp v138, v164 quad_perm:[0,0,0,0] row_mask:0xf bank_mask:0xf
    v_mov_b32_dpp v139, v165 quad_perm:[0,0,0,0] row_mask:0xf bank_mask:0xf
    v_mov_b32_dpp v140, v160 quad_perm:[1,1,1,1] row_mask:0xf bank_mask:0xf
    v_mov_b32_dpp v141, v161 quad_perm:[1,1,1,1] row_mask:0xf bank_mask:0xf
    v_mov_b32_dpp v142, v164 quad_perm:[1,1,1,1] row_mask:0xf bank_mask:0xf
    v_mov_b32_dpp v143, v165 quad_perm:[1,1,1,1] row_mask:0xf bank_mask:0xf
    v_mov_b32_dpp v144, v160 quad_perm:[2,2,2,2] row_mask:0xf bank_mask:0xf
    v_mov_b32_dpp v145, v161 quad_perm:[2,2,2,2] row_mask:0xf bank_mask:0xf
    v_mov_b32_dpp v146, v164 quad_perm:[2,2,2,2] row_mask:0xf bank_mask:0xf
    v_mov_b32_dpp v147, v165 quad_perm:[2,2,2,2] row_mask:0xf bank_mask:0xf
    v_mov_b32_dpp v148, v160 quad_perm:[3,3,3,3] row_mask:0xf bank_mask:0xf
    v_mov_b32_dpp v149, v161 quad_perm:[3,3,3,3] row_mask:0xf bank_mask:0xf
    v_mov_b32_dpp v150, v164 quad_perm:[3,3,3,3] row_mask:0xf bank_mask:0xf
    v_mov_b32_dpp v151, v165 quad_perm:[3,3,3,3] row_mask:0xf bank_mask:0xf
PPD_81:
S2M_70:
    s_nop 1
    v_mfma_f32_16x16x32_bf16 v[4:7], v[136:139], v[8:11], 0
    v_mfma_f32_16x16x32_bf16 v[4:7], v[140:143], v[40:43], v[4:7]
    v_mfma_f32_16x16x32_bf16 v[4:7], v[144:147], v[72:75], v[4:7]
    v_mfma_f32_16x16x32_bf16 v[4:7], v[148:151], v[104:107], v[4:7]
    v_mfma_f32_16x16x32_bf16 v[8:11], v[136:139], v[12:15], 0
    v_mfma_f32_16x16x32_bf16 v[8:11], v[140:143], v[44:47], v[8:11]
    v_mfma_f32_16x16x32_bf16 v[8:11], v[144:147], v[76:79], v[8:11]
    v_mfma_f32_16x16x32_bf16 v[8:11], v[148:151], v[108:111], v[8:11]
    v_mfma_f32_16x16x32_bf16 v[12:15], v[136:139], v[16:19], 0
    v_mfma_f32_16x16x32_bf16 v[12:15], v[140:143], v[48:51], v[12:15]
    v_mfma_f32_16x16x32_bf16 v[12:15], v[144:147], v[80:83], v[12:15]
    v_mfma_f32_16x16x32_bf16 v[12:15], v[148:151], v[112:115], v[12:15]
    v_mfma_f32_16x16x32_bf16 v[16:19], v[136:139], v[20:23], 0
    v_mfma_f32_16x16x32_bf16 v[16:19], v[140:143], v[52:55], v[16:19]
    v_mfma_f32_16x16x32_bf16 v[16:19], v[144:147], v[84:87], v[16:19]
    v_mfma_f32_16x16x32_bf16 v[16:19], v[148:151], v[116:119], v[16:19]
    v_mfma_f32_16x16x32_bf16 v[20:23], v[136:139], v[24:27], 0
    v_mfma_f32_16x16x32_bf16 v[20:23], v[140:143], v[56:59], v[20:23]
    v_mfma_f32_16x16x32_bf16 v[20:23], v[144:147], v[88:91], v[20:23]
    v_mfma_f32_16x16x32_bf16 v[20:23], v[148:151], v[120:123], v[20:23]
    v_mfma_f32_16x16x32_bf16 v[24:27], v[136:139], v[28:31], 0
    v_mfma_f32_16x16x32_bf16 v[24:27], v[140:143], v[60:63], v[24:27]
    v_mfma_f32_16x16x32_bf16 v[24:27], v[144:147], v[92:95], v[24:27]
    v_mfma_f32_16x16x32_bf16 v[24:27], v[148:151], v[124:127], v[24:27]
    v_mfma_f32_16x16x32_bf16 v[28:31], v[136:139], v[32:35], 0
    v_mfma_f32_16x16x32_bf16 v[28:31], v[140:143], v[64:67], v[28:31]
    v_mfma_f32_16x16x32_bf16 v[28:31], v[144:147], v[96:99], v[28:31]
    v_mfma_f32_16x16x32_bf16 v[28:31], v[148:151], v[128:131], v[28:31]
    v_mfma_f32_16x16x32_bf16 v[32:35], v[136:139], v[36:39], 0
    v_mfma_f32_16x16x32_bf16 v[32:35], v[140:143], v[68:71], v[32:35]
    v_mfma_f32_16x16x32_bf16 v[32:35], v[144:147], v[100:103], v[32:35]
    v_mfma_f32_16x16x32_bf16 v[32:35], v[148:151], v[132:135], v[32:35]
    v_mov_b32 v42, s94
    v_mov_b32 v43, s95
    v_cvt_pk_bf16_f32 v40, v4, v8
    v_cvt_pk_bf16_f32 v41, v12, v16
    buffer_store_dwordx4 v[40:43], v3, s[36:39], 0 offen sc1
    v_mov_b32 v46, s94
    v_mov_b32 v47, s95
    v_cvt_pk_bf16_f32 v44, v20, v24
    v_cvt_pk_bf16_f32 v45, v28, v32
    buffer_store_dwordx4 v[44:47], v3, s[36:39], s70 offen sc1
    s_endpgm
.p2align 12
LT_CR:
    s_branch LR_CR
L_CR:
    v_and_b32 v160, 15, v1
    v_lshlrev_b32 v4, 10, v160
    v_lshrrev_b32 v161, 4, v1
    v_lshl_add_u32 v4, v161, 8, v4
    v_lshl_add_u32 v3, v160, 4, v4
    s_lshl_b32 s7, s65, 14
    s_add_u32 s7, s7, 0x18000
    v_add_u32 v3, s7, v3
    v_and_b32 v162, 3, v1
    v_lshl_add_u32 v4, v162, 6, v4
    v_bfe_u32 v162, v1, 2, 2
    v_lshl_add_u32 v4, v162, 4, v4
    s_lshl_b32 s7, s64, 14
    v_add_u32 v4, s7, v4
    v_add_u32 v2, 0x10000, v4
    s_lshl_b32 s7, s65, 6
    s_add_u32 s7, s7, 0x27200
    v_lshl_add_u32 v5, v160, 2, s7
    s_lshl_b32 s7, s64, 10
    s_lshl_b32 s66, s65, 9
    s_add_u32 s7, s7, s66
    s_add_u32 s7, s7, 0x25200
    v_lshl_add_u32 v6, v160, 5, s7
    v_lshl_add_u32 v6, v161, 3, v6
    v_and_b32 v162, 31, v1
    v_lshlrev_b32 v7, 5, v162
    v_lshrrev_b32 v163, 5, v1
    v_lshl_add_u32 v7, v163, 4, v7
    v_add_u32 v7, 0x25200, v7
    v_lshlrev_b32 v8, 2, v162
    v_add_u32 v8, 0x27e00, v8
    v_bfe_u32 v162, v1, 2, 2
    v_lshl_add_u32 v164, v163, 3, v162
    v_lshlrev_b32 v164, 10, v164
    v_and_b32 v165, 1, v1
    v_lshl_add_u32 v164, v165, 3, v164
    s_lshl_b32 s7, s64, 8
    v_add_u32 v164, s7, v164
    v_bfe_u32 v165, v1, 4, 1
    v_lshlrev_b32 v165, 1, v165
    v_bfe_u32 v160, v1, 1, 1
    v_or_b32 v165, v165, v160
    s_lshl_b32 s7, s65, 3
    v_or_b32 v165, s7, v165
    v_lshlrev_b32 v162, 2, v162
    v_xor_b32 v165, v165, v162
    v_lshlrev_b32 v163, 1, v163
    v_xor_b32 v165, v165, v163
    v_xor_b32 v160, 0, v165
    v_lshl_add_u32 v9, v160, 4, v164
    v_xor_b32 v160, 4, v165
    v_lshl_add_u32 v10, v160, 4, v164
    v_xor_b32 v160, 1, v165
    v_lshl_add_u32 v11, v160, 4, v164
    v_add_u32 v11, 0x1000, v11
    v_xor_b32 v160, 5, v165
    v_lshl_add_u32 v12, v160, 4, v164
    v_add_u32 v12, 0x1000, v12
    v_mov_b32 v13, 0xff800000
    v_mov_b32 v14, 0
    v_cmp_gt_u32 s[86:87], 16, v1
    s_cmp_eq_u32 s64, 0
    s_cselect_b32 s88, 0xffff, 0
    s_mov_b32 s89, 0
    s_barrier
    v_xor_b32 v160, 0x0, v3
    ds_read_b128 v[32:35], v160
    v_xor_b32 v161, 0x10, v3
    ds_read_b128 v[36:39], v161
    v_xor_b32 v160, 0x20, v3
    ds_read_b128 v[40:43], v160
    v_xor_b32 v161, 0x30, v3
    ds_read_b128 v[44:47], v161
    v_xor_b32 v160, 0x40, v3
    ds_read_b128 v[48:51], v160
    v_xor_b32 v161, 0x50, v3
    ds_read_b128 v[52:55], v161
    v_xor_b32 v160, 0x60, v3
    ds_read_b128 v[56:59], v160
    v_xor_b32 v161, 0x70, v3
    ds_read_b128 v[60:63], v161
    v_xor_b32 v160, 0x80, v3
    ds_read_b128 v[64:67], v160
    v_xor_b32 v161, 0x90, v3
    ds_read_b128 v[68:71], v161
    v_xor_b32 v160, 0xa0, v3
    ds_read_b128 v[72:75], v160
    v_xor_b32 v161, 0xb0, v3
    ds_read_b128 v[76:79], v161
    v_xor_b32 v160, 0xc0, v3
    ds_read_b128 v[80:83], v160
    v_xor_b32 v161, 0xd0, v3
    ds_read_b128 v[84:87], v161
    v_xor_b32 v160, 0xe0, v3
    ds_read_b128 v[88:91], v160
    v_xor_b32 v161, 0xf0, v3
    ds_read_b128 v[92:95], v161
    s_lshl_b32 s7, s3, 10
    s_add_u32 s7, s7, 0x18000
    v_lshl_add_u32 v3, v1, 4, s7
    s_waitcnt lgkmcnt(0)
    s_barrier
    ds_write_b128 v3, v[128:131] offset:0
    ds_write_b128 v3, v[132:135] offset:8192
    ds_write_b128 v3, v[136:139] offset:16384
    ds_write_b128 v3, v[140:143] offset:24576
    v_xor_b32 v160, 0x0, v4
    ds_read_b128 v[24:27], v160
    v_xor_b32 v161, 0x10, v4
    ds_read_b128 v[28:31], v161
    v_xor_b32 v162, 0x20, v4
    ds_read_b128 v[164:167], v162
    v_xor_b32 v160, 0x30, v4
    ds_read_b128 v[144:147], v160
    v_xor_b32 v161, 0x40, v4
    ds_read_b128 v[148:151], v161
    v_xor_b32 v162, 0x50, v4
    ds_read_b128 v[152:155], v162
    v_xor_b32 v160, 0x60, v4
    ds_read_b128 v[156:159], v160
    s_waitcnt lgkmcnt(6)
    v_mfma_f32_16x16x32_bf16 v[16:19], v[24:27], v[32:35], 0
    v_xor_b32 v161, 0x70, v4
    ds_read_b128 v[24:27], v161
    s_waitcnt lgkmcnt(6)
    v_mfma_f32_16x16x32_bf16 v[16:19], v[28:31], v[36:39], v[16:19]
    v_xor_b32 v162, 0x80, v4
    ds_read_b128 v[28:31], v162
    s_waitcnt lgkmcnt(6)
    v_mfma_f32_16x16x32_bf16 v[16:19], v[164:167], v[40:43], v[16:19]
    v_xor_b32 v160, 0x90, v4
    ds_read_b128 v[164:167], v160
    s_waitcnt lgkmcnt(6)
    v_mfma_f32_16x16x32_bf16 v[16:19], v[144:147], v[44:47], v[16:19]
    v_xor_b32 v161, 0xa0, v4
    ds_read_b128 v[144:147], v161
    s_waitcnt lgkmcnt(6)
    v_mfma_f32_16x16x32_bf16 v[16:19], v[148:151], v[48:51], v[16:19]
    v_xor_b32 v162, 0xb0, v4
    ds_read_b128 v[148:151], v162
    s_waitcnt lgkmcnt(6)
    v_mfma_f32_16x16x32_bf16 v[16:19], v[152:155], v[52:55], v[16:19]
    v_xor_b32 v160, 0xc0, v4
    ds_read_b128 v[152:155], v160
    s_waitcnt lgkmcnt(6)
    v_mfma_f32_16x16x32_bf16 v[16:19], v[156:159], v[56:59], v[16:19]
    v_xor_b32 v161, 0xd0, v4
    ds_read_b128 v[156:159], v161
    s_waitcnt lgkmcnt(6)
    v_mfma_f32_16x16x32_bf16 v[16:19], v[24:27], v[60:63], v[16:19]
    v_xor_b32 v162, 0xe0, v4
    ds_read_b128 v[24:27], v162
    s_waitcnt lgkmcnt(6)
    v_mfma_f32_16x16x32_bf16 v[16:19], v[28:31], v[64:67], v[16:19]
    v_xor_b32 v160, 0xf0, v4
    ds_read_b128 v[28:31], v160
    s_waitcnt lgkmcnt(6)
    v_mfma_f32_16x16x32_bf16 v[16:19], v[164:167], v[68:71], v[16:19]
    s_waitcnt lgkmcnt(5)
    v_mfma_f32_16x16x32_bf16 v[16:19], v[144:147], v[72:75], v[16:19]
    s_waitcnt lgkmcnt(4)
    v_mfma_f32_16x16x32_bf16 v[16:19], v[148:151], v[76:79], v[16:19]
    s_waitcnt lgkmcnt(3)
    v_mfma_f32_16x16x32_bf16 v[16:19], v[152:155], v[80:83], v[16:19]
    s_waitcnt lgkmcnt(2)
    v_mfma_f32_16x16x32_bf16 v[16:19], v[156:159], v[84:87], v[16:19]
    s_waitcnt lgkmcnt(1)
    v_mfma_f32_16x16x32_bf16 v[16:19], v[24:27], v[88:91], v[16:19]
    s_waitcnt lgkmcnt(0)
    v_mfma_f32_16x16x32_bf16 v[16:19], v[28:31], v[92:95], v[16:19]
    s_waitcnt lgkmcnt(0)
    s_barrier
    v_xor_b32 v160, 0x0, v2
    ds_read_b128 v[24:27], v160
    v_xor_b32 v161, 0x10, v2
    ds_read_b128 v[28:31], v161
    v_xor_b32 v162, 0x20, v2
    ds_read_b128 v[164:167], v162
    v_xor_b32 v160, 0x30, v2
    ds_read_b128 v[144:147], v160
    v_xor_b32 v161, 0x40, v2
    ds_read_b128 v[148:151], v161
    v_xor_b32 v162, 0x50, v2
    ds_read_b128 v[152:155], v162
    v_xor_b32 v160, 0x60, v2
    ds_read_b128 v[156:159], v160
    s_waitcnt lgkmcnt(6)
    v_mfma_f32_16x16x32_bf16 v[20:23], v[24:27], v[32:35], 0
    v_xor_b32 v161, 0x70, v2
    ds_read_b128 v[24:27], v161
    s_waitcnt lgkmcnt(6)
    v_mfma_f32_16x16x32_bf16 v[20:23], v[28:31], v[36:39], v[20:23]
    v_xor_b32 v162, 0x80, v2
    ds_read_b128 v[28:31], v162
    s_waitcnt lgkmcnt(6)
    v_mfma_f32_16x16x32_bf16 v[20:23], v[164:167], v[40:43], v[20:23]
    v_xor_b32 v160, 0x90, v2
    ds_read_b128 v[164:167], v160
    s_waitcnt lgkmcnt(6)
    v_mfma_f32_16x16x32_bf16 v[20:23], v[144:147], v[44:47], v[20:23]
    v_xor_b32 v161, 0xa0, v2
    ds_read_b128 v[144:147], v161
    s_waitcnt lgkmcnt(6)
    v_mfma_f32_16x16x32_bf16 v[20:23], v[148:151], v[48:51], v[20:23]
    v_xor_b32 v162, 0xb0, v2
    ds_read_b128 v[148:151], v162
    s_waitcnt lgkmcnt(6)
    v_mfma_f32_16x16x32_bf16 v[20:23], v[152:155], v[52:55], v[20:23]
    v_xor_b32 v160, 0xc0, v2
    ds_read_b128 v[152:155], v160
    s_waitcnt lgkmcnt(6)
    v_mfma_f32_16x16x32_bf16 v[20:23], v[156:159], v[56:59], v[20:23]
    v_xor_b32 v161, 0xd0, v2
    ds_read_b128 v[156:159], v161
    s_waitcnt lgkmcnt(6)
    v_mfma_f32_16x16x32_bf16 v[20:23], v[24:27], v[60:63], v[20:23]
    v_xor_b32 v162, 0xe0, v2
    ds_read_b128 v[24:27], v162
    s_waitcnt lgkmcnt(6)
    v_mfma_f32_16x16x32_bf16 v[20:23], v[28:31], v[64:67], v[20:23]
    v_xor_b32 v160, 0xf0, v2
    ds_read_b128 v[28:31], v160
    s_waitcnt lgkmcnt(6)
    v_mfma_f32_16x16x32_bf16 v[20:23], v[164:167], v[68:71], v[20:23]
    s_waitcnt lgkmcnt(5)
    v_mfma_f32_16x16x32_bf16 v[20:23], v[144:147], v[72:75], v[20:23]
    s_waitcnt lgkmcnt(4)
    v_mfma_f32_16x16x32_bf16 v[20:23], v[148:151], v[76:79], v[20:23]
    s_waitcnt lgkmcnt(3)
    v_mfma_f32_16x16x32_bf16 v[20:23], v[152:155], v[80:83], v[20:23]
    s_waitcnt lgkmcnt(2)
    v_mfma_f32_16x16x32_bf16 v[20:23], v[156:159], v[84:87], v[20:23]
    s_waitcnt lgkmcnt(1)
    v_mfma_f32_16x16x32_bf16 v[20:23], v[24:27], v[88:91], v[20:23]
    s_waitcnt lgkmcnt(0)
    v_mfma_f32_16x16x32_bf16 v[20:23], v[28:31], v[92:95], v[20:23]
    v_max3_f32 v160, v16, v17, v18
    s_nop 6
    v_max3_f32 v160, v160, v19, v20
    v_max3_f32 v160, v160, v21, v22
    v_max_f32 v160, v160, v23
    v_mov_b32 v161, v160
    s_nop 1
    v_permlane32_swap_b32 v160, v161
    v_max_f32 v160, v160, v161
    v_mov_b32 v161, v160
    s_nop 1
    v_permlane16_swap_b32 v160, v161
    v_max_f32 v160, v160, v161
    s_lshl_b32 s7, s64, 7
    v_add_u32 v161, s7, v5
    s_mov_b64 exec, s[86:87]
    ds_write_b32 v161, v160
    s_mov_b64 exec, -1
    s_waitcnt lgkmcnt(0)
    s_barrier
    ds_read_b32 v160, v5 offset:0
    ds_read_b32 v161, v5 offset:128
    ds_read_b32 v162, v5 offset:256
    ds_read_b32 v163, v5 offset:384
    s_waitcnt lgkmcnt(0)
    v_max3_f32 v160, v160, v161, v162
    v_max_f32 v160, v160, v163
    v_mul_f32 v160, s67, v160
    v_max_f32 v160, v160, v13
    v_sub_f32 v161, v13, v160
    v_exp_f32 v161, v161
    v_mov_b32 v13, v160
    v_fma_f32 v16, v16, s67, -v160
    v_fma_f32 v17, v17, s67, -v160
    v_fma_f32 v18, v18, s67, -v160
    v_fma_f32 v19, v19, s67, -v160
    v_fma_f32 v20, v20, s67, -v160
    v_fma_f32 v21, v21, s67, -v160
    v_fma_f32 v22, v22, s67, -v160
    v_fma_f32 v23, v23, s67, -v160
    v_exp_f32 v16, v16
    v_exp_f32 v17, v17
    v_exp_f32 v18, v18
    v_exp_f32 v19, v19
    v_exp_f32 v20, v20
    v_exp_f32 v21, v21
    v_exp_f32 v22, v22
    v_exp_f32 v23, v23
    v_cvt_pk_bf16_f32 v24, v16, v17
    v_cvt_pk_bf16_f32 v25, v18, v19
    v_cvt_pk_bf16_f32 v26, v20, v21
    v_cvt_pk_bf16_f32 v27, v22, v23
    ds_write_b64 v6, v[24:25]
    ds_write_b64 v6, v[26:27] offset:4096
    v_add_u32 v162, 0xc00, v5
    s_mov_b64 exec, s[88:89]
    ds_write_b32 v162, v161
    s_mov_b64 exec, -1
    v_mul_f32 v14, v14, v161
    v_add_f32 v16, v16, v20
    v_add_f32 v17, v17, v21
    v_add_f32 v18, v18, v22
    v_add_f32 v19, v19, v23
    v_add_f32 v16, v16, v18
    v_add_f32 v17, v17, v19
    v_add_f32 v16, v16, v17
    v_add_f32 v14, v14, v16
    v_lshlrev_b32 v3, 4, v1
    v_xor_b32 v3, s62, v3
    v_xor_b32 v15, 32, v3
    s_lshl_b32 s68, s3, 10
    s_waitcnt lgkmcnt(0)
    s_barrier
    ds_read_b128 v[16:19], v7 offset:0
    ds_read_b64_tr_b16 v[24:25], v9 offset:0
    ds_read_b64_tr_b16 v[26:27], v11 offset:0
    ds_read_b64_tr_b16 v[28:29], v10 offset:0
    ds_read_b64_tr_b16 v[30:31], v12 offset:0
    ds_read_b128 v[20:23], v7 offset:1024
    ds_read_b64_tr_b16 v[160:161], v9 offset:16384
    ds_read_b64_tr_b16 v[162:163], v11 offset:16384
    ds_read_b64_tr_b16 v[164:165], v10 offset:16384
    ds_read_b64_tr_b16 v[166:167], v12 offset:16384
    s_waitcnt lgkmcnt(7)
    v_mfma_f32_32x32x16_bf16 v[128:143], v[24:27], v[16:19], 0
    s_waitcnt lgkmcnt(5)
    v_mfma_f32_32x32x16_bf16 v[144:159], v[28:31], v[16:19], 0
    ds_read_b128 v[16:19], v7 offset:2048
    ds_read_b64_tr_b16 v[24:25], v9 offset:32768
    ds_read_b64_tr_b16 v[26:27], v11 offset:32768
    ds_read_b64_tr_b16 v[28:29], v10 offset:32768
    ds_read_b64_tr_b16 v[30:31], v12 offset:32768
    s_waitcnt lgkmcnt(7)
    v_mfma_f32_32x32x16_bf16 v[128:143], v[160:163], v[20:23], v[128:143]
    s_waitcnt lgkmcnt(5)
    v_mfma_f32_32x32x16_bf16 v[144:159], v[164:167], v[20:23], v[144:159]
    ds_read_b128 v[20:23], v7 offset:3072
    ds_read_b64_tr_b16 v[160:161], v9 offset:49152
    ds_read_b64_tr_b16 v[162:163], v11 offset:49152
    ds_read_b64_tr_b16 v[164:165], v10 offset:49152
    ds_read_b64_tr_b16 v[166:167], v12 offset:49152
    s_waitcnt lgkmcnt(7)
    v_mfma_f32_32x32x16_bf16 v[128:143], v[24:27], v[16:19], v[128:143]
    s_waitcnt lgkmcnt(5)
    v_mfma_f32_32x32x16_bf16 v[144:159], v[28:31], v[16:19], v[144:159]
    v_add_u32 v9, 0x10000, v9
    v_add_u32 v10, 0x10000, v10
    v_add_u32 v11, 0x10000, v11
    v_add_u32 v12, 0x10000, v12
    ds_read_b128 v[16:19], v7 offset:4096
    ds_read_b64_tr_b16 v[24:25], v9 offset:0
    ds_read_b64_tr_b16 v[26:27], v11 offset:0
    ds_read_b64_tr_b16 v[28:29], v10 offset:0
    ds_read_b64_tr_b16 v[30:31], v12 offset:0
    s_waitcnt lgkmcnt(7)
    v_mfma_f32_32x32x16_bf16 v[128:143], v[160:163], v[20:23], v[128:143]
    s_waitcnt lgkmcnt(5)
    v_mfma_f32_32x32x16_bf16 v[144:159], v[164:167], v[20:23], v[144:159]
    s_barrier
    ds_read_b128 v[20:23], v7 offset:5120
    ds_read_b64_tr_b16 v[160:161], v9 offset:16384
    ds_read_b64_tr_b16 v[162:163], v11 offset:16384
    ds_read_b64_tr_b16 v[164:165], v10 offset:16384
    ds_read_b64_tr_b16 v[166:167], v12 offset:16384
    s_waitcnt lgkmcnt(7)
    v_mfma_f32_32x32x16_bf16 v[128:143], v[24:27], v[16:19], v[128:143]
    s_waitcnt lgkmcnt(5)
    v_mfma_f32_32x32x16_bf16 v[144:159], v[28:31], v[16:19], v[144:159]
    ds_read_b128 v[16:19], v7 offset:6144
    ds_read_b64_tr_b16 v[24:25], v9 offset:32768
    ds_read_b64_tr_b16 v[26:27], v11 offset:32768
    ds_read_b64_tr_b16 v[28:29], v10 offset:32768
    ds_read_b64_tr_b16 v[30:31], v12 offset:32768
    s_waitcnt lgkmcnt(7)
    v_mfma_f32_32x32x16_bf16 v[128:143], v[160:163], v[20:23], v[128:143]
    s_waitcnt lgkmcnt(5)
    v_mfma_f32_32x32x16_bf16 v[144:159], v[164:167], v[20:23], v[144:159]
    ds_read_b128 v[20:23], v7 offset:7168
    ds_read_b64_tr_b16 v[160:161], v9 offset:49152
    ds_read_b64_tr_b16 v[162:163], v11 offset:49152
    ds_read_b64_tr_b16 v[164:165], v10 offset:49152
    ds_read_b64_tr_b16 v[166:167], v12 offset:49152
    s_waitcnt lgkmcnt(7)
    v_mfma_f32_32x32x16_bf16 v[128:143], v[24:27], v[16:19], v[128:143]
    s_waitcnt lgkmcnt(5)
    v_mfma_f32_32x32x16_bf16 v[144:159], v[28:31], v[16:19], v[144:159]
    s_waitcnt lgkmcnt(2)
    v_mfma_f32_32x32x16_bf16 v[128:143], v[160:163], v[20:23], v[128:143]
    s_waitcnt lgkmcnt(0)
    v_mfma_f32_32x32x16_bf16 v[144:159], v[164:167], v[20:23], v[144:159]
    v_add_u32 v9, 0xffff0000, v9
    v_add_u32 v10, 0xffff0000, v10
    v_add_u32 v11, 0xffff0000, v11
    v_add_u32 v12, 0xffff0000, v12
    s_lshl_b32 s7, s3, 10
    s_add_u32 s7, s7, 0x10000
    v_lshl_add_u32 v3, v1, 4, s7
    s_waitcnt vmcnt(0)
    s_barrier
    ds_write_b128 v3, v[96:99] offset:0
    ds_write_b128 v3, v[100:103] offset:8192
    ds_write_b128 v3, v[104:107] offset:16384
    ds_write_b128 v3, v[108:111] offset:24576
    ds_write_b128 v3, v[112:115] offset:32768
    ds_write_b128 v3, v[116:119] offset:40960
    ds_write_b128 v3, v[120:123] offset:49152
    ds_write_b128 v3, v[124:127] offset:57344
    s_waitcnt lgkmcnt(4)
    v_xor_b32 v160, 0x0, v4
    ds_read_b128 v[24:27], v160
    v_xor_b32 v161, 0x10, v4
    ds_read_b128 v[28:31], v161
    v_xor_b32 v162, 0x20, v4
    ds_read_b128 v[164:167], v162
    v_xor_b32 v160, 0x30, v4
    ds_read_b128 v[96:99], v160
    v_xor_b32 v161, 0x40, v4
    ds_read_b128 v[100:103], v161
    v_xor_b32 v162, 0x50, v4
    ds_read_b128 v[104:107], v162
    v_xor_b32 v160, 0x60, v4
    ds_read_b128 v[108:111], v160
    s_waitcnt lgkmcnt(6)
    v_mfma_f32_16x16x32_bf16 v[16:19], v[24:27], v[32:35], 0
    v_xor_b32 v161, 0x70, v4
    ds_read_b128 v[24:27], v161
    s_waitcnt lgkmcnt(6)
    v_mfma_f32_16x16x32_bf16 v[16:19], v[28:31], v[36:39], v[16:19]
    v_xor_b32 v162, 0x80, v4
    ds_read_b128 v[28:31], v162
    s_waitcnt lgkmcnt(6)
    v_mfma_f32_16x16x32_bf16 v[16:19], v[164:167], v[40:43], v[16:19]
    v_xor_b32 v160, 0x90, v4
    ds_read_b128 v[164:167], v160
    s_waitcnt lgkmcnt(6)
    v_mfma_f32_16x16x32_bf16 v[16:19], v[96:99], v[44:47], v[16:19]
    v_xor_b32 v161, 0xa0, v4
    ds_read_b128 v[96:99], v161
    s_waitcnt lgkmcnt(6)
    v_mfma_f32_16x16x32_bf16 v[16:19], v[100:103], v[48:51], v[16:19]
    v_xor_b32 v162, 0xb0, v4
    ds_read_b128 v[100:103], v162
    s_waitcnt lgkmcnt(6)
    v_mfma_f32_16x16x32_bf16 v[16:19], v[104:107], v[52:55], v[16:19]
    v_xor_b32 v160, 0xc0, v4
    ds_read_b128 v[104:107], v160
    s_waitcnt lgkmcnt(6)
    v_mfma_f32_16x16x32_bf16 v[16:19], v[108:111], v[56:59], v[16:19]
    v_xor_b32 v161, 0xd0, v4
    ds_read_b128 v[108:111], v161
    s_waitcnt lgkmcnt(6)
    v_mfma_f32_16x16x32_bf16 v[16:19], v[24:27], v[60:63], v[16:19]
    v_xor_b32 v162, 0xe0, v4
    ds_read_b128 v[24:27], v162
    s_waitcnt lgkmcnt(6)
    v_mfma_f32_16x16x32_bf16 v[16:19], v[28:31], v[64:67], v[16:19]
    v_xor_b32 v160, 0xf0, v4
    ds_read_b128 v[28:31], v160
    s_waitcnt lgkmcnt(6)
    v_mfma_f32_16x16x32_bf16 v[16:19], v[164:167], v[68:71], v[16:19]
    s_waitcnt lgkmcnt(5)
    v_mfma_f32_16x16x32_bf16 v[16:19], v[96:99], v[72:75], v[16:19]
    s_waitcnt lgkmcnt(4)
    v_mfma_f32_16x16x32_bf16 v[16:19], v[100:103], v[76:79], v[16:19]
    s_waitcnt lgkmcnt(3)
    v_mfma_f32_16x16x32_bf16 v[16:19], v[104:107], v[80:83], v[16:19]
    s_waitcnt lgkmcnt(2)
    v_mfma_f32_16x16x32_bf16 v[16:19], v[108:111], v[84:87], v[16:19]
    s_waitcnt lgkmcnt(1)
    v_mfma_f32_16x16x32_bf16 v[16:19], v[24:27], v[88:91], v[16:19]
    s_waitcnt lgkmcnt(0)
    v_mfma_f32_16x16x32_bf16 v[16:19], v[28:31], v[92:95], v[16:19]
    s_barrier
    v_xor_b32 v160, 0x0, v2
    ds_read_b128 v[24:27], v160
    v_xor_b32 v161, 0x10, v2
    ds_read_b128 v[28:31], v161
    v_xor_b32 v162, 0x20, v2
    ds_read_b128 v[164:167], v162
    v_xor_b32 v160, 0x30, v2
    ds_read_b128 v[96:99], v160
    v_xor_b32 v161, 0x40, v2
    ds_read_b128 v[100:103], v161
    v_xor_b32 v162, 0x50, v2
    ds_read_b128 v[104:107], v162
    v_xor_b32 v160, 0x60, v2
    ds_read_b128 v[108:111], v160
    s_waitcnt lgkmcnt(6)
    v_mfma_f32_16x16x32_bf16 v[20:23], v[24:27], v[32:35], 0
    v_xor_b32 v161, 0x70, v2
    ds_read_b128 v[24:27], v161
    s_waitcnt lgkmcnt(6)
    v_mfma_f32_16x16x32_bf16 v[20:23], v[28:31], v[36:39], v[20:23]
    v_xor_b32 v162, 0x80, v2
    ds_read_b128 v[28:31], v162
    s_waitcnt lgkmcnt(6)
    v_mfma_f32_16x16x32_bf16 v[20:23], v[164:167], v[40:43], v[20:23]
    v_xor_b32 v160, 0x90, v2
    ds_read_b128 v[164:167], v160
    s_waitcnt lgkmcnt(6)
    v_mfma_f32_16x16x32_bf16 v[20:23], v[96:99], v[44:47], v[20:23]
    v_xor_b32 v161, 0xa0, v2
    ds_read_b128 v[96:99], v161
    s_waitcnt lgkmcnt(6)
    v_mfma_f32_16x16x32_bf16 v[20:23], v[100:103], v[48:51], v[20:23]
    v_xor_b32 v162, 0xb0, v2
    ds_read_b128 v[100:103], v162
    s_waitcnt lgkmcnt(6)
    v_mfma_f32_16x16x32_bf16 v[20:23], v[104:107], v[52:55], v[20:23]
    v_xor_b32 v160, 0xc0, v2
    ds_read_b128 v[104:107], v160
    s_waitcnt lgkmcnt(6)
    v_mfma_f32_16x16x32_bf16 v[20:23], v[108:111], v[56:59], v[20:23]
    v_xor_b32 v161, 0xd0, v2
    ds_read_b128 v[108:111], v161
    s_waitcnt lgkmcnt(6)
    v_mfma_f32_16x16x32_bf16 v[20:23], v[24:27], v[60:63], v[20:23]
    v_xor_b32 v162, 0xe0, v2
    ds_read_b128 v[24:27], v162
    s_waitcnt lgkmcnt(6)
    v_mfma_f32_16x16x32_bf16 v[20:23], v[28:31], v[64:67], v[20:23]
    v_xor_b32 v160, 0xf0, v2
    ds_read_b128 v[28:31], v160
    s_waitcnt lgkmcnt(6)
    v_mfma_f32_16x16x32_bf16 v[20:23], v[164:167], v[68:71], v[20:23]
    s_waitcnt lgkmcnt(5)
    v_mfma_f32_16x16x32_bf16 v[20:23], v[96:99], v[72:75], v[20:23]
    s_waitcnt lgkmcnt(4)
    v_mfma_f32_16x16x32_bf16 v[20:23], v[100:103], v[76:79], v[20:23]
    s_waitcnt lgkmcnt(3)
    v_mfma_f32_16x16x32_bf16 v[20:23], v[104:107], v[80:83], v[20:23]
    s_waitcnt lgkmcnt(2)
    v_mfma_f32_16x16x32_bf16 v[20:23], v[108:111], v[84:87], v[20:23]
    s_waitcnt lgkmcnt(1)
    v_mfma_f32_16x16x32_bf16 v[20:23], v[24:27], v[88:91], v[20:23]
    s_waitcnt lgkmcnt(0)
    v_mfma_f32_16x16x32_bf16 v[20:23], v[28:31], v[92:95], v[20:23]
    v_max3_f32 v160, v16, v17, v18
    s_nop 6
    v_max3_f32 v160, v160, v19, v20
    v_max3_f32 v160, v160, v21, v22
    v_max_f32 v160, v160, v23
    v_mov_b32 v161, v160
    s_nop 1
    v_permlane32_swap_b32 v160, v161
    v_max_f32 v160, v160, v161
    v_mov_b32 v161, v160
    s_nop 1
    v_permlane16_swap_b32 v160, v161
    v_max_f32 v160, v160, v161
    s_lshl_b32 s7, s64, 7
    v_add_u32 v161, s7, v5
    s_mov_b64 exec, s[86:87]
    ds_write_b32 v161, v160
    s_mov_b64 exec, -1
    s_waitcnt lgkmcnt(0)
    s_barrier
    ds_read_b32 v160, v5 offset:0
    ds_read_b32 v161, v5 offset:128
    ds_read_b32 v162, v5 offset:256
    ds_read_b32 v163, v5 offset:384
    s_waitcnt lgkmcnt(0)
    v_max3_f32 v160, v160, v161, v162
    v_max_f32 v160, v160, v163
    v_mul_f32 v160, s67, v160
    v_max_f32 v160, v160, v13
    v_sub_f32 v161, v13, v160
    v_exp_f32 v161, v161
    v_mov_b32 v13, v160
    v_fma_f32 v16, v16, s67, -v160
    v_fma_f32 v17, v17, s67, -v160
    v_fma_f32 v18, v18, s67, -v160
    v_fma_f32 v19, v19, s67, -v160
    v_fma_f32 v20, v20, s67, -v160
    v_fma_f32 v21, v21, s67, -v160
    v_fma_f32 v22, v22, s67, -v160
    v_fma_f32 v23, v23, s67, -v160
    v_exp_f32 v16, v16
    v_exp_f32 v17, v17
    v_exp_f32 v18, v18
    v_exp_f32 v19, v19
    v_exp_f32 v20, v20
    v_exp_f32 v21, v21
    v_exp_f32 v22, v22
    v_exp_f32 v23, v23
    v_cvt_pk_bf16_f32 v24, v16, v17
    v_cvt_pk_bf16_f32 v25, v18, v19
    v_cvt_pk_bf16_f32 v26, v20, v21
    v_cvt_pk_bf16_f32 v27, v22, v23
    ds_write_b64 v6, v[24:25]
    ds_write_b64 v6, v[26:27] offset:4096
    v_add_u32 v162, 0xc00, v5
    s_mov_b64 exec, s[88:89]
    ds_write_b32 v162, v161
    s_mov_b64 exec, -1
    v_mul_f32 v14, v14, v161
    v_add_f32 v16, v16, v20
    v_add_f32 v17, v17, v21
    v_add_f32 v18, v18, v22
    v_add_f32 v19, v19, v23
    v_add_f32 v16, v16, v18
    v_add_f32 v17, v17, v19
    v_add_f32 v16, v16, v17
    v_add_f32 v14, v14, v16
    v_mov_b32 v160, v14
    s_nop 1
    v_permlane32_swap_b32 v14, v160
    v_add_f32 v14, v14, v160
    v_mov_b32 v160, v14
    s_nop 1
    v_permlane16_swap_b32 v14, v160
    v_add_f32 v14, v14, v160
    s_lshl_b32 s7, s64, 7
    s_add_u32 s7, s7, 0x200
    v_add_u32 v161, s7, v5
    v_add_u32 v162, 0xc80, v5
    s_mov_b64 exec, s[86:87]
    ds_write_b32 v161, v14
    s_mov_b64 exec, s[88:89]
    ds_write_b32 v162, v13
    s_mov_b64 exec, -1
    v_and_b32 v160, 31, v1
    v_lshlrev_b32 v98, 7, v160
    v_lshrrev_b32 v161, 5, v1
    v_and_b32 v160, 7, v1
    v_xor_b32 v161, v160, v161
    v_lshl_add_u32 v98, v161, 4, v98
    s_lshl_b32 s7, s3, 12
    v_add_u32 v98, s7, v98
    v_lshl_add_u32 v99, v1, 4, s7
    v_lshrrev_b32 v161, 3, v1
    v_xor_b32 v160, v160, v161
    v_lshlrev_b32 v100, 7, v161
    v_lshl_add_u32 v100, v160, 4, v100
    s_lshl_b32 s69, s60, 15
    s_add_u32 s69, s69, s7
    s_add_u32 s69, s69, 0x500000
    s_waitcnt lgkmcnt(0)
    s_barrier
    ds_read_b32 v15, v8
    ds_read_b128 v[16:19], v7 offset:0
    ds_read_b64_tr_b16 v[24:25], v9 offset:0
    ds_read_b64_tr_b16 v[26:27], v11 offset:0
    ds_read_b64_tr_b16 v[28:29], v10 offset:0
    ds_read_b64_tr_b16 v[30:31], v12 offset:0
    s_waitcnt lgkmcnt(5)
    v_mul_f32 v128, v15, v128
    v_mul_f32 v129, v15, v129
    v_mul_f32 v130, v15, v130
    v_mul_f32 v131, v15, v131
    v_mul_f32 v132, v15, v132
    v_mul_f32 v133, v15, v133
    v_mul_f32 v134, v15, v134
    v_mul_f32 v135, v15, v135
    s_branch LC_CR
.p2align 12
LT_CR2:
    s_branch LR_CR2
LC_CR:
    v_mul_f32 v136, v15, v136
    v_mul_f32 v137, v15, v137
    v_mul_f32 v138, v15, v138
    v_mul_f32 v139, v15, v139
    v_mul_f32 v140, v15, v140
    v_mul_f32 v141, v15, v141
    v_mul_f32 v142, v15, v142
    v_mul_f32 v143, v15, v143
    v_mul_f32 v144, v15, v144
    v_mul_f32 v145, v15, v145
    v_mul_f32 v146, v15, v146
    v_mul_f32 v147, v15, v147
    v_mul_f32 v148, v15, v148
    v_mul_f32 v149, v15, v149
    v_mul_f32 v150, v15, v150
    v_mul_f32 v151, v15, v151
    v_mul_f32 v152, v15, v152
    v_mul_f32 v153, v15, v153
    v_mul_f32 v154, v15, v154
    v_mul_f32 v155, v15, v155
    v_mul_f32 v156, v15, v156
    v_mul_f32 v157, v15, v157
    v_mul_f32 v158, v15, v158
    v_mul_f32 v159, v15, v159
    ds_read_b128 v[20:23], v7 offset:1024
    ds_read_b64_tr_b16 v[160:161], v9 offset:16384
    ds_read_b64_tr_b16 v[162:163], v11 offset:16384
    ds_read_b64_tr_b16 v[164:165], v10 offset:16384
    ds_read_b64_tr_b16 v[166:167], v12 offset:16384
    s_waitcnt lgkmcnt(7)
    v_mfma_f32_32x32x16_bf16 v[128:143], v[24:27], v[16:19], v[128:143]
    s_waitcnt lgkmcnt(5)
    v_mfma_f32_32x32x16_bf16 v[144:159], v[28:31], v[16:19], v[144:159]
    ds_read_b128 v[16:19], v7 offset:2048
    ds_read_b64_tr_b16 v[24:25], v9 offset:32768
    ds_read_b64_tr_b16 v[26:27], v11 offset:32768
    ds_read_b64_tr_b16 v[28:29], v10 offset:32768
    ds_read_b64_tr_b16 v[30:31], v12 offset:32768
    s_waitcnt lgkmcnt(7)
    v_mfma_f32_32x32x16_bf16 v[128:143], v[160:163], v[20:23], v[128:143]
    s_waitcnt lgkmcnt(5)
    v_mfma_f32_32x32x16_bf16 v[144:159], v[164:167], v[20:23], v[144:159]
    ds_read_b128 v[20:23], v7 offset:3072
    ds_read_b64_tr_b16 v[160:161], v9 offset:49152
    ds_read_b64_tr_b16 v[162:163], v11 offset:49152
    ds_read_b64_tr_b16 v[164:165], v10 offset:49152
    ds_read_b64_tr_b16 v[166:167], v12 offset:49152
    s_waitcnt lgkmcnt(7)
    v_mfma_f32_32x32x16_bf16 v[128:143], v[24:27], v[16:19], v[128:143]
    s_waitcnt lgkmcnt(5)
    v_mfma_f32_32x32x16_bf16 v[144:159], v[28:31], v[16:19], v[144:159]
    v_add_u32 v9, 0x10000, v9
    v_add_u32 v10, 0x10000, v10
    v_add_u32 v11, 0x10000, v11
    v_add_u32 v12, 0x10000, v12
    ds_read_b128 v[16:19], v7 offset:4096
    ds_read_b64_tr_b16 v[24:25], v9 offset:0
    ds_read_b64_tr_b16 v[26:27], v11 offset:0
    ds_read_b64_tr_b16 v[28:29], v10 offset:0
    ds_read_b64_tr_b16 v[30:31], v12 offset:0
    s_waitcnt lgkmcnt(7)
    v_mfma_f32_32x32x16_bf16 v[128:143], v[160:163], v[20:23], v[128:143]
    s_waitcnt lgkmcnt(5)
    v_mfma_f32_32x32x16_bf16 v[144:159], v[164:167], v[20:23], v[144:159]
    s_barrier
    ds_read_b128 v[20:23], v7 offset:5120
    ds_read_b64_tr_b16 v[160:161], v9 offset:16384
    ds_read_b64_tr_b16 v[162:163], v11 offset:16384
    ds_read_b64_tr_b16 v[164:165], v10 offset:16384
    ds_read_b64_tr_b16 v[166:167], v12 offset:16384
    s_waitcnt lgkmcnt(7)
    v_mfma_f32_32x32x16_bf16 v[128:143], v[24:27], v[16:19], v[128:143]
    s_waitcnt lgkmcnt(5)
    v_mfma_f32_32x32x16_bf16 v[144:159], v[28:31], v[16:19], v[144:159]
    ds_read_b128 v[16:19], v7 offset:6144
    ds_read_b64_tr_b16 v[24:25], v9 offset:32768
    ds_read_b64_tr_b16 v[26:27], v11 offset:32768
    ds_read_b64_tr_b16 v[28:29], v10 offset:32768
    ds_read_b64_tr_b16 v[30:31], v12 offset:32768
    s_waitcnt lgkmcnt(7)
    v_mfma_f32_32x32x16_bf16 v[128:143], v[160:163], v[20:23], v[128:143]
    s_waitcnt lgkmcnt(5)
    v_mfma_f32_32x32x16_bf16 v[144:159], v[164:167], v[20:23], v[144:159]
    ds_read_b128 v[20:23], v7 offset:7168
    ds_read_b64_tr_b16 v[160:161], v9 offset:49152
    ds_read_b64_tr_b16 v[162:163], v11 offset:49152
    ds_read_b64_tr_b16 v[164:165], v10 offset:49152
    ds_read_b64_tr_b16 v[166:167], v12 offset:49152
    s_waitcnt lgkmcnt(7)
    v_mfma_f32_32x32x16_bf16 v[128:143], v[24:27], v[16:19], v[128:143]
    s_waitcnt lgkmcnt(5)
    v_mfma_f32_32x32x16_bf16 v[144:159], v[28:31], v[16:19], v[144:159]
    s_waitcnt lgkmcnt(2)
    v_mfma_f32_32x32x16_bf16 v[128:143], v[160:163], v[20:23], v[128:143]
    s_waitcnt lgkmcnt(0)
    v_mfma_f32_32x32x16_bf16 v[144:159], v[164:167], v[20:23], v[144:159]
    s_nop 9
    v_permlane32_swap_b32 v128, v132
    v_permlane32_swap_b32 v129, v133
    v_permlane32_swap_b32 v130, v134
    v_permlane32_swap_b32 v131, v135
    v_cvt_pk_bf16_f32 v16, v128, v129
    v_cvt_pk_bf16_f32 v17, v130, v131
    v_cvt_pk_bf16_f32 v18, v132, v133
    v_cvt_pk_bf16_f32 v19, v134, v135
    v_xor_b32 v160, 0x0, v98
    ds_write_b128 v160, v[16:19]
    v_permlane32_swap_b32 v136, v140
    v_permlane32_swap_b32 v137, v141
    v_permlane32_swap_b32 v138, v142
    v_permlane32_swap_b32 v139, v143
    v_cvt_pk_bf16_f32 v20, v136, v137
    v_cvt_pk_bf16_f32 v21, v138, v139
    v_cvt_pk_bf16_f32 v22, v140, v141
    v_cvt_pk_bf16_f32 v23, v142, v143
    v_xor_b32 v161, 0x20, v98
    ds_write_b128 v161, v[20:23]
    v_permlane32_swap_b32 v144, v148
    v_permlane32_swap_b32 v145, v149
    v_permlane32_swap_b32 v146, v150
    v_permlane32_swap_b32 v147, v151
    v_cvt_pk_bf16_f32 v24, v144, v145
    v_cvt_pk_bf16_f32 v25, v146, v147
    v_cvt_pk_bf16_f32 v26, v148, v149
    v_cvt_pk_bf16_f32 v27, v150, v151
    v_xor_b32 v160, 0x40, v98
    ds_write_b128 v160, v[24:27]
    v_permlane32_swap_b32 v152, v156
    v_permlane32_swap_b32 v153, v157
    v_permlane32_swap_b32 v154, v158
    v_permlane32_swap_b32 v155, v159
    v_cvt_pk_bf16_f32 v28, v152, v153
    v_cvt_pk_bf16_f32 v29, v154, v155
    v_cvt_pk_bf16_f32 v30, v156, v157
    v_cvt_pk_bf16_f32 v31, v158, v159
    v_xor_b32 v161, 0x60, v98
    ds_write_b128 v161, v[28:31]
    ds_read_b128 v[32:35], v99 offset:0
    ds_read_b128 v[36:39], v99 offset:1024
    ds_read_b128 v[40:43], v99 offset:2048
    ds_read_b128 v[44:47], v99 offset:3072
    s_waitcnt lgkmcnt(3)
    buffer_store_dwordx4 v[32:35], v100, s[36:39], s69 offen offset:0 sc1
    s_waitcnt lgkmcnt(2)
    buffer_store_dwordx4 v[36:39], v100, s[36:39], s69 offen offset:1024 sc1
    s_waitcnt lgkmcnt(1)
    buffer_store_dwordx4 v[40:43], v100, s[36:39], s69 offen offset:2048 sc1
    s_waitcnt lgkmcnt(0)
    buffer_store_dwordx4 v[44:47], v100, s[36:39], s69 offen offset:3072 sc1
    v_mov_b32 v160, 0x2404c
    s_mov_b32 s80, 1600000
LW_84:
    ds_read_b32 v161, v160
    s_waitcnt lgkmcnt(0)
    v_readfirstlane_b32 s79, v161
    s_cmp_ge_u32 s79, 1
    s_cbranch_scc1 LWD_85
    s_sleep 2
    s_sub_u32 s80, s80, 1
    s_cmp_lg_u32 s80, 0
    s_cbranch_scc1 LW_84
LWD_85:
    v_mov_b32 v160, 0x24050
    ds_read_b64 v[162:163], v160
    s_waitcnt lgkmcnt(0)
    v_readfirstlane_b32 s94, v162
    v_readfirstlane_b32 s95, v163
    v_and_b32 v160, 31, v1
    v_lshlrev_b32 v3, 2, v160
    v_add_u32 v3, 0x27400, v3
    s_lshl_b32 s7, s60, 9
    s_add_u32 s7, s7, 0xe0000
    s_cmp_eq_u32 s3, 0
    s_cselect_b32 s7, s7, 0x40000000
    v_lshl_add_u32 v4, v160, 4, s7
    v_mov_b32 v22, s94
    v_mov_b32 v23, s95
    ds_read_b32 v16, v3 offset:0
    ds_read_b32 v17, v3 offset:128
    ds_read_b32 v18, v3 offset:256
    ds_read_b32 v19, v3 offset:384
    ds_read_b32 v20, v3 offset:2688
    s_waitcnt lgkmcnt(0)
    v_add_f32 v16, v16, v17
    v_add_f32 v18, v18, v19
    v_add_f32 v21, v16, v18
    s_waitcnt vmcnt(0)
    s_barrier
    s_mov_b64 exec, 0xffffffff
    buffer_store_dwordx4 v[20:23], v4, s[36:39], 0 offen sc1
    s_mov_b64 exec, -1
    v_lshlrev_b32 v2, 4, v1
    s_mov_b32 s44, s12
    s_and_b32 s45, s13, 0xffff
    s_mov_b32 s46, 0x8000000
    s_mov_b32 s47, 0x20000
    s_bfe_u32 s7, s5, 0x10002
    s_lshl_b32 s7, s7, 6
    s_add_u32 s7, s7, s6
    s_lshl_b32 s7, s7, 20
    s_lshl_b32 s72, s3, 10
    s_add_u32 s72, s72, s7
    s_add_u32 s72, s72, 1040384
    s_add_u32 s73, s72, 0x2000000
    s_mov_b32 s74, 4
    s_sleep 60
PV_86:
    s_waitcnt vmcnt(3)
    buffer_load_dwordx4 v[8:11], v2, s[44:47], s72 offen
    s_sub_u32 s72, s72, 8192
    s_waitcnt vmcnt(3)
    buffer_load_dwordx4 v[8:11], v2, s[44:47], s73 offen
    s_sub_u32 s73, s73, 8192
    s_sub_u32 s74, s74, 1
    s_cmp_lg_u32 s74, 0
    s_cbranch_scc1 PV_86
    s_mov_b32 s52, s30
    s_and_b32 s53, s31, 0xffff
    s_mov_b32 s54, 0x2000
    s_mov_b32 s55, 0x20000
    s_lshl_b32 s7, s60, 3
    s_add_u32 s7, s7, s3
    s_lshl_b32 s7, s7, 10
    s_add_u32 s7, s7, 0x100000
    v_add_u32 v4, s7, v2
    s_bfe_u32 s7, s60, 0x20003
    s_lshl_b32 s7, s7, 11
    s_lshr_b32 s66, s60, 5
    s_lshl_b32 s66, s66, 10
    s_add_u32 s7, s7, s66
    s_and_b32 s66, s60, 7
    s_lshl_b32 s66, s66, 7
    s_add_u32 s7, s7, s66
    v_and_b32 v5, 7, v1
    v_lshl_add_u32 v5, v5, 4, s7
    v_lshrrev_b32 v6, 4, v1
    v_lshl_add_u32 v5, v6, 2, v5
    s_mov_b32 s90, 0x00ff00ff
    s_mov_b32 s91, 0x00ff00ff
    s_lshl_b32 s7, s3, 10
    s_add_u32 s7, s7, 0x25200
    v_add_u32 v6, s7, v2
    s_mov_b32 s80, 200000
PO_87:
    buffer_load_dwordx4 v[32:35], v4, s[36:39], 0 offen sc1
PO2_88:
    s_waitcnt vmcnt(0)
    v_cmp_ne_u64 vcc, s[94:95], v[34:35]
    s_cmp_lg_u64 vcc, -1
    s_cbranch_scc1 POD_89
    s_sleep 20
    s_sub_u32 s80, s80, 1
    s_cmp_lg_u32 s80, 0
    s_cbranch_scc1 PO_87
POD_89:
    v_lshlrev_b32 v64, 16, v32
    v_and_b32 v65, 0xffff0000, v32
    v_lshlrev_b32 v66, 16, v33
    v_and_b32 v67, 0xffff0000, v33
    s_cbranch_vccz RD_90
    buffer_load_dwordx4 v[32:35], v4, s[36:39], 0 offen sc1
    s_sleep 4
    buffer_load_dwordx4 v[36:39], v4, s[36:39], 0 offen sc1
    s_sleep 4
    s_mov_b32 s80, 200000
PP_91:
    s_waitcnt vmcnt(1)
    v_cmp_ne_u64 vcc, s[94:95], v[34:35]
    s_cmp_eq_u64 vcc, 0
    s_cbranch_scc1 PPO_93
    buffer_load_dwordx4 v[32:35], v4, s[36:39], 0 offen sc1
    s_waitcnt vmcnt(1)
    v_cmp_ne_u64 vcc, s[94:95], v[38:39]
    s_cmp_eq_u64 vcc, 0
    s_cbranch_scc1 PPO_94
    buffer_load_dwordx4 v[36:39], v4, s[36:39], 0 offen sc1
    s_sub_u32 s80, s80, 1
    s_cmp_lg_u32 s80, 0
    s_cbranch_scc1 PP_91
PPO_93:
    v_lshlrev_b32 v64, 16, v32
    v_and_b32 v65, 0xffff0000, v32
    v_lshlrev_b32 v66, 16, v33
    v_and_b32 v67, 0xffff0000, v33
    s_branch PPD_92
PPO_94:
    v_lshlrev_b32 v64, 16, v36
    v_and_b32 v65, 0xffff0000, v36
    v_lshlrev_b32 v66, 16, v37
    v_and_b32 v67, 0xffff0000, v37
PPD_92:
RD_90:
    ds_write_b128 v6, v[64:67]
    s_waitcnt lgkmcnt(0)
    s_barrier
    s_cmp_lg_u32 s3, 0
    s_cbranch_scc1 L_END
    ds_read_b128 v[64:67], v6 offset:0
    ds_read_b128 v[68:71], v6 offset:1024
    ds_read_b128 v[72:75], v6 offset:2048
    ds_read_b128 v[76:79], v6 offset:3072
    ds_read_b128 v[80:83], v6 offset:4096
    ds_read_b128 v[84:87], v6 offset:5120
    ds_read_b128 v[88:91], v6 offset:6144
    ds_read_b128 v[92:95], v6 offset:7168
    s_waitcnt lgkmcnt(4)
    v_pk_add_f32 v[64:65], v[64:65], v[72:73]
    v_pk_add_f32 v[66:67], v[66:67], v[74:75]
    v_pk_add_f32 v[68:69], v[68:69], v[76:77]
    v_pk_add_f32 v[70:71], v[70:71], v[78:79]
    v_pk_add_f32 v[64:65], v[64:65], v[68:69]
    v_pk_add_f32 v[66:67], v[66:67], v[70:71]
    s_waitcnt lgkmcnt(0)
    v_pk_add_f32 v[80:81], v[80:81], v[88:89]
    v_pk_add_f32 v[82:83], v[82:83], v[90:91]
    v_pk_add_f32 v[84:85], v[84:85], v[92:93]
    v_pk_add_f32 v[86:87], v[86:87], v[94:95]
    v_pk_add_f32 v[80:81], v[80:81], v[84:85]
    v_pk_add_f32 v[82:83], v[82:83], v[86:87]
    s_nop 0
    v_permlane32_swap_b32 v64, v80
    v_permlane32_swap_b32 v65, v81
    v_permlane32_swap_b32 v66, v82
    v_permlane32_swap_b32 v67, v83
    v_add_f32 v64, v64, v80
    v_add_f32 v65, v65, v81
    v_add_f32 v66, v66, v82
    v_add_f32 v67, v67, v83
    s_nop 0
    v_permlane16_swap_b32 v64, v66
    v_permlane16_swap_b32 v65, v67
    v_add_f32 v64, v64, v66
    v_add_f32 v65, v65, v67
    s_nop 0
    v_add_f32_dpp v64, v64, v64 row_ror:8 row_mask:0xf bank_mask:0xf
    v_add_f32_dpp v65, v65, v65 row_ror:8 row_mask:0xf bank_mask:0xf
    v_cvt_pk_bf16_f32 v8, v64, v65
    s_mov_b64 exec, s[90:91]
    buffer_store_dword v8, v5, s[52:55], 0 offen
    s_mov_b64 exec, -1
    s_endpgm
L_CODE_END:
.section .rodata,"a"
.p2align 6
.amdhsa_kernel concat_heads__sliding_block_cached__compressed_kv_cla__decode_kernel
  .amdhsa_next_free_vgpr 168
  .amdhsa_next_free_sgpr 102
  .amdhsa_accum_offset 168
  .amdhsa_group_segment_fixed_size 0
  .amdhsa_kernarg_size 112
  .amdhsa_user_sgpr_count 2
  .amdhsa_user_sgpr_kernarg_segment_ptr 1
  .amdhsa_system_sgpr_workgroup_id_x 1
  .amdhsa_float_denorm_mode_32 3
.end_amdhsa_kernel
```

```asm
; @launch grid=(256,1,1) block=(768,1,1) lds=163840
.amdgcn_target "amdgcn-amd-amdhsa--gfx950"
.text
.globl concat_heads__sliding_block_cached__compressed_kv_cla__decode_kernel
.p2align 12
.p2align 8
.type concat_heads__sliding_block_cached__compressed_kv_cla__decode_kernel,@function
concat_heads__sliding_block_cached__compressed_kv_cla__decode_kernel:
    s_load_dwordx16 s[8:23], s[0:1], 0
    s_load_dwordx8 s[24:31], s[0:1], 64
    s_load_dwordx4 s[32:35], s[0:1], 96
    v_lshrrev_b32 v1, 6, v0
    s_and_b32 s4, s2, 7
    v_readfirstlane_b32 s3, v1
    s_lshr_b32 s5, s2, 3
    v_and_b32 v1, 63, v0
    s_and_b32 s7, s5, 3
    s_lshl2_add_u32 s6, s4, s7
    s_cmp_ge_u32 s5, 32
    s_cbranch_scc1 L_END0
    s_cmp_ge_u32 s5, 16
    s_cbranch_scc1 EA_1
    s_cmp_ge_u32 s5, 8
    s_cbranch_scc1 EC_2
    s_cmp_ge_u32 s3, 8
    s_cbranch_scc1 L_W2
    s_cmp_ge_u32 s3, 4
    s_cbranch_scc1 L_W1
    s_branch L_W
EC_2:
    s_cmp_ge_u32 s3, 8
    s_cbranch_scc1 L_CSVC
    s_branch L_C
EA_1:
    s_cmp_eq_u32 s3, 11
    s_cbranch_scc1 L_ASVC
    s_branch L_AA
L_W2:
    s_sub_u32 s62, s3, 8
    s_lshl_b32 s7, s5, 2
    s_add_u32 s7, s7, s62
    s_lshl_b32 s7, s7, 17
    s_lshl_b32 s70, s4, 10
    s_add_u32 s70, s70, s7
    s_lshl_b32 s71, s62, 14
    v_lshlrev_b32 v2, 4, v1
    s_lshl_b32 s7, s62, 6
    v_xor_b32 v4, s7, v2
    v_xor_b32 v5, 16, v4
    v_xor_b32 v6, 32, v4
    v_xor_b32 v7, 48, v4
    s_waitcnt lgkmcnt(0)
    s_lshl_b32 s7, s2, 4
    s_add_u32 s7, s7, s3
    s_cmp_lg_u32 s7, 8
    s_cbranch_scc1 NM_61
    s_memrealtime s[94:95]
    s_mov_b32 s40, s32
    s_and_b32 s41, s33, 0xffff
    s_mov_b32 s42, 0x100
    s_mov_b32 s43, 0x20000
    v_mov_b32 v8, 0
    s_waitcnt lgkmcnt(0)
    s_or_b32 s95, s95, 0x80000000
    v_mov_b32 v10, s94
    v_mov_b32 v11, s95
    s_mov_b64 exec, 1
    buffer_store_dwordx2 v[10:11], v8, s[40:43], 0 offen sc1
    s_mov_b64 exec, -1
NM_61:
    s_mov_b32 s52, s24
    s_and_b32 s53, s25, 0xffff
    s_mov_b32 s54, 0x400000
    s_mov_b32 s55, 0x20000
    s_mov_b32 m0, s71
    s_nop 0
    buffer_load_dwordx4 v4, s[52:55], s70 offen nt lds
    s_addk_i32 s70, 8192
    s_addk_i32 s71, 1024
    s_mov_b32 m0, s71
    s_nop 0
    buffer_load_dwordx4 v4, s[52:55], s70 offen nt lds
    s_addk_i32 s70, 8192
    s_addk_i32 s71, 1024
    s_mov_b32 m0, s71
    s_nop 0
    buffer_load_dwordx4 v4, s[52:55], s70 offen nt lds
    s_addk_i32 s70, 8192
    s_addk_i32 s71, 1024
    s_mov_b32 m0, s71
    s_nop 0
    buffer_load_dwordx4 v4, s[52:55], s70 offen nt lds
    s_addk_i32 s70, 8192
    s_addk_i32 s71, 1024
    s_mov_b32 m0, s71
    s_nop 0
    buffer_load_dwordx4 v5, s[52:55], s70 offen nt lds
    s_addk_i32 s70, 8192
    s_addk_i32 s71, 1024
    s_mov_b32 m0, s71
    s_nop 0
    buffer_load_dwordx4 v5, s[52:55], s70 offen nt lds
    s_addk_i32 s70, 8192
    s_addk_i32 s71, 1024
    s_mov_b32 m0, s71
    s_nop 0
    buffer_load_dwordx4 v5, s[52:55], s70 offen nt lds
    s_addk_i32 s70, 8192
    s_addk_i32 s71, 1024
    s_mov_b32 m0, s71
    s_nop 0
    buffer_load_dwordx4 v5, s[52:55], s70 offen nt lds
    s_addk_i32 s70, 8192
    s_addk_i32 s71, 1024
    s_branch L_W2B
L_AA:
    s_cmp_ge_u32 s3, 8
    s_cbranch_scc1 AK_3
    s_and_b32 s7, s5, 12
    s_and_b32 s66, s3, 3
    s_add_u32 s7, s7, s66
    v_lshrrev_b32 v2, 4, v1
    v_lshlrev_b32 v3, 16, v2
    v_and_b32 v4, 15, v1
    v_lshl_add_u32 v3, v4, 4, v3
    s_lshl_b32 s66, s7, 18
    s_lshl_b32 s67, s6, 8
    s_add_u32 s66, s66, s67
    s_cmp_lt_u32 s3, 4
    s_cbranch_scc1 AP_5
    s_xor_b32 s66, s66, 512
    s_barrier
    s_sleep 26
AP_5:
    s_cmp_lt_u32 s3, 4
    s_waitcnt lgkmcnt(0)
    s_cselect_b32 s72, s22, s14
    s_cselect_b32 s73, s23, s15
    s_cselect_b32 s70, s18, s8
    s_cselect_b32 s71, s19, s9
    s_mov_b32 s56, s72
    s_and_b32 s57, s73, 0xffff
    s_mov_b32 s58, 0x400000
    s_mov_b32 s59, 0x20000
    buffer_load_dwordx4 v[128:131], v3, s[56:59], s66 offen nt
    s_addk_i32 s66, 8192
    buffer_load_dwordx4 v[132:135], v3, s[56:59], s66 offen nt
    s_addk_i32 s66, 8192
    buffer_load_dwordx4 v[136:139], v3, s[56:59], s66 offen nt
    s_addk_i32 s66, 8192
    buffer_load_dwordx4 v[140:143], v3, s[56:59], s66 offen nt
    s_addk_i32 s66, 8192
    buffer_load_dwordx4 v[144:147], v3, s[56:59], s66 offen nt
    s_addk_i32 s66, 8192
    buffer_load_dwordx4 v[148:151], v3, s[56:59], s66 offen nt
    s_addk_i32 s66, 8192
    buffer_load_dwordx4 v[152:155], v3, s[56:59], s66 offen nt
    s_addk_i32 s66, 8192
    buffer_load_dwordx4 v[156:159], v3, s[56:59], s66 offen nt
    s_addk_i32 s66, 8192
    s_branch L_AB
L_C:
    s_lshl_b32 s60, s4, 3
    s_add_u32 s60, s60, s5
    s_sub_u32 s60, s60, 8
    v_lshlrev_b32 v160, 4, v1
    s_and_b32 s7, s3, 3
    s_lshl_b32 s7, s7, 2
    s_lshr_b32 s66, s3, 2
    s_or_b32 s7, s7, s66
    s_lshl_b32 s62, s7, 4
    v_xor_b32 v2, s62, v160
    v_xor_b32 v3, 32, v2
    s_lshl_b32 s70, s60, 18
    s_lshl_b32 s68, s3, 10
    s_add_u32 s61, s70, s68
    s_waitcnt lgkmcnt(0)
    s_mov_b32 s44, s20
    s_and_b32 s45, s21, 0xffff
    s_mov_b32 s46, 0x1000000
    s_mov_b32 s47, 0x20000
    s_mov_b32 m0, s68
    s_nop 0
    buffer_load_dwordx4 v2, s[44:47], s61 offen nt lds
    s_addk_i32 s68, 8192
    s_addk_i32 s61, 8192
    s_mov_b32 m0, s68
    s_nop 0
    buffer_load_dwordx4 v3, s[44:47], s61 offen nt lds
    s_addk_i32 s68, 8192
    s_addk_i32 s61, 8192
    s_mov_b32 m0, s68
    s_nop 0
    buffer_load_dwordx4 v2, s[44:47], s61 offen nt lds
    s_addk_i32 s68, 8192
    s_addk_i32 s61, 8192
    s_mov_b32 m0, s68
    s_nop 0
    buffer_load_dwordx4 v3, s[44:47], s61 offen nt lds
    s_addk_i32 s68, 8192
    s_branch L_CB
L_AB:
    v_bfe_u32 v4, v1, 2, 2
    v_lshlrev_b32 v4, 10, v4
    v_lshl_add_u32 v4, v2, 4, v4
    s_lshl_b32 s67, s7, 6
    s_mov_b32 s52, s70
    s_and_b32 s53, s71, 0xffff
    s_mov_b32 s54, 0x1000
    s_mov_b32 s55, 0x20000
    buffer_load_dwordx4 v[160:163], v4, s[52:55], s67 offen
    s_mov_b32 s92, 0x05040100
    s_mov_b32 s93, 0x07060302
    s_mov_b32 s36, s34
    s_and_b32 s37, s35, 0xffff
    s_mov_b32 s38, 0x1000000
    s_mov_b32 s39, 0x20000
    s_mov_b32 s40, s32
    s_and_b32 s41, s33, 0xffff
    s_mov_b32 s42, 0x100
    s_mov_b32 s43, 0x20000
    s_mov_b32 s44, s10
    s_and_b32 s45, s11, 0xffff
    s_mov_b32 s46, 0x8000000
    s_mov_b32 s47, 0x20000
    s_mov_b32 s48, s12
    s_and_b32 s49, s13, 0xffff
    s_mov_b32 s50, 0x8000000
    s_mov_b32 s51, 0x20000
    s_lshr_b32 s7, s5, 2
    s_sub_u32 s7, s7, 4
    s_lshl_b32 s7, s7, 5
    s_add_u32 s7, s7, s6
    s_lshl_b32 s7, s7, 20
    s_add_u32 s7, s7, 0xC0000
    v_lshlrev_b32 v6, 4, v1
    v_add_u32 v6, s7, v6
    s_mov_b32 s64, 0x3e0293ee
    s_lshl_b32 s60, s3, 12
    s_mov_b32 s61, s60
    s_cmp_ge_u32 s3, 8
    s_cselect_b32 s7, 5, 0
    s_sub_u32 s7, s3, s7
    s_mul_i32 s7, s7, 6144
    s_add_u32 s63, s7, 225280
    s_add_u32 s65, s63, 4096
    s_sub_u32 s7, s3, 3
    s_cmp_lt_u32 s7, 5
    s_cselect_b32 s62, 0xff800000, 0
    s_cmp_ge_u32 s3, 4
    s_cbranch_scc1 AP_6
    s_barrier
AP_6:
    s_lshl_b32 s7, s3, 11
    s_add_u32 s7, s7, 0x0
    v_lshl_add_u32 v2, v1, 5, s7
    s_cmp_lt_u32 s3, 4
    s_cselect_b32 s7, 0x44, 0x40
    s_add_u32 s7, s7, 0x24000
    v_mov_b32 v3, s7
    v_mov_b32 v4, 1
    s_waitcnt vmcnt(0)
    v_perm_b32 v96, v132, v128, s92
    v_perm_b32 v97, v140, v136, s92
    v_perm_b32 v98, v148, v144, s92
    v_perm_b32 v99, v156, v152, s92
    v_perm_b32 v100, v132, v128, s93
    v_perm_b32 v101, v140, v136, s93
    v_perm_b32 v102, v148, v144, s93
    v_perm_b32 v103, v156, v152, s93
    v_perm_b32 v104, v133, v129, s92
    v_perm_b32 v105, v141, v137, s92
    v_perm_b32 v106, v149, v145, s92
    v_perm_b32 v107, v157, v153, s92
    v_perm_b32 v108, v133, v129, s93
    v_perm_b32 v109, v141, v137, s93
    v_perm_b32 v110, v149, v145, s93
    v_perm_b32 v111, v157, v153, s93
    v_perm_b32 v112, v134, v130, s92
    v_perm_b32 v113, v142, v138, s92
    v_perm_b32 v114, v150, v146, s92
    v_perm_b32 v115, v158, v154, s92
    v_perm_b32 v116, v134, v130, s93
    v_perm_b32 v117, v142, v138, s93
    v_perm_b32 v118, v150, v146, s93
    v_perm_b32 v119, v158, v154, s93
    v_perm_b32 v120, v135, v131, s92
    v_perm_b32 v121, v143, v139, s92
    v_perm_b32 v122, v151, v147, s92
    v_perm_b32 v123, v159, v155, s92
    v_perm_b32 v124, v135, v131, s93
    v_perm_b32 v125, v143, v139, s93
    v_perm_b32 v126, v151, v147, s93
    v_perm_b32 v127, v159, v155, s93
    v_mfma_f32_16x16x32_bf16 v[64:67], v[160:163], v[96:99], 0
    v_mfma_f32_16x16x32_bf16 v[68:71], v[160:163], v[100:103], 0
    v_mfma_f32_16x16x32_bf16 v[72:75], v[160:163], v[104:107], 0
    v_mfma_f32_16x16x32_bf16 v[76:79], v[160:163], v[108:111], 0
    v_mfma_f32_16x16x32_bf16 v[80:83], v[160:163], v[112:115], 0
    v_mfma_f32_16x16x32_bf16 v[84:87], v[160:163], v[116:119], 0
    v_mfma_f32_16x16x32_bf16 v[88:91], v[160:163], v[120:123], 0
    v_mfma_f32_16x16x32_bf16 v[92:95], v[160:163], v[124:127], 0
    s_nop 0
    v_mov_b32 v128, v64
    v_mov_b32 v129, v68
    v_mov_b32 v130, v72
    v_mov_b32 v131, v76
    v_mov_b32 v132, v80
    v_mov_b32 v133, v84
    v_mov_b32 v134, v88
    v_mov_b32 v135, v92
    ds_write_b128 v2, v[128:131]
    ds_write_b128 v2, v[132:135] offset:16
    s_waitcnt lgkmcnt(0)
    s_mov_b64 exec, 1
    ds_add_u32 v3, v4
    s_mov_b64 exec, -1
    s_branch AJ_4
AK_3:
    s_waitcnt lgkmcnt(0)
    s_mov_b32 s92, 0x05040100
    s_mov_b32 s93, 0x07060302
    s_mov_b32 s36, s34
    s_and_b32 s37, s35, 0xffff
    s_mov_b32 s38, 0x1000000
    s_mov_b32 s39, 0x20000
    s_mov_b32 s40, s32
    s_and_b32 s41, s33, 0xffff
    s_mov_b32 s42, 0x100
    s_mov_b32 s43, 0x20000
    s_mov_b32 s44, s10
    s_and_b32 s45, s11, 0xffff
    s_mov_b32 s46, 0x8000000
    s_mov_b32 s47, 0x20000
    s_mov_b32 s48, s12
    s_and_b32 s49, s13, 0xffff
    s_mov_b32 s50, 0x8000000
    s_mov_b32 s51, 0x20000
    s_lshr_b32 s7, s5, 2
    s_sub_u32 s7, s7, 4
    s_lshl_b32 s7, s7, 5
    s_add_u32 s7, s7, s6
    s_lshl_b32 s7, s7, 20
    s_add_u32 s7, s7, 0xC0000
    v_lshlrev_b32 v6, 4, v1
    v_add_u32 v6, s7, v6
    s_mov_b32 s64, 0x3e0293ee
    s_lshl_b32 s60, s3, 12
    s_mov_b32 s61, s60
    s_cmp_ge_u32 s3, 8
    s_cselect_b32 s7, 5, 0
    s_sub_u32 s7, s3, s7
    s_mul_i32 s7, s7, 6144
    s_add_u32 s63, s7, 225280
    s_add_u32 s65, s63, 4096
    s_sub_u32 s7, s3, 3
    s_cmp_lt_u32 s7, 5
    s_cselect_b32 s62, 0xff800000, 0
    s_barrier
    s_cmp_eq_u32 s3, 8
    s_cbranch_scc1 LT_AR
LR_AR:
    s_cmp_eq_u32 s3, 9
    s_cbranch_scc1 LT_AR2
LR_AR2:
    s_sleep 40
AJ_4:
    s_branch L_AR
L_W2B:
    s_cmp_lg_u32 s3, 11
    s_cbranch_scc1 Z_62
    v_lshlrev_b32 v2, 2, v1
    v_add_u32 v2, 0x24000, v2
    v_mov_b32 v3, 0
    ds_write_b32 v2, v3
Z_62:
    s_waitcnt lgkmcnt(0)
    s_mov_b32 s92, 0x05040100
    s_mov_b32 s93, 0x07060302
    s_mov_b32 s36, s34
    s_and_b32 s37, s35, 0xffff
    s_mov_b32 s38, 0x1000000
    s_mov_b32 s39, 0x20000
    s_mov_b32 s40, s32
    s_and_b32 s41, s33, 0xffff
    s_mov_b32 s42, 0x100
    s_mov_b32 s43, 0x20000
    s_barrier
    s_mov_b32 m0, s71
    s_waitcnt vmcnt(7)
    buffer_load_dwordx4 v6, s[52:55], s70 offen nt lds
    s_addk_i32 s70, 8192
    s_addk_i32 s71, 1024
    s_mov_b32 m0, s71
    s_waitcnt vmcnt(7)
    buffer_load_dwordx4 v6, s[52:55], s70 offen nt lds
    s_addk_i32 s70, 8192
    s_addk_i32 s71, 1024
    s_mov_b32 m0, s71
    s_waitcnt vmcnt(7)
    buffer_load_dwordx4 v6, s[52:55], s70 offen nt lds
    s_addk_i32 s70, 8192
    s_addk_i32 s71, 1024
    s_mov_b32 m0, s71
    s_waitcnt vmcnt(7)
    buffer_load_dwordx4 v6, s[52:55], s70 offen nt lds
    s_addk_i32 s70, 8192
    s_addk_i32 s71, 1024
    s_mov_b32 m0, s71
    s_waitcnt vmcnt(7)
    buffer_load_dwordx4 v7, s[52:55], s70 offen nt lds
    s_addk_i32 s70, 8192
    s_addk_i32 s71, 1024
    s_mov_b32 m0, s71
    s_waitcnt vmcnt(7)
    buffer_load_dwordx4 v7, s[52:55], s70 offen nt lds
    s_addk_i32 s70, 8192
    s_addk_i32 s71, 1024
    s_mov_b32 m0, s71
    s_waitcnt vmcnt(7)
    buffer_load_dwordx4 v7, s[52:55], s70 offen nt lds
    s_addk_i32 s70, 8192
    s_addk_i32 s71, 1024
    s_mov_b32 m0, s71
    s_waitcnt vmcnt(7)
    buffer_load_dwordx4 v7, s[52:55], s70 offen nt lds
    s_addk_i32 s70, 8192
    s_addk_i32 s71, 1024
    s_branch L_W2R
L_CB:
    s_mov_b32 s92, 0x05040100
    s_mov_b32 s93, 0x07060302
    s_mov_b32 s36, s34
    s_and_b32 s37, s35, 0xffff
    s_mov_b32 s38, 0x1000000
    s_mov_b32 s39, 0x20000
    s_mov_b32 s40, s32
    s_and_b32 s41, s33, 0xffff
    s_mov_b32 s42, 0x100
    s_mov_b32 s43, 0x20000
    s_lshr_b32 s64, s3, 1
    s_and_b32 s65, s3, 1
    s_mov_b32 s67, 0x3e0293ee
    s_barrier
    s_addk_i32 s61, 8192
    s_mov_b32 m0, s68
    s_waitcnt vmcnt(3)
    buffer_load_dwordx4 v2, s[44:47], s61 offen nt lds
    s_addk_i32 s68, 8192
    s_addk_i32 s61, 8192
    s_mov_b32 m0, s68
    s_waitcnt vmcnt(3)
    buffer_load_dwordx4 v3, s[44:47], s61 offen nt lds
    s_addk_i32 s68, 8192
    s_addk_i32 s61, 8192
    s_mov_b32 m0, s68
    s_waitcnt vmcnt(3)
    buffer_load_dwordx4 v2, s[44:47], s61 offen nt lds
    s_addk_i32 s68, 8192
    s_addk_i32 s61, 8192
    s_mov_b32 m0, s68
    s_waitcnt vmcnt(3)
    buffer_load_dwordx4 v3, s[44:47], s61 offen nt lds
    s_addk_i32 s68, 8192
    s_addk_i32 s61, 8192
    s_mov_b32 m0, s68
    s_waitcnt vmcnt(3)
    buffer_load_dwordx4 v2, s[44:47], s61 offen nt lds
    s_addk_i32 s68, 8192
    s_addk_i32 s61, 8192
    s_mov_b32 m0, s68
    s_waitcnt vmcnt(3)
    buffer_load_dwordx4 v3, s[44:47], s61 offen nt lds
    s_addk_i32 s68, 8192
    s_addk_i32 s61, 8192
    s_mov_b32 m0, s68
    s_waitcnt vmcnt(3)
    buffer_load_dwordx4 v2, s[44:47], s61 offen nt lds
    s_addk_i32 s68, 8192
    s_addk_i32 s61, 8192
    s_mov_b32 m0, s68
    s_waitcnt vmcnt(3)
    buffer_load_dwordx4 v3, s[44:47], s61 offen nt lds
    s_addk_i32 s68, 8192
    s_addk_i32 s61, 8192
    s_waitcnt vmcnt(3)
    buffer_load_dwordx4 v[128:131], v2, s[44:47], s61 offen nt
    s_addk_i32 s61, 8192
    s_waitcnt vmcnt(3)
    buffer_load_dwordx4 v[132:135], v3, s[44:47], s61 offen nt
    s_addk_i32 s61, 8192
    s_waitcnt vmcnt(3)
    buffer_load_dwordx4 v[136:139], v2, s[44:47], s61 offen nt
    s_addk_i32 s61, 8192
    s_waitcnt vmcnt(3)
    buffer_load_dwordx4 v[140:143], v3, s[44:47], s61 offen nt
    s_addk_i32 s61, 8192
    s_waitcnt vmcnt(3)
    buffer_load_dwordx4 v[96:99], v2, s[44:47], s61 offen nt
    s_addk_i32 s61, 8192
    s_waitcnt vmcnt(3)
    buffer_load_dwordx4 v[100:103], v3, s[44:47], s61 offen nt
    s_addk_i32 s61, 8192
    s_waitcnt vmcnt(3)
    buffer_load_dwordx4 v[104:107], v2, s[44:47], s61 offen nt
    s_addk_i32 s61, 8192
    s_waitcnt vmcnt(3)
    buffer_load_dwordx4 v[108:111], v3, s[44:47], s61 offen nt
    s_addk_i32 s61, 8192
    s_waitcnt vmcnt(3)
    buffer_load_dwordx4 v[112:115], v2, s[44:47], s61 offen nt
    s_addk_i32 s61, 8192
    s_waitcnt vmcnt(3)
    buffer_load_dwordx4 v[116:119], v3, s[44:47], s61 offen nt
    s_addk_i32 s61, 8192
    v_mov_b32 v160, 0x24018
    v_mov_b32 v161, 1
    s_waitcnt lgkmcnt(0)
    s_mov_b64 exec, 1
    ds_add_u32 v160, v161
    s_mov_b64 exec, -1
    s_waitcnt vmcnt(3)
    buffer_load_dwordx4 v[120:123], v2, s[44:47], s61 offen nt
    s_addk_i32 s61, 8192
    s_waitcnt vmcnt(3)
    buffer_load_dwordx4 v[124:127], v3, s[44:47], s61 offen nt
    s_addk_i32 s61, 8192
    s_branch L_CR
L_END:
    s_endpgm
L_END0:
    s_endpgm
.p2align 12
LT_AR:
    s_branch LR_AR
L_AR:
    v_mov_b32 v34, 0
    v_mov_b32 v35, 0
    v_mov_b32 v36, 0
    v_mov_b32 v37, 0
    v_mov_b32 v38, 0
    v_mov_b32 v39, 0
    v_mov_b32 v40, 0
    v_mov_b32 v41, 0
    v_mov_b32 v42, 0
    v_mov_b32 v43, 0
    v_mov_b32 v44, 0
    v_mov_b32 v45, 0
    v_mov_b32 v46, 0
    v_mov_b32 v47, 0
    v_mov_b32 v48, 0
    v_mov_b32 v49, 0
    v_mov_b32 v50, 0
    v_mov_b32 v51, 0
    v_mov_b32 v52, 0
    v_mov_b32 v53, 0
    v_mov_b32 v54, 0
    v_mov_b32 v55, 0
    v_mov_b32 v56, 0
    v_mov_b32 v57, 0
    s_cmp_lg_u32 s62, 0
    s_cbranch_scc1 L_AK2
    buffer_load_dwordx4 v[34:37], v6, s[44:47], s63 offen offset:0 nt
    buffer_load_dwordx4 v[38:41], v6, s[44:47], s63 offen offset:1024 nt
    buffer_load_dwordx4 v[42:45], v6, s[44:47], s63 offen offset:2048 nt
    buffer_load_dwordx4 v[46:49], v6, s[44:47], s63 offen offset:3072 nt
    buffer_load_dwordx4 v[50:53], v6, s[44:47], s65 offen offset:0 nt
    buffer_load_dwordx4 v[54:57], v6, s[44:47], s65 offen offset:1024 nt
L_AK2:
    s_waitcnt vmcnt(0)
    buffer_load_dwordx4 v[58:61], v6, s[44:47], s60 offen offset:0 nt
    buffer_load_dwordx4 v[62:65], v6, s[44:47], s60 offen offset:1024 nt
    buffer_load_dwordx4 v[66:69], v6, s[44:47], s60 offen offset:2048 nt
    buffer_load_dwordx4 v[70:73], v6, s[44:47], s60 offen offset:3072 nt
    s_add_u32 s60, s60, 45056
    s_waitcnt vmcnt(0)
    buffer_load_dwordx4 v[74:77], v6, s[44:47], s60 offen offset:0 nt
    buffer_load_dwordx4 v[78:81], v6, s[44:47], s60 offen offset:1024 nt
    buffer_load_dwordx4 v[82:85], v6, s[44:47], s60 offen offset:2048 nt
    buffer_load_dwordx4 v[86:89], v6, s[44:47], s60 offen offset:3072 nt
    s_add_u32 s60, s60, 45056
    s_waitcnt vmcnt(0)
    buffer_load_dwordx4 v[90:93], v6, s[44:47], s60 offen offset:0 nt
    buffer_load_dwordx4 v[94:97], v6, s[44:47], s60 offen offset:1024 nt
    buffer_load_dwordx4 v[98:101], v6, s[44:47], s60 offen offset:2048 nt
    buffer_load_dwordx4 v[102:105], v6, s[44:47], s60 offen offset:3072 nt
    s_add_u32 s60, s60, 45056
    v_mov_b32 v160, 0x24004
    s_mov_b32 s80, 1600000
LW_7:
    ds_read_b32 v161, v160
    s_waitcnt lgkmcnt(0)
    v_readfirstlane_b32 s79, v161
    s_cmp_ge_u32 s79, 1
    s_cbranch_scc1 LWD_8
    s_sleep 4
    s_sub_u32 s80, s80, 1
    s_cmp_lg_u32 s80, 0
    s_cbranch_scc1 LW_7
LWD_8:
    v_and_b32 v160, 15, v1
    v_lshlrev_b32 v160, 4, v160
    v_add_u32 v160, 0x24100, v160
    ds_read_b128 v[2:5], v160
    s_waitcnt lgkmcnt(0)
    v_dot2_f32_bf16 v8, v34, v2, 0
    v_dot2_f32_bf16 v9, v38, v2, 0
    v_dot2_f32_bf16 v10, v42, v2, 0
    v_dot2_f32_bf16 v11, v46, v2, 0
    v_dot2_f32_bf16 v12, v50, v2, 0
    v_dot2_f32_bf16 v13, v54, v2, 0
    v_dot2_f32_bf16 v8, v35, v3, v8
    v_dot2_f32_bf16 v9, v39, v3, v9
    v_dot2_f32_bf16 v10, v43, v3, v10
    v_dot2_f32_bf16 v11, v47, v3, v11
    v_dot2_f32_bf16 v12, v51, v3, v12
    v_dot2_f32_bf16 v13, v55, v3, v13
    v_dot2_f32_bf16 v8, v36, v4, v8
    v_dot2_f32_bf16 v9, v40, v4, v9
    v_dot2_f32_bf16 v10, v44, v4, v10
    v_dot2_f32_bf16 v11, v48, v4, v11
    v_dot2_f32_bf16 v12, v52, v4, v12
    v_dot2_f32_bf16 v13, v56, v4, v13
    v_dot2_f32_bf16 v8, v37, v5, v8
    v_dot2_f32_bf16 v9, v41, v5, v9
    v_dot2_f32_bf16 v10, v45, v5, v10
    v_dot2_f32_bf16 v11, v49, v5, v11
    v_dot2_f32_bf16 v12, v53, v5, v12
    v_dot2_f32_bf16 v13, v57, v5, v13
    v_add_f32_dpp v8, v8, v8 row_ror:8 row_mask:0xf bank_mask:0xf
    v_add_f32_dpp v9, v9, v9 row_ror:8 row_mask:0xf bank_mask:0xf
    v_add_f32_dpp v10, v10, v10 row_ror:8 row_mask:0xf bank_mask:0xf
    v_add_f32_dpp v11, v11, v11 row_ror:8 row_mask:0xf bank_mask:0xf
    v_add_f32_dpp v12, v12, v12 row_ror:8 row_mask:0xf bank_mask:0xf
    v_add_f32_dpp v13, v13, v13 row_ror:8 row_mask:0xf bank_mask:0xf
    v_add_f32_dpp v8, v8, v8 row_ror:4 row_mask:0xf bank_mask:0xf
    v_add_f32_dpp v9, v9, v9 row_ror:4 row_mask:0xf bank_mask:0xf
    v_add_f32_dpp v10, v10, v10 row_ror:4 row_mask:0xf bank_mask:0xf
    v_add_f32_dpp v11, v11, v11 row_ror:4 row_mask:0xf bank_mask:0xf
    v_add_f32_dpp v12, v12, v12 row_ror:4 row_mask:0xf bank_mask:0xf
    v_add_f32_dpp v13, v13, v13 row_ror:4 row_mask:0xf bank_mask:0xf
    v_add_f32_dpp v8, v8, v8 row_ror:2 row_mask:0xf bank_mask:0xf
    v_add_f32_dpp v9, v9, v9 row_ror:2 row_mask:0xf bank_mask:0xf
    v_add_f32_dpp v10, v10, v10 row_ror:2 row_mask:0xf bank_mask:0xf
    v_add_f32_dpp v11, v11, v11 row_ror:2 row_mask:0xf bank_mask:0xf
    v_add_f32_dpp v12, v12, v12 row_ror:2 row_mask:0xf bank_mask:0xf
    v_add_f32_dpp v13, v13, v13 row_ror:2 row_mask:0xf bank_mask:0xf
    v_add_f32_dpp v8, v8, v8 row_ror:1 row_mask:0xf bank_mask:0xf
    v_add_f32_dpp v9, v9, v9 row_ror:1 row_mask:0xf bank_mask:0xf
    v_add_f32_dpp v10, v10, v10 row_ror:1 row_mask:0xf bank_mask:0xf
    v_add_f32_dpp v11, v11, v11 row_ror:1 row_mask:0xf bank_mask:0xf
    v_add_f32_dpp v12, v12, v12 row_ror:1 row_mask:0xf bank_mask:0xf
    v_add_f32_dpp v13, v13, v13 row_ror:1 row_mask:0xf bank_mask:0xf
    v_dot2_f32_bf16 v14, v58, v2, 0
    v_dot2_f32_bf16 v15, v62, v2, 0
    v_dot2_f32_bf16 v16, v66, v2, 0
    v_dot2_f32_bf16 v17, v70, v2, 0
    v_dot2_f32_bf16 v14, v59, v3, v14
    v_dot2_f32_bf16 v15, v63, v3, v15
    v_dot2_f32_bf16 v16, v67, v3, v16
    v_dot2_f32_bf16 v17, v71, v3, v17
    v_dot2_f32_bf16 v14, v60, v4, v14
    v_dot2_f32_bf16 v15, v64, v4, v15
    v_dot2_f32_bf16 v16, v68, v4, v16
    v_dot2_f32_bf16 v17, v72, v4, v17
    v_dot2_f32_bf16 v14, v61, v5, v14
    v_dot2_f32_bf16 v15, v65, v5, v15
    v_dot2_f32_bf16 v16, v69, v5, v16
    v_dot2_f32_bf16 v17, v73, v5, v17
    v_add_f32_dpp v14, v14, v14 row_ror:8 row_mask:0xf bank_mask:0xf
    v_add_f32_dpp v15, v15, v15 row_ror:8 row_mask:0xf bank_mask:0xf
    v_add_f32_dpp v16, v16, v16 row_ror:8 row_mask:0xf bank_mask:0xf
    v_add_f32_dpp v17, v17, v17 row_ror:8 row_mask:0xf bank_mask:0xf
    v_add_f32_dpp v14, v14, v14 row_ror:4 row_mask:0xf bank_mask:0xf
    v_add_f32_dpp v15, v15, v15 row_ror:4 row_mask:0xf bank_mask:0xf
    v_add_f32_dpp v16, v16, v16 row_ror:4 row_mask:0xf bank_mask:0xf
    v_add_f32_dpp v17, v17, v17 row_ror:4 row_mask:0xf bank_mask:0xf
    v_add_f32_dpp v14, v14, v14 row_ror:2 row_mask:0xf bank_mask:0xf
    v_add_f32_dpp v15, v15, v15 row_ror:2 row_mask:0xf bank_mask:0xf
    v_add_f32_dpp v16, v16, v16 row_ror:2 row_mask:0xf bank_mask:0xf
    v_add_f32_dpp v17, v17, v17 row_ror:2 row_mask:0xf bank_mask:0xf
    v_add_f32_dpp v14, v14, v14 row_ror:1 row_mask:0xf bank_mask:0xf
    v_add_f32_dpp v15, v15, v15 row_ror:1 row_mask:0xf bank_mask:0xf
    v_add_f32_dpp v16, v16, v16 row_ror:1 row_mask:0xf bank_mask:0xf
    v_add_f32_dpp v17, v17, v17 row_ror:1 row_mask:0xf bank_mask:0xf
    s_waitcnt vmcnt(0)
    buffer_load_dwordx4 v[106:109], v6, s[44:47], s60 offen offset:0 nt
    buffer_load_dwordx4 v[110:113], v6, s[44:47], s60 offen offset:1024 nt
    buffer_load_dwordx4 v[114:117], v6, s[44:47], s60 offen offset:2048 nt
    buffer_load_dwordx4 v[118:121], v6, s[44:47], s60 offen offset:3072 nt
    s_add_u32 s60, s60, 45056
    v_dot2_f32_bf16 v18, v74, v2, 0
    v_dot2_f32_bf16 v19, v78, v2, 0
    v_dot2_f32_bf16 v20, v82, v2, 0
    v_dot2_f32_bf16 v21, v86, v2, 0
    v_dot2_f32_bf16 v18, v75, v3, v18
    v_dot2_f32_bf16 v19, v79, v3, v19
    v_dot2_f32_bf16 v20, v83, v3, v20
    v_dot2_f32_bf16 v21, v87, v3, v21
    v_dot2_f32_bf16 v18, v76, v4, v18
    v_dot2_f32_bf16 v19, v80, v4, v19
    v_dot2_f32_bf16 v20, v84, v4, v20
    v_dot2_f32_bf16 v21, v88, v4, v21
    v_dot2_f32_bf16 v18, v77, v5, v18
    v_dot2_f32_bf16 v19, v81, v5, v19
    v_dot2_f32_bf16 v20, v85, v5, v20
    v_dot2_f32_bf16 v21, v89, v5, v21
    v_add_f32_dpp v18, v18, v18 row_ror:8 row_mask:0xf bank_mask:0xf
    v_add_f32_dpp v19, v19, v19 row_ror:8 row_mask:0xf bank_mask:0xf
    v_add_f32_dpp v20, v20, v20 row_ror:8 row_mask:0xf bank_mask:0xf
    v_add_f32_dpp v21, v21, v21 row_ror:8 row_mask:0xf bank_mask:0xf
    v_add_f32_dpp v18, v18, v18 row_ror:4 row_mask:0xf bank_mask:0xf
    v_add_f32_dpp v19, v19, v19 row_ror:4 row_mask:0xf bank_mask:0xf
    v_add_f32_dpp v20, v20, v20 row_ror:4 row_mask:0xf bank_mask:0xf
    v_add_f32_dpp v21, v21, v21 row_ror:4 row_mask:0xf bank_mask:0xf
    v_add_f32_dpp v18, v18, v18 row_ror:2 row_mask:0xf bank_mask:0xf
    v_add_f32_dpp v19, v19, v19 row_ror:2 row_mask:0xf bank_mask:0xf
    v_add_f32_dpp v20, v20, v20 row_ror:2 row_mask:0xf bank_mask:0xf
    v_add_f32_dpp v21, v21, v21 row_ror:2 row_mask:0xf bank_mask:0xf
    v_add_f32_dpp v18, v18, v18 row_ror:1 row_mask:0xf bank_mask:0xf
    v_add_f32_dpp v19, v19, v19 row_ror:1 row_mask:0xf bank_mask:0xf
    v_add_f32_dpp v20, v20, v20 row_ror:1 row_mask:0xf bank_mask:0xf
    v_add_f32_dpp v21, v21, v21 row_ror:1 row_mask:0xf bank_mask:0xf
    v_dot2_f32_bf16 v22, v90, v2, 0
    v_dot2_f32_bf16 v23, v94, v2, 0
    v_dot2_f32_bf16 v24, v98, v2, 0
    v_dot2_f32_bf16 v25, v102, v2, 0
    v_dot2_f32_bf16 v22, v91, v3, v22
    v_dot2_f32_bf16 v23, v95, v3, v23
    v_dot2_f32_bf16 v24, v99, v3, v24
    v_dot2_f32_bf16 v25, v103, v3, v25
    v_dot2_f32_bf16 v22, v92, v4, v22
    v_dot2_f32_bf16 v23, v96, v4, v23
    v_dot2_f32_bf16 v24, v100, v4, v24
    v_dot2_f32_bf16 v25, v104, v4, v25
    v_dot2_f32_bf16 v22, v93, v5, v22
    v_dot2_f32_bf16 v23, v97, v5, v23
    v_dot2_f32_bf16 v24, v101, v5, v24
    v_dot2_f32_bf16 v25, v105, v5, v25
    v_add_f32_dpp v22, v22, v22 row_ror:8 row_mask:0xf bank_mask:0xf
    v_add_f32_dpp v23, v23, v23 row_ror:8 row_mask:0xf bank_mask:0xf
    v_add_f32_dpp v24, v24, v24 row_ror:8 row_mask:0xf bank_mask:0xf
    v_add_f32_dpp v25, v25, v25 row_ror:8 row_mask:0xf bank_mask:0xf
    v_add_f32_dpp v22, v22, v22 row_ror:4 row_mask:0xf bank_mask:0xf
    v_add_f32_dpp v23, v23, v23 row_ror:4 row_mask:0xf bank_mask:0xf
    v_add_f32_dpp v24, v24, v24 row_ror:4 row_mask:0xf bank_mask:0xf
    v_add_f32_dpp v25, v25, v25 row_ror:4 row_mask:0xf bank_mask:0xf
    v_add_f32_dpp v22, v22, v22 row_ror:2 row_mask:0xf bank_mask:0xf
    v_add_f32_dpp v23, v23, v23 row_ror:2 row_mask:0xf bank_mask:0xf
    v_add_f32_dpp v24, v24, v24 row_ror:2 row_mask:0xf bank_mask:0xf
    v_add_f32_dpp v25, v25, v25 row_ror:2 row_mask:0xf bank_mask:0xf
    v_add_f32_dpp v22, v22, v22 row_ror:1 row_mask:0xf bank_mask:0xf
    v_add_f32_dpp v23, v23, v23 row_ror:1 row_mask:0xf bank_mask:0xf
    v_add_f32_dpp v24, v24, v24 row_ror:1 row_mask:0xf bank_mask:0xf
    v_add_f32_dpp v25, v25, v25 row_ror:1 row_mask:0xf bank_mask:0xf
    s_waitcnt vmcnt(0)
    buffer_load_dwordx4 v[122:125], v6, s[44:47], s60 offen offset:0 nt
    buffer_load_dwordx4 v[126:129], v6, s[44:47], s60 offen offset:1024 nt
    buffer_load_dwordx4 v[130:133], v6, s[44:47], s60 offen offset:2048 nt
    buffer_load_dwordx4 v[134:137], v6, s[44:47], s60 offen offset:3072 nt
    s_add_u32 s60, s60, 45056
    v_dot2_f32_bf16 v26, v106, v2, 0
    v_dot2_f32_bf16 v27, v110, v2, 0
    v_dot2_f32_bf16 v28, v114, v2, 0
    v_dot2_f32_bf16 v29, v118, v2, 0
    v_dot2_f32_bf16 v26, v107, v3, v26
    v_dot2_f32_bf16 v27, v111, v3, v27
    v_dot2_f32_bf16 v28, v115, v3, v28
    v_dot2_f32_bf16 v29, v119, v3, v29
    v_dot2_f32_bf16 v26, v108, v4, v26
    v_dot2_f32_bf16 v27, v112, v4, v27
    v_dot2_f32_bf16 v28, v116, v4, v28
    v_dot2_f32_bf16 v29, v120, v4, v29
    v_dot2_f32_bf16 v26, v109, v5, v26
    v_dot2_f32_bf16 v27, v113, v5, v27
    v_dot2_f32_bf16 v28, v117, v5, v28
    v_dot2_f32_bf16 v29, v121, v5, v29
    v_add_f32_dpp v26, v26, v26 row_ror:8 row_mask:0xf bank_mask:0xf
    v_add_f32_dpp v27, v27, v27 row_ror:8 row_mask:0xf bank_mask:0xf
    v_add_f32_dpp v28, v28, v28 row_ror:8 row_mask:0xf bank_mask:0xf
    v_add_f32_dpp v29, v29, v29 row_ror:8 row_mask:0xf bank_mask:0xf
    v_add_f32_dpp v26, v26, v26 row_ror:4 row_mask:0xf bank_mask:0xf
    v_add_f32_dpp v27, v27, v27 row_ror:4 row_mask:0xf bank_mask:0xf
    v_add_f32_dpp v28, v28, v28 row_ror:4 row_mask:0xf bank_mask:0xf
    v_add_f32_dpp v29, v29, v29 row_ror:4 row_mask:0xf bank_mask:0xf
    v_add_f32_dpp v26, v26, v26 row_ror:2 row_mask:0xf bank_mask:0xf
    v_add_f32_dpp v27, v27, v27 row_ror:2 row_mask:0xf bank_mask:0xf
    v_add_f32_dpp v28, v28, v28 row_ror:2 row_mask:0xf bank_mask:0xf
    v_add_f32_dpp v29, v29, v29 row_ror:2 row_mask:0xf bank_mask:0xf
    v_add_f32_dpp v26, v26, v26 row_ror:1 row_mask:0xf bank_mask:0xf
    v_add_f32_dpp v27, v27, v27 row_ror:1 row_mask:0xf bank_mask:0xf
    v_add_f32_dpp v28, v28, v28 row_ror:1 row_mask:0xf bank_mask:0xf
    v_add_f32_dpp v29, v29, v29 row_ror:1 row_mask:0xf bank_mask:0xf
    s_waitcnt vmcnt(0)
    buffer_load_dwordx4 v[34:37], v6, s[48:51], s61 offen offset:0 nt
    buffer_load_dwordx4 v[38:41], v6, s[48:51], s61 offen offset:1024 nt
    buffer_load_dwordx4 v[42:45], v6, s[48:51], s61 offen offset:2048 nt
    buffer_load_dwordx4 v[46:49], v6, s[48:51], s61 offen offset:3072 nt
    s_add_u32 s61, s61, 45056
    v_dot2_f32_bf16 v30, v122, v2, 0
    v_dot2_f32_bf16 v31, v126, v2, 0
    v_dot2_f32_bf16 v32, v130, v2, 0
    v_dot2_f32_bf16 v33, v134, v2, 0
    v_dot2_f32_bf16 v30, v123, v3, v30
    v_dot2_f32_bf16 v31, v127, v3, v31
    v_dot2_f32_bf16 v32, v131, v3, v32
    v_dot2_f32_bf16 v33, v135, v3, v33
    v_dot2_f32_bf16 v30, v124, v4, v30
    v_dot2_f32_bf16 v31, v128, v4, v31
    v_dot2_f32_bf16 v32, v132, v4, v32
    v_dot2_f32_bf16 v33, v136, v4, v33
    v_dot2_f32_bf16 v30, v125, v5, v30
    v_dot2_f32_bf16 v31, v129, v5, v31
    v_dot2_f32_bf16 v32, v133, v5, v32
    v_dot2_f32_bf16 v33, v137, v5, v33
    v_add_f32_dpp v30, v30, v30 row_ror:8 row_mask:0xf bank_mask:0xf
    v_add_f32_dpp v31, v31, v31 row_ror:8 row_mask:0xf bank_mask:0xf
    v_add_f32_dpp v32, v32, v32 row_ror:8 row_mask:0xf bank_mask:0xf
    v_add_f32_dpp v33, v33, v33 row_ror:8 row_mask:0xf bank_mask:0xf
    v_add_f32_dpp v30, v30, v30 row_ror:4 row_mask:0xf bank_mask:0xf
    v_add_f32_dpp v31, v31, v31 row_ror:4 row_mask:0xf bank_mask:0xf
    v_add_f32_dpp v32, v32, v32 row_ror:4 row_mask:0xf bank_mask:0xf
    v_add_f32_dpp v33, v33, v33 row_ror:4 row_mask:0xf bank_mask:0xf
    v_add_f32_dpp v30, v30, v30 row_ror:2 row_mask:0xf bank_mask:0xf
    v_add_f32_dpp v31, v31, v31 row_ror:2 row_mask:0xf bank_mask:0xf
    v_add_f32_dpp v32, v32, v32 row_ror:2 row_mask:0xf bank_mask:0xf
    v_add_f32_dpp v33, v33, v33 row_ror:2 row_mask:0xf bank_mask:0xf
    v_add_f32_dpp v30, v30, v30 row_ror:1 row_mask:0xf bank_mask:0xf
    v_add_f32_dpp v31, v31, v31 row_ror:1 row_mask:0xf bank_mask:0xf
    v_add_f32_dpp v32, v32, v32 row_ror:1 row_mask:0xf bank_mask:0xf
    v_add_f32_dpp v33, v33, v33 row_ror:1 row_mask:0xf bank_mask:0xf
    s_waitcnt vmcnt(0)
    buffer_load_dwordx4 v[50:53], v6, s[48:51], s61 offen offset:0 nt
    buffer_load_dwordx4 v[54:57], v6, s[48:51], s61 offen offset:1024 nt
    buffer_load_dwordx4 v[58:61], v6, s[48:51], s61 offen offset:2048 nt
    buffer_load_dwordx4 v[62:65], v6, s[48:51], s61 offen offset:3072 nt
    s_add_u32 s61, s61, 45056
    v_add_f32 v8, s62, v8
    v_add_f32 v9, s62, v9
    v_add_f32 v10, s62, v10
    v_add_f32 v11, s62, v11
    v_add_f32 v12, s62, v12
    v_add_f32 v13, s62, v13
    v_max3_f32 v160, v8, v9, v10
    v_max3_f32 v160, v160, v11, v12
    v_max3_f32 v160, v160, v13, v14
    v_max3_f32 v160, v160, v15, v16
    v_max3_f32 v160, v160, v17, v18
    v_max3_f32 v160, v160, v19, v20
    v_max3_f32 v160, v160, v21, v22
    v_max3_f32 v160, v160, v23, v24
    v_max3_f32 v160, v160, v25, v26
    v_max3_f32 v160, v160, v27, v28
    v_max3_f32 v160, v160, v29, v30
    v_max3_f32 v160, v160, v31, v32
    v_max_f32 v160, v160, v33
    v_mov_b32 v161, v160
    s_nop 1
    v_permlane32_swap_b32 v160, v161
    v_max_f32 v160, v160, v161
    v_mov_b32 v161, v160
    s_nop 1
    v_permlane16_swap_b32 v160, v161
    v_max_f32 v160, v160, v161
    v_mul_f32 v160, s64, v160
    v_fma_f32 v8, v8, s64, -v160
    v_fma_f32 v9, v9, s64, -v160
    v_fma_f32 v10, v10, s64, -v160
    v_fma_f32 v11, v11, s64, -v160
    v_fma_f32 v12, v12, s64, -v160
    v_fma_f32 v13, v13, s64, -v160
    v_fma_f32 v14, v14, s64, -v160
    v_fma_f32 v15, v15, s64, -v160
    v_fma_f32 v16, v16, s64, -v160
    v_fma_f32 v17, v17, s64, -v160
    v_fma_f32 v18, v18, s64, -v160
    v_fma_f32 v19, v19, s64, -v160
    v_fma_f32 v20, v20, s64, -v160
    v_fma_f32 v21, v21, s64, -v160
    v_fma_f32 v22, v22, s64, -v160
    v_fma_f32 v23, v23, s64, -v160
    v_fma_f32 v24, v24, s64, -v160
    v_fma_f32 v25, v25, s64, -v160
    v_fma_f32 v26, v26, s64, -v160
    v_fma_f32 v27, v27, s64, -v160
    v_fma_f32 v28, v28, s64, -v160
    v_fma_f32 v29, v29, s64, -v160
    v_fma_f32 v30, v30, s64, -v160
    v_fma_f32 v31, v31, s64, -v160
    v_fma_f32 v32, v32, s64, -v160
    v_fma_f32 v33, v33, s64, -v160
    v_exp_f32 v8, v8
    v_exp_f32 v9, v9
    v_exp_f32 v10, v10
    v_exp_f32 v11, v11
    v_exp_f32 v12, v12
    v_exp_f32 v13, v13
    v_exp_f32 v14, v14
    v_exp_f32 v15, v15
    v_exp_f32 v16, v16
    v_exp_f32 v17, v17
    v_exp_f32 v18, v18
    v_exp_f32 v19, v19
    v_exp_f32 v20, v20
    v_exp_f32 v21, v21
    v_exp_f32 v22, v22
    v_exp_f32 v23, v23
    v_exp_f32 v24, v24
    v_exp_f32 v25, v25
    v_exp_f32 v26, v26
    v_exp_f32 v27, v27
    v_exp_f32 v28, v28
    v_exp_f32 v29, v29
    v_exp_f32 v30, v30
    v_exp_f32 v31, v31
    v_exp_f32 v32, v32
    v_exp_f32 v33, v33
    v_add_f32 v162, v8, v9
    v_add_f32 v163, v10, v11
    v_add_f32 v162, v162, v12
    v_add_f32 v163, v163, v13
    v_add_f32 v162, v162, v14
    v_add_f32 v163, v163, v15
    v_add_f32 v162, v162, v16
    v_add_f32 v163, v163, v17
    v_add_f32 v162, v162, v18
    v_add_f32 v163, v163, v19
    v_add_f32 v162, v162, v20
    v_add_f32 v163, v163, v21
    v_add_f32 v162, v162, v22
    v_add_f32 v163, v163, v23
    v_add_f32 v162, v162, v24
    v_add_f32 v163, v163, v25
    v_add_f32 v162, v162, v26
    v_add_f32 v163, v163, v27
    v_add_f32 v162, v162, v28
    v_add_f32 v163, v163, v29
    v_add_f32 v162, v162, v30
    v_add_f32 v163, v163, v31
    v_add_f32 v162, v162, v32
    v_add_f32 v163, v163, v33
    v_add_f32 v162, v162, v163
    v_mov_b32 v163, v162
    s_nop 1
    v_permlane32_swap_b32 v162, v163
    v_add_f32 v162, v162, v163
    v_mov_b32 v163, v162
    s_nop 1
    v_permlane16_swap_b32 v162, v163
    v_add_f32 v161, v162, v163
    s_lshl_b32 s7, s3, 3
    s_add_u32 s7, s7, 0x24200
    v_mov_b32 v164, s7
    ds_write_b64 v164, v[160:161]
    v_mov_b32 v164, 0x24008
    v_mov_b32 v165, 1
    s_waitcnt lgkmcnt(0)
    s_mov_b64 exec, 1
    ds_add_u32 v164, v165
    s_mov_b64 exec, -1
    v_and_b32 v2, 15, v1
    v_lshlrev_b32 v2, 5, v2
    v_bfe_u32 v3, v1, 5, 1
    v_lshl_add_u32 v2, v3, 4, v2
    v_bfe_u32 v3, v1, 4, 1
    v_lshl_add_u32 v2, v3, 3, v2
    s_lshl_b32 s7, s3, 9
    s_add_u32 s7, s7, 0x25000
    v_add_u32 v2, s7, v2
    s_waitcnt vmcnt(0)
    buffer_load_dwordx4 v[66:69], v6, s[48:51], s61 offen offset:0 nt
    buffer_load_dwordx4 v[70:73], v6, s[48:51], s61 offen offset:1024 nt
    buffer_load_dwordx4 v[74:77], v6, s[48:51], s61 offen offset:2048 nt
    buffer_load_dwordx4 v[78:81], v6, s[48:51], s61 offen offset:3072 nt
    s_add_u32 s61, s61, 45056
    v_lshlrev_b32 v160, 16, v34
    v_and_b32 v161, 0xffff0000, v34
    v_lshlrev_b32 v162, 16, v35
    v_and_b32 v163, 0xffff0000, v35
    v_lshlrev_b32 v164, 16, v36
    v_and_b32 v165, 0xffff0000, v36
    v_lshlrev_b32 v166, 16, v37
    v_and_b32 v167, 0xffff0000, v37
    v_pk_mul_f32 v[152:153], v[160:161], v[14:15] op_sel_hi:[1,0]
    v_pk_mul_f32 v[154:155], v[162:163], v[14:15] op_sel_hi:[1,0]
    v_pk_mul_f32 v[156:157], v[164:165], v[14:15] op_sel_hi:[1,0]
    v_pk_mul_f32 v[158:159], v[166:167], v[14:15] op_sel_hi:[1,0]
    v_lshlrev_b32 v160, 16, v38
    v_and_b32 v161, 0xffff0000, v38
    v_lshlrev_b32 v162, 16, v39
    v_and_b32 v163, 0xffff0000, v39
    v_lshlrev_b32 v164, 16, v40
    v_and_b32 v165, 0xffff0000, v40
    v_lshlrev_b32 v166, 16, v41
    v_and_b32 v167, 0xffff0000, v41
    v_pk_fma_f32 v[152:153], v[160:161], v[14:15], v[152:153] op_sel:[0,1,0] op_sel_hi:[1,1,1]
    v_pk_fma_f32 v[154:155], v[162:163], v[14:15], v[154:155] op_sel:[0,1,0] op_sel_hi:[1,1,1]
    v_pk_fma_f32 v[156:157], v[164:165], v[14:15], v[156:157] op_sel:[0,1,0] op_sel_hi:[1,1,1]
    v_pk_fma_f32 v[158:159], v[166:167], v[14:15], v[158:159] op_sel:[0,1,0] op_sel_hi:[1,1,1]
    v_lshlrev_b32 v160, 16, v42
    v_and_b32 v161, 0xffff0000, v42
    v_lshlrev_b32 v162, 16, v43
    v_and_b32 v163, 0xffff0000, v43
    v_lshlrev_b32 v164, 16, v44
    v_and_b32 v165, 0xffff0000, v44
    v_lshlrev_b32 v166, 16, v45
    v_and_b32 v167, 0xffff0000, v45
    v_pk_fma_f32 v[152:153], v[160:161], v[16:17], v[152:153] op_sel_hi:[1,0,1]
    v_pk_fma_f32 v[154:155], v[162:163], v[16:17], v[154:155] op_sel_hi:[1,0,1]
    v_pk_fma_f32 v[156:157], v[164:165], v[16:17], v[156:157] op_sel_hi:[1,0,1]
    v_pk_fma_f32 v[158:159], v[166:167], v[16:17], v[158:159] op_sel_hi:[1,0,1]
    v_lshlrev_b32 v160, 16, v46
    v_and_b32 v161, 0xffff0000, v46
    v_lshlrev_b32 v162, 16, v47
    v_and_b32 v163, 0xffff0000, v47
    v_lshlrev_b32 v164, 16, v48
    v_and_b32 v165, 0xffff0000, v48
    v_lshlrev_b32 v166, 16, v49
    v_and_b32 v167, 0xffff0000, v49
    v_pk_fma_f32 v[152:153], v[160:161], v[16:17], v[152:153] op_sel:[0,1,0] op_sel_hi:[1,1,1]
    v_pk_fma_f32 v[154:155], v[162:163], v[16:17], v[154:155] op_sel:[0,1,0] op_sel_hi:[1,1,1]
    v_pk_fma_f32 v[156:157], v[164:165], v[16:17], v[156:157] op_sel:[0,1,0] op_sel_hi:[1,1,1]
    v_pk_fma_f32 v[158:159], v[166:167], v[16:17], v[158:159] op_sel:[0,1,0] op_sel_hi:[1,1,1]
    v_lshlrev_b32 v160, 16, v50
    v_and_b32 v161, 0xffff0000, v50
    v_lshlrev_b32 v162, 16, v51
    v_and_b32 v163, 0xffff0000, v51
    v_lshlrev_b32 v164, 16, v52
    v_and_b32 v165, 0xffff0000, v52
    v_lshlrev_b32 v166, 16, v53
    v_and_b32 v167, 0xffff0000, v53
    v_pk_fma_f32 v[152:153], v[160:161], v[18:19], v[152:153] op_sel_hi:[1,0,1]
    v_pk_fma_f32 v[154:155], v[162:163], v[18:19], v[154:155] op_sel_hi:[1,0,1]
    v_pk_fma_f32 v[156:157], v[164:165], v[18:19], v[156:157] op_sel_hi:[1,0,1]
    v_pk_fma_f32 v[158:159], v[166:167], v[18:19], v[158:159] op_sel_hi:[1,0,1]
    v_lshlrev_b32 v160, 16, v54
    v_and_b32 v161, 0xffff0000, v54
    v_lshlrev_b32 v162, 16, v55
    v_and_b32 v163, 0xffff0000, v55
    v_lshlrev_b32 v164, 16, v56
    v_and_b32 v165, 0xffff0000, v56
    v_lshlrev_b32 v166, 16, v57
    v_and_b32 v167, 0xffff0000, v57
    v_pk_fma_f32 v[152:153], v[160:161], v[18:19], v[152:153] op_sel:[0,1,0] op_sel_hi:[1,1,1]
    v_pk_fma_f32 v[154:155], v[162:163], v[18:19], v[154:155] op_sel:[0,1,0] op_sel_hi:[1,1,1]
    v_pk_fma_f32 v[156:157], v[164:165], v[18:19], v[156:157] op_sel:[0,1,0] op_sel_hi:[1,1,1]
    v_pk_fma_f32 v[158:159], v[166:167], v[18:19], v[158:159] op_sel:[0,1,0] op_sel_hi:[1,1,1]
    v_lshlrev_b32 v160, 16, v58
    v_and_b32 v161, 0xffff0000, v58
    v_lshlrev_b32 v162, 16, v59
    v_and_b32 v163, 0xffff0000, v59
    v_lshlrev_b32 v164, 16, v60
    v_and_b32 v165, 0xffff0000, v60
    v_lshlrev_b32 v166, 16, v61
    v_and_b32 v167, 0xffff0000, v61
    v_pk_fma_f32 v[152:153], v[160:161], v[20:21], v[152:153] op_sel_hi:[1,0,1]
    v_pk_fma_f32 v[154:155], v[162:163], v[20:21], v[154:155] op_sel_hi:[1,0,1]
    v_pk_fma_f32 v[156:157], v[164:165], v[20:21], v[156:157] op_sel_hi:[1,0,1]
    v_pk_fma_f32 v[158:159], v[166:167], v[20:21], v[158:159] op_sel_hi:[1,0,1]
    v_lshlrev_b32 v160, 16, v62
    v_and_b32 v161, 0xffff0000, v62
    v_lshlrev_b32 v162, 16, v63
    v_and_b32 v163, 0xffff0000, v63
    v_lshlrev_b32 v164, 16, v64
    v_and_b32 v165, 0xffff0000, v64
    v_lshlrev_b32 v166, 16, v65
    v_and_b32 v167, 0xffff0000, v65
    v_pk_fma_f32 v[152:153], v[160:161], v[20:21], v[152:153] op_sel:[0,1,0] op_sel_hi:[1,1,1]
    v_pk_fma_f32 v[154:155], v[162:163], v[20:21], v[154:155] op_sel:[0,1,0] op_sel_hi:[1,1,1]
    v_pk_fma_f32 v[156:157], v[164:165], v[20:21], v[156:157] op_sel:[0,1,0] op_sel_hi:[1,1,1]
    v_pk_fma_f32 v[158:159], v[166:167], v[20:21], v[158:159] op_sel:[0,1,0] op_sel_hi:[1,1,1]
    s_waitcnt vmcnt(0)
    buffer_load_dwordx4 v[82:85], v6, s[48:51], s61 offen offset:0 nt
    buffer_load_dwordx4 v[86:89], v6, s[48:51], s61 offen offset:1024 nt
    buffer_load_dwordx4 v[90:93], v6, s[48:51], s61 offen offset:2048 nt
    buffer_load_dwordx4 v[94:97], v6, s[48:51], s61 offen offset:3072 nt
    s_add_u32 s61, s61, 45056
    v_lshlrev_b32 v160, 16, v66
    v_and_b32 v161, 0xffff0000, v66
    v_lshlrev_b32 v162, 16, v67
    v_and_b32 v163, 0xffff0000, v67
    v_lshlrev_b32 v164, 16, v68
    v_and_b32 v165, 0xffff0000, v68
    v_lshlrev_b32 v166, 16, v69
    v_and_b32 v167, 0xffff0000, v69
    v_pk_fma_f32 v[152:153], v[160:161], v[22:23], v[152:153] op_sel_hi:[1,0,1]
    v_pk_fma_f32 v[154:155], v[162:163], v[22:23], v[154:155] op_sel_hi:[1,0,1]
    v_pk_fma_f32 v[156:157], v[164:165], v[22:23], v[156:157] op_sel_hi:[1,0,1]
    v_pk_fma_f32 v[158:159], v[166:167], v[22:23], v[158:159] op_sel_hi:[1,0,1]
    v_lshlrev_b32 v160, 16, v70
    v_and_b32 v161, 0xffff0000, v70
    v_lshlrev_b32 v162, 16, v71
    v_and_b32 v163, 0xffff0000, v71
    v_lshlrev_b32 v164, 16, v72
    v_and_b32 v165, 0xffff0000, v72
    v_lshlrev_b32 v166, 16, v73
    v_and_b32 v167, 0xffff0000, v73
    v_pk_fma_f32 v[152:153], v[160:161], v[22:23], v[152:153] op_sel:[0,1,0] op_sel_hi:[1,1,1]
    v_pk_fma_f32 v[154:155], v[162:163], v[22:23], v[154:155] op_sel:[0,1,0] op_sel_hi:[1,1,1]
    v_pk_fma_f32 v[156:157], v[164:165], v[22:23], v[156:157] op_sel:[0,1,0] op_sel_hi:[1,1,1]
    v_pk_fma_f32 v[158:159], v[166:167], v[22:23], v[158:159] op_sel:[0,1,0] op_sel_hi:[1,1,1]
    v_lshlrev_b32 v160, 16, v74
    v_and_b32 v161, 0xffff0000, v74
    v_lshlrev_b32 v162, 16, v75
    v_and_b32 v163, 0xffff0000, v75
    v_lshlrev_b32 v164, 16, v76
    v_and_b32 v165, 0xffff0000, v76
    v_lshlrev_b32 v166, 16, v77
    v_and_b32 v167, 0xffff0000, v77
    v_pk_fma_f32 v[152:153], v[160:161], v[24:25], v[152:153] op_sel_hi:[1,0,1]
    v_pk_fma_f32 v[154:155], v[162:163], v[24:25], v[154:155] op_sel_hi:[1,0,1]
    v_pk_fma_f32 v[156:157], v[164:165], v[24:25], v[156:157] op_sel_hi:[1,0,1]
    v_pk_fma_f32 v[158:159], v[166:167], v[24:25], v[158:159] op_sel_hi:[1,0,1]
    v_lshlrev_b32 v160, 16, v78
    v_and_b32 v161, 0xffff0000, v78
    v_lshlrev_b32 v162, 16, v79
    v_and_b32 v163, 0xffff0000, v79
    v_lshlrev_b32 v164, 16, v80
    v_and_b32 v165, 0xffff0000, v80
    v_lshlrev_b32 v166, 16, v81
    v_and_b32 v167, 0xffff0000, v81
    v_pk_fma_f32 v[152:153], v[160:161], v[24:25], v[152:153] op_sel:[0,1,0] op_sel_hi:[1,1,1]
    v_pk_fma_f32 v[154:155], v[162:163], v[24:25], v[154:155] op_sel:[0,1,0] op_sel_hi:[1,1,1]
    v_pk_fma_f32 v[156:157], v[164:165], v[24:25], v[156:157] op_sel:[0,1,0] op_sel_hi:[1,1,1]
    v_pk_fma_f32 v[158:159], v[166:167], v[24:25], v[158:159] op_sel:[0,1,0] op_sel_hi:[1,1,1]
    s_waitcnt vmcnt(0)
    buffer_load_dwordx4 v[98:101], v6, s[48:51], s61 offen offset:0 nt
    buffer_load_dwordx4 v[102:105], v6, s[48:51], s61 offen offset:1024 nt
    buffer_load_dwordx4 v[106:109], v6, s[48:51], s61 offen offset:2048 nt
    buffer_load_dwordx4 v[110:113], v6, s[48:51], s61 offen offset:3072 nt
    s_add_u32 s61, s61, 45056
    v_lshlrev_b32 v160, 16, v82
    v_and_b32 v161, 0xffff0000, v82
    v_lshlrev_b32 v162, 16, v83
    v_and_b32 v163, 0xffff0000, v83
    v_lshlrev_b32 v164, 16, v84
    v_and_b32 v165, 0xffff0000, v84
    v_lshlrev_b32 v166, 16, v85
    v_and_b32 v167, 0xffff0000, v85
    v_pk_fma_f32 v[152:153], v[160:161], v[26:27], v[152:153] op_sel_hi:[1,0,1]
    v_pk_fma_f32 v[154:155], v[162:163], v[26:27], v[154:155] op_sel_hi:[1,0,1]
    v_pk_fma_f32 v[156:157], v[164:165], v[26:27], v[156:157] op_sel_hi:[1,0,1]
    s_branch LC_AR
.p2align 12
LT_AR2:
    s_branch LR_AR2
LC_AR:
    v_pk_fma_f32 v[158:159], v[166:167], v[26:27], v[158:159] op_sel_hi:[1,0,1]
    v_lshlrev_b32 v160, 16, v86
    v_and_b32 v161, 0xffff0000, v86
    v_lshlrev_b32 v162, 16, v87
    v_and_b32 v163, 0xffff0000, v87
    v_lshlrev_b32 v164, 16, v88
    v_and_b32 v165, 0xffff0000, v88
    v_lshlrev_b32 v166, 16, v89
    v_and_b32 v167, 0xffff0000, v89
    v_pk_fma_f32 v[152:153], v[160:161], v[26:27], v[152:153] op_sel:[0,1,0] op_sel_hi:[1,1,1]
    v_pk_fma_f32 v[154:155], v[162:163], v[26:27], v[154:155] op_sel:[0,1,0] op_sel_hi:[1,1,1]
    v_pk_fma_f32 v[156:157], v[164:165], v[26:27], v[156:157] op_sel:[0,1,0] op_sel_hi:[1,1,1]
    v_pk_fma_f32 v[158:159], v[166:167], v[26:27], v[158:159] op_sel:[0,1,0] op_sel_hi:[1,1,1]
    v_lshlrev_b32 v160, 16, v90
    v_and_b32 v161, 0xffff0000, v90
    v_lshlrev_b32 v162, 16, v91
    v_and_b32 v163, 0xffff0000, v91
    v_lshlrev_b32 v164, 16, v92
    v_and_b32 v165, 0xffff0000, v92
    v_lshlrev_b32 v166, 16, v93
    v_and_b32 v167, 0xffff0000, v93
    v_pk_fma_f32 v[152:153], v[160:161], v[28:29], v[152:153] op_sel_hi:[1,0,1]
    v_pk_fma_f32 v[154:155], v[162:163], v[28:29], v[154:155] op_sel_hi:[1,0,1]
    v_pk_fma_f32 v[156:157], v[164:165], v[28:29], v[156:157] op_sel_hi:[1,0,1]
    v_pk_fma_f32 v[158:159], v[166:167], v[28:29], v[158:159] op_sel_hi:[1,0,1]
    v_lshlrev_b32 v160, 16, v94
    v_and_b32 v161, 0xffff0000, v94
    v_lshlrev_b32 v162, 16, v95
    v_and_b32 v163, 0xffff0000, v95
    v_lshlrev_b32 v164, 16, v96
    v_and_b32 v165, 0xffff0000, v96
    v_lshlrev_b32 v166, 16, v97
    v_and_b32 v167, 0xffff0000, v97
    v_pk_fma_f32 v[152:153], v[160:161], v[28:29], v[152:153] op_sel:[0,1,0] op_sel_hi:[1,1,1]
    v_pk_fma_f32 v[154:155], v[162:163], v[28:29], v[154:155] op_sel:[0,1,0] op_sel_hi:[1,1,1]
    v_pk_fma_f32 v[156:157], v[164:165], v[28:29], v[156:157] op_sel:[0,1,0] op_sel_hi:[1,1,1]
    v_pk_fma_f32 v[158:159], v[166:167], v[28:29], v[158:159] op_sel:[0,1,0] op_sel_hi:[1,1,1]
    s_cmp_eq_u32 s62, 0
    s_cbranch_scc1 AL_9
    s_waitcnt vmcnt(3)
    v_lshlrev_b32 v160, 16, v98
    v_and_b32 v161, 0xffff0000, v98
    v_lshlrev_b32 v162, 16, v99
    v_and_b32 v163, 0xffff0000, v99
    v_lshlrev_b32 v164, 16, v100
    v_and_b32 v165, 0xffff0000, v100
    v_lshlrev_b32 v166, 16, v101
    v_and_b32 v167, 0xffff0000, v101
    v_pk_fma_f32 v[152:153], v[160:161], v[30:31], v[152:153] op_sel_hi:[1,0,1]
    v_pk_fma_f32 v[154:155], v[162:163], v[30:31], v[154:155] op_sel_hi:[1,0,1]
    v_pk_fma_f32 v[156:157], v[164:165], v[30:31], v[156:157] op_sel_hi:[1,0,1]
    v_pk_fma_f32 v[158:159], v[166:167], v[30:31], v[158:159] op_sel_hi:[1,0,1]
    s_waitcnt vmcnt(2)
    v_lshlrev_b32 v160, 16, v102
    v_and_b32 v161, 0xffff0000, v102
    v_lshlrev_b32 v162, 16, v103
    v_and_b32 v163, 0xffff0000, v103
    v_lshlrev_b32 v164, 16, v104
    v_and_b32 v165, 0xffff0000, v104
    v_lshlrev_b32 v166, 16, v105
    v_and_b32 v167, 0xffff0000, v105
    v_pk_fma_f32 v[152:153], v[160:161], v[30:31], v[152:153] op_sel:[0,1,0] op_sel_hi:[1,1,1]
    v_pk_fma_f32 v[154:155], v[162:163], v[30:31], v[154:155] op_sel:[0,1,0] op_sel_hi:[1,1,1]
    v_pk_fma_f32 v[156:157], v[164:165], v[30:31], v[156:157] op_sel:[0,1,0] op_sel_hi:[1,1,1]
    v_pk_fma_f32 v[158:159], v[166:167], v[30:31], v[158:159] op_sel:[0,1,0] op_sel_hi:[1,1,1]
    s_waitcnt vmcnt(1)
    v_lshlrev_b32 v160, 16, v106
    v_and_b32 v161, 0xffff0000, v106
    v_lshlrev_b32 v162, 16, v107
    v_and_b32 v163, 0xffff0000, v107
    v_lshlrev_b32 v164, 16, v108
    v_and_b32 v165, 0xffff0000, v108
    v_lshlrev_b32 v166, 16, v109
    v_and_b32 v167, 0xffff0000, v109
    v_pk_fma_f32 v[152:153], v[160:161], v[32:33], v[152:153] op_sel_hi:[1,0,1]
    v_pk_fma_f32 v[154:155], v[162:163], v[32:33], v[154:155] op_sel_hi:[1,0,1]
    v_pk_fma_f32 v[156:157], v[164:165], v[32:33], v[156:157] op_sel_hi:[1,0,1]
    v_pk_fma_f32 v[158:159], v[166:167], v[32:33], v[158:159] op_sel_hi:[1,0,1]
    s_waitcnt vmcnt(0)
    v_lshlrev_b32 v160, 16, v110
    v_and_b32 v161, 0xffff0000, v110
    v_lshlrev_b32 v162, 16, v111
    v_and_b32 v163, 0xffff0000, v111
    v_lshlrev_b32 v164, 16, v112
    v_and_b32 v165, 0xffff0000, v112
    v_lshlrev_b32 v166, 16, v113
    v_and_b32 v167, 0xffff0000, v113
    v_pk_fma_f32 v[152:153], v[160:161], v[32:33], v[152:153] op_sel:[0,1,0] op_sel_hi:[1,1,1]
    v_pk_fma_f32 v[154:155], v[162:163], v[32:33], v[154:155] op_sel:[0,1,0] op_sel_hi:[1,1,1]
    v_pk_fma_f32 v[156:157], v[164:165], v[32:33], v[156:157] op_sel:[0,1,0] op_sel_hi:[1,1,1]
    v_pk_fma_f32 v[158:159], v[166:167], v[32:33], v[158:159] op_sel:[0,1,0] op_sel_hi:[1,1,1]
    s_branch L_AFIN
AL_9:
    s_waitcnt vmcnt(0)
    buffer_load_dwordx4 v[114:117], v6, s[48:51], s63 offen offset:0 nt
    buffer_load_dwordx4 v[118:121], v6, s[48:51], s63 offen offset:1024 nt
    buffer_load_dwordx4 v[122:125], v6, s[48:51], s63 offen offset:2048 nt
    buffer_load_dwordx4 v[126:129], v6, s[48:51], s63 offen offset:3072 nt
    buffer_load_dwordx4 v[130:133], v6, s[48:51], s65 offen offset:0 nt
    buffer_load_dwordx4 v[134:137], v6, s[48:51], s65 offen offset:1024 nt
    v_lshlrev_b32 v160, 16, v98
    v_and_b32 v161, 0xffff0000, v98
    v_lshlrev_b32 v162, 16, v99
    v_and_b32 v163, 0xffff0000, v99
    v_lshlrev_b32 v164, 16, v100
    v_and_b32 v165, 0xffff0000, v100
    v_lshlrev_b32 v166, 16, v101
    v_and_b32 v167, 0xffff0000, v101
    v_pk_fma_f32 v[152:153], v[160:161], v[30:31], v[152:153] op_sel_hi:[1,0,1]
    v_pk_fma_f32 v[154:155], v[162:163], v[30:31], v[154:155] op_sel_hi:[1,0,1]
    v_pk_fma_f32 v[156:157], v[164:165], v[30:31], v[156:157] op_sel_hi:[1,0,1]
    v_pk_fma_f32 v[158:159], v[166:167], v[30:31], v[158:159] op_sel_hi:[1,0,1]
    v_lshlrev_b32 v160, 16, v102
    v_and_b32 v161, 0xffff0000, v102
    v_lshlrev_b32 v162, 16, v103
    v_and_b32 v163, 0xffff0000, v103
    v_lshlrev_b32 v164, 16, v104
    v_and_b32 v165, 0xffff0000, v104
    v_lshlrev_b32 v166, 16, v105
    v_and_b32 v167, 0xffff0000, v105
    v_pk_fma_f32 v[152:153], v[160:161], v[30:31], v[152:153] op_sel:[0,1,0] op_sel_hi:[1,1,1]
    v_pk_fma_f32 v[154:155], v[162:163], v[30:31], v[154:155] op_sel:[0,1,0] op_sel_hi:[1,1,1]
    v_pk_fma_f32 v[156:157], v[164:165], v[30:31], v[156:157] op_sel:[0,1,0] op_sel_hi:[1,1,1]
    v_pk_fma_f32 v[158:159], v[166:167], v[30:31], v[158:159] op_sel:[0,1,0] op_sel_hi:[1,1,1]
    v_lshlrev_b32 v160, 16, v106
    v_and_b32 v161, 0xffff0000, v106
    v_lshlrev_b32 v162, 16, v107
    v_and_b32 v163, 0xffff0000, v107
    v_lshlrev_b32 v164, 16, v108
    v_and_b32 v165, 0xffff0000, v108
    v_lshlrev_b32 v166, 16, v109
    v_and_b32 v167, 0xffff0000, v109
    v_pk_fma_f32 v[152:153], v[160:161], v[32:33], v[152:153] op_sel_hi:[1,0,1]
    v_pk_fma_f32 v[154:155], v[162:163], v[32:33], v[154:155] op_sel_hi:[1,0,1]
    v_pk_fma_f32 v[156:157], v[164:165], v[32:33], v[156:157] op_sel_hi:[1,0,1]
    v_pk_fma_f32 v[158:159], v[166:167], v[32:33], v[158:159] op_sel_hi:[1,0,1]
    v_lshlrev_b32 v160, 16, v110
    v_and_b32 v161, 0xffff0000, v110
    v_lshlrev_b32 v162, 16, v111
    v_and_b32 v163, 0xffff0000, v111
    v_lshlrev_b32 v164, 16, v112
    v_and_b32 v165, 0xffff0000, v112
    v_lshlrev_b32 v166, 16, v113
    v_and_b32 v167, 0xffff0000, v113
    v_pk_fma_f32 v[152:153], v[160:161], v[32:33], v[152:153] op_sel:[0,1,0] op_sel_hi:[1,1,1]
    v_pk_fma_f32 v[154:155], v[162:163], v[32:33], v[154:155] op_sel:[0,1,0] op_sel_hi:[1,1,1]
    v_pk_fma_f32 v[156:157], v[164:165], v[32:33], v[156:157] op_sel:[0,1,0] op_sel_hi:[1,1,1]
    v_pk_fma_f32 v[158:159], v[166:167], v[32:33], v[158:159] op_sel:[0,1,0] op_sel_hi:[1,1,1]
    s_waitcnt vmcnt(5)
    v_lshlrev_b32 v160, 16, v114
    v_and_b32 v161, 0xffff0000, v114
    v_lshlrev_b32 v162, 16, v115
    v_and_b32 v163, 0xffff0000, v115
    v_lshlrev_b32 v164, 16, v116
    v_and_b32 v165, 0xffff0000, v116
    v_lshlrev_b32 v166, 16, v117
    v_and_b32 v167, 0xffff0000, v117
    v_pk_fma_f32 v[152:153], v[160:161], v[8:9], v[152:153] op_sel_hi:[1,0,1]
    v_pk_fma_f32 v[154:155], v[162:163], v[8:9], v[154:155] op_sel_hi:[1,0,1]
    v_pk_fma_f32 v[156:157], v[164:165], v[8:9], v[156:157] op_sel_hi:[1,0,1]
    v_pk_fma_f32 v[158:159], v[166:167], v[8:9], v[158:159] op_sel_hi:[1,0,1]
    s_waitcnt vmcnt(4)
    v_lshlrev_b32 v160, 16, v118
    v_and_b32 v161, 0xffff0000, v118
    v_lshlrev_b32 v162, 16, v119
    v_and_b32 v163, 0xffff0000, v119
    v_lshlrev_b32 v164, 16, v120
    v_and_b32 v165, 0xffff0000, v120
    v_lshlrev_b32 v166, 16, v121
    v_and_b32 v167, 0xffff0000, v121
    v_pk_fma_f32 v[152:153], v[160:161], v[8:9], v[152:153] op_sel:[0,1,0] op_sel_hi:[1,1,1]
    v_pk_fma_f32 v[154:155], v[162:163], v[8:9], v[154:155] op_sel:[0,1,0] op_sel_hi:[1,1,1]
    v_pk_fma_f32 v[156:157], v[164:165], v[8:9], v[156:157] op_sel:[0,1,0] op_sel_hi:[1,1,1]
    v_pk_fma_f32 v[158:159], v[166:167], v[8:9], v[158:159] op_sel:[0,1,0] op_sel_hi:[1,1,1]
    s_waitcnt vmcnt(3)
    v_lshlrev_b32 v160, 16, v122
    v_and_b32 v161, 0xffff0000, v122
    v_lshlrev_b32 v162, 16, v123
    v_and_b32 v163, 0xffff0000, v123
    v_lshlrev_b32 v164, 16, v124
    v_and_b32 v165, 0xffff0000, v124
    v_lshlrev_b32 v166, 16, v125
    v_and_b32 v167, 0xffff0000, v125
    v_pk_fma_f32 v[152:153], v[160:161], v[10:11], v[152:153] op_sel_hi:[1,0,1]
    v_pk_fma_f32 v[154:155], v[162:163], v[10:11], v[154:155] op_sel_hi:[1,0,1]
    v_pk_fma_f32 v[156:157], v[164:165], v[10:11], v[156:157] op_sel_hi:[1,0,1]
    v_pk_fma_f32 v[158:159], v[166:167], v[10:11], v[158:159] op_sel_hi:[1,0,1]
    s_waitcnt vmcnt(2)
    v_lshlrev_b32 v160, 16, v126
    v_and_b32 v161, 0xffff0000, v126
    v_lshlrev_b32 v162, 16, v127
    v_and_b32 v163, 0xffff0000, v127
    v_lshlrev_b32 v164, 16, v128
    v_and_b32 v165, 0xffff0000, v128
    v_lshlrev_b32 v166, 16, v129
    v_and_b32 v167, 0xffff0000, v129
    v_pk_fma_f32 v[152:153], v[160:161], v[10:11], v[152:153] op_sel:[0,1,0] op_sel_hi:[1,1,1]
    v_pk_fma_f32 v[154:155], v[162:163], v[10:11], v[154:155] op_sel:[0,1,0] op_sel_hi:[1,1,1]
    v_pk_fma_f32 v[156:157], v[164:165], v[10:11], v[156:157] op_sel:[0,1,0] op_sel_hi:[1,1,1]
    v_pk_fma_f32 v[158:159], v[166:167], v[10:11], v[158:159] op_sel:[0,1,0] op_sel_hi:[1,1,1]
    s_waitcnt vmcnt(1)
    v_lshlrev_b32 v160, 16, v130
    v_and_b32 v161, 0xffff0000, v130
    v_lshlrev_b32 v162, 16, v131
    v_and_b32 v163, 0xffff0000, v131
    v_lshlrev_b32 v164, 16, v132
    v_and_b32 v165, 0xffff0000, v132
    v_lshlrev_b32 v166, 16, v133
    v_and_b32 v167, 0xffff0000, v133
    v_pk_fma_f32 v[152:153], v[160:161], v[12:13], v[152:153] op_sel_hi:[1,0,1]
    v_pk_fma_f32 v[154:155], v[162:163], v[12:13], v[154:155] op_sel_hi:[1,0,1]
    v_pk_fma_f32 v[156:157], v[164:165], v[12:13], v[156:157] op_sel_hi:[1,0,1]
    v_pk_fma_f32 v[158:159], v[166:167], v[12:13], v[158:159] op_sel_hi:[1,0,1]
    s_waitcnt vmcnt(0)
    v_lshlrev_b32 v160, 16, v134
    v_and_b32 v161, 0xffff0000, v134
    v_lshlrev_b32 v162, 16, v135
    v_and_b32 v163, 0xffff0000, v135
    v_lshlrev_b32 v164, 16, v136
    v_and_b32 v165, 0xffff0000, v136
    v_lshlrev_b32 v166, 16, v137
    v_and_b32 v167, 0xffff0000, v137
    v_pk_fma_f32 v[152:153], v[160:161], v[12:13], v[152:153] op_sel:[0,1,0] op_sel_hi:[1,1,1]
    v_pk_fma_f32 v[154:155], v[162:163], v[12:13], v[154:155] op_sel:[0,1,0] op_sel_hi:[1,1,1]
    v_pk_fma_f32 v[156:157], v[164:165], v[12:13], v[156:157] op_sel:[0,1,0] op_sel_hi:[1,1,1]
    v_pk_fma_f32 v[158:159], v[166:167], v[12:13], v[158:159] op_sel:[0,1,0] op_sel_hi:[1,1,1]
L_AFIN:
    s_nop 1
    v_permlane32_swap_b32 v152, v156
    v_permlane32_swap_b32 v153, v157
    v_permlane32_swap_b32 v154, v158
    v_permlane32_swap_b32 v155, v159
    v_add_f32 v152, v152, v156
    v_add_f32 v153, v153, v157
    v_add_f32 v154, v154, v158
    v_add_f32 v155, v155, v159
    s_nop 0
    v_permlane16_swap_b32 v152, v154
    v_permlane16_swap_b32 v153, v155
    v_add_f32 v152, v152, v154
    v_add_f32 v153, v153, v155
    ds_write_b64 v2, v[152:153]
    s_waitcnt lgkmcnt(0)
    s_barrier
    s_endpgm
L_ASVC:
    s_cmp_lg_u32 s3, 11
    s_cbranch_scc1 Z_10
    v_lshlrev_b32 v2, 2, v1
    v_add_u32 v2, 0x24000, v2
    v_mov_b32 v3, 0
    ds_write_b32 v2, v3
Z_10:
    s_waitcnt lgkmcnt(0)
    s_mov_b32 s92, 0x05040100
    s_mov_b32 s93, 0x07060302
    s_mov_b32 s36, s34
    s_and_b32 s37, s35, 0xffff
    s_mov_b32 s38, 0x1000000
    s_mov_b32 s39, 0x20000
    s_mov_b32 s40, s32
    s_and_b32 s41, s33, 0xffff
    s_mov_b32 s42, 0x100
    s_mov_b32 s43, 0x20000
    s_setprio 3
    s_lshr_b32 s60, s5, 2
    s_sub_u32 s60, s60, 4
    s_barrier
    s_lshl_b32 s7, s6, 2
    s_add_u32 s7, s7, s60
    s_lshl_b32 s7, s7, 11
    v_lshl_add_u32 v3, v1, 4, s7
    v_add_u32 v5, 0x40000, v3
    v_add_u32 v3, 0x80000, v3
    s_xor_b32 s7, s6, 2
    s_lshl_b32 s7, s7, 5
    s_add_u32 s7, s7, s60
    s_lshl_b32 s7, s7, 8
    s_add_u32 s7, s7, 0x80000
    v_lshrrev_b32 v6, 4, v1
    v_lshlrev_b32 v6, 11, v6
    v_and_b32 v100, 15, v1
    v_lshl_add_u32 v6, v100, 4, v6
    v_add_u32 v6, s7, v6
    s_sleep 8
    v_mov_b32 v90, 0
    s_mov_b32 s80, 200000
    s_mov_b64 exec, 1
    buffer_load_dwordx2 v[94:95], v90, s[40:43], 0 offen sc1
    s_sleep 16
    buffer_load_dwordx2 v[92:93], v90, s[40:43], 0 offen sc1
    s_mov_b64 exec, -1
    s_waitcnt vmcnt(1)
    v_readfirstlane_b32 s94, v94
    v_readfirstlane_b32 s95, v95
    s_cmp_lg_u32 s95, 0
    s_cbranch_scc1 NGD_12
    s_branch NG2_13
NG_11:
    s_mov_b64 exec, 1
    buffer_load_dwordx2 v[92:93], v90, s[40:43], 0 offen sc1
    s_mov_b64 exec, -1
NG2_13:
    s_waitcnt vmcnt(0)
    v_readfirstlane_b32 s94, v92
    v_readfirstlane_b32 s95, v93
    s_cmp_lg_u32 s95, 0
    s_cbranch_scc1 NGD_12
    s_sleep 4
    s_sub_u32 s80, s80, 1
    s_cmp_lg_u32 s80, 0
    s_cbranch_scc1 NG_11
NGD_12:
    v_lshlrev_b32 v7, 5, v1
    v_mov_b32 v114, s94
    v_mov_b32 v115, s95
    v_mov_b32 v118, s94
    v_mov_b32 v119, s95
    v_mov_b32 v122, s94
    v_mov_b32 v123, s95
    v_mov_b32 v126, s94
    v_mov_b32 v127, s95
    v_mov_b32 v100, 0x24044
    s_mov_b32 s80, 1600000
LW_14:
    ds_read_b32 v101, v100
    s_waitcnt lgkmcnt(0)
    v_readfirstlane_b32 s79, v101
    s_cmp_ge_u32 s79, 4
    s_cbranch_scc1 LWD_15
    s_sub_u32 s80, s80, 1
    s_cmp_lg_u32 s80, 0
    s_cbranch_scc1 LW_14
LWD_15:
    ds_read_b128 v[16:19], v7 offset:0
    ds_read_b128 v[20:23], v7 offset:16
    ds_read_b128 v[24:27], v7 offset:2048
    ds_read_b128 v[28:31], v7 offset:2064
    ds_read_b128 v[32:35], v7 offset:4096
    ds_read_b128 v[36:39], v7 offset:4112
    ds_read_b128 v[40:43], v7 offset:6144
    ds_read_b128 v[44:47], v7 offset:6160
    s_waitcnt lgkmcnt(0)
    v_add_f32 v16, v16, v32
    v_add_f32 v17, v17, v33
    v_add_f32 v18, v18, v34
    v_add_f32 v19, v19, v35
    v_add_f32 v20, v20, v36
    v_add_f32 v21, v21, v37
    v_add_f32 v22, v22, v38
    v_add_f32 v23, v23, v39
    v_add_f32 v24, v24, v40
    v_add_f32 v25, v25, v41
    v_add_f32 v26, v26, v42
    v_add_f32 v27, v27, v43
    v_add_f32 v28, v28, v44
    v_add_f32 v29, v29, v45
    v_add_f32 v30, v30, v46
    v_add_f32 v31, v31, v47
    v_add_f32 v16, v16, v24
    v_add_f32 v17, v17, v25
    v_add_f32 v18, v18, v26
    v_add_f32 v19, v19, v27
    v_add_f32 v20, v20, v28
    v_add_f32 v21, v21, v29
    v_add_f32 v22, v22, v30
    v_add_f32 v23, v23, v31
    v_cvt_pk_bf16_f32 v112, v16, v17
    v_cvt_pk_bf16_f32 v113, v18, v19
    v_cvt_pk_bf16_f32 v116, v20, v21
    v_cvt_pk_bf16_f32 v117, v22, v23
    buffer_store_dwordx4 v[112:115], v5, s[36:39], 0 offen offset:0
    buffer_store_dwordx4 v[116:119], v5, s[36:39], 0 offen offset:1024
    v_mov_b32 v100, 0x24018
    v_mov_b32 v101, 1
    s_waitcnt lgkmcnt(0)
    s_mov_b64 exec, 1
    ds_add_u32 v100, v101
    s_mov_b64 exec, -1
    v_mov_b32 v100, 0x24040
    s_mov_b32 s80, 1600000
LW_16:
    ds_read_b32 v101, v100
    s_waitcnt lgkmcnt(0)
    v_readfirstlane_b32 s79, v101
    s_cmp_ge_u32 s79, 4
    s_cbranch_scc1 LWD_17
    s_sub_u32 s80, s80, 1
    s_cmp_lg_u32 s80, 0
    s_cbranch_scc1 LW_16
LWD_17:
    ds_read_b128 v[16:19], v7 offset:8192
    ds_read_b128 v[20:23], v7 offset:8208
    ds_read_b128 v[24:27], v7 offset:10240
    ds_read_b128 v[28:31], v7 offset:10256
    ds_read_b128 v[32:35], v7 offset:12288
    ds_read_b128 v[36:39], v7 offset:12304
    ds_read_b128 v[40:43], v7 offset:14336
    ds_read_b128 v[44:47], v7 offset:14352
    s_waitcnt lgkmcnt(0)
    v_add_f32 v16, v16, v32
    v_add_f32 v17, v17, v33
    v_add_f32 v18, v18, v34
    v_add_f32 v19, v19, v35
    v_add_f32 v20, v20, v36
    v_add_f32 v21, v21, v37
    v_add_f32 v22, v22, v38
    v_add_f32 v23, v23, v39
    v_add_f32 v24, v24, v40
    v_add_f32 v25, v25, v41
    v_add_f32 v26, v26, v42
    v_add_f32 v27, v27, v43
    v_add_f32 v28, v28, v44
    v_add_f32 v29, v29, v45
    v_add_f32 v30, v30, v46
    v_add_f32 v31, v31, v47
    v_add_f32 v16, v16, v24
    v_add_f32 v17, v17, v25
    v_add_f32 v18, v18, v26
    v_add_f32 v19, v19, v27
    v_add_f32 v20, v20, v28
    v_add_f32 v21, v21, v29
    v_add_f32 v22, v22, v30
    v_add_f32 v23, v23, v31
    v_cvt_pk_bf16_f32 v120, v16, v17
    v_cvt_pk_bf16_f32 v121, v18, v19
    v_cvt_pk_bf16_f32 v124, v20, v21
    v_cvt_pk_bf16_f32 v125, v22, v23
    buffer_store_dwordx4 v[120:123], v6, s[36:39], 0 offen offset:0
    buffer_store_dwordx4 v[124:127], v6, s[36:39], 0 offen offset:1024
    v_mov_b32 v100, 0x24018
    v_mov_b32 v101, 1
    s_waitcnt lgkmcnt(0)
    s_mov_b64 exec, 1
    ds_add_u32 v100, v101
    s_mov_b64 exec, -1
    v_mov_b32 v110, v5
    v_mov_b32 v111, v6
    s_getreg_b32 s96, hwreg(HW_REG_XCC_ID, 0, 4)
    s_lshl_b32 s7, s4, 5
    s_add_u32 s7, s7, s5
    s_lshl_b32 s7, s7, 4
    s_add_u32 s7, s7, 0xc0000
    v_mov_b32 v100, s7
    v_mov_b32 v102, s96
    v_mov_b32 v103, 0
    v_mov_b32 v104, s94
    v_mov_b32 v105, s95
    s_mov_b64 exec, 1
    buffer_store_dwordx4 v[102:105], v100, s[36:39], 0 offen
    s_mov_b64 exec, -1
    s_sleep 16
    buffer_load_dwordx4 v[32:35], v3, s[36:39], 0 offen offset:0 sc1
    buffer_load_dwordx4 v[36:39], v3, s[36:39], 0 offen offset:1024 sc1
    s_mov_b32 s80, 200000
PS_18:
    s_waitcnt vmcnt(0)
    s_mov_b32 s78, 0
    v_cmp_ne_u64 vcc, s[94:95], v[34:35]
    s_cbranch_vccz PSS_20
    buffer_load_dwordx4 v[32:35], v3, s[36:39], 0 offen offset:0 sc1
    s_mov_b32 s78, 1
PSS_20:
    v_cmp_ne_u64 vcc, s[94:95], v[38:39]
    s_cbranch_vccz PSS_21
    buffer_load_dwordx4 v[36:39], v3, s[36:39], 0 offen offset:1024 sc1
    s_mov_b32 s78, 1
PSS_21:
    s_cmp_eq_u32 s78, 0
    s_cbranch_scc1 PSD_19
    s_sleep 8
    s_cmp_lg_u32 s80, 199984
    s_cbranch_scc1 PSL_22
    buffer_store_dwordx4 v[112:115], v110, s[36:39], 0 offen offset:0 sc1
    buffer_store_dwordx4 v[116:119], v110, s[36:39], 0 offen offset:1024 sc1
    buffer_store_dwordx4 v[120:123], v111, s[36:39], 0 offen offset:0 sc1
    buffer_store_dwordx4 v[124:127], v111, s[36:39], 0 offen offset:1024 sc1
PSL_22:
    s_sub_u32 s80, s80, 1
    s_cmp_lg_u32 s80, 0
    s_cbranch_scc1 PS_18
    s_waitcnt vmcnt(0)
PSD_19:
    v_lshlrev_b32 v16, 16, v32
    v_and_b32 v17, 0xffff0000, v32
    v_lshlrev_b32 v18, 16, v33
    v_and_b32 v19, 0xffff0000, v33
    v_lshlrev_b32 v20, 16, v36
    v_and_b32 v21, 0xffff0000, v36
    v_lshlrev_b32 v22, 16, v37
    v_and_b32 v23, 0xffff0000, v37
    v_mov_b32 v24, v16
    v_mov_b32 v25, v17
    v_mov_b32 v26, v18
    v_mov_b32 v27, v19
    v_mov_b32 v28, v20
    v_mov_b32 v29, v21
    v_mov_b32 v30, v22
    v_mov_b32 v31, v23
    v_permlane32_swap_b32 v16, v24
    v_permlane32_swap_b32 v17, v25
    v_permlane32_swap_b32 v18, v26
    v_permlane32_swap_b32 v19, v27
    v_permlane32_swap_b32 v20, v28
    v_permlane32_swap_b32 v21, v29
    v_permlane32_swap_b32 v22, v30
    v_permlane32_swap_b32 v23, v31
    v_add_f32 v16, v16, v24
    v_add_f32 v17, v17, v25
    v_add_f32 v18, v18, v26
    v_add_f32 v19, v19, v27
    v_add_f32 v20, v20, v28
    v_add_f32 v21, v21, v29
    v_add_f32 v22, v22, v30
    v_add_f32 v23, v23, v31
    v_mov_b32 v24, v16
    v_mov_b32 v25, v17
    v_mov_b32 v26, v18
    v_mov_b32 v27, v19
    v_mov_b32 v28, v20
    v_mov_b32 v29, v21
    v_mov_b32 v30, v22
    v_mov_b32 v31, v23
    v_permlane16_swap_b32 v16, v24
    v_permlane16_swap_b32 v17, v25
    v_permlane16_swap_b32 v18, v26
    v_permlane16_swap_b32 v19, v27
    v_permlane16_swap_b32 v20, v28
    v_permlane16_swap_b32 v21, v29
    v_permlane16_swap_b32 v22, v30
    v_permlane16_swap_b32 v23, v31
    v_add_f32 v16, v16, v24
    v_add_f32 v17, v17, v25
    v_add_f32 v18, v18, v26
    v_add_f32 v19, v19, v27
    v_add_f32 v20, v20, v28
    v_add_f32 v21, v21, v29
    v_add_f32 v22, v22, v30
    v_add_f32 v23, v23, v31
    v_cvt_pk_bf16_f32 v8, v16, v17
    v_cvt_pk_bf16_f32 v9, v18, v19
    v_cvt_pk_bf16_f32 v10, v20, v21
    v_cvt_pk_bf16_f32 v11, v22, v23
    v_and_b32 v100, 15, v1
    v_lshlrev_b32 v100, 4, v100
    v_add_u32 v100, 0x24100, v100
    ds_write_b128 v100, v[8:11]
L_ACUT:
    v_mov_b32 v100, 0x24004
    v_mov_b32 v101, 1
    s_waitcnt lgkmcnt(0)
    s_mov_b64 exec, 1
    ds_add_u32 v100, v101
    s_mov_b64 exec, -1
    s_sleep 100
    v_and_b32 v100, 31, v1
    s_lshl_b32 s7, s4, 9
    s_add_u32 s7, s7, 0xc0000
    v_lshl_add_u32 v100, v100, 4, s7
    buffer_load_dwordx4 v[32:35], v100, s[36:39], 0 offen sc1
    s_waitcnt vmcnt(0)
    v_cmp_ne_u64 vcc, s[94:95], v[34:35]
    v_cmp_ne_u32 s[86:87], s96, v32
    s_or_b32 s97, vcc_lo, s86
    s_and_b32 s97, s97, 0xffff00ff
    s_cbranch_scc0 AF_23
    buffer_store_dwordx4 v[112:115], v110, s[36:39], 0 offen offset:0 sc1
    buffer_store_dwordx4 v[116:119], v110, s[36:39], 0 offen offset:1024 sc1
    buffer_store_dwordx4 v[120:123], v111, s[36:39], 0 offen offset:0 sc1
    buffer_store_dwordx4 v[124:127], v111, s[36:39], 0 offen offset:1024 sc1
AF_23:
    v_mov_b32 v100, 0x24008
    s_mov_b32 s80, 1600000
LW_24:
    ds_read_b32 v101, v100
    s_waitcnt lgkmcnt(0)
    v_readfirstlane_b32 s79, v101
    s_cmp_ge_u32 s79, 11
    s_cbranch_scc1 LWD_25
    s_sleep 2
    s_sub_u32 s80, s80, 1
    s_cmp_lg_u32 s80, 0
    s_cbranch_scc1 LW_24
LWD_25:
    v_mov_b32 v100, 0x24200
    ds_read_b128 v[8:11], v100 offset:0
    ds_read_b128 v[12:15], v100 offset:16
    ds_read_b128 v[16:19], v100 offset:32
    ds_read_b128 v[20:23], v100 offset:48
    ds_read_b128 v[24:27], v100 offset:64
    ds_read_b128 v[28:31], v100 offset:80
    s_waitcnt lgkmcnt(0)
    v_max3_f32 v100, v8, v10, v12
    v_max3_f32 v100, v100, v14, v16
    v_max3_f32 v100, v100, v18, v20
    v_max3_f32 v100, v100, v22, v24
    v_max3_f32 v100, v100, v26, v28
    v_sub_f32 v8, v8, v100
    v_sub_f32 v10, v10, v100
    v_sub_f32 v12, v12, v100
    v_sub_f32 v14, v14, v100
    v_sub_f32 v16, v16, v100
    v_sub_f32 v18, v18, v100
    v_sub_f32 v20, v20, v100
    v_sub_f32 v22, v22, v100
    v_sub_f32 v24, v24, v100
    v_sub_f32 v26, v26, v100
    v_sub_f32 v28, v28, v100
    v_exp_f32 v8, v8
    v_exp_f32 v10, v10
    v_exp_f32 v12, v12
    v_exp_f32 v14, v14
    v_exp_f32 v16, v16
    v_exp_f32 v18, v18
    v_exp_f32 v20, v20
    v_exp_f32 v22, v22
    v_exp_f32 v24, v24
    v_exp_f32 v26, v26
    v_exp_f32 v28, v28
    v_mul_f32 v101, v8, v9
    v_fmac_f32 v101, v10, v11
    v_fmac_f32 v101, v12, v13
    v_fmac_f32 v101, v14, v15
    v_fmac_f32 v101, v16, v17
    v_fmac_f32 v101, v18, v19
    v_fmac_f32 v101, v20, v21
    v_fmac_f32 v101, v22, v23
    v_fmac_f32 v101, v24, v25
    v_fmac_f32 v101, v26, v27
    v_fmac_f32 v101, v28, v29
    v_rcp_f32 v101, v101
    s_nop 0
    v_mul_f32 v8, v8, v101
    v_mul_f32 v10, v10, v101
    v_mul_f32 v12, v12, v101
    v_mul_f32 v14, v14, v101
    v_mul_f32 v16, v16, v101
    v_mul_f32 v18, v18, v101
    v_mul_f32 v20, v20, v101
    v_mul_f32 v22, v22, v101
    v_mul_f32 v24, v24, v101
    v_mul_f32 v26, v26, v101
    v_mul_f32 v28, v28, v101
    v_and_b32 v100, 15, v1
    v_bfe_u32 v101, v1, 4, 1
    v_lshlrev_b32 v3, 5, v100
    v_lshl_add_u32 v3, v101, 4, v3
    v_add_u32 v3, 0x25000, v3
    s_lshl_b32 s7, s6, 3
    s_add_u32 s7, s7, s60
    s_lshl_b32 s7, s7, 8
    s_add_u32 s7, s7, 0xd0000
    v_lshlrev_b32 v2, 4, v100
    v_lshl_add_u32 v2, v101, 10, v2
    v_add_u32 v2, s7, v2
    v_mov_b32 v6, s94
    v_mov_b32 v7, s95
    s_barrier
    ds_read_b128 v[40:43], v3 offset:0
    ds_read_b128 v[44:47], v3 offset:512
    ds_read_b128 v[48:51], v3 offset:1024
    ds_read_b128 v[52:55], v3 offset:1536
    ds_read_b128 v[56:59], v3 offset:2048
    ds_read_b128 v[60:63], v3 offset:2560
    ds_read_b128 v[64:67], v3 offset:3072
    ds_read_b128 v[68:71], v3 offset:3584
    ds_read_b128 v[72:75], v3 offset:4096
    ds_read_b128 v[76:79], v3 offset:4608
    ds_read_b128 v[80:83], v3 offset:5120
    s_waitcnt lgkmcnt(10)
    v_pk_mul_f32 v[32:33], v[40:41], v[8:9] op_sel_hi:[1,0]
    v_pk_mul_f32 v[34:35], v[42:43], v[8:9] op_sel_hi:[1,0]
    s_waitcnt lgkmcnt(9)
    v_pk_mul_f32 v[36:37], v[44:45], v[10:11] op_sel_hi:[1,0]
    v_pk_mul_f32 v[38:39], v[46:47], v[10:11] op_sel_hi:[1,0]
    s_waitcnt lgkmcnt(8)
    v_pk_fma_f32 v[32:33], v[48:49], v[12:13], v[32:33] op_sel_hi:[1,0,1]
    v_pk_fma_f32 v[34:35], v[50:51], v[12:13], v[34:35] op_sel_hi:[1,0,1]
    s_waitcnt lgkmcnt(7)
    v_pk_fma_f32 v[36:37], v[52:53], v[14:15], v[36:37] op_sel_hi:[1,0,1]
    v_pk_fma_f32 v[38:39], v[54:55], v[14:15], v[38:39] op_sel_hi:[1,0,1]
    s_waitcnt lgkmcnt(6)
    v_pk_fma_f32 v[32:33], v[56:57], v[16:17], v[32:33] op_sel_hi:[1,0,1]
    v_pk_fma_f32 v[34:35], v[58:59], v[16:17], v[34:35] op_sel_hi:[1,0,1]
    s_waitcnt lgkmcnt(5)
    v_pk_fma_f32 v[36:37], v[60:61], v[18:19], v[36:37] op_sel_hi:[1,0,1]
    v_pk_fma_f32 v[38:39], v[62:63], v[18:19], v[38:39] op_sel_hi:[1,0,1]
    s_waitcnt lgkmcnt(4)
    v_pk_fma_f32 v[32:33], v[64:65], v[20:21], v[32:33] op_sel_hi:[1,0,1]
    v_pk_fma_f32 v[34:35], v[66:67], v[20:21], v[34:35] op_sel_hi:[1,0,1]
    s_waitcnt lgkmcnt(3)
    v_pk_fma_f32 v[36:37], v[68:69], v[22:23], v[36:37] op_sel_hi:[1,0,1]
    v_pk_fma_f32 v[38:39], v[70:71], v[22:23], v[38:39] op_sel_hi:[1,0,1]
    s_waitcnt lgkmcnt(2)
    v_pk_fma_f32 v[32:33], v[72:73], v[24:25], v[32:33] op_sel_hi:[1,0,1]
    v_pk_fma_f32 v[34:35], v[74:75], v[24:25], v[34:35] op_sel_hi:[1,0,1]
    s_waitcnt lgkmcnt(1)
    v_pk_fma_f32 v[36:37], v[76:77], v[26:27], v[36:37] op_sel_hi:[1,0,1]
    v_pk_fma_f32 v[38:39], v[78:79], v[26:27], v[38:39] op_sel_hi:[1,0,1]
    s_waitcnt lgkmcnt(0)
    v_pk_fma_f32 v[32:33], v[80:81], v[28:29], v[32:33] op_sel_hi:[1,0,1]
    v_pk_fma_f32 v[34:35], v[82:83], v[28:29], v[34:35] op_sel_hi:[1,0,1]
    v_pk_add_f32 v[32:33], v[32:33], v[36:37]
    v_pk_add_f32 v[34:35], v[34:35], v[38:39]
    v_cvt_pk_bf16_f32 v4, v32, v33
    v_cvt_pk_bf16_f32 v5, v34, v35
    s_mov_b64 exec, 0xffffffff
    buffer_store_dwordx4 v[4:7], v2, s[36:39], 0 offen
    s_cmp_eq_u32 s97, 0
    s_cbranch_scc1 AF_26
    buffer_store_dwordx4 v[4:7], v2, s[36:39], 0 offen sc1
AF_26:
    s_mov_b64 exec, -1
    s_endpgm
.p2align 12
L_W:
    s_waitcnt lgkmcnt(0)
    s_mov_b32 s92, 0x05040100
    s_mov_b32 s93, 0x07060302
    s_mov_b32 s36, s34
    s_and_b32 s37, s35, 0xffff
    s_mov_b32 s38, 0x1000000
    s_mov_b32 s39, 0x20000
    s_mov_b32 s40, s32
    s_and_b32 s41, s33, 0xffff
    s_mov_b32 s42, 0x100
    s_mov_b32 s43, 0x20000
    s_barrier
    s_cmp_eq_u32 s3, 0
    s_cbranch_scc1 LT_U1
LR_U1:
    s_cmp_eq_u32 s3, 1
    s_cbranch_scc1 LT_W2R
LR_W2R:
    s_cmp_ge_u32 s5, 4
    s_cbranch_scc1 L_END
    v_mov_b32 v160, 0x24048
    s_mov_b32 s80, 1600000
LW_27:
    ds_read_b32 v161, v160
    s_waitcnt lgkmcnt(0)
    v_readfirstlane_b32 s79, v161
    s_cmp_ge_u32 s79, 4
    s_cbranch_scc1 LWD_28
    s_sleep 4
    s_sub_u32 s80, s80, 1
    s_cmp_lg_u32 s80, 0
    s_cbranch_scc1 LW_27
LWD_28:
    s_branch L_U1
L_W1:
    s_waitcnt lgkmcnt(0)
    s_mov_b32 s92, 0x05040100
    s_mov_b32 s93, 0x07060302
    s_mov_b32 s36, s34
    s_and_b32 s37, s35, 0xffff
    s_mov_b32 s38, 0x1000000
    s_mov_b32 s39, 0x20000
    s_mov_b32 s40, s32
    s_and_b32 s41, s33, 0xffff
    s_mov_b32 s42, 0x100
    s_mov_b32 s43, 0x20000
    s_setprio 3
    s_barrier
    s_cmp_lg_u32 s3, 4
    s_cbranch_scc1 W4_29
    s_sleep 8
    v_mov_b32 v152, 0
    s_mov_b32 s80, 200000
    s_mov_b64 exec, 1
    buffer_load_dwordx2 v[156:157], v152, s[40:43], 0 offen sc1
    s_sleep 16
    buffer_load_dwordx2 v[154:155], v152, s[40:43], 0 offen sc1
    s_mov_b64 exec, -1
    s_waitcnt vmcnt(1)
    v_readfirstlane_b32 s94, v156
    v_readfirstlane_b32 s95, v157
    s_cmp_lg_u32 s95, 0
    s_cbranch_scc1 NGD_31
    s_branch NG2_32
NG_30:
    s_mov_b64 exec, 1
    buffer_load_dwordx2 v[154:155], v152, s[40:43], 0 offen sc1
    s_mov_b64 exec, -1
NG2_32:
    s_waitcnt vmcnt(0)
    v_readfirstlane_b32 s94, v154
    v_readfirstlane_b32 s95, v155
    s_cmp_lg_u32 s95, 0
    s_cbranch_scc1 NGD_31
    s_sleep 4
    s_sub_u32 s80, s80, 1
    s_cmp_lg_u32 s80, 0
    s_cbranch_scc1 NG_30
NGD_31:
    v_mov_b32 v160, 0x24050
    v_mov_b32 v162, s94
    v_mov_b32 v163, s95
    ds_write_b64 v160, v[162:163]
    v_mov_b32 v160, 0x2404c
    v_mov_b32 v161, 1
    s_waitcnt lgkmcnt(0)
    s_mov_b64 exec, 1
    ds_add_u32 v160, v161
    s_mov_b64 exec, -1
    s_getreg_b32 s96, hwreg(HW_REG_XCC_ID, 0, 4)
    s_lshl_b32 s7, s4, 5
    s_add_u32 s7, s7, s5
    s_lshl_b32 s7, s7, 4
    s_add_u32 s7, s7, 0xc0000
    v_mov_b32 v160, s7
    v_mov_b32 v162, s96
    v_mov_b32 v163, 0
    v_mov_b32 v164, s94
    v_mov_b32 v165, s95
    s_mov_b64 exec, 1
    buffer_store_dwordx4 v[162:165], v160, s[36:39], 0 offen
    s_mov_b64 exec, -1
W4_29:
    s_sub_u32 s62, s3, 4
    s_lshl_b32 s61, s4, 2
    s_add_u32 s61, s61, s62
    v_lshrrev_b32 v162, 4, v1
    v_and_b32 v161, 15, v1
    v_lshlrev_b32 v2, 16, v162
    v_lshl_add_u32 v2, v161, 4, v2
    s_lshl_b32 s7, s61, 3
    s_add_u32 s7, s7, s5
    s_lshl_b32 s7, s7, 8
    s_add_u32 s7, s7, 0x0
    v_add_u32 v2, s7, v2
    v_lshlrev_b32 v3, 6, v161
    v_lshl_add_u32 v3, v162, 4, v3
    s_lshl_b32 s7, s61, 13
    s_add_u32 s7, s7, 0x40000
    v_add_u32 v3, s7, v3
    v_xor_b32 v5, v162, v161
    v_lshlrev_b32 v5, 4, v5
    v_lshl_add_u32 v4, v161, 12, v5
    s_lshl_b32 s7, s62, 8
    v_add_u32 v4, s7, v4
    v_mov_b32 v160, 0x2404c
    s_mov_b32 s80, 1600000
LW_33:
    ds_read_b32 v161, v160
    s_waitcnt lgkmcnt(0)
    v_readfirstlane_b32 s79, v161
    s_cmp_ge_u32 s79, 1
    s_cbranch_scc1 LWD_34
    s_sleep 2
    s_sub_u32 s80, s80, 1
    s_cmp_lg_u32 s80, 0
    s_cbranch_scc1 LW_33
LWD_34:
    v_mov_b32 v160, 0x24050
    ds_read_b64 v[162:163], v160
    s_waitcnt lgkmcnt(0)
    v_readfirstlane_b32 s94, v162
    v_readfirstlane_b32 s95, v163
    s_sleep 4
    s_mov_b32 s63, 4096
    buffer_load_dwordx4 v[72:75], v3, s[36:39], 0 offen offset:0 sc1
    buffer_load_dwordx4 v[76:79], v3, s[36:39], 0 offen offset:1024 sc1
    buffer_load_dwordx4 v[80:83], v3, s[36:39], 0 offen offset:2048 sc1
    buffer_load_dwordx4 v[84:87], v3, s[36:39], 0 offen offset:3072 sc1
    buffer_load_dwordx4 v[88:91], v3, s[36:39], s63 offen offset:0 sc1
    buffer_load_dwordx4 v[92:95], v3, s[36:39], s63 offen offset:1024 sc1
    buffer_load_dwordx4 v[96:99], v3, s[36:39], s63 offen offset:2048 sc1
    buffer_load_dwordx4 v[100:103], v3, s[36:39], s63 offen offset:3072 sc1
    v_mov_b32 v160, 0x24014
    s_mov_b32 s80, 1600000
LW_37:
    ds_read_b32 v161, v160
    s_waitcnt lgkmcnt(0)
    v_readfirstlane_b32 s79, v161
    s_cmp_ge_u32 s79, 4
    s_cbranch_scc1 LWD_38
    s_sleep 1
    s_sub_u32 s80, s80, 1
    s_cmp_lg_u32 s80, 0
    s_cbranch_scc1 LW_37
LWD_38:
    v_xor_b32 v160, 0x0, v4
    v_xor_b32 v161, 0x40, v4
    v_xor_b32 v162, 0x80, v4
    v_xor_b32 v163, 0xc0, v4
    ds_read_b128 v[8:11], v160 offset:0
    ds_read_b128 v[12:15], v161 offset:0
    ds_read_b128 v[16:19], v162 offset:0
    ds_read_b128 v[20:23], v163 offset:0
    ds_read_b128 v[24:27], v160 offset:1024
    ds_read_b128 v[28:31], v161 offset:1024
    ds_read_b128 v[32:35], v162 offset:1024
    ds_read_b128 v[36:39], v163 offset:1024
    ds_read_b128 v[40:43], v160 offset:2048
    ds_read_b128 v[44:47], v161 offset:2048
    ds_read_b128 v[48:51], v162 offset:2048
    ds_read_b128 v[52:55], v163 offset:2048
    ds_read_b128 v[56:59], v160 offset:3072
    ds_read_b128 v[60:63], v161 offset:3072
    ds_read_b128 v[64:67], v162 offset:3072
    ds_read_b128 v[68:71], v163 offset:3072
    s_mov_b32 s80, 200000
PS_35:
    s_waitcnt vmcnt(0)
    s_mov_b32 s78, 0
    v_cmp_ne_u64 vcc, s[94:95], v[74:75]
    s_cbranch_vccz PSS_39
    buffer_load_dwordx4 v[72:75], v3, s[36:39], 0 offen offset:0 sc1
    s_mov_b32 s78, 1
PSS_39:
    v_cmp_ne_u64 vcc, s[94:95], v[78:79]
    s_cbranch_vccz PSS_40
    buffer_load_dwordx4 v[76:79], v3, s[36:39], 0 offen offset:1024 sc1
    s_mov_b32 s78, 1
PSS_40:
    v_cmp_ne_u64 vcc, s[94:95], v[82:83]
    s_cbranch_vccz PSS_41
    buffer_load_dwordx4 v[80:83], v3, s[36:39], 0 offen offset:2048 sc1
    s_mov_b32 s78, 1
PSS_41:
    v_cmp_ne_u64 vcc, s[94:95], v[86:87]
    s_cbranch_vccz PSS_42
    buffer_load_dwordx4 v[84:87], v3, s[36:39], 0 offen offset:3072 sc1
    s_mov_b32 s78, 1
PSS_42:
    v_cmp_ne_u64 vcc, s[94:95], v[90:91]
    s_cbranch_vccz PSS_43
    buffer_load_dwordx4 v[88:91], v3, s[36:39], s63 offen offset:0 sc1
    s_mov_b32 s78, 1
PSS_43:
    v_cmp_ne_u64 vcc, s[94:95], v[94:95]
    s_cbranch_vccz PSS_44
    buffer_load_dwordx4 v[92:95], v3, s[36:39], s63 offen offset:1024 sc1
    s_mov_b32 s78, 1
PSS_44:
    v_cmp_ne_u64 vcc, s[94:95], v[98:99]
    s_cbranch_vccz PSS_45
    buffer_load_dwordx4 v[96:99], v3, s[36:39], s63 offen offset:2048 sc1
    s_mov_b32 s78, 1
PSS_45:
    v_cmp_ne_u64 vcc, s[94:95], v[102:103]
    s_cbranch_vccz PSS_46
    buffer_load_dwordx4 v[100:103], v3, s[36:39], s63 offen offset:3072 sc1
    s_mov_b32 s78, 1
PSS_46:
    s_cmp_eq_u32 s78, 0
    s_cbranch_scc1 PSD_36
    s_sub_u32 s80, s80, 1
    s_cmp_lg_u32 s80, 0
    s_cbranch_scc1 PS_35
    s_waitcnt vmcnt(0)
PSD_36:
    v_lshlrev_b32 v104, 16, v72
    v_and_b32 v105, 0xffff0000, v72
    v_lshlrev_b32 v106, 16, v73
    v_and_b32 v107, 0xffff0000, v73
    v_lshlrev_b32 v108, 16, v76
    v_and_b32 v109, 0xffff0000, v76
    v_lshlrev_b32 v110, 16, v77
    v_and_b32 v111, 0xffff0000, v77
    v_lshlrev_b32 v120, 16, v80
    v_and_b32 v121, 0xffff0000, v80
    v_lshlrev_b32 v122, 16, v81
    v_and_b32 v123, 0xffff0000, v81
    v_lshlrev_b32 v124, 16, v84
    v_and_b32 v125, 0xffff0000, v84
    v_lshlrev_b32 v126, 16, v85
    v_and_b32 v127, 0xffff0000, v85
    v_add_f32 v104, v104, v120
    v_add_f32 v105, v105, v121
    v_add_f32 v106, v106, v122
    v_add_f32 v107, v107, v123
    v_add_f32 v108, v108, v124
    v_add_f32 v109, v109, v125
    v_add_f32 v110, v110, v126
    v_add_f32 v111, v111, v127
    v_lshlrev_b32 v112, 16, v88
    v_and_b32 v113, 0xffff0000, v88
    v_lshlrev_b32 v114, 16, v89
    v_and_b32 v115, 0xffff0000, v89
    v_lshlrev_b32 v116, 16, v92
    v_and_b32 v117, 0xffff0000, v92
    v_lshlrev_b32 v118, 16, v93
    v_and_b32 v119, 0xffff0000, v93
    v_add_f32 v104, v104, v112
    v_add_f32 v105, v105, v113
    v_add_f32 v106, v106, v114
    v_add_f32 v107, v107, v115
    v_add_f32 v108, v108, v116
    v_add_f32 v109, v109, v117
    v_add_f32 v110, v110, v118
    v_add_f32 v111, v111, v119
    v_lshlrev_b32 v120, 16, v96
    v_and_b32 v121, 0xffff0000, v96
    v_lshlrev_b32 v122, 16, v97
    v_and_b32 v123, 0xffff0000, v97
    v_lshlrev_b32 v124, 16, v100
    v_and_b32 v125, 0xffff0000, v100
    v_lshlrev_b32 v126, 16, v101
    v_and_b32 v127, 0xffff0000, v101
    v_add_f32 v104, v104, v120
    v_add_f32 v105, v105, v121
    v_add_f32 v106, v106, v122
    v_add_f32 v107, v107, v123
    v_add_f32 v108, v108, v124
    v_add_f32 v109, v109, v125
    v_add_f32 v110, v110, v126
    v_add_f32 v111, v111, v127
    v_cvt_pk_bf16_f32 v136, v104, v105
    v_cvt_pk_bf16_f32 v137, v106, v107
    v_cvt_pk_bf16_f32 v138, v108, v109
    v_cvt_pk_bf16_f32 v139, v110, v111
    v_mov_b32_dpp v140, v136 quad_perm:[1,2,3,0] row_mask:0xf bank_mask:0xf
    v_mov_b32_dpp v141, v137 quad_perm:[1,2,3,0] row_mask:0xf bank_mask:0xf
    v_mov_b32_dpp v142, v138 quad_perm:[1,2,3,0] row_mask:0xf bank_mask:0xf
    v_mov_b32_dpp v143, v139 quad_perm:[1,2,3,0] row_mask:0xf bank_mask:0xf
    v_mov_b32_dpp v144, v136 quad_perm:[2,3,0,1] row_mask:0xf bank_mask:0xf
    v_mov_b32_dpp v145, v137 quad_perm:[2,3,0,1] row_mask:0xf bank_mask:0xf
    v_mov_b32_dpp v146, v138 quad_perm:[2,3,0,1] row_mask:0xf bank_mask:0xf
    v_mov_b32_dpp v147, v139 quad_perm:[2,3,0,1] row_mask:0xf bank_mask:0xf
    v_mov_b32_dpp v148, v136 quad_perm:[3,0,1,2] row_mask:0xf bank_mask:0xf
    v_mov_b32_dpp v149, v137 quad_perm:[3,0,1,2] row_mask:0xf bank_mask:0xf
    v_mov_b32_dpp v150, v138 quad_perm:[3,0,1,2] row_mask:0xf bank_mask:0xf
    v_mov_b32_dpp v151, v139 quad_perm:[3,0,1,2] row_mask:0xf bank_mask:0xf
    v_mov_b32 v74, s94
    v_mov_b32 v75, s95
    s_waitcnt lgkmcnt(0)
    v_mfma_f32_16x16x32_bf16 v[104:107], v[136:139], v[8:11], 0
    v_mfma_f32_16x16x32_bf16 v[108:111], v[136:139], v[28:31], 0
    v_mfma_f32_16x16x32_bf16 v[112:115], v[136:139], v[48:51], 0
    v_mfma_f32_16x16x32_bf16 v[116:119], v[136:139], v[68:71], 0
    v_mfma_f32_16x16x32_bf16 v[104:107], v[140:143], v[12:15], v[104:107]
    v_mfma_f32_16x16x32_bf16 v[108:111], v[140:143], v[32:35], v[108:111]
    v_mfma_f32_16x16x32_bf16 v[112:115], v[140:143], v[52:55], v[112:115]
    v_mfma_f32_16x16x32_bf16 v[116:119], v[140:143], v[56:59], v[116:119]
    v_mfma_f32_16x16x32_bf16 v[104:107], v[144:147], v[16:19], v[104:107]
    v_mfma_f32_16x16x32_bf16 v[108:111], v[144:147], v[36:39], v[108:111]
    v_mfma_f32_16x16x32_bf16 v[112:115], v[144:147], v[40:43], v[112:115]
    v_mfma_f32_16x16x32_bf16 v[116:119], v[144:147], v[60:63], v[116:119]
    v_mfma_f32_16x16x32_bf16 v[104:107], v[148:151], v[20:23], v[104:107]
    v_mfma_f32_16x16x32_bf16 v[108:111], v[148:151], v[24:27], v[108:111]
    v_mfma_f32_16x16x32_bf16 v[112:115], v[148:151], v[44:47], v[112:115]
    v_mfma_f32_16x16x32_bf16 v[116:119], v[148:151], v[64:67], v[116:119]
    s_nop 5
    v_cvt_pk_bf16_f32 v72, v104, v109
    s_nop 0
    v_cvt_pk_bf16_f32 v73, v114, v119
    buffer_store_dwordx4 v[72:75], v2, s[36:39], 0 offen sc1
    v_mov_b32 v160, 0x24048
    v_mov_b32 v161, 1
    s_waitcnt lgkmcnt(0)
    s_mov_b64 exec, 1
    ds_add_u32 v160, v161
    s_mov_b64 exec, -1
    s_setprio 0
    s_cmp_ge_u32 s5, 4
    s_cbranch_scc1 L_END
    s_branch L_U1
L_CSVC:
    s_cmp_lg_u32 s3, 11
    s_cbranch_scc1 Z_95
    v_lshlrev_b32 v2, 2, v1
    v_add_u32 v2, 0x24000, v2
    v_mov_b32 v3, 0
    ds_write_b32 v2, v3
Z_95:
    s_waitcnt lgkmcnt(0)
    s_mov_b32 s92, 0x05040100
    s_mov_b32 s93, 0x07060302
    s_mov_b32 s36, s34
    s_and_b32 s37, s35, 0xffff
    s_mov_b32 s38, 0x1000000
    s_mov_b32 s39, 0x20000
    s_mov_b32 s40, s32
    s_and_b32 s41, s33, 0xffff
    s_mov_b32 s42, 0x100
    s_mov_b32 s43, 0x20000
    s_setprio 3
    s_sub_u32 s60, s3, 8
    s_lshl_b32 s64, s4, 3
    s_add_u32 s64, s64, s5
    s_sub_u32 s64, s64, 8
    v_lshlrev_b32 v2, 4, v1
    s_barrier
    s_cmp_eq_u32 s3, 9
    s_cbranch_scc1 LT_CR
LR_CR:
    s_cmp_eq_u32 s3, 10
    s_cbranch_scc1 LT_CR2
LR_CR2:
    s_cmp_lg_u32 s60, 0
    s_cbranch_scc1 C8_96
    s_sleep 24
    v_mov_b32 v160, 0
    s_mov_b32 s80, 200000
NG_97:
    s_mov_b64 exec, 1
    buffer_load_dwordx2 v[162:163], v160, s[40:43], 0 offen sc1
    s_mov_b64 exec, -1
    s_waitcnt vmcnt(0)
    v_readfirstlane_b32 s94, v162
    v_readfirstlane_b32 s95, v163
    s_cmp_lg_u32 s95, 0
    s_cbranch_scc1 NGD_98
    s_sleep 4
    s_sub_u32 s80, s80, 1
    s_cmp_lg_u32 s80, 0
    s_cbranch_scc1 NG_97
NGD_98:
    v_mov_b32 v160, 0x24050
    v_mov_b32 v162, s94
    v_mov_b32 v163, s95
    ds_write_b64 v160, v[162:163]
    v_mov_b32 v160, 0x2404c
    v_mov_b32 v161, 1
    s_waitcnt lgkmcnt(0)
    s_mov_b64 exec, 1
    ds_add_u32 v160, v161
    s_mov_b64 exec, -1
C8_96:
    s_lshr_b32 s7, s64, 4
    s_lshl_b32 s7, s7, 16
    s_lshl_b32 s63, s60, 14
    s_add_u32 s7, s7, s63
    s_add_u32 s7, s7, 0x0
    v_lshl_add_u32 v4, v1, 4, s7
    s_and_b32 s7, s60, 1
    s_lshl_b32 s7, s7, 7
    v_lshlrev_b32 v3, 3, v1
    v_xor_b32 v3, s7, v3
    s_lshl_b32 s7, s60, 13
    s_add_u32 s7, s7, 0x18000
    v_add_u32 v3, s7, v3
    s_mov_b32 s44, s20
    s_and_b32 s45, s21, 0xffff
    s_mov_b32 s46, 0x1000000
    s_mov_b32 s47, 0x20000
    s_lshl_b32 s7, s64, 18
    s_lshl_b32 s65, s60, 10
    s_add_u32 s65, s65, s7
    s_add_u32 s65, s65, 196608
    s_lshl_b32 s7, s60, 6
    v_xor_b32 v12, s7, v2
    v_xor_b32 v13, 16, v12
    v_xor_b32 v14, 32, v12
    v_xor_b32 v15, 48, v12
    v_mov_b32 v160, 0x2404c
    s_mov_b32 s80, 1600000
LW_99:
    ds_read_b32 v161, v160
    s_waitcnt lgkmcnt(0)
    v_readfirstlane_b32 s79, v161
    s_cmp_ge_u32 s79, 1
    s_cbranch_scc1 LWD_100
    s_sleep 4
    s_sub_u32 s80, s80, 1
    s_cmp_lg_u32 s80, 0
    s_cbranch_scc1 LW_99
LWD_100:
    v_mov_b32 v160, 0x24050
    ds_read_b64 v[162:163], v160
    s_waitcnt lgkmcnt(0)
    v_readfirstlane_b32 s94, v162
    v_readfirstlane_b32 s95, v163
    v_mov_b32 v160, 0x24018
    s_mov_b32 s80, 1600000
LW_101:
    ds_read_b32 v161, v160
    s_waitcnt lgkmcnt(0)
    v_readfirstlane_b32 s79, v161
    s_cmp_ge_u32 s79, 8
    s_cbranch_scc1 LWD_102
    s_sleep 2
    s_sub_u32 s80, s80, 1
    s_cmp_lg_u32 s80, 0
    s_cbranch_scc1 LW_101
LWD_102:
    s_sleep 1
    s_mov_b32 s67, 4096
    s_mov_b32 s68, 8192
    s_mov_b32 s69, 12288
    buffer_load_dwordx4 v[96:99], v4, s[36:39], 0 offen offset:0 sc1
    buffer_load_dwordx4 v[100:103], v4, s[36:39], 0 offen offset:1024 sc1
    buffer_load_dwordx4 v[104:107], v4, s[36:39], 0 offen offset:2048 sc1
    buffer_load_dwordx4 v[108:111], v4, s[36:39], 0 offen offset:3072 sc1
    buffer_load_dwordx4 v[112:115], v4, s[36:39], s67 offen offset:0 sc1
    buffer_load_dwordx4 v[116:119], v4, s[36:39], s67 offen offset:1024 sc1
    buffer_load_dwordx4 v[120:123], v4, s[36:39], s67 offen offset:2048 sc1
    buffer_load_dwordx4 v[124:127], v4, s[36:39], s67 offen offset:3072 sc1
    buffer_load_dwordx4 v[128:131], v4, s[36:39], s68 offen offset:0 sc1
    buffer_load_dwordx4 v[132:135], v4, s[36:39], s68 offen offset:1024 sc1
    buffer_load_dwordx4 v[136:139], v4, s[36:39], s68 offen offset:2048 sc1
    buffer_load_dwordx4 v[140:143], v4, s[36:39], s68 offen offset:3072 sc1
    buffer_load_dwordx4 v[144:147], v4, s[36:39], s69 offen offset:0 sc1
    buffer_load_dwordx4 v[148:151], v4, s[36:39], s69 offen offset:1024 sc1
    buffer_load_dwordx4 v[152:155], v4, s[36:39], s69 offen offset:2048 sc1
    buffer_load_dwordx4 v[156:159], v4, s[36:39], s69 offen offset:3072 sc1
    s_mov_b32 s80, 200000
PS_103:
    s_waitcnt vmcnt(0)
    s_mov_b32 s78, 0
    v_cmp_ne_u64 vcc, s[94:95], v[98:99]
    s_cbranch_vccz PSS_105
    buffer_load_dwordx4 v[96:99], v4, s[36:39], 0 offen offset:0 sc1
    s_mov_b32 s78, 1
PSS_105:
    v_cmp_ne_u64 vcc, s[94:95], v[102:103]
    s_cbranch_vccz PSS_106
    buffer_load_dwordx4 v[100:103], v4, s[36:39], 0 offen offset:1024 sc1
    s_mov_b32 s78, 1
PSS_106:
    v_cmp_ne_u64 vcc, s[94:95], v[106:107]
    s_cbranch_vccz PSS_107
    buffer_load_dwordx4 v[104:107], v4, s[36:39], 0 offen offset:2048 sc1
    s_mov_b32 s78, 1
PSS_107:
    v_cmp_ne_u64 vcc, s[94:95], v[110:111]
    s_cbranch_vccz PSS_108
    buffer_load_dwordx4 v[108:111], v4, s[36:39], 0 offen offset:3072 sc1
    s_mov_b32 s78, 1
PSS_108:
    v_cmp_ne_u64 vcc, s[94:95], v[114:115]
    s_cbranch_vccz PSS_109
    buffer_load_dwordx4 v[112:115], v4, s[36:39], s67 offen offset:0 sc1
    s_mov_b32 s78, 1
PSS_109:
    v_cmp_ne_u64 vcc, s[94:95], v[118:119]
    s_cbranch_vccz PSS_110
    buffer_load_dwordx4 v[116:119], v4, s[36:39], s67 offen offset:1024 sc1
    s_mov_b32 s78, 1
PSS_110:
    v_cmp_ne_u64 vcc, s[94:95], v[122:123]
    s_cbranch_vccz PSS_111
    buffer_load_dwordx4 v[120:123], v4, s[36:39], s67 offen offset:2048 sc1
    s_mov_b32 s78, 1
PSS_111:
    v_cmp_ne_u64 vcc, s[94:95], v[126:127]
    s_cbranch_vccz PSS_112
    buffer_load_dwordx4 v[124:127], v4, s[36:39], s67 offen offset:3072 sc1
    s_mov_b32 s78, 1
PSS_112:
    v_cmp_ne_u64 vcc, s[94:95], v[130:131]
    s_cbranch_vccz PSS_113
    buffer_load_dwordx4 v[128:131], v4, s[36:39], s68 offen offset:0 sc1
    s_mov_b32 s78, 1
PSS_113:
    v_cmp_ne_u64 vcc, s[94:95], v[134:135]
    s_cbranch_vccz PSS_114
    buffer_load_dwordx4 v[132:135], v4, s[36:39], s68 offen offset:1024 sc1
    s_mov_b32 s78, 1
PSS_114:
    v_cmp_ne_u64 vcc, s[94:95], v[138:139]
    s_cbranch_vccz PSS_115
    buffer_load_dwordx4 v[136:139], v4, s[36:39], s68 offen offset:2048 sc1
    s_mov_b32 s78, 1
PSS_115:
    v_cmp_ne_u64 vcc, s[94:95], v[142:143]
    s_cbranch_vccz PSS_116
    buffer_load_dwordx4 v[140:143], v4, s[36:39], s68 offen offset:3072 sc1
    s_mov_b32 s78, 1
PSS_116:
    v_cmp_ne_u64 vcc, s[94:95], v[146:147]
    s_cbranch_vccz PSS_117
    buffer_load_dwordx4 v[144:147], v4, s[36:39], s69 offen offset:0 sc1
    s_mov_b32 s78, 1
PSS_117:
    v_cmp_ne_u64 vcc, s[94:95], v[150:151]
    s_cbranch_vccz PSS_118
    buffer_load_dwordx4 v[148:151], v4, s[36:39], s69 offen offset:1024 sc1
    s_mov_b32 s78, 1
PSS_118:
    v_cmp_ne_u64 vcc, s[94:95], v[154:155]
    s_cbranch_vccz PSS_119
    buffer_load_dwordx4 v[152:155], v4, s[36:39], s69 offen offset:2048 sc1
    s_mov_b32 s78, 1
PSS_119:
    v_cmp_ne_u64 vcc, s[94:95], v[158:159]
    s_cbranch_vccz PSS_120
    buffer_load_dwordx4 v[156:159], v4, s[36:39], s69 offen offset:3072 sc1
    s_mov_b32 s78, 1
PSS_120:
    s_cmp_eq_u32 s78, 0
    s_cbranch_scc1 PSD_104
    s_sub_u32 s80, s80, 1
    s_cmp_lg_u32 s80, 0
    s_cbranch_scc1 PS_103
    s_waitcnt vmcnt(0)
PSD_104:
    buffer_load_dwordx4 v[32:35], v12, s[44:47], s65 offen nt
    s_addk_i32 s65, 4096
    buffer_load_dwordx4 v[36:39], v13, s[44:47], s65 offen nt
    s_addk_i32 s65, 4096
    buffer_load_dwordx4 v[40:43], v14, s[44:47], s65 offen nt
    s_addk_i32 s65, 4096
    buffer_load_dwordx4 v[44:47], v15, s[44:47], s65 offen nt
    s_addk_i32 s65, 4096
    buffer_load_dwordx4 v[48:51], v12, s[44:47], s65 offen nt
    s_addk_i32 s65, 4096
    buffer_load_dwordx4 v[52:55], v13, s[44:47], s65 offen nt
    s_addk_i32 s65, 4096
    buffer_load_dwordx4 v[56:59], v14, s[44:47], s65 offen nt
    s_addk_i32 s65, 4096
    buffer_load_dwordx4 v[60:63], v15, s[44:47], s65 offen nt
    s_addk_i32 s65, 4096
    v_xor_b32 v6, 0x0, v3
    ds_write_b64 v6, v[96:97] offset:0
    ds_write_b64 v6, v[100:101] offset:512
    v_xor_b32 v7, 0x10, v3
    ds_write_b64 v7, v[104:105] offset:1024
    ds_write_b64 v7, v[108:109] offset:1536
    v_xor_b32 v6, 0x20, v3
    ds_write_b64 v6, v[112:113] offset:2048
    ds_write_b64 v6, v[116:117] offset:2560
    v_xor_b32 v7, 0x30, v3
    ds_write_b64 v7, v[120:121] offset:3072
    ds_write_b64 v7, v[124:125] offset:3584
    v_xor_b32 v6, 0x40, v3
    ds_write_b64 v6, v[128:129] offset:4096
    ds_write_b64 v6, v[132:133] offset:4608
    v_xor_b32 v7, 0x50, v3
    ds_write_b64 v7, v[136:137] offset:5120
    ds_write_b64 v7, v[140:141] offset:5632
    v_xor_b32 v6, 0x60, v3
    ds_write_b64 v6, v[144:145] offset:6144
    ds_write_b64 v6, v[148:149] offset:6656
    v_xor_b32 v7, 0x70, v3
    ds_write_b64 v7, v[152:153] offset:7168
    ds_write_b64 v7, v[156:157] offset:7680
L_CCUT:
    s_waitcnt lgkmcnt(0)
    s_barrier
    s_setprio 0
    s_barrier
    s_barrier
    buffer_load_dwordx4 v[64:67], v12, s[44:47], s65 offen nt
    s_addk_i32 s65, 4096
    buffer_load_dwordx4 v[68:71], v13, s[44:47], s65 offen nt
    s_addk_i32 s65, 4096
    buffer_load_dwordx4 v[72:75], v14, s[44:47], s65 offen nt
    s_addk_i32 s65, 4096
    buffer_load_dwordx4 v[76:79], v15, s[44:47], s65 offen nt
    s_addk_i32 s65, 4096
    buffer_load_dwordx4 v[80:83], v12, s[44:47], s65 offen nt
    s_addk_i32 s65, 4096
    buffer_load_dwordx4 v[84:87], v13, s[44:47], s65 offen nt
    s_addk_i32 s65, 4096
    buffer_load_dwordx4 v[88:91], v14, s[44:47], s65 offen nt
    s_addk_i32 s65, 4096
    buffer_load_dwordx4 v[92:95], v15, s[44:47], s65 offen nt
    s_addk_i32 s65, 4096
    s_barrier
    s_barrier
    s_barrier
    s_setprio 3
    s_lshl_b32 s7, s60, 10
    v_add_u32 v3, s7, v2
    s_waitcnt vmcnt(15)
    ds_write_b128 v3, v[32:35] offset:0
    s_waitcnt vmcnt(14)
    ds_write_b128 v3, v[36:39] offset:4096
    s_waitcnt vmcnt(13)
    ds_write_b128 v3, v[40:43] offset:8192
    s_waitcnt vmcnt(12)
    ds_write_b128 v3, v[44:47] offset:12288
    s_waitcnt vmcnt(11)
    ds_write_b128 v3, v[48:51] offset:16384
    s_waitcnt vmcnt(10)
    ds_write_b128 v3, v[52:55] offset:20480
    s_waitcnt vmcnt(9)
    ds_write_b128 v3, v[56:59] offset:24576
    s_waitcnt vmcnt(8)
    ds_write_b128 v3, v[60:63] offset:28672
    s_waitcnt vmcnt(7)
    ds_write_b128 v3, v[64:67] offset:32768
    s_waitcnt vmcnt(6)
    ds_write_b128 v3, v[68:71] offset:36864
    s_waitcnt vmcnt(5)
    ds_write_b128 v3, v[72:75] offset:40960
    s_waitcnt vmcnt(4)
    ds_write_b128 v3, v[76:79] offset:45056
    s_waitcnt vmcnt(3)
    ds_write_b128 v3, v[80:83] offset:49152
    s_waitcnt vmcnt(2)
    ds_write_b128 v3, v[84:87] offset:53248
    s_waitcnt vmcnt(1)
    ds_write_b128 v3, v[88:91] offset:57344
    s_waitcnt vmcnt(0)
    ds_write_b128 v3, v[92:95] offset:61440
    s_waitcnt lgkmcnt(0)
    s_endpgm
.p2align 12
LT_U1:
    s_branch LR_U1
L_U1:
    s_mov_b32 s48, s26
    s_and_b32 s49, s27, 0xffff
    s_mov_b32 s50, 0x400000
    s_mov_b32 s51, 0x20000
    v_lshrrev_b32 v162, 4, v1
    v_lshlrev_b32 v2, 16, v162
    v_and_b32 v160, 15, v1
    v_lshl_add_u32 v2, v160, 4, v2
    s_lshl_b32 s7, s6, 8
    v_add_u32 v2, s7, v2
    s_lshl_b32 s70, s3, 19
    s_waitcnt vmcnt(2)
    buffer_load_dwordx4 v[8:11], v2, s[48:51], s70 offen nt
    s_add_u32 s70, s70, 8192
    s_waitcnt vmcnt(2)
    buffer_load_dwordx4 v[12:15], v2, s[48:51], s70 offen nt
    s_add_u32 s70, s70, 8192
    s_waitcnt vmcnt(2)
    buffer_load_dwordx4 v[16:19], v2, s[48:51], s70 offen nt
    s_add_u32 s70, s70, 8192
    s_waitcnt vmcnt(2)
    buffer_load_dwordx4 v[20:23], v2, s[48:51], s70 offen nt
    s_add_u32 s70, s70, 8192
    s_waitcnt vmcnt(2)
    buffer_load_dwordx4 v[24:27], v2, s[48:51], s70 offen nt
    s_add_u32 s70, s70, 8192
    s_waitcnt vmcnt(2)
    buffer_load_dwordx4 v[28:31], v2, s[48:51], s70 offen nt
    s_add_u32 s70, s70, 8192
    s_waitcnt vmcnt(2)
    buffer_load_dwordx4 v[32:35], v2, s[48:51], s70 offen nt
    s_add_u32 s70, s70, 8192
    s_waitcnt vmcnt(2)
    buffer_load_dwordx4 v[36:39], v2, s[48:51], s70 offen nt
    s_add_u32 s70, s70, 204800
    s_waitcnt vmcnt(2)
    buffer_load_dwordx4 v[104:107], v2, s[48:51], s70 offen nt
    s_add_u32 s70, s70, 8192
    s_waitcnt vmcnt(2)
    buffer_load_dwordx4 v[108:111], v2, s[48:51], s70 offen nt
    s_add_u32 s70, s70, 8192
    s_waitcnt vmcnt(2)
    buffer_load_dwordx4 v[112:115], v2, s[48:51], s70 offen nt
    s_add_u32 s70, s70, 8192
    s_waitcnt vmcnt(2)
    buffer_load_dwordx4 v[116:119], v2, s[48:51], s70 offen nt
    s_add_u32 s70, s70, 8192
    s_waitcnt vmcnt(2)
    buffer_load_dwordx4 v[120:123], v2, s[48:51], s70 offen nt
    s_add_u32 s70, s70, 8192
    s_waitcnt vmcnt(2)
    buffer_load_dwordx4 v[124:127], v2, s[48:51], s70 offen nt
    s_add_u32 s70, s70, 8192
    s_waitcnt vmcnt(2)
    buffer_load_dwordx4 v[128:131], v2, s[48:51], s70 offen nt
    s_add_u32 s70, s70, 8192
    s_waitcnt vmcnt(2)
    buffer_load_dwordx4 v[132:135], v2, s[48:51], s70 offen nt
    s_add_u32 s70, s70, 204800
    v_lshlrev_b32 v3, 4, v1
    v_add_u32 v3, 0x24800, v3
    v_lshrrev_b32 v4, 1, v160
    v_lshlrev_b32 v4, 18, v4
    v_lshl_add_u32 v4, v162, 4, v4
    v_and_b32 v163, 1, v1
    v_lshl_add_u32 v4, v163, 6, v4
    v_cmp_eq_u32 s[86:87], 1, v163
    s_lshl_b32 s7, s3, 5
    s_add_u32 s7, s7, s6
    s_lshl_b32 s7, s7, 7
    s_add_u32 s7, s7, 0x500000
    v_add_u32 v4, s7, v4
    s_lshl_b32 s7, s3, 11
    s_add_u32 s7, s7, 0x10000
    v_lshl_add_u32 v5, v1, 5, s7
    v_perm_b32 v40, v12, v8, s92
    v_perm_b32 v41, v20, v16, s92
    v_perm_b32 v42, v28, v24, s92
    v_perm_b32 v43, v36, v32, s92
    v_perm_b32 v44, v12, v8, s93
    v_perm_b32 v45, v20, v16, s93
    v_perm_b32 v46, v28, v24, s93
    v_perm_b32 v47, v36, v32, s93
    v_perm_b32 v48, v13, v9, s92
    v_perm_b32 v49, v21, v17, s92
    v_perm_b32 v50, v29, v25, s92
    v_perm_b32 v51, v37, v33, s92
    v_perm_b32 v52, v13, v9, s93
    v_perm_b32 v53, v21, v17, s93
    v_perm_b32 v54, v29, v25, s93
    v_perm_b32 v55, v37, v33, s93
    v_perm_b32 v56, v14, v10, s92
    v_perm_b32 v57, v22, v18, s92
    v_perm_b32 v58, v30, v26, s92
    v_perm_b32 v59, v38, v34, s92
    v_perm_b32 v60, v14, v10, s93
    v_perm_b32 v61, v22, v18, s93
    v_perm_b32 v62, v30, v26, s93
    v_perm_b32 v63, v38, v34, s93
    v_perm_b32 v64, v15, v11, s92
    v_perm_b32 v65, v23, v19, s92
    v_perm_b32 v66, v31, v27, s92
    v_perm_b32 v67, v39, v35, s92
    v_perm_b32 v68, v15, v11, s93
    v_perm_b32 v69, v23, v19, s93
    v_perm_b32 v70, v31, v27, s93
    v_perm_b32 v71, v39, v35, s93
    s_waitcnt vmcnt(0)
    v_perm_b32 v72, v108, v104, s92
    v_perm_b32 v73, v116, v112, s92
    v_perm_b32 v74, v124, v120, s92
    v_perm_b32 v75, v132, v128, s92
    v_perm_b32 v76, v108, v104, s93
    v_perm_b32 v77, v116, v112, s93
    v_perm_b32 v78, v124, v120, s93
    v_perm_b32 v79, v132, v128, s93
    v_perm_b32 v80, v109, v105, s92
    v_perm_b32 v81, v117, v113, s92
    v_perm_b32 v82, v125, v121, s92
    v_perm_b32 v83, v133, v129, s92
    v_perm_b32 v84, v109, v105, s93
    v_perm_b32 v85, v117, v113, s93
    v_perm_b32 v86, v125, v121, s93
    v_perm_b32 v87, v133, v129, s93
    v_perm_b32 v88, v110, v106, s92
    v_perm_b32 v89, v118, v114, s92
    v_perm_b32 v90, v126, v122, s92
    v_perm_b32 v91, v134, v130, s92
    v_perm_b32 v92, v110, v106, s93
    v_perm_b32 v93, v118, v114, s93
    v_perm_b32 v94, v126, v122, s93
    v_perm_b32 v95, v134, v130, s93
    v_perm_b32 v96, v111, v107, s92
    v_perm_b32 v97, v119, v115, s92
    v_perm_b32 v98, v127, v123, s92
    v_perm_b32 v99, v135, v131, s92
    v_perm_b32 v100, v111, v107, s93
    v_perm_b32 v101, v119, v115, s93
    v_perm_b32 v102, v127, v123, s93
    v_perm_b32 v103, v135, v131, s93
    v_mov_b32 v160, 0x2404c
    s_mov_b32 s80, 1600000
LW_47:
    ds_read_b32 v161, v160
    s_waitcnt lgkmcnt(0)
    v_readfirstlane_b32 s79, v161
    s_cmp_ge_u32 s79, 1
    s_cbranch_scc1 LWD_48
    s_sleep 2
    s_sub_u32 s80, s80, 1
    s_cmp_lg_u32 s80, 0
    s_cbranch_scc1 LW_47
LWD_48:
    v_mov_b32 v160, 0x24050
    ds_read_b64 v[162:163], v160
    s_waitcnt lgkmcnt(0)
    v_readfirstlane_b32 s94, v162
    v_readfirstlane_b32 s95, v163
    v_mov_b32 v160, 0x2401c
    s_mov_b32 s80, 1600000
LW_49:
    ds_read_b32 v161, v160
    s_waitcnt lgkmcnt(0)
    v_readfirstlane_b32 s79, v161
    s_cmp_ge_u32 s79, 1
    s_cbranch_scc1 LWD_50
    s_sleep 4
    s_sub_u32 s80, s80, 1
    s_cmp_lg_u32 s80, 0
    s_cbranch_scc1 LW_49
LWD_50:
    s_setprio 3
    s_mov_b64 s[88:89], 0
    s_mov_b32 s80, 1600000
UM_51:
    ds_read_b128 v[136:139], v3
    s_waitcnt lgkmcnt(0)
    v_cmp_ne_u64 vcc, s[94:95], v[138:139]
    s_or_b64 s[90:91], vcc, s[88:89]
    s_and_b32 s7, s90, 0x5555
    s_cbranch_scc1 UMS_53
    s_mov_b32 s70, 0
    buffer_load_dwordx4 v[8:11], v4, s[36:39], s70 offen sc1
    s_or_b32 s88, s88, 0x5555
UMS_53:
    s_and_b32 s7, s90, 0x55550000
    s_cbranch_scc1 UMS_54
    s_mov_b32 s70, 32768
    buffer_load_dwordx4 v[12:15], v4, s[36:39], s70 offen sc1
    s_or_b32 s88, s88, 0x55550000
UMS_54:
    s_and_b32 s7, s91, 0x5555
    s_cbranch_scc1 UMS_55
    s_mov_b32 s70, 65536
    buffer_load_dwordx4 v[16:19], v4, s[36:39], s70 offen sc1
    s_or_b32 s89, s89, 0x5555
UMS_55:
    s_and_b32 s7, s91, 0x55550000
    s_cbranch_scc1 UMS_56
    s_mov_b32 s70, 98304
    buffer_load_dwordx4 v[20:23], v4, s[36:39], s70 offen sc1
    s_or_b32 s89, s89, 0x55550000
UMS_56:
    s_and_b32 s7, s90, 0xaaaa
    s_cbranch_scc1 UMS_57
    s_mov_b32 s70, 131072
    buffer_load_dwordx4 v[24:27], v4, s[36:39], s70 offen sc1
    s_or_b32 s88, s88, 0xaaaa
UMS_57:
    s_and_b32 s7, s90, 0xaaaa0000
    s_cbranch_scc1 UMS_58
    s_mov_b32 s70, 163840
    buffer_load_dwordx4 v[28:31], v4, s[36:39], s70 offen sc1
    s_or_b32 s88, s88, 0xaaaa0000
UMS_58:
    s_and_b32 s7, s91, 0xaaaa
    s_cbranch_scc1 UMS_59
    s_mov_b32 s70, 196608
    buffer_load_dwordx4 v[32:35], v4, s[36:39], s70 offen sc1
    s_or_b32 s89, s89, 0xaaaa
UMS_59:
    s_and_b32 s7, s91, 0xaaaa0000
    s_cbranch_scc1 UMS_60
    s_mov_b32 s70, 229376
    buffer_load_dwordx4 v[36:39], v4, s[36:39], s70 offen sc1
    s_or_b32 s89, s89, 0xaaaa0000
UMS_60:
    s_cbranch_vccz UMD_52
    s_sleep 1
    s_sub_u32 s80, s80, 1
    s_cmp_lg_u32 s80, 0
    s_cbranch_scc1 UM_51
UMD_52:
    v_max_f32_dpp v138, v136, v136 quad_perm:[1,0,3,2] row_mask:0xf bank_mask:0xf
    s_nop 1
    v_max_f32_dpp v138, v138, v138 quad_perm:[2,3,0,1] row_mask:0xf bank_mask:0xf
    v_mov_b32 v139, v138
    s_nop 1
    v_permlane32_swap_b32 v138, v139
    v_max_f32 v138, v138, v139
    v_mov_b32 v139, v138
    s_nop 1
    v_permlane16_swap_b32 v138, v139
    v_max_f32 v138, v138, v139
    v_sub_f32 v136, v136, v138
    v_exp_f32 v136, v136
    s_nop 0
    v_mul_f32 v137, v137, v136
    s_nop 1
    v_add_f32_dpp v137, v137, v137 quad_perm:[1,0,3,2] row_mask:0xf bank_mask:0xf
    s_nop 1
    v_add_f32_dpp v137, v137, v137 quad_perm:[2,3,0,1] row_mask:0xf bank_mask:0xf
    v_mov_b32 v138, v137
    s_nop 1
    v_permlane32_swap_b32 v137, v138
    v_add_f32 v137, v137, v138
    v_mov_b32 v138, v137
    s_nop 1
    v_permlane16_swap_b32 v137, v138
    v_add_f32 v137, v137, v138
    v_rcp_f32 v137, v137
    s_nop 0
    v_mul_f32 v136, v136, v137
    v_mov_b32 v137, v136
    s_nop 1
    v_permlane16_swap_b32 v136, v137
    v_mov_b32 v138, v136
    v_mov_b32 v139, v137
    s_nop 0
    v_permlane32_swap_b32 v136, v138
    v_permlane32_swap_b32 v137, v139
    s_nop 0
    v_mov_b32_dpp v148, v136 quad_perm:[0,0,2,2] row_mask:0xf bank_mask:0xf
    v_mov_b32_dpp v149, v137 quad_perm:[0,0,2,2] row_mask:0xf bank_mask:0xf
    v_mov_b32_dpp v150, v138 quad_perm:[0,0,2,2] row_mask:0xf bank_mask:0xf
    v_mov_b32_dpp v151, v139 quad_perm:[0,0,2,2] row_mask:0xf bank_mask:0xf
    v_mov_b32_dpp v152, v136 quad_perm:[1,1,3,3] row_mask:0xf bank_mask:0xf
    v_mov_b32_dpp v153, v137 quad_perm:[1,1,3,3] row_mask:0xf bank_mask:0xf
    v_mov_b32_dpp v154, v138 quad_perm:[1,1,3,3] row_mask:0xf bank_mask:0xf
    v_mov_b32_dpp v155, v139 quad_perm:[1,1,3,3] row_mask:0xf bank_mask:0xf
    s_waitcnt vmcnt(0)
    v_lshlrev_b32 v104, 16, v8
    v_and_b32 v105, 0xffff0000, v8
    v_lshlrev_b32 v106, 16, v9
    v_and_b32 v107, 0xffff0000, v9
    v_lshlrev_b32 v108, 16, v10
    v_and_b32 v109, 0xffff0000, v10
    v_lshlrev_b32 v110, 16, v11
    v_and_b32 v111, 0xffff0000, v11
    v_mul_f32 v120, v104, v148
    v_mul_f32 v121, v105, v148
    v_mul_f32 v122, v106, v148
    v_mul_f32 v123, v107, v148
    v_mul_f32 v124, v108, v148
    v_mul_f32 v125, v109, v148
    v_mul_f32 v126, v110, v148
    v_mul_f32 v127, v111, v148
    v_lshlrev_b32 v112, 16, v12
    v_and_b32 v113, 0xffff0000, v12
    v_lshlrev_b32 v114, 16, v13
    v_and_b32 v115, 0xffff0000, v13
    v_lshlrev_b32 v116, 16, v14
    v_and_b32 v117, 0xffff0000, v14
    v_lshlrev_b32 v118, 16, v15
    v_and_b32 v119, 0xffff0000, v15
    v_fmac_f32 v120, v112, v149
    v_fmac_f32 v121, v113, v149
    v_fmac_f32 v122, v114, v149
    v_fmac_f32 v123, v115, v149
    v_fmac_f32 v124, v116, v149
    v_fmac_f32 v125, v117, v149
    v_fmac_f32 v126, v118, v149
    v_fmac_f32 v127, v119, v149
    v_lshlrev_b32 v104, 16, v16
    v_and_b32 v105, 0xffff0000, v16
    v_lshlrev_b32 v106, 16, v17
    v_and_b32 v107, 0xffff0000, v17
    v_lshlrev_b32 v108, 16, v18
    v_and_b32 v109, 0xffff0000, v18
    v_lshlrev_b32 v110, 16, v19
    v_and_b32 v111, 0xffff0000, v19
    v_fmac_f32 v120, v104, v150
    v_fmac_f32 v121, v105, v150
    v_fmac_f32 v122, v106, v150
    v_fmac_f32 v123, v107, v150
    v_fmac_f32 v124, v108, v150
    v_fmac_f32 v125, v109, v150
    v_fmac_f32 v126, v110, v150
    v_fmac_f32 v127, v111, v150
    v_lshlrev_b32 v112, 16, v20
    v_and_b32 v113, 0xffff0000, v20
    v_lshlrev_b32 v114, 16, v21
    v_and_b32 v115, 0xffff0000, v21
    v_lshlrev_b32 v116, 16, v22
    v_and_b32 v117, 0xffff0000, v22
    v_lshlrev_b32 v118, 16, v23
    v_and_b32 v119, 0xffff0000, v23
    v_fmac_f32 v120, v112, v151
    v_fmac_f32 v121, v113, v151
    v_fmac_f32 v122, v114, v151
    v_fmac_f32 v123, v115, v151
    v_fmac_f32 v124, v116, v151
    v_fmac_f32 v125, v117, v151
    v_fmac_f32 v126, v118, v151
    v_fmac_f32 v127, v119, v151
    v_lshlrev_b32 v104, 16, v24
    v_and_b32 v105, 0xffff0000, v24
    v_lshlrev_b32 v106, 16, v25
    v_and_b32 v107, 0xffff0000, v25
    v_lshlrev_b32 v108, 16, v26
    v_and_b32 v109, 0xffff0000, v26
    v_lshlrev_b32 v110, 16, v27
    v_and_b32 v111, 0xffff0000, v27
    v_fmac_f32 v120, v104, v152
    v_fmac_f32 v121, v105, v152
    v_fmac_f32 v122, v106, v152
    v_fmac_f32 v123, v107, v152
    v_fmac_f32 v124, v108, v152
    v_fmac_f32 v125, v109, v152
    v_fmac_f32 v126, v110, v152
    v_fmac_f32 v127, v111, v152
    v_lshlrev_b32 v112, 16, v28
    v_and_b32 v113, 0xffff0000, v28
    v_lshlrev_b32 v114, 16, v29
    v_and_b32 v115, 0xffff0000, v29
    v_lshlrev_b32 v116, 16, v30
    v_and_b32 v117, 0xffff0000, v30
    v_lshlrev_b32 v118, 16, v31
    v_and_b32 v119, 0xffff0000, v31
    v_fmac_f32 v120, v112, v153
    v_fmac_f32 v121, v113, v153
    v_fmac_f32 v122, v114, v153
    v_fmac_f32 v123, v115, v153
    v_fmac_f32 v124, v116, v153
    v_fmac_f32 v125, v117, v153
    v_fmac_f32 v126, v118, v153
    v_fmac_f32 v127, v119, v153
    v_lshlrev_b32 v104, 16, v32
    v_and_b32 v105, 0xffff0000, v32
    v_lshlrev_b32 v106, 16, v33
    v_and_b32 v107, 0xffff0000, v33
    v_lshlrev_b32 v108, 16, v34
    v_and_b32 v109, 0xffff0000, v34
    v_lshlrev_b32 v110, 16, v35
    v_and_b32 v111, 0xffff0000, v35
    v_fmac_f32 v120, v104, v154
    v_fmac_f32 v121, v105, v154
    v_fmac_f32 v122, v106, v154
    v_fmac_f32 v123, v107, v154
    v_fmac_f32 v124, v108, v154
    v_fmac_f32 v125, v109, v154
    v_fmac_f32 v126, v110, v154
    v_fmac_f32 v127, v111, v154
    v_lshlrev_b32 v112, 16, v36
    v_and_b32 v113, 0xffff0000, v36
    v_lshlrev_b32 v114, 16, v37
    v_and_b32 v115, 0xffff0000, v37
    v_lshlrev_b32 v116, 16, v38
    v_and_b32 v117, 0xffff0000, v38
    v_lshlrev_b32 v118, 16, v39
    v_and_b32 v119, 0xffff0000, v39
    v_fmac_f32 v120, v112, v155
    v_fmac_f32 v121, v113, v155
    v_fmac_f32 v122, v114, v155
    v_fmac_f32 v123, v115, v155
    v_fmac_f32 v124, v116, v155
    v_fmac_f32 v125, v117, v155
    v_fmac_f32 v126, v118, v155
    v_fmac_f32 v127, v119, v155
    v_cvt_pk_bf16_f32 v128, v120, v121
    v_cvt_pk_bf16_f32 v129, v122, v123
    v_cvt_pk_bf16_f32 v130, v124, v125
    v_cvt_pk_bf16_f32 v131, v126, v127
    v_cndmask_b32 v140, v128, 0, s[86:87]
    v_cndmask_b32 v144, 0, v128, s[86:87]
    v_cndmask_b32 v141, v129, 0, s[86:87]
    v_cndmask_b32 v145, 0, v129, s[86:87]
    v_cndmask_b32 v142, v130, 0, s[86:87]
    v_cndmask_b32 v146, 0, v130, s[86:87]
    v_cndmask_b32 v143, v131, 0, s[86:87]
    v_cndmask_b32 v147, 0, v131, s[86:87]
    s_nop 0
    v_mfma_f32_16x16x32_bf16 v[8:11], v[140:143], v[40:43], 0
    v_mfma_f32_16x16x32_bf16 v[12:15], v[140:143], v[44:47], 0
    v_mfma_f32_16x16x32_bf16 v[16:19], v[140:143], v[48:51], 0
    v_mfma_f32_16x16x32_bf16 v[20:23], v[140:143], v[52:55], 0
    v_mfma_f32_16x16x32_bf16 v[24:27], v[140:143], v[56:59], 0
    v_mfma_f32_16x16x32_bf16 v[28:31], v[140:143], v[60:63], 0
    v_mfma_f32_16x16x32_bf16 v[32:35], v[140:143], v[64:67], 0
    v_mfma_f32_16x16x32_bf16 v[36:39], v[140:143], v[68:71], 0
    v_mfma_f32_16x16x32_bf16 v[8:11], v[144:147], v[72:75], v[8:11]
    v_mfma_f32_16x16x32_bf16 v[12:15], v[144:147], v[76:79], v[12:15]
    v_mfma_f32_16x16x32_bf16 v[16:19], v[144:147], v[80:83], v[16:19]
    v_mfma_f32_16x16x32_bf16 v[20:23], v[144:147], v[84:87], v[20:23]
    v_mfma_f32_16x16x32_bf16 v[24:27], v[144:147], v[88:91], v[24:27]
    v_mfma_f32_16x16x32_bf16 v[28:31], v[144:147], v[92:95], v[28:31]
    v_mfma_f32_16x16x32_bf16 v[32:35], v[144:147], v[96:99], v[32:35]
    v_mfma_f32_16x16x32_bf16 v[36:39], v[144:147], v[100:103], v[36:39]
    s_nop 0
    v_add_f32 v8, v8, v10
    v_add_f32 v9, v9, v11
    v_add_f32 v12, v12, v14
    v_add_f32 v13, v13, v15
    v_add_f32 v16, v16, v18
    v_add_f32 v17, v17, v19
    v_add_f32 v20, v20, v22
    v_add_f32 v21, v21, v23
    v_add_f32 v24, v24, v26
    v_add_f32 v25, v25, v27
    v_add_f32 v28, v28, v30
    v_add_f32 v29, v29, v31
    v_add_f32 v32, v32, v34
    v_add_f32 v33, v33, v35
    v_add_f32 v36, v36, v38
    v_add_f32 v37, v37, v39
    v_add_f32 v104, v8, v9
    v_add_f32 v105, v12, v13
    v_add_f32 v106, v16, v17
    v_add_f32 v107, v20, v21
    v_add_f32 v108, v24, v25
    v_add_f32 v109, v28, v29
    v_add_f32 v110, v32, v33
    v_add_f32 v111, v36, v37
    ds_write_b128 v5, v[104:107]
    ds_write_b128 v5, v[108:111] offset:16
    v_and_b32 v160, 31, v1
    s_lshl_b32 s7, s3, 8
    s_add_u32 s7, s7, 0x10000
    v_lshl_add_u32 v5, v160, 3, s7
    s_lshl_b32 s7, s3, 7
    s_add_u32 s7, s7, 0x24400
    v_lshl_add_u32 v4, v160, 2, s7
    s_waitcnt lgkmcnt(0)
    s_barrier
    ds_read_b64 v[8:9], v5 offset:0
    ds_read_b64 v[10:11], v5 offset:2048
    ds_read_b64 v[12:13], v5 offset:4096
    ds_read_b64 v[14:15], v5 offset:6144
    ds_read_b64 v[16:17], v5 offset:8192
    ds_read_b64 v[18:19], v5 offset:10240
    ds_read_b64 v[20:21], v5 offset:12288
    ds_read_b64 v[22:23], v5 offset:14336
    s_waitcnt lgkmcnt(0)
    v_add_f32 v8, v8, v16
    v_add_f32 v9, v9, v17
    v_add_f32 v10, v10, v18
    v_add_f32 v11, v11, v19
    v_add_f32 v12, v12, v20
    v_add_f32 v13, v13, v21
    v_add_f32 v14, v14, v22
    v_add_f32 v15, v15, v23
    v_add_f32 v8, v8, v12
    v_add_f32 v9, v9, v13
    v_add_f32 v10, v10, v14
    v_add_f32 v11, v11, v15
    v_add_f32 v8, v8, v10
    v_add_f32 v9, v9, v11
    v_cvt_pk_bf16_f32 v8, v8, v9
    ds_write_b32 v4, v8
    s_waitcnt lgkmcnt(0)
    s_barrier
    s_endpgm
.p2align 12
LT_W2R:
    s_branch LR_W2R
L_W2R:
    s_cmp_lt_u32 s5, 4
    s_cselect_b32 s72, s28, s16
    s_cselect_b32 s73, s29, s17
    s_mov_b32 s56, s72
    s_and_b32 s57, s73, 0xffff
    s_mov_b32 s58, 0x400000
    s_mov_b32 s59, 0x20000
    v_lshrrev_b32 v4, 4, v1
    v_lshlrev_b32 v2, 13, v4
    v_and_b32 v4, 15, v1
    v_lshl_add_u32 v2, v4, 4, v2
    s_lshl_b32 s7, s6, 17
    s_lshl_b32 s70, s62, 8
    s_add_u32 s7, s7, s70
    v_add_u32 v2, s7, v2
    v_lshrrev_b32 v3, 4, v1
    v_lshlrev_b32 v3, 16, v3
    v_bfe_u32 v4, v1, 3, 1
    v_lshl_add_u32 v3, v4, 13, v3
    v_and_b32 v4, 7, v1
    v_lshl_add_u32 v3, v4, 4, v3
    s_cmp_lt_u32 s5, 4
    s_cselect_b32 s7, 0x800, 0x0
    s_add_u32 s7, s7, s6
    s_lshl_b32 s7, s7, 7
    s_add_u32 s7, s7, 0x100000
    v_add_u32 v3, s7, v3
    s_lshl_b32 s7, s62, 14
    v_add_u32 v3, s7, v3
    s_waitcnt vmcnt(0)
    v_mov_b32 v4, 0x24014
    v_mov_b32 v5, 1
    s_waitcnt lgkmcnt(0)
    s_mov_b64 exec, 1
    ds_add_u32 v4, v5
    s_mov_b64 exec, -1
    s_mov_b32 s70, 0
    v_mov_b32 v4, 0x24048
    s_mov_b32 s80, 1600000
LW_65:
    ds_read_b32 v5, v4
    s_waitcnt lgkmcnt(0)
    v_readfirstlane_b32 s79, v5
    s_cmp_ge_u32 s79, 4
    s_cbranch_scc1 LWD_66
    s_sleep 4
    s_sub_u32 s80, s80, 1
    s_cmp_lg_u32 s80, 0
    s_cbranch_scc1 LW_65
LWD_66:
    s_cmp_lt_u32 s5, 4
    s_cbranch_scc1 S2U_63
    s_sleep 36
    s_sleep 36
    s_sleep 36
    buffer_load_dwordx4 v[40:43], v2, s[56:59], s70 offen offset:0 nt
    buffer_load_dwordx4 v[44:47], v2, s[56:59], s70 offen offset:1024 nt
    buffer_load_dwordx4 v[48:51], v2, s[56:59], s70 offen offset:2048 nt
    buffer_load_dwordx4 v[52:55], v2, s[56:59], s70 offen offset:3072 nt
    s_add_u32 s70, s70, 4096
    s_waitcnt vmcnt(0)
    buffer_load_dwordx4 v[56:59], v2, s[56:59], s70 offen offset:0 nt
    buffer_load_dwordx4 v[60:63], v2, s[56:59], s70 offen offset:1024 nt
    buffer_load_dwordx4 v[64:67], v2, s[56:59], s70 offen offset:2048 nt
    buffer_load_dwordx4 v[68:71], v2, s[56:59], s70 offen offset:3072 nt
    s_add_u32 s70, s70, 28672
    s_waitcnt vmcnt(0)
    buffer_load_dwordx4 v[72:75], v2, s[56:59], s70 offen offset:0 nt
    buffer_load_dwordx4 v[76:79], v2, s[56:59], s70 offen offset:1024 nt
    buffer_load_dwordx4 v[80:83], v2, s[56:59], s70 offen offset:2048 nt
    buffer_load_dwordx4 v[84:87], v2, s[56:59], s70 offen offset:3072 nt
    s_add_u32 s70, s70, 4096
    s_waitcnt vmcnt(0)
    buffer_load_dwordx4 v[88:91], v2, s[56:59], s70 offen offset:0 nt
    buffer_load_dwordx4 v[92:95], v2, s[56:59], s70 offen offset:1024 nt
    buffer_load_dwordx4 v[96:99], v2, s[56:59], s70 offen offset:2048 nt
    buffer_load_dwordx4 v[100:103], v2, s[56:59], s70 offen offset:3072 nt
    s_add_u32 s70, s70, 28672
    s_waitcnt vmcnt(0)
    buffer_load_dwordx4 v[104:107], v2, s[56:59], s70 offen offset:0 nt
    buffer_load_dwordx4 v[108:111], v2, s[56:59], s70 offen offset:1024 nt
    buffer_load_dwordx4 v[112:115], v2, s[56:59], s70 offen offset:2048 nt
    buffer_load_dwordx4 v[116:119], v2, s[56:59], s70 offen offset:3072 nt
    s_add_u32 s70, s70, 4096
    s_waitcnt vmcnt(0)
    buffer_load_dwordx4 v[120:123], v2, s[56:59], s70 offen offset:0 nt
    buffer_load_dwordx4 v[124:127], v2, s[56:59], s70 offen offset:1024 nt
    buffer_load_dwordx4 v[128:131], v2, s[56:59], s70 offen offset:2048 nt
    buffer_load_dwordx4 v[132:135], v2, s[56:59], s70 offen offset:3072 nt
    s_add_u32 s70, s70, 28672
    s_waitcnt vmcnt(0)
    buffer_load_dwordx4 v[136:139], v2, s[56:59], s70 offen offset:0 nt
    buffer_load_dwordx4 v[140:143], v2, s[56:59], s70 offen offset:1024 nt
    buffer_load_dwordx4 v[144:147], v2, s[56:59], s70 offen offset:2048 nt
    buffer_load_dwordx4 v[148:151], v2, s[56:59], s70 offen offset:3072 nt
    s_add_u32 s70, s70, 4096
    s_waitcnt vmcnt(0)
    buffer_load_dwordx4 v[152:155], v2, s[56:59], s70 offen offset:0 nt
    buffer_load_dwordx4 v[156:159], v2, s[56:59], s70 offen offset:1024 nt
    buffer_load_dwordx4 v[160:163], v2, s[56:59], s70 offen offset:2048 nt
    buffer_load_dwordx4 v[164:167], v2, s[56:59], s70 offen offset:3072 nt
    s_add_u32 s70, s70, 28672
    s_waitcnt vmcnt(0)
    s_branch S2J_64
S2U_63:
    buffer_load_dwordx4 v[40:43], v2, s[56:59], s70 offen offset:0 nt
    buffer_load_dwordx4 v[44:47], v2, s[56:59], s70 offen offset:1024 nt
    buffer_load_dwordx4 v[48:51], v2, s[56:59], s70 offen offset:2048 nt
    buffer_load_dwordx4 v[52:55], v2, s[56:59], s70 offen offset:3072 nt
    s_add_u32 s70, s70, 4096
    s_waitcnt vmcnt(2)
    buffer_load_dwordx4 v[56:59], v2, s[56:59], s70 offen offset:0 nt
    buffer_load_dwordx4 v[60:63], v2, s[56:59], s70 offen offset:1024 nt
    buffer_load_dwordx4 v[64:67], v2, s[56:59], s70 offen offset:2048 nt
    buffer_load_dwordx4 v[68:71], v2, s[56:59], s70 offen offset:3072 nt
    s_add_u32 s70, s70, 28672
    s_waitcnt vmcnt(2)
    buffer_load_dwordx4 v[72:75], v2, s[56:59], s70 offen offset:0 nt
    buffer_load_dwordx4 v[76:79], v2, s[56:59], s70 offen offset:1024 nt
    buffer_load_dwordx4 v[80:83], v2, s[56:59], s70 offen offset:2048 nt
    buffer_load_dwordx4 v[84:87], v2, s[56:59], s70 offen offset:3072 nt
    s_add_u32 s70, s70, 4096
    s_waitcnt vmcnt(2)
    buffer_load_dwordx4 v[88:91], v2, s[56:59], s70 offen offset:0 nt
    buffer_load_dwordx4 v[92:95], v2, s[56:59], s70 offen offset:1024 nt
    buffer_load_dwordx4 v[96:99], v2, s[56:59], s70 offen offset:2048 nt
    buffer_load_dwordx4 v[100:103], v2, s[56:59], s70 offen offset:3072 nt
    s_add_u32 s70, s70, 28672
    s_waitcnt vmcnt(2)
    buffer_load_dwordx4 v[104:107], v2, s[56:59], s70 offen offset:0 nt
    buffer_load_dwordx4 v[108:111], v2, s[56:59], s70 offen offset:1024 nt
    buffer_load_dwordx4 v[112:115], v2, s[56:59], s70 offen offset:2048 nt
    buffer_load_dwordx4 v[116:119], v2, s[56:59], s70 offen offset:3072 nt
    s_add_u32 s70, s70, 4096
    s_waitcnt vmcnt(2)
    buffer_load_dwordx4 v[120:123], v2, s[56:59], s70 offen offset:0 nt
    buffer_load_dwordx4 v[124:127], v2, s[56:59], s70 offen offset:1024 nt
    buffer_load_dwordx4 v[128:131], v2, s[56:59], s70 offen offset:2048 nt
    buffer_load_dwordx4 v[132:135], v2, s[56:59], s70 offen offset:3072 nt
    s_add_u32 s70, s70, 28672
    s_waitcnt vmcnt(2)
    buffer_load_dwordx4 v[136:139], v2, s[56:59], s70 offen offset:0 nt
    buffer_load_dwordx4 v[140:143], v2, s[56:59], s70 offen offset:1024 nt
    buffer_load_dwordx4 v[144:147], v2, s[56:59], s70 offen offset:2048 nt
    buffer_load_dwordx4 v[148:151], v2, s[56:59], s70 offen offset:3072 nt
    s_add_u32 s70, s70, 4096
    s_waitcnt vmcnt(2)
    buffer_load_dwordx4 v[152:155], v2, s[56:59], s70 offen offset:0 nt
    buffer_load_dwordx4 v[156:159], v2, s[56:59], s70 offen offset:1024 nt
    buffer_load_dwordx4 v[160:163], v2, s[56:59], s70 offen offset:2048 nt
    buffer_load_dwordx4 v[164:167], v2, s[56:59], s70 offen offset:3072 nt
    s_add_u32 s70, s70, 28672
    s_waitcnt vmcnt(0)
S2J_64:
    v_perm_b32 v8, v44, v40, s92
    v_perm_b32 v9, v52, v48, s92
    v_perm_b32 v10, v60, v56, s92
    v_perm_b32 v11, v68, v64, s92
    v_perm_b32 v12, v44, v40, s93
    v_perm_b32 v13, v52, v48, s93
    v_perm_b32 v14, v60, v56, s93
    v_perm_b32 v15, v68, v64, s93
    v_perm_b32 v16, v45, v41, s92
    v_perm_b32 v17, v53, v49, s92
    v_perm_b32 v18, v61, v57, s92
    v_perm_b32 v19, v69, v65, s92
    v_perm_b32 v20, v45, v41, s93
    v_perm_b32 v21, v53, v49, s93
    v_perm_b32 v22, v61, v57, s93
    v_perm_b32 v23, v69, v65, s93
    v_perm_b32 v24, v46, v42, s92
    v_perm_b32 v25, v54, v50, s92
    v_perm_b32 v26, v62, v58, s92
    v_perm_b32 v27, v70, v66, s92
    v_perm_b32 v28, v46, v42, s93
    v_perm_b32 v29, v54, v50, s93
    v_perm_b32 v30, v62, v58, s93
    v_perm_b32 v31, v70, v66, s93
    v_perm_b32 v32, v47, v43, s92
    v_perm_b32 v33, v55, v51, s92
    v_perm_b32 v34, v63, v59, s92
    v_perm_b32 v35, v71, v67, s92
    v_perm_b32 v36, v47, v43, s93
    v_perm_b32 v37, v55, v51, s93
    v_perm_b32 v38, v63, v59, s93
    v_perm_b32 v39, v71, v67, s93
    v_perm_b32 v40, v76, v72, s92
    v_perm_b32 v41, v84, v80, s92
    v_perm_b32 v42, v92, v88, s92
    v_perm_b32 v43, v100, v96, s92
    v_perm_b32 v44, v76, v72, s93
    v_perm_b32 v45, v84, v80, s93
    v_perm_b32 v46, v92, v88, s93
    v_perm_b32 v47, v100, v96, s93
    v_perm_b32 v48, v77, v73, s92
    v_perm_b32 v49, v85, v81, s92
    v_perm_b32 v50, v93, v89, s92
    v_perm_b32 v51, v101, v97, s92
    v_perm_b32 v52, v77, v73, s93
    v_perm_b32 v53, v85, v81, s93
    v_perm_b32 v54, v93, v89, s93
    v_perm_b32 v55, v101, v97, s93
    v_perm_b32 v56, v78, v74, s92
    v_perm_b32 v57, v86, v82, s92
    v_perm_b32 v58, v94, v90, s92
    v_perm_b32 v59, v102, v98, s92
    v_perm_b32 v60, v78, v74, s93
    v_perm_b32 v61, v86, v82, s93
    v_perm_b32 v62, v94, v90, s93
    v_perm_b32 v63, v102, v98, s93
    v_perm_b32 v64, v79, v75, s92
    v_perm_b32 v65, v87, v83, s92
    v_perm_b32 v66, v95, v91, s92
    v_perm_b32 v67, v103, v99, s92
    v_perm_b32 v68, v79, v75, s93
    v_perm_b32 v69, v87, v83, s93
    v_perm_b32 v70, v95, v91, s93
    v_perm_b32 v71, v103, v99, s93
    v_perm_b32 v72, v108, v104, s92
    v_perm_b32 v73, v116, v112, s92
    v_perm_b32 v74, v124, v120, s92
    v_perm_b32 v75, v132, v128, s92
    v_perm_b32 v76, v108, v104, s93
    v_perm_b32 v77, v116, v112, s93
    v_perm_b32 v78, v124, v120, s93
    v_perm_b32 v79, v132, v128, s93
    v_perm_b32 v80, v109, v105, s92
    v_perm_b32 v81, v117, v113, s92
    v_perm_b32 v82, v125, v121, s92
    v_perm_b32 v83, v133, v129, s92
    v_perm_b32 v84, v109, v105, s93
    v_perm_b32 v85, v117, v113, s93
    v_perm_b32 v86, v125, v121, s93
    v_perm_b32 v87, v133, v129, s93
    v_perm_b32 v88, v110, v106, s92
    v_perm_b32 v89, v118, v114, s92
    v_perm_b32 v90, v126, v122, s92
    v_perm_b32 v91, v134, v130, s92
    v_perm_b32 v92, v110, v106, s93
    v_perm_b32 v93, v118, v114, s93
    v_perm_b32 v94, v126, v122, s93
    v_perm_b32 v95, v134, v130, s93
    v_perm_b32 v96, v111, v107, s92
    v_perm_b32 v97, v119, v115, s92
    v_perm_b32 v98, v127, v123, s92
    v_perm_b32 v99, v135, v131, s92
    v_perm_b32 v100, v111, v107, s93
    v_perm_b32 v101, v119, v115, s93
    v_perm_b32 v102, v127, v123, s93
    v_perm_b32 v103, v135, v131, s93
    v_perm_b32 v104, v140, v136, s92
    v_perm_b32 v105, v148, v144, s92
    v_perm_b32 v106, v156, v152, s92
    v_perm_b32 v107, v164, v160, s92
    v_perm_b32 v108, v140, v136, s93
    v_perm_b32 v109, v148, v144, s93
    v_perm_b32 v110, v156, v152, s93
    v_perm_b32 v111, v164, v160, s93
    v_perm_b32 v112, v141, v137, s92
    v_perm_b32 v113, v149, v145, s92
    v_perm_b32 v114, v157, v153, s92
    v_perm_b32 v115, v165, v161, s92
    v_perm_b32 v116, v141, v137, s93
    v_perm_b32 v117, v149, v145, s93
    v_perm_b32 v118, v157, v153, s93
    v_perm_b32 v119, v165, v161, s93
    v_perm_b32 v120, v142, v138, s92
    v_perm_b32 v121, v150, v146, s92
    v_perm_b32 v122, v158, v154, s92
    v_perm_b32 v123, v166, v162, s92
    v_perm_b32 v124, v142, v138, s93
    v_perm_b32 v125, v150, v146, s93
    v_perm_b32 v126, v158, v154, s93
    v_perm_b32 v127, v166, v162, s93
    v_perm_b32 v128, v143, v139, s92
    v_perm_b32 v129, v151, v147, s92
    v_perm_b32 v130, v159, v155, s92
    v_perm_b32 v131, v167, v163, s92
    v_perm_b32 v132, v143, v139, s93
    v_perm_b32 v133, v151, v147, s93
    v_perm_b32 v134, v159, v155, s93
    v_perm_b32 v135, v167, v163, s93
    v_mov_b32 v160, 0x2404c
    s_mov_b32 s80, 1600000
LW_67:
    ds_read_b32 v161, v160
    s_waitcnt lgkmcnt(0)
    v_readfirstlane_b32 s79, v161
    s_cmp_ge_u32 s79, 1
    s_cbranch_scc1 LWD_68
    s_sleep 2
    s_sub_u32 s80, s80, 1
    s_cmp_lg_u32 s80, 0
    s_cbranch_scc1 LW_67
LWD_68:
    v_mov_b32 v160, 0x24050
    ds_read_b64 v[162:163], v160
    s_waitcnt lgkmcnt(0)
    v_readfirstlane_b32 s94, v162
    v_readfirstlane_b32 s95, v163
    v_bfe_u32 v4, v1, 2, 2
    v_lshlrev_b32 v4, 8, v4
    v_lshrrev_b32 v160, 4, v1
    v_lshl_add_u32 v4, v160, 4, v4
    s_mov_b32 s70, 4096
    s_cmp_ge_u32 s5, 4
    s_cbranch_scc1 S2X_69
    v_add_u32 v4, 0x24400, v4
    s_cmp_lg_u32 s3, 8
    s_cbranch_scc1 U8_71
    v_and_b32 v5, 15, v1
    v_lshl_add_u32 v5, v5, 2, v160
    s_lshl_b32 s7, s6, 4
    s_add_u32 s7, s7, 0xe0000
    v_lshl_add_u32 v5, v5, 9, s7
    v_lshlrev_b32 v6, 4, v1
    v_add_u32 v6, 0x24800, v6
    s_mov_b32 s80, 200000
PO_72:
    buffer_load_dwordx4 v[136:139], v5, s[36:39], 0 offen sc1
PO2_73:
    s_waitcnt vmcnt(0)
    v_cmp_ne_u64 vcc, s[94:95], v[138:139]
    s_cmp_lg_u64 vcc, -1
    s_cbranch_scc1 POD_74
    s_sleep 16
    s_sub_u32 s80, s80, 1
    s_cmp_lg_u32 s80, 0
    s_cbranch_scc1 PO_72
POD_74:
    s_setprio 3
    ds_write_b128 v6, v[136:139]
    v_mov_b32 v160, 0x2401c
    v_mov_b32 v161, 1
    s_waitcnt lgkmcnt(0)
    s_mov_b64 exec, 1
    ds_add_u32 v160, v161
    s_mov_b64 exec, -1
    s_cbranch_vccz U8D_76
    buffer_load_dwordx4 v[136:139], v5, s[36:39], 0 offen sc1
    s_sleep 4
    buffer_load_dwordx4 v[140:143], v5, s[36:39], 0 offen sc1
    s_sleep 4
    s_mov_b32 s80, 200000
U8P_75:
    s_waitcnt vmcnt(1)
    ds_write_b128 v6, v[136:139]
    v_cmp_ne_u64 vcc, s[94:95], v[138:139]
    s_cbranch_vccz U8D_76
    s_waitcnt lgkmcnt(0)
    buffer_load_dwordx4 v[136:139], v5, s[36:39], 0 offen sc1
    s_waitcnt vmcnt(1)
    ds_write_b128 v6, v[140:143]
    v_cmp_ne_u64 vcc, s[94:95], v[142:143]
    s_cbranch_vccz U8D_76
    s_waitcnt lgkmcnt(0)
    buffer_load_dwordx4 v[140:143], v5, s[36:39], 0 offen sc1
    s_sub_u32 s80, s80, 1
    s_cmp_lg_u32 s80, 0
    s_cbranch_scc1 U8P_75
U8D_76:
    s_waitcnt vmcnt(0)
U8_71:
    s_setprio 3
    s_barrier
    s_barrier
    ds_read_b128 v[136:139], v4 offset:0
    ds_read_b128 v[140:143], v4 offset:64
    ds_read_b128 v[144:147], v4 offset:128
    ds_read_b128 v[148:151], v4 offset:192
    s_waitcnt lgkmcnt(0)
    s_branch S2M_70
S2X_69:
    v_and_b32 v160, 3, v1
    v_lshl_add_u32 v4, v160, 6, v4
    s_lshl_b32 s7, s6, 11
    s_add_u32 s7, s7, 0xd0000
    v_add_u32 v4, s7, v4
    s_mov_b32 s80, 200000
PO_77:
    buffer_load_dwordx4 v[152:155], v4, s[36:39], 0 offen offset:0 sc1
PO2_78:
    s_waitcnt vmcnt(0)
    v_cmp_ne_u64 vcc, s[94:95], v[154:155]
    s_cmp_lg_u64 vcc, -1
    s_cbranch_scc1 POD_79
    s_sleep 2
    s_sub_u32 s80, s80, 1
    s_cmp_lg_u32 s80, 0
    s_cbranch_scc1 PO_77
POD_79:
    s_setprio 3
    buffer_load_dwordx4 v[152:155], v4, s[36:39], 0 offen offset:0 sc1
    buffer_load_dwordx4 v[156:159], v4, s[36:39], 0 offen offset:1024 sc1
    s_sleep 4
    buffer_load_dwordx4 v[160:163], v4, s[36:39], 0 offen offset:0 sc1
    buffer_load_dwordx4 v[164:167], v4, s[36:39], 0 offen offset:1024 sc1
    s_sleep 4
    s_mov_b32 s80, 200000
PP_80:
    s_waitcnt vmcnt(2)
    v_cmp_ne_u64 vcc, s[94:95], v[154:155]
    v_cmp_ne_u64 s[84:85], s[94:95], v[158:159]
    s_or_b64 vcc, vcc, s[84:85]
    s_cmp_eq_u64 vcc, 0
    s_cbranch_scc1 PPO_82
    buffer_load_dwordx4 v[152:155], v4, s[36:39], 0 offen offset:0 sc1
    buffer_load_dwordx4 v[156:159], v4, s[36:39], 0 offen offset:1024 sc1
    s_waitcnt vmcnt(2)
    v_cmp_ne_u64 vcc, s[94:95], v[162:163]
    v_cmp_ne_u64 s[84:85], s[94:95], v[166:167]
    s_or_b64 vcc, vcc, s[84:85]
    s_cmp_eq_u64 vcc, 0
    s_cbranch_scc1 PPO_83
    buffer_load_dwordx4 v[160:163], v4, s[36:39], 0 offen offset:0 sc1
    buffer_load_dwordx4 v[164:167], v4, s[36:39], 0 offen offset:1024 sc1
    s_sub_u32 s80, s80, 1
    s_cmp_lg_u32 s80, 0
    s_cbranch_scc1 PP_80
PPO_82:
    v_mov_b32_dpp v136, v152 quad_perm:[0,0,0,0] row_mask:0xf bank_mask:0xf
    v_mov_b32_dpp v137, v153 quad_perm:[0,0,0,0] row_mask:0xf bank_mask:0xf
    v_mov_b32_dpp v138, v156 quad_perm:[0,0,0,0] row_mask:0xf bank_mask:0xf
    v_mov_b32_dpp v139, v157 quad_perm:[0,0,0,0] row_mask:0xf bank_mask:0xf
    v_mov_b32_dpp v140, v152 quad_perm:[1,1,1,1] row_mask:0xf bank_mask:0xf
    v_mov_b32_dpp v141, v153 quad_perm:[1,1,1,1] row_mask:0xf bank_mask:0xf
    v_mov_b32_dpp v142, v156 quad_perm:[1,1,1,1] row_mask:0xf bank_mask:0xf
    v_mov_b32_dpp v143, v157 quad_perm:[1,1,1,1] row_mask:0xf bank_mask:0xf
    v_mov_b32_dpp v144, v152 quad_perm:[2,2,2,2] row_mask:0xf bank_mask:0xf
    v_mov_b32_dpp v145, v153 quad_perm:[2,2,2,2] row_mask:0xf bank_mask:0xf
    v_mov_b32_dpp v146, v156 quad_perm:[2,2,2,2] row_mask:0xf bank_mask:0xf
    v_mov_b32_dpp v147, v157 quad_perm:[2,2,2,2] row_mask:0xf bank_mask:0xf
    v_mov_b32_dpp v148, v152 quad_perm:[3,3,3,3] row_mask:0xf bank_mask:0xf
    v_mov_b32_dpp v149, v153 quad_perm:[3,3,3,3] row_mask:0xf bank_mask:0xf
    v_mov_b32_dpp v150, v156 quad_perm:[3,3,3,3] row_mask:0xf bank_mask:0xf
    v_mov_b32_dpp v151, v157 quad_perm:[3,3,3,3] row_mask:0xf bank_mask:0xf
    s_branch PPD_81
PPO_83:
    v_mov_b32_dpp v136, v160 quad_perm:[0,0,0,0] row_mask:0xf bank_mask:0xf
    v_mov_b32_dpp v137, v161 quad_perm:[0,0,0,0] row_mask:0xf bank_mask:0xf
    v_mov_b32_dpp v138, v164 quad_perm:[0,0,0,0] row_mask:0xf bank_mask:0xf
    v_mov_b32_dpp v139, v165 quad_perm:[0,0,0,0] row_mask:0xf bank_mask:0xf
    v_mov_b32_dpp v140, v160 quad_perm:[1,1,1,1] row_mask:0xf bank_mask:0xf
    v_mov_b32_dpp v141, v161 quad_perm:[1,1,1,1] row_mask:0xf bank_mask:0xf
    v_mov_b32_dpp v142, v164 quad_perm:[1,1,1,1] row_mask:0xf bank_mask:0xf
    v_mov_b32_dpp v143, v165 quad_perm:[1,1,1,1] row_mask:0xf bank_mask:0xf
    v_mov_b32_dpp v144, v160 quad_perm:[2,2,2,2] row_mask:0xf bank_mask:0xf
    v_mov_b32_dpp v145, v161 quad_perm:[2,2,2,2] row_mask:0xf bank_mask:0xf
    v_mov_b32_dpp v146, v164 quad_perm:[2,2,2,2] row_mask:0xf bank_mask:0xf
    v_mov_b32_dpp v147, v165 quad_perm:[2,2,2,2] row_mask:0xf bank_mask:0xf
    v_mov_b32_dpp v148, v160 quad_perm:[3,3,3,3] row_mask:0xf bank_mask:0xf
    v_mov_b32_dpp v149, v161 quad_perm:[3,3,3,3] row_mask:0xf bank_mask:0xf
    v_mov_b32_dpp v150, v164 quad_perm:[3,3,3,3] row_mask:0xf bank_mask:0xf
    v_mov_b32_dpp v151, v165 quad_perm:[3,3,3,3] row_mask:0xf bank_mask:0xf
PPD_81:
S2M_70:
    s_nop 1
    v_mfma_f32_16x16x32_bf16 v[4:7], v[136:139], v[8:11], 0
    v_mfma_f32_16x16x32_bf16 v[4:7], v[140:143], v[40:43], v[4:7]
    v_mfma_f32_16x16x32_bf16 v[4:7], v[144:147], v[72:75], v[4:7]
    v_mfma_f32_16x16x32_bf16 v[4:7], v[148:151], v[104:107], v[4:7]
    v_mfma_f32_16x16x32_bf16 v[8:11], v[136:139], v[12:15], 0
    v_mfma_f32_16x16x32_bf16 v[8:11], v[140:143], v[44:47], v[8:11]
    v_mfma_f32_16x16x32_bf16 v[8:11], v[144:147], v[76:79], v[8:11]
    v_mfma_f32_16x16x32_bf16 v[8:11], v[148:151], v[108:111], v[8:11]
    v_mfma_f32_16x16x32_bf16 v[12:15], v[136:139], v[16:19], 0
    v_mfma_f32_16x16x32_bf16 v[12:15], v[140:143], v[48:51], v[12:15]
    v_mfma_f32_16x16x32_bf16 v[12:15], v[144:147], v[80:83], v[12:15]
    v_mfma_f32_16x16x32_bf16 v[12:15], v[148:151], v[112:115], v[12:15]
    v_mfma_f32_16x16x32_bf16 v[16:19], v[136:139], v[20:23], 0
    v_mfma_f32_16x16x32_bf16 v[16:19], v[140:143], v[52:55], v[16:19]
    v_mfma_f32_16x16x32_bf16 v[16:19], v[144:147], v[84:87], v[16:19]
    v_mfma_f32_16x16x32_bf16 v[16:19], v[148:151], v[116:119], v[16:19]
    v_mfma_f32_16x16x32_bf16 v[20:23], v[136:139], v[24:27], 0
    v_mfma_f32_16x16x32_bf16 v[20:23], v[140:143], v[56:59], v[20:23]
    v_mfma_f32_16x16x32_bf16 v[20:23], v[144:147], v[88:91], v[20:23]
    v_mfma_f32_16x16x32_bf16 v[20:23], v[148:151], v[120:123], v[20:23]
    v_mfma_f32_16x16x32_bf16 v[24:27], v[136:139], v[28:31], 0
    v_mfma_f32_16x16x32_bf16 v[24:27], v[140:143], v[60:63], v[24:27]
    v_mfma_f32_16x16x32_bf16 v[24:27], v[144:147], v[92:95], v[24:27]
    v_mfma_f32_16x16x32_bf16 v[24:27], v[148:151], v[124:127], v[24:27]
    v_mfma_f32_16x16x32_bf16 v[28:31], v[136:139], v[32:35], 0
    v_mfma_f32_16x16x32_bf16 v[28:31], v[140:143], v[64:67], v[28:31]
    v_mfma_f32_16x16x32_bf16 v[28:31], v[144:147], v[96:99], v[28:31]
    v_mfma_f32_16x16x32_bf16 v[28:31], v[148:151], v[128:131], v[28:31]
    v_mfma_f32_16x16x32_bf16 v[32:35], v[136:139], v[36:39], 0
    v_mfma_f32_16x16x32_bf16 v[32:35], v[140:143], v[68:71], v[32:35]
    v_mfma_f32_16x16x32_bf16 v[32:35], v[144:147], v[100:103], v[32:35]
    v_mfma_f32_16x16x32_bf16 v[32:35], v[148:151], v[132:135], v[32:35]
    v_mov_b32 v42, s94
    v_mov_b32 v43, s95
    v_cvt_pk_bf16_f32 v40, v4, v8
    v_cvt_pk_bf16_f32 v41, v12, v16
    buffer_store_dwordx4 v[40:43], v3, s[36:39], 0 offen sc1
    v_mov_b32 v46, s94
    v_mov_b32 v47, s95
    v_cvt_pk_bf16_f32 v44, v20, v24
    v_cvt_pk_bf16_f32 v45, v28, v32
    buffer_store_dwordx4 v[44:47], v3, s[36:39], s70 offen sc1
    s_endpgm
.p2align 12
LT_CR:
    s_branch LR_CR
L_CR:
    v_and_b32 v160, 15, v1
    v_lshlrev_b32 v4, 10, v160
    v_lshrrev_b32 v161, 4, v1
    v_lshl_add_u32 v4, v161, 8, v4
    v_lshl_add_u32 v3, v160, 4, v4
    s_lshl_b32 s7, s65, 14
    s_add_u32 s7, s7, 0x18000
    v_add_u32 v3, s7, v3
    v_and_b32 v162, 3, v1
    v_lshl_add_u32 v4, v162, 6, v4
    v_bfe_u32 v162, v1, 2, 2
    v_lshl_add_u32 v4, v162, 4, v4
    s_lshl_b32 s7, s64, 14
    v_add_u32 v4, s7, v4
    v_add_u32 v2, 0x10000, v4
    s_lshl_b32 s7, s65, 6
    s_add_u32 s7, s7, 0x27200
    v_lshl_add_u32 v5, v160, 2, s7
    s_lshl_b32 s7, s64, 10
    s_lshl_b32 s66, s65, 9
    s_add_u32 s7, s7, s66
    s_add_u32 s7, s7, 0x25200
    v_lshl_add_u32 v6, v160, 5, s7
    v_lshl_add_u32 v6, v161, 3, v6
    v_and_b32 v162, 31, v1
    v_lshlrev_b32 v7, 5, v162
    v_lshrrev_b32 v163, 5, v1
    v_lshl_add_u32 v7, v163, 4, v7
    v_add_u32 v7, 0x25200, v7
    v_lshlrev_b32 v8, 2, v162
    v_add_u32 v8, 0x27e00, v8
    v_bfe_u32 v162, v1, 2, 2
    v_lshl_add_u32 v164, v163, 3, v162
    v_lshlrev_b32 v164, 10, v164
    v_and_b32 v165, 1, v1
    v_lshl_add_u32 v164, v165, 3, v164
    s_lshl_b32 s7, s64, 8
    v_add_u32 v164, s7, v164
    v_bfe_u32 v165, v1, 4, 1
    v_lshlrev_b32 v165, 1, v165
    v_bfe_u32 v160, v1, 1, 1
    v_or_b32 v165, v165, v160
    s_lshl_b32 s7, s65, 3
    v_or_b32 v165, s7, v165
    v_lshlrev_b32 v162, 2, v162
    v_xor_b32 v165, v165, v162
    v_lshlrev_b32 v163, 1, v163
    v_xor_b32 v165, v165, v163
    v_xor_b32 v160, 0, v165
    v_lshl_add_u32 v9, v160, 4, v164
    v_xor_b32 v160, 4, v165
    v_lshl_add_u32 v10, v160, 4, v164
    v_xor_b32 v160, 1, v165
    v_lshl_add_u32 v11, v160, 4, v164
    v_add_u32 v11, 0x1000, v11
    v_xor_b32 v160, 5, v165
    v_lshl_add_u32 v12, v160, 4, v164
    v_add_u32 v12, 0x1000, v12
    v_mov_b32 v13, 0xff800000
    v_mov_b32 v14, 0
    v_cmp_gt_u32 s[86:87], 16, v1
    s_cmp_eq_u32 s64, 0
    s_cselect_b32 s88, 0xffff, 0
    s_mov_b32 s89, 0
    s_barrier
    v_xor_b32 v160, 0x0, v3
    ds_read_b128 v[32:35], v160
    v_xor_b32 v161, 0x10, v3
    ds_read_b128 v[36:39], v161
    v_xor_b32 v160, 0x20, v3
    ds_read_b128 v[40:43], v160
    v_xor_b32 v161, 0x30, v3
    ds_read_b128 v[44:47], v161
    v_xor_b32 v160, 0x40, v3
    ds_read_b128 v[48:51], v160
    v_xor_b32 v161, 0x50, v3
    ds_read_b128 v[52:55], v161
    v_xor_b32 v160, 0x60, v3
    ds_read_b128 v[56:59], v160
    v_xor_b32 v161, 0x70, v3
    ds_read_b128 v[60:63], v161
    v_xor_b32 v160, 0x80, v3
    ds_read_b128 v[64:67], v160
    v_xor_b32 v161, 0x90, v3
    ds_read_b128 v[68:71], v161
    v_xor_b32 v160, 0xa0, v3
    ds_read_b128 v[72:75], v160
    v_xor_b32 v161, 0xb0, v3
    ds_read_b128 v[76:79], v161
    v_xor_b32 v160, 0xc0, v3
    ds_read_b128 v[80:83], v160
    v_xor_b32 v161, 0xd0, v3
    ds_read_b128 v[84:87], v161
    v_xor_b32 v160, 0xe0, v3
    ds_read_b128 v[88:91], v160
    v_xor_b32 v161, 0xf0, v3
    ds_read_b128 v[92:95], v161
    s_lshl_b32 s7, s3, 10
    s_add_u32 s7, s7, 0x18000
    v_lshl_add_u32 v3, v1, 4, s7
    s_waitcnt lgkmcnt(0)
    s_barrier
    ds_write_b128 v3, v[128:131] offset:0
    ds_write_b128 v3, v[132:135] offset:8192
    ds_write_b128 v3, v[136:139] offset:16384
    ds_write_b128 v3, v[140:143] offset:24576
    v_xor_b32 v160, 0x0, v4
    ds_read_b128 v[24:27], v160
    v_xor_b32 v161, 0x10, v4
    ds_read_b128 v[28:31], v161
    v_xor_b32 v162, 0x20, v4
    ds_read_b128 v[164:167], v162
    v_xor_b32 v160, 0x30, v4
    ds_read_b128 v[144:147], v160
    v_xor_b32 v161, 0x40, v4
    ds_read_b128 v[148:151], v161
    v_xor_b32 v162, 0x50, v4
    ds_read_b128 v[152:155], v162
    v_xor_b32 v160, 0x60, v4
    ds_read_b128 v[156:159], v160
    s_waitcnt lgkmcnt(6)
    v_mfma_f32_16x16x32_bf16 v[16:19], v[24:27], v[32:35], 0
    v_xor_b32 v161, 0x70, v4
    ds_read_b128 v[24:27], v161
    s_waitcnt lgkmcnt(6)
    v_mfma_f32_16x16x32_bf16 v[16:19], v[28:31], v[36:39], v[16:19]
    v_xor_b32 v162, 0x80, v4
    ds_read_b128 v[28:31], v162
    s_waitcnt lgkmcnt(6)
    v_mfma_f32_16x16x32_bf16 v[16:19], v[164:167], v[40:43], v[16:19]
    v_xor_b32 v160, 0x90, v4
    ds_read_b128 v[164:167], v160
    s_waitcnt lgkmcnt(6)
    v_mfma_f32_16x16x32_bf16 v[16:19], v[144:147], v[44:47], v[16:19]
    v_xor_b32 v161, 0xa0, v4
    ds_read_b128 v[144:147], v161
    s_waitcnt lgkmcnt(6)
    v_mfma_f32_16x16x32_bf16 v[16:19], v[148:151], v[48:51], v[16:19]
    v_xor_b32 v162, 0xb0, v4
    ds_read_b128 v[148:151], v162
    s_waitcnt lgkmcnt(6)
    v_mfma_f32_16x16x32_bf16 v[16:19], v[152:155], v[52:55], v[16:19]
    v_xor_b32 v160, 0xc0, v4
    ds_read_b128 v[152:155], v160
    s_waitcnt lgkmcnt(6)
    v_mfma_f32_16x16x32_bf16 v[16:19], v[156:159], v[56:59], v[16:19]
    v_xor_b32 v161, 0xd0, v4
    ds_read_b128 v[156:159], v161
    s_waitcnt lgkmcnt(6)
    v_mfma_f32_16x16x32_bf16 v[16:19], v[24:27], v[60:63], v[16:19]
    v_xor_b32 v162, 0xe0, v4
    ds_read_b128 v[24:27], v162
    s_waitcnt lgkmcnt(6)
    v_mfma_f32_16x16x32_bf16 v[16:19], v[28:31], v[64:67], v[16:19]
    v_xor_b32 v160, 0xf0, v4
    ds_read_b128 v[28:31], v160
    s_waitcnt lgkmcnt(6)
    v_mfma_f32_16x16x32_bf16 v[16:19], v[164:167], v[68:71], v[16:19]
    s_waitcnt lgkmcnt(5)
    v_mfma_f32_16x16x32_bf16 v[16:19], v[144:147], v[72:75], v[16:19]
    s_waitcnt lgkmcnt(4)
    v_mfma_f32_16x16x32_bf16 v[16:19], v[148:151], v[76:79], v[16:19]
    s_waitcnt lgkmcnt(3)
    v_mfma_f32_16x16x32_bf16 v[16:19], v[152:155], v[80:83], v[16:19]
    s_waitcnt lgkmcnt(2)
    v_mfma_f32_16x16x32_bf16 v[16:19], v[156:159], v[84:87], v[16:19]
    s_waitcnt lgkmcnt(1)
    v_mfma_f32_16x16x32_bf16 v[16:19], v[24:27], v[88:91], v[16:19]
    s_waitcnt lgkmcnt(0)
    v_mfma_f32_16x16x32_bf16 v[16:19], v[28:31], v[92:95], v[16:19]
    s_waitcnt lgkmcnt(0)
    s_barrier
    v_xor_b32 v160, 0x0, v2
    ds_read_b128 v[24:27], v160
    v_xor_b32 v161, 0x10, v2
    ds_read_b128 v[28:31], v161
    v_xor_b32 v162, 0x20, v2
    ds_read_b128 v[164:167], v162
    v_xor_b32 v160, 0x30, v2
    ds_read_b128 v[144:147], v160
    v_xor_b32 v161, 0x40, v2
    ds_read_b128 v[148:151], v161
    v_xor_b32 v162, 0x50, v2
    ds_read_b128 v[152:155], v162
    v_xor_b32 v160, 0x60, v2
    ds_read_b128 v[156:159], v160
    s_waitcnt lgkmcnt(6)
    v_mfma_f32_16x16x32_bf16 v[20:23], v[24:27], v[32:35], 0
    v_xor_b32 v161, 0x70, v2
    ds_read_b128 v[24:27], v161
    s_waitcnt lgkmcnt(6)
    v_mfma_f32_16x16x32_bf16 v[20:23], v[28:31], v[36:39], v[20:23]
    v_xor_b32 v162, 0x80, v2
    ds_read_b128 v[28:31], v162
    s_waitcnt lgkmcnt(6)
    v_mfma_f32_16x16x32_bf16 v[20:23], v[164:167], v[40:43], v[20:23]
    v_xor_b32 v160, 0x90, v2
    ds_read_b128 v[164:167], v160
    s_waitcnt lgkmcnt(6)
    v_mfma_f32_16x16x32_bf16 v[20:23], v[144:147], v[44:47], v[20:23]
    v_xor_b32 v161, 0xa0, v2
    ds_read_b128 v[144:147], v161
    s_waitcnt lgkmcnt(6)
    v_mfma_f32_16x16x32_bf16 v[20:23], v[148:151], v[48:51], v[20:23]
    v_xor_b32 v162, 0xb0, v2
    ds_read_b128 v[148:151], v162
    s_waitcnt lgkmcnt(6)
    v_mfma_f32_16x16x32_bf16 v[20:23], v[152:155], v[52:55], v[20:23]
    v_xor_b32 v160, 0xc0, v2
    ds_read_b128 v[152:155], v160
    s_waitcnt lgkmcnt(6)
    v_mfma_f32_16x16x32_bf16 v[20:23], v[156:159], v[56:59], v[20:23]
    v_xor_b32 v161, 0xd0, v2
    ds_read_b128 v[156:159], v161
    s_waitcnt lgkmcnt(6)
    v_mfma_f32_16x16x32_bf16 v[20:23], v[24:27], v[60:63], v[20:23]
    v_xor_b32 v162, 0xe0, v2
    ds_read_b128 v[24:27], v162
    s_waitcnt lgkmcnt(6)
    v_mfma_f32_16x16x32_bf16 v[20:23], v[28:31], v[64:67], v[20:23]
    v_xor_b32 v160, 0xf0, v2
    ds_read_b128 v[28:31], v160
    s_waitcnt lgkmcnt(6)
    v_mfma_f32_16x16x32_bf16 v[20:23], v[164:167], v[68:71], v[20:23]
    s_waitcnt lgkmcnt(5)
    v_mfma_f32_16x16x32_bf16 v[20:23], v[144:147], v[72:75], v[20:23]
    s_waitcnt lgkmcnt(4)
    v_mfma_f32_16x16x32_bf16 v[20:23], v[148:151], v[76:79], v[20:23]
    s_waitcnt lgkmcnt(3)
    v_mfma_f32_16x16x32_bf16 v[20:23], v[152:155], v[80:83], v[20:23]
    s_waitcnt lgkmcnt(2)
    v_mfma_f32_16x16x32_bf16 v[20:23], v[156:159], v[84:87], v[20:23]
    s_waitcnt lgkmcnt(1)
    v_mfma_f32_16x16x32_bf16 v[20:23], v[24:27], v[88:91], v[20:23]
    s_waitcnt lgkmcnt(0)
    v_mfma_f32_16x16x32_bf16 v[20:23], v[28:31], v[92:95], v[20:23]
    v_max3_f32 v160, v16, v17, v18
    s_nop 6
    v_max3_f32 v160, v160, v19, v20
    v_max3_f32 v160, v160, v21, v22
    v_max_f32 v160, v160, v23
    v_mov_b32 v161, v160
    s_nop 1
    v_permlane32_swap_b32 v160, v161
    v_max_f32 v160, v160, v161
    v_mov_b32 v161, v160
    s_nop 1
    v_permlane16_swap_b32 v160, v161
    v_max_f32 v160, v160, v161
    s_lshl_b32 s7, s64, 7
    v_add_u32 v161, s7, v5
    s_mov_b64 exec, s[86:87]
    ds_write_b32 v161, v160
    s_mov_b64 exec, -1
    s_waitcnt lgkmcnt(0)
    s_barrier
    ds_read_b32 v160, v5 offset:0
    ds_read_b32 v161, v5 offset:128
    ds_read_b32 v162, v5 offset:256
    ds_read_b32 v163, v5 offset:384
    s_waitcnt lgkmcnt(0)
    v_max3_f32 v160, v160, v161, v162
    v_max_f32 v160, v160, v163
    v_mul_f32 v160, s67, v160
    v_max_f32 v160, v160, v13
    v_sub_f32 v161, v13, v160
    v_exp_f32 v161, v161
    v_mov_b32 v13, v160
    v_fma_f32 v16, v16, s67, -v160
    v_fma_f32 v17, v17, s67, -v160
    v_fma_f32 v18, v18, s67, -v160
    v_fma_f32 v19, v19, s67, -v160
    v_fma_f32 v20, v20, s67, -v160
    v_fma_f32 v21, v21, s67, -v160
    v_fma_f32 v22, v22, s67, -v160
    v_fma_f32 v23, v23, s67, -v160
    v_exp_f32 v16, v16
    v_exp_f32 v17, v17
    v_exp_f32 v18, v18
    v_exp_f32 v19, v19
    v_exp_f32 v20, v20
    v_exp_f32 v21, v21
    v_exp_f32 v22, v22
    v_exp_f32 v23, v23
    v_cvt_pk_bf16_f32 v24, v16, v17
    v_cvt_pk_bf16_f32 v25, v18, v19
    v_cvt_pk_bf16_f32 v26, v20, v21
    v_cvt_pk_bf16_f32 v27, v22, v23
    ds_write_b64 v6, v[24:25]
    ds_write_b64 v6, v[26:27] offset:4096
    v_add_u32 v162, 0xc00, v5
    s_mov_b64 exec, s[88:89]
    ds_write_b32 v162, v161
    s_mov_b64 exec, -1
    v_mul_f32 v14, v14, v161
    v_add_f32 v16, v16, v20
    v_add_f32 v17, v17, v21
    v_add_f32 v18, v18, v22
    v_add_f32 v19, v19, v23
    v_add_f32 v16, v16, v18
    v_add_f32 v17, v17, v19
    v_add_f32 v16, v16, v17
    v_add_f32 v14, v14, v16
    v_lshlrev_b32 v3, 4, v1
    v_xor_b32 v3, s62, v3
    v_xor_b32 v15, 32, v3
    s_lshl_b32 s68, s3, 10
    s_waitcnt lgkmcnt(0)
    s_barrier
    ds_read_b128 v[16:19], v7 offset:0
    ds_read_b64_tr_b16 v[24:25], v9 offset:0
    ds_read_b64_tr_b16 v[26:27], v11 offset:0
    ds_read_b64_tr_b16 v[28:29], v10 offset:0
    ds_read_b64_tr_b16 v[30:31], v12 offset:0
    ds_read_b128 v[20:23], v7 offset:1024
    ds_read_b64_tr_b16 v[160:161], v9 offset:16384
    ds_read_b64_tr_b16 v[162:163], v11 offset:16384
    ds_read_b64_tr_b16 v[164:165], v10 offset:16384
    ds_read_b64_tr_b16 v[166:167], v12 offset:16384
    s_waitcnt lgkmcnt(7)
    v_mfma_f32_32x32x16_bf16 v[128:143], v[24:27], v[16:19], 0
    s_waitcnt lgkmcnt(5)
    v_mfma_f32_32x32x16_bf16 v[144:159], v[28:31], v[16:19], 0
    ds_read_b128 v[16:19], v7 offset:2048
    ds_read_b64_tr_b16 v[24:25], v9 offset:32768
    ds_read_b64_tr_b16 v[26:27], v11 offset:32768
    ds_read_b64_tr_b16 v[28:29], v10 offset:32768
    ds_read_b64_tr_b16 v[30:31], v12 offset:32768
    s_waitcnt lgkmcnt(7)
    v_mfma_f32_32x32x16_bf16 v[128:143], v[160:163], v[20:23], v[128:143]
    s_waitcnt lgkmcnt(5)
    v_mfma_f32_32x32x16_bf16 v[144:159], v[164:167], v[20:23], v[144:159]
    ds_read_b128 v[20:23], v7 offset:3072
    ds_read_b64_tr_b16 v[160:161], v9 offset:49152
    ds_read_b64_tr_b16 v[162:163], v11 offset:49152
    ds_read_b64_tr_b16 v[164:165], v10 offset:49152
    ds_read_b64_tr_b16 v[166:167], v12 offset:49152
    s_waitcnt lgkmcnt(7)
    v_mfma_f32_32x32x16_bf16 v[128:143], v[24:27], v[16:19], v[128:143]
    s_waitcnt lgkmcnt(5)
    v_mfma_f32_32x32x16_bf16 v[144:159], v[28:31], v[16:19], v[144:159]
    v_add_u32 v9, 0x10000, v9
    v_add_u32 v10, 0x10000, v10
    v_add_u32 v11, 0x10000, v11
    v_add_u32 v12, 0x10000, v12
    ds_read_b128 v[16:19], v7 offset:4096
    ds_read_b64_tr_b16 v[24:25], v9 offset:0
    ds_read_b64_tr_b16 v[26:27], v11 offset:0
    ds_read_b64_tr_b16 v[28:29], v10 offset:0
    ds_read_b64_tr_b16 v[30:31], v12 offset:0
    s_waitcnt lgkmcnt(7)
    v_mfma_f32_32x32x16_bf16 v[128:143], v[160:163], v[20:23], v[128:143]
    s_waitcnt lgkmcnt(5)
    v_mfma_f32_32x32x16_bf16 v[144:159], v[164:167], v[20:23], v[144:159]
    s_barrier
    ds_read_b128 v[20:23], v7 offset:5120
    ds_read_b64_tr_b16 v[160:161], v9 offset:16384
    ds_read_b64_tr_b16 v[162:163], v11 offset:16384
    ds_read_b64_tr_b16 v[164:165], v10 offset:16384
    ds_read_b64_tr_b16 v[166:167], v12 offset:16384
    s_waitcnt lgkmcnt(7)
    v_mfma_f32_32x32x16_bf16 v[128:143], v[24:27], v[16:19], v[128:143]
    s_waitcnt lgkmcnt(5)
    v_mfma_f32_32x32x16_bf16 v[144:159], v[28:31], v[16:19], v[144:159]
    ds_read_b128 v[16:19], v7 offset:6144
    ds_read_b64_tr_b16 v[24:25], v9 offset:32768
    ds_read_b64_tr_b16 v[26:27], v11 offset:32768
    ds_read_b64_tr_b16 v[28:29], v10 offset:32768
    ds_read_b64_tr_b16 v[30:31], v12 offset:32768
    s_waitcnt lgkmcnt(7)
    v_mfma_f32_32x32x16_bf16 v[128:143], v[160:163], v[20:23], v[128:143]
    s_waitcnt lgkmcnt(5)
    v_mfma_f32_32x32x16_bf16 v[144:159], v[164:167], v[20:23], v[144:159]
    ds_read_b128 v[20:23], v7 offset:7168
    ds_read_b64_tr_b16 v[160:161], v9 offset:49152
    ds_read_b64_tr_b16 v[162:163], v11 offset:49152
    ds_read_b64_tr_b16 v[164:165], v10 offset:49152
    ds_read_b64_tr_b16 v[166:167], v12 offset:49152
    s_waitcnt lgkmcnt(7)
    v_mfma_f32_32x32x16_bf16 v[128:143], v[24:27], v[16:19], v[128:143]
    s_waitcnt lgkmcnt(5)
    v_mfma_f32_32x32x16_bf16 v[144:159], v[28:31], v[16:19], v[144:159]
    s_waitcnt lgkmcnt(2)
    v_mfma_f32_32x32x16_bf16 v[128:143], v[160:163], v[20:23], v[128:143]
    s_waitcnt lgkmcnt(0)
    v_mfma_f32_32x32x16_bf16 v[144:159], v[164:167], v[20:23], v[144:159]
    v_add_u32 v9, 0xffff0000, v9
    v_add_u32 v10, 0xffff0000, v10
    v_add_u32 v11, 0xffff0000, v11
    v_add_u32 v12, 0xffff0000, v12
    s_lshl_b32 s7, s3, 10
    s_add_u32 s7, s7, 0x10000
    v_lshl_add_u32 v3, v1, 4, s7
    s_waitcnt vmcnt(0)
    s_barrier
    ds_write_b128 v3, v[96:99] offset:0
    ds_write_b128 v3, v[100:103] offset:8192
    ds_write_b128 v3, v[104:107] offset:16384
    ds_write_b128 v3, v[108:111] offset:24576
    ds_write_b128 v3, v[112:115] offset:32768
    ds_write_b128 v3, v[116:119] offset:40960
    ds_write_b128 v3, v[120:123] offset:49152
    ds_write_b128 v3, v[124:127] offset:57344
    s_waitcnt lgkmcnt(4)
    v_xor_b32 v160, 0x0, v4
    ds_read_b128 v[24:27], v160
    v_xor_b32 v161, 0x10, v4
    ds_read_b128 v[28:31], v161
    v_xor_b32 v162, 0x20, v4
    ds_read_b128 v[164:167], v162
    v_xor_b32 v160, 0x30, v4
    ds_read_b128 v[96:99], v160
    v_xor_b32 v161, 0x40, v4
    ds_read_b128 v[100:103], v161
    v_xor_b32 v162, 0x50, v4
    ds_read_b128 v[104:107], v162
    v_xor_b32 v160, 0x60, v4
    ds_read_b128 v[108:111], v160
    s_waitcnt lgkmcnt(6)
    v_mfma_f32_16x16x32_bf16 v[16:19], v[24:27], v[32:35], 0
    v_xor_b32 v161, 0x70, v4
    ds_read_b128 v[24:27], v161
    s_waitcnt lgkmcnt(6)
    v_mfma_f32_16x16x32_bf16 v[16:19], v[28:31], v[36:39], v[16:19]
    v_xor_b32 v162, 0x80, v4
    ds_read_b128 v[28:31], v162
    s_waitcnt lgkmcnt(6)
    v_mfma_f32_16x16x32_bf16 v[16:19], v[164:167], v[40:43], v[16:19]
    v_xor_b32 v160, 0x90, v4
    ds_read_b128 v[164:167], v160
    s_waitcnt lgkmcnt(6)
    v_mfma_f32_16x16x32_bf16 v[16:19], v[96:99], v[44:47], v[16:19]
    v_xor_b32 v161, 0xa0, v4
    ds_read_b128 v[96:99], v161
    s_waitcnt lgkmcnt(6)
    v_mfma_f32_16x16x32_bf16 v[16:19], v[100:103], v[48:51], v[16:19]
    v_xor_b32 v162, 0xb0, v4
    ds_read_b128 v[100:103], v162
    s_waitcnt lgkmcnt(6)
    v_mfma_f32_16x16x32_bf16 v[16:19], v[104:107], v[52:55], v[16:19]
    v_xor_b32 v160, 0xc0, v4
    ds_read_b128 v[104:107], v160
    s_waitcnt lgkmcnt(6)
    v_mfma_f32_16x16x32_bf16 v[16:19], v[108:111], v[56:59], v[16:19]
    v_xor_b32 v161, 0xd0, v4
    ds_read_b128 v[108:111], v161
    s_waitcnt lgkmcnt(6)
    v_mfma_f32_16x16x32_bf16 v[16:19], v[24:27], v[60:63], v[16:19]
    v_xor_b32 v162, 0xe0, v4
    ds_read_b128 v[24:27], v162
    s_waitcnt lgkmcnt(6)
    v_mfma_f32_16x16x32_bf16 v[16:19], v[28:31], v[64:67], v[16:19]
    v_xor_b32 v160, 0xf0, v4
    ds_read_b128 v[28:31], v160
    s_waitcnt lgkmcnt(6)
    v_mfma_f32_16x16x32_bf16 v[16:19], v[164:167], v[68:71], v[16:19]
    s_waitcnt lgkmcnt(5)
    v_mfma_f32_16x16x32_bf16 v[16:19], v[96:99], v[72:75], v[16:19]
    s_waitcnt lgkmcnt(4)
    v_mfma_f32_16x16x32_bf16 v[16:19], v[100:103], v[76:79], v[16:19]
    s_waitcnt lgkmcnt(3)
    v_mfma_f32_16x16x32_bf16 v[16:19], v[104:107], v[80:83], v[16:19]
    s_waitcnt lgkmcnt(2)
    v_mfma_f32_16x16x32_bf16 v[16:19], v[108:111], v[84:87], v[16:19]
    s_waitcnt lgkmcnt(1)
    v_mfma_f32_16x16x32_bf16 v[16:19], v[24:27], v[88:91], v[16:19]
    s_waitcnt lgkmcnt(0)
    v_mfma_f32_16x16x32_bf16 v[16:19], v[28:31], v[92:95], v[16:19]
    s_barrier
    v_xor_b32 v160, 0x0, v2
    ds_read_b128 v[24:27], v160
    v_xor_b32 v161, 0x10, v2
    ds_read_b128 v[28:31], v161
    v_xor_b32 v162, 0x20, v2
    ds_read_b128 v[164:167], v162
    v_xor_b32 v160, 0x30, v2
    ds_read_b128 v[96:99], v160
    v_xor_b32 v161, 0x40, v2
    ds_read_b128 v[100:103], v161
    v_xor_b32 v162, 0x50, v2
    ds_read_b128 v[104:107], v162
    v_xor_b32 v160, 0x60, v2
    ds_read_b128 v[108:111], v160
    s_waitcnt lgkmcnt(6)
    v_mfma_f32_16x16x32_bf16 v[20:23], v[24:27], v[32:35], 0
    v_xor_b32 v161, 0x70, v2
    ds_read_b128 v[24:27], v161
    s_waitcnt lgkmcnt(6)
    v_mfma_f32_16x16x32_bf16 v[20:23], v[28:31], v[36:39], v[20:23]
    v_xor_b32 v162, 0x80, v2
    ds_read_b128 v[28:31], v162
    s_waitcnt lgkmcnt(6)
    v_mfma_f32_16x16x32_bf16 v[20:23], v[164:167], v[40:43], v[20:23]
    v_xor_b32 v160, 0x90, v2
    ds_read_b128 v[164:167], v160
    s_waitcnt lgkmcnt(6)
    v_mfma_f32_16x16x32_bf16 v[20:23], v[96:99], v[44:47], v[20:23]
    v_xor_b32 v161, 0xa0, v2
    ds_read_b128 v[96:99], v161
    s_waitcnt lgkmcnt(6)
    v_mfma_f32_16x16x32_bf16 v[20:23], v[100:103], v[48:51], v[20:23]
    v_xor_b32 v162, 0xb0, v2
    ds_read_b128 v[100:103], v162
    s_waitcnt lgkmcnt(6)
    v_mfma_f32_16x16x32_bf16 v[20:23], v[104:107], v[52:55], v[20:23]
    v_xor_b32 v160, 0xc0, v2
    ds_read_b128 v[104:107], v160
    s_waitcnt lgkmcnt(6)
    v_mfma_f32_16x16x32_bf16 v[20:23], v[108:111], v[56:59], v[20:23]
    v_xor_b32 v161, 0xd0, v2
    ds_read_b128 v[108:111], v161
    s_waitcnt lgkmcnt(6)
    v_mfma_f32_16x16x32_bf16 v[20:23], v[24:27], v[60:63], v[20:23]
    v_xor_b32 v162, 0xe0, v2
    ds_read_b128 v[24:27], v162
    s_waitcnt lgkmcnt(6)
    v_mfma_f32_16x16x32_bf16 v[20:23], v[28:31], v[64:67], v[20:23]
    v_xor_b32 v160, 0xf0, v2
    ds_read_b128 v[28:31], v160
    s_waitcnt lgkmcnt(6)
    v_mfma_f32_16x16x32_bf16 v[20:23], v[164:167], v[68:71], v[20:23]
    s_waitcnt lgkmcnt(5)
    v_mfma_f32_16x16x32_bf16 v[20:23], v[96:99], v[72:75], v[20:23]
    s_waitcnt lgkmcnt(4)
    v_mfma_f32_16x16x32_bf16 v[20:23], v[100:103], v[76:79], v[20:23]
    s_waitcnt lgkmcnt(3)
    v_mfma_f32_16x16x32_bf16 v[20:23], v[104:107], v[80:83], v[20:23]
    s_waitcnt lgkmcnt(2)
    v_mfma_f32_16x16x32_bf16 v[20:23], v[108:111], v[84:87], v[20:23]
    s_waitcnt lgkmcnt(1)
    v_mfma_f32_16x16x32_bf16 v[20:23], v[24:27], v[88:91], v[20:23]
    s_waitcnt lgkmcnt(0)
    v_mfma_f32_16x16x32_bf16 v[20:23], v[28:31], v[92:95], v[20:23]
    v_max3_f32 v160, v16, v17, v18
    s_nop 6
    v_max3_f32 v160, v160, v19, v20
    v_max3_f32 v160, v160, v21, v22
    v_max_f32 v160, v160, v23
    v_mov_b32 v161, v160
    s_nop 1
    v_permlane32_swap_b32 v160, v161
    v_max_f32 v160, v160, v161
    v_mov_b32 v161, v160
    s_nop 1
    v_permlane16_swap_b32 v160, v161
    v_max_f32 v160, v160, v161
    s_lshl_b32 s7, s64, 7
    v_add_u32 v161, s7, v5
    s_mov_b64 exec, s[86:87]
    ds_write_b32 v161, v160
    s_mov_b64 exec, -1
    s_waitcnt lgkmcnt(0)
    s_barrier
    ds_read_b32 v160, v5 offset:0
    ds_read_b32 v161, v5 offset:128
    ds_read_b32 v162, v5 offset:256
    ds_read_b32 v163, v5 offset:384
    s_waitcnt lgkmcnt(0)
    v_max3_f32 v160, v160, v161, v162
    v_max_f32 v160, v160, v163
    v_mul_f32 v160, s67, v160
    v_max_f32 v160, v160, v13
    v_sub_f32 v161, v13, v160
    v_exp_f32 v161, v161
    v_mov_b32 v13, v160
    v_fma_f32 v16, v16, s67, -v160
    v_fma_f32 v17, v17, s67, -v160
    v_fma_f32 v18, v18, s67, -v160
    v_fma_f32 v19, v19, s67, -v160
    v_fma_f32 v20, v20, s67, -v160
    v_fma_f32 v21, v21, s67, -v160
    v_fma_f32 v22, v22, s67, -v160
    v_fma_f32 v23, v23, s67, -v160
    v_exp_f32 v16, v16
    v_exp_f32 v17, v17
    v_exp_f32 v18, v18
    v_exp_f32 v19, v19
    v_exp_f32 v20, v20
    v_exp_f32 v21, v21
    v_exp_f32 v22, v22
    v_exp_f32 v23, v23
    v_cvt_pk_bf16_f32 v24, v16, v17
    v_cvt_pk_bf16_f32 v25, v18, v19
    v_cvt_pk_bf16_f32 v26, v20, v21
    v_cvt_pk_bf16_f32 v27, v22, v23
    ds_write_b64 v6, v[24:25]
    ds_write_b64 v6, v[26:27] offset:4096
    v_add_u32 v162, 0xc00, v5
    s_mov_b64 exec, s[88:89]
    ds_write_b32 v162, v161
    s_mov_b64 exec, -1
    v_mul_f32 v14, v14, v161
    v_add_f32 v16, v16, v20
    v_add_f32 v17, v17, v21
    v_add_f32 v18, v18, v22
    v_add_f32 v19, v19, v23
    v_add_f32 v16, v16, v18
    v_add_f32 v17, v17, v19
    v_add_f32 v16, v16, v17
    v_add_f32 v14, v14, v16
    v_mov_b32 v160, v14
    s_nop 1
    v_permlane32_swap_b32 v14, v160
    v_add_f32 v14, v14, v160
    v_mov_b32 v160, v14
    s_nop 1
    v_permlane16_swap_b32 v14, v160
    v_add_f32 v14, v14, v160
    s_lshl_b32 s7, s64, 7
    s_add_u32 s7, s7, 0x200
    v_add_u32 v161, s7, v5
    v_add_u32 v162, 0xc80, v5
    s_mov_b64 exec, s[86:87]
    ds_write_b32 v161, v14
    s_mov_b64 exec, s[88:89]
    ds_write_b32 v162, v13
    s_mov_b64 exec, -1
    v_and_b32 v160, 31, v1
    v_lshlrev_b32 v98, 7, v160
    v_lshrrev_b32 v161, 5, v1
    v_and_b32 v160, 7, v1
    v_xor_b32 v161, v160, v161
    v_lshl_add_u32 v98, v161, 4, v98
    s_lshl_b32 s7, s3, 12
    v_add_u32 v98, s7, v98
    v_lshl_add_u32 v99, v1, 4, s7
    v_lshrrev_b32 v161, 3, v1
    v_xor_b32 v160, v160, v161
    v_lshlrev_b32 v100, 7, v161
    v_lshl_add_u32 v100, v160, 4, v100
    s_lshl_b32 s69, s60, 15
    s_add_u32 s69, s69, s7
    s_add_u32 s69, s69, 0x500000
    s_waitcnt lgkmcnt(0)
    s_barrier
    ds_read_b32 v15, v8
    ds_read_b128 v[16:19], v7 offset:0
    ds_read_b64_tr_b16 v[24:25], v9 offset:0
    ds_read_b64_tr_b16 v[26:27], v11 offset:0
    ds_read_b64_tr_b16 v[28:29], v10 offset:0
    ds_read_b64_tr_b16 v[30:31], v12 offset:0
    s_waitcnt lgkmcnt(5)
    v_mul_f32 v128, v15, v128
    v_mul_f32 v129, v15, v129
    v_mul_f32 v130, v15, v130
    v_mul_f32 v131, v15, v131
    v_mul_f32 v132, v15, v132
    v_mul_f32 v133, v15, v133
    v_mul_f32 v134, v15, v134
    v_mul_f32 v135, v15, v135
    s_branch LC_CR
.p2align 12
LT_CR2:
    s_branch LR_CR2
LC_CR:
    v_mul_f32 v136, v15, v136
    v_mul_f32 v137, v15, v137
    v_mul_f32 v138, v15, v138
    v_mul_f32 v139, v15, v139
    v_mul_f32 v140, v15, v140
    v_mul_f32 v141, v15, v141
    v_mul_f32 v142, v15, v142
    v_mul_f32 v143, v15, v143
    v_mul_f32 v144, v15, v144
    v_mul_f32 v145, v15, v145
    v_mul_f32 v146, v15, v146
    v_mul_f32 v147, v15, v147
    v_mul_f32 v148, v15, v148
    v_mul_f32 v149, v15, v149
    v_mul_f32 v150, v15, v150
    v_mul_f32 v151, v15, v151
    v_mul_f32 v152, v15, v152
    v_mul_f32 v153, v15, v153
    v_mul_f32 v154, v15, v154
    v_mul_f32 v155, v15, v155
    v_mul_f32 v156, v15, v156
    v_mul_f32 v157, v15, v157
    v_mul_f32 v158, v15, v158
    v_mul_f32 v159, v15, v159
    ds_read_b128 v[20:23], v7 offset:1024
    ds_read_b64_tr_b16 v[160:161], v9 offset:16384
    ds_read_b64_tr_b16 v[162:163], v11 offset:16384
    ds_read_b64_tr_b16 v[164:165], v10 offset:16384
    ds_read_b64_tr_b16 v[166:167], v12 offset:16384
    s_waitcnt lgkmcnt(7)
    v_mfma_f32_32x32x16_bf16 v[128:143], v[24:27], v[16:19], v[128:143]
    s_waitcnt lgkmcnt(5)
    v_mfma_f32_32x32x16_bf16 v[144:159], v[28:31], v[16:19], v[144:159]
    ds_read_b128 v[16:19], v7 offset:2048
    ds_read_b64_tr_b16 v[24:25], v9 offset:32768
    ds_read_b64_tr_b16 v[26:27], v11 offset:32768
    ds_read_b64_tr_b16 v[28:29], v10 offset:32768
    ds_read_b64_tr_b16 v[30:31], v12 offset:32768
    s_waitcnt lgkmcnt(7)
    v_mfma_f32_32x32x16_bf16 v[128:143], v[160:163], v[20:23], v[128:143]
    s_waitcnt lgkmcnt(5)
    v_mfma_f32_32x32x16_bf16 v[144:159], v[164:167], v[20:23], v[144:159]
    ds_read_b128 v[20:23], v7 offset:3072
    ds_read_b64_tr_b16 v[160:161], v9 offset:49152
    ds_read_b64_tr_b16 v[162:163], v11 offset:49152
    ds_read_b64_tr_b16 v[164:165], v10 offset:49152
    ds_read_b64_tr_b16 v[166:167], v12 offset:49152
    s_waitcnt lgkmcnt(7)
    v_mfma_f32_32x32x16_bf16 v[128:143], v[24:27], v[16:19], v[128:143]
    s_waitcnt lgkmcnt(5)
    v_mfma_f32_32x32x16_bf16 v[144:159], v[28:31], v[16:19], v[144:159]
    v_add_u32 v9, 0x10000, v9
    v_add_u32 v10, 0x10000, v10
    v_add_u32 v11, 0x10000, v11
    v_add_u32 v12, 0x10000, v12
    ds_read_b128 v[16:19], v7 offset:4096
    ds_read_b64_tr_b16 v[24:25], v9 offset:0
    ds_read_b64_tr_b16 v[26:27], v11 offset:0
    ds_read_b64_tr_b16 v[28:29], v10 offset:0
    ds_read_b64_tr_b16 v[30:31], v12 offset:0
    s_waitcnt lgkmcnt(7)
    v_mfma_f32_32x32x16_bf16 v[128:143], v[160:163], v[20:23], v[128:143]
    s_waitcnt lgkmcnt(5)
    v_mfma_f32_32x32x16_bf16 v[144:159], v[164:167], v[20:23], v[144:159]
    s_barrier
    ds_read_b128 v[20:23], v7 offset:5120
    ds_read_b64_tr_b16 v[160:161], v9 offset:16384
    ds_read_b64_tr_b16 v[162:163], v11 offset:16384
    ds_read_b64_tr_b16 v[164:165], v10 offset:16384
    ds_read_b64_tr_b16 v[166:167], v12 offset:16384
    s_waitcnt lgkmcnt(7)
    v_mfma_f32_32x32x16_bf16 v[128:143], v[24:27], v[16:19], v[128:143]
    s_waitcnt lgkmcnt(5)
    v_mfma_f32_32x32x16_bf16 v[144:159], v[28:31], v[16:19], v[144:159]
    ds_read_b128 v[16:19], v7 offset:6144
    ds_read_b64_tr_b16 v[24:25], v9 offset:32768
    ds_read_b64_tr_b16 v[26:27], v11 offset:32768
    ds_read_b64_tr_b16 v[28:29], v10 offset:32768
    ds_read_b64_tr_b16 v[30:31], v12 offset:32768
    s_waitcnt lgkmcnt(7)
    v_mfma_f32_32x32x16_bf16 v[128:143], v[160:163], v[20:23], v[128:143]
    s_waitcnt lgkmcnt(5)
    v_mfma_f32_32x32x16_bf16 v[144:159], v[164:167], v[20:23], v[144:159]
    ds_read_b128 v[20:23], v7 offset:7168
    ds_read_b64_tr_b16 v[160:161], v9 offset:49152
    ds_read_b64_tr_b16 v[162:163], v11 offset:49152
    ds_read_b64_tr_b16 v[164:165], v10 offset:49152
    ds_read_b64_tr_b16 v[166:167], v12 offset:49152
    s_waitcnt lgkmcnt(7)
    v_mfma_f32_32x32x16_bf16 v[128:143], v[24:27], v[16:19], v[128:143]
    s_waitcnt lgkmcnt(5)
    v_mfma_f32_32x32x16_bf16 v[144:159], v[28:31], v[16:19], v[144:159]
    s_waitcnt lgkmcnt(2)
    v_mfma_f32_32x32x16_bf16 v[128:143], v[160:163], v[20:23], v[128:143]
    s_waitcnt lgkmcnt(0)
    v_mfma_f32_32x32x16_bf16 v[144:159], v[164:167], v[20:23], v[144:159]
    s_nop 9
    v_permlane32_swap_b32 v128, v132
    v_permlane32_swap_b32 v129, v133
    v_permlane32_swap_b32 v130, v134
    v_permlane32_swap_b32 v131, v135
    v_cvt_pk_bf16_f32 v16, v128, v129
    v_cvt_pk_bf16_f32 v17, v130, v131
    v_cvt_pk_bf16_f32 v18, v132, v133
    v_cvt_pk_bf16_f32 v19, v134, v135
    v_xor_b32 v160, 0x0, v98
    ds_write_b128 v160, v[16:19]
    v_permlane32_swap_b32 v136, v140
    v_permlane32_swap_b32 v137, v141
    v_permlane32_swap_b32 v138, v142
    v_permlane32_swap_b32 v139, v143
    v_cvt_pk_bf16_f32 v20, v136, v137
    v_cvt_pk_bf16_f32 v21, v138, v139
    v_cvt_pk_bf16_f32 v22, v140, v141
    v_cvt_pk_bf16_f32 v23, v142, v143
    v_xor_b32 v161, 0x20, v98
    ds_write_b128 v161, v[20:23]
    v_permlane32_swap_b32 v144, v148
    v_permlane32_swap_b32 v145, v149
    v_permlane32_swap_b32 v146, v150
    v_permlane32_swap_b32 v147, v151
    v_cvt_pk_bf16_f32 v24, v144, v145
    v_cvt_pk_bf16_f32 v25, v146, v147
    v_cvt_pk_bf16_f32 v26, v148, v149
    v_cvt_pk_bf16_f32 v27, v150, v151
    v_xor_b32 v160, 0x40, v98
    ds_write_b128 v160, v[24:27]
    v_permlane32_swap_b32 v152, v156
    v_permlane32_swap_b32 v153, v157
    v_permlane32_swap_b32 v154, v158
    v_permlane32_swap_b32 v155, v159
    v_cvt_pk_bf16_f32 v28, v152, v153
    v_cvt_pk_bf16_f32 v29, v154, v155
    v_cvt_pk_bf16_f32 v30, v156, v157
    v_cvt_pk_bf16_f32 v31, v158, v159
    v_xor_b32 v161, 0x60, v98
    ds_write_b128 v161, v[28:31]
    ds_read_b128 v[32:35], v99 offset:0
    ds_read_b128 v[36:39], v99 offset:1024
    ds_read_b128 v[40:43], v99 offset:2048
    ds_read_b128 v[44:47], v99 offset:3072
    s_waitcnt lgkmcnt(3)
    buffer_store_dwordx4 v[32:35], v100, s[36:39], s69 offen offset:0 sc1
    s_waitcnt lgkmcnt(2)
    buffer_store_dwordx4 v[36:39], v100, s[36:39], s69 offen offset:1024 sc1
    s_waitcnt lgkmcnt(1)
    buffer_store_dwordx4 v[40:43], v100, s[36:39], s69 offen offset:2048 sc1
    s_waitcnt lgkmcnt(0)
    buffer_store_dwordx4 v[44:47], v100, s[36:39], s69 offen offset:3072 sc1
    v_mov_b32 v160, 0x2404c
    s_mov_b32 s80, 1600000
LW_84:
    ds_read_b32 v161, v160
    s_waitcnt lgkmcnt(0)
    v_readfirstlane_b32 s79, v161
    s_cmp_ge_u32 s79, 1
    s_cbranch_scc1 LWD_85
    s_sleep 2
    s_sub_u32 s80, s80, 1
    s_cmp_lg_u32 s80, 0
    s_cbranch_scc1 LW_84
LWD_85:
    v_mov_b32 v160, 0x24050
    ds_read_b64 v[162:163], v160
    s_waitcnt lgkmcnt(0)
    v_readfirstlane_b32 s94, v162
    v_readfirstlane_b32 s95, v163
    v_and_b32 v160, 31, v1
    v_lshlrev_b32 v3, 2, v160
    v_add_u32 v3, 0x27400, v3
    s_lshl_b32 s7, s60, 9
    s_add_u32 s7, s7, 0xe0000
    s_cmp_eq_u32 s3, 0
    s_cselect_b32 s7, s7, 0x40000000
    v_lshl_add_u32 v4, v160, 4, s7
    v_mov_b32 v22, s94
    v_mov_b32 v23, s95
    ds_read_b32 v16, v3 offset:0
    ds_read_b32 v17, v3 offset:128
    ds_read_b32 v18, v3 offset:256
    ds_read_b32 v19, v3 offset:384
    ds_read_b32 v20, v3 offset:2688
    s_waitcnt lgkmcnt(0)
    v_add_f32 v16, v16, v17
    v_add_f32 v18, v18, v19
    v_add_f32 v21, v16, v18
    s_waitcnt vmcnt(0)
    s_barrier
    s_mov_b64 exec, 0xffffffff
    buffer_store_dwordx4 v[20:23], v4, s[36:39], 0 offen sc1
    s_mov_b64 exec, -1
    v_lshlrev_b32 v2, 4, v1
    s_mov_b32 s44, s12
    s_and_b32 s45, s13, 0xffff
    s_mov_b32 s46, 0x8000000
    s_mov_b32 s47, 0x20000
    s_bfe_u32 s7, s5, 0x10002
    s_lshl_b32 s7, s7, 6
    s_add_u32 s7, s7, s6
    s_lshl_b32 s7, s7, 20
    s_lshl_b32 s72, s3, 10
    s_add_u32 s72, s72, s7
    s_add_u32 s72, s72, 1040384
    s_add_u32 s73, s72, 0x2000000
    s_mov_b32 s74, 4
    s_sleep 60
PV_86:
    s_waitcnt vmcnt(3)
    buffer_load_dwordx4 v[8:11], v2, s[44:47], s72 offen
    s_sub_u32 s72, s72, 8192
    s_waitcnt vmcnt(3)
    buffer_load_dwordx4 v[8:11], v2, s[44:47], s73 offen
    s_sub_u32 s73, s73, 8192
    s_sub_u32 s74, s74, 1
    s_cmp_lg_u32 s74, 0
    s_cbranch_scc1 PV_86
    s_mov_b32 s52, s30
    s_and_b32 s53, s31, 0xffff
    s_mov_b32 s54, 0x2000
    s_mov_b32 s55, 0x20000
    s_lshl_b32 s7, s60, 3
    s_add_u32 s7, s7, s3
    s_lshl_b32 s7, s7, 10
    s_add_u32 s7, s7, 0x100000
    v_add_u32 v4, s7, v2
    s_bfe_u32 s7, s60, 0x20003
    s_lshl_b32 s7, s7, 11
    s_lshr_b32 s66, s60, 5
    s_lshl_b32 s66, s66, 10
    s_add_u32 s7, s7, s66
    s_and_b32 s66, s60, 7
    s_lshl_b32 s66, s66, 7
    s_add_u32 s7, s7, s66
    v_and_b32 v5, 7, v1
    v_lshl_add_u32 v5, v5, 4, s7
    v_lshrrev_b32 v6, 4, v1
    v_lshl_add_u32 v5, v6, 2, v5
    s_mov_b32 s90, 0x00ff00ff
    s_mov_b32 s91, 0x00ff00ff
    s_lshl_b32 s7, s3, 10
    s_add_u32 s7, s7, 0x25200
    v_add_u32 v6, s7, v2
    s_mov_b32 s80, 200000
PO_87:
    buffer_load_dwordx4 v[32:35], v4, s[36:39], 0 offen sc1
PO2_88:
    s_waitcnt vmcnt(0)
    v_cmp_ne_u64 vcc, s[94:95], v[34:35]
    s_cmp_lg_u64 vcc, -1
    s_cbranch_scc1 POD_89
    s_sleep 20
    s_sub_u32 s80, s80, 1
    s_cmp_lg_u32 s80, 0
    s_cbranch_scc1 PO_87
POD_89:
    v_lshlrev_b32 v64, 16, v32
    v_and_b32 v65, 0xffff0000, v32
    v_lshlrev_b32 v66, 16, v33
    v_and_b32 v67, 0xffff0000, v33
    s_cbranch_vccz RD_90
    buffer_load_dwordx4 v[32:35], v4, s[36:39], 0 offen sc1
    s_sleep 4
    buffer_load_dwordx4 v[36:39], v4, s[36:39], 0 offen sc1
    s_sleep 4
    s_mov_b32 s80, 200000
PP_91:
    s_waitcnt vmcnt(1)
    v_cmp_ne_u64 vcc, s[94:95], v[34:35]
    s_cmp_eq_u64 vcc, 0
    s_cbranch_scc1 PPO_93
    buffer_load_dwordx4 v[32:35], v4, s[36:39], 0 offen sc1
    s_waitcnt vmcnt(1)
    v_cmp_ne_u64 vcc, s[94:95], v[38:39]
    s_cmp_eq_u64 vcc, 0
    s_cbranch_scc1 PPO_94
    buffer_load_dwordx4 v[36:39], v4, s[36:39], 0 offen sc1
    s_sub_u32 s80, s80, 1
    s_cmp_lg_u32 s80, 0
    s_cbranch_scc1 PP_91
PPO_93:
    v_lshlrev_b32 v64, 16, v32
    v_and_b32 v65, 0xffff0000, v32
    v_lshlrev_b32 v66, 16, v33
    v_and_b32 v67, 0xffff0000, v33
    s_branch PPD_92
PPO_94:
    v_lshlrev_b32 v64, 16, v36
    v_and_b32 v65, 0xffff0000, v36
    v_lshlrev_b32 v66, 16, v37
    v_and_b32 v67, 0xffff0000, v37
PPD_92:
RD_90:
    ds_write_b128 v6, v[64:67]
    s_waitcnt lgkmcnt(0)
    s_barrier
    s_cmp_lg_u32 s3, 0
    s_cbranch_scc1 L_END
    ds_read_b128 v[64:67], v6 offset:0
    ds_read_b128 v[68:71], v6 offset:1024
    ds_read_b128 v[72:75], v6 offset:2048
    ds_read_b128 v[76:79], v6 offset:3072
    ds_read_b128 v[80:83], v6 offset:4096
    ds_read_b128 v[84:87], v6 offset:5120
    ds_read_b128 v[88:91], v6 offset:6144
    ds_read_b128 v[92:95], v6 offset:7168
    s_waitcnt lgkmcnt(4)
    v_pk_add_f32 v[64:65], v[64:65], v[72:73]
    v_pk_add_f32 v[66:67], v[66:67], v[74:75]
    v_pk_add_f32 v[68:69], v[68:69], v[76:77]
    v_pk_add_f32 v[70:71], v[70:71], v[78:79]
    v_pk_add_f32 v[64:65], v[64:65], v[68:69]
    v_pk_add_f32 v[66:67], v[66:67], v[70:71]
    s_waitcnt lgkmcnt(0)
    v_pk_add_f32 v[80:81], v[80:81], v[88:89]
    v_pk_add_f32 v[82:83], v[82:83], v[90:91]
    v_pk_add_f32 v[84:85], v[84:85], v[92:93]
    v_pk_add_f32 v[86:87], v[86:87], v[94:95]
    v_pk_add_f32 v[80:81], v[80:81], v[84:85]
    v_pk_add_f32 v[82:83], v[82:83], v[86:87]
    s_nop 0
    v_permlane32_swap_b32 v64, v80
    v_permlane32_swap_b32 v65, v81
    v_permlane32_swap_b32 v66, v82
    v_permlane32_swap_b32 v67, v83
    v_add_f32 v64, v64, v80
    v_add_f32 v65, v65, v81
    v_add_f32 v66, v66, v82
    v_add_f32 v67, v67, v83
    s_nop 0
    v_permlane16_swap_b32 v64, v66
    v_permlane16_swap_b32 v65, v67
    v_add_f32 v64, v64, v66
    v_add_f32 v65, v65, v67
    s_nop 0
    v_add_f32_dpp v64, v64, v64 row_ror:8 row_mask:0xf bank_mask:0xf
    v_add_f32_dpp v65, v65, v65 row_ror:8 row_mask:0xf bank_mask:0xf
    v_cvt_pk_bf16_f32 v8, v64, v65
    s_mov_b64 exec, s[90:91]
    buffer_store_dword v8, v5, s[52:55], 0 offen
    s_mov_b64 exec, -1
    s_endpgm
L_CODE_END:
.section .rodata,"a"
.p2align 6
.amdhsa_kernel concat_heads__sliding_block_cached__compressed_kv_cla__decode_kernel
  .amdhsa_next_free_vgpr 168
  .amdhsa_next_free_sgpr 102
  .amdhsa_accum_offset 168
  .amdhsa_group_segment_fixed_size 0
  .amdhsa_kernarg_size 112
  .amdhsa_user_sgpr_count 2
  .amdhsa_user_sgpr_kernarg_segment_ptr 1
  .amdhsa_system_sgpr_workgroup_id_x 1
  .amdhsa_float_denorm_mode_32 3
.end_amdhsa_kernel
```

```asm
; @launch grid=(256,1,1) block=(768,1,1) lds=163840
.amdgcn_target "amdgcn-amd-amdhsa--gfx950"
.text
.globl concat_heads__sliding_block_cached__compressed_kv_cla__decode_kernel
.p2align 12
.p2align 8
.type concat_heads__sliding_block_cached__compressed_kv_cla__decode_kernel,@function
concat_heads__sliding_block_cached__compressed_kv_cla__decode_kernel:
    s_load_dwordx16 s[8:23], s[0:1], 0
    s_load_dwordx8 s[24:31], s[0:1], 64
    s_load_dwordx4 s[32:35], s[0:1], 96
    v_lshrrev_b32 v1, 6, v0
    s_and_b32 s4, s2, 7
    v_readfirstlane_b32 s3, v1
    s_lshr_b32 s5, s2, 3
    v_and_b32 v1, 63, v0
    s_and_b32 s7, s5, 3
    s_lshl2_add_u32 s6, s4, s7
    s_cmp_ge_u32 s5, 32
    s_cbranch_scc1 L_END0
    s_cmp_ge_u32 s5, 16
    s_cbranch_scc1 EA_1
    s_cmp_ge_u32 s5, 8
    s_cbranch_scc1 EC_2
    s_cmp_ge_u32 s3, 8
    s_cbranch_scc1 L_W2
    s_cmp_ge_u32 s3, 4
    s_cbranch_scc1 L_W1
    s_branch L_W
EC_2:
    s_cmp_ge_u32 s3, 8
    s_cbranch_scc1 L_CSVC
    s_branch L_C
EA_1:
    s_cmp_eq_u32 s3, 11
    s_cbranch_scc1 L_ASVC
    s_branch L_AA
L_W2:
    s_sub_u32 s62, s3, 8
    s_lshl_b32 s7, s5, 2
    s_add_u32 s7, s7, s62
    s_lshl_b32 s7, s7, 17
    s_lshl_b32 s70, s4, 10
    s_add_u32 s70, s70, s7
    s_lshl_b32 s71, s62, 14
    v_lshlrev_b32 v2, 4, v1
    s_lshl_b32 s7, s62, 6
    v_xor_b32 v4, s7, v2
    v_xor_b32 v5, 16, v4
    v_xor_b32 v6, 32, v4
    v_xor_b32 v7, 48, v4
    s_waitcnt lgkmcnt(0)
    s_lshl_b32 s7, s2, 4
    s_add_u32 s7, s7, s3
    s_cmp_lg_u32 s7, 8
    s_cbranch_scc1 NM_67
    s_memrealtime s[94:95]
    s_mov_b32 s40, s32
    s_and_b32 s41, s33, 0xffff
    s_mov_b32 s42, 0x100
    s_mov_b32 s43, 0x20000
    v_mov_b32 v8, 0
    s_waitcnt lgkmcnt(0)
    s_or_b32 s95, s95, 0x80000000
    v_mov_b32 v10, s94
    v_mov_b32 v11, s95
    s_mov_b64 exec, 1
    buffer_store_dwordx2 v[10:11], v8, s[40:43], 0 offen sc1
    s_mov_b64 exec, -1
NM_67:
    s_mov_b32 s52, s24
    s_and_b32 s53, s25, 0xffff
    s_mov_b32 s54, 0x400000
    s_mov_b32 s55, 0x20000
    s_mov_b32 m0, s71
    s_nop 0
    buffer_load_dwordx4 v4, s[52:55], s70 offen nt lds
    s_addk_i32 s70, 8192
    s_addk_i32 s71, 1024
    s_mov_b32 m0, s71
    s_nop 0
    buffer_load_dwordx4 v4, s[52:55], s70 offen nt lds
    s_addk_i32 s70, 8192
    s_addk_i32 s71, 1024
    s_mov_b32 m0, s71
    s_nop 0
    buffer_load_dwordx4 v4, s[52:55], s70 offen nt lds
    s_addk_i32 s70, 8192
    s_addk_i32 s71, 1024
    s_mov_b32 m0, s71
    s_nop 0
    buffer_load_dwordx4 v4, s[52:55], s70 offen nt lds
    s_addk_i32 s70, 8192
    s_addk_i32 s71, 1024
    s_mov_b32 m0, s71
    s_nop 0
    buffer_load_dwordx4 v5, s[52:55], s70 offen nt lds
    s_addk_i32 s70, 8192
    s_addk_i32 s71, 1024
    s_mov_b32 m0, s71
    s_nop 0
    buffer_load_dwordx4 v5, s[52:55], s70 offen nt lds
    s_addk_i32 s70, 8192
    s_addk_i32 s71, 1024
    s_mov_b32 m0, s71
    s_nop 0
    buffer_load_dwordx4 v5, s[52:55], s70 offen nt lds
    s_addk_i32 s70, 8192
    s_addk_i32 s71, 1024
    s_mov_b32 m0, s71
    s_nop 0
    buffer_load_dwordx4 v5, s[52:55], s70 offen nt lds
    s_addk_i32 s70, 8192
    s_addk_i32 s71, 1024
    s_branch L_W2B
L_AA:
    s_cmp_ge_u32 s3, 8
    s_cbranch_scc1 AK_3
    s_and_b32 s7, s5, 12
    s_and_b32 s66, s3, 3
    s_add_u32 s7, s7, s66
    v_lshrrev_b32 v2, 4, v1
    v_lshlrev_b32 v3, 16, v2
    v_and_b32 v4, 15, v1
    v_lshl_add_u32 v3, v4, 4, v3
    s_lshl_b32 s66, s7, 18
    s_lshl_b32 s67, s6, 8
    s_add_u32 s66, s66, s67
    s_cmp_lt_u32 s3, 4
    s_cbranch_scc1 AP_5
    s_xor_b32 s66, s66, 512
    s_barrier
    v_mov_b32 v8, 0x24000
    s_mov_b32 s80, 1600000
LW_6:
    ds_read_b32 v9, v8
    s_waitcnt lgkmcnt(0)
    v_readfirstlane_b32 s79, v9
    s_cmp_ge_u32 s79, 1
    s_cbranch_scc1 LWD_7
    s_sleep 1
    s_sub_u32 s80, s80, 1
    s_cmp_lg_u32 s80, 0
    s_cbranch_scc1 LW_6
LWD_7:
AP_5:
    s_cmp_lt_u32 s3, 4
    s_waitcnt lgkmcnt(0)
    s_cselect_b32 s72, s22, s14
    s_cselect_b32 s73, s23, s15
    s_cselect_b32 s70, s18, s8
    s_cselect_b32 s71, s19, s9
    s_mov_b32 s56, s72
    s_and_b32 s57, s73, 0xffff
    s_mov_b32 s58, 0x400000
    s_mov_b32 s59, 0x20000
    buffer_load_dwordx4 v[128:131], v3, s[56:59], s66 offen nt
    s_addk_i32 s66, 8192
    buffer_load_dwordx4 v[132:135], v3, s[56:59], s66 offen nt
    s_addk_i32 s66, 8192
    buffer_load_dwordx4 v[136:139], v3, s[56:59], s66 offen nt
    s_addk_i32 s66, 8192
    buffer_load_dwordx4 v[140:143], v3, s[56:59], s66 offen nt
    s_addk_i32 s66, 8192
    buffer_load_dwordx4 v[144:147], v3, s[56:59], s66 offen nt
    s_addk_i32 s66, 8192
    buffer_load_dwordx4 v[148:151], v3, s[56:59], s66 offen nt
    s_addk_i32 s66, 8192
    buffer_load_dwordx4 v[152:155], v3, s[56:59], s66 offen nt
    s_addk_i32 s66, 8192
    buffer_load_dwordx4 v[156:159], v3, s[56:59], s66 offen nt
    s_addk_i32 s66, 8192
    s_branch L_AB
L_C:
    s_lshl_b32 s60, s4, 3
    s_add_u32 s60, s60, s5
    s_sub_u32 s60, s60, 8
    v_lshlrev_b32 v160, 4, v1
    s_and_b32 s7, s3, 3
    s_lshl_b32 s7, s7, 2
    s_lshr_b32 s66, s3, 2
    s_or_b32 s7, s7, s66
    s_lshl_b32 s62, s7, 4
    v_xor_b32 v2, s62, v160
    v_xor_b32 v3, 32, v2
    s_lshl_b32 s70, s60, 18
    s_lshl_b32 s68, s3, 10
    s_add_u32 s61, s70, s68
    s_waitcnt lgkmcnt(0)
    s_mov_b32 s44, s20
    s_and_b32 s45, s21, 0xffff
    s_mov_b32 s46, 0x1000000
    s_mov_b32 s47, 0x20000
    s_mov_b32 m0, s68
    s_nop 0
    buffer_load_dwordx4 v2, s[44:47], s61 offen nt lds
    s_addk_i32 s68, 8192
    s_addk_i32 s61, 8192
    s_mov_b32 m0, s68
    s_nop 0
    buffer_load_dwordx4 v3, s[44:47], s61 offen nt lds
    s_addk_i32 s68, 8192
    s_addk_i32 s61, 8192
    s_mov_b32 m0, s68
    s_nop 0
    buffer_load_dwordx4 v2, s[44:47], s61 offen nt lds
    s_addk_i32 s68, 8192
    s_addk_i32 s61, 8192
    s_mov_b32 m0, s68
    s_nop 0
    buffer_load_dwordx4 v3, s[44:47], s61 offen nt lds
    s_addk_i32 s68, 8192
    s_branch L_CB
L_AB:
    v_bfe_u32 v4, v1, 2, 2
    v_lshlrev_b32 v4, 10, v4
    v_lshl_add_u32 v4, v2, 4, v4
    s_lshl_b32 s67, s7, 6
    s_mov_b32 s52, s70
    s_and_b32 s53, s71, 0xffff
    s_mov_b32 s54, 0x1000
    s_mov_b32 s55, 0x20000
    buffer_load_dwordx4 v[160:163], v4, s[52:55], s67 offen
    s_mov_b32 s92, 0x05040100
    s_mov_b32 s93, 0x07060302
    s_mov_b32 s36, s34
    s_and_b32 s37, s35, 0xffff
    s_mov_b32 s38, 0x1000000
    s_mov_b32 s39, 0x20000
    s_mov_b32 s40, s32
    s_and_b32 s41, s33, 0xffff
    s_mov_b32 s42, 0x100
    s_mov_b32 s43, 0x20000
    s_mov_b32 s44, s10
    s_and_b32 s45, s11, 0xffff
    s_mov_b32 s46, 0x8000000
    s_mov_b32 s47, 0x20000
    s_mov_b32 s48, s12
    s_and_b32 s49, s13, 0xffff
    s_mov_b32 s50, 0x8000000
    s_mov_b32 s51, 0x20000
    s_lshr_b32 s7, s5, 2
    s_sub_u32 s7, s7, 4
    s_lshl_b32 s7, s7, 5
    s_add_u32 s7, s7, s6
    s_lshl_b32 s7, s7, 20
    s_add_u32 s7, s7, 0xC0000
    v_lshlrev_b32 v6, 4, v1
    v_add_u32 v6, s7, v6
    s_mov_b32 s64, 0x3e0293ee
    s_lshl_b32 s60, s3, 12
    s_mov_b32 s61, s60
    s_cmp_ge_u32 s3, 8
    s_cselect_b32 s7, 5, 0
    s_sub_u32 s7, s3, s7
    s_mul_i32 s7, s7, 6144
    s_add_u32 s63, s7, 225280
    s_add_u32 s65, s63, 4096
    s_sub_u32 s7, s3, 3
    s_cmp_lt_u32 s7, 5
    s_cselect_b32 s62, 0xff800000, 0
    s_cmp_ge_u32 s3, 4
    s_cbranch_scc1 AP_8
    s_barrier
AP_8:
    s_lshl_b32 s7, s3, 11
    s_add_u32 s7, s7, 0x0
    v_lshl_add_u32 v2, v1, 5, s7
    s_cmp_lt_u32 s3, 4
    s_cselect_b32 s7, 0x44, 0x40
    s_add_u32 s7, s7, 0x24000
    v_mov_b32 v3, s7
    v_mov_b32 v4, 1
    s_waitcnt vmcnt(0)
    v_perm_b32 v96, v132, v128, s92
    v_perm_b32 v97, v140, v136, s92
    v_perm_b32 v98, v148, v144, s92
    v_perm_b32 v99, v156, v152, s92
    v_perm_b32 v100, v132, v128, s93
    v_perm_b32 v101, v140, v136, s93
    v_perm_b32 v102, v148, v144, s93
    v_perm_b32 v103, v156, v152, s93
    v_perm_b32 v104, v133, v129, s92
    v_perm_b32 v105, v141, v137, s92
    v_perm_b32 v106, v149, v145, s92
    v_perm_b32 v107, v157, v153, s92
    v_perm_b32 v108, v133, v129, s93
    v_perm_b32 v109, v141, v137, s93
    v_perm_b32 v110, v149, v145, s93
    v_perm_b32 v111, v157, v153, s93
    v_perm_b32 v112, v134, v130, s92
    v_perm_b32 v113, v142, v138, s92
    v_perm_b32 v114, v150, v146, s92
    v_perm_b32 v115, v158, v154, s92
    v_perm_b32 v116, v134, v130, s93
    v_perm_b32 v117, v142, v138, s93
    v_perm_b32 v118, v150, v146, s93
    v_perm_b32 v119, v158, v154, s93
    v_perm_b32 v120, v135, v131, s92
    v_perm_b32 v121, v143, v139, s92
    v_perm_b32 v122, v151, v147, s92
    v_perm_b32 v123, v159, v155, s92
    v_perm_b32 v124, v135, v131, s93
    v_perm_b32 v125, v143, v139, s93
    v_perm_b32 v126, v151, v147, s93
    v_perm_b32 v127, v159, v155, s93
    v_mfma_f32_16x16x32_bf16 v[64:67], v[160:163], v[96:99], 0
    v_mfma_f32_16x16x32_bf16 v[68:71], v[160:163], v[100:103], 0
    v_mfma_f32_16x16x32_bf16 v[72:75], v[160:163], v[104:107], 0
    v_mfma_f32_16x16x32_bf16 v[76:79], v[160:163], v[108:111], 0
    v_mfma_f32_16x16x32_bf16 v[80:83], v[160:163], v[112:115], 0
    v_mfma_f32_16x16x32_bf16 v[84:87], v[160:163], v[116:119], 0
    v_mfma_f32_16x16x32_bf16 v[88:91], v[160:163], v[120:123], 0
    v_mfma_f32_16x16x32_bf16 v[92:95], v[160:163], v[124:127], 0
    s_nop 0
    v_mov_b32 v128, v64
    v_mov_b32 v129, v68
    v_mov_b32 v130, v72
    v_mov_b32 v131, v76
    v_mov_b32 v132, v80
    v_mov_b32 v133, v84
    v_mov_b32 v134, v88
    v_mov_b32 v135, v92
    ds_write_b128 v2, v[128:131]
    ds_write_b128 v2, v[132:135] offset:16
    s_waitcnt lgkmcnt(0)
    s_mov_b64 exec, 1
    ds_add_u32 v3, v4
    s_mov_b64 exec, -1
    s_branch AJ_4
AK_3:
    s_waitcnt lgkmcnt(0)
    s_mov_b32 s92, 0x05040100
    s_mov_b32 s93, 0x07060302
    s_mov_b32 s36, s34
    s_and_b32 s37, s35, 0xffff
    s_mov_b32 s38, 0x1000000
    s_mov_b32 s39, 0x20000
    s_mov_b32 s40, s32
    s_and_b32 s41, s33, 0xffff
    s_mov_b32 s42, 0x100
    s_mov_b32 s43, 0x20000
    s_mov_b32 s44, s10
    s_and_b32 s45, s11, 0xffff
    s_mov_b32 s46, 0x8000000
    s_mov_b32 s47, 0x20000
    s_mov_b32 s48, s12
    s_and_b32 s49, s13, 0xffff
    s_mov_b32 s50, 0x8000000
    s_mov_b32 s51, 0x20000
    s_lshr_b32 s7, s5, 2
    s_sub_u32 s7, s7, 4
    s_lshl_b32 s7, s7, 5
    s_add_u32 s7, s7, s6
    s_lshl_b32 s7, s7, 20
    s_add_u32 s7, s7, 0xC0000
    v_lshlrev_b32 v6, 4, v1
    v_add_u32 v6, s7, v6
    s_mov_b32 s64, 0x3e0293ee
    s_lshl_b32 s60, s3, 12
    s_mov_b32 s61, s60
    s_cmp_ge_u32 s3, 8
    s_cselect_b32 s7, 5, 0
    s_sub_u32 s7, s3, s7
    s_mul_i32 s7, s7, 6144
    s_add_u32 s63, s7, 225280
    s_add_u32 s65, s63, 4096
    s_sub_u32 s7, s3, 3
    s_cmp_lt_u32 s7, 5
    s_cselect_b32 s62, 0xff800000, 0
    s_barrier
    s_cmp_eq_u32 s3, 8
    s_cbranch_scc1 LT_AR
LR_AR:
    s_cmp_eq_u32 s3, 9
    s_cbranch_scc1 LT_AR2
LR_AR2:
    v_mov_b32 v8, 0x24044
    s_mov_b32 s80, 1600000
LW_9:
    ds_read_b32 v9, v8
    s_waitcnt lgkmcnt(0)
    v_readfirstlane_b32 s79, v9
    s_cmp_ge_u32 s79, 1
    s_cbranch_scc1 LWD_10
    s_sleep 2
    s_sub_u32 s80, s80, 1
    s_cmp_lg_u32 s80, 0
    s_cbranch_scc1 LW_9
LWD_10:
AJ_4:
    s_branch L_AR
L_W2B:
    s_cmp_lg_u32 s3, 11
    s_cbranch_scc1 Z_68
    v_lshlrev_b32 v2, 2, v1
    v_add_u32 v2, 0x24000, v2
    v_mov_b32 v3, 0
    ds_write_b32 v2, v3
Z_68:
    s_waitcnt lgkmcnt(0)
    s_mov_b32 s92, 0x05040100
    s_mov_b32 s93, 0x07060302
    s_mov_b32 s36, s34
    s_and_b32 s37, s35, 0xffff
    s_mov_b32 s38, 0x1000000
    s_mov_b32 s39, 0x20000
    s_mov_b32 s40, s32
    s_and_b32 s41, s33, 0xffff
    s_mov_b32 s42, 0x100
    s_mov_b32 s43, 0x20000
    s_barrier
    s_mov_b32 m0, s71
    s_waitcnt vmcnt(7)
    buffer_load_dwordx4 v6, s[52:55], s70 offen nt lds
    s_addk_i32 s70, 8192
    s_addk_i32 s71, 1024
    s_mov_b32 m0, s71
    s_waitcnt vmcnt(7)
    buffer_load_dwordx4 v6, s[52:55], s70 offen nt lds
    s_addk_i32 s70, 8192
    s_addk_i32 s71, 1024
    s_mov_b32 m0, s71
    s_waitcnt vmcnt(7)
    buffer_load_dwordx4 v6, s[52:55], s70 offen nt lds
    s_addk_i32 s70, 8192
    s_addk_i32 s71, 1024
    s_mov_b32 m0, s71
    s_waitcnt vmcnt(7)
    buffer_load_dwordx4 v6, s[52:55], s70 offen nt lds
    s_addk_i32 s70, 8192
    s_addk_i32 s71, 1024
    s_mov_b32 m0, s71
    s_waitcnt vmcnt(7)
    buffer_load_dwordx4 v7, s[52:55], s70 offen nt lds
    s_addk_i32 s70, 8192
    s_addk_i32 s71, 1024
    s_mov_b32 m0, s71
    s_waitcnt vmcnt(7)
    buffer_load_dwordx4 v7, s[52:55], s70 offen nt lds
    s_addk_i32 s70, 8192
    s_addk_i32 s71, 1024
    s_mov_b32 m0, s71
    s_waitcnt vmcnt(7)
    buffer_load_dwordx4 v7, s[52:55], s70 offen nt lds
    s_addk_i32 s70, 8192
    s_addk_i32 s71, 1024
    s_mov_b32 m0, s71
    s_waitcnt vmcnt(7)
    buffer_load_dwordx4 v7, s[52:55], s70 offen nt lds
    s_addk_i32 s70, 8192
    s_addk_i32 s71, 1024
    s_branch L_W2R
L_CB:
    s_mov_b32 s92, 0x05040100
    s_mov_b32 s93, 0x07060302
    s_mov_b32 s36, s34
    s_and_b32 s37, s35, 0xffff
    s_mov_b32 s38, 0x1000000
    s_mov_b32 s39, 0x20000
    s_mov_b32 s40, s32
    s_and_b32 s41, s33, 0xffff
    s_mov_b32 s42, 0x100
    s_mov_b32 s43, 0x20000
    s_lshr_b32 s64, s3, 1
    s_and_b32 s65, s3, 1
    s_mov_b32 s67, 0x3e0293ee
    s_barrier
    s_addk_i32 s61, 8192
    s_mov_b32 m0, s68
    s_waitcnt vmcnt(3)
    buffer_load_dwordx4 v2, s[44:47], s61 offen nt lds
    s_addk_i32 s68, 8192
    s_addk_i32 s61, 8192
    s_mov_b32 m0, s68
    s_waitcnt vmcnt(3)
    buffer_load_dwordx4 v3, s[44:47], s61 offen nt lds
    s_addk_i32 s68, 8192
    s_addk_i32 s61, 8192
    s_mov_b32 m0, s68
    s_waitcnt vmcnt(3)
    buffer_load_dwordx4 v2, s[44:47], s61 offen nt lds
    s_addk_i32 s68, 8192
    s_addk_i32 s61, 8192
    s_mov_b32 m0, s68
    s_waitcnt vmcnt(3)
    buffer_load_dwordx4 v3, s[44:47], s61 offen nt lds
    s_addk_i32 s68, 8192
    s_addk_i32 s61, 8192
    s_mov_b32 m0, s68
    s_waitcnt vmcnt(3)
    buffer_load_dwordx4 v2, s[44:47], s61 offen nt lds
    s_addk_i32 s68, 8192
    s_addk_i32 s61, 8192
    s_mov_b32 m0, s68
    s_waitcnt vmcnt(3)
    buffer_load_dwordx4 v3, s[44:47], s61 offen nt lds
    s_addk_i32 s68, 8192
    s_addk_i32 s61, 8192
    s_mov_b32 m0, s68
    s_waitcnt vmcnt(3)
    buffer_load_dwordx4 v2, s[44:47], s61 offen nt lds
    s_addk_i32 s68, 8192
    s_addk_i32 s61, 8192
    s_mov_b32 m0, s68
    s_waitcnt vmcnt(3)
    buffer_load_dwordx4 v3, s[44:47], s61 offen nt lds
    s_addk_i32 s68, 8192
    s_addk_i32 s61, 8192
    s_waitcnt vmcnt(3)
    buffer_load_dwordx4 v[128:131], v2, s[44:47], s61 offen nt
    s_addk_i32 s61, 8192
    s_waitcnt vmcnt(3)
    buffer_load_dwordx4 v[132:135], v3, s[44:47], s61 offen nt
    s_addk_i32 s61, 8192
    s_waitcnt vmcnt(3)
    buffer_load_dwordx4 v[136:139], v2, s[44:47], s61 offen nt
    s_addk_i32 s61, 8192
    s_waitcnt vmcnt(3)
    buffer_load_dwordx4 v[140:143], v3, s[44:47], s61 offen nt
    s_addk_i32 s61, 8192
    s_waitcnt vmcnt(3)
    buffer_load_dwordx4 v[96:99], v2, s[44:47], s61 offen nt
    s_addk_i32 s61, 8192
    s_waitcnt vmcnt(3)
    buffer_load_dwordx4 v[100:103], v3, s[44:47], s61 offen nt
    s_addk_i32 s61, 8192
    s_waitcnt vmcnt(3)
    buffer_load_dwordx4 v[104:107], v2, s[44:47], s61 offen nt
    s_addk_i32 s61, 8192
    s_waitcnt vmcnt(3)
    buffer_load_dwordx4 v[108:111], v3, s[44:47], s61 offen nt
    s_addk_i32 s61, 8192
    s_waitcnt vmcnt(3)
    buffer_load_dwordx4 v[112:115], v2, s[44:47], s61 offen nt
    s_addk_i32 s61, 8192
    s_waitcnt vmcnt(3)
    buffer_load_dwordx4 v[116:119], v3, s[44:47], s61 offen nt
    s_addk_i32 s61, 8192
    v_mov_b32 v160, 0x24018
    v_mov_b32 v161, 1
    s_waitcnt lgkmcnt(0)
    s_mov_b64 exec, 1
    ds_add_u32 v160, v161
    s_mov_b64 exec, -1
    s_waitcnt vmcnt(3)
    buffer_load_dwordx4 v[120:123], v2, s[44:47], s61 offen nt
    s_addk_i32 s61, 8192
    s_waitcnt vmcnt(3)
    buffer_load_dwordx4 v[124:127], v3, s[44:47], s61 offen nt
    s_addk_i32 s61, 8192
    s_branch L_CR
L_END:
    s_endpgm
L_END0:
    s_endpgm
.p2align 12
LT_AR:
    s_branch LR_AR
L_AR:
    v_mov_b32 v34, 0
    v_mov_b32 v35, 0
    v_mov_b32 v36, 0
    v_mov_b32 v37, 0
    v_mov_b32 v38, 0
    v_mov_b32 v39, 0
    v_mov_b32 v40, 0
    v_mov_b32 v41, 0
    v_mov_b32 v42, 0
    v_mov_b32 v43, 0
    v_mov_b32 v44, 0
    v_mov_b32 v45, 0
    v_mov_b32 v46, 0
    v_mov_b32 v47, 0
    v_mov_b32 v48, 0
    v_mov_b32 v49, 0
    v_mov_b32 v50, 0
    v_mov_b32 v51, 0
    v_mov_b32 v52, 0
    v_mov_b32 v53, 0
    v_mov_b32 v54, 0
    v_mov_b32 v55, 0
    v_mov_b32 v56, 0
    v_mov_b32 v57, 0
    s_cmp_lg_u32 s62, 0
    s_cbranch_scc1 L_AK2
    buffer_load_dwordx4 v[34:37], v6, s[44:47], s63 offen offset:0 nt
    buffer_load_dwordx4 v[38:41], v6, s[44:47], s63 offen offset:1024 nt
    buffer_load_dwordx4 v[42:45], v6, s[44:47], s63 offen offset:2048 nt
    buffer_load_dwordx4 v[46:49], v6, s[44:47], s63 offen offset:3072 nt
    buffer_load_dwordx4 v[50:53], v6, s[44:47], s65 offen offset:0 nt
    buffer_load_dwordx4 v[54:57], v6, s[44:47], s65 offen offset:1024 nt
L_AK2:
    s_waitcnt vmcnt(0)
    buffer_load_dwordx4 v[58:61], v6, s[44:47], s60 offen offset:0 nt
    buffer_load_dwordx4 v[62:65], v6, s[44:47], s60 offen offset:1024 nt
    buffer_load_dwordx4 v[66:69], v6, s[44:47], s60 offen offset:2048 nt
    buffer_load_dwordx4 v[70:73], v6, s[44:47], s60 offen offset:3072 nt
    s_add_u32 s60, s60, 45056
    s_waitcnt vmcnt(0)
    buffer_load_dwordx4 v[74:77], v6, s[44:47], s60 offen offset:0 nt
    buffer_load_dwordx4 v[78:81], v6, s[44:47], s60 offen offset:1024 nt
    buffer_load_dwordx4 v[82:85], v6, s[44:47], s60 offen offset:2048 nt
    buffer_load_dwordx4 v[86:89], v6, s[44:47], s60 offen offset:3072 nt
    s_add_u32 s60, s60, 45056
    s_waitcnt vmcnt(0)
    buffer_load_dwordx4 v[90:93], v6, s[44:47], s60 offen offset:0 nt
    buffer_load_dwordx4 v[94:97], v6, s[44:47], s60 offen offset:1024 nt
    buffer_load_dwordx4 v[98:101], v6, s[44:47], s60 offen offset:2048 nt
    buffer_load_dwordx4 v[102:105], v6, s[44:47], s60 offen offset:3072 nt
    s_add_u32 s60, s60, 45056
    v_mov_b32 v160, 0x24004
    s_mov_b32 s80, 1600000
LW_11:
    ds_read_b32 v161, v160
    s_waitcnt lgkmcnt(0)
    v_readfirstlane_b32 s79, v161
    s_cmp_ge_u32 s79, 1
    s_cbranch_scc1 LWD_12
    s_sleep 4
    s_sub_u32 s80, s80, 1
    s_cmp_lg_u32 s80, 0
    s_cbranch_scc1 LW_11
LWD_12:
    v_and_b32 v160, 15, v1
    v_lshlrev_b32 v160, 4, v160
    v_add_u32 v160, 0x24100, v160
    ds_read_b128 v[2:5], v160
    s_waitcnt lgkmcnt(0)
    v_dot2_f32_bf16 v8, v34, v2, 0
    v_dot2_f32_bf16 v9, v38, v2, 0
    v_dot2_f32_bf16 v10, v42, v2, 0
    v_dot2_f32_bf16 v11, v46, v2, 0
    v_dot2_f32_bf16 v12, v50, v2, 0
    v_dot2_f32_bf16 v13, v54, v2, 0
    v_dot2_f32_bf16 v8, v35, v3, v8
    v_dot2_f32_bf16 v9, v39, v3, v9
    v_dot2_f32_bf16 v10, v43, v3, v10
    v_dot2_f32_bf16 v11, v47, v3, v11
    v_dot2_f32_bf16 v12, v51, v3, v12
    v_dot2_f32_bf16 v13, v55, v3, v13
    v_dot2_f32_bf16 v8, v36, v4, v8
    v_dot2_f32_bf16 v9, v40, v4, v9
    v_dot2_f32_bf16 v10, v44, v4, v10
    v_dot2_f32_bf16 v11, v48, v4, v11
    v_dot2_f32_bf16 v12, v52, v4, v12
    v_dot2_f32_bf16 v13, v56, v4, v13
    v_dot2_f32_bf16 v8, v37, v5, v8
    v_dot2_f32_bf16 v9, v41, v5, v9
    v_dot2_f32_bf16 v10, v45, v5, v10
    v_dot2_f32_bf16 v11, v49, v5, v11
    v_dot2_f32_bf16 v12, v53, v5, v12
    v_dot2_f32_bf16 v13, v57, v5, v13
    v_add_f32_dpp v8, v8, v8 row_ror:8 row_mask:0xf bank_mask:0xf
    v_add_f32_dpp v9, v9, v9 row_ror:8 row_mask:0xf bank_mask:0xf
    v_add_f32_dpp v10, v10, v10 row_ror:8 row_mask:0xf bank_mask:0xf
    v_add_f32_dpp v11, v11, v11 row_ror:8 row_mask:0xf bank_mask:0xf
    v_add_f32_dpp v12, v12, v12 row_ror:8 row_mask:0xf bank_mask:0xf
    v_add_f32_dpp v13, v13, v13 row_ror:8 row_mask:0xf bank_mask:0xf
    v_add_f32_dpp v8, v8, v8 row_ror:4 row_mask:0xf bank_mask:0xf
    v_add_f32_dpp v9, v9, v9 row_ror:4 row_mask:0xf bank_mask:0xf
    v_add_f32_dpp v10, v10, v10 row_ror:4 row_mask:0xf bank_mask:0xf
    v_add_f32_dpp v11, v11, v11 row_ror:4 row_mask:0xf bank_mask:0xf
    v_add_f32_dpp v12, v12, v12 row_ror:4 row_mask:0xf bank_mask:0xf
    v_add_f32_dpp v13, v13, v13 row_ror:4 row_mask:0xf bank_mask:0xf
    v_add_f32_dpp v8, v8, v8 row_ror:2 row_mask:0xf bank_mask:0xf
    v_add_f32_dpp v9, v9, v9 row_ror:2 row_mask:0xf bank_mask:0xf
    v_add_f32_dpp v10, v10, v10 row_ror:2 row_mask:0xf bank_mask:0xf
    v_add_f32_dpp v11, v11, v11 row_ror:2 row_mask:0xf bank_mask:0xf
    v_add_f32_dpp v12, v12, v12 row_ror:2 row_mask:0xf bank_mask:0xf
    v_add_f32_dpp v13, v13, v13 row_ror:2 row_mask:0xf bank_mask:0xf
    v_add_f32_dpp v8, v8, v8 row_ror:1 row_mask:0xf bank_mask:0xf
    v_add_f32_dpp v9, v9, v9 row_ror:1 row_mask:0xf bank_mask:0xf
    v_add_f32_dpp v10, v10, v10 row_ror:1 row_mask:0xf bank_mask:0xf
    v_add_f32_dpp v11, v11, v11 row_ror:1 row_mask:0xf bank_mask:0xf
    v_add_f32_dpp v12, v12, v12 row_ror:1 row_mask:0xf bank_mask:0xf
    v_add_f32_dpp v13, v13, v13 row_ror:1 row_mask:0xf bank_mask:0xf
    v_dot2_f32_bf16 v14, v58, v2, 0
    v_dot2_f32_bf16 v15, v62, v2, 0
    v_dot2_f32_bf16 v16, v66, v2, 0
    v_dot2_f32_bf16 v17, v70, v2, 0
    v_dot2_f32_bf16 v14, v59, v3, v14
    v_dot2_f32_bf16 v15, v63, v3, v15
    v_dot2_f32_bf16 v16, v67, v3, v16
    v_dot2_f32_bf16 v17, v71, v3, v17
    v_dot2_f32_bf16 v14, v60, v4, v14
    v_dot2_f32_bf16 v15, v64, v4, v15
    v_dot2_f32_bf16 v16, v68, v4, v16
    v_dot2_f32_bf16 v17, v72, v4, v17
    v_dot2_f32_bf16 v14, v61, v5, v14
    v_dot2_f32_bf16 v15, v65, v5, v15
    v_dot2_f32_bf16 v16, v69, v5, v16
    v_dot2_f32_bf16 v17, v73, v5, v17
    v_add_f32_dpp v14, v14, v14 row_ror:8 row_mask:0xf bank_mask:0xf
    v_add_f32_dpp v15, v15, v15 row_ror:8 row_mask:0xf bank_mask:0xf
    v_add_f32_dpp v16, v16, v16 row_ror:8 row_mask:0xf bank_mask:0xf
    v_add_f32_dpp v17, v17, v17 row_ror:8 row_mask:0xf bank_mask:0xf
    v_add_f32_dpp v14, v14, v14 row_ror:4 row_mask:0xf bank_mask:0xf
    v_add_f32_dpp v15, v15, v15 row_ror:4 row_mask:0xf bank_mask:0xf
    v_add_f32_dpp v16, v16, v16 row_ror:4 row_mask:0xf bank_mask:0xf
    v_add_f32_dpp v17, v17, v17 row_ror:4 row_mask:0xf bank_mask:0xf
    v_add_f32_dpp v14, v14, v14 row_ror:2 row_mask:0xf bank_mask:0xf
    v_add_f32_dpp v15, v15, v15 row_ror:2 row_mask:0xf bank_mask:0xf
    v_add_f32_dpp v16, v16, v16 row_ror:2 row_mask:0xf bank_mask:0xf
    v_add_f32_dpp v17, v17, v17 row_ror:2 row_mask:0xf bank_mask:0xf
    v_add_f32_dpp v14, v14, v14 row_ror:1 row_mask:0xf bank_mask:0xf
    v_add_f32_dpp v15, v15, v15 row_ror:1 row_mask:0xf bank_mask:0xf
    v_add_f32_dpp v16, v16, v16 row_ror:1 row_mask:0xf bank_mask:0xf
    v_add_f32_dpp v17, v17, v17 row_ror:1 row_mask:0xf bank_mask:0xf
    s_waitcnt vmcnt(0)
    buffer_load_dwordx4 v[106:109], v6, s[44:47], s60 offen offset:0 nt
    buffer_load_dwordx4 v[110:113], v6, s[44:47], s60 offen offset:1024 nt
    buffer_load_dwordx4 v[114:117], v6, s[44:47], s60 offen offset:2048 nt
    buffer_load_dwordx4 v[118:121], v6, s[44:47], s60 offen offset:3072 nt
    s_add_u32 s60, s60, 45056
    v_dot2_f32_bf16 v18, v74, v2, 0
    v_dot2_f32_bf16 v19, v78, v2, 0
    v_dot2_f32_bf16 v20, v82, v2, 0
    v_dot2_f32_bf16 v21, v86, v2, 0
    v_dot2_f32_bf16 v18, v75, v3, v18
    v_dot2_f32_bf16 v19, v79, v3, v19
    v_dot2_f32_bf16 v20, v83, v3, v20
    v_dot2_f32_bf16 v21, v87, v3, v21
    v_dot2_f32_bf16 v18, v76, v4, v18
    v_dot2_f32_bf16 v19, v80, v4, v19
    v_dot2_f32_bf16 v20, v84, v4, v20
    v_dot2_f32_bf16 v21, v88, v4, v21
    v_dot2_f32_bf16 v18, v77, v5, v18
    v_dot2_f32_bf16 v19, v81, v5, v19
    v_dot2_f32_bf16 v20, v85, v5, v20
    v_dot2_f32_bf16 v21, v89, v5, v21
    v_add_f32_dpp v18, v18, v18 row_ror:8 row_mask:0xf bank_mask:0xf
    v_add_f32_dpp v19, v19, v19 row_ror:8 row_mask:0xf bank_mask:0xf
    v_add_f32_dpp v20, v20, v20 row_ror:8 row_mask:0xf bank_mask:0xf
    v_add_f32_dpp v21, v21, v21 row_ror:8 row_mask:0xf bank_mask:0xf
    v_add_f32_dpp v18, v18, v18 row_ror:4 row_mask:0xf bank_mask:0xf
    v_add_f32_dpp v19, v19, v19 row_ror:4 row_mask:0xf bank_mask:0xf
    v_add_f32_dpp v20, v20, v20 row_ror:4 row_mask:0xf bank_mask:0xf
    v_add_f32_dpp v21, v21, v21 row_ror:4 row_mask:0xf bank_mask:0xf
    v_add_f32_dpp v18, v18, v18 row_ror:2 row_mask:0xf bank_mask:0xf
    v_add_f32_dpp v19, v19, v19 row_ror:2 row_mask:0xf bank_mask:0xf
    v_add_f32_dpp v20, v20, v20 row_ror:2 row_mask:0xf bank_mask:0xf
    v_add_f32_dpp v21, v21, v21 row_ror:2 row_mask:0xf bank_mask:0xf
    v_add_f32_dpp v18, v18, v18 row_ror:1 row_mask:0xf bank_mask:0xf
    v_add_f32_dpp v19, v19, v19 row_ror:1 row_mask:0xf bank_mask:0xf
    v_add_f32_dpp v20, v20, v20 row_ror:1 row_mask:0xf bank_mask:0xf
    v_add_f32_dpp v21, v21, v21 row_ror:1 row_mask:0xf bank_mask:0xf
    v_dot2_f32_bf16 v22, v90, v2, 0
    v_dot2_f32_bf16 v23, v94, v2, 0
    v_dot2_f32_bf16 v24, v98, v2, 0
    v_dot2_f32_bf16 v25, v102, v2, 0
    v_dot2_f32_bf16 v22, v91, v3, v22
    v_dot2_f32_bf16 v23, v95, v3, v23
    v_dot2_f32_bf16 v24, v99, v3, v24
    v_dot2_f32_bf16 v25, v103, v3, v25
    v_dot2_f32_bf16 v22, v92, v4, v22
    v_dot2_f32_bf16 v23, v96, v4, v23
    v_dot2_f32_bf16 v24, v100, v4, v24
    v_dot2_f32_bf16 v25, v104, v4, v25
    v_dot2_f32_bf16 v22, v93, v5, v22
    v_dot2_f32_bf16 v23, v97, v5, v23
    v_dot2_f32_bf16 v24, v101, v5, v24
    v_dot2_f32_bf16 v25, v105, v5, v25
    v_add_f32_dpp v22, v22, v22 row_ror:8 row_mask:0xf bank_mask:0xf
    v_add_f32_dpp v23, v23, v23 row_ror:8 row_mask:0xf bank_mask:0xf
    v_add_f32_dpp v24, v24, v24 row_ror:8 row_mask:0xf bank_mask:0xf
    v_add_f32_dpp v25, v25, v25 row_ror:8 row_mask:0xf bank_mask:0xf
    v_add_f32_dpp v22, v22, v22 row_ror:4 row_mask:0xf bank_mask:0xf
    v_add_f32_dpp v23, v23, v23 row_ror:4 row_mask:0xf bank_mask:0xf
    v_add_f32_dpp v24, v24, v24 row_ror:4 row_mask:0xf bank_mask:0xf
    v_add_f32_dpp v25, v25, v25 row_ror:4 row_mask:0xf bank_mask:0xf
    v_add_f32_dpp v22, v22, v22 row_ror:2 row_mask:0xf bank_mask:0xf
    v_add_f32_dpp v23, v23, v23 row_ror:2 row_mask:0xf bank_mask:0xf
    v_add_f32_dpp v24, v24, v24 row_ror:2 row_mask:0xf bank_mask:0xf
    v_add_f32_dpp v25, v25, v25 row_ror:2 row_mask:0xf bank_mask:0xf
    v_add_f32_dpp v22, v22, v22 row_ror:1 row_mask:0xf bank_mask:0xf
    v_add_f32_dpp v23, v23, v23 row_ror:1 row_mask:0xf bank_mask:0xf
    v_add_f32_dpp v24, v24, v24 row_ror:1 row_mask:0xf bank_mask:0xf
    v_add_f32_dpp v25, v25, v25 row_ror:1 row_mask:0xf bank_mask:0xf
    s_waitcnt vmcnt(0)
    buffer_load_dwordx4 v[122:125], v6, s[44:47], s60 offen offset:0 nt
    buffer_load_dwordx4 v[126:129], v6, s[44:47], s60 offen offset:1024 nt
    buffer_load_dwordx4 v[130:133], v6, s[44:47], s60 offen offset:2048 nt
    buffer_load_dwordx4 v[134:137], v6, s[44:47], s60 offen offset:3072 nt
    s_add_u32 s60, s60, 45056
    v_dot2_f32_bf16 v26, v106, v2, 0
    v_dot2_f32_bf16 v27, v110, v2, 0
    v_dot2_f32_bf16 v28, v114, v2, 0
    v_dot2_f32_bf16 v29, v118, v2, 0
    v_dot2_f32_bf16 v26, v107, v3, v26
    v_dot2_f32_bf16 v27, v111, v3, v27
    v_dot2_f32_bf16 v28, v115, v3, v28
    v_dot2_f32_bf16 v29, v119, v3, v29
    v_dot2_f32_bf16 v26, v108, v4, v26
    v_dot2_f32_bf16 v27, v112, v4, v27
    v_dot2_f32_bf16 v28, v116, v4, v28
    v_dot2_f32_bf16 v29, v120, v4, v29
    v_dot2_f32_bf16 v26, v109, v5, v26
    v_dot2_f32_bf16 v27, v113, v5, v27
    v_dot2_f32_bf16 v28, v117, v5, v28
    v_dot2_f32_bf16 v29, v121, v5, v29
    v_add_f32_dpp v26, v26, v26 row_ror:8 row_mask:0xf bank_mask:0xf
    v_add_f32_dpp v27, v27, v27 row_ror:8 row_mask:0xf bank_mask:0xf
    v_add_f32_dpp v28, v28, v28 row_ror:8 row_mask:0xf bank_mask:0xf
    v_add_f32_dpp v29, v29, v29 row_ror:8 row_mask:0xf bank_mask:0xf
    v_add_f32_dpp v26, v26, v26 row_ror:4 row_mask:0xf bank_mask:0xf
    v_add_f32_dpp v27, v27, v27 row_ror:4 row_mask:0xf bank_mask:0xf
    v_add_f32_dpp v28, v28, v28 row_ror:4 row_mask:0xf bank_mask:0xf
    v_add_f32_dpp v29, v29, v29 row_ror:4 row_mask:0xf bank_mask:0xf
    v_add_f32_dpp v26, v26, v26 row_ror:2 row_mask:0xf bank_mask:0xf
    v_add_f32_dpp v27, v27, v27 row_ror:2 row_mask:0xf bank_mask:0xf
    v_add_f32_dpp v28, v28, v28 row_ror:2 row_mask:0xf bank_mask:0xf
    v_add_f32_dpp v29, v29, v29 row_ror:2 row_mask:0xf bank_mask:0xf
    v_add_f32_dpp v26, v26, v26 row_ror:1 row_mask:0xf bank_mask:0xf
    v_add_f32_dpp v27, v27, v27 row_ror:1 row_mask:0xf bank_mask:0xf
    v_add_f32_dpp v28, v28, v28 row_ror:1 row_mask:0xf bank_mask:0xf
    v_add_f32_dpp v29, v29, v29 row_ror:1 row_mask:0xf bank_mask:0xf
    s_waitcnt vmcnt(0)
    buffer_load_dwordx4 v[34:37], v6, s[48:51], s61 offen offset:0 nt
    buffer_load_dwordx4 v[38:41], v6, s[48:51], s61 offen offset:1024 nt
    buffer_load_dwordx4 v[42:45], v6, s[48:51], s61 offen offset:2048 nt
    buffer_load_dwordx4 v[46:49], v6, s[48:51], s61 offen offset:3072 nt
    s_add_u32 s61, s61, 45056
    v_dot2_f32_bf16 v30, v122, v2, 0
    v_dot2_f32_bf16 v31, v126, v2, 0
    v_dot2_f32_bf16 v32, v130, v2, 0
    v_dot2_f32_bf16 v33, v134, v2, 0
    v_dot2_f32_bf16 v30, v123, v3, v30
    v_dot2_f32_bf16 v31, v127, v3, v31
    v_dot2_f32_bf16 v32, v131, v3, v32
    v_dot2_f32_bf16 v33, v135, v3, v33
    v_dot2_f32_bf16 v30, v124, v4, v30
    v_dot2_f32_bf16 v31, v128, v4, v31
    v_dot2_f32_bf16 v32, v132, v4, v32
    v_dot2_f32_bf16 v33, v136, v4, v33
    v_dot2_f32_bf16 v30, v125, v5, v30
    v_dot2_f32_bf16 v31, v129, v5, v31
    v_dot2_f32_bf16 v32, v133, v5, v32
    v_dot2_f32_bf16 v33, v137, v5, v33
    v_add_f32_dpp v30, v30, v30 row_ror:8 row_mask:0xf bank_mask:0xf
    v_add_f32_dpp v31, v31, v31 row_ror:8 row_mask:0xf bank_mask:0xf
    v_add_f32_dpp v32, v32, v32 row_ror:8 row_mask:0xf bank_mask:0xf
    v_add_f32_dpp v33, v33, v33 row_ror:8 row_mask:0xf bank_mask:0xf
    v_add_f32_dpp v30, v30, v30 row_ror:4 row_mask:0xf bank_mask:0xf
    v_add_f32_dpp v31, v31, v31 row_ror:4 row_mask:0xf bank_mask:0xf
    v_add_f32_dpp v32, v32, v32 row_ror:4 row_mask:0xf bank_mask:0xf
    v_add_f32_dpp v33, v33, v33 row_ror:4 row_mask:0xf bank_mask:0xf
    v_add_f32_dpp v30, v30, v30 row_ror:2 row_mask:0xf bank_mask:0xf
    v_add_f32_dpp v31, v31, v31 row_ror:2 row_mask:0xf bank_mask:0xf
    v_add_f32_dpp v32, v32, v32 row_ror:2 row_mask:0xf bank_mask:0xf
    v_add_f32_dpp v33, v33, v33 row_ror:2 row_mask:0xf bank_mask:0xf
    v_add_f32_dpp v30, v30, v30 row_ror:1 row_mask:0xf bank_mask:0xf
    v_add_f32_dpp v31, v31, v31 row_ror:1 row_mask:0xf bank_mask:0xf
    v_add_f32_dpp v32, v32, v32 row_ror:1 row_mask:0xf bank_mask:0xf
    v_add_f32_dpp v33, v33, v33 row_ror:1 row_mask:0xf bank_mask:0xf
    s_waitcnt vmcnt(0)
    buffer_load_dwordx4 v[50:53], v6, s[48:51], s61 offen offset:0 nt
    buffer_load_dwordx4 v[54:57], v6, s[48:51], s61 offen offset:1024 nt
    buffer_load_dwordx4 v[58:61], v6, s[48:51], s61 offen offset:2048 nt
    buffer_load_dwordx4 v[62:65], v6, s[48:51], s61 offen offset:3072 nt
    s_add_u32 s61, s61, 45056
    v_add_f32 v8, s62, v8
    v_add_f32 v9, s62, v9
    v_add_f32 v10, s62, v10
    v_add_f32 v11, s62, v11
    v_add_f32 v12, s62, v12
    v_add_f32 v13, s62, v13
    v_max3_f32 v160, v8, v9, v10
    v_max3_f32 v160, v160, v11, v12
    v_max3_f32 v160, v160, v13, v14
    v_max3_f32 v160, v160, v15, v16
    v_max3_f32 v160, v160, v17, v18
    v_max3_f32 v160, v160, v19, v20
    v_max3_f32 v160, v160, v21, v22
    v_max3_f32 v160, v160, v23, v24
    v_max3_f32 v160, v160, v25, v26
    v_max3_f32 v160, v160, v27, v28
    v_max3_f32 v160, v160, v29, v30
    v_max3_f32 v160, v160, v31, v32
    v_max_f32 v160, v160, v33
    v_mov_b32 v161, v160
    s_nop 1
    v_permlane32_swap_b32 v160, v161
    v_max_f32 v160, v160, v161
    v_mov_b32 v161, v160
    s_nop 1
    v_permlane16_swap_b32 v160, v161
    v_max_f32 v160, v160, v161
    v_mul_f32 v160, s64, v160
    v_fma_f32 v8, v8, s64, -v160
    v_fma_f32 v9, v9, s64, -v160
    v_fma_f32 v10, v10, s64, -v160
    v_fma_f32 v11, v11, s64, -v160
    v_fma_f32 v12, v12, s64, -v160
    v_fma_f32 v13, v13, s64, -v160
    v_fma_f32 v14, v14, s64, -v160
    v_fma_f32 v15, v15, s64, -v160
    v_fma_f32 v16, v16, s64, -v160
    v_fma_f32 v17, v17, s64, -v160
    v_fma_f32 v18, v18, s64, -v160
    v_fma_f32 v19, v19, s64, -v160
    v_fma_f32 v20, v20, s64, -v160
    v_fma_f32 v21, v21, s64, -v160
    v_fma_f32 v22, v22, s64, -v160
    v_fma_f32 v23, v23, s64, -v160
    v_fma_f32 v24, v24, s64, -v160
    v_fma_f32 v25, v25, s64, -v160
    v_fma_f32 v26, v26, s64, -v160
    v_fma_f32 v27, v27, s64, -v160
    v_fma_f32 v28, v28, s64, -v160
    v_fma_f32 v29, v29, s64, -v160
    v_fma_f32 v30, v30, s64, -v160
    v_fma_f32 v31, v31, s64, -v160
    v_fma_f32 v32, v32, s64, -v160
    v_fma_f32 v33, v33, s64, -v160
    v_exp_f32 v8, v8
    v_exp_f32 v9, v9
    v_exp_f32 v10, v10
    v_exp_f32 v11, v11
    v_exp_f32 v12, v12
    v_exp_f32 v13, v13
    v_exp_f32 v14, v14
    v_exp_f32 v15, v15
    v_exp_f32 v16, v16
    v_exp_f32 v17, v17
    v_exp_f32 v18, v18
    v_exp_f32 v19, v19
    v_exp_f32 v20, v20
    v_exp_f32 v21, v21
    v_exp_f32 v22, v22
    v_exp_f32 v23, v23
    v_exp_f32 v24, v24
    v_exp_f32 v25, v25
    v_exp_f32 v26, v26
    v_exp_f32 v27, v27
    v_exp_f32 v28, v28
    v_exp_f32 v29, v29
    v_exp_f32 v30, v30
    v_exp_f32 v31, v31
    v_exp_f32 v32, v32
    v_exp_f32 v33, v33
    v_add_f32 v162, v8, v9
    v_add_f32 v163, v10, v11
    v_add_f32 v162, v162, v12
    v_add_f32 v163, v163, v13
    v_add_f32 v162, v162, v14
    v_add_f32 v163, v163, v15
    v_add_f32 v162, v162, v16
    v_add_f32 v163, v163, v17
    v_add_f32 v162, v162, v18
    v_add_f32 v163, v163, v19
    v_add_f32 v162, v162, v20
    v_add_f32 v163, v163, v21
    v_add_f32 v162, v162, v22
    v_add_f32 v163, v163, v23
    v_add_f32 v162, v162, v24
    v_add_f32 v163, v163, v25
    v_add_f32 v162, v162, v26
    v_add_f32 v163, v163, v27
    v_add_f32 v162, v162, v28
    v_add_f32 v163, v163, v29
    v_add_f32 v162, v162, v30
    v_add_f32 v163, v163, v31
    v_add_f32 v162, v162, v32
    v_add_f32 v163, v163, v33
    v_add_f32 v162, v162, v163
    v_mov_b32 v163, v162
    s_nop 1
    v_permlane32_swap_b32 v162, v163
    v_add_f32 v162, v162, v163
    v_mov_b32 v163, v162
    s_nop 1
    v_permlane16_swap_b32 v162, v163
    v_add_f32 v161, v162, v163
    s_lshl_b32 s7, s3, 3
    s_add_u32 s7, s7, 0x24200
    v_mov_b32 v164, s7
    ds_write_b64 v164, v[160:161]
    v_mov_b32 v164, 0x24008
    v_mov_b32 v165, 1
    s_waitcnt lgkmcnt(0)
    s_mov_b64 exec, 1
    ds_add_u32 v164, v165
    s_mov_b64 exec, -1
    v_and_b32 v2, 15, v1
    v_lshlrev_b32 v2, 5, v2
    v_bfe_u32 v3, v1, 5, 1
    v_lshl_add_u32 v2, v3, 4, v2
    v_bfe_u32 v3, v1, 4, 1
    v_lshl_add_u32 v2, v3, 3, v2
    s_lshl_b32 s7, s3, 9
    s_add_u32 s7, s7, 0x25000
    v_add_u32 v2, s7, v2
    s_waitcnt vmcnt(0)
    buffer_load_dwordx4 v[66:69], v6, s[48:51], s61 offen offset:0 nt
    buffer_load_dwordx4 v[70:73], v6, s[48:51], s61 offen offset:1024 nt
    buffer_load_dwordx4 v[74:77], v6, s[48:51], s61 offen offset:2048 nt
    buffer_load_dwordx4 v[78:81], v6, s[48:51], s61 offen offset:3072 nt
    s_add_u32 s61, s61, 45056
    v_lshlrev_b32 v160, 16, v34
    v_and_b32 v161, 0xffff0000, v34
    v_lshlrev_b32 v162, 16, v35
    v_and_b32 v163, 0xffff0000, v35
    v_lshlrev_b32 v164, 16, v36
    v_and_b32 v165, 0xffff0000, v36
    v_lshlrev_b32 v166, 16, v37
    v_and_b32 v167, 0xffff0000, v37
    v_pk_mul_f32 v[152:153], v[160:161], v[14:15] op_sel_hi:[1,0]
    v_pk_mul_f32 v[154:155], v[162:163], v[14:15] op_sel_hi:[1,0]
    v_pk_mul_f32 v[156:157], v[164:165], v[14:15] op_sel_hi:[1,0]
    v_pk_mul_f32 v[158:159], v[166:167], v[14:15] op_sel_hi:[1,0]
    v_lshlrev_b32 v160, 16, v38
    v_and_b32 v161, 0xffff0000, v38
    v_lshlrev_b32 v162, 16, v39
    v_and_b32 v163, 0xffff0000, v39
    v_lshlrev_b32 v164, 16, v40
    v_and_b32 v165, 0xffff0000, v40
    v_lshlrev_b32 v166, 16, v41
    v_and_b32 v167, 0xffff0000, v41
    v_pk_fma_f32 v[152:153], v[160:161], v[14:15], v[152:153] op_sel:[0,1,0] op_sel_hi:[1,1,1]
    v_pk_fma_f32 v[154:155], v[162:163], v[14:15], v[154:155] op_sel:[0,1,0] op_sel_hi:[1,1,1]
    v_pk_fma_f32 v[156:157], v[164:165], v[14:15], v[156:157] op_sel:[0,1,0] op_sel_hi:[1,1,1]
    v_pk_fma_f32 v[158:159], v[166:167], v[14:15], v[158:159] op_sel:[0,1,0] op_sel_hi:[1,1,1]
    v_lshlrev_b32 v160, 16, v42
    v_and_b32 v161, 0xffff0000, v42
    v_lshlrev_b32 v162, 16, v43
    v_and_b32 v163, 0xffff0000, v43
    v_lshlrev_b32 v164, 16, v44
    v_and_b32 v165, 0xffff0000, v44
    v_lshlrev_b32 v166, 16, v45
    v_and_b32 v167, 0xffff0000, v45
    v_pk_fma_f32 v[152:153], v[160:161], v[16:17], v[152:153] op_sel_hi:[1,0,1]
    v_pk_fma_f32 v[154:155], v[162:163], v[16:17], v[154:155] op_sel_hi:[1,0,1]
    v_pk_fma_f32 v[156:157], v[164:165], v[16:17], v[156:157] op_sel_hi:[1,0,1]
    v_pk_fma_f32 v[158:159], v[166:167], v[16:17], v[158:159] op_sel_hi:[1,0,1]
    v_lshlrev_b32 v160, 16, v46
    v_and_b32 v161, 0xffff0000, v46
    v_lshlrev_b32 v162, 16, v47
    v_and_b32 v163, 0xffff0000, v47
    v_lshlrev_b32 v164, 16, v48
    v_and_b32 v165, 0xffff0000, v48
    v_lshlrev_b32 v166, 16, v49
    v_and_b32 v167, 0xffff0000, v49
    v_pk_fma_f32 v[152:153], v[160:161], v[16:17], v[152:153] op_sel:[0,1,0] op_sel_hi:[1,1,1]
    v_pk_fma_f32 v[154:155], v[162:163], v[16:17], v[154:155] op_sel:[0,1,0] op_sel_hi:[1,1,1]
    v_pk_fma_f32 v[156:157], v[164:165], v[16:17], v[156:157] op_sel:[0,1,0] op_sel_hi:[1,1,1]
    v_pk_fma_f32 v[158:159], v[166:167], v[16:17], v[158:159] op_sel:[0,1,0] op_sel_hi:[1,1,1]
    v_lshlrev_b32 v160, 16, v50
    v_and_b32 v161, 0xffff0000, v50
    v_lshlrev_b32 v162, 16, v51
    v_and_b32 v163, 0xffff0000, v51
    v_lshlrev_b32 v164, 16, v52
    v_and_b32 v165, 0xffff0000, v52
    v_lshlrev_b32 v166, 16, v53
    v_and_b32 v167, 0xffff0000, v53
    v_pk_fma_f32 v[152:153], v[160:161], v[18:19], v[152:153] op_sel_hi:[1,0,1]
    v_pk_fma_f32 v[154:155], v[162:163], v[18:19], v[154:155] op_sel_hi:[1,0,1]
    v_pk_fma_f32 v[156:157], v[164:165], v[18:19], v[156:157] op_sel_hi:[1,0,1]
    v_pk_fma_f32 v[158:159], v[166:167], v[18:19], v[158:159] op_sel_hi:[1,0,1]
    v_lshlrev_b32 v160, 16, v54
    v_and_b32 v161, 0xffff0000, v54
    v_lshlrev_b32 v162, 16, v55
    v_and_b32 v163, 0xffff0000, v55
    v_lshlrev_b32 v164, 16, v56
    v_and_b32 v165, 0xffff0000, v56
    v_lshlrev_b32 v166, 16, v57
    v_and_b32 v167, 0xffff0000, v57
    v_pk_fma_f32 v[152:153], v[160:161], v[18:19], v[152:153] op_sel:[0,1,0] op_sel_hi:[1,1,1]
    v_pk_fma_f32 v[154:155], v[162:163], v[18:19], v[154:155] op_sel:[0,1,0] op_sel_hi:[1,1,1]
    v_pk_fma_f32 v[156:157], v[164:165], v[18:19], v[156:157] op_sel:[0,1,0] op_sel_hi:[1,1,1]
    v_pk_fma_f32 v[158:159], v[166:167], v[18:19], v[158:159] op_sel:[0,1,0] op_sel_hi:[1,1,1]
    v_lshlrev_b32 v160, 16, v58
    v_and_b32 v161, 0xffff0000, v58
    v_lshlrev_b32 v162, 16, v59
    v_and_b32 v163, 0xffff0000, v59
    v_lshlrev_b32 v164, 16, v60
    v_and_b32 v165, 0xffff0000, v60
    v_lshlrev_b32 v166, 16, v61
    v_and_b32 v167, 0xffff0000, v61
    v_pk_fma_f32 v[152:153], v[160:161], v[20:21], v[152:153] op_sel_hi:[1,0,1]
    v_pk_fma_f32 v[154:155], v[162:163], v[20:21], v[154:155] op_sel_hi:[1,0,1]
    v_pk_fma_f32 v[156:157], v[164:165], v[20:21], v[156:157] op_sel_hi:[1,0,1]
    v_pk_fma_f32 v[158:159], v[166:167], v[20:21], v[158:159] op_sel_hi:[1,0,1]
    v_lshlrev_b32 v160, 16, v62
    v_and_b32 v161, 0xffff0000, v62
    v_lshlrev_b32 v162, 16, v63
    v_and_b32 v163, 0xffff0000, v63
    v_lshlrev_b32 v164, 16, v64
    v_and_b32 v165, 0xffff0000, v64
    v_lshlrev_b32 v166, 16, v65
    v_and_b32 v167, 0xffff0000, v65
    v_pk_fma_f32 v[152:153], v[160:161], v[20:21], v[152:153] op_sel:[0,1,0] op_sel_hi:[1,1,1]
    v_pk_fma_f32 v[154:155], v[162:163], v[20:21], v[154:155] op_sel:[0,1,0] op_sel_hi:[1,1,1]
    v_pk_fma_f32 v[156:157], v[164:165], v[20:21], v[156:157] op_sel:[0,1,0] op_sel_hi:[1,1,1]
    v_pk_fma_f32 v[158:159], v[166:167], v[20:21], v[158:159] op_sel:[0,1,0] op_sel_hi:[1,1,1]
    s_waitcnt vmcnt(0)
    buffer_load_dwordx4 v[82:85], v6, s[48:51], s61 offen offset:0 nt
    buffer_load_dwordx4 v[86:89], v6, s[48:51], s61 offen offset:1024 nt
    buffer_load_dwordx4 v[90:93], v6, s[48:51], s61 offen offset:2048 nt
    buffer_load_dwordx4 v[94:97], v6, s[48:51], s61 offen offset:3072 nt
    s_add_u32 s61, s61, 45056
    v_lshlrev_b32 v160, 16, v66
    v_and_b32 v161, 0xffff0000, v66
    v_lshlrev_b32 v162, 16, v67
    v_and_b32 v163, 0xffff0000, v67
    v_lshlrev_b32 v164, 16, v68
    v_and_b32 v165, 0xffff0000, v68
    v_lshlrev_b32 v166, 16, v69
    v_and_b32 v167, 0xffff0000, v69
    v_pk_fma_f32 v[152:153], v[160:161], v[22:23], v[152:153] op_sel_hi:[1,0,1]
    v_pk_fma_f32 v[154:155], v[162:163], v[22:23], v[154:155] op_sel_hi:[1,0,1]
    v_pk_fma_f32 v[156:157], v[164:165], v[22:23], v[156:157] op_sel_hi:[1,0,1]
    v_pk_fma_f32 v[158:159], v[166:167], v[22:23], v[158:159] op_sel_hi:[1,0,1]
    v_lshlrev_b32 v160, 16, v70
    v_and_b32 v161, 0xffff0000, v70
    v_lshlrev_b32 v162, 16, v71
    v_and_b32 v163, 0xffff0000, v71
    v_lshlrev_b32 v164, 16, v72
    v_and_b32 v165, 0xffff0000, v72
    v_lshlrev_b32 v166, 16, v73
    v_and_b32 v167, 0xffff0000, v73
    v_pk_fma_f32 v[152:153], v[160:161], v[22:23], v[152:153] op_sel:[0,1,0] op_sel_hi:[1,1,1]
    v_pk_fma_f32 v[154:155], v[162:163], v[22:23], v[154:155] op_sel:[0,1,0] op_sel_hi:[1,1,1]
    v_pk_fma_f32 v[156:157], v[164:165], v[22:23], v[156:157] op_sel:[0,1,0] op_sel_hi:[1,1,1]
    v_pk_fma_f32 v[158:159], v[166:167], v[22:23], v[158:159] op_sel:[0,1,0] op_sel_hi:[1,1,1]
    v_lshlrev_b32 v160, 16, v74
    v_and_b32 v161, 0xffff0000, v74
    v_lshlrev_b32 v162, 16, v75
    v_and_b32 v163, 0xffff0000, v75
    v_lshlrev_b32 v164, 16, v76
    v_and_b32 v165, 0xffff0000, v76
    v_lshlrev_b32 v166, 16, v77
    v_and_b32 v167, 0xffff0000, v77
    v_pk_fma_f32 v[152:153], v[160:161], v[24:25], v[152:153] op_sel_hi:[1,0,1]
    v_pk_fma_f32 v[154:155], v[162:163], v[24:25], v[154:155] op_sel_hi:[1,0,1]
    v_pk_fma_f32 v[156:157], v[164:165], v[24:25], v[156:157] op_sel_hi:[1,0,1]
    v_pk_fma_f32 v[158:159], v[166:167], v[24:25], v[158:159] op_sel_hi:[1,0,1]
    v_lshlrev_b32 v160, 16, v78
    v_and_b32 v161, 0xffff0000, v78
    v_lshlrev_b32 v162, 16, v79
    v_and_b32 v163, 0xffff0000, v79
    v_lshlrev_b32 v164, 16, v80
    v_and_b32 v165, 0xffff0000, v80
    v_lshlrev_b32 v166, 16, v81
    v_and_b32 v167, 0xffff0000, v81
    v_pk_fma_f32 v[152:153], v[160:161], v[24:25], v[152:153] op_sel:[0,1,0] op_sel_hi:[1,1,1]
    v_pk_fma_f32 v[154:155], v[162:163], v[24:25], v[154:155] op_sel:[0,1,0] op_sel_hi:[1,1,1]
    v_pk_fma_f32 v[156:157], v[164:165], v[24:25], v[156:157] op_sel:[0,1,0] op_sel_hi:[1,1,1]
    v_pk_fma_f32 v[158:159], v[166:167], v[24:25], v[158:159] op_sel:[0,1,0] op_sel_hi:[1,1,1]
    s_waitcnt vmcnt(0)
    buffer_load_dwordx4 v[98:101], v6, s[48:51], s61 offen offset:0 nt
    buffer_load_dwordx4 v[102:105], v6, s[48:51], s61 offen offset:1024 nt
    buffer_load_dwordx4 v[106:109], v6, s[48:51], s61 offen offset:2048 nt
    buffer_load_dwordx4 v[110:113], v6, s[48:51], s61 offen offset:3072 nt
    s_add_u32 s61, s61, 45056
    v_lshlrev_b32 v160, 16, v82
    v_and_b32 v161, 0xffff0000, v82
    v_lshlrev_b32 v162, 16, v83
    v_and_b32 v163, 0xffff0000, v83
    v_lshlrev_b32 v164, 16, v84
    v_and_b32 v165, 0xffff0000, v84
    v_lshlrev_b32 v166, 16, v85
    v_and_b32 v167, 0xffff0000, v85
    v_pk_fma_f32 v[152:153], v[160:161], v[26:27], v[152:153] op_sel_hi:[1,0,1]
    v_pk_fma_f32 v[154:155], v[162:163], v[26:27], v[154:155] op_sel_hi:[1,0,1]
    v_pk_fma_f32 v[156:157], v[164:165], v[26:27], v[156:157] op_sel_hi:[1,0,1]
    s_branch LC_AR
.p2align 12
LT_AR2:
    s_branch LR_AR2
LC_AR:
    v_pk_fma_f32 v[158:159], v[166:167], v[26:27], v[158:159] op_sel_hi:[1,0,1]
    v_lshlrev_b32 v160, 16, v86
    v_and_b32 v161, 0xffff0000, v86
    v_lshlrev_b32 v162, 16, v87
    v_and_b32 v163, 0xffff0000, v87
    v_lshlrev_b32 v164, 16, v88
    v_and_b32 v165, 0xffff0000, v88
    v_lshlrev_b32 v166, 16, v89
    v_and_b32 v167, 0xffff0000, v89
    v_pk_fma_f32 v[152:153], v[160:161], v[26:27], v[152:153] op_sel:[0,1,0] op_sel_hi:[1,1,1]
    v_pk_fma_f32 v[154:155], v[162:163], v[26:27], v[154:155] op_sel:[0,1,0] op_sel_hi:[1,1,1]
    v_pk_fma_f32 v[156:157], v[164:165], v[26:27], v[156:157] op_sel:[0,1,0] op_sel_hi:[1,1,1]
    v_pk_fma_f32 v[158:159], v[166:167], v[26:27], v[158:159] op_sel:[0,1,0] op_sel_hi:[1,1,1]
    v_lshlrev_b32 v160, 16, v90
    v_and_b32 v161, 0xffff0000, v90
    v_lshlrev_b32 v162, 16, v91
    v_and_b32 v163, 0xffff0000, v91
    v_lshlrev_b32 v164, 16, v92
    v_and_b32 v165, 0xffff0000, v92
    v_lshlrev_b32 v166, 16, v93
    v_and_b32 v167, 0xffff0000, v93
    v_pk_fma_f32 v[152:153], v[160:161], v[28:29], v[152:153] op_sel_hi:[1,0,1]
    v_pk_fma_f32 v[154:155], v[162:163], v[28:29], v[154:155] op_sel_hi:[1,0,1]
    v_pk_fma_f32 v[156:157], v[164:165], v[28:29], v[156:157] op_sel_hi:[1,0,1]
    v_pk_fma_f32 v[158:159], v[166:167], v[28:29], v[158:159] op_sel_hi:[1,0,1]
    v_lshlrev_b32 v160, 16, v94
    v_and_b32 v161, 0xffff0000, v94
    v_lshlrev_b32 v162, 16, v95
    v_and_b32 v163, 0xffff0000, v95
    v_lshlrev_b32 v164, 16, v96
    v_and_b32 v165, 0xffff0000, v96
    v_lshlrev_b32 v166, 16, v97
    v_and_b32 v167, 0xffff0000, v97
    v_pk_fma_f32 v[152:153], v[160:161], v[28:29], v[152:153] op_sel:[0,1,0] op_sel_hi:[1,1,1]
    v_pk_fma_f32 v[154:155], v[162:163], v[28:29], v[154:155] op_sel:[0,1,0] op_sel_hi:[1,1,1]
    v_pk_fma_f32 v[156:157], v[164:165], v[28:29], v[156:157] op_sel:[0,1,0] op_sel_hi:[1,1,1]
    v_pk_fma_f32 v[158:159], v[166:167], v[28:29], v[158:159] op_sel:[0,1,0] op_sel_hi:[1,1,1]
    s_cmp_eq_u32 s62, 0
    s_cbranch_scc1 AL_13
    s_waitcnt vmcnt(3)
    v_lshlrev_b32 v160, 16, v98
    v_and_b32 v161, 0xffff0000, v98
    v_lshlrev_b32 v162, 16, v99
    v_and_b32 v163, 0xffff0000, v99
    v_lshlrev_b32 v164, 16, v100
    v_and_b32 v165, 0xffff0000, v100
    v_lshlrev_b32 v166, 16, v101
    v_and_b32 v167, 0xffff0000, v101
    v_pk_fma_f32 v[152:153], v[160:161], v[30:31], v[152:153] op_sel_hi:[1,0,1]
    v_pk_fma_f32 v[154:155], v[162:163], v[30:31], v[154:155] op_sel_hi:[1,0,1]
    v_pk_fma_f32 v[156:157], v[164:165], v[30:31], v[156:157] op_sel_hi:[1,0,1]
    v_pk_fma_f32 v[158:159], v[166:167], v[30:31], v[158:159] op_sel_hi:[1,0,1]
    s_waitcnt vmcnt(2)
    v_lshlrev_b32 v160, 16, v102
    v_and_b32 v161, 0xffff0000, v102
    v_lshlrev_b32 v162, 16, v103
    v_and_b32 v163, 0xffff0000, v103
    v_lshlrev_b32 v164, 16, v104
    v_and_b32 v165, 0xffff0000, v104
    v_lshlrev_b32 v166, 16, v105
    v_and_b32 v167, 0xffff0000, v105
    v_pk_fma_f32 v[152:153], v[160:161], v[30:31], v[152:153] op_sel:[0,1,0] op_sel_hi:[1,1,1]
    v_pk_fma_f32 v[154:155], v[162:163], v[30:31], v[154:155] op_sel:[0,1,0] op_sel_hi:[1,1,1]
    v_pk_fma_f32 v[156:157], v[164:165], v[30:31], v[156:157] op_sel:[0,1,0] op_sel_hi:[1,1,1]
    v_pk_fma_f32 v[158:159], v[166:167], v[30:31], v[158:159] op_sel:[0,1,0] op_sel_hi:[1,1,1]
    s_waitcnt vmcnt(1)
    v_lshlrev_b32 v160, 16, v106
    v_and_b32 v161, 0xffff0000, v106
    v_lshlrev_b32 v162, 16, v107
    v_and_b32 v163, 0xffff0000, v107
    v_lshlrev_b32 v164, 16, v108
    v_and_b32 v165, 0xffff0000, v108
    v_lshlrev_b32 v166, 16, v109
    v_and_b32 v167, 0xffff0000, v109
    v_pk_fma_f32 v[152:153], v[160:161], v[32:33], v[152:153] op_sel_hi:[1,0,1]
    v_pk_fma_f32 v[154:155], v[162:163], v[32:33], v[154:155] op_sel_hi:[1,0,1]
    v_pk_fma_f32 v[156:157], v[164:165], v[32:33], v[156:157] op_sel_hi:[1,0,1]
    v_pk_fma_f32 v[158:159], v[166:167], v[32:33], v[158:159] op_sel_hi:[1,0,1]
    s_waitcnt vmcnt(0)
    v_lshlrev_b32 v160, 16, v110
    v_and_b32 v161, 0xffff0000, v110
    v_lshlrev_b32 v162, 16, v111
    v_and_b32 v163, 0xffff0000, v111
    v_lshlrev_b32 v164, 16, v112
    v_and_b32 v165, 0xffff0000, v112
    v_lshlrev_b32 v166, 16, v113
    v_and_b32 v167, 0xffff0000, v113
    v_pk_fma_f32 v[152:153], v[160:161], v[32:33], v[152:153] op_sel:[0,1,0] op_sel_hi:[1,1,1]
    v_pk_fma_f32 v[154:155], v[162:163], v[32:33], v[154:155] op_sel:[0,1,0] op_sel_hi:[1,1,1]
    v_pk_fma_f32 v[156:157], v[164:165], v[32:33], v[156:157] op_sel:[0,1,0] op_sel_hi:[1,1,1]
    v_pk_fma_f32 v[158:159], v[166:167], v[32:33], v[158:159] op_sel:[0,1,0] op_sel_hi:[1,1,1]
    s_branch L_AFIN
AL_13:
    s_waitcnt vmcnt(0)
    buffer_load_dwordx4 v[114:117], v6, s[48:51], s63 offen offset:0 nt
    buffer_load_dwordx4 v[118:121], v6, s[48:51], s63 offen offset:1024 nt
    buffer_load_dwordx4 v[122:125], v6, s[48:51], s63 offen offset:2048 nt
    buffer_load_dwordx4 v[126:129], v6, s[48:51], s63 offen offset:3072 nt
    buffer_load_dwordx4 v[130:133], v6, s[48:51], s65 offen offset:0 nt
    buffer_load_dwordx4 v[134:137], v6, s[48:51], s65 offen offset:1024 nt
    v_lshlrev_b32 v160, 16, v98
    v_and_b32 v161, 0xffff0000, v98
    v_lshlrev_b32 v162, 16, v99
    v_and_b32 v163, 0xffff0000, v99
    v_lshlrev_b32 v164, 16, v100
    v_and_b32 v165, 0xffff0000, v100
    v_lshlrev_b32 v166, 16, v101
    v_and_b32 v167, 0xffff0000, v101
    v_pk_fma_f32 v[152:153], v[160:161], v[30:31], v[152:153] op_sel_hi:[1,0,1]
    v_pk_fma_f32 v[154:155], v[162:163], v[30:31], v[154:155] op_sel_hi:[1,0,1]
    v_pk_fma_f32 v[156:157], v[164:165], v[30:31], v[156:157] op_sel_hi:[1,0,1]
    v_pk_fma_f32 v[158:159], v[166:167], v[30:31], v[158:159] op_sel_hi:[1,0,1]
    v_lshlrev_b32 v160, 16, v102
    v_and_b32 v161, 0xffff0000, v102
    v_lshlrev_b32 v162, 16, v103
    v_and_b32 v163, 0xffff0000, v103
    v_lshlrev_b32 v164, 16, v104
    v_and_b32 v165, 0xffff0000, v104
    v_lshlrev_b32 v166, 16, v105
    v_and_b32 v167, 0xffff0000, v105
    v_pk_fma_f32 v[152:153], v[160:161], v[30:31], v[152:153] op_sel:[0,1,0] op_sel_hi:[1,1,1]
    v_pk_fma_f32 v[154:155], v[162:163], v[30:31], v[154:155] op_sel:[0,1,0] op_sel_hi:[1,1,1]
    v_pk_fma_f32 v[156:157], v[164:165], v[30:31], v[156:157] op_sel:[0,1,0] op_sel_hi:[1,1,1]
    v_pk_fma_f32 v[158:159], v[166:167], v[30:31], v[158:159] op_sel:[0,1,0] op_sel_hi:[1,1,1]
    v_lshlrev_b32 v160, 16, v106
    v_and_b32 v161, 0xffff0000, v106
    v_lshlrev_b32 v162, 16, v107
    v_and_b32 v163, 0xffff0000, v107
    v_lshlrev_b32 v164, 16, v108
    v_and_b32 v165, 0xffff0000, v108
    v_lshlrev_b32 v166, 16, v109
    v_and_b32 v167, 0xffff0000, v109
    v_pk_fma_f32 v[152:153], v[160:161], v[32:33], v[152:153] op_sel_hi:[1,0,1]
    v_pk_fma_f32 v[154:155], v[162:163], v[32:33], v[154:155] op_sel_hi:[1,0,1]
    v_pk_fma_f32 v[156:157], v[164:165], v[32:33], v[156:157] op_sel_hi:[1,0,1]
    v_pk_fma_f32 v[158:159], v[166:167], v[32:33], v[158:159] op_sel_hi:[1,0,1]
    v_lshlrev_b32 v160, 16, v110
    v_and_b32 v161, 0xffff0000, v110
    v_lshlrev_b32 v162, 16, v111
    v_and_b32 v163, 0xffff0000, v111
    v_lshlrev_b32 v164, 16, v112
    v_and_b32 v165, 0xffff0000, v112
    v_lshlrev_b32 v166, 16, v113
    v_and_b32 v167, 0xffff0000, v113
    v_pk_fma_f32 v[152:153], v[160:161], v[32:33], v[152:153] op_sel:[0,1,0] op_sel_hi:[1,1,1]
    v_pk_fma_f32 v[154:155], v[162:163], v[32:33], v[154:155] op_sel:[0,1,0] op_sel_hi:[1,1,1]
    v_pk_fma_f32 v[156:157], v[164:165], v[32:33], v[156:157] op_sel:[0,1,0] op_sel_hi:[1,1,1]
    v_pk_fma_f32 v[158:159], v[166:167], v[32:33], v[158:159] op_sel:[0,1,0] op_sel_hi:[1,1,1]
    s_waitcnt vmcnt(5)
    v_lshlrev_b32 v160, 16, v114
    v_and_b32 v161, 0xffff0000, v114
    v_lshlrev_b32 v162, 16, v115
    v_and_b32 v163, 0xffff0000, v115
    v_lshlrev_b32 v164, 16, v116
    v_and_b32 v165, 0xffff0000, v116
    v_lshlrev_b32 v166, 16, v117
    v_and_b32 v167, 0xffff0000, v117
    v_pk_fma_f32 v[152:153], v[160:161], v[8:9], v[152:153] op_sel_hi:[1,0,1]
    v_pk_fma_f32 v[154:155], v[162:163], v[8:9], v[154:155] op_sel_hi:[1,0,1]
    v_pk_fma_f32 v[156:157], v[164:165], v[8:9], v[156:157] op_sel_hi:[1,0,1]
    v_pk_fma_f32 v[158:159], v[166:167], v[8:9], v[158:159] op_sel_hi:[1,0,1]
    s_waitcnt vmcnt(4)
    v_lshlrev_b32 v160, 16, v118
    v_and_b32 v161, 0xffff0000, v118
    v_lshlrev_b32 v162, 16, v119
    v_and_b32 v163, 0xffff0000, v119
    v_lshlrev_b32 v164, 16, v120
    v_and_b32 v165, 0xffff0000, v120
    v_lshlrev_b32 v166, 16, v121
    v_and_b32 v167, 0xffff0000, v121
    v_pk_fma_f32 v[152:153], v[160:161], v[8:9], v[152:153] op_sel:[0,1,0] op_sel_hi:[1,1,1]
    v_pk_fma_f32 v[154:155], v[162:163], v[8:9], v[154:155] op_sel:[0,1,0] op_sel_hi:[1,1,1]
    v_pk_fma_f32 v[156:157], v[164:165], v[8:9], v[156:157] op_sel:[0,1,0] op_sel_hi:[1,1,1]
    v_pk_fma_f32 v[158:159], v[166:167], v[8:9], v[158:159] op_sel:[0,1,0] op_sel_hi:[1,1,1]
    s_waitcnt vmcnt(3)
    v_lshlrev_b32 v160, 16, v122
    v_and_b32 v161, 0xffff0000, v122
    v_lshlrev_b32 v162, 16, v123
    v_and_b32 v163, 0xffff0000, v123
    v_lshlrev_b32 v164, 16, v124
    v_and_b32 v165, 0xffff0000, v124
    v_lshlrev_b32 v166, 16, v125
    v_and_b32 v167, 0xffff0000, v125
    v_pk_fma_f32 v[152:153], v[160:161], v[10:11], v[152:153] op_sel_hi:[1,0,1]
    v_pk_fma_f32 v[154:155], v[162:163], v[10:11], v[154:155] op_sel_hi:[1,0,1]
    v_pk_fma_f32 v[156:157], v[164:165], v[10:11], v[156:157] op_sel_hi:[1,0,1]
    v_pk_fma_f32 v[158:159], v[166:167], v[10:11], v[158:159] op_sel_hi:[1,0,1]
    s_waitcnt vmcnt(2)
    v_lshlrev_b32 v160, 16, v126
    v_and_b32 v161, 0xffff0000, v126
    v_lshlrev_b32 v162, 16, v127
    v_and_b32 v163, 0xffff0000, v127
    v_lshlrev_b32 v164, 16, v128
    v_and_b32 v165, 0xffff0000, v128
    v_lshlrev_b32 v166, 16, v129
    v_and_b32 v167, 0xffff0000, v129
    v_pk_fma_f32 v[152:153], v[160:161], v[10:11], v[152:153] op_sel:[0,1,0] op_sel_hi:[1,1,1]
    v_pk_fma_f32 v[154:155], v[162:163], v[10:11], v[154:155] op_sel:[0,1,0] op_sel_hi:[1,1,1]
    v_pk_fma_f32 v[156:157], v[164:165], v[10:11], v[156:157] op_sel:[0,1,0] op_sel_hi:[1,1,1]
    v_pk_fma_f32 v[158:159], v[166:167], v[10:11], v[158:159] op_sel:[0,1,0] op_sel_hi:[1,1,1]
    s_waitcnt vmcnt(1)
    v_lshlrev_b32 v160, 16, v130
    v_and_b32 v161, 0xffff0000, v130
    v_lshlrev_b32 v162, 16, v131
    v_and_b32 v163, 0xffff0000, v131
    v_lshlrev_b32 v164, 16, v132
    v_and_b32 v165, 0xffff0000, v132
    v_lshlrev_b32 v166, 16, v133
    v_and_b32 v167, 0xffff0000, v133
    v_pk_fma_f32 v[152:153], v[160:161], v[12:13], v[152:153] op_sel_hi:[1,0,1]
    v_pk_fma_f32 v[154:155], v[162:163], v[12:13], v[154:155] op_sel_hi:[1,0,1]
    v_pk_fma_f32 v[156:157], v[164:165], v[12:13], v[156:157] op_sel_hi:[1,0,1]
    v_pk_fma_f32 v[158:159], v[166:167], v[12:13], v[158:159] op_sel_hi:[1,0,1]
    s_waitcnt vmcnt(0)
    v_lshlrev_b32 v160, 16, v134
    v_and_b32 v161, 0xffff0000, v134
    v_lshlrev_b32 v162, 16, v135
    v_and_b32 v163, 0xffff0000, v135
    v_lshlrev_b32 v164, 16, v136
    v_and_b32 v165, 0xffff0000, v136
    v_lshlrev_b32 v166, 16, v137
    v_and_b32 v167, 0xffff0000, v137
    v_pk_fma_f32 v[152:153], v[160:161], v[12:13], v[152:153] op_sel:[0,1,0] op_sel_hi:[1,1,1]
    v_pk_fma_f32 v[154:155], v[162:163], v[12:13], v[154:155] op_sel:[0,1,0] op_sel_hi:[1,1,1]
    v_pk_fma_f32 v[156:157], v[164:165], v[12:13], v[156:157] op_sel:[0,1,0] op_sel_hi:[1,1,1]
    v_pk_fma_f32 v[158:159], v[166:167], v[12:13], v[158:159] op_sel:[0,1,0] op_sel_hi:[1,1,1]
L_AFIN:
    s_nop 1
    v_permlane32_swap_b32 v152, v156
    v_permlane32_swap_b32 v153, v157
    v_permlane32_swap_b32 v154, v158
    v_permlane32_swap_b32 v155, v159
    v_add_f32 v152, v152, v156
    v_add_f32 v153, v153, v157
    v_add_f32 v154, v154, v158
    v_add_f32 v155, v155, v159
    s_nop 0
    v_permlane16_swap_b32 v152, v154
    v_permlane16_swap_b32 v153, v155
    v_add_f32 v152, v152, v154
    v_add_f32 v153, v153, v155
    ds_write_b64 v2, v[152:153]
    s_waitcnt lgkmcnt(0)
    s_barrier
    s_endpgm
L_ASVC:
    s_cmp_lg_u32 s3, 11
    s_cbranch_scc1 Z_14
    v_lshlrev_b32 v2, 2, v1
    v_add_u32 v2, 0x24000, v2
    v_mov_b32 v3, 0
    ds_write_b32 v2, v3
Z_14:
    s_waitcnt lgkmcnt(0)
    s_mov_b32 s92, 0x05040100
    s_mov_b32 s93, 0x07060302
    s_mov_b32 s36, s34
    s_and_b32 s37, s35, 0xffff
    s_mov_b32 s38, 0x1000000
    s_mov_b32 s39, 0x20000
    s_mov_b32 s40, s32
    s_and_b32 s41, s33, 0xffff
    s_mov_b32 s42, 0x100
    s_mov_b32 s43, 0x20000
    s_setprio 3
    s_lshr_b32 s60, s5, 2
    s_sub_u32 s60, s60, 4
    s_barrier
    s_lshl_b32 s7, s6, 2
    s_add_u32 s7, s7, s60
    s_lshl_b32 s7, s7, 11
    v_lshl_add_u32 v3, v1, 4, s7
    v_add_u32 v5, 0x40000, v3
    v_add_u32 v3, 0x80000, v3
    s_xor_b32 s7, s6, 2
    s_lshl_b32 s7, s7, 5
    s_add_u32 s7, s7, s60
    s_lshl_b32 s7, s7, 8
    s_add_u32 s7, s7, 0x80000
    v_lshrrev_b32 v6, 4, v1
    v_lshlrev_b32 v6, 11, v6
    v_and_b32 v100, 15, v1
    v_lshl_add_u32 v6, v100, 4, v6
    v_add_u32 v6, s7, v6
    s_sleep 8
    v_mov_b32 v90, 0
    s_mov_b32 s80, 200000
    s_mov_b64 exec, 1
    buffer_load_dwordx2 v[94:95], v90, s[40:43], 0 offen sc1
    s_sleep 16
    buffer_load_dwordx2 v[92:93], v90, s[40:43], 0 offen sc1
    s_mov_b64 exec, -1
    v_mov_b32 v96, 0x24000
    v_mov_b32 v97, 1
    s_waitcnt lgkmcnt(0)
    s_mov_b64 exec, 1
    ds_add_u32 v96, v97
    s_mov_b64 exec, -1
    s_waitcnt vmcnt(1)
    v_readfirstlane_b32 s94, v94
    v_readfirstlane_b32 s95, v95
    s_cmp_lg_u32 s95, 0
    s_cbranch_scc1 NGD_16
    s_branch NG2_17
NG_15:
    s_mov_b64 exec, 1
    buffer_load_dwordx2 v[92:93], v90, s[40:43], 0 offen sc1
    s_mov_b64 exec, -1
NG2_17:
    s_waitcnt vmcnt(0)
    v_readfirstlane_b32 s94, v92
    v_readfirstlane_b32 s95, v93
    s_cmp_lg_u32 s95, 0
    s_cbranch_scc1 NGD_16
    s_sleep 4
    s_sub_u32 s80, s80, 1
    s_cmp_lg_u32 s80, 0
    s_cbranch_scc1 NG_15
NGD_16:
    v_lshlrev_b32 v7, 5, v1
    v_mov_b32 v114, s94
    v_mov_b32 v115, s95
    v_mov_b32 v118, s94
    v_mov_b32 v119, s95
    v_mov_b32 v122, s94
    v_mov_b32 v123, s95
    v_mov_b32 v126, s94
    v_mov_b32 v127, s95
    v_mov_b32 v100, 0x24044
    s_mov_b32 s80, 1600000
LW_18:
    ds_read_b32 v101, v100
    s_waitcnt lgkmcnt(0)
    v_readfirstlane_b32 s79, v101
    s_cmp_ge_u32 s79, 4
    s_cbranch_scc1 LWD_19
    s_sub_u32 s80, s80, 1
    s_cmp_lg_u32 s80, 0
    s_cbranch_scc1 LW_18
LWD_19:
    ds_read_b128 v[16:19], v7 offset:0
    ds_read_b128 v[20:23], v7 offset:16
    ds_read_b128 v[24:27], v7 offset:2048
    ds_read_b128 v[28:31], v7 offset:2064
    ds_read_b128 v[32:35], v7 offset:4096
    ds_read_b128 v[36:39], v7 offset:4112
    ds_read_b128 v[40:43], v7 offset:6144
    ds_read_b128 v[44:47], v7 offset:6160
    s_waitcnt lgkmcnt(0)
    v_add_f32 v16, v16, v32
    v_add_f32 v17, v17, v33
    v_add_f32 v18, v18, v34
    v_add_f32 v19, v19, v35
    v_add_f32 v20, v20, v36
    v_add_f32 v21, v21, v37
    v_add_f32 v22, v22, v38
    v_add_f32 v23, v23, v39
    v_add_f32 v24, v24, v40
    v_add_f32 v25, v25, v41
    v_add_f32 v26, v26, v42
    v_add_f32 v27, v27, v43
    v_add_f32 v28, v28, v44
    v_add_f32 v29, v29, v45
    v_add_f32 v30, v30, v46
    v_add_f32 v31, v31, v47
    v_add_f32 v16, v16, v24
    v_add_f32 v17, v17, v25
    v_add_f32 v18, v18, v26
    v_add_f32 v19, v19, v27
    v_add_f32 v20, v20, v28
    v_add_f32 v21, v21, v29
    v_add_f32 v22, v22, v30
    v_add_f32 v23, v23, v31
    v_cvt_pk_bf16_f32 v112, v16, v17
    v_cvt_pk_bf16_f32 v113, v18, v19
    v_cvt_pk_bf16_f32 v116, v20, v21
    v_cvt_pk_bf16_f32 v117, v22, v23
    buffer_store_dwordx4 v[112:115], v5, s[36:39], 0 offen offset:0
    buffer_store_dwordx4 v[116:119], v5, s[36:39], 0 offen offset:1024
    v_mov_b32 v100, 0x24018
    v_mov_b32 v101, 1
    s_waitcnt lgkmcnt(0)
    s_mov_b64 exec, 1
    ds_add_u32 v100, v101
    s_mov_b64 exec, -1
    v_mov_b32 v100, 0x24040
    s_mov_b32 s80, 1600000
LW_20:
    ds_read_b32 v101, v100
    s_waitcnt lgkmcnt(0)
    v_readfirstlane_b32 s79, v101
    s_cmp_ge_u32 s79, 4
    s_cbranch_scc1 LWD_21
    s_sub_u32 s80, s80, 1
    s_cmp_lg_u32 s80, 0
    s_cbranch_scc1 LW_20
LWD_21:
    ds_read_b128 v[16:19], v7 offset:8192
    ds_read_b128 v[20:23], v7 offset:8208
    ds_read_b128 v[24:27], v7 offset:10240
    ds_read_b128 v[28:31], v7 offset:10256
    ds_read_b128 v[32:35], v7 offset:12288
    ds_read_b128 v[36:39], v7 offset:12304
    ds_read_b128 v[40:43], v7 offset:14336
    ds_read_b128 v[44:47], v7 offset:14352
    s_waitcnt lgkmcnt(0)
    v_add_f32 v16, v16, v32
    v_add_f32 v17, v17, v33
    v_add_f32 v18, v18, v34
    v_add_f32 v19, v19, v35
    v_add_f32 v20, v20, v36
    v_add_f32 v21, v21, v37
    v_add_f32 v22, v22, v38
    v_add_f32 v23, v23, v39
    v_add_f32 v24, v24, v40
    v_add_f32 v25, v25, v41
    v_add_f32 v26, v26, v42
    v_add_f32 v27, v27, v43
    v_add_f32 v28, v28, v44
    v_add_f32 v29, v29, v45
    v_add_f32 v30, v30, v46
    v_add_f32 v31, v31, v47
    v_add_f32 v16, v16, v24
    v_add_f32 v17, v17, v25
    v_add_f32 v18, v18, v26
    v_add_f32 v19, v19, v27
    v_add_f32 v20, v20, v28
    v_add_f32 v21, v21, v29
    v_add_f32 v22, v22, v30
    v_add_f32 v23, v23, v31
    v_cvt_pk_bf16_f32 v120, v16, v17
    v_cvt_pk_bf16_f32 v121, v18, v19
    v_cvt_pk_bf16_f32 v124, v20, v21
    v_cvt_pk_bf16_f32 v125, v22, v23
    buffer_store_dwordx4 v[120:123], v6, s[36:39], 0 offen offset:0
    buffer_store_dwordx4 v[124:127], v6, s[36:39], 0 offen offset:1024
    v_mov_b32 v100, 0x24018
    v_mov_b32 v101, 1
    s_waitcnt lgkmcnt(0)
    s_mov_b64 exec, 1
    ds_add_u32 v100, v101
    s_mov_b64 exec, -1
    v_mov_b32 v110, v5
    v_mov_b32 v111, v6
    s_getreg_b32 s96, hwreg(HW_REG_XCC_ID, 0, 4)
    s_lshl_b32 s7, s4, 5
    s_add_u32 s7, s7, s5
    s_lshl_b32 s7, s7, 4
    s_add_u32 s7, s7, 0xc0000
    v_mov_b32 v100, s7
    v_mov_b32 v102, s96
    v_mov_b32 v103, 0
    v_mov_b32 v104, s94
    v_mov_b32 v105, s95
    s_mov_b64 exec, 1
    buffer_store_dwordx4 v[102:105], v100, s[36:39], 0 offen
    s_mov_b64 exec, -1
    s_sleep 16
    buffer_load_dwordx4 v[32:35], v3, s[36:39], 0 offen offset:0 sc1
    buffer_load_dwordx4 v[36:39], v3, s[36:39], 0 offen offset:1024 sc1
    s_mov_b32 s80, 200000
PS_22:
    s_waitcnt vmcnt(0)
    s_mov_b32 s78, 0
    v_cmp_ne_u64 vcc, s[94:95], v[34:35]
    s_cbranch_vccz PSS_24
    buffer_load_dwordx4 v[32:35], v3, s[36:39], 0 offen offset:0 sc1
    s_mov_b32 s78, 1
PSS_24:
    v_cmp_ne_u64 vcc, s[94:95], v[38:39]
    s_cbranch_vccz PSS_25
    buffer_load_dwordx4 v[36:39], v3, s[36:39], 0 offen offset:1024 sc1
    s_mov_b32 s78, 1
PSS_25:
    s_cmp_eq_u32 s78, 0
    s_cbranch_scc1 PSD_23
    s_sleep 8
    s_cmp_lg_u32 s80, 199984
    s_cbranch_scc1 PSL_26
    buffer_store_dwordx4 v[112:115], v110, s[36:39], 0 offen offset:0 sc1
    buffer_store_dwordx4 v[116:119], v110, s[36:39], 0 offen offset:1024 sc1
    buffer_store_dwordx4 v[120:123], v111, s[36:39], 0 offen offset:0 sc1
    buffer_store_dwordx4 v[124:127], v111, s[36:39], 0 offen offset:1024 sc1
PSL_26:
    s_sub_u32 s80, s80, 1
    s_cmp_lg_u32 s80, 0
    s_cbranch_scc1 PS_22
    s_waitcnt vmcnt(0)
PSD_23:
    v_lshlrev_b32 v16, 16, v32
    v_and_b32 v17, 0xffff0000, v32
    v_lshlrev_b32 v18, 16, v33
    v_and_b32 v19, 0xffff0000, v33
    v_lshlrev_b32 v20, 16, v36
    v_and_b32 v21, 0xffff0000, v36
    v_lshlrev_b32 v22, 16, v37
    v_and_b32 v23, 0xffff0000, v37
    v_mov_b32 v24, v16
    v_mov_b32 v25, v17
    v_mov_b32 v26, v18
    v_mov_b32 v27, v19
    v_mov_b32 v28, v20
    v_mov_b32 v29, v21
    v_mov_b32 v30, v22
    v_mov_b32 v31, v23
    v_permlane32_swap_b32 v16, v24
    v_permlane32_swap_b32 v17, v25
    v_permlane32_swap_b32 v18, v26
    v_permlane32_swap_b32 v19, v27
    v_permlane32_swap_b32 v20, v28
    v_permlane32_swap_b32 v21, v29
    v_permlane32_swap_b32 v22, v30
    v_permlane32_swap_b32 v23, v31
    v_add_f32 v16, v16, v24
    v_add_f32 v17, v17, v25
    v_add_f32 v18, v18, v26
    v_add_f32 v19, v19, v27
    v_add_f32 v20, v20, v28
    v_add_f32 v21, v21, v29
    v_add_f32 v22, v22, v30
    v_add_f32 v23, v23, v31
    v_mov_b32 v24, v16
    v_mov_b32 v25, v17
    v_mov_b32 v26, v18
    v_mov_b32 v27, v19
    v_mov_b32 v28, v20
    v_mov_b32 v29, v21
    v_mov_b32 v30, v22
    v_mov_b32 v31, v23
    v_permlane16_swap_b32 v16, v24
    v_permlane16_swap_b32 v17, v25
    v_permlane16_swap_b32 v18, v26
    v_permlane16_swap_b32 v19, v27
    v_permlane16_swap_b32 v20, v28
    v_permlane16_swap_b32 v21, v29
    v_permlane16_swap_b32 v22, v30
    v_permlane16_swap_b32 v23, v31
    v_add_f32 v16, v16, v24
    v_add_f32 v17, v17, v25
    v_add_f32 v18, v18, v26
    v_add_f32 v19, v19, v27
    v_add_f32 v20, v20, v28
    v_add_f32 v21, v21, v29
    v_add_f32 v22, v22, v30
    v_add_f32 v23, v23, v31
    v_cvt_pk_bf16_f32 v8, v16, v17
    v_cvt_pk_bf16_f32 v9, v18, v19
    v_cvt_pk_bf16_f32 v10, v20, v21
    v_cvt_pk_bf16_f32 v11, v22, v23
    v_and_b32 v100, 15, v1
    v_lshlrev_b32 v100, 4, v100
    v_add_u32 v100, 0x24100, v100
    ds_write_b128 v100, v[8:11]
L_ACUT:
    v_mov_b32 v100, 0x24004
    v_mov_b32 v101, 1
    s_waitcnt lgkmcnt(0)
    s_mov_b64 exec, 1
    ds_add_u32 v100, v101
    s_mov_b64 exec, -1
    v_mov_b32 v100, 0x24008
    s_mov_b32 s80, 1600000
LW_27:
    ds_read_b32 v101, v100
    s_waitcnt lgkmcnt(0)
    v_readfirstlane_b32 s79, v101
    s_cmp_ge_u32 s79, 1
    s_cbranch_scc1 LWD_28
    s_sleep 8
    s_sub_u32 s80, s80, 1
    s_cmp_lg_u32 s80, 0
    s_cbranch_scc1 LW_27
LWD_28:
    v_and_b32 v100, 31, v1
    s_lshl_b32 s7, s4, 9
    s_add_u32 s7, s7, 0xc0000
    v_lshl_add_u32 v100, v100, 4, s7
    buffer_load_dwordx4 v[32:35], v100, s[36:39], 0 offen sc1
    s_waitcnt vmcnt(0)
    v_cmp_ne_u64 vcc, s[94:95], v[34:35]
    v_cmp_ne_u32 s[86:87], s96, v32
    s_or_b32 s97, vcc_lo, s86
    s_and_b32 s97, s97, 0xffff00ff
    s_cbranch_scc0 AF_29
    buffer_store_dwordx4 v[112:115], v110, s[36:39], 0 offen offset:0 sc1
    buffer_store_dwordx4 v[116:119], v110, s[36:39], 0 offen offset:1024 sc1
    buffer_store_dwordx4 v[120:123], v111, s[36:39], 0 offen offset:0 sc1
    buffer_store_dwordx4 v[124:127], v111, s[36:39], 0 offen offset:1024 sc1
AF_29:
    v_mov_b32 v100, 0x24008
    s_mov_b32 s80, 1600000
LW_30:
    ds_read_b32 v101, v100
    s_waitcnt lgkmcnt(0)
    v_readfirstlane_b32 s79, v101
    s_cmp_ge_u32 s79, 11
    s_cbranch_scc1 LWD_31
    s_sleep 2
    s_sub_u32 s80, s80, 1
    s_cmp_lg_u32 s80, 0
    s_cbranch_scc1 LW_30
LWD_31:
    v_mov_b32 v100, 0x24200
    ds_read_b128 v[8:11], v100 offset:0
    ds_read_b128 v[12:15], v100 offset:16
    ds_read_b128 v[16:19], v100 offset:32
    ds_read_b128 v[20:23], v100 offset:48
    ds_read_b128 v[24:27], v100 offset:64
    ds_read_b128 v[28:31], v100 offset:80
    s_waitcnt lgkmcnt(0)
    v_max3_f32 v100, v8, v10, v12
    v_max3_f32 v100, v100, v14, v16
    v_max3_f32 v100, v100, v18, v20
    v_max3_f32 v100, v100, v22, v24
    v_max3_f32 v100, v100, v26, v28
    v_sub_f32 v8, v8, v100
    v_sub_f32 v10, v10, v100
    v_sub_f32 v12, v12, v100
    v_sub_f32 v14, v14, v100
    v_sub_f32 v16, v16, v100
    v_sub_f32 v18, v18, v100
    v_sub_f32 v20, v20, v100
    v_sub_f32 v22, v22, v100
    v_sub_f32 v24, v24, v100
    v_sub_f32 v26, v26, v100
    v_sub_f32 v28, v28, v100
    v_exp_f32 v8, v8
    v_exp_f32 v10, v10
    v_exp_f32 v12, v12
    v_exp_f32 v14, v14
    v_exp_f32 v16, v16
    v_exp_f32 v18, v18
    v_exp_f32 v20, v20
    v_exp_f32 v22, v22
    v_exp_f32 v24, v24
    v_exp_f32 v26, v26
    v_exp_f32 v28, v28
    v_mul_f32 v101, v8, v9
    v_fmac_f32 v101, v10, v11
    v_fmac_f32 v101, v12, v13
    v_fmac_f32 v101, v14, v15
    v_fmac_f32 v101, v16, v17
    v_fmac_f32 v101, v18, v19
    v_fmac_f32 v101, v20, v21
    v_fmac_f32 v101, v22, v23
    v_fmac_f32 v101, v24, v25
    v_fmac_f32 v101, v26, v27
    v_fmac_f32 v101, v28, v29
    v_rcp_f32 v101, v101
    s_nop 0
    v_mul_f32 v8, v8, v101
    v_mul_f32 v10, v10, v101
    v_mul_f32 v12, v12, v101
    v_mul_f32 v14, v14, v101
    v_mul_f32 v16, v16, v101
    v_mul_f32 v18, v18, v101
    v_mul_f32 v20, v20, v101
    v_mul_f32 v22, v22, v101
    v_mul_f32 v24, v24, v101
    v_mul_f32 v26, v26, v101
    v_mul_f32 v28, v28, v101
    v_and_b32 v100, 15, v1
    v_bfe_u32 v101, v1, 4, 1
    v_lshlrev_b32 v3, 5, v100
    v_lshl_add_u32 v3, v101, 4, v3
    v_add_u32 v3, 0x25000, v3
    s_lshl_b32 s7, s6, 3
    s_add_u32 s7, s7, s60
    s_lshl_b32 s7, s7, 8
    s_add_u32 s7, s7, 0xd0000
    v_lshlrev_b32 v2, 4, v100
    v_lshl_add_u32 v2, v101, 10, v2
    v_add_u32 v2, s7, v2
    v_mov_b32 v6, s94
    v_mov_b32 v7, s95
    s_barrier
    ds_read_b128 v[40:43], v3 offset:0
    ds_read_b128 v[44:47], v3 offset:512
    ds_read_b128 v[48:51], v3 offset:1024
    ds_read_b128 v[52:55], v3 offset:1536
    ds_read_b128 v[56:59], v3 offset:2048
    ds_read_b128 v[60:63], v3 offset:2560
    ds_read_b128 v[64:67], v3 offset:3072
    ds_read_b128 v[68:71], v3 offset:3584
    ds_read_b128 v[72:75], v3 offset:4096
    ds_read_b128 v[76:79], v3 offset:4608
    ds_read_b128 v[80:83], v3 offset:5120
    s_waitcnt lgkmcnt(10)
    v_pk_mul_f32 v[32:33], v[40:41], v[8:9] op_sel_hi:[1,0]
    v_pk_mul_f32 v[34:35], v[42:43], v[8:9] op_sel_hi:[1,0]
    s_waitcnt lgkmcnt(9)
    v_pk_mul_f32 v[36:37], v[44:45], v[10:11] op_sel_hi:[1,0]
    v_pk_mul_f32 v[38:39], v[46:47], v[10:11] op_sel_hi:[1,0]
    s_waitcnt lgkmcnt(8)
    v_pk_fma_f32 v[32:33], v[48:49], v[12:13], v[32:33] op_sel_hi:[1,0,1]
    v_pk_fma_f32 v[34:35], v[50:51], v[12:13], v[34:35] op_sel_hi:[1,0,1]
    s_waitcnt lgkmcnt(7)
    v_pk_fma_f32 v[36:37], v[52:53], v[14:15], v[36:37] op_sel_hi:[1,0,1]
    v_pk_fma_f32 v[38:39], v[54:55], v[14:15], v[38:39] op_sel_hi:[1,0,1]
    s_waitcnt lgkmcnt(6)
    v_pk_fma_f32 v[32:33], v[56:57], v[16:17], v[32:33] op_sel_hi:[1,0,1]
    v_pk_fma_f32 v[34:35], v[58:59], v[16:17], v[34:35] op_sel_hi:[1,0,1]
    s_waitcnt lgkmcnt(5)
    v_pk_fma_f32 v[36:37], v[60:61], v[18:19], v[36:37] op_sel_hi:[1,0,1]
    v_pk_fma_f32 v[38:39], v[62:63], v[18:19], v[38:39] op_sel_hi:[1,0,1]
    s_waitcnt lgkmcnt(4)
    v_pk_fma_f32 v[32:33], v[64:65], v[20:21], v[32:33] op_sel_hi:[1,0,1]
    v_pk_fma_f32 v[34:35], v[66:67], v[20:21], v[34:35] op_sel_hi:[1,0,1]
    s_waitcnt lgkmcnt(3)
    v_pk_fma_f32 v[36:37], v[68:69], v[22:23], v[36:37] op_sel_hi:[1,0,1]
    v_pk_fma_f32 v[38:39], v[70:71], v[22:23], v[38:39] op_sel_hi:[1,0,1]
    s_waitcnt lgkmcnt(2)
    v_pk_fma_f32 v[32:33], v[72:73], v[24:25], v[32:33] op_sel_hi:[1,0,1]
    v_pk_fma_f32 v[34:35], v[74:75], v[24:25], v[34:35] op_sel_hi:[1,0,1]
    s_waitcnt lgkmcnt(1)
    v_pk_fma_f32 v[36:37], v[76:77], v[26:27], v[36:37] op_sel_hi:[1,0,1]
    v_pk_fma_f32 v[38:39], v[78:79], v[26:27], v[38:39] op_sel_hi:[1,0,1]
    s_waitcnt lgkmcnt(0)
    v_pk_fma_f32 v[32:33], v[80:81], v[28:29], v[32:33] op_sel_hi:[1,0,1]
    v_pk_fma_f32 v[34:35], v[82:83], v[28:29], v[34:35] op_sel_hi:[1,0,1]
    v_pk_add_f32 v[32:33], v[32:33], v[36:37]
    v_pk_add_f32 v[34:35], v[34:35], v[38:39]
    v_cvt_pk_bf16_f32 v4, v32, v33
    v_cvt_pk_bf16_f32 v5, v34, v35
    s_mov_b64 exec, 0xffffffff
    buffer_store_dwordx4 v[4:7], v2, s[36:39], 0 offen
    s_cmp_eq_u32 s97, 0
    s_cbranch_scc1 AF_32
    buffer_store_dwordx4 v[4:7], v2, s[36:39], 0 offen sc1
AF_32:
    s_mov_b64 exec, -1
    s_endpgm
.p2align 12
L_W:
    s_waitcnt lgkmcnt(0)
    s_mov_b32 s92, 0x05040100
    s_mov_b32 s93, 0x07060302
    s_mov_b32 s36, s34
    s_and_b32 s37, s35, 0xffff
    s_mov_b32 s38, 0x1000000
    s_mov_b32 s39, 0x20000
    s_mov_b32 s40, s32
    s_and_b32 s41, s33, 0xffff
    s_mov_b32 s42, 0x100
    s_mov_b32 s43, 0x20000
    s_barrier
    s_cmp_eq_u32 s3, 0
    s_cbranch_scc1 LT_U1
LR_U1:
    s_cmp_eq_u32 s3, 1
    s_cbranch_scc1 LT_W2R
LR_W2R:
    s_cmp_ge_u32 s5, 4
    s_cbranch_scc1 L_END
    v_mov_b32 v160, 0x24048
    s_mov_b32 s80, 1600000
LW_33:
    ds_read_b32 v161, v160
    s_waitcnt lgkmcnt(0)
    v_readfirstlane_b32 s79, v161
    s_cmp_ge_u32 s79, 4
    s_cbranch_scc1 LWD_34
    s_sleep 4
    s_sub_u32 s80, s80, 1
    s_cmp_lg_u32 s80, 0
    s_cbranch_scc1 LW_33
LWD_34:
    s_branch L_U1
L_W1:
    s_waitcnt lgkmcnt(0)
    s_mov_b32 s92, 0x05040100
    s_mov_b32 s93, 0x07060302
    s_mov_b32 s36, s34
    s_and_b32 s37, s35, 0xffff
    s_mov_b32 s38, 0x1000000
    s_mov_b32 s39, 0x20000
    s_mov_b32 s40, s32
    s_and_b32 s41, s33, 0xffff
    s_mov_b32 s42, 0x100
    s_mov_b32 s43, 0x20000
    s_setprio 3
    s_barrier
    s_cmp_lg_u32 s3, 4
    s_cbranch_scc1 W4_35
    s_sleep 8
    v_mov_b32 v152, 0
    s_mov_b32 s80, 200000
    s_mov_b64 exec, 1
    buffer_load_dwordx2 v[156:157], v152, s[40:43], 0 offen sc1
    s_sleep 16
    buffer_load_dwordx2 v[154:155], v152, s[40:43], 0 offen sc1
    s_mov_b64 exec, -1
    s_waitcnt vmcnt(1)
    v_readfirstlane_b32 s94, v156
    v_readfirstlane_b32 s95, v157
    s_cmp_lg_u32 s95, 0
    s_cbranch_scc1 NGD_37
    s_branch NG2_38
NG_36:
    s_mov_b64 exec, 1
    buffer_load_dwordx2 v[154:155], v152, s[40:43], 0 offen sc1
    s_mov_b64 exec, -1
NG2_38:
    s_waitcnt vmcnt(0)
    v_readfirstlane_b32 s94, v154
    v_readfirstlane_b32 s95, v155
    s_cmp_lg_u32 s95, 0
    s_cbranch_scc1 NGD_37
    s_sleep 4
    s_sub_u32 s80, s80, 1
    s_cmp_lg_u32 s80, 0
    s_cbranch_scc1 NG_36
NGD_37:
    v_mov_b32 v160, 0x24050
    v_mov_b32 v162, s94
    v_mov_b32 v163, s95
    ds_write_b64 v160, v[162:163]
    v_mov_b32 v160, 0x2404c
    v_mov_b32 v161, 1
    s_waitcnt lgkmcnt(0)
    s_mov_b64 exec, 1
    ds_add_u32 v160, v161
    s_mov_b64 exec, -1
    s_getreg_b32 s96, hwreg(HW_REG_XCC_ID, 0, 4)
    s_lshl_b32 s7, s4, 5
    s_add_u32 s7, s7, s5
    s_lshl_b32 s7, s7, 4
    s_add_u32 s7, s7, 0xc0000
    v_mov_b32 v160, s7
    v_mov_b32 v162, s96
    v_mov_b32 v163, 0
    v_mov_b32 v164, s94
    v_mov_b32 v165, s95
    s_mov_b64 exec, 1
    buffer_store_dwordx4 v[162:165], v160, s[36:39], 0 offen
    s_mov_b64 exec, -1
W4_35:
    s_sub_u32 s62, s3, 4
    s_lshl_b32 s61, s4, 2
    s_add_u32 s61, s61, s62
    v_lshrrev_b32 v162, 4, v1
    v_and_b32 v161, 15, v1
    v_lshlrev_b32 v2, 16, v162
    v_lshl_add_u32 v2, v161, 4, v2
    s_lshl_b32 s7, s61, 3
    s_add_u32 s7, s7, s5
    s_lshl_b32 s7, s7, 8
    s_add_u32 s7, s7, 0x0
    v_add_u32 v2, s7, v2
    v_lshlrev_b32 v3, 6, v161
    v_lshl_add_u32 v3, v162, 4, v3
    s_lshl_b32 s7, s61, 13
    s_add_u32 s7, s7, 0x40000
    v_add_u32 v3, s7, v3
    v_xor_b32 v5, v162, v161
    v_lshlrev_b32 v5, 4, v5
    v_lshl_add_u32 v4, v161, 12, v5
    s_lshl_b32 s7, s62, 8
    v_add_u32 v4, s7, v4
    v_mov_b32 v160, 0x2404c
    s_mov_b32 s80, 1600000
LW_39:
    ds_read_b32 v161, v160
    s_waitcnt lgkmcnt(0)
    v_readfirstlane_b32 s79, v161
    s_cmp_ge_u32 s79, 1
    s_cbranch_scc1 LWD_40
    s_sleep 2
    s_sub_u32 s80, s80, 1
    s_cmp_lg_u32 s80, 0
    s_cbranch_scc1 LW_39
LWD_40:
    v_mov_b32 v160, 0x24050
    ds_read_b64 v[162:163], v160
    s_waitcnt lgkmcnt(0)
    v_readfirstlane_b32 s94, v162
    v_readfirstlane_b32 s95, v163
    s_sleep 4
    s_mov_b32 s63, 4096
    buffer_load_dwordx4 v[72:75], v3, s[36:39], 0 offen offset:0 sc1
    buffer_load_dwordx4 v[76:79], v3, s[36:39], 0 offen offset:1024 sc1
    buffer_load_dwordx4 v[80:83], v3, s[36:39], 0 offen offset:2048 sc1
    buffer_load_dwordx4 v[84:87], v3, s[36:39], 0 offen offset:3072 sc1
    buffer_load_dwordx4 v[88:91], v3, s[36:39], s63 offen offset:0 sc1
    buffer_load_dwordx4 v[92:95], v3, s[36:39], s63 offen offset:1024 sc1
    buffer_load_dwordx4 v[96:99], v3, s[36:39], s63 offen offset:2048 sc1
    buffer_load_dwordx4 v[100:103], v3, s[36:39], s63 offen offset:3072 sc1
    v_mov_b32 v160, 0x24014
    s_mov_b32 s80, 1600000
LW_43:
    ds_read_b32 v161, v160
    s_waitcnt lgkmcnt(0)
    v_readfirstlane_b32 s79, v161
    s_cmp_ge_u32 s79, 4
    s_cbranch_scc1 LWD_44
    s_sleep 1
    s_sub_u32 s80, s80, 1
    s_cmp_lg_u32 s80, 0
    s_cbranch_scc1 LW_43
LWD_44:
    v_xor_b32 v160, 0x0, v4
    v_xor_b32 v161, 0x40, v4
    v_xor_b32 v162, 0x80, v4
    v_xor_b32 v163, 0xc0, v4
    ds_read_b128 v[8:11], v160 offset:0
    ds_read_b128 v[12:15], v161 offset:0
    ds_read_b128 v[16:19], v162 offset:0
    ds_read_b128 v[20:23], v163 offset:0
    ds_read_b128 v[24:27], v160 offset:1024
    ds_read_b128 v[28:31], v161 offset:1024
    ds_read_b128 v[32:35], v162 offset:1024
    ds_read_b128 v[36:39], v163 offset:1024
    ds_read_b128 v[40:43], v160 offset:2048
    ds_read_b128 v[44:47], v161 offset:2048
    ds_read_b128 v[48:51], v162 offset:2048
    ds_read_b128 v[52:55], v163 offset:2048
    ds_read_b128 v[56:59], v160 offset:3072
    ds_read_b128 v[60:63], v161 offset:3072
    ds_read_b128 v[64:67], v162 offset:3072
    ds_read_b128 v[68:71], v163 offset:3072
    s_mov_b32 s80, 200000
PS_41:
    s_waitcnt vmcnt(0)
    s_mov_b32 s78, 0
    v_cmp_ne_u64 vcc, s[94:95], v[74:75]
    s_cbranch_vccz PSS_45
    buffer_load_dwordx4 v[72:75], v3, s[36:39], 0 offen offset:0 sc1
    s_mov_b32 s78, 1
PSS_45:
    v_cmp_ne_u64 vcc, s[94:95], v[78:79]
    s_cbranch_vccz PSS_46
    buffer_load_dwordx4 v[76:79], v3, s[36:39], 0 offen offset:1024 sc1
    s_mov_b32 s78, 1
PSS_46:
    v_cmp_ne_u64 vcc, s[94:95], v[82:83]
    s_cbranch_vccz PSS_47
    buffer_load_dwordx4 v[80:83], v3, s[36:39], 0 offen offset:2048 sc1
    s_mov_b32 s78, 1
PSS_47:
    v_cmp_ne_u64 vcc, s[94:95], v[86:87]
    s_cbranch_vccz PSS_48
    buffer_load_dwordx4 v[84:87], v3, s[36:39], 0 offen offset:3072 sc1
    s_mov_b32 s78, 1
PSS_48:
    v_cmp_ne_u64 vcc, s[94:95], v[90:91]
    s_cbranch_vccz PSS_49
    buffer_load_dwordx4 v[88:91], v3, s[36:39], s63 offen offset:0 sc1
    s_mov_b32 s78, 1
PSS_49:
    v_cmp_ne_u64 vcc, s[94:95], v[94:95]
    s_cbranch_vccz PSS_50
    buffer_load_dwordx4 v[92:95], v3, s[36:39], s63 offen offset:1024 sc1
    s_mov_b32 s78, 1
PSS_50:
    v_cmp_ne_u64 vcc, s[94:95], v[98:99]
    s_cbranch_vccz PSS_51
    buffer_load_dwordx4 v[96:99], v3, s[36:39], s63 offen offset:2048 sc1
    s_mov_b32 s78, 1
PSS_51:
    v_cmp_ne_u64 vcc, s[94:95], v[102:103]
    s_cbranch_vccz PSS_52
    buffer_load_dwordx4 v[100:103], v3, s[36:39], s63 offen offset:3072 sc1
    s_mov_b32 s78, 1
PSS_52:
    s_cmp_eq_u32 s78, 0
    s_cbranch_scc1 PSD_42
    s_sub_u32 s80, s80, 1
    s_cmp_lg_u32 s80, 0
    s_cbranch_scc1 PS_41
    s_waitcnt vmcnt(0)
PSD_42:
    v_lshlrev_b32 v104, 16, v72
    v_and_b32 v105, 0xffff0000, v72
    v_lshlrev_b32 v106, 16, v73
    v_and_b32 v107, 0xffff0000, v73
    v_lshlrev_b32 v108, 16, v76
    v_and_b32 v109, 0xffff0000, v76
    v_lshlrev_b32 v110, 16, v77
    v_and_b32 v111, 0xffff0000, v77
    v_lshlrev_b32 v120, 16, v80
    v_and_b32 v121, 0xffff0000, v80
    v_lshlrev_b32 v122, 16, v81
    v_and_b32 v123, 0xffff0000, v81
    v_lshlrev_b32 v124, 16, v84
    v_and_b32 v125, 0xffff0000, v84
    v_lshlrev_b32 v126, 16, v85
    v_and_b32 v127, 0xffff0000, v85
    v_add_f32 v104, v104, v120
    v_add_f32 v105, v105, v121
    v_add_f32 v106, v106, v122
    v_add_f32 v107, v107, v123
    v_add_f32 v108, v108, v124
    v_add_f32 v109, v109, v125
    v_add_f32 v110, v110, v126
    v_add_f32 v111, v111, v127
    v_lshlrev_b32 v112, 16, v88
    v_and_b32 v113, 0xffff0000, v88
    v_lshlrev_b32 v114, 16, v89
    v_and_b32 v115, 0xffff0000, v89
    v_lshlrev_b32 v116, 16, v92
    v_and_b32 v117, 0xffff0000, v92
    v_lshlrev_b32 v118, 16, v93
    v_and_b32 v119, 0xffff0000, v93
    v_add_f32 v104, v104, v112
    v_add_f32 v105, v105, v113
    v_add_f32 v106, v106, v114
    v_add_f32 v107, v107, v115
    v_add_f32 v108, v108, v116
    v_add_f32 v109, v109, v117
    v_add_f32 v110, v110, v118
    v_add_f32 v111, v111, v119
    v_lshlrev_b32 v120, 16, v96
    v_and_b32 v121, 0xffff0000, v96
    v_lshlrev_b32 v122, 16, v97
    v_and_b32 v123, 0xffff0000, v97
    v_lshlrev_b32 v124, 16, v100
    v_and_b32 v125, 0xffff0000, v100
    v_lshlrev_b32 v126, 16, v101
    v_and_b32 v127, 0xffff0000, v101
    v_add_f32 v104, v104, v120
    v_add_f32 v105, v105, v121
    v_add_f32 v106, v106, v122
    v_add_f32 v107, v107, v123
    v_add_f32 v108, v108, v124
    v_add_f32 v109, v109, v125
    v_add_f32 v110, v110, v126
    v_add_f32 v111, v111, v127
    v_cvt_pk_bf16_f32 v136, v104, v105
    v_cvt_pk_bf16_f32 v137, v106, v107
    v_cvt_pk_bf16_f32 v138, v108, v109
    v_cvt_pk_bf16_f32 v139, v110, v111
    v_mov_b32_dpp v140, v136 quad_perm:[1,2,3,0] row_mask:0xf bank_mask:0xf
    v_mov_b32_dpp v141, v137 quad_perm:[1,2,3,0] row_mask:0xf bank_mask:0xf
    v_mov_b32_dpp v142, v138 quad_perm:[1,2,3,0] row_mask:0xf bank_mask:0xf
    v_mov_b32_dpp v143, v139 quad_perm:[1,2,3,0] row_mask:0xf bank_mask:0xf
    v_mov_b32_dpp v144, v136 quad_perm:[2,3,0,1] row_mask:0xf bank_mask:0xf
    v_mov_b32_dpp v145, v137 quad_perm:[2,3,0,1] row_mask:0xf bank_mask:0xf
    v_mov_b32_dpp v146, v138 quad_perm:[2,3,0,1] row_mask:0xf bank_mask:0xf
    v_mov_b32_dpp v147, v139 quad_perm:[2,3,0,1] row_mask:0xf bank_mask:0xf
    v_mov_b32_dpp v148, v136 quad_perm:[3,0,1,2] row_mask:0xf bank_mask:0xf
    v_mov_b32_dpp v149, v137 quad_perm:[3,0,1,2] row_mask:0xf bank_mask:0xf
    v_mov_b32_dpp v150, v138 quad_perm:[3,0,1,2] row_mask:0xf bank_mask:0xf
    v_mov_b32_dpp v151, v139 quad_perm:[3,0,1,2] row_mask:0xf bank_mask:0xf
    v_mov_b32 v74, s94
    v_mov_b32 v75, s95
    s_waitcnt lgkmcnt(0)
    v_mfma_f32_16x16x32_bf16 v[104:107], v[136:139], v[8:11], 0
    v_mfma_f32_16x16x32_bf16 v[108:111], v[136:139], v[28:31], 0
    v_mfma_f32_16x16x32_bf16 v[112:115], v[136:139], v[48:51], 0
    v_mfma_f32_16x16x32_bf16 v[116:119], v[136:139], v[68:71], 0
    v_mfma_f32_16x16x32_bf16 v[104:107], v[140:143], v[12:15], v[104:107]
    v_mfma_f32_16x16x32_bf16 v[108:111], v[140:143], v[32:35], v[108:111]
    v_mfma_f32_16x16x32_bf16 v[112:115], v[140:143], v[52:55], v[112:115]
    v_mfma_f32_16x16x32_bf16 v[116:119], v[140:143], v[56:59], v[116:119]
    v_mfma_f32_16x16x32_bf16 v[104:107], v[144:147], v[16:19], v[104:107]
    v_mfma_f32_16x16x32_bf16 v[108:111], v[144:147], v[36:39], v[108:111]
    v_mfma_f32_16x16x32_bf16 v[112:115], v[144:147], v[40:43], v[112:115]
    v_mfma_f32_16x16x32_bf16 v[116:119], v[144:147], v[60:63], v[116:119]
    v_mfma_f32_16x16x32_bf16 v[104:107], v[148:151], v[20:23], v[104:107]
    v_mfma_f32_16x16x32_bf16 v[108:111], v[148:151], v[24:27], v[108:111]
    v_mfma_f32_16x16x32_bf16 v[112:115], v[148:151], v[44:47], v[112:115]
    v_mfma_f32_16x16x32_bf16 v[116:119], v[148:151], v[64:67], v[116:119]
    s_nop 5
    v_cvt_pk_bf16_f32 v72, v104, v109
    s_nop 0
    v_cvt_pk_bf16_f32 v73, v114, v119
    buffer_store_dwordx4 v[72:75], v2, s[36:39], 0 offen sc1
    v_mov_b32 v160, 0x24048
    v_mov_b32 v161, 1
    s_waitcnt lgkmcnt(0)
    s_mov_b64 exec, 1
    ds_add_u32 v160, v161
    s_mov_b64 exec, -1
    s_setprio 0
    s_cmp_ge_u32 s5, 4
    s_cbranch_scc1 L_END
    s_branch L_U1
L_CSVC:
    s_cmp_lg_u32 s3, 11
    s_cbranch_scc1 Z_101
    v_lshlrev_b32 v2, 2, v1
    v_add_u32 v2, 0x24000, v2
    v_mov_b32 v3, 0
    ds_write_b32 v2, v3
Z_101:
    s_waitcnt lgkmcnt(0)
    s_mov_b32 s92, 0x05040100
    s_mov_b32 s93, 0x07060302
    s_mov_b32 s36, s34
    s_and_b32 s37, s35, 0xffff
    s_mov_b32 s38, 0x1000000
    s_mov_b32 s39, 0x20000
    s_mov_b32 s40, s32
    s_and_b32 s41, s33, 0xffff
    s_mov_b32 s42, 0x100
    s_mov_b32 s43, 0x20000
    s_setprio 3
    s_sub_u32 s60, s3, 8
    s_lshl_b32 s64, s4, 3
    s_add_u32 s64, s64, s5
    s_sub_u32 s64, s64, 8
    v_lshlrev_b32 v2, 4, v1
    s_barrier
    s_cmp_eq_u32 s3, 9
    s_cbranch_scc1 LT_CR
LR_CR:
    s_cmp_eq_u32 s3, 10
    s_cbranch_scc1 LT_CR2
LR_CR2:
    s_cmp_lg_u32 s60, 0
    s_cbranch_scc1 C8_102
    s_sleep 24
    v_mov_b32 v160, 0
    s_mov_b32 s80, 200000
NG_103:
    s_mov_b64 exec, 1
    buffer_load_dwordx2 v[162:163], v160, s[40:43], 0 offen sc1
    s_mov_b64 exec, -1
    s_waitcnt vmcnt(0)
    v_readfirstlane_b32 s94, v162
    v_readfirstlane_b32 s95, v163
    s_cmp_lg_u32 s95, 0
    s_cbranch_scc1 NGD_104
    s_sleep 4
    s_sub_u32 s80, s80, 1
    s_cmp_lg_u32 s80, 0
    s_cbranch_scc1 NG_103
NGD_104:
    v_mov_b32 v160, 0x24050
    v_mov_b32 v162, s94
    v_mov_b32 v163, s95
    ds_write_b64 v160, v[162:163]
    v_mov_b32 v160, 0x2404c
    v_mov_b32 v161, 1
    s_waitcnt lgkmcnt(0)
    s_mov_b64 exec, 1
    ds_add_u32 v160, v161
    s_mov_b64 exec, -1
C8_102:
    s_lshr_b32 s7, s64, 4
    s_lshl_b32 s7, s7, 16
    s_lshl_b32 s63, s60, 14
    s_add_u32 s7, s7, s63
    s_add_u32 s7, s7, 0x0
    v_lshl_add_u32 v4, v1, 4, s7
    s_and_b32 s7, s60, 1
    s_lshl_b32 s7, s7, 7
    v_lshlrev_b32 v3, 3, v1
    v_xor_b32 v3, s7, v3
    s_lshl_b32 s7, s60, 13
    s_add_u32 s7, s7, 0x18000
    v_add_u32 v3, s7, v3
    s_mov_b32 s44, s20
    s_and_b32 s45, s21, 0xffff
    s_mov_b32 s46, 0x1000000
    s_mov_b32 s47, 0x20000
    s_lshl_b32 s7, s64, 18
    s_lshl_b32 s65, s60, 10
    s_add_u32 s65, s65, s7
    s_add_u32 s65, s65, 196608
    s_lshl_b32 s7, s60, 6
    v_xor_b32 v12, s7, v2
    v_xor_b32 v13, 16, v12
    v_xor_b32 v14, 32, v12
    v_xor_b32 v15, 48, v12
    v_mov_b32 v160, 0x2404c
    s_mov_b32 s80, 1600000
LW_105:
    ds_read_b32 v161, v160
    s_waitcnt lgkmcnt(0)
    v_readfirstlane_b32 s79, v161
    s_cmp_ge_u32 s79, 1
    s_cbranch_scc1 LWD_106
    s_sleep 4
    s_sub_u32 s80, s80, 1
    s_cmp_lg_u32 s80, 0
    s_cbranch_scc1 LW_105
LWD_106:
    v_mov_b32 v160, 0x24050
    ds_read_b64 v[162:163], v160
    s_waitcnt lgkmcnt(0)
    v_readfirstlane_b32 s94, v162
    v_readfirstlane_b32 s95, v163
    v_mov_b32 v160, 0x24018
    s_mov_b32 s80, 1600000
LW_107:
    ds_read_b32 v161, v160
    s_waitcnt lgkmcnt(0)
    v_readfirstlane_b32 s79, v161
    s_cmp_ge_u32 s79, 8
    s_cbranch_scc1 LWD_108
    s_sleep 2
    s_sub_u32 s80, s80, 1
    s_cmp_lg_u32 s80, 0
    s_cbranch_scc1 LW_107
LWD_108:
    s_sleep 1
    s_mov_b32 s67, 4096
    s_mov_b32 s68, 8192
    s_mov_b32 s69, 12288
    buffer_load_dwordx4 v[96:99], v4, s[36:39], 0 offen offset:0 sc1
    buffer_load_dwordx4 v[100:103], v4, s[36:39], 0 offen offset:1024 sc1
    buffer_load_dwordx4 v[104:107], v4, s[36:39], 0 offen offset:2048 sc1
    buffer_load_dwordx4 v[108:111], v4, s[36:39], 0 offen offset:3072 sc1
    buffer_load_dwordx4 v[112:115], v4, s[36:39], s67 offen offset:0 sc1
    buffer_load_dwordx4 v[116:119], v4, s[36:39], s67 offen offset:1024 sc1
    buffer_load_dwordx4 v[120:123], v4, s[36:39], s67 offen offset:2048 sc1
    buffer_load_dwordx4 v[124:127], v4, s[36:39], s67 offen offset:3072 sc1
    buffer_load_dwordx4 v[128:131], v4, s[36:39], s68 offen offset:0 sc1
    buffer_load_dwordx4 v[132:135], v4, s[36:39], s68 offen offset:1024 sc1
    buffer_load_dwordx4 v[136:139], v4, s[36:39], s68 offen offset:2048 sc1
    buffer_load_dwordx4 v[140:143], v4, s[36:39], s68 offen offset:3072 sc1
    buffer_load_dwordx4 v[144:147], v4, s[36:39], s69 offen offset:0 sc1
    buffer_load_dwordx4 v[148:151], v4, s[36:39], s69 offen offset:1024 sc1
    buffer_load_dwordx4 v[152:155], v4, s[36:39], s69 offen offset:2048 sc1
    buffer_load_dwordx4 v[156:159], v4, s[36:39], s69 offen offset:3072 sc1
    s_mov_b32 s80, 200000
PS_109:
    s_waitcnt vmcnt(0)
    s_mov_b32 s78, 0
    v_cmp_ne_u64 vcc, s[94:95], v[98:99]
    s_cbranch_vccz PSS_111
    buffer_load_dwordx4 v[96:99], v4, s[36:39], 0 offen offset:0 sc1
    s_mov_b32 s78, 1
PSS_111:
    v_cmp_ne_u64 vcc, s[94:95], v[102:103]
    s_cbranch_vccz PSS_112
    buffer_load_dwordx4 v[100:103], v4, s[36:39], 0 offen offset:1024 sc1
    s_mov_b32 s78, 1
PSS_112:
    v_cmp_ne_u64 vcc, s[94:95], v[106:107]
    s_cbranch_vccz PSS_113
    buffer_load_dwordx4 v[104:107], v4, s[36:39], 0 offen offset:2048 sc1
    s_mov_b32 s78, 1
PSS_113:
    v_cmp_ne_u64 vcc, s[94:95], v[110:111]
    s_cbranch_vccz PSS_114
    buffer_load_dwordx4 v[108:111], v4, s[36:39], 0 offen offset:3072 sc1
    s_mov_b32 s78, 1
PSS_114:
    v_cmp_ne_u64 vcc, s[94:95], v[114:115]
    s_cbranch_vccz PSS_115
    buffer_load_dwordx4 v[112:115], v4, s[36:39], s67 offen offset:0 sc1
    s_mov_b32 s78, 1
PSS_115:
    v_cmp_ne_u64 vcc, s[94:95], v[118:119]
    s_cbranch_vccz PSS_116
    buffer_load_dwordx4 v[116:119], v4, s[36:39], s67 offen offset:1024 sc1
    s_mov_b32 s78, 1
PSS_116:
    v_cmp_ne_u64 vcc, s[94:95], v[122:123]
    s_cbranch_vccz PSS_117
    buffer_load_dwordx4 v[120:123], v4, s[36:39], s67 offen offset:2048 sc1
    s_mov_b32 s78, 1
PSS_117:
    v_cmp_ne_u64 vcc, s[94:95], v[126:127]
    s_cbranch_vccz PSS_118
    buffer_load_dwordx4 v[124:127], v4, s[36:39], s67 offen offset:3072 sc1
    s_mov_b32 s78, 1
PSS_118:
    v_cmp_ne_u64 vcc, s[94:95], v[130:131]
    s_cbranch_vccz PSS_119
    buffer_load_dwordx4 v[128:131], v4, s[36:39], s68 offen offset:0 sc1
    s_mov_b32 s78, 1
PSS_119:
    v_cmp_ne_u64 vcc, s[94:95], v[134:135]
    s_cbranch_vccz PSS_120
    buffer_load_dwordx4 v[132:135], v4, s[36:39], s68 offen offset:1024 sc1
    s_mov_b32 s78, 1
PSS_120:
    v_cmp_ne_u64 vcc, s[94:95], v[138:139]
    s_cbranch_vccz PSS_121
    buffer_load_dwordx4 v[136:139], v4, s[36:39], s68 offen offset:2048 sc1
    s_mov_b32 s78, 1
PSS_121:
    v_cmp_ne_u64 vcc, s[94:95], v[142:143]
    s_cbranch_vccz PSS_122
    buffer_load_dwordx4 v[140:143], v4, s[36:39], s68 offen offset:3072 sc1
    s_mov_b32 s78, 1
PSS_122:
    v_cmp_ne_u64 vcc, s[94:95], v[146:147]
    s_cbranch_vccz PSS_123
    buffer_load_dwordx4 v[144:147], v4, s[36:39], s69 offen offset:0 sc1
    s_mov_b32 s78, 1
PSS_123:
    v_cmp_ne_u64 vcc, s[94:95], v[150:151]
    s_cbranch_vccz PSS_124
    buffer_load_dwordx4 v[148:151], v4, s[36:39], s69 offen offset:1024 sc1
    s_mov_b32 s78, 1
PSS_124:
    v_cmp_ne_u64 vcc, s[94:95], v[154:155]
    s_cbranch_vccz PSS_125
    buffer_load_dwordx4 v[152:155], v4, s[36:39], s69 offen offset:2048 sc1
    s_mov_b32 s78, 1
PSS_125:
    v_cmp_ne_u64 vcc, s[94:95], v[158:159]
    s_cbranch_vccz PSS_126
    buffer_load_dwordx4 v[156:159], v4, s[36:39], s69 offen offset:3072 sc1
    s_mov_b32 s78, 1
PSS_126:
    s_cmp_eq_u32 s78, 0
    s_cbranch_scc1 PSD_110
    s_sub_u32 s80, s80, 1
    s_cmp_lg_u32 s80, 0
    s_cbranch_scc1 PS_109
    s_waitcnt vmcnt(0)
PSD_110:
    buffer_load_dwordx4 v[32:35], v12, s[44:47], s65 offen nt
    s_addk_i32 s65, 4096
    buffer_load_dwordx4 v[36:39], v13, s[44:47], s65 offen nt
    s_addk_i32 s65, 4096
    buffer_load_dwordx4 v[40:43], v14, s[44:47], s65 offen nt
    s_addk_i32 s65, 4096
    buffer_load_dwordx4 v[44:47], v15, s[44:47], s65 offen nt
    s_addk_i32 s65, 4096
    buffer_load_dwordx4 v[48:51], v12, s[44:47], s65 offen nt
    s_addk_i32 s65, 4096
    buffer_load_dwordx4 v[52:55], v13, s[44:47], s65 offen nt
    s_addk_i32 s65, 4096
    buffer_load_dwordx4 v[56:59], v14, s[44:47], s65 offen nt
    s_addk_i32 s65, 4096
    buffer_load_dwordx4 v[60:63], v15, s[44:47], s65 offen nt
    s_addk_i32 s65, 4096
    v_xor_b32 v6, 0x0, v3
    ds_write_b64 v6, v[96:97] offset:0
    ds_write_b64 v6, v[100:101] offset:512
    v_xor_b32 v7, 0x10, v3
    ds_write_b64 v7, v[104:105] offset:1024
    ds_write_b64 v7, v[108:109] offset:1536
    v_xor_b32 v6, 0x20, v3
    ds_write_b64 v6, v[112:113] offset:2048
    ds_write_b64 v6, v[116:117] offset:2560
    v_xor_b32 v7, 0x30, v3
    ds_write_b64 v7, v[120:121] offset:3072
    ds_write_b64 v7, v[124:125] offset:3584
    v_xor_b32 v6, 0x40, v3
    ds_write_b64 v6, v[128:129] offset:4096
    ds_write_b64 v6, v[132:133] offset:4608
    v_xor_b32 v7, 0x50, v3
    ds_write_b64 v7, v[136:137] offset:5120
    ds_write_b64 v7, v[140:141] offset:5632
    v_xor_b32 v6, 0x60, v3
    ds_write_b64 v6, v[144:145] offset:6144
    ds_write_b64 v6, v[148:149] offset:6656
    v_xor_b32 v7, 0x70, v3
    ds_write_b64 v7, v[152:153] offset:7168
    ds_write_b64 v7, v[156:157] offset:7680
L_CCUT:
    s_waitcnt lgkmcnt(0)
    s_barrier
    s_setprio 0
    s_barrier
    s_barrier
    buffer_load_dwordx4 v[64:67], v12, s[44:47], s65 offen nt
    s_addk_i32 s65, 4096
    buffer_load_dwordx4 v[68:71], v13, s[44:47], s65 offen nt
    s_addk_i32 s65, 4096
    buffer_load_dwordx4 v[72:75], v14, s[44:47], s65 offen nt
    s_addk_i32 s65, 4096
    buffer_load_dwordx4 v[76:79], v15, s[44:47], s65 offen nt
    s_addk_i32 s65, 4096
    buffer_load_dwordx4 v[80:83], v12, s[44:47], s65 offen nt
    s_addk_i32 s65, 4096
    buffer_load_dwordx4 v[84:87], v13, s[44:47], s65 offen nt
    s_addk_i32 s65, 4096
    buffer_load_dwordx4 v[88:91], v14, s[44:47], s65 offen nt
    s_addk_i32 s65, 4096
    buffer_load_dwordx4 v[92:95], v15, s[44:47], s65 offen nt
    s_addk_i32 s65, 4096
    s_barrier
    s_barrier
    s_barrier
    s_setprio 3
    s_lshl_b32 s7, s60, 10
    v_add_u32 v3, s7, v2
    s_waitcnt vmcnt(15)
    ds_write_b128 v3, v[32:35] offset:0
    s_waitcnt vmcnt(14)
    ds_write_b128 v3, v[36:39] offset:4096
    s_waitcnt vmcnt(13)
    ds_write_b128 v3, v[40:43] offset:8192
    s_waitcnt vmcnt(12)
    ds_write_b128 v3, v[44:47] offset:12288
    s_waitcnt vmcnt(11)
    ds_write_b128 v3, v[48:51] offset:16384
    s_waitcnt vmcnt(10)
    ds_write_b128 v3, v[52:55] offset:20480
    s_waitcnt vmcnt(9)
    ds_write_b128 v3, v[56:59] offset:24576
    s_waitcnt vmcnt(8)
    ds_write_b128 v3, v[60:63] offset:28672
    s_waitcnt vmcnt(7)
    ds_write_b128 v3, v[64:67] offset:32768
    s_waitcnt vmcnt(6)
    ds_write_b128 v3, v[68:71] offset:36864
    s_waitcnt vmcnt(5)
    ds_write_b128 v3, v[72:75] offset:40960
    s_waitcnt vmcnt(4)
    ds_write_b128 v3, v[76:79] offset:45056
    s_waitcnt vmcnt(3)
    ds_write_b128 v3, v[80:83] offset:49152
    s_waitcnt vmcnt(2)
    ds_write_b128 v3, v[84:87] offset:53248
    s_waitcnt vmcnt(1)
    ds_write_b128 v3, v[88:91] offset:57344
    s_waitcnt vmcnt(0)
    ds_write_b128 v3, v[92:95] offset:61440
    s_waitcnt lgkmcnt(0)
    s_endpgm
.p2align 12
LT_U1:
    s_branch LR_U1
L_U1:
    s_mov_b32 s48, s26
    s_and_b32 s49, s27, 0xffff
    s_mov_b32 s50, 0x400000
    s_mov_b32 s51, 0x20000
    v_lshrrev_b32 v162, 4, v1
    v_lshlrev_b32 v2, 16, v162
    v_and_b32 v160, 15, v1
    v_lshl_add_u32 v2, v160, 4, v2
    s_lshl_b32 s7, s6, 8
    v_add_u32 v2, s7, v2
    s_lshl_b32 s70, s3, 19
    s_waitcnt vmcnt(2)
    buffer_load_dwordx4 v[8:11], v2, s[48:51], s70 offen nt
    s_add_u32 s70, s70, 8192
    s_waitcnt vmcnt(2)
    buffer_load_dwordx4 v[12:15], v2, s[48:51], s70 offen nt
    s_add_u32 s70, s70, 8192
    s_waitcnt vmcnt(2)
    buffer_load_dwordx4 v[16:19], v2, s[48:51], s70 offen nt
    s_add_u32 s70, s70, 8192
    s_waitcnt vmcnt(2)
    buffer_load_dwordx4 v[20:23], v2, s[48:51], s70 offen nt
    s_add_u32 s70, s70, 8192
    s_waitcnt vmcnt(2)
    buffer_load_dwordx4 v[24:27], v2, s[48:51], s70 offen nt
    s_add_u32 s70, s70, 8192
    s_waitcnt vmcnt(2)
    buffer_load_dwordx4 v[28:31], v2, s[48:51], s70 offen nt
    s_add_u32 s70, s70, 8192
    s_waitcnt vmcnt(2)
    buffer_load_dwordx4 v[32:35], v2, s[48:51], s70 offen nt
    s_add_u32 s70, s70, 8192
    s_waitcnt vmcnt(2)
    buffer_load_dwordx4 v[36:39], v2, s[48:51], s70 offen nt
    s_add_u32 s70, s70, 204800
    s_waitcnt vmcnt(2)
    buffer_load_dwordx4 v[104:107], v2, s[48:51], s70 offen nt
    s_add_u32 s70, s70, 8192
    s_waitcnt vmcnt(2)
    buffer_load_dwordx4 v[108:111], v2, s[48:51], s70 offen nt
    s_add_u32 s70, s70, 8192
    s_waitcnt vmcnt(2)
    buffer_load_dwordx4 v[112:115], v2, s[48:51], s70 offen nt
    s_add_u32 s70, s70, 8192
    s_waitcnt vmcnt(2)
    buffer_load_dwordx4 v[116:119], v2, s[48:51], s70 offen nt
    s_add_u32 s70, s70, 8192
    s_waitcnt vmcnt(2)
    buffer_load_dwordx4 v[120:123], v2, s[48:51], s70 offen nt
    s_add_u32 s70, s70, 8192
    s_waitcnt vmcnt(2)
    buffer_load_dwordx4 v[124:127], v2, s[48:51], s70 offen nt
    s_add_u32 s70, s70, 8192
    s_waitcnt vmcnt(2)
    buffer_load_dwordx4 v[128:131], v2, s[48:51], s70 offen nt
    s_add_u32 s70, s70, 8192
    s_waitcnt vmcnt(2)
    buffer_load_dwordx4 v[132:135], v2, s[48:51], s70 offen nt
    s_add_u32 s70, s70, 204800
    v_lshlrev_b32 v3, 4, v1
    v_add_u32 v3, 0x24800, v3
    v_lshrrev_b32 v4, 1, v160
    v_lshlrev_b32 v4, 18, v4
    v_lshl_add_u32 v4, v162, 4, v4
    v_and_b32 v163, 1, v1
    v_lshl_add_u32 v4, v163, 6, v4
    v_cmp_eq_u32 s[86:87], 1, v163
    s_lshl_b32 s7, s3, 5
    s_add_u32 s7, s7, s6
    s_lshl_b32 s7, s7, 7
    s_add_u32 s7, s7, 0x500000
    v_add_u32 v4, s7, v4
    s_lshl_b32 s7, s3, 11
    s_add_u32 s7, s7, 0x10000
    v_lshl_add_u32 v5, v1, 5, s7
    v_perm_b32 v40, v12, v8, s92
    v_perm_b32 v41, v20, v16, s92
    v_perm_b32 v42, v28, v24, s92
    v_perm_b32 v43, v36, v32, s92
    v_perm_b32 v44, v12, v8, s93
    v_perm_b32 v45, v20, v16, s93
    v_perm_b32 v46, v28, v24, s93
    v_perm_b32 v47, v36, v32, s93
    v_perm_b32 v48, v13, v9, s92
    v_perm_b32 v49, v21, v17, s92
    v_perm_b32 v50, v29, v25, s92
    v_perm_b32 v51, v37, v33, s92
    v_perm_b32 v52, v13, v9, s93
    v_perm_b32 v53, v21, v17, s93
    v_perm_b32 v54, v29, v25, s93
    v_perm_b32 v55, v37, v33, s93
    v_perm_b32 v56, v14, v10, s92
    v_perm_b32 v57, v22, v18, s92
    v_perm_b32 v58, v30, v26, s92
    v_perm_b32 v59, v38, v34, s92
    v_perm_b32 v60, v14, v10, s93
    v_perm_b32 v61, v22, v18, s93
    v_perm_b32 v62, v30, v26, s93
    v_perm_b32 v63, v38, v34, s93
    v_perm_b32 v64, v15, v11, s92
    v_perm_b32 v65, v23, v19, s92
    v_perm_b32 v66, v31, v27, s92
    v_perm_b32 v67, v39, v35, s92
    v_perm_b32 v68, v15, v11, s93
    v_perm_b32 v69, v23, v19, s93
    v_perm_b32 v70, v31, v27, s93
    v_perm_b32 v71, v39, v35, s93
    s_waitcnt vmcnt(0)
    v_perm_b32 v72, v108, v104, s92
    v_perm_b32 v73, v116, v112, s92
    v_perm_b32 v74, v124, v120, s92
    v_perm_b32 v75, v132, v128, s92
    v_perm_b32 v76, v108, v104, s93
    v_perm_b32 v77, v116, v112, s93
    v_perm_b32 v78, v124, v120, s93
    v_perm_b32 v79, v132, v128, s93
    v_perm_b32 v80, v109, v105, s92
    v_perm_b32 v81, v117, v113, s92
    v_perm_b32 v82, v125, v121, s92
    v_perm_b32 v83, v133, v129, s92
    v_perm_b32 v84, v109, v105, s93
    v_perm_b32 v85, v117, v113, s93
    v_perm_b32 v86, v125, v121, s93
    v_perm_b32 v87, v133, v129, s93
    v_perm_b32 v88, v110, v106, s92
    v_perm_b32 v89, v118, v114, s92
    v_perm_b32 v90, v126, v122, s92
    v_perm_b32 v91, v134, v130, s92
    v_perm_b32 v92, v110, v106, s93
    v_perm_b32 v93, v118, v114, s93
    v_perm_b32 v94, v126, v122, s93
    v_perm_b32 v95, v134, v130, s93
    v_perm_b32 v96, v111, v107, s92
    v_perm_b32 v97, v119, v115, s92
    v_perm_b32 v98, v127, v123, s92
    v_perm_b32 v99, v135, v131, s92
    v_perm_b32 v100, v111, v107, s93
    v_perm_b32 v101, v119, v115, s93
    v_perm_b32 v102, v127, v123, s93
    v_perm_b32 v103, v135, v131, s93
    v_mov_b32 v160, 0x2404c
    s_mov_b32 s80, 1600000
LW_53:
    ds_read_b32 v161, v160
    s_waitcnt lgkmcnt(0)
    v_readfirstlane_b32 s79, v161
    s_cmp_ge_u32 s79, 1
    s_cbranch_scc1 LWD_54
    s_sleep 2
    s_sub_u32 s80, s80, 1
    s_cmp_lg_u32 s80, 0
    s_cbranch_scc1 LW_53
LWD_54:
    v_mov_b32 v160, 0x24050
    ds_read_b64 v[162:163], v160
    s_waitcnt lgkmcnt(0)
    v_readfirstlane_b32 s94, v162
    v_readfirstlane_b32 s95, v163
    v_mov_b32 v160, 0x2401c
    s_mov_b32 s80, 1600000
LW_55:
    ds_read_b32 v161, v160
    s_waitcnt lgkmcnt(0)
    v_readfirstlane_b32 s79, v161
    s_cmp_ge_u32 s79, 1
    s_cbranch_scc1 LWD_56
    s_sleep 4
    s_sub_u32 s80, s80, 1
    s_cmp_lg_u32 s80, 0
    s_cbranch_scc1 LW_55
LWD_56:
    s_setprio 3
    s_mov_b64 s[88:89], 0
    s_mov_b32 s80, 1600000
UM_57:
    ds_read_b128 v[136:139], v3
    s_waitcnt lgkmcnt(0)
    v_cmp_ne_u64 vcc, s[94:95], v[138:139]
    s_or_b64 s[90:91], vcc, s[88:89]
    s_and_b32 s7, s90, 0x5555
    s_cbranch_scc1 UMS_59
    s_mov_b32 s70, 0
    buffer_load_dwordx4 v[8:11], v4, s[36:39], s70 offen sc1
    s_or_b32 s88, s88, 0x5555
UMS_59:
    s_and_b32 s7, s90, 0x55550000
    s_cbranch_scc1 UMS_60
    s_mov_b32 s70, 32768
    buffer_load_dwordx4 v[12:15], v4, s[36:39], s70 offen sc1
    s_or_b32 s88, s88, 0x55550000
UMS_60:
    s_and_b32 s7, s91, 0x5555
    s_cbranch_scc1 UMS_61
    s_mov_b32 s70, 65536
    buffer_load_dwordx4 v[16:19], v4, s[36:39], s70 offen sc1
    s_or_b32 s89, s89, 0x5555
UMS_61:
    s_and_b32 s7, s91, 0x55550000
    s_cbranch_scc1 UMS_62
    s_mov_b32 s70, 98304
    buffer_load_dwordx4 v[20:23], v4, s[36:39], s70 offen sc1
    s_or_b32 s89, s89, 0x55550000
UMS_62:
    s_and_b32 s7, s90, 0xaaaa
    s_cbranch_scc1 UMS_63
    s_mov_b32 s70, 131072
    buffer_load_dwordx4 v[24:27], v4, s[36:39], s70 offen sc1
    s_or_b32 s88, s88, 0xaaaa
UMS_63:
    s_and_b32 s7, s90, 0xaaaa0000
    s_cbranch_scc1 UMS_64
    s_mov_b32 s70, 163840
    buffer_load_dwordx4 v[28:31], v4, s[36:39], s70 offen sc1
    s_or_b32 s88, s88, 0xaaaa0000
UMS_64:
    s_and_b32 s7, s91, 0xaaaa
    s_cbranch_scc1 UMS_65
    s_mov_b32 s70, 196608
    buffer_load_dwordx4 v[32:35], v4, s[36:39], s70 offen sc1
    s_or_b32 s89, s89, 0xaaaa
UMS_65:
    s_and_b32 s7, s91, 0xaaaa0000
    s_cbranch_scc1 UMS_66
    s_mov_b32 s70, 229376
    buffer_load_dwordx4 v[36:39], v4, s[36:39], s70 offen sc1
    s_or_b32 s89, s89, 0xaaaa0000
UMS_66:
    s_cbranch_vccz UMD_58
    s_sleep 1
    s_sub_u32 s80, s80, 1
    s_cmp_lg_u32 s80, 0
    s_cbranch_scc1 UM_57
UMD_58:
    v_max_f32_dpp v138, v136, v136 quad_perm:[1,0,3,2] row_mask:0xf bank_mask:0xf
    s_nop 1
    v_max_f32_dpp v138, v138, v138 quad_perm:[2,3,0,1] row_mask:0xf bank_mask:0xf
    v_mov_b32 v139, v138
    s_nop 1
    v_permlane32_swap_b32 v138, v139
    v_max_f32 v138, v138, v139
    v_mov_b32 v139, v138
    s_nop 1
    v_permlane16_swap_b32 v138, v139
    v_max_f32 v138, v138, v139
    v_sub_f32 v136, v136, v138
    v_exp_f32 v136, v136
    s_nop 0
    v_mul_f32 v137, v137, v136
    s_nop 1
    v_add_f32_dpp v137, v137, v137 quad_perm:[1,0,3,2] row_mask:0xf bank_mask:0xf
    s_nop 1
    v_add_f32_dpp v137, v137, v137 quad_perm:[2,3,0,1] row_mask:0xf bank_mask:0xf
    v_mov_b32 v138, v137
    s_nop 1
    v_permlane32_swap_b32 v137, v138
    v_add_f32 v137, v137, v138
    v_mov_b32 v138, v137
    s_nop 1
    v_permlane16_swap_b32 v137, v138
    v_add_f32 v137, v137, v138
    v_rcp_f32 v137, v137
    s_nop 0
    v_mul_f32 v136, v136, v137
    v_mov_b32 v137, v136
    s_nop 1
    v_permlane16_swap_b32 v136, v137
    v_mov_b32 v138, v136
    v_mov_b32 v139, v137
    s_nop 0
    v_permlane32_swap_b32 v136, v138
    v_permlane32_swap_b32 v137, v139
    s_nop 0
    v_mov_b32_dpp v148, v136 quad_perm:[0,0,2,2] row_mask:0xf bank_mask:0xf
    v_mov_b32_dpp v149, v137 quad_perm:[0,0,2,2] row_mask:0xf bank_mask:0xf
    v_mov_b32_dpp v150, v138 quad_perm:[0,0,2,2] row_mask:0xf bank_mask:0xf
    v_mov_b32_dpp v151, v139 quad_perm:[0,0,2,2] row_mask:0xf bank_mask:0xf
    v_mov_b32_dpp v152, v136 quad_perm:[1,1,3,3] row_mask:0xf bank_mask:0xf
    v_mov_b32_dpp v153, v137 quad_perm:[1,1,3,3] row_mask:0xf bank_mask:0xf
    v_mov_b32_dpp v154, v138 quad_perm:[1,1,3,3] row_mask:0xf bank_mask:0xf
    v_mov_b32_dpp v155, v139 quad_perm:[1,1,3,3] row_mask:0xf bank_mask:0xf
    s_waitcnt vmcnt(0)
    v_lshlrev_b32 v104, 16, v8
    v_and_b32 v105, 0xffff0000, v8
    v_lshlrev_b32 v106, 16, v9
    v_and_b32 v107, 0xffff0000, v9
    v_lshlrev_b32 v108, 16, v10
    v_and_b32 v109, 0xffff0000, v10
    v_lshlrev_b32 v110, 16, v11
    v_and_b32 v111, 0xffff0000, v11
    v_mul_f32 v120, v104, v148
    v_mul_f32 v121, v105, v148
    v_mul_f32 v122, v106, v148
    v_mul_f32 v123, v107, v148
    v_mul_f32 v124, v108, v148
    v_mul_f32 v125, v109, v148
    v_mul_f32 v126, v110, v148
    v_mul_f32 v127, v111, v148
    v_lshlrev_b32 v112, 16, v12
    v_and_b32 v113, 0xffff0000, v12
    v_lshlrev_b32 v114, 16, v13
    v_and_b32 v115, 0xffff0000, v13
    v_lshlrev_b32 v116, 16, v14
    v_and_b32 v117, 0xffff0000, v14
    v_lshlrev_b32 v118, 16, v15
    v_and_b32 v119, 0xffff0000, v15
    v_fmac_f32 v120, v112, v149
    v_fmac_f32 v121, v113, v149
    v_fmac_f32 v122, v114, v149
    v_fmac_f32 v123, v115, v149
    v_fmac_f32 v124, v116, v149
    v_fmac_f32 v125, v117, v149
    v_fmac_f32 v126, v118, v149
    v_fmac_f32 v127, v119, v149
    v_lshlrev_b32 v104, 16, v16
    v_and_b32 v105, 0xffff0000, v16
    v_lshlrev_b32 v106, 16, v17
    v_and_b32 v107, 0xffff0000, v17
    v_lshlrev_b32 v108, 16, v18
    v_and_b32 v109, 0xffff0000, v18
    v_lshlrev_b32 v110, 16, v19
    v_and_b32 v111, 0xffff0000, v19
    v_fmac_f32 v120, v104, v150
    v_fmac_f32 v121, v105, v150
    v_fmac_f32 v122, v106, v150
    v_fmac_f32 v123, v107, v150
    v_fmac_f32 v124, v108, v150
    v_fmac_f32 v125, v109, v150
    v_fmac_f32 v126, v110, v150
    v_fmac_f32 v127, v111, v150
    v_lshlrev_b32 v112, 16, v20
    v_and_b32 v113, 0xffff0000, v20
    v_lshlrev_b32 v114, 16, v21
    v_and_b32 v115, 0xffff0000, v21
    v_lshlrev_b32 v116, 16, v22
    v_and_b32 v117, 0xffff0000, v22
    v_lshlrev_b32 v118, 16, v23
    v_and_b32 v119, 0xffff0000, v23
    v_fmac_f32 v120, v112, v151
    v_fmac_f32 v121, v113, v151
    v_fmac_f32 v122, v114, v151
    v_fmac_f32 v123, v115, v151
    v_fmac_f32 v124, v116, v151
    v_fmac_f32 v125, v117, v151
    v_fmac_f32 v126, v118, v151
    v_fmac_f32 v127, v119, v151
    v_lshlrev_b32 v104, 16, v24
    v_and_b32 v105, 0xffff0000, v24
    v_lshlrev_b32 v106, 16, v25
    v_and_b32 v107, 0xffff0000, v25
    v_lshlrev_b32 v108, 16, v26
    v_and_b32 v109, 0xffff0000, v26
    v_lshlrev_b32 v110, 16, v27
    v_and_b32 v111, 0xffff0000, v27
    v_fmac_f32 v120, v104, v152
    v_fmac_f32 v121, v105, v152
    v_fmac_f32 v122, v106, v152
    v_fmac_f32 v123, v107, v152
    v_fmac_f32 v124, v108, v152
    v_fmac_f32 v125, v109, v152
    v_fmac_f32 v126, v110, v152
    v_fmac_f32 v127, v111, v152
    v_lshlrev_b32 v112, 16, v28
    v_and_b32 v113, 0xffff0000, v28
    v_lshlrev_b32 v114, 16, v29
    v_and_b32 v115, 0xffff0000, v29
    v_lshlrev_b32 v116, 16, v30
    v_and_b32 v117, 0xffff0000, v30
    v_lshlrev_b32 v118, 16, v31
    v_and_b32 v119, 0xffff0000, v31
    v_fmac_f32 v120, v112, v153
    v_fmac_f32 v121, v113, v153
    v_fmac_f32 v122, v114, v153
    v_fmac_f32 v123, v115, v153
    v_fmac_f32 v124, v116, v153
    v_fmac_f32 v125, v117, v153
    v_fmac_f32 v126, v118, v153
    v_fmac_f32 v127, v119, v153
    v_lshlrev_b32 v104, 16, v32
    v_and_b32 v105, 0xffff0000, v32
    v_lshlrev_b32 v106, 16, v33
    v_and_b32 v107, 0xffff0000, v33
    v_lshlrev_b32 v108, 16, v34
    v_and_b32 v109, 0xffff0000, v34
    v_lshlrev_b32 v110, 16, v35
    v_and_b32 v111, 0xffff0000, v35
    v_fmac_f32 v120, v104, v154
    v_fmac_f32 v121, v105, v154
    v_fmac_f32 v122, v106, v154
    v_fmac_f32 v123, v107, v154
    v_fmac_f32 v124, v108, v154
    v_fmac_f32 v125, v109, v154
    v_fmac_f32 v126, v110, v154
    v_fmac_f32 v127, v111, v154
    v_lshlrev_b32 v112, 16, v36
    v_and_b32 v113, 0xffff0000, v36
    v_lshlrev_b32 v114, 16, v37
    v_and_b32 v115, 0xffff0000, v37
    v_lshlrev_b32 v116, 16, v38
    v_and_b32 v117, 0xffff0000, v38
    v_lshlrev_b32 v118, 16, v39
    v_and_b32 v119, 0xffff0000, v39
    v_fmac_f32 v120, v112, v155
    v_fmac_f32 v121, v113, v155
    v_fmac_f32 v122, v114, v155
    v_fmac_f32 v123, v115, v155
    v_fmac_f32 v124, v116, v155
    v_fmac_f32 v125, v117, v155
    v_fmac_f32 v126, v118, v155
    v_fmac_f32 v127, v119, v155
    v_cvt_pk_bf16_f32 v128, v120, v121
    v_cvt_pk_bf16_f32 v129, v122, v123
    v_cvt_pk_bf16_f32 v130, v124, v125
    v_cvt_pk_bf16_f32 v131, v126, v127
    v_cndmask_b32 v140, v128, 0, s[86:87]
    v_cndmask_b32 v144, 0, v128, s[86:87]
    v_cndmask_b32 v141, v129, 0, s[86:87]
    v_cndmask_b32 v145, 0, v129, s[86:87]
    v_cndmask_b32 v142, v130, 0, s[86:87]
    v_cndmask_b32 v146, 0, v130, s[86:87]
    v_cndmask_b32 v143, v131, 0, s[86:87]
    v_cndmask_b32 v147, 0, v131, s[86:87]
    s_nop 0
    v_mfma_f32_16x16x32_bf16 v[8:11], v[140:143], v[40:43], 0
    v_mfma_f32_16x16x32_bf16 v[12:15], v[140:143], v[44:47], 0
    v_mfma_f32_16x16x32_bf16 v[16:19], v[140:143], v[48:51], 0
    v_mfma_f32_16x16x32_bf16 v[20:23], v[140:143], v[52:55], 0
    v_mfma_f32_16x16x32_bf16 v[24:27], v[140:143], v[56:59], 0
    v_mfma_f32_16x16x32_bf16 v[28:31], v[140:143], v[60:63], 0
    v_mfma_f32_16x16x32_bf16 v[32:35], v[140:143], v[64:67], 0
    v_mfma_f32_16x16x32_bf16 v[36:39], v[140:143], v[68:71], 0
    v_mfma_f32_16x16x32_bf16 v[8:11], v[144:147], v[72:75], v[8:11]
    v_mfma_f32_16x16x32_bf16 v[12:15], v[144:147], v[76:79], v[12:15]
    v_mfma_f32_16x16x32_bf16 v[16:19], v[144:147], v[80:83], v[16:19]
    v_mfma_f32_16x16x32_bf16 v[20:23], v[144:147], v[84:87], v[20:23]
    v_mfma_f32_16x16x32_bf16 v[24:27], v[144:147], v[88:91], v[24:27]
    v_mfma_f32_16x16x32_bf16 v[28:31], v[144:147], v[92:95], v[28:31]
    v_mfma_f32_16x16x32_bf16 v[32:35], v[144:147], v[96:99], v[32:35]
    v_mfma_f32_16x16x32_bf16 v[36:39], v[144:147], v[100:103], v[36:39]
    s_nop 0
    v_add_f32 v8, v8, v10
    v_add_f32 v9, v9, v11
    v_add_f32 v12, v12, v14
    v_add_f32 v13, v13, v15
    v_add_f32 v16, v16, v18
    v_add_f32 v17, v17, v19
    v_add_f32 v20, v20, v22
    v_add_f32 v21, v21, v23
    v_add_f32 v24, v24, v26
    v_add_f32 v25, v25, v27
    v_add_f32 v28, v28, v30
    v_add_f32 v29, v29, v31
    v_add_f32 v32, v32, v34
    v_add_f32 v33, v33, v35
    v_add_f32 v36, v36, v38
    v_add_f32 v37, v37, v39
    v_add_f32 v104, v8, v9
    v_add_f32 v105, v12, v13
    v_add_f32 v106, v16, v17
    v_add_f32 v107, v20, v21
    v_add_f32 v108, v24, v25
    v_add_f32 v109, v28, v29
    v_add_f32 v110, v32, v33
    v_add_f32 v111, v36, v37
    ds_write_b128 v5, v[104:107]
    ds_write_b128 v5, v[108:111] offset:16
    v_and_b32 v160, 31, v1
    s_lshl_b32 s7, s3, 8
    s_add_u32 s7, s7, 0x10000
    v_lshl_add_u32 v5, v160, 3, s7
    s_lshl_b32 s7, s3, 7
    s_add_u32 s7, s7, 0x24400
    v_lshl_add_u32 v4, v160, 2, s7
    s_waitcnt lgkmcnt(0)
    s_barrier
    ds_read_b64 v[8:9], v5 offset:0
    ds_read_b64 v[10:11], v5 offset:2048
    ds_read_b64 v[12:13], v5 offset:4096
    ds_read_b64 v[14:15], v5 offset:6144
    ds_read_b64 v[16:17], v5 offset:8192
    ds_read_b64 v[18:19], v5 offset:10240
    ds_read_b64 v[20:21], v5 offset:12288
    ds_read_b64 v[22:23], v5 offset:14336
    s_waitcnt lgkmcnt(0)
    v_add_f32 v8, v8, v16
    v_add_f32 v9, v9, v17
    v_add_f32 v10, v10, v18
    v_add_f32 v11, v11, v19
    v_add_f32 v12, v12, v20
    v_add_f32 v13, v13, v21
    v_add_f32 v14, v14, v22
    v_add_f32 v15, v15, v23
    v_add_f32 v8, v8, v12
    v_add_f32 v9, v9, v13
    v_add_f32 v10, v10, v14
    v_add_f32 v11, v11, v15
    v_add_f32 v8, v8, v10
    v_add_f32 v9, v9, v11
    v_cvt_pk_bf16_f32 v8, v8, v9
    ds_write_b32 v4, v8
    s_waitcnt lgkmcnt(0)
    s_barrier
    s_endpgm
.p2align 12
LT_W2R:
    s_branch LR_W2R
L_W2R:
    s_cmp_lt_u32 s5, 4
    s_cselect_b32 s72, s28, s16
    s_cselect_b32 s73, s29, s17
    s_mov_b32 s56, s72
    s_and_b32 s57, s73, 0xffff
    s_mov_b32 s58, 0x400000
    s_mov_b32 s59, 0x20000
    v_lshrrev_b32 v4, 4, v1
    v_lshlrev_b32 v2, 13, v4
    v_and_b32 v4, 15, v1
    v_lshl_add_u32 v2, v4, 4, v2
    s_lshl_b32 s7, s6, 17
    s_lshl_b32 s70, s62, 8
    s_add_u32 s7, s7, s70
    v_add_u32 v2, s7, v2
    v_lshrrev_b32 v3, 4, v1
    v_lshlrev_b32 v3, 16, v3
    v_bfe_u32 v4, v1, 3, 1
    v_lshl_add_u32 v3, v4, 13, v3
    v_and_b32 v4, 7, v1
    v_lshl_add_u32 v3, v4, 4, v3
    s_cmp_lt_u32 s5, 4
    s_cselect_b32 s7, 0x800, 0x0
    s_add_u32 s7, s7, s6
    s_lshl_b32 s7, s7, 7
    s_add_u32 s7, s7, 0x100000
    v_add_u32 v3, s7, v3
    s_lshl_b32 s7, s62, 14
    v_add_u32 v3, s7, v3
    s_waitcnt vmcnt(0)
    v_mov_b32 v4, 0x24014
    v_mov_b32 v5, 1
    s_waitcnt lgkmcnt(0)
    s_mov_b64 exec, 1
    ds_add_u32 v4, v5
    s_mov_b64 exec, -1
    s_mov_b32 s70, 0
    v_mov_b32 v4, 0x24048
    s_mov_b32 s80, 1600000
LW_71:
    ds_read_b32 v5, v4
    s_waitcnt lgkmcnt(0)
    v_readfirstlane_b32 s79, v5
    s_cmp_ge_u32 s79, 4
    s_cbranch_scc1 LWD_72
    s_sleep 4
    s_sub_u32 s80, s80, 1
    s_cmp_lg_u32 s80, 0
    s_cbranch_scc1 LW_71
LWD_72:
    s_cmp_lt_u32 s5, 4
    s_cbranch_scc1 S2U_69
    buffer_load_dwordx4 v[40:43], v2, s[56:59], s70 offen offset:0 nt
    buffer_load_dwordx4 v[44:47], v2, s[56:59], s70 offen offset:1024 nt
    s_waitcnt vmcnt(0)
    buffer_load_dwordx4 v[48:51], v2, s[56:59], s70 offen offset:2048 nt
    buffer_load_dwordx4 v[52:55], v2, s[56:59], s70 offen offset:3072 nt
    s_add_u32 s70, s70, 4096
    s_waitcnt vmcnt(0)
    buffer_load_dwordx4 v[56:59], v2, s[56:59], s70 offen offset:0 nt
    buffer_load_dwordx4 v[60:63], v2, s[56:59], s70 offen offset:1024 nt
    s_waitcnt vmcnt(0)
    buffer_load_dwordx4 v[64:67], v2, s[56:59], s70 offen offset:2048 nt
    buffer_load_dwordx4 v[68:71], v2, s[56:59], s70 offen offset:3072 nt
    s_add_u32 s70, s70, 28672
    s_waitcnt vmcnt(0)
    buffer_load_dwordx4 v[72:75], v2, s[56:59], s70 offen offset:0 nt
    buffer_load_dwordx4 v[76:79], v2, s[56:59], s70 offen offset:1024 nt
    s_waitcnt vmcnt(0)
    buffer_load_dwordx4 v[80:83], v2, s[56:59], s70 offen offset:2048 nt
    buffer_load_dwordx4 v[84:87], v2, s[56:59], s70 offen offset:3072 nt
    s_add_u32 s70, s70, 4096
    s_waitcnt vmcnt(0)
    buffer_load_dwordx4 v[88:91], v2, s[56:59], s70 offen offset:0 nt
    buffer_load_dwordx4 v[92:95], v2, s[56:59], s70 offen offset:1024 nt
    s_waitcnt vmcnt(0)
    buffer_load_dwordx4 v[96:99], v2, s[56:59], s70 offen offset:2048 nt
    buffer_load_dwordx4 v[100:103], v2, s[56:59], s70 offen offset:3072 nt
    s_add_u32 s70, s70, 28672
    s_waitcnt vmcnt(0)
    buffer_load_dwordx4 v[104:107], v2, s[56:59], s70 offen offset:0 nt
    buffer_load_dwordx4 v[108:111], v2, s[56:59], s70 offen offset:1024 nt
    buffer_load_dwordx4 v[112:115], v2, s[56:59], s70 offen offset:2048 nt
    buffer_load_dwordx4 v[116:119], v2, s[56:59], s70 offen offset:3072 nt
    s_add_u32 s70, s70, 4096
    s_waitcnt vmcnt(0)
    buffer_load_dwordx4 v[120:123], v2, s[56:59], s70 offen offset:0 nt
    buffer_load_dwordx4 v[124:127], v2, s[56:59], s70 offen offset:1024 nt
    buffer_load_dwordx4 v[128:131], v2, s[56:59], s70 offen offset:2048 nt
    buffer_load_dwordx4 v[132:135], v2, s[56:59], s70 offen offset:3072 nt
    s_add_u32 s70, s70, 28672
    s_waitcnt vmcnt(0)
    buffer_load_dwordx4 v[136:139], v2, s[56:59], s70 offen offset:0 nt
    buffer_load_dwordx4 v[140:143], v2, s[56:59], s70 offen offset:1024 nt
    buffer_load_dwordx4 v[144:147], v2, s[56:59], s70 offen offset:2048 nt
    buffer_load_dwordx4 v[148:151], v2, s[56:59], s70 offen offset:3072 nt
    s_add_u32 s70, s70, 4096
    s_waitcnt vmcnt(0)
    buffer_load_dwordx4 v[152:155], v2, s[56:59], s70 offen offset:0 nt
    buffer_load_dwordx4 v[156:159], v2, s[56:59], s70 offen offset:1024 nt
    buffer_load_dwordx4 v[160:163], v2, s[56:59], s70 offen offset:2048 nt
    buffer_load_dwordx4 v[164:167], v2, s[56:59], s70 offen offset:3072 nt
    s_add_u32 s70, s70, 28672
    s_waitcnt vmcnt(0)
    s_branch S2J_70
S2U_69:
    buffer_load_dwordx4 v[40:43], v2, s[56:59], s70 offen offset:0 nt
    buffer_load_dwordx4 v[44:47], v2, s[56:59], s70 offen offset:1024 nt
    buffer_load_dwordx4 v[48:51], v2, s[56:59], s70 offen offset:2048 nt
    buffer_load_dwordx4 v[52:55], v2, s[56:59], s70 offen offset:3072 nt
    s_add_u32 s70, s70, 4096
    s_waitcnt vmcnt(2)
    buffer_load_dwordx4 v[56:59], v2, s[56:59], s70 offen offset:0 nt
    buffer_load_dwordx4 v[60:63], v2, s[56:59], s70 offen offset:1024 nt
    buffer_load_dwordx4 v[64:67], v2, s[56:59], s70 offen offset:2048 nt
    buffer_load_dwordx4 v[68:71], v2, s[56:59], s70 offen offset:3072 nt
    s_add_u32 s70, s70, 28672
    s_waitcnt vmcnt(2)
    buffer_load_dwordx4 v[72:75], v2, s[56:59], s70 offen offset:0 nt
    buffer_load_dwordx4 v[76:79], v2, s[56:59], s70 offen offset:1024 nt
    buffer_load_dwordx4 v[80:83], v2, s[56:59], s70 offen offset:2048 nt
    buffer_load_dwordx4 v[84:87], v2, s[56:59], s70 offen offset:3072 nt
    s_add_u32 s70, s70, 4096
    s_waitcnt vmcnt(2)
    buffer_load_dwordx4 v[88:91], v2, s[56:59], s70 offen offset:0 nt
    buffer_load_dwordx4 v[92:95], v2, s[56:59], s70 offen offset:1024 nt
    buffer_load_dwordx4 v[96:99], v2, s[56:59], s70 offen offset:2048 nt
    buffer_load_dwordx4 v[100:103], v2, s[56:59], s70 offen offset:3072 nt
    s_add_u32 s70, s70, 28672
    s_waitcnt vmcnt(2)
    buffer_load_dwordx4 v[104:107], v2, s[56:59], s70 offen offset:0 nt
    buffer_load_dwordx4 v[108:111], v2, s[56:59], s70 offen offset:1024 nt
    buffer_load_dwordx4 v[112:115], v2, s[56:59], s70 offen offset:2048 nt
    buffer_load_dwordx4 v[116:119], v2, s[56:59], s70 offen offset:3072 nt
    s_add_u32 s70, s70, 4096
    s_waitcnt vmcnt(2)
    buffer_load_dwordx4 v[120:123], v2, s[56:59], s70 offen offset:0 nt
    buffer_load_dwordx4 v[124:127], v2, s[56:59], s70 offen offset:1024 nt
    buffer_load_dwordx4 v[128:131], v2, s[56:59], s70 offen offset:2048 nt
    buffer_load_dwordx4 v[132:135], v2, s[56:59], s70 offen offset:3072 nt
    s_add_u32 s70, s70, 28672
    s_waitcnt vmcnt(2)
    buffer_load_dwordx4 v[136:139], v2, s[56:59], s70 offen offset:0 nt
    buffer_load_dwordx4 v[140:143], v2, s[56:59], s70 offen offset:1024 nt
    buffer_load_dwordx4 v[144:147], v2, s[56:59], s70 offen offset:2048 nt
    buffer_load_dwordx4 v[148:151], v2, s[56:59], s70 offen offset:3072 nt
    s_add_u32 s70, s70, 4096
    s_waitcnt vmcnt(2)
    buffer_load_dwordx4 v[152:155], v2, s[56:59], s70 offen offset:0 nt
    buffer_load_dwordx4 v[156:159], v2, s[56:59], s70 offen offset:1024 nt
    buffer_load_dwordx4 v[160:163], v2, s[56:59], s70 offen offset:2048 nt
    buffer_load_dwordx4 v[164:167], v2, s[56:59], s70 offen offset:3072 nt
    s_add_u32 s70, s70, 28672
    s_waitcnt vmcnt(0)
S2J_70:
    v_perm_b32 v8, v44, v40, s92
    v_perm_b32 v9, v52, v48, s92
    v_perm_b32 v10, v60, v56, s92
    v_perm_b32 v11, v68, v64, s92
    v_perm_b32 v12, v44, v40, s93
    v_perm_b32 v13, v52, v48, s93
    v_perm_b32 v14, v60, v56, s93
    v_perm_b32 v15, v68, v64, s93
    v_perm_b32 v16, v45, v41, s92
    v_perm_b32 v17, v53, v49, s92
    v_perm_b32 v18, v61, v57, s92
    v_perm_b32 v19, v69, v65, s92
    v_perm_b32 v20, v45, v41, s93
    v_perm_b32 v21, v53, v49, s93
    v_perm_b32 v22, v61, v57, s93
    v_perm_b32 v23, v69, v65, s93
    v_perm_b32 v24, v46, v42, s92
    v_perm_b32 v25, v54, v50, s92
    v_perm_b32 v26, v62, v58, s92
    v_perm_b32 v27, v70, v66, s92
    v_perm_b32 v28, v46, v42, s93
    v_perm_b32 v29, v54, v50, s93
    v_perm_b32 v30, v62, v58, s93
    v_perm_b32 v31, v70, v66, s93
    v_perm_b32 v32, v47, v43, s92
    v_perm_b32 v33, v55, v51, s92
    v_perm_b32 v34, v63, v59, s92
    v_perm_b32 v35, v71, v67, s92
    v_perm_b32 v36, v47, v43, s93
    v_perm_b32 v37, v55, v51, s93
    v_perm_b32 v38, v63, v59, s93
    v_perm_b32 v39, v71, v67, s93
    v_perm_b32 v40, v76, v72, s92
    v_perm_b32 v41, v84, v80, s92
    v_perm_b32 v42, v92, v88, s92
    v_perm_b32 v43, v100, v96, s92
    v_perm_b32 v44, v76, v72, s93
    v_perm_b32 v45, v84, v80, s93
    v_perm_b32 v46, v92, v88, s93
    v_perm_b32 v47, v100, v96, s93
    v_perm_b32 v48, v77, v73, s92
    v_perm_b32 v49, v85, v81, s92
    v_perm_b32 v50, v93, v89, s92
    v_perm_b32 v51, v101, v97, s92
    v_perm_b32 v52, v77, v73, s93
    v_perm_b32 v53, v85, v81, s93
    v_perm_b32 v54, v93, v89, s93
    v_perm_b32 v55, v101, v97, s93
    v_perm_b32 v56, v78, v74, s92
    v_perm_b32 v57, v86, v82, s92
    v_perm_b32 v58, v94, v90, s92
    v_perm_b32 v59, v102, v98, s92
    v_perm_b32 v60, v78, v74, s93
    v_perm_b32 v61, v86, v82, s93
    v_perm_b32 v62, v94, v90, s93
    v_perm_b32 v63, v102, v98, s93
    v_perm_b32 v64, v79, v75, s92
    v_perm_b32 v65, v87, v83, s92
    v_perm_b32 v66, v95, v91, s92
    v_perm_b32 v67, v103, v99, s92
    v_perm_b32 v68, v79, v75, s93
    v_perm_b32 v69, v87, v83, s93
    v_perm_b32 v70, v95, v91, s93
    v_perm_b32 v71, v103, v99, s93
    v_perm_b32 v72, v108, v104, s92
    v_perm_b32 v73, v116, v112, s92
    v_perm_b32 v74, v124, v120, s92
    v_perm_b32 v75, v132, v128, s92
    v_perm_b32 v76, v108, v104, s93
    v_perm_b32 v77, v116, v112, s93
    v_perm_b32 v78, v124, v120, s93
    v_perm_b32 v79, v132, v128, s93
    v_perm_b32 v80, v109, v105, s92
    v_perm_b32 v81, v117, v113, s92
    v_perm_b32 v82, v125, v121, s92
    v_perm_b32 v83, v133, v129, s92
    v_perm_b32 v84, v109, v105, s93
    v_perm_b32 v85, v117, v113, s93
    v_perm_b32 v86, v125, v121, s93
    v_perm_b32 v87, v133, v129, s93
    v_perm_b32 v88, v110, v106, s92
    v_perm_b32 v89, v118, v114, s92
    v_perm_b32 v90, v126, v122, s92
    v_perm_b32 v91, v134, v130, s92
    v_perm_b32 v92, v110, v106, s93
    v_perm_b32 v93, v118, v114, s93
    v_perm_b32 v94, v126, v122, s93
    v_perm_b32 v95, v134, v130, s93
    v_perm_b32 v96, v111, v107, s92
    v_perm_b32 v97, v119, v115, s92
    v_perm_b32 v98, v127, v123, s92
    v_perm_b32 v99, v135, v131, s92
    v_perm_b32 v100, v111, v107, s93
    v_perm_b32 v101, v119, v115, s93
    v_perm_b32 v102, v127, v123, s93
    v_perm_b32 v103, v135, v131, s93
    v_perm_b32 v104, v140, v136, s92
    v_perm_b32 v105, v148, v144, s92
    v_perm_b32 v106, v156, v152, s92
    v_perm_b32 v107, v164, v160, s92
    v_perm_b32 v108, v140, v136, s93
    v_perm_b32 v109, v148, v144, s93
    v_perm_b32 v110, v156, v152, s93
    v_perm_b32 v111, v164, v160, s93
    v_perm_b32 v112, v141, v137, s92
    v_perm_b32 v113, v149, v145, s92
    v_perm_b32 v114, v157, v153, s92
    v_perm_b32 v115, v165, v161, s92
    v_perm_b32 v116, v141, v137, s93
    v_perm_b32 v117, v149, v145, s93
    v_perm_b32 v118, v157, v153, s93
    v_perm_b32 v119, v165, v161, s93
    v_perm_b32 v120, v142, v138, s92
    v_perm_b32 v121, v150, v146, s92
    v_perm_b32 v122, v158, v154, s92
    v_perm_b32 v123, v166, v162, s92
    v_perm_b32 v124, v142, v138, s93
    v_perm_b32 v125, v150, v146, s93
    v_perm_b32 v126, v158, v154, s93
    v_perm_b32 v127, v166, v162, s93
    v_perm_b32 v128, v143, v139, s92
    v_perm_b32 v129, v151, v147, s92
    v_perm_b32 v130, v159, v155, s92
    v_perm_b32 v131, v167, v163, s92
    v_perm_b32 v132, v143, v139, s93
    v_perm_b32 v133, v151, v147, s93
    v_perm_b32 v134, v159, v155, s93
    v_perm_b32 v135, v167, v163, s93
    v_mov_b32 v160, 0x2404c
    s_mov_b32 s80, 1600000
LW_73:
    ds_read_b32 v161, v160
    s_waitcnt lgkmcnt(0)
    v_readfirstlane_b32 s79, v161
    s_cmp_ge_u32 s79, 1
    s_cbranch_scc1 LWD_74
    s_sleep 2
    s_sub_u32 s80, s80, 1
    s_cmp_lg_u32 s80, 0
    s_cbranch_scc1 LW_73
LWD_74:
    v_mov_b32 v160, 0x24050
    ds_read_b64 v[162:163], v160
    s_waitcnt lgkmcnt(0)
    v_readfirstlane_b32 s94, v162
    v_readfirstlane_b32 s95, v163
    v_bfe_u32 v4, v1, 2, 2
    v_lshlrev_b32 v4, 8, v4
    v_lshrrev_b32 v160, 4, v1
    v_lshl_add_u32 v4, v160, 4, v4
    s_mov_b32 s70, 4096
    s_cmp_ge_u32 s5, 4
    s_cbranch_scc1 S2X_75
    v_add_u32 v4, 0x24400, v4
    s_cmp_lg_u32 s3, 8
    s_cbranch_scc1 U8_77
    v_and_b32 v5, 15, v1
    v_lshl_add_u32 v5, v5, 2, v160
    s_lshl_b32 s7, s6, 4
    s_add_u32 s7, s7, 0xe0000
    v_lshl_add_u32 v5, v5, 9, s7
    v_lshlrev_b32 v6, 4, v1
    v_add_u32 v6, 0x24800, v6
    s_mov_b32 s80, 200000
PO_78:
    buffer_load_dwordx4 v[136:139], v5, s[36:39], 0 offen sc1
PO2_79:
    s_waitcnt vmcnt(0)
    v_cmp_ne_u64 vcc, s[94:95], v[138:139]
    s_cmp_lg_u64 vcc, -1
    s_cbranch_scc1 POD_80
    s_sleep 16
    s_sub_u32 s80, s80, 1
    s_cmp_lg_u32 s80, 0
    s_cbranch_scc1 PO_78
POD_80:
    s_setprio 3
    ds_write_b128 v6, v[136:139]
    v_mov_b32 v160, 0x2401c
    v_mov_b32 v161, 1
    s_waitcnt lgkmcnt(0)
    s_mov_b64 exec, 1
    ds_add_u32 v160, v161
    s_mov_b64 exec, -1
    s_cbranch_vccz U8D_82
    buffer_load_dwordx4 v[136:139], v5, s[36:39], 0 offen sc1
    s_sleep 4
    buffer_load_dwordx4 v[140:143], v5, s[36:39], 0 offen sc1
    s_sleep 4
    s_mov_b32 s80, 200000
U8P_81:
    s_waitcnt vmcnt(1)
    ds_write_b128 v6, v[136:139]
    v_cmp_ne_u64 vcc, s[94:95], v[138:139]
    s_cbranch_vccz U8D_82
    s_waitcnt lgkmcnt(0)
    buffer_load_dwordx4 v[136:139], v5, s[36:39], 0 offen sc1
    s_waitcnt vmcnt(1)
    ds_write_b128 v6, v[140:143]
    v_cmp_ne_u64 vcc, s[94:95], v[142:143]
    s_cbranch_vccz U8D_82
    s_waitcnt lgkmcnt(0)
    buffer_load_dwordx4 v[140:143], v5, s[36:39], 0 offen sc1
    s_sub_u32 s80, s80, 1
    s_cmp_lg_u32 s80, 0
    s_cbranch_scc1 U8P_81
U8D_82:
    s_waitcnt vmcnt(0)
U8_77:
    s_setprio 3
    s_barrier
    s_barrier
    ds_read_b128 v[136:139], v4 offset:0
    ds_read_b128 v[140:143], v4 offset:64
    ds_read_b128 v[144:147], v4 offset:128
    ds_read_b128 v[148:151], v4 offset:192
    s_waitcnt lgkmcnt(0)
    s_branch S2M_76
S2X_75:
    v_and_b32 v160, 3, v1
    v_lshl_add_u32 v4, v160, 6, v4
    s_lshl_b32 s7, s6, 11
    s_add_u32 s7, s7, 0xd0000
    v_add_u32 v4, s7, v4
    s_mov_b32 s80, 200000
PO_83:
    buffer_load_dwordx4 v[152:155], v4, s[36:39], 0 offen offset:0 sc1
PO2_84:
    s_waitcnt vmcnt(0)
    v_cmp_ne_u64 vcc, s[94:95], v[154:155]
    s_cmp_lg_u64 vcc, -1
    s_cbranch_scc1 POD_85
    s_sleep 2
    s_sub_u32 s80, s80, 1
    s_cmp_lg_u32 s80, 0
    s_cbranch_scc1 PO_83
POD_85:
    s_setprio 3
    buffer_load_dwordx4 v[152:155], v4, s[36:39], 0 offen offset:0 sc1
    buffer_load_dwordx4 v[156:159], v4, s[36:39], 0 offen offset:1024 sc1
    s_sleep 4
    buffer_load_dwordx4 v[160:163], v4, s[36:39], 0 offen offset:0 sc1
    buffer_load_dwordx4 v[164:167], v4, s[36:39], 0 offen offset:1024 sc1
    s_sleep 4
    s_mov_b32 s80, 200000
PP_86:
    s_waitcnt vmcnt(2)
    v_cmp_ne_u64 vcc, s[94:95], v[154:155]
    v_cmp_ne_u64 s[84:85], s[94:95], v[158:159]
    s_or_b64 vcc, vcc, s[84:85]
    s_cmp_eq_u64 vcc, 0
    s_cbranch_scc1 PPO_88
    buffer_load_dwordx4 v[152:155], v4, s[36:39], 0 offen offset:0 sc1
    buffer_load_dwordx4 v[156:159], v4, s[36:39], 0 offen offset:1024 sc1
    s_waitcnt vmcnt(2)
    v_cmp_ne_u64 vcc, s[94:95], v[162:163]
    v_cmp_ne_u64 s[84:85], s[94:95], v[166:167]
    s_or_b64 vcc, vcc, s[84:85]
    s_cmp_eq_u64 vcc, 0
    s_cbranch_scc1 PPO_89
    buffer_load_dwordx4 v[160:163], v4, s[36:39], 0 offen offset:0 sc1
    buffer_load_dwordx4 v[164:167], v4, s[36:39], 0 offen offset:1024 sc1
    s_sub_u32 s80, s80, 1
    s_cmp_lg_u32 s80, 0
    s_cbranch_scc1 PP_86
PPO_88:
    v_mov_b32_dpp v136, v152 quad_perm:[0,0,0,0] row_mask:0xf bank_mask:0xf
    v_mov_b32_dpp v137, v153 quad_perm:[0,0,0,0] row_mask:0xf bank_mask:0xf
    v_mov_b32_dpp v138, v156 quad_perm:[0,0,0,0] row_mask:0xf bank_mask:0xf
    v_mov_b32_dpp v139, v157 quad_perm:[0,0,0,0] row_mask:0xf bank_mask:0xf
    v_mov_b32_dpp v140, v152 quad_perm:[1,1,1,1] row_mask:0xf bank_mask:0xf
    v_mov_b32_dpp v141, v153 quad_perm:[1,1,1,1] row_mask:0xf bank_mask:0xf
    v_mov_b32_dpp v142, v156 quad_perm:[1,1,1,1] row_mask:0xf bank_mask:0xf
    v_mov_b32_dpp v143, v157 quad_perm:[1,1,1,1] row_mask:0xf bank_mask:0xf
    v_mov_b32_dpp v144, v152 quad_perm:[2,2,2,2] row_mask:0xf bank_mask:0xf
    v_mov_b32_dpp v145, v153 quad_perm:[2,2,2,2] row_mask:0xf bank_mask:0xf
    v_mov_b32_dpp v146, v156 quad_perm:[2,2,2,2] row_mask:0xf bank_mask:0xf
    v_mov_b32_dpp v147, v157 quad_perm:[2,2,2,2] row_mask:0xf bank_mask:0xf
    v_mov_b32_dpp v148, v152 quad_perm:[3,3,3,3] row_mask:0xf bank_mask:0xf
    v_mov_b32_dpp v149, v153 quad_perm:[3,3,3,3] row_mask:0xf bank_mask:0xf
    v_mov_b32_dpp v150, v156 quad_perm:[3,3,3,3] row_mask:0xf bank_mask:0xf
    v_mov_b32_dpp v151, v157 quad_perm:[3,3,3,3] row_mask:0xf bank_mask:0xf
    s_branch PPD_87
PPO_89:
    v_mov_b32_dpp v136, v160 quad_perm:[0,0,0,0] row_mask:0xf bank_mask:0xf
    v_mov_b32_dpp v137, v161 quad_perm:[0,0,0,0] row_mask:0xf bank_mask:0xf
    v_mov_b32_dpp v138, v164 quad_perm:[0,0,0,0] row_mask:0xf bank_mask:0xf
    v_mov_b32_dpp v139, v165 quad_perm:[0,0,0,0] row_mask:0xf bank_mask:0xf
    v_mov_b32_dpp v140, v160 quad_perm:[1,1,1,1] row_mask:0xf bank_mask:0xf
    v_mov_b32_dpp v141, v161 quad_perm:[1,1,1,1] row_mask:0xf bank_mask:0xf
    v_mov_b32_dpp v142, v164 quad_perm:[1,1,1,1] row_mask:0xf bank_mask:0xf
    v_mov_b32_dpp v143, v165 quad_perm:[1,1,1,1] row_mask:0xf bank_mask:0xf
    v_mov_b32_dpp v144, v160 quad_perm:[2,2,2,2] row_mask:0xf bank_mask:0xf
    v_mov_b32_dpp v145, v161 quad_perm:[2,2,2,2] row_mask:0xf bank_mask:0xf
    v_mov_b32_dpp v146, v164 quad_perm:[2,2,2,2] row_mask:0xf bank_mask:0xf
    v_mov_b32_dpp v147, v165 quad_perm:[2,2,2,2] row_mask:0xf bank_mask:0xf
    v_mov_b32_dpp v148, v160 quad_perm:[3,3,3,3] row_mask:0xf bank_mask:0xf
    v_mov_b32_dpp v149, v161 quad_perm:[3,3,3,3] row_mask:0xf bank_mask:0xf
    v_mov_b32_dpp v150, v164 quad_perm:[3,3,3,3] row_mask:0xf bank_mask:0xf
    v_mov_b32_dpp v151, v165 quad_perm:[3,3,3,3] row_mask:0xf bank_mask:0xf
PPD_87:
S2M_76:
    s_nop 1
    v_mfma_f32_16x16x32_bf16 v[4:7], v[136:139], v[8:11], 0
    v_mfma_f32_16x16x32_bf16 v[4:7], v[140:143], v[40:43], v[4:7]
    v_mfma_f32_16x16x32_bf16 v[4:7], v[144:147], v[72:75], v[4:7]
    v_mfma_f32_16x16x32_bf16 v[4:7], v[148:151], v[104:107], v[4:7]
    v_mfma_f32_16x16x32_bf16 v[8:11], v[136:139], v[12:15], 0
    v_mfma_f32_16x16x32_bf16 v[8:11], v[140:143], v[44:47], v[8:11]
    v_mfma_f32_16x16x32_bf16 v[8:11], v[144:147], v[76:79], v[8:11]
    v_mfma_f32_16x16x32_bf16 v[8:11], v[148:151], v[108:111], v[8:11]
    v_mfma_f32_16x16x32_bf16 v[12:15], v[136:139], v[16:19], 0
    v_mfma_f32_16x16x32_bf16 v[12:15], v[140:143], v[48:51], v[12:15]
    v_mfma_f32_16x16x32_bf16 v[12:15], v[144:147], v[80:83], v[12:15]
    v_mfma_f32_16x16x32_bf16 v[12:15], v[148:151], v[112:115], v[12:15]
    v_mfma_f32_16x16x32_bf16 v[16:19], v[136:139], v[20:23], 0
    v_mfma_f32_16x16x32_bf16 v[16:19], v[140:143], v[52:55], v[16:19]
    v_mfma_f32_16x16x32_bf16 v[16:19], v[144:147], v[84:87], v[16:19]
    v_mfma_f32_16x16x32_bf16 v[16:19], v[148:151], v[116:119], v[16:19]
    v_mfma_f32_16x16x32_bf16 v[20:23], v[136:139], v[24:27], 0
    v_mfma_f32_16x16x32_bf16 v[20:23], v[140:143], v[56:59], v[20:23]
    v_mfma_f32_16x16x32_bf16 v[20:23], v[144:147], v[88:91], v[20:23]
    v_mfma_f32_16x16x32_bf16 v[20:23], v[148:151], v[120:123], v[20:23]
    v_mfma_f32_16x16x32_bf16 v[24:27], v[136:139], v[28:31], 0
    v_mfma_f32_16x16x32_bf16 v[24:27], v[140:143], v[60:63], v[24:27]
    v_mfma_f32_16x16x32_bf16 v[24:27], v[144:147], v[92:95], v[24:27]
    v_mfma_f32_16x16x32_bf16 v[24:27], v[148:151], v[124:127], v[24:27]
    v_mfma_f32_16x16x32_bf16 v[28:31], v[136:139], v[32:35], 0
    v_mfma_f32_16x16x32_bf16 v[28:31], v[140:143], v[64:67], v[28:31]
    v_mfma_f32_16x16x32_bf16 v[28:31], v[144:147], v[96:99], v[28:31]
    v_mfma_f32_16x16x32_bf16 v[28:31], v[148:151], v[128:131], v[28:31]
    v_mfma_f32_16x16x32_bf16 v[32:35], v[136:139], v[36:39], 0
    v_mfma_f32_16x16x32_bf16 v[32:35], v[140:143], v[68:71], v[32:35]
    v_mfma_f32_16x16x32_bf16 v[32:35], v[144:147], v[100:103], v[32:35]
    v_mfma_f32_16x16x32_bf16 v[32:35], v[148:151], v[132:135], v[32:35]
    v_mov_b32 v42, s94
    v_mov_b32 v43, s95
    v_cvt_pk_bf16_f32 v40, v4, v8
    v_cvt_pk_bf16_f32 v41, v12, v16
    buffer_store_dwordx4 v[40:43], v3, s[36:39], 0 offen sc1
    v_mov_b32 v46, s94
    v_mov_b32 v47, s95
    v_cvt_pk_bf16_f32 v44, v20, v24
    v_cvt_pk_bf16_f32 v45, v28, v32
    buffer_store_dwordx4 v[44:47], v3, s[36:39], s70 offen sc1
    s_endpgm
.p2align 12
LT_CR:
    s_branch LR_CR
L_CR:
    v_and_b32 v160, 15, v1
    v_lshlrev_b32 v4, 10, v160
    v_lshrrev_b32 v161, 4, v1
    v_lshl_add_u32 v4, v161, 8, v4
    v_lshl_add_u32 v3, v160, 4, v4
    s_lshl_b32 s7, s65, 14
    s_add_u32 s7, s7, 0x18000
    v_add_u32 v3, s7, v3
    v_and_b32 v162, 3, v1
    v_lshl_add_u32 v4, v162, 6, v4
    v_bfe_u32 v162, v1, 2, 2
    v_lshl_add_u32 v4, v162, 4, v4
    s_lshl_b32 s7, s64, 14
    v_add_u32 v4, s7, v4
    v_add_u32 v2, 0x10000, v4
    s_lshl_b32 s7, s65, 6
    s_add_u32 s7, s7, 0x27200
    v_lshl_add_u32 v5, v160, 2, s7
    s_lshl_b32 s7, s64, 10
    s_lshl_b32 s66, s65, 9
    s_add_u32 s7, s7, s66
    s_add_u32 s7, s7, 0x25200
    v_lshl_add_u32 v6, v160, 5, s7
    v_lshl_add_u32 v6, v161, 3, v6
    v_and_b32 v162, 31, v1
    v_lshlrev_b32 v7, 5, v162
    v_lshrrev_b32 v163, 5, v1
    v_lshl_add_u32 v7, v163, 4, v7
    v_add_u32 v7, 0x25200, v7
    v_lshlrev_b32 v8, 2, v162
    v_add_u32 v8, 0x27e00, v8
    v_bfe_u32 v162, v1, 2, 2
    v_lshl_add_u32 v164, v163, 3, v162
    v_lshlrev_b32 v164, 10, v164
    v_and_b32 v165, 1, v1
    v_lshl_add_u32 v164, v165, 3, v164
    s_lshl_b32 s7, s64, 8
    v_add_u32 v164, s7, v164
    v_bfe_u32 v165, v1, 4, 1
    v_lshlrev_b32 v165, 1, v165
    v_bfe_u32 v160, v1, 1, 1
    v_or_b32 v165, v165, v160
    s_lshl_b32 s7, s65, 3
    v_or_b32 v165, s7, v165
    v_lshlrev_b32 v162, 2, v162
    v_xor_b32 v165, v165, v162
    v_lshlrev_b32 v163, 1, v163
    v_xor_b32 v165, v165, v163
    v_xor_b32 v160, 0, v165
    v_lshl_add_u32 v9, v160, 4, v164
    v_xor_b32 v160, 4, v165
    v_lshl_add_u32 v10, v160, 4, v164
    v_xor_b32 v160, 1, v165
    v_lshl_add_u32 v11, v160, 4, v164
    v_add_u32 v11, 0x1000, v11
    v_xor_b32 v160, 5, v165
    v_lshl_add_u32 v12, v160, 4, v164
    v_add_u32 v12, 0x1000, v12
    v_mov_b32 v13, 0xff800000
    v_mov_b32 v14, 0
    v_cmp_gt_u32 s[86:87], 16, v1
    s_cmp_eq_u32 s64, 0
    s_cselect_b32 s88, 0xffff, 0
    s_mov_b32 s89, 0
    s_barrier
    v_xor_b32 v160, 0x0, v3
    ds_read_b128 v[32:35], v160
    v_xor_b32 v161, 0x10, v3
    ds_read_b128 v[36:39], v161
    v_xor_b32 v160, 0x20, v3
    ds_read_b128 v[40:43], v160
    v_xor_b32 v161, 0x30, v3
    ds_read_b128 v[44:47], v161
    v_xor_b32 v160, 0x40, v3
    ds_read_b128 v[48:51], v160
    v_xor_b32 v161, 0x50, v3
    ds_read_b128 v[52:55], v161
    v_xor_b32 v160, 0x60, v3
    ds_read_b128 v[56:59], v160
    v_xor_b32 v161, 0x70, v3
    ds_read_b128 v[60:63], v161
    v_xor_b32 v160, 0x80, v3
    ds_read_b128 v[64:67], v160
    v_xor_b32 v161, 0x90, v3
    ds_read_b128 v[68:71], v161
    v_xor_b32 v160, 0xa0, v3
    ds_read_b128 v[72:75], v160
    v_xor_b32 v161, 0xb0, v3
    ds_read_b128 v[76:79], v161
    v_xor_b32 v160, 0xc0, v3
    ds_read_b128 v[80:83], v160
    v_xor_b32 v161, 0xd0, v3
    ds_read_b128 v[84:87], v161
    v_xor_b32 v160, 0xe0, v3
    ds_read_b128 v[88:91], v160
    v_xor_b32 v161, 0xf0, v3
    ds_read_b128 v[92:95], v161
    s_lshl_b32 s7, s3, 10
    s_add_u32 s7, s7, 0x18000
    v_lshl_add_u32 v3, v1, 4, s7
    s_waitcnt lgkmcnt(0)
    s_barrier
    ds_write_b128 v3, v[128:131] offset:0
    ds_write_b128 v3, v[132:135] offset:8192
    ds_write_b128 v3, v[136:139] offset:16384
    ds_write_b128 v3, v[140:143] offset:24576
    v_xor_b32 v160, 0x0, v4
    ds_read_b128 v[24:27], v160
    v_xor_b32 v161, 0x10, v4
    ds_read_b128 v[28:31], v161
    v_xor_b32 v162, 0x20, v4
    ds_read_b128 v[164:167], v162
    v_xor_b32 v160, 0x30, v4
    ds_read_b128 v[144:147], v160
    v_xor_b32 v161, 0x40, v4
    ds_read_b128 v[148:151], v161
    v_xor_b32 v162, 0x50, v4
    ds_read_b128 v[152:155], v162
    v_xor_b32 v160, 0x60, v4
    ds_read_b128 v[156:159], v160
    s_waitcnt lgkmcnt(6)
    v_mfma_f32_16x16x32_bf16 v[16:19], v[24:27], v[32:35], 0
    v_xor_b32 v161, 0x70, v4
    ds_read_b128 v[24:27], v161
    s_waitcnt lgkmcnt(6)
    v_mfma_f32_16x16x32_bf16 v[16:19], v[28:31], v[36:39], v[16:19]
    v_xor_b32 v162, 0x80, v4
    ds_read_b128 v[28:31], v162
    s_waitcnt lgkmcnt(6)
    v_mfma_f32_16x16x32_bf16 v[16:19], v[164:167], v[40:43], v[16:19]
    v_xor_b32 v160, 0x90, v4
    ds_read_b128 v[164:167], v160
    s_waitcnt lgkmcnt(6)
    v_mfma_f32_16x16x32_bf16 v[16:19], v[144:147], v[44:47], v[16:19]
    v_xor_b32 v161, 0xa0, v4
    ds_read_b128 v[144:147], v161
    s_waitcnt lgkmcnt(6)
    v_mfma_f32_16x16x32_bf16 v[16:19], v[148:151], v[48:51], v[16:19]
    v_xor_b32 v162, 0xb0, v4
    ds_read_b128 v[148:151], v162
    s_waitcnt lgkmcnt(6)
    v_mfma_f32_16x16x32_bf16 v[16:19], v[152:155], v[52:55], v[16:19]
    v_xor_b32 v160, 0xc0, v4
    ds_read_b128 v[152:155], v160
    s_waitcnt lgkmcnt(6)
    v_mfma_f32_16x16x32_bf16 v[16:19], v[156:159], v[56:59], v[16:19]
    v_xor_b32 v161, 0xd0, v4
    ds_read_b128 v[156:159], v161
    s_waitcnt lgkmcnt(6)
    v_mfma_f32_16x16x32_bf16 v[16:19], v[24:27], v[60:63], v[16:19]
    v_xor_b32 v162, 0xe0, v4
    ds_read_b128 v[24:27], v162
    s_waitcnt lgkmcnt(6)
    v_mfma_f32_16x16x32_bf16 v[16:19], v[28:31], v[64:67], v[16:19]
    v_xor_b32 v160, 0xf0, v4
    ds_read_b128 v[28:31], v160
    s_waitcnt lgkmcnt(6)
    v_mfma_f32_16x16x32_bf16 v[16:19], v[164:167], v[68:71], v[16:19]
    s_waitcnt lgkmcnt(5)
    v_mfma_f32_16x16x32_bf16 v[16:19], v[144:147], v[72:75], v[16:19]
    s_waitcnt lgkmcnt(4)
    v_mfma_f32_16x16x32_bf16 v[16:19], v[148:151], v[76:79], v[16:19]
    s_waitcnt lgkmcnt(3)
    v_mfma_f32_16x16x32_bf16 v[16:19], v[152:155], v[80:83], v[16:19]
    s_waitcnt lgkmcnt(2)
    v_mfma_f32_16x16x32_bf16 v[16:19], v[156:159], v[84:87], v[16:19]
    s_waitcnt lgkmcnt(1)
    v_mfma_f32_16x16x32_bf16 v[16:19], v[24:27], v[88:91], v[16:19]
    s_waitcnt lgkmcnt(0)
    v_mfma_f32_16x16x32_bf16 v[16:19], v[28:31], v[92:95], v[16:19]
    s_waitcnt lgkmcnt(0)
    s_barrier
    v_xor_b32 v160, 0x0, v2
    ds_read_b128 v[24:27], v160
    v_xor_b32 v161, 0x10, v2
    ds_read_b128 v[28:31], v161
    v_xor_b32 v162, 0x20, v2
    ds_read_b128 v[164:167], v162
    v_xor_b32 v160, 0x30, v2
    ds_read_b128 v[144:147], v160
    v_xor_b32 v161, 0x40, v2
    ds_read_b128 v[148:151], v161
    v_xor_b32 v162, 0x50, v2
    ds_read_b128 v[152:155], v162
    v_xor_b32 v160, 0x60, v2
    ds_read_b128 v[156:159], v160
    s_waitcnt lgkmcnt(6)
    v_mfma_f32_16x16x32_bf16 v[20:23], v[24:27], v[32:35], 0
    v_xor_b32 v161, 0x70, v2
    ds_read_b128 v[24:27], v161
    s_waitcnt lgkmcnt(6)
    v_mfma_f32_16x16x32_bf16 v[20:23], v[28:31], v[36:39], v[20:23]
    v_xor_b32 v162, 0x80, v2
    ds_read_b128 v[28:31], v162
    s_waitcnt lgkmcnt(6)
    v_mfma_f32_16x16x32_bf16 v[20:23], v[164:167], v[40:43], v[20:23]
    v_xor_b32 v160, 0x90, v2
    ds_read_b128 v[164:167], v160
    s_waitcnt lgkmcnt(6)
    v_mfma_f32_16x16x32_bf16 v[20:23], v[144:147], v[44:47], v[20:23]
    v_xor_b32 v161, 0xa0, v2
    ds_read_b128 v[144:147], v161
    s_waitcnt lgkmcnt(6)
    v_mfma_f32_16x16x32_bf16 v[20:23], v[148:151], v[48:51], v[20:23]
    v_xor_b32 v162, 0xb0, v2
    ds_read_b128 v[148:151], v162
    s_waitcnt lgkmcnt(6)
    v_mfma_f32_16x16x32_bf16 v[20:23], v[152:155], v[52:55], v[20:23]
    v_xor_b32 v160, 0xc0, v2
    ds_read_b128 v[152:155], v160
    s_waitcnt lgkmcnt(6)
    v_mfma_f32_16x16x32_bf16 v[20:23], v[156:159], v[56:59], v[20:23]
    v_xor_b32 v161, 0xd0, v2
    ds_read_b128 v[156:159], v161
    s_waitcnt lgkmcnt(6)
    v_mfma_f32_16x16x32_bf16 v[20:23], v[24:27], v[60:63], v[20:23]
    v_xor_b32 v162, 0xe0, v2
    ds_read_b128 v[24:27], v162
    s_waitcnt lgkmcnt(6)
    v_mfma_f32_16x16x32_bf16 v[20:23], v[28:31], v[64:67], v[20:23]
    v_xor_b32 v160, 0xf0, v2
    ds_read_b128 v[28:31], v160
    s_waitcnt lgkmcnt(6)
    v_mfma_f32_16x16x32_bf16 v[20:23], v[164:167], v[68:71], v[20:23]
    s_waitcnt lgkmcnt(5)
    v_mfma_f32_16x16x32_bf16 v[20:23], v[144:147], v[72:75], v[20:23]
    s_waitcnt lgkmcnt(4)
    v_mfma_f32_16x16x32_bf16 v[20:23], v[148:151], v[76:79], v[20:23]
    s_waitcnt lgkmcnt(3)
    v_mfma_f32_16x16x32_bf16 v[20:23], v[152:155], v[80:83], v[20:23]
    s_waitcnt lgkmcnt(2)
    v_mfma_f32_16x16x32_bf16 v[20:23], v[156:159], v[84:87], v[20:23]
    s_waitcnt lgkmcnt(1)
    v_mfma_f32_16x16x32_bf16 v[20:23], v[24:27], v[88:91], v[20:23]
    s_waitcnt lgkmcnt(0)
    v_mfma_f32_16x16x32_bf16 v[20:23], v[28:31], v[92:95], v[20:23]
    v_max3_f32 v160, v16, v17, v18
    s_nop 6
    v_max3_f32 v160, v160, v19, v20
    v_max3_f32 v160, v160, v21, v22
    v_max_f32 v160, v160, v23
    v_mov_b32 v161, v160
    s_nop 1
    v_permlane32_swap_b32 v160, v161
    v_max_f32 v160, v160, v161
    v_mov_b32 v161, v160
    s_nop 1
    v_permlane16_swap_b32 v160, v161
    v_max_f32 v160, v160, v161
    s_lshl_b32 s7, s64, 7
    v_add_u32 v161, s7, v5
    s_mov_b64 exec, s[86:87]
    ds_write_b32 v161, v160
    s_mov_b64 exec, -1
    s_waitcnt lgkmcnt(0)
    s_barrier
    ds_read_b32 v160, v5 offset:0
    ds_read_b32 v161, v5 offset:128
    ds_read_b32 v162, v5 offset:256
    ds_read_b32 v163, v5 offset:384
    s_waitcnt lgkmcnt(0)
    v_max3_f32 v160, v160, v161, v162
    v_max_f32 v160, v160, v163
    v_mul_f32 v160, s67, v160
    v_max_f32 v160, v160, v13
    v_sub_f32 v161, v13, v160
    v_exp_f32 v161, v161
    v_mov_b32 v13, v160
    v_fma_f32 v16, v16, s67, -v160
    v_fma_f32 v17, v17, s67, -v160
    v_fma_f32 v18, v18, s67, -v160
    v_fma_f32 v19, v19, s67, -v160
    v_fma_f32 v20, v20, s67, -v160
    v_fma_f32 v21, v21, s67, -v160
    v_fma_f32 v22, v22, s67, -v160
    v_fma_f32 v23, v23, s67, -v160
    v_exp_f32 v16, v16
    v_exp_f32 v17, v17
    v_exp_f32 v18, v18
    v_exp_f32 v19, v19
    v_exp_f32 v20, v20
    v_exp_f32 v21, v21
    v_exp_f32 v22, v22
    v_exp_f32 v23, v23
    v_cvt_pk_bf16_f32 v24, v16, v17
    v_cvt_pk_bf16_f32 v25, v18, v19
    v_cvt_pk_bf16_f32 v26, v20, v21
    v_cvt_pk_bf16_f32 v27, v22, v23
    ds_write_b64 v6, v[24:25]
    ds_write_b64 v6, v[26:27] offset:4096
    v_add_u32 v162, 0xc00, v5
    s_mov_b64 exec, s[88:89]
    ds_write_b32 v162, v161
    s_mov_b64 exec, -1
    v_mul_f32 v14, v14, v161
    v_add_f32 v16, v16, v20
    v_add_f32 v17, v17, v21
    v_add_f32 v18, v18, v22
    v_add_f32 v19, v19, v23
    v_add_f32 v16, v16, v18
    v_add_f32 v17, v17, v19
    v_add_f32 v16, v16, v17
    v_add_f32 v14, v14, v16
    v_lshlrev_b32 v3, 4, v1
    v_xor_b32 v3, s62, v3
    v_xor_b32 v15, 32, v3
    s_lshl_b32 s68, s3, 10
    s_waitcnt lgkmcnt(0)
    s_barrier
    ds_read_b128 v[16:19], v7 offset:0
    ds_read_b64_tr_b16 v[24:25], v9 offset:0
    ds_read_b64_tr_b16 v[26:27], v11 offset:0
    ds_read_b64_tr_b16 v[28:29], v10 offset:0
    ds_read_b64_tr_b16 v[30:31], v12 offset:0
    ds_read_b128 v[20:23], v7 offset:1024
    ds_read_b64_tr_b16 v[160:161], v9 offset:16384
    ds_read_b64_tr_b16 v[162:163], v11 offset:16384
    ds_read_b64_tr_b16 v[164:165], v10 offset:16384
    ds_read_b64_tr_b16 v[166:167], v12 offset:16384
    s_waitcnt lgkmcnt(7)
    v_mfma_f32_32x32x16_bf16 v[128:143], v[24:27], v[16:19], 0
    s_waitcnt lgkmcnt(5)
    v_mfma_f32_32x32x16_bf16 v[144:159], v[28:31], v[16:19], 0
    ds_read_b128 v[16:19], v7 offset:2048
    ds_read_b64_tr_b16 v[24:25], v9 offset:32768
    ds_read_b64_tr_b16 v[26:27], v11 offset:32768
    ds_read_b64_tr_b16 v[28:29], v10 offset:32768
    ds_read_b64_tr_b16 v[30:31], v12 offset:32768
    s_waitcnt lgkmcnt(7)
    v_mfma_f32_32x32x16_bf16 v[128:143], v[160:163], v[20:23], v[128:143]
    s_waitcnt lgkmcnt(5)
    v_mfma_f32_32x32x16_bf16 v[144:159], v[164:167], v[20:23], v[144:159]
    ds_read_b128 v[20:23], v7 offset:3072
    ds_read_b64_tr_b16 v[160:161], v9 offset:49152
    ds_read_b64_tr_b16 v[162:163], v11 offset:49152
    ds_read_b64_tr_b16 v[164:165], v10 offset:49152
    ds_read_b64_tr_b16 v[166:167], v12 offset:49152
    s_waitcnt lgkmcnt(7)
    v_mfma_f32_32x32x16_bf16 v[128:143], v[24:27], v[16:19], v[128:143]
    s_waitcnt lgkmcnt(5)
    v_mfma_f32_32x32x16_bf16 v[144:159], v[28:31], v[16:19], v[144:159]
    v_add_u32 v9, 0x10000, v9
    v_add_u32 v10, 0x10000, v10
    v_add_u32 v11, 0x10000, v11
    v_add_u32 v12, 0x10000, v12
    ds_read_b128 v[16:19], v7 offset:4096
    ds_read_b64_tr_b16 v[24:25], v9 offset:0
    ds_read_b64_tr_b16 v[26:27], v11 offset:0
    ds_read_b64_tr_b16 v[28:29], v10 offset:0
    ds_read_b64_tr_b16 v[30:31], v12 offset:0
    s_waitcnt lgkmcnt(7)
    v_mfma_f32_32x32x16_bf16 v[128:143], v[160:163], v[20:23], v[128:143]
    s_waitcnt lgkmcnt(5)
    v_mfma_f32_32x32x16_bf16 v[144:159], v[164:167], v[20:23], v[144:159]
    s_barrier
    ds_read_b128 v[20:23], v7 offset:5120
    ds_read_b64_tr_b16 v[160:161], v9 offset:16384
    ds_read_b64_tr_b16 v[162:163], v11 offset:16384
    ds_read_b64_tr_b16 v[164:165], v10 offset:16384
    ds_read_b64_tr_b16 v[166:167], v12 offset:16384
    s_waitcnt lgkmcnt(7)
    v_mfma_f32_32x32x16_bf16 v[128:143], v[24:27], v[16:19], v[128:143]
    s_waitcnt lgkmcnt(5)
    v_mfma_f32_32x32x16_bf16 v[144:159], v[28:31], v[16:19], v[144:159]
    ds_read_b128 v[16:19], v7 offset:6144
    ds_read_b64_tr_b16 v[24:25], v9 offset:32768
    ds_read_b64_tr_b16 v[26:27], v11 offset:32768
    ds_read_b64_tr_b16 v[28:29], v10 offset:32768
    ds_read_b64_tr_b16 v[30:31], v12 offset:32768
    s_waitcnt lgkmcnt(7)
    v_mfma_f32_32x32x16_bf16 v[128:143], v[160:163], v[20:23], v[128:143]
    s_waitcnt lgkmcnt(5)
    v_mfma_f32_32x32x16_bf16 v[144:159], v[164:167], v[20:23], v[144:159]
    ds_read_b128 v[20:23], v7 offset:7168
    ds_read_b64_tr_b16 v[160:161], v9 offset:49152
    ds_read_b64_tr_b16 v[162:163], v11 offset:49152
    ds_read_b64_tr_b16 v[164:165], v10 offset:49152
    ds_read_b64_tr_b16 v[166:167], v12 offset:49152
    s_waitcnt lgkmcnt(7)
    v_mfma_f32_32x32x16_bf16 v[128:143], v[24:27], v[16:19], v[128:143]
    s_waitcnt lgkmcnt(5)
    v_mfma_f32_32x32x16_bf16 v[144:159], v[28:31], v[16:19], v[144:159]
    s_waitcnt lgkmcnt(2)
    v_mfma_f32_32x32x16_bf16 v[128:143], v[160:163], v[20:23], v[128:143]
    s_waitcnt lgkmcnt(0)
    v_mfma_f32_32x32x16_bf16 v[144:159], v[164:167], v[20:23], v[144:159]
    v_add_u32 v9, 0xffff0000, v9
    v_add_u32 v10, 0xffff0000, v10
    v_add_u32 v11, 0xffff0000, v11
    v_add_u32 v12, 0xffff0000, v12
    s_lshl_b32 s7, s3, 10
    s_add_u32 s7, s7, 0x10000
    v_lshl_add_u32 v3, v1, 4, s7
    s_waitcnt vmcnt(0)
    s_barrier
    ds_write_b128 v3, v[96:99] offset:0
    ds_write_b128 v3, v[100:103] offset:8192
    ds_write_b128 v3, v[104:107] offset:16384
    ds_write_b128 v3, v[108:111] offset:24576
    ds_write_b128 v3, v[112:115] offset:32768
    ds_write_b128 v3, v[116:119] offset:40960
    ds_write_b128 v3, v[120:123] offset:49152
    ds_write_b128 v3, v[124:127] offset:57344
    s_waitcnt lgkmcnt(4)
    v_xor_b32 v160, 0x0, v4
    ds_read_b128 v[24:27], v160
    v_xor_b32 v161, 0x10, v4
    ds_read_b128 v[28:31], v161
    v_xor_b32 v162, 0x20, v4
    ds_read_b128 v[164:167], v162
    v_xor_b32 v160, 0x30, v4
    ds_read_b128 v[96:99], v160
    v_xor_b32 v161, 0x40, v4
    ds_read_b128 v[100:103], v161
    v_xor_b32 v162, 0x50, v4
    ds_read_b128 v[104:107], v162
    v_xor_b32 v160, 0x60, v4
    ds_read_b128 v[108:111], v160
    s_waitcnt lgkmcnt(6)
    v_mfma_f32_16x16x32_bf16 v[16:19], v[24:27], v[32:35], 0
    v_xor_b32 v161, 0x70, v4
    ds_read_b128 v[24:27], v161
    s_waitcnt lgkmcnt(6)
    v_mfma_f32_16x16x32_bf16 v[16:19], v[28:31], v[36:39], v[16:19]
    v_xor_b32 v162, 0x80, v4
    ds_read_b128 v[28:31], v162
    s_waitcnt lgkmcnt(6)
    v_mfma_f32_16x16x32_bf16 v[16:19], v[164:167], v[40:43], v[16:19]
    v_xor_b32 v160, 0x90, v4
    ds_read_b128 v[164:167], v160
    s_waitcnt lgkmcnt(6)
    v_mfma_f32_16x16x32_bf16 v[16:19], v[96:99], v[44:47], v[16:19]
    v_xor_b32 v161, 0xa0, v4
    ds_read_b128 v[96:99], v161
    s_waitcnt lgkmcnt(6)
    v_mfma_f32_16x16x32_bf16 v[16:19], v[100:103], v[48:51], v[16:19]
    v_xor_b32 v162, 0xb0, v4
    ds_read_b128 v[100:103], v162
    s_waitcnt lgkmcnt(6)
    v_mfma_f32_16x16x32_bf16 v[16:19], v[104:107], v[52:55], v[16:19]
    v_xor_b32 v160, 0xc0, v4
    ds_read_b128 v[104:107], v160
    s_waitcnt lgkmcnt(6)
    v_mfma_f32_16x16x32_bf16 v[16:19], v[108:111], v[56:59], v[16:19]
    v_xor_b32 v161, 0xd0, v4
    ds_read_b128 v[108:111], v161
    s_waitcnt lgkmcnt(6)
    v_mfma_f32_16x16x32_bf16 v[16:19], v[24:27], v[60:63], v[16:19]
    v_xor_b32 v162, 0xe0, v4
    ds_read_b128 v[24:27], v162
    s_waitcnt lgkmcnt(6)
    v_mfma_f32_16x16x32_bf16 v[16:19], v[28:31], v[64:67], v[16:19]
    v_xor_b32 v160, 0xf0, v4
    ds_read_b128 v[28:31], v160
    s_waitcnt lgkmcnt(6)
    v_mfma_f32_16x16x32_bf16 v[16:19], v[164:167], v[68:71], v[16:19]
    s_waitcnt lgkmcnt(5)
    v_mfma_f32_16x16x32_bf16 v[16:19], v[96:99], v[72:75], v[16:19]
    s_waitcnt lgkmcnt(4)
    v_mfma_f32_16x16x32_bf16 v[16:19], v[100:103], v[76:79], v[16:19]
    s_waitcnt lgkmcnt(3)
    v_mfma_f32_16x16x32_bf16 v[16:19], v[104:107], v[80:83], v[16:19]
    s_waitcnt lgkmcnt(2)
    v_mfma_f32_16x16x32_bf16 v[16:19], v[108:111], v[84:87], v[16:19]
    s_waitcnt lgkmcnt(1)
    v_mfma_f32_16x16x32_bf16 v[16:19], v[24:27], v[88:91], v[16:19]
    s_waitcnt lgkmcnt(0)
    v_mfma_f32_16x16x32_bf16 v[16:19], v[28:31], v[92:95], v[16:19]
    s_barrier
    v_xor_b32 v160, 0x0, v2
    ds_read_b128 v[24:27], v160
    v_xor_b32 v161, 0x10, v2
    ds_read_b128 v[28:31], v161
    v_xor_b32 v162, 0x20, v2
    ds_read_b128 v[164:167], v162
    v_xor_b32 v160, 0x30, v2
    ds_read_b128 v[96:99], v160
    v_xor_b32 v161, 0x40, v2
    ds_read_b128 v[100:103], v161
    v_xor_b32 v162, 0x50, v2
    ds_read_b128 v[104:107], v162
    v_xor_b32 v160, 0x60, v2
    ds_read_b128 v[108:111], v160
    s_waitcnt lgkmcnt(6)
    v_mfma_f32_16x16x32_bf16 v[20:23], v[24:27], v[32:35], 0
    v_xor_b32 v161, 0x70, v2
    ds_read_b128 v[24:27], v161
    s_waitcnt lgkmcnt(6)
    v_mfma_f32_16x16x32_bf16 v[20:23], v[28:31], v[36:39], v[20:23]
    v_xor_b32 v162, 0x80, v2
    ds_read_b128 v[28:31], v162
    s_waitcnt lgkmcnt(6)
    v_mfma_f32_16x16x32_bf16 v[20:23], v[164:167], v[40:43], v[20:23]
    v_xor_b32 v160, 0x90, v2
    ds_read_b128 v[164:167], v160
    s_waitcnt lgkmcnt(6)
    v_mfma_f32_16x16x32_bf16 v[20:23], v[96:99], v[44:47], v[20:23]
    v_xor_b32 v161, 0xa0, v2
    ds_read_b128 v[96:99], v161
    s_waitcnt lgkmcnt(6)
    v_mfma_f32_16x16x32_bf16 v[20:23], v[100:103], v[48:51], v[20:23]
    v_xor_b32 v162, 0xb0, v2
    ds_read_b128 v[100:103], v162
    s_waitcnt lgkmcnt(6)
    v_mfma_f32_16x16x32_bf16 v[20:23], v[104:107], v[52:55], v[20:23]
    v_xor_b32 v160, 0xc0, v2
    ds_read_b128 v[104:107], v160
    s_waitcnt lgkmcnt(6)
    v_mfma_f32_16x16x32_bf16 v[20:23], v[108:111], v[56:59], v[20:23]
    v_xor_b32 v161, 0xd0, v2
    ds_read_b128 v[108:111], v161
    s_waitcnt lgkmcnt(6)
    v_mfma_f32_16x16x32_bf16 v[20:23], v[24:27], v[60:63], v[20:23]
    v_xor_b32 v162, 0xe0, v2
    ds_read_b128 v[24:27], v162
    s_waitcnt lgkmcnt(6)
    v_mfma_f32_16x16x32_bf16 v[20:23], v[28:31], v[64:67], v[20:23]
    v_xor_b32 v160, 0xf0, v2
    ds_read_b128 v[28:31], v160
    s_waitcnt lgkmcnt(6)
    v_mfma_f32_16x16x32_bf16 v[20:23], v[164:167], v[68:71], v[20:23]
    s_waitcnt lgkmcnt(5)
    v_mfma_f32_16x16x32_bf16 v[20:23], v[96:99], v[72:75], v[20:23]
    s_waitcnt lgkmcnt(4)
    v_mfma_f32_16x16x32_bf16 v[20:23], v[100:103], v[76:79], v[20:23]
    s_waitcnt lgkmcnt(3)
    v_mfma_f32_16x16x32_bf16 v[20:23], v[104:107], v[80:83], v[20:23]
    s_waitcnt lgkmcnt(2)
    v_mfma_f32_16x16x32_bf16 v[20:23], v[108:111], v[84:87], v[20:23]
    s_waitcnt lgkmcnt(1)
    v_mfma_f32_16x16x32_bf16 v[20:23], v[24:27], v[88:91], v[20:23]
    s_waitcnt lgkmcnt(0)
    v_mfma_f32_16x16x32_bf16 v[20:23], v[28:31], v[92:95], v[20:23]
    v_max3_f32 v160, v16, v17, v18
    s_nop 6
    v_max3_f32 v160, v160, v19, v20
    v_max3_f32 v160, v160, v21, v22
    v_max_f32 v160, v160, v23
    v_mov_b32 v161, v160
    s_nop 1
    v_permlane32_swap_b32 v160, v161
    v_max_f32 v160, v160, v161
    v_mov_b32 v161, v160
    s_nop 1
    v_permlane16_swap_b32 v160, v161
    v_max_f32 v160, v160, v161
    s_lshl_b32 s7, s64, 7
    v_add_u32 v161, s7, v5
    s_mov_b64 exec, s[86:87]
    ds_write_b32 v161, v160
    s_mov_b64 exec, -1
    s_waitcnt lgkmcnt(0)
    s_barrier
    ds_read_b32 v160, v5 offset:0
    ds_read_b32 v161, v5 offset:128
    ds_read_b32 v162, v5 offset:256
    ds_read_b32 v163, v5 offset:384
    s_waitcnt lgkmcnt(0)
    v_max3_f32 v160, v160, v161, v162
    v_max_f32 v160, v160, v163
    v_mul_f32 v160, s67, v160
    v_max_f32 v160, v160, v13
    v_sub_f32 v161, v13, v160
    v_exp_f32 v161, v161
    v_mov_b32 v13, v160
    v_fma_f32 v16, v16, s67, -v160
    v_fma_f32 v17, v17, s67, -v160
    v_fma_f32 v18, v18, s67, -v160
    v_fma_f32 v19, v19, s67, -v160
    v_fma_f32 v20, v20, s67, -v160
    v_fma_f32 v21, v21, s67, -v160
    v_fma_f32 v22, v22, s67, -v160
    v_fma_f32 v23, v23, s67, -v160
    v_exp_f32 v16, v16
    v_exp_f32 v17, v17
    v_exp_f32 v18, v18
    v_exp_f32 v19, v19
    v_exp_f32 v20, v20
    v_exp_f32 v21, v21
    v_exp_f32 v22, v22
    v_exp_f32 v23, v23
    v_cvt_pk_bf16_f32 v24, v16, v17
    v_cvt_pk_bf16_f32 v25, v18, v19
    v_cvt_pk_bf16_f32 v26, v20, v21
    v_cvt_pk_bf16_f32 v27, v22, v23
    ds_write_b64 v6, v[24:25]
    ds_write_b64 v6, v[26:27] offset:4096
    v_add_u32 v162, 0xc00, v5
    s_mov_b64 exec, s[88:89]
    ds_write_b32 v162, v161
    s_mov_b64 exec, -1
    v_mul_f32 v14, v14, v161
    v_add_f32 v16, v16, v20
    v_add_f32 v17, v17, v21
    v_add_f32 v18, v18, v22
    v_add_f32 v19, v19, v23
    v_add_f32 v16, v16, v18
    v_add_f32 v17, v17, v19
    v_add_f32 v16, v16, v17
    v_add_f32 v14, v14, v16
    v_mov_b32 v160, v14
    s_nop 1
    v_permlane32_swap_b32 v14, v160
    v_add_f32 v14, v14, v160
    v_mov_b32 v160, v14
    s_nop 1
    v_permlane16_swap_b32 v14, v160
    v_add_f32 v14, v14, v160
    s_lshl_b32 s7, s64, 7
    s_add_u32 s7, s7, 0x200
    v_add_u32 v161, s7, v5
    v_add_u32 v162, 0xc80, v5
    s_mov_b64 exec, s[86:87]
    ds_write_b32 v161, v14
    s_mov_b64 exec, s[88:89]
    ds_write_b32 v162, v13
    s_mov_b64 exec, -1
    v_and_b32 v160, 31, v1
    v_lshlrev_b32 v98, 7, v160
    v_lshrrev_b32 v161, 5, v1
    v_and_b32 v160, 7, v1
    v_xor_b32 v161, v160, v161
    v_lshl_add_u32 v98, v161, 4, v98
    s_lshl_b32 s7, s3, 12
    v_add_u32 v98, s7, v98
    v_lshl_add_u32 v99, v1, 4, s7
    v_lshrrev_b32 v161, 3, v1
    v_xor_b32 v160, v160, v161
    v_lshlrev_b32 v100, 7, v161
    v_lshl_add_u32 v100, v160, 4, v100
    s_lshl_b32 s69, s60, 15
    s_add_u32 s69, s69, s7
    s_add_u32 s69, s69, 0x500000
    s_waitcnt lgkmcnt(0)
    s_barrier
    ds_read_b32 v15, v8
    ds_read_b128 v[16:19], v7 offset:0
    ds_read_b64_tr_b16 v[24:25], v9 offset:0
    ds_read_b64_tr_b16 v[26:27], v11 offset:0
    ds_read_b64_tr_b16 v[28:29], v10 offset:0
    ds_read_b64_tr_b16 v[30:31], v12 offset:0
    s_waitcnt lgkmcnt(5)
    v_mul_f32 v128, v15, v128
    v_mul_f32 v129, v15, v129
    v_mul_f32 v130, v15, v130
    v_mul_f32 v131, v15, v131
    v_mul_f32 v132, v15, v132
    v_mul_f32 v133, v15, v133
    v_mul_f32 v134, v15, v134
    v_mul_f32 v135, v15, v135
    s_branch LC_CR
.p2align 12
LT_CR2:
    s_branch LR_CR2
LC_CR:
    v_mul_f32 v136, v15, v136
    v_mul_f32 v137, v15, v137
    v_mul_f32 v138, v15, v138
    v_mul_f32 v139, v15, v139
    v_mul_f32 v140, v15, v140
    v_mul_f32 v141, v15, v141
    v_mul_f32 v142, v15, v142
    v_mul_f32 v143, v15, v143
    v_mul_f32 v144, v15, v144
    v_mul_f32 v145, v15, v145
    v_mul_f32 v146, v15, v146
    v_mul_f32 v147, v15, v147
    v_mul_f32 v148, v15, v148
    v_mul_f32 v149, v15, v149
    v_mul_f32 v150, v15, v150
    v_mul_f32 v151, v15, v151
    v_mul_f32 v152, v15, v152
    v_mul_f32 v153, v15, v153
    v_mul_f32 v154, v15, v154
    v_mul_f32 v155, v15, v155
    v_mul_f32 v156, v15, v156
    v_mul_f32 v157, v15, v157
    v_mul_f32 v158, v15, v158
    v_mul_f32 v159, v15, v159
    ds_read_b128 v[20:23], v7 offset:1024
    ds_read_b64_tr_b16 v[160:161], v9 offset:16384
    ds_read_b64_tr_b16 v[162:163], v11 offset:16384
    ds_read_b64_tr_b16 v[164:165], v10 offset:16384
    ds_read_b64_tr_b16 v[166:167], v12 offset:16384
    s_waitcnt lgkmcnt(7)
    v_mfma_f32_32x32x16_bf16 v[128:143], v[24:27], v[16:19], v[128:143]
    s_waitcnt lgkmcnt(5)
    v_mfma_f32_32x32x16_bf16 v[144:159], v[28:31], v[16:19], v[144:159]
    ds_read_b128 v[16:19], v7 offset:2048
    ds_read_b64_tr_b16 v[24:25], v9 offset:32768
    ds_read_b64_tr_b16 v[26:27], v11 offset:32768
    ds_read_b64_tr_b16 v[28:29], v10 offset:32768
    ds_read_b64_tr_b16 v[30:31], v12 offset:32768
    s_waitcnt lgkmcnt(7)
    v_mfma_f32_32x32x16_bf16 v[128:143], v[160:163], v[20:23], v[128:143]
    s_waitcnt lgkmcnt(5)
    v_mfma_f32_32x32x16_bf16 v[144:159], v[164:167], v[20:23], v[144:159]
    ds_read_b128 v[20:23], v7 offset:3072
    ds_read_b64_tr_b16 v[160:161], v9 offset:49152
    ds_read_b64_tr_b16 v[162:163], v11 offset:49152
    ds_read_b64_tr_b16 v[164:165], v10 offset:49152
    ds_read_b64_tr_b16 v[166:167], v12 offset:49152
    s_waitcnt lgkmcnt(7)
    v_mfma_f32_32x32x16_bf16 v[128:143], v[24:27], v[16:19], v[128:143]
    s_waitcnt lgkmcnt(5)
    v_mfma_f32_32x32x16_bf16 v[144:159], v[28:31], v[16:19], v[144:159]
    v_add_u32 v9, 0x10000, v9
    v_add_u32 v10, 0x10000, v10
    v_add_u32 v11, 0x10000, v11
    v_add_u32 v12, 0x10000, v12
    ds_read_b128 v[16:19], v7 offset:4096
    ds_read_b64_tr_b16 v[24:25], v9 offset:0
    ds_read_b64_tr_b16 v[26:27], v11 offset:0
    ds_read_b64_tr_b16 v[28:29], v10 offset:0
    ds_read_b64_tr_b16 v[30:31], v12 offset:0
    s_waitcnt lgkmcnt(7)
    v_mfma_f32_32x32x16_bf16 v[128:143], v[160:163], v[20:23], v[128:143]
    s_waitcnt lgkmcnt(5)
    v_mfma_f32_32x32x16_bf16 v[144:159], v[164:167], v[20:23], v[144:159]
    s_barrier
    ds_read_b128 v[20:23], v7 offset:5120
    ds_read_b64_tr_b16 v[160:161], v9 offset:16384
    ds_read_b64_tr_b16 v[162:163], v11 offset:16384
    ds_read_b64_tr_b16 v[164:165], v10 offset:16384
    ds_read_b64_tr_b16 v[166:167], v12 offset:16384
    s_waitcnt lgkmcnt(7)
    v_mfma_f32_32x32x16_bf16 v[128:143], v[24:27], v[16:19], v[128:143]
    s_waitcnt lgkmcnt(5)
    v_mfma_f32_32x32x16_bf16 v[144:159], v[28:31], v[16:19], v[144:159]
    ds_read_b128 v[16:19], v7 offset:6144
    ds_read_b64_tr_b16 v[24:25], v9 offset:32768
    ds_read_b64_tr_b16 v[26:27], v11 offset:32768
    ds_read_b64_tr_b16 v[28:29], v10 offset:32768
    ds_read_b64_tr_b16 v[30:31], v12 offset:32768
    s_waitcnt lgkmcnt(7)
    v_mfma_f32_32x32x16_bf16 v[128:143], v[160:163], v[20:23], v[128:143]
    s_waitcnt lgkmcnt(5)
    v_mfma_f32_32x32x16_bf16 v[144:159], v[164:167], v[20:23], v[144:159]
    ds_read_b128 v[20:23], v7 offset:7168
    ds_read_b64_tr_b16 v[160:161], v9 offset:49152
    ds_read_b64_tr_b16 v[162:163], v11 offset:49152
    ds_read_b64_tr_b16 v[164:165], v10 offset:49152
    ds_read_b64_tr_b16 v[166:167], v12 offset:49152
    s_waitcnt lgkmcnt(7)
    v_mfma_f32_32x32x16_bf16 v[128:143], v[24:27], v[16:19], v[128:143]
    s_waitcnt lgkmcnt(5)
    v_mfma_f32_32x32x16_bf16 v[144:159], v[28:31], v[16:19], v[144:159]
    s_waitcnt lgkmcnt(2)
    v_mfma_f32_32x32x16_bf16 v[128:143], v[160:163], v[20:23], v[128:143]
    s_waitcnt lgkmcnt(0)
    v_mfma_f32_32x32x16_bf16 v[144:159], v[164:167], v[20:23], v[144:159]
    s_nop 9
    v_permlane32_swap_b32 v128, v132
    v_permlane32_swap_b32 v129, v133
    v_permlane32_swap_b32 v130, v134
    v_permlane32_swap_b32 v131, v135
    v_cvt_pk_bf16_f32 v16, v128, v129
    v_cvt_pk_bf16_f32 v17, v130, v131
    v_cvt_pk_bf16_f32 v18, v132, v133
    v_cvt_pk_bf16_f32 v19, v134, v135
    v_xor_b32 v160, 0x0, v98
    ds_write_b128 v160, v[16:19]
    v_permlane32_swap_b32 v136, v140
    v_permlane32_swap_b32 v137, v141
    v_permlane32_swap_b32 v138, v142
    v_permlane32_swap_b32 v139, v143
    v_cvt_pk_bf16_f32 v20, v136, v137
    v_cvt_pk_bf16_f32 v21, v138, v139
    v_cvt_pk_bf16_f32 v22, v140, v141
    v_cvt_pk_bf16_f32 v23, v142, v143
    v_xor_b32 v161, 0x20, v98
    ds_write_b128 v161, v[20:23]
    v_permlane32_swap_b32 v144, v148
    v_permlane32_swap_b32 v145, v149
    v_permlane32_swap_b32 v146, v150
    v_permlane32_swap_b32 v147, v151
    v_cvt_pk_bf16_f32 v24, v144, v145
    v_cvt_pk_bf16_f32 v25, v146, v147
    v_cvt_pk_bf16_f32 v26, v148, v149
    v_cvt_pk_bf16_f32 v27, v150, v151
    v_xor_b32 v160, 0x40, v98
    ds_write_b128 v160, v[24:27]
    v_permlane32_swap_b32 v152, v156
    v_permlane32_swap_b32 v153, v157
    v_permlane32_swap_b32 v154, v158
    v_permlane32_swap_b32 v155, v159
    v_cvt_pk_bf16_f32 v28, v152, v153
    v_cvt_pk_bf16_f32 v29, v154, v155
    v_cvt_pk_bf16_f32 v30, v156, v157
    v_cvt_pk_bf16_f32 v31, v158, v159
    v_xor_b32 v161, 0x60, v98
    ds_write_b128 v161, v[28:31]
    ds_read_b128 v[32:35], v99 offset:0
    ds_read_b128 v[36:39], v99 offset:1024
    ds_read_b128 v[40:43], v99 offset:2048
    ds_read_b128 v[44:47], v99 offset:3072
    s_waitcnt lgkmcnt(3)
    buffer_store_dwordx4 v[32:35], v100, s[36:39], s69 offen offset:0 sc1
    s_waitcnt lgkmcnt(2)
    buffer_store_dwordx4 v[36:39], v100, s[36:39], s69 offen offset:1024 sc1
    s_waitcnt lgkmcnt(1)
    buffer_store_dwordx4 v[40:43], v100, s[36:39], s69 offen offset:2048 sc1
    s_waitcnt lgkmcnt(0)
    buffer_store_dwordx4 v[44:47], v100, s[36:39], s69 offen offset:3072 sc1
    v_mov_b32 v160, 0x2404c
    s_mov_b32 s80, 1600000
LW_90:
    ds_read_b32 v161, v160
    s_waitcnt lgkmcnt(0)
    v_readfirstlane_b32 s79, v161
    s_cmp_ge_u32 s79, 1
    s_cbranch_scc1 LWD_91
    s_sleep 2
    s_sub_u32 s80, s80, 1
    s_cmp_lg_u32 s80, 0
    s_cbranch_scc1 LW_90
LWD_91:
    v_mov_b32 v160, 0x24050
    ds_read_b64 v[162:163], v160
    s_waitcnt lgkmcnt(0)
    v_readfirstlane_b32 s94, v162
    v_readfirstlane_b32 s95, v163
    v_and_b32 v160, 31, v1
    v_lshlrev_b32 v3, 2, v160
    v_add_u32 v3, 0x27400, v3
    s_lshl_b32 s7, s60, 9
    s_add_u32 s7, s7, 0xe0000
    s_cmp_eq_u32 s3, 0
    s_cselect_b32 s7, s7, 0x40000000
    v_lshl_add_u32 v4, v160, 4, s7
    v_mov_b32 v22, s94
    v_mov_b32 v23, s95
    ds_read_b32 v16, v3 offset:0
    ds_read_b32 v17, v3 offset:128
    ds_read_b32 v18, v3 offset:256
    ds_read_b32 v19, v3 offset:384
    ds_read_b32 v20, v3 offset:2688
    s_waitcnt lgkmcnt(0)
    v_add_f32 v16, v16, v17
    v_add_f32 v18, v18, v19
    v_add_f32 v21, v16, v18
    s_waitcnt vmcnt(0)
    s_barrier
    s_mov_b64 exec, 0xffffffff
    buffer_store_dwordx4 v[20:23], v4, s[36:39], 0 offen sc1
    s_mov_b64 exec, -1
    v_lshlrev_b32 v2, 4, v1
    s_mov_b32 s44, s12
    s_and_b32 s45, s13, 0xffff
    s_mov_b32 s46, 0x8000000
    s_mov_b32 s47, 0x20000
    s_bfe_u32 s7, s5, 0x10002
    s_lshl_b32 s7, s7, 6
    s_add_u32 s7, s7, s6
    s_lshl_b32 s7, s7, 20
    s_lshl_b32 s72, s3, 10
    s_add_u32 s72, s72, s7
    s_add_u32 s72, s72, 1040384
    s_add_u32 s73, s72, 0x2000000
    s_mov_b32 s74, 4
    s_waitcnt vmcnt(0)
    s_barrier
PV_92:
    s_waitcnt vmcnt(1)
    buffer_load_dwordx4 v[8:11], v2, s[44:47], s72 offen
    s_sub_u32 s72, s72, 8192
    s_waitcnt vmcnt(1)
    buffer_load_dwordx4 v[8:11], v2, s[44:47], s73 offen
    s_sub_u32 s73, s73, 8192
    s_sub_u32 s74, s74, 1
    s_cmp_lg_u32 s74, 0
    s_cbranch_scc1 PV_92
    s_mov_b32 s52, s30
    s_and_b32 s53, s31, 0xffff
    s_mov_b32 s54, 0x2000
    s_mov_b32 s55, 0x20000
    s_lshl_b32 s7, s60, 3
    s_add_u32 s7, s7, s3
    s_lshl_b32 s7, s7, 10
    s_add_u32 s7, s7, 0x100000
    v_add_u32 v4, s7, v2
    s_bfe_u32 s7, s60, 0x20003
    s_lshl_b32 s7, s7, 11
    s_lshr_b32 s66, s60, 5
    s_lshl_b32 s66, s66, 10
    s_add_u32 s7, s7, s66
    s_and_b32 s66, s60, 7
    s_lshl_b32 s66, s66, 7
    s_add_u32 s7, s7, s66
    v_and_b32 v5, 7, v1
    v_lshl_add_u32 v5, v5, 4, s7
    v_lshrrev_b32 v6, 4, v1
    v_lshl_add_u32 v5, v6, 2, v5
    s_mov_b32 s90, 0x00ff00ff
    s_mov_b32 s91, 0x00ff00ff
    s_lshl_b32 s7, s3, 10
    s_add_u32 s7, s7, 0x25200
    v_add_u32 v6, s7, v2
    s_mov_b32 s80, 200000
PO_93:
    buffer_load_dwordx4 v[32:35], v4, s[36:39], 0 offen sc1
PO2_94:
    s_waitcnt vmcnt(0)
    v_cmp_ne_u64 vcc, s[94:95], v[34:35]
    s_cmp_lg_u64 vcc, -1
    s_cbranch_scc1 POD_95
    s_sleep 20
    s_sub_u32 s80, s80, 1
    s_cmp_lg_u32 s80, 0
    s_cbranch_scc1 PO_93
POD_95:
    v_lshlrev_b32 v64, 16, v32
    v_and_b32 v65, 0xffff0000, v32
    v_lshlrev_b32 v66, 16, v33
    v_and_b32 v67, 0xffff0000, v33
    s_cbranch_vccz RD_96
    buffer_load_dwordx4 v[32:35], v4, s[36:39], 0 offen sc1
    s_sleep 4
    buffer_load_dwordx4 v[36:39], v4, s[36:39], 0 offen sc1
    s_sleep 4
    s_mov_b32 s80, 200000
PP_97:
    s_waitcnt vmcnt(1)
    v_cmp_ne_u64 vcc, s[94:95], v[34:35]
    s_cmp_eq_u64 vcc, 0
    s_cbranch_scc1 PPO_99
    buffer_load_dwordx4 v[32:35], v4, s[36:39], 0 offen sc1
    s_waitcnt vmcnt(1)
    v_cmp_ne_u64 vcc, s[94:95], v[38:39]
    s_cmp_eq_u64 vcc, 0
    s_cbranch_scc1 PPO_100
    buffer_load_dwordx4 v[36:39], v4, s[36:39], 0 offen sc1
    s_sub_u32 s80, s80, 1
    s_cmp_lg_u32 s80, 0
    s_cbranch_scc1 PP_97
PPO_99:
    v_lshlrev_b32 v64, 16, v32
    v_and_b32 v65, 0xffff0000, v32
    v_lshlrev_b32 v66, 16, v33
    v_and_b32 v67, 0xffff0000, v33
    s_branch PPD_98
PPO_100:
    v_lshlrev_b32 v64, 16, v36
    v_and_b32 v65, 0xffff0000, v36
    v_lshlrev_b32 v66, 16, v37
    v_and_b32 v67, 0xffff0000, v37
PPD_98:
RD_96:
    ds_write_b128 v6, v[64:67]
    s_waitcnt lgkmcnt(0)
    s_barrier
    s_cmp_lg_u32 s3, 0
    s_cbranch_scc1 L_END
    ds_read_b128 v[64:67], v6 offset:0
    ds_read_b128 v[68:71], v6 offset:1024
    ds_read_b128 v[72:75], v6 offset:2048
    ds_read_b128 v[76:79], v6 offset:3072
    ds_read_b128 v[80:83], v6 offset:4096
    ds_read_b128 v[84:87], v6 offset:5120
    ds_read_b128 v[88:91], v6 offset:6144
    ds_read_b128 v[92:95], v6 offset:7168
    s_waitcnt lgkmcnt(4)
    v_pk_add_f32 v[64:65], v[64:65], v[72:73]
    v_pk_add_f32 v[66:67], v[66:67], v[74:75]
    v_pk_add_f32 v[68:69], v[68:69], v[76:77]
    v_pk_add_f32 v[70:71], v[70:71], v[78:79]
    v_pk_add_f32 v[64:65], v[64:65], v[68:69]
    v_pk_add_f32 v[66:67], v[66:67], v[70:71]
    s_waitcnt lgkmcnt(0)
    v_pk_add_f32 v[80:81], v[80:81], v[88:89]
    v_pk_add_f32 v[82:83], v[82:83], v[90:91]
    v_pk_add_f32 v[84:85], v[84:85], v[92:93]
    v_pk_add_f32 v[86:87], v[86:87], v[94:95]
    v_pk_add_f32 v[80:81], v[80:81], v[84:85]
    v_pk_add_f32 v[82:83], v[82:83], v[86:87]
    s_nop 0
    v_permlane32_swap_b32 v64, v80
    v_permlane32_swap_b32 v65, v81
    v_permlane32_swap_b32 v66, v82
    v_permlane32_swap_b32 v67, v83
    v_add_f32 v64, v64, v80
    v_add_f32 v65, v65, v81
    v_add_f32 v66, v66, v82
    v_add_f32 v67, v67, v83
    s_nop 0
    v_permlane16_swap_b32 v64, v66
    v_permlane16_swap_b32 v65, v67
    v_add_f32 v64, v64, v66
    v_add_f32 v65, v65, v67
    s_nop 0
    v_add_f32_dpp v64, v64, v64 row_ror:8 row_mask:0xf bank_mask:0xf
    v_add_f32_dpp v65, v65, v65 row_ror:8 row_mask:0xf bank_mask:0xf
    v_cvt_pk_bf16_f32 v8, v64, v65
    s_mov_b64 exec, s[90:91]
    buffer_store_dword v8, v5, s[52:55], 0 offen
    s_mov_b64 exec, -1
    s_endpgm
L_CODE_END:
.section .rodata,"a"
.p2align 6
.amdhsa_kernel concat_heads__sliding_block_cached__compressed_kv_cla__decode_kernel
  .amdhsa_next_free_vgpr 168
  .amdhsa_next_free_sgpr 102
  .amdhsa_accum_offset 168
  .amdhsa_group_segment_fixed_size 0
  .amdhsa_kernarg_size 112
  .amdhsa_user_sgpr_count 2
  .amdhsa_user_sgpr_kernarg_segment_ptr 1
  .amdhsa_system_sgpr_workgroup_id_x 1
  .amdhsa_float_denorm_mode_32 3
.end_amdhsa_kernel
```

```asm
; @launch grid=(256,1,1) block=(768,1,1) lds=163840
.amdgcn_target "amdgcn-amd-amdhsa--gfx950"
.text
.globl concat_heads__sliding_block_cached__compressed_kv_cla__decode_kernel
.p2align 12
.p2align 8
.type concat_heads__sliding_block_cached__compressed_kv_cla__decode_kernel,@function
concat_heads__sliding_block_cached__compressed_kv_cla__decode_kernel:
    s_load_dwordx16 s[8:23], s[0:1], 0
    s_load_dwordx8 s[24:31], s[0:1], 64
    s_load_dwordx4 s[32:35], s[0:1], 96
    v_lshrrev_b32 v1, 6, v0
    s_and_b32 s4, s2, 7
    v_readfirstlane_b32 s3, v1
    s_lshr_b32 s5, s2, 3
    v_and_b32 v1, 63, v0
    s_and_b32 s7, s5, 3
    s_lshl2_add_u32 s6, s4, s7
    s_cmp_ge_u32 s5, 32
    s_cbranch_scc1 L_END0
    s_cmp_ge_u32 s5, 16
    s_cbranch_scc1 EA_1
    s_cmp_ge_u32 s5, 8
    s_cbranch_scc1 EC_2
    s_cmp_ge_u32 s3, 8
    s_cbranch_scc1 L_W2
    s_cmp_ge_u32 s3, 4
    s_cbranch_scc1 L_W1
    s_branch L_W
EC_2:
    s_cmp_ge_u32 s3, 8
    s_cbranch_scc1 L_CSVC
    s_branch L_C
EA_1:
    s_cmp_eq_u32 s3, 11
    s_cbranch_scc1 L_ASVC
    s_branch L_AA
L_W2:
    s_sub_u32 s62, s3, 8
    s_lshl_b32 s7, s5, 2
    s_add_u32 s7, s7, s62
    s_lshl_b32 s7, s7, 17
    s_lshl_b32 s70, s4, 10
    s_add_u32 s70, s70, s7
    s_lshl_b32 s71, s62, 14
    v_lshlrev_b32 v2, 4, v1
    s_lshl_b32 s7, s62, 6
    v_xor_b32 v4, s7, v2
    v_xor_b32 v5, 16, v4
    v_xor_b32 v6, 32, v4
    v_xor_b32 v7, 48, v4
    s_waitcnt lgkmcnt(0)
    s_lshl_b32 s7, s2, 4
    s_add_u32 s7, s7, s3
    s_cmp_lg_u32 s7, 8
    s_cbranch_scc1 NM_67
    s_memrealtime s[94:95]
    s_mov_b32 s40, s32
    s_and_b32 s41, s33, 0xffff
    s_mov_b32 s42, 0x100
    s_mov_b32 s43, 0x20000
    v_mov_b32 v8, 0
    s_waitcnt lgkmcnt(0)
    s_or_b32 s95, s95, 0x80000000
    v_mov_b32 v10, s94
    v_mov_b32 v11, s95
    s_mov_b64 exec, 1
    buffer_store_dwordx2 v[10:11], v8, s[40:43], 0 offen sc1
    s_mov_b64 exec, -1
NM_67:
    s_mov_b32 s52, s24
    s_and_b32 s53, s25, 0xffff
    s_mov_b32 s54, 0x400000
    s_mov_b32 s55, 0x20000
    s_mov_b32 m0, s71
    s_nop 0
    buffer_load_dwordx4 v4, s[52:55], s70 offen nt lds
    s_addk_i32 s70, 8192
    s_addk_i32 s71, 1024
    s_mov_b32 m0, s71
    s_nop 0
    buffer_load_dwordx4 v4, s[52:55], s70 offen nt lds
    s_addk_i32 s70, 8192
    s_addk_i32 s71, 1024
    s_mov_b32 m0, s71
    s_nop 0
    buffer_load_dwordx4 v4, s[52:55], s70 offen nt lds
    s_addk_i32 s70, 8192
    s_addk_i32 s71, 1024
    s_mov_b32 m0, s71
    s_nop 0
    buffer_load_dwordx4 v4, s[52:55], s70 offen nt lds
    s_addk_i32 s70, 8192
    s_addk_i32 s71, 1024
    s_mov_b32 m0, s71
    s_nop 0
    buffer_load_dwordx4 v5, s[52:55], s70 offen nt lds
    s_addk_i32 s70, 8192
    s_addk_i32 s71, 1024
    s_mov_b32 m0, s71
    s_nop 0
    buffer_load_dwordx4 v5, s[52:55], s70 offen nt lds
    s_addk_i32 s70, 8192
    s_addk_i32 s71, 1024
    s_mov_b32 m0, s71
    s_nop 0
    buffer_load_dwordx4 v5, s[52:55], s70 offen nt lds
    s_addk_i32 s70, 8192
    s_addk_i32 s71, 1024
    s_mov_b32 m0, s71
    s_nop 0
    buffer_load_dwordx4 v5, s[52:55], s70 offen nt lds
    s_addk_i32 s70, 8192
    s_addk_i32 s71, 1024
    s_branch L_W2B
L_AA:
    s_cmp_ge_u32 s3, 8
    s_cbranch_scc1 AK_3
    s_and_b32 s7, s5, 12
    s_and_b32 s66, s3, 3
    s_add_u32 s7, s7, s66
    v_lshrrev_b32 v2, 4, v1
    v_lshlrev_b32 v3, 16, v2
    v_and_b32 v4, 15, v1
    v_lshl_add_u32 v3, v4, 4, v3
    s_lshl_b32 s66, s7, 18
    s_lshl_b32 s67, s6, 8
    s_add_u32 s66, s66, s67
    s_cmp_lt_u32 s3, 4
    s_cbranch_scc1 AP_5
    s_xor_b32 s66, s66, 512
    s_barrier
    v_mov_b32 v8, 0x24000
    s_mov_b32 s80, 1600000
LW_6:
    ds_read_b32 v9, v8
    s_waitcnt lgkmcnt(0)
    v_readfirstlane_b32 s79, v9
    s_cmp_ge_u32 s79, 1
    s_cbranch_scc1 LWD_7
    s_sleep 1
    s_sub_u32 s80, s80, 1
    s_cmp_lg_u32 s80, 0
    s_cbranch_scc1 LW_6
LWD_7:
AP_5:
    s_cmp_lt_u32 s3, 4
    s_waitcnt lgkmcnt(0)
    s_cselect_b32 s72, s22, s14
    s_cselect_b32 s73, s23, s15
    s_cselect_b32 s70, s18, s8
    s_cselect_b32 s71, s19, s9
    s_mov_b32 s56, s72
    s_and_b32 s57, s73, 0xffff
    s_mov_b32 s58, 0x400000
    s_mov_b32 s59, 0x20000
    buffer_load_dwordx4 v[128:131], v3, s[56:59], s66 offen nt
    s_addk_i32 s66, 8192
    buffer_load_dwordx4 v[132:135], v3, s[56:59], s66 offen nt
    s_addk_i32 s66, 8192
    buffer_load_dwordx4 v[136:139], v3, s[56:59], s66 offen nt
    s_addk_i32 s66, 8192
    buffer_load_dwordx4 v[140:143], v3, s[56:59], s66 offen nt
    s_addk_i32 s66, 8192
    buffer_load_dwordx4 v[144:147], v3, s[56:59], s66 offen nt
    s_addk_i32 s66, 8192
    buffer_load_dwordx4 v[148:151], v3, s[56:59], s66 offen nt
    s_addk_i32 s66, 8192
    buffer_load_dwordx4 v[152:155], v3, s[56:59], s66 offen nt
    s_addk_i32 s66, 8192
    buffer_load_dwordx4 v[156:159], v3, s[56:59], s66 offen nt
    s_addk_i32 s66, 8192
    s_branch L_AB
L_C:
    s_lshl_b32 s60, s4, 3
    s_add_u32 s60, s60, s5
    s_sub_u32 s60, s60, 8
    v_lshlrev_b32 v160, 4, v1
    s_and_b32 s7, s3, 3
    s_lshl_b32 s7, s7, 2
    s_lshr_b32 s66, s3, 2
    s_or_b32 s7, s7, s66
    s_lshl_b32 s62, s7, 4
    v_xor_b32 v2, s62, v160
    v_xor_b32 v3, 32, v2
    s_lshl_b32 s70, s60, 18
    s_lshl_b32 s68, s3, 10
    s_add_u32 s61, s70, s68
    s_waitcnt lgkmcnt(0)
    s_mov_b32 s44, s20
    s_and_b32 s45, s21, 0xffff
    s_mov_b32 s46, 0x1000000
    s_mov_b32 s47, 0x20000
    s_mov_b32 m0, s68
    s_nop 0
    buffer_load_dwordx4 v2, s[44:47], s61 offen nt lds
    s_addk_i32 s68, 8192
    s_addk_i32 s61, 8192
    s_mov_b32 m0, s68
    s_nop 0
    buffer_load_dwordx4 v3, s[44:47], s61 offen nt lds
    s_addk_i32 s68, 8192
    s_addk_i32 s61, 8192
    s_mov_b32 m0, s68
    s_nop 0
    buffer_load_dwordx4 v2, s[44:47], s61 offen nt lds
    s_addk_i32 s68, 8192
    s_addk_i32 s61, 8192
    s_mov_b32 m0, s68
    s_nop 0
    buffer_load_dwordx4 v3, s[44:47], s61 offen nt lds
    s_addk_i32 s68, 8192
    s_branch L_CB
L_AB:
    v_bfe_u32 v4, v1, 2, 2
    v_lshlrev_b32 v4, 10, v4
    v_lshl_add_u32 v4, v2, 4, v4
    s_lshl_b32 s67, s7, 6
    s_mov_b32 s52, s70
    s_and_b32 s53, s71, 0xffff
    s_mov_b32 s54, 0x1000
    s_mov_b32 s55, 0x20000
    buffer_load_dwordx4 v[160:163], v4, s[52:55], s67 offen
    s_mov_b32 s92, 0x05040100
    s_mov_b32 s93, 0x07060302
    s_mov_b32 s36, s34
    s_and_b32 s37, s35, 0xffff
    s_mov_b32 s38, 0x1000000
    s_mov_b32 s39, 0x20000
    s_mov_b32 s40, s32
    s_and_b32 s41, s33, 0xffff
    s_mov_b32 s42, 0x100
    s_mov_b32 s43, 0x20000
    s_mov_b32 s44, s10
    s_and_b32 s45, s11, 0xffff
    s_mov_b32 s46, 0x8000000
    s_mov_b32 s47, 0x20000
    s_mov_b32 s48, s12
    s_and_b32 s49, s13, 0xffff
    s_mov_b32 s50, 0x8000000
    s_mov_b32 s51, 0x20000
    s_lshr_b32 s7, s5, 2
    s_sub_u32 s7, s7, 4
    s_lshl_b32 s7, s7, 5
    s_add_u32 s7, s7, s6
    s_lshl_b32 s7, s7, 20
    s_add_u32 s7, s7, 0xC0000
    v_lshlrev_b32 v6, 4, v1
    v_add_u32 v6, s7, v6
    s_mov_b32 s64, 0x3e0293ee
    s_lshl_b32 s60, s3, 12
    s_mov_b32 s61, s60
    s_cmp_ge_u32 s3, 8
    s_cselect_b32 s7, 5, 0
    s_sub_u32 s7, s3, s7
    s_mul_i32 s7, s7, 6144
    s_add_u32 s63, s7, 225280
    s_add_u32 s65, s63, 4096
    s_sub_u32 s7, s3, 3
    s_cmp_lt_u32 s7, 5
    s_cselect_b32 s62, 0xff800000, 0
    s_cmp_ge_u32 s3, 4
    s_cbranch_scc1 AP_8
    s_barrier
AP_8:
    s_lshl_b32 s7, s3, 11
    s_add_u32 s7, s7, 0x0
    v_lshl_add_u32 v2, v1, 5, s7
    s_cmp_lt_u32 s3, 4
    s_cselect_b32 s7, 0x44, 0x40
    s_add_u32 s7, s7, 0x24000
    v_mov_b32 v3, s7
    v_mov_b32 v4, 1
    s_waitcnt vmcnt(0)
    v_perm_b32 v96, v132, v128, s92
    v_perm_b32 v97, v140, v136, s92
    v_perm_b32 v98, v148, v144, s92
    v_perm_b32 v99, v156, v152, s92
    v_perm_b32 v100, v132, v128, s93
    v_perm_b32 v101, v140, v136, s93
    v_perm_b32 v102, v148, v144, s93
    v_perm_b32 v103, v156, v152, s93
    v_perm_b32 v104, v133, v129, s92
    v_perm_b32 v105, v141, v137, s92
    v_perm_b32 v106, v149, v145, s92
    v_perm_b32 v107, v157, v153, s92
    v_perm_b32 v108, v133, v129, s93
    v_perm_b32 v109, v141, v137, s93
    v_perm_b32 v110, v149, v145, s93
    v_perm_b32 v111, v157, v153, s93
    v_perm_b32 v112, v134, v130, s92
    v_perm_b32 v113, v142, v138, s92
    v_perm_b32 v114, v150, v146, s92
    v_perm_b32 v115, v158, v154, s92
    v_perm_b32 v116, v134, v130, s93
    v_perm_b32 v117, v142, v138, s93
    v_perm_b32 v118, v150, v146, s93
    v_perm_b32 v119, v158, v154, s93
    v_perm_b32 v120, v135, v131, s92
    v_perm_b32 v121, v143, v139, s92
    v_perm_b32 v122, v151, v147, s92
    v_perm_b32 v123, v159, v155, s92
    v_perm_b32 v124, v135, v131, s93
    v_perm_b32 v125, v143, v139, s93
    v_perm_b32 v126, v151, v147, s93
    v_perm_b32 v127, v159, v155, s93
    v_mfma_f32_16x16x32_bf16 v[64:67], v[160:163], v[96:99], 0
    v_mfma_f32_16x16x32_bf16 v[68:71], v[160:163], v[100:103], 0
    v_mfma_f32_16x16x32_bf16 v[72:75], v[160:163], v[104:107], 0
    v_mfma_f32_16x16x32_bf16 v[76:79], v[160:163], v[108:111], 0
    v_mfma_f32_16x16x32_bf16 v[80:83], v[160:163], v[112:115], 0
    v_mfma_f32_16x16x32_bf16 v[84:87], v[160:163], v[116:119], 0
    v_mfma_f32_16x16x32_bf16 v[88:91], v[160:163], v[120:123], 0
    v_mfma_f32_16x16x32_bf16 v[92:95], v[160:163], v[124:127], 0
    s_nop 0
    v_mov_b32 v128, v64
    v_mov_b32 v129, v68
    v_mov_b32 v130, v72
    v_mov_b32 v131, v76
    v_mov_b32 v132, v80
    v_mov_b32 v133, v84
    v_mov_b32 v134, v88
    v_mov_b32 v135, v92
    ds_write_b128 v2, v[128:131]
    ds_write_b128 v2, v[132:135] offset:16
    s_waitcnt lgkmcnt(0)
    s_mov_b64 exec, 1
    ds_add_u32 v3, v4
    s_mov_b64 exec, -1
    s_branch AJ_4
AK_3:
    s_waitcnt lgkmcnt(0)
    s_mov_b32 s92, 0x05040100
    s_mov_b32 s93, 0x07060302
    s_mov_b32 s36, s34
    s_and_b32 s37, s35, 0xffff
    s_mov_b32 s38, 0x1000000
    s_mov_b32 s39, 0x20000
    s_mov_b32 s40, s32
    s_and_b32 s41, s33, 0xffff
    s_mov_b32 s42, 0x100
    s_mov_b32 s43, 0x20000
    s_mov_b32 s44, s10
    s_and_b32 s45, s11, 0xffff
    s_mov_b32 s46, 0x8000000
    s_mov_b32 s47, 0x20000
    s_mov_b32 s48, s12
    s_and_b32 s49, s13, 0xffff
    s_mov_b32 s50, 0x8000000
    s_mov_b32 s51, 0x20000
    s_lshr_b32 s7, s5, 2
    s_sub_u32 s7, s7, 4
    s_lshl_b32 s7, s7, 5
    s_add_u32 s7, s7, s6
    s_lshl_b32 s7, s7, 20
    s_add_u32 s7, s7, 0xC0000
    v_lshlrev_b32 v6, 4, v1
    v_add_u32 v6, s7, v6
    s_mov_b32 s64, 0x3e0293ee
    s_lshl_b32 s60, s3, 12
    s_mov_b32 s61, s60
    s_cmp_ge_u32 s3, 8
    s_cselect_b32 s7, 5, 0
    s_sub_u32 s7, s3, s7
    s_mul_i32 s7, s7, 6144
    s_add_u32 s63, s7, 225280
    s_add_u32 s65, s63, 4096
    s_sub_u32 s7, s3, 3
    s_cmp_lt_u32 s7, 5
    s_cselect_b32 s62, 0xff800000, 0
    s_barrier
    s_cmp_eq_u32 s3, 8
    s_cbranch_scc1 LT_AR
LR_AR:
    s_cmp_eq_u32 s3, 9
    s_cbranch_scc1 LT_AR2
LR_AR2:
    v_mov_b32 v8, 0x24044
    s_mov_b32 s80, 1600000
LW_9:
    ds_read_b32 v9, v8
    s_waitcnt lgkmcnt(0)
    v_readfirstlane_b32 s79, v9
    s_cmp_ge_u32 s79, 1
    s_cbranch_scc1 LWD_10
    s_sleep 2
    s_sub_u32 s80, s80, 1
    s_cmp_lg_u32 s80, 0
    s_cbranch_scc1 LW_9
LWD_10:
AJ_4:
    s_branch L_AR
L_W2B:
    s_cmp_lg_u32 s3, 11
    s_cbranch_scc1 Z_68
    v_lshlrev_b32 v2, 2, v1
    v_add_u32 v2, 0x24000, v2
    v_mov_b32 v3, 0
    ds_write_b32 v2, v3
Z_68:
    s_waitcnt lgkmcnt(0)
    s_mov_b32 s92, 0x05040100
    s_mov_b32 s93, 0x07060302
    s_mov_b32 s36, s34
    s_and_b32 s37, s35, 0xffff
    s_mov_b32 s38, 0x1000000
    s_mov_b32 s39, 0x20000
    s_mov_b32 s40, s32
    s_and_b32 s41, s33, 0xffff
    s_mov_b32 s42, 0x100
    s_mov_b32 s43, 0x20000
    s_barrier
    s_mov_b32 m0, s71
    s_waitcnt vmcnt(7)
    buffer_load_dwordx4 v6, s[52:55], s70 offen nt lds
    s_addk_i32 s70, 8192
    s_addk_i32 s71, 1024
    s_mov_b32 m0, s71
    s_waitcnt vmcnt(7)
    buffer_load_dwordx4 v6, s[52:55], s70 offen nt lds
    s_addk_i32 s70, 8192
    s_addk_i32 s71, 1024
    s_mov_b32 m0, s71
    s_waitcnt vmcnt(7)
    buffer_load_dwordx4 v6, s[52:55], s70 offen nt lds
    s_addk_i32 s70, 8192
    s_addk_i32 s71, 1024
    s_mov_b32 m0, s71
    s_waitcnt vmcnt(7)
    buffer_load_dwordx4 v6, s[52:55], s70 offen nt lds
    s_addk_i32 s70, 8192
    s_addk_i32 s71, 1024
    s_mov_b32 m0, s71
    s_waitcnt vmcnt(7)
    buffer_load_dwordx4 v7, s[52:55], s70 offen nt lds
    s_addk_i32 s70, 8192
    s_addk_i32 s71, 1024
    s_mov_b32 m0, s71
    s_waitcnt vmcnt(7)
    buffer_load_dwordx4 v7, s[52:55], s70 offen nt lds
    s_addk_i32 s70, 8192
    s_addk_i32 s71, 1024
    s_mov_b32 m0, s71
    s_waitcnt vmcnt(7)
    buffer_load_dwordx4 v7, s[52:55], s70 offen nt lds
    s_addk_i32 s70, 8192
    s_addk_i32 s71, 1024
    s_mov_b32 m0, s71
    s_waitcnt vmcnt(7)
    buffer_load_dwordx4 v7, s[52:55], s70 offen nt lds
    s_addk_i32 s70, 8192
    s_addk_i32 s71, 1024
    s_branch L_W2R
L_CB:
    s_mov_b32 s92, 0x05040100
    s_mov_b32 s93, 0x07060302
    s_mov_b32 s36, s34
    s_and_b32 s37, s35, 0xffff
    s_mov_b32 s38, 0x1000000
    s_mov_b32 s39, 0x20000
    s_mov_b32 s40, s32
    s_and_b32 s41, s33, 0xffff
    s_mov_b32 s42, 0x100
    s_mov_b32 s43, 0x20000
    s_lshr_b32 s64, s3, 1
    s_and_b32 s65, s3, 1
    s_mov_b32 s67, 0x3e0293ee
    s_barrier
    s_addk_i32 s61, 8192
    s_mov_b32 m0, s68
    s_waitcnt vmcnt(3)
    buffer_load_dwordx4 v2, s[44:47], s61 offen nt lds
    s_addk_i32 s68, 8192
    s_addk_i32 s61, 8192
    s_mov_b32 m0, s68
    s_waitcnt vmcnt(3)
    buffer_load_dwordx4 v3, s[44:47], s61 offen nt lds
    s_addk_i32 s68, 8192
    s_addk_i32 s61, 8192
    s_mov_b32 m0, s68
    s_waitcnt vmcnt(3)
    buffer_load_dwordx4 v2, s[44:47], s61 offen nt lds
    s_addk_i32 s68, 8192
    s_addk_i32 s61, 8192
    s_mov_b32 m0, s68
    s_waitcnt vmcnt(3)
    buffer_load_dwordx4 v3, s[44:47], s61 offen nt lds
    s_addk_i32 s68, 8192
    s_addk_i32 s61, 8192
    s_mov_b32 m0, s68
    s_waitcnt vmcnt(3)
    buffer_load_dwordx4 v2, s[44:47], s61 offen nt lds
    s_addk_i32 s68, 8192
    s_addk_i32 s61, 8192
    s_mov_b32 m0, s68
    s_waitcnt vmcnt(3)
    buffer_load_dwordx4 v3, s[44:47], s61 offen nt lds
    s_addk_i32 s68, 8192
    s_addk_i32 s61, 8192
    s_mov_b32 m0, s68
    s_waitcnt vmcnt(3)
    buffer_load_dwordx4 v2, s[44:47], s61 offen nt lds
    s_addk_i32 s68, 8192
    s_addk_i32 s61, 8192
    s_mov_b32 m0, s68
    s_waitcnt vmcnt(3)
    buffer_load_dwordx4 v3, s[44:47], s61 offen nt lds
    s_addk_i32 s68, 8192
    s_addk_i32 s61, 8192
    s_waitcnt vmcnt(3)
    buffer_load_dwordx4 v[128:131], v2, s[44:47], s61 offen nt
    s_addk_i32 s61, 8192
    s_waitcnt vmcnt(3)
    buffer_load_dwordx4 v[132:135], v3, s[44:47], s61 offen nt
    s_addk_i32 s61, 8192
    s_waitcnt vmcnt(3)
    buffer_load_dwordx4 v[136:139], v2, s[44:47], s61 offen nt
    s_addk_i32 s61, 8192
    s_waitcnt vmcnt(3)
    buffer_load_dwordx4 v[140:143], v3, s[44:47], s61 offen nt
    s_addk_i32 s61, 8192
    s_waitcnt vmcnt(3)
    buffer_load_dwordx4 v[96:99], v2, s[44:47], s61 offen nt
    s_addk_i32 s61, 8192
    s_waitcnt vmcnt(3)
    buffer_load_dwordx4 v[100:103], v3, s[44:47], s61 offen nt
    s_addk_i32 s61, 8192
    s_waitcnt vmcnt(3)
    buffer_load_dwordx4 v[104:107], v2, s[44:47], s61 offen nt
    s_addk_i32 s61, 8192
    s_waitcnt vmcnt(3)
    buffer_load_dwordx4 v[108:111], v3, s[44:47], s61 offen nt
    s_addk_i32 s61, 8192
    s_waitcnt vmcnt(3)
    buffer_load_dwordx4 v[112:115], v2, s[44:47], s61 offen nt
    s_addk_i32 s61, 8192
    s_waitcnt vmcnt(3)
    buffer_load_dwordx4 v[116:119], v3, s[44:47], s61 offen nt
    s_addk_i32 s61, 8192
    v_mov_b32 v160, 0x24018
    v_mov_b32 v161, 1
    s_waitcnt lgkmcnt(0)
    s_mov_b64 exec, 1
    ds_add_u32 v160, v161
    s_mov_b64 exec, -1
    s_waitcnt vmcnt(3)
    buffer_load_dwordx4 v[120:123], v2, s[44:47], s61 offen nt
    s_addk_i32 s61, 8192
    s_waitcnt vmcnt(3)
    buffer_load_dwordx4 v[124:127], v3, s[44:47], s61 offen nt
    s_addk_i32 s61, 8192
    s_branch L_CR
L_END:
    s_endpgm
L_END0:
    s_endpgm
.p2align 12
LT_AR:
    s_branch LR_AR
L_AR:
    v_mov_b32 v34, 0
    v_mov_b32 v35, 0
    v_mov_b32 v36, 0
    v_mov_b32 v37, 0
    v_mov_b32 v38, 0
    v_mov_b32 v39, 0
    v_mov_b32 v40, 0
    v_mov_b32 v41, 0
    v_mov_b32 v42, 0
    v_mov_b32 v43, 0
    v_mov_b32 v44, 0
    v_mov_b32 v45, 0
    v_mov_b32 v46, 0
    v_mov_b32 v47, 0
    v_mov_b32 v48, 0
    v_mov_b32 v49, 0
    v_mov_b32 v50, 0
    v_mov_b32 v51, 0
    v_mov_b32 v52, 0
    v_mov_b32 v53, 0
    v_mov_b32 v54, 0
    v_mov_b32 v55, 0
    v_mov_b32 v56, 0
    v_mov_b32 v57, 0
    s_cmp_lg_u32 s62, 0
    s_cbranch_scc1 L_AK2
    buffer_load_dwordx4 v[34:37], v6, s[44:47], s63 offen offset:0 nt
    buffer_load_dwordx4 v[38:41], v6, s[44:47], s63 offen offset:1024 nt
    buffer_load_dwordx4 v[42:45], v6, s[44:47], s63 offen offset:2048 nt
    buffer_load_dwordx4 v[46:49], v6, s[44:47], s63 offen offset:3072 nt
    buffer_load_dwordx4 v[50:53], v6, s[44:47], s65 offen offset:0 nt
    buffer_load_dwordx4 v[54:57], v6, s[44:47], s65 offen offset:1024 nt
L_AK2:
    s_waitcnt vmcnt(0)
    buffer_load_dwordx4 v[58:61], v6, s[44:47], s60 offen offset:0 nt
    buffer_load_dwordx4 v[62:65], v6, s[44:47], s60 offen offset:1024 nt
    buffer_load_dwordx4 v[66:69], v6, s[44:47], s60 offen offset:2048 nt
    buffer_load_dwordx4 v[70:73], v6, s[44:47], s60 offen offset:3072 nt
    s_add_u32 s60, s60, 45056
    s_waitcnt vmcnt(0)
    buffer_load_dwordx4 v[74:77], v6, s[44:47], s60 offen offset:0 nt
    buffer_load_dwordx4 v[78:81], v6, s[44:47], s60 offen offset:1024 nt
    buffer_load_dwordx4 v[82:85], v6, s[44:47], s60 offen offset:2048 nt
    buffer_load_dwordx4 v[86:89], v6, s[44:47], s60 offen offset:3072 nt
    s_add_u32 s60, s60, 45056
    s_waitcnt vmcnt(0)
    buffer_load_dwordx4 v[90:93], v6, s[44:47], s60 offen offset:0 nt
    buffer_load_dwordx4 v[94:97], v6, s[44:47], s60 offen offset:1024 nt
    buffer_load_dwordx4 v[98:101], v6, s[44:47], s60 offen offset:2048 nt
    buffer_load_dwordx4 v[102:105], v6, s[44:47], s60 offen offset:3072 nt
    s_add_u32 s60, s60, 45056
    s_waitcnt vmcnt(0)
    buffer_load_dwordx4 v[106:109], v6, s[44:47], s60 offen offset:0 nt
    buffer_load_dwordx4 v[110:113], v6, s[44:47], s60 offen offset:1024 nt
    buffer_load_dwordx4 v[114:117], v6, s[44:47], s60 offen offset:2048 nt
    buffer_load_dwordx4 v[118:121], v6, s[44:47], s60 offen offset:3072 nt
    s_add_u32 s60, s60, 45056
    v_mov_b32 v160, 0x24004
    s_mov_b32 s80, 1600000
LW_11:
    ds_read_b32 v161, v160
    s_waitcnt lgkmcnt(0)
    v_readfirstlane_b32 s79, v161
    s_cmp_ge_u32 s79, 1
    s_cbranch_scc1 LWD_12
    s_sleep 4
    s_sub_u32 s80, s80, 1
    s_cmp_lg_u32 s80, 0
    s_cbranch_scc1 LW_11
LWD_12:
    v_and_b32 v160, 15, v1
    v_lshlrev_b32 v160, 4, v160
    v_add_u32 v160, 0x24100, v160
    ds_read_b128 v[2:5], v160
    s_waitcnt lgkmcnt(0)
    v_dot2_f32_bf16 v8, v34, v2, 0
    v_dot2_f32_bf16 v9, v38, v2, 0
    v_dot2_f32_bf16 v10, v42, v2, 0
    v_dot2_f32_bf16 v11, v46, v2, 0
    v_dot2_f32_bf16 v12, v50, v2, 0
    v_dot2_f32_bf16 v13, v54, v2, 0
    v_dot2_f32_bf16 v8, v35, v3, v8
    v_dot2_f32_bf16 v9, v39, v3, v9
    v_dot2_f32_bf16 v10, v43, v3, v10
    v_dot2_f32_bf16 v11, v47, v3, v11
    v_dot2_f32_bf16 v12, v51, v3, v12
    v_dot2_f32_bf16 v13, v55, v3, v13
    v_dot2_f32_bf16 v8, v36, v4, v8
    v_dot2_f32_bf16 v9, v40, v4, v9
    v_dot2_f32_bf16 v10, v44, v4, v10
    v_dot2_f32_bf16 v11, v48, v4, v11
    v_dot2_f32_bf16 v12, v52, v4, v12
    v_dot2_f32_bf16 v13, v56, v4, v13
    v_dot2_f32_bf16 v8, v37, v5, v8
    v_dot2_f32_bf16 v9, v41, v5, v9
    v_dot2_f32_bf16 v10, v45, v5, v10
    v_dot2_f32_bf16 v11, v49, v5, v11
    v_dot2_f32_bf16 v12, v53, v5, v12
    v_dot2_f32_bf16 v13, v57, v5, v13
    v_add_f32_dpp v8, v8, v8 row_ror:8 row_mask:0xf bank_mask:0xf
    v_add_f32_dpp v9, v9, v9 row_ror:8 row_mask:0xf bank_mask:0xf
    v_add_f32_dpp v10, v10, v10 row_ror:8 row_mask:0xf bank_mask:0xf
    v_add_f32_dpp v11, v11, v11 row_ror:8 row_mask:0xf bank_mask:0xf
    v_add_f32_dpp v12, v12, v12 row_ror:8 row_mask:0xf bank_mask:0xf
    v_add_f32_dpp v13, v13, v13 row_ror:8 row_mask:0xf bank_mask:0xf
    v_add_f32_dpp v8, v8, v8 row_ror:4 row_mask:0xf bank_mask:0xf
    v_add_f32_dpp v9, v9, v9 row_ror:4 row_mask:0xf bank_mask:0xf
    v_add_f32_dpp v10, v10, v10 row_ror:4 row_mask:0xf bank_mask:0xf
    v_add_f32_dpp v11, v11, v11 row_ror:4 row_mask:0xf bank_mask:0xf
    v_add_f32_dpp v12, v12, v12 row_ror:4 row_mask:0xf bank_mask:0xf
    v_add_f32_dpp v13, v13, v13 row_ror:4 row_mask:0xf bank_mask:0xf
    v_add_f32_dpp v8, v8, v8 row_ror:2 row_mask:0xf bank_mask:0xf
    v_add_f32_dpp v9, v9, v9 row_ror:2 row_mask:0xf bank_mask:0xf
    v_add_f32_dpp v10, v10, v10 row_ror:2 row_mask:0xf bank_mask:0xf
    v_add_f32_dpp v11, v11, v11 row_ror:2 row_mask:0xf bank_mask:0xf
    v_add_f32_dpp v12, v12, v12 row_ror:2 row_mask:0xf bank_mask:0xf
    v_add_f32_dpp v13, v13, v13 row_ror:2 row_mask:0xf bank_mask:0xf
    v_add_f32_dpp v8, v8, v8 row_ror:1 row_mask:0xf bank_mask:0xf
    v_add_f32_dpp v9, v9, v9 row_ror:1 row_mask:0xf bank_mask:0xf
    v_add_f32_dpp v10, v10, v10 row_ror:1 row_mask:0xf bank_mask:0xf
    v_add_f32_dpp v11, v11, v11 row_ror:1 row_mask:0xf bank_mask:0xf
    v_add_f32_dpp v12, v12, v12 row_ror:1 row_mask:0xf bank_mask:0xf
    v_add_f32_dpp v13, v13, v13 row_ror:1 row_mask:0xf bank_mask:0xf
    v_dot2_f32_bf16 v14, v58, v2, 0
    v_dot2_f32_bf16 v15, v62, v2, 0
    v_dot2_f32_bf16 v16, v66, v2, 0
    v_dot2_f32_bf16 v17, v70, v2, 0
    v_dot2_f32_bf16 v14, v59, v3, v14
    v_dot2_f32_bf16 v15, v63, v3, v15
    v_dot2_f32_bf16 v16, v67, v3, v16
    v_dot2_f32_bf16 v17, v71, v3, v17
    v_dot2_f32_bf16 v14, v60, v4, v14
    v_dot2_f32_bf16 v15, v64, v4, v15
    v_dot2_f32_bf16 v16, v68, v4, v16
    v_dot2_f32_bf16 v17, v72, v4, v17
    v_dot2_f32_bf16 v14, v61, v5, v14
    v_dot2_f32_bf16 v15, v65, v5, v15
    v_dot2_f32_bf16 v16, v69, v5, v16
    v_dot2_f32_bf16 v17, v73, v5, v17
    v_add_f32_dpp v14, v14, v14 row_ror:8 row_mask:0xf bank_mask:0xf
    v_add_f32_dpp v15, v15, v15 row_ror:8 row_mask:0xf bank_mask:0xf
    v_add_f32_dpp v16, v16, v16 row_ror:8 row_mask:0xf bank_mask:0xf
    v_add_f32_dpp v17, v17, v17 row_ror:8 row_mask:0xf bank_mask:0xf
    v_add_f32_dpp v14, v14, v14 row_ror:4 row_mask:0xf bank_mask:0xf
    v_add_f32_dpp v15, v15, v15 row_ror:4 row_mask:0xf bank_mask:0xf
    v_add_f32_dpp v16, v16, v16 row_ror:4 row_mask:0xf bank_mask:0xf
    v_add_f32_dpp v17, v17, v17 row_ror:4 row_mask:0xf bank_mask:0xf
    v_add_f32_dpp v14, v14, v14 row_ror:2 row_mask:0xf bank_mask:0xf
    v_add_f32_dpp v15, v15, v15 row_ror:2 row_mask:0xf bank_mask:0xf
    v_add_f32_dpp v16, v16, v16 row_ror:2 row_mask:0xf bank_mask:0xf
    v_add_f32_dpp v17, v17, v17 row_ror:2 row_mask:0xf bank_mask:0xf
    v_add_f32_dpp v14, v14, v14 row_ror:1 row_mask:0xf bank_mask:0xf
    v_add_f32_dpp v15, v15, v15 row_ror:1 row_mask:0xf bank_mask:0xf
    v_add_f32_dpp v16, v16, v16 row_ror:1 row_mask:0xf bank_mask:0xf
    v_add_f32_dpp v17, v17, v17 row_ror:1 row_mask:0xf bank_mask:0xf
    s_waitcnt vmcnt(0)
    buffer_load_dwordx4 v[122:125], v6, s[44:47], s60 offen offset:0 nt
    buffer_load_dwordx4 v[126:129], v6, s[44:47], s60 offen offset:1024 nt
    buffer_load_dwordx4 v[130:133], v6, s[44:47], s60 offen offset:2048 nt
    buffer_load_dwordx4 v[134:137], v6, s[44:47], s60 offen offset:3072 nt
    s_add_u32 s60, s60, 45056
    v_dot2_f32_bf16 v18, v74, v2, 0
    v_dot2_f32_bf16 v19, v78, v2, 0
    v_dot2_f32_bf16 v20, v82, v2, 0
    v_dot2_f32_bf16 v21, v86, v2, 0
    v_dot2_f32_bf16 v18, v75, v3, v18
    v_dot2_f32_bf16 v19, v79, v3, v19
    v_dot2_f32_bf16 v20, v83, v3, v20
    v_dot2_f32_bf16 v21, v87, v3, v21
    v_dot2_f32_bf16 v18, v76, v4, v18
    v_dot2_f32_bf16 v19, v80, v4, v19
    v_dot2_f32_bf16 v20, v84, v4, v20
    v_dot2_f32_bf16 v21, v88, v4, v21
    v_dot2_f32_bf16 v18, v77, v5, v18
    v_dot2_f32_bf16 v19, v81, v5, v19
    v_dot2_f32_bf16 v20, v85, v5, v20
    v_dot2_f32_bf16 v21, v89, v5, v21
    v_add_f32_dpp v18, v18, v18 row_ror:8 row_mask:0xf bank_mask:0xf
    v_add_f32_dpp v19, v19, v19 row_ror:8 row_mask:0xf bank_mask:0xf
    v_add_f32_dpp v20, v20, v20 row_ror:8 row_mask:0xf bank_mask:0xf
    v_add_f32_dpp v21, v21, v21 row_ror:8 row_mask:0xf bank_mask:0xf
    v_add_f32_dpp v18, v18, v18 row_ror:4 row_mask:0xf bank_mask:0xf
    v_add_f32_dpp v19, v19, v19 row_ror:4 row_mask:0xf bank_mask:0xf
    v_add_f32_dpp v20, v20, v20 row_ror:4 row_mask:0xf bank_mask:0xf
    v_add_f32_dpp v21, v21, v21 row_ror:4 row_mask:0xf bank_mask:0xf
    v_add_f32_dpp v18, v18, v18 row_ror:2 row_mask:0xf bank_mask:0xf
    v_add_f32_dpp v19, v19, v19 row_ror:2 row_mask:0xf bank_mask:0xf
    v_add_f32_dpp v20, v20, v20 row_ror:2 row_mask:0xf bank_mask:0xf
    v_add_f32_dpp v21, v21, v21 row_ror:2 row_mask:0xf bank_mask:0xf
    v_add_f32_dpp v18, v18, v18 row_ror:1 row_mask:0xf bank_mask:0xf
    v_add_f32_dpp v19, v19, v19 row_ror:1 row_mask:0xf bank_mask:0xf
    v_add_f32_dpp v20, v20, v20 row_ror:1 row_mask:0xf bank_mask:0xf
    v_add_f32_dpp v21, v21, v21 row_ror:1 row_mask:0xf bank_mask:0xf
    v_dot2_f32_bf16 v22, v90, v2, 0
    v_dot2_f32_bf16 v23, v94, v2, 0
    v_dot2_f32_bf16 v24, v98, v2, 0
    v_dot2_f32_bf16 v25, v102, v2, 0
    v_dot2_f32_bf16 v22, v91, v3, v22
    v_dot2_f32_bf16 v23, v95, v3, v23
    v_dot2_f32_bf16 v24, v99, v3, v24
    v_dot2_f32_bf16 v25, v103, v3, v25
    v_dot2_f32_bf16 v22, v92, v4, v22
    v_dot2_f32_bf16 v23, v96, v4, v23
    v_dot2_f32_bf16 v24, v100, v4, v24
    v_dot2_f32_bf16 v25, v104, v4, v25
    v_dot2_f32_bf16 v22, v93, v5, v22
    v_dot2_f32_bf16 v23, v97, v5, v23
    v_dot2_f32_bf16 v24, v101, v5, v24
    v_dot2_f32_bf16 v25, v105, v5, v25
    v_add_f32_dpp v22, v22, v22 row_ror:8 row_mask:0xf bank_mask:0xf
    v_add_f32_dpp v23, v23, v23 row_ror:8 row_mask:0xf bank_mask:0xf
    v_add_f32_dpp v24, v24, v24 row_ror:8 row_mask:0xf bank_mask:0xf
    v_add_f32_dpp v25, v25, v25 row_ror:8 row_mask:0xf bank_mask:0xf
    v_add_f32_dpp v22, v22, v22 row_ror:4 row_mask:0xf bank_mask:0xf
    v_add_f32_dpp v23, v23, v23 row_ror:4 row_mask:0xf bank_mask:0xf
    v_add_f32_dpp v24, v24, v24 row_ror:4 row_mask:0xf bank_mask:0xf
    v_add_f32_dpp v25, v25, v25 row_ror:4 row_mask:0xf bank_mask:0xf
    v_add_f32_dpp v22, v22, v22 row_ror:2 row_mask:0xf bank_mask:0xf
    v_add_f32_dpp v23, v23, v23 row_ror:2 row_mask:0xf bank_mask:0xf
    v_add_f32_dpp v24, v24, v24 row_ror:2 row_mask:0xf bank_mask:0xf
    v_add_f32_dpp v25, v25, v25 row_ror:2 row_mask:0xf bank_mask:0xf
    v_add_f32_dpp v22, v22, v22 row_ror:1 row_mask:0xf bank_mask:0xf
    v_add_f32_dpp v23, v23, v23 row_ror:1 row_mask:0xf bank_mask:0xf
    v_add_f32_dpp v24, v24, v24 row_ror:1 row_mask:0xf bank_mask:0xf
    v_add_f32_dpp v25, v25, v25 row_ror:1 row_mask:0xf bank_mask:0xf
    s_waitcnt vmcnt(0)
    buffer_load_dwordx4 v[34:37], v6, s[48:51], s61 offen offset:0 nt
    buffer_load_dwordx4 v[38:41], v6, s[48:51], s61 offen offset:1024 nt
    buffer_load_dwordx4 v[42:45], v6, s[48:51], s61 offen offset:2048 nt
    buffer_load_dwordx4 v[46:49], v6, s[48:51], s61 offen offset:3072 nt
    s_add_u32 s61, s61, 45056
    v_dot2_f32_bf16 v26, v106, v2, 0
    v_dot2_f32_bf16 v27, v110, v2, 0
    v_dot2_f32_bf16 v28, v114, v2, 0
    v_dot2_f32_bf16 v29, v118, v2, 0
    v_dot2_f32_bf16 v26, v107, v3, v26
    v_dot2_f32_bf16 v27, v111, v3, v27
    v_dot2_f32_bf16 v28, v115, v3, v28
    v_dot2_f32_bf16 v29, v119, v3, v29
    v_dot2_f32_bf16 v26, v108, v4, v26
    v_dot2_f32_bf16 v27, v112, v4, v27
    v_dot2_f32_bf16 v28, v116, v4, v28
    v_dot2_f32_bf16 v29, v120, v4, v29
    v_dot2_f32_bf16 v26, v109, v5, v26
    v_dot2_f32_bf16 v27, v113, v5, v27
    v_dot2_f32_bf16 v28, v117, v5, v28
    v_dot2_f32_bf16 v29, v121, v5, v29
    v_add_f32_dpp v26, v26, v26 row_ror:8 row_mask:0xf bank_mask:0xf
    v_add_f32_dpp v27, v27, v27 row_ror:8 row_mask:0xf bank_mask:0xf
    v_add_f32_dpp v28, v28, v28 row_ror:8 row_mask:0xf bank_mask:0xf
    v_add_f32_dpp v29, v29, v29 row_ror:8 row_mask:0xf bank_mask:0xf
    v_add_f32_dpp v26, v26, v26 row_ror:4 row_mask:0xf bank_mask:0xf
    v_add_f32_dpp v27, v27, v27 row_ror:4 row_mask:0xf bank_mask:0xf
    v_add_f32_dpp v28, v28, v28 row_ror:4 row_mask:0xf bank_mask:0xf
    v_add_f32_dpp v29, v29, v29 row_ror:4 row_mask:0xf bank_mask:0xf
    v_add_f32_dpp v26, v26, v26 row_ror:2 row_mask:0xf bank_mask:0xf
    v_add_f32_dpp v27, v27, v27 row_ror:2 row_mask:0xf bank_mask:0xf
    v_add_f32_dpp v28, v28, v28 row_ror:2 row_mask:0xf bank_mask:0xf
    v_add_f32_dpp v29, v29, v29 row_ror:2 row_mask:0xf bank_mask:0xf
    v_add_f32_dpp v26, v26, v26 row_ror:1 row_mask:0xf bank_mask:0xf
    v_add_f32_dpp v27, v27, v27 row_ror:1 row_mask:0xf bank_mask:0xf
    v_add_f32_dpp v28, v28, v28 row_ror:1 row_mask:0xf bank_mask:0xf
    v_add_f32_dpp v29, v29, v29 row_ror:1 row_mask:0xf bank_mask:0xf
    v_dot2_f32_bf16 v30, v122, v2, 0
    v_dot2_f32_bf16 v31, v126, v2, 0
    v_dot2_f32_bf16 v32, v130, v2, 0
    v_dot2_f32_bf16 v33, v134, v2, 0
    v_dot2_f32_bf16 v30, v123, v3, v30
    v_dot2_f32_bf16 v31, v127, v3, v31
    v_dot2_f32_bf16 v32, v131, v3, v32
    v_dot2_f32_bf16 v33, v135, v3, v33
    v_dot2_f32_bf16 v30, v124, v4, v30
    v_dot2_f32_bf16 v31, v128, v4, v31
    v_dot2_f32_bf16 v32, v132, v4, v32
    v_dot2_f32_bf16 v33, v136, v4, v33
    v_dot2_f32_bf16 v30, v125, v5, v30
    v_dot2_f32_bf16 v31, v129, v5, v31
    v_dot2_f32_bf16 v32, v133, v5, v32
    v_dot2_f32_bf16 v33, v137, v5, v33
    v_add_f32_dpp v30, v30, v30 row_ror:8 row_mask:0xf bank_mask:0xf
    v_add_f32_dpp v31, v31, v31 row_ror:8 row_mask:0xf bank_mask:0xf
    v_add_f32_dpp v32, v32, v32 row_ror:8 row_mask:0xf bank_mask:0xf
    v_add_f32_dpp v33, v33, v33 row_ror:8 row_mask:0xf bank_mask:0xf
    v_add_f32_dpp v30, v30, v30 row_ror:4 row_mask:0xf bank_mask:0xf
    v_add_f32_dpp v31, v31, v31 row_ror:4 row_mask:0xf bank_mask:0xf
    v_add_f32_dpp v32, v32, v32 row_ror:4 row_mask:0xf bank_mask:0xf
    v_add_f32_dpp v33, v33, v33 row_ror:4 row_mask:0xf bank_mask:0xf
    v_add_f32_dpp v30, v30, v30 row_ror:2 row_mask:0xf bank_mask:0xf
    v_add_f32_dpp v31, v31, v31 row_ror:2 row_mask:0xf bank_mask:0xf
    v_add_f32_dpp v32, v32, v32 row_ror:2 row_mask:0xf bank_mask:0xf
    v_add_f32_dpp v33, v33, v33 row_ror:2 row_mask:0xf bank_mask:0xf
    v_add_f32_dpp v30, v30, v30 row_ror:1 row_mask:0xf bank_mask:0xf
    v_add_f32_dpp v31, v31, v31 row_ror:1 row_mask:0xf bank_mask:0xf
    v_add_f32_dpp v32, v32, v32 row_ror:1 row_mask:0xf bank_mask:0xf
    v_add_f32_dpp v33, v33, v33 row_ror:1 row_mask:0xf bank_mask:0xf
    s_waitcnt vmcnt(0)
    buffer_load_dwordx4 v[50:53], v6, s[48:51], s61 offen offset:0 nt
    buffer_load_dwordx4 v[54:57], v6, s[48:51], s61 offen offset:1024 nt
    buffer_load_dwordx4 v[58:61], v6, s[48:51], s61 offen offset:2048 nt
    buffer_load_dwordx4 v[62:65], v6, s[48:51], s61 offen offset:3072 nt
    s_add_u32 s61, s61, 45056
    v_add_f32 v8, s62, v8
    v_add_f32 v9, s62, v9
    v_add_f32 v10, s62, v10
    v_add_f32 v11, s62, v11
    v_add_f32 v12, s62, v12
    v_add_f32 v13, s62, v13
    v_max3_f32 v160, v8, v9, v10
    v_max3_f32 v160, v160, v11, v12
    v_max3_f32 v160, v160, v13, v14
    v_max3_f32 v160, v160, v15, v16
    v_max3_f32 v160, v160, v17, v18
    v_max3_f32 v160, v160, v19, v20
    v_max3_f32 v160, v160, v21, v22
    v_max3_f32 v160, v160, v23, v24
    v_max3_f32 v160, v160, v25, v26
    v_max3_f32 v160, v160, v27, v28
    v_max3_f32 v160, v160, v29, v30
    v_max3_f32 v160, v160, v31, v32
    v_max_f32 v160, v160, v33
    v_mov_b32 v161, v160
    s_nop 1
    v_permlane32_swap_b32 v160, v161
    v_max_f32 v160, v160, v161
    v_mov_b32 v161, v160
    s_nop 1
    v_permlane16_swap_b32 v160, v161
    v_max_f32 v160, v160, v161
    v_mul_f32 v160, s64, v160
    v_fma_f32 v8, v8, s64, -v160
    v_fma_f32 v9, v9, s64, -v160
    v_fma_f32 v10, v10, s64, -v160
    v_fma_f32 v11, v11, s64, -v160
    v_fma_f32 v12, v12, s64, -v160
    v_fma_f32 v13, v13, s64, -v160
    v_fma_f32 v14, v14, s64, -v160
    v_fma_f32 v15, v15, s64, -v160
    v_fma_f32 v16, v16, s64, -v160
    v_fma_f32 v17, v17, s64, -v160
    v_fma_f32 v18, v18, s64, -v160
    v_fma_f32 v19, v19, s64, -v160
    v_fma_f32 v20, v20, s64, -v160
    v_fma_f32 v21, v21, s64, -v160
    v_fma_f32 v22, v22, s64, -v160
    v_fma_f32 v23, v23, s64, -v160
    v_fma_f32 v24, v24, s64, -v160
    v_fma_f32 v25, v25, s64, -v160
    v_fma_f32 v26, v26, s64, -v160
    v_fma_f32 v27, v27, s64, -v160
    v_fma_f32 v28, v28, s64, -v160
    v_fma_f32 v29, v29, s64, -v160
    v_fma_f32 v30, v30, s64, -v160
    v_fma_f32 v31, v31, s64, -v160
    v_fma_f32 v32, v32, s64, -v160
    v_fma_f32 v33, v33, s64, -v160
    v_exp_f32 v8, v8
    v_exp_f32 v9, v9
    v_exp_f32 v10, v10
    v_exp_f32 v11, v11
    v_exp_f32 v12, v12
    v_exp_f32 v13, v13
    v_exp_f32 v14, v14
    v_exp_f32 v15, v15
    v_exp_f32 v16, v16
    v_exp_f32 v17, v17
    v_exp_f32 v18, v18
    v_exp_f32 v19, v19
    v_exp_f32 v20, v20
    v_exp_f32 v21, v21
    v_exp_f32 v22, v22
    v_exp_f32 v23, v23
    v_exp_f32 v24, v24
    v_exp_f32 v25, v25
    v_exp_f32 v26, v26
    v_exp_f32 v27, v27
    v_exp_f32 v28, v28
    v_exp_f32 v29, v29
    v_exp_f32 v30, v30
    v_exp_f32 v31, v31
    v_exp_f32 v32, v32
    v_exp_f32 v33, v33
    v_add_f32 v162, v8, v9
    v_add_f32 v163, v10, v11
    v_add_f32 v162, v162, v12
    v_add_f32 v163, v163, v13
    v_add_f32 v162, v162, v14
    v_add_f32 v163, v163, v15
    v_add_f32 v162, v162, v16
    v_add_f32 v163, v163, v17
    v_add_f32 v162, v162, v18
    v_add_f32 v163, v163, v19
    v_add_f32 v162, v162, v20
    v_add_f32 v163, v163, v21
    v_add_f32 v162, v162, v22
    v_add_f32 v163, v163, v23
    v_add_f32 v162, v162, v24
    v_add_f32 v163, v163, v25
    v_add_f32 v162, v162, v26
    v_add_f32 v163, v163, v27
    v_add_f32 v162, v162, v28
    v_add_f32 v163, v163, v29
    v_add_f32 v162, v162, v30
    v_add_f32 v163, v163, v31
    v_add_f32 v162, v162, v32
    v_add_f32 v163, v163, v33
    v_add_f32 v162, v162, v163
    v_mov_b32 v163, v162
    s_nop 1
    v_permlane32_swap_b32 v162, v163
    v_add_f32 v162, v162, v163
    v_mov_b32 v163, v162
    s_nop 1
    v_permlane16_swap_b32 v162, v163
    v_add_f32 v161, v162, v163
    s_lshl_b32 s7, s3, 3
    s_add_u32 s7, s7, 0x24200
    v_mov_b32 v164, s7
    ds_write_b64 v164, v[160:161]
    v_mov_b32 v164, 0x24008
    v_mov_b32 v165, 1
    s_waitcnt lgkmcnt(0)
    s_mov_b64 exec, 1
    ds_add_u32 v164, v165
    s_mov_b64 exec, -1
    v_and_b32 v2, 15, v1
    v_lshlrev_b32 v2, 5, v2
    v_bfe_u32 v3, v1, 5, 1
    v_lshl_add_u32 v2, v3, 4, v2
    v_bfe_u32 v3, v1, 4, 1
    v_lshl_add_u32 v2, v3, 3, v2
    s_lshl_b32 s7, s3, 9
    s_add_u32 s7, s7, 0x25000
    v_add_u32 v2, s7, v2
    s_waitcnt vmcnt(0)
    buffer_load_dwordx4 v[66:69], v6, s[48:51], s61 offen offset:0 nt
    buffer_load_dwordx4 v[70:73], v6, s[48:51], s61 offen offset:1024 nt
    buffer_load_dwordx4 v[74:77], v6, s[48:51], s61 offen offset:2048 nt
    buffer_load_dwordx4 v[78:81], v6, s[48:51], s61 offen offset:3072 nt
    s_add_u32 s61, s61, 45056
    v_lshlrev_b32 v160, 16, v34
    v_and_b32 v161, 0xffff0000, v34
    v_lshlrev_b32 v162, 16, v35
    v_and_b32 v163, 0xffff0000, v35
    v_lshlrev_b32 v164, 16, v36
    v_and_b32 v165, 0xffff0000, v36
    v_lshlrev_b32 v166, 16, v37
    v_and_b32 v167, 0xffff0000, v37
    v_pk_mul_f32 v[152:153], v[160:161], v[14:15] op_sel_hi:[1,0]
    v_pk_mul_f32 v[154:155], v[162:163], v[14:15] op_sel_hi:[1,0]
    v_pk_mul_f32 v[156:157], v[164:165], v[14:15] op_sel_hi:[1,0]
    v_pk_mul_f32 v[158:159], v[166:167], v[14:15] op_sel_hi:[1,0]
    v_lshlrev_b32 v160, 16, v38
    v_and_b32 v161, 0xffff0000, v38
    v_lshlrev_b32 v162, 16, v39
    v_and_b32 v163, 0xffff0000, v39
    v_lshlrev_b32 v164, 16, v40
    v_and_b32 v165, 0xffff0000, v40
    v_lshlrev_b32 v166, 16, v41
    v_and_b32 v167, 0xffff0000, v41
    v_pk_fma_f32 v[152:153], v[160:161], v[14:15], v[152:153] op_sel:[0,1,0] op_sel_hi:[1,1,1]
    v_pk_fma_f32 v[154:155], v[162:163], v[14:15], v[154:155] op_sel:[0,1,0] op_sel_hi:[1,1,1]
    v_pk_fma_f32 v[156:157], v[164:165], v[14:15], v[156:157] op_sel:[0,1,0] op_sel_hi:[1,1,1]
    v_pk_fma_f32 v[158:159], v[166:167], v[14:15], v[158:159] op_sel:[0,1,0] op_sel_hi:[1,1,1]
    v_lshlrev_b32 v160, 16, v42
    v_and_b32 v161, 0xffff0000, v42
    v_lshlrev_b32 v162, 16, v43
    v_and_b32 v163, 0xffff0000, v43
    v_lshlrev_b32 v164, 16, v44
    v_and_b32 v165, 0xffff0000, v44
    v_lshlrev_b32 v166, 16, v45
    v_and_b32 v167, 0xffff0000, v45
    v_pk_fma_f32 v[152:153], v[160:161], v[16:17], v[152:153] op_sel_hi:[1,0,1]
    v_pk_fma_f32 v[154:155], v[162:163], v[16:17], v[154:155] op_sel_hi:[1,0,1]
    v_pk_fma_f32 v[156:157], v[164:165], v[16:17], v[156:157] op_sel_hi:[1,0,1]
    v_pk_fma_f32 v[158:159], v[166:167], v[16:17], v[158:159] op_sel_hi:[1,0,1]
    v_lshlrev_b32 v160, 16, v46
    v_and_b32 v161, 0xffff0000, v46
    v_lshlrev_b32 v162, 16, v47
    v_and_b32 v163, 0xffff0000, v47
    v_lshlrev_b32 v164, 16, v48
    v_and_b32 v165, 0xffff0000, v48
    v_lshlrev_b32 v166, 16, v49
    v_and_b32 v167, 0xffff0000, v49
    v_pk_fma_f32 v[152:153], v[160:161], v[16:17], v[152:153] op_sel:[0,1,0] op_sel_hi:[1,1,1]
    v_pk_fma_f32 v[154:155], v[162:163], v[16:17], v[154:155] op_sel:[0,1,0] op_sel_hi:[1,1,1]
    v_pk_fma_f32 v[156:157], v[164:165], v[16:17], v[156:157] op_sel:[0,1,0] op_sel_hi:[1,1,1]
    v_pk_fma_f32 v[158:159], v[166:167], v[16:17], v[158:159] op_sel:[0,1,0] op_sel_hi:[1,1,1]
    v_lshlrev_b32 v160, 16, v50
    v_and_b32 v161, 0xffff0000, v50
    v_lshlrev_b32 v162, 16, v51
    v_and_b32 v163, 0xffff0000, v51
    v_lshlrev_b32 v164, 16, v52
    v_and_b32 v165, 0xffff0000, v52
    v_lshlrev_b32 v166, 16, v53
    v_and_b32 v167, 0xffff0000, v53
    v_pk_fma_f32 v[152:153], v[160:161], v[18:19], v[152:153] op_sel_hi:[1,0,1]
    v_pk_fma_f32 v[154:155], v[162:163], v[18:19], v[154:155] op_sel_hi:[1,0,1]
    v_pk_fma_f32 v[156:157], v[164:165], v[18:19], v[156:157] op_sel_hi:[1,0,1]
    v_pk_fma_f32 v[158:159], v[166:167], v[18:19], v[158:159] op_sel_hi:[1,0,1]
    v_lshlrev_b32 v160, 16, v54
    v_and_b32 v161, 0xffff0000, v54
    v_lshlrev_b32 v162, 16, v55
    v_and_b32 v163, 0xffff0000, v55
    v_lshlrev_b32 v164, 16, v56
    v_and_b32 v165, 0xffff0000, v56
    v_lshlrev_b32 v166, 16, v57
    v_and_b32 v167, 0xffff0000, v57
    v_pk_fma_f32 v[152:153], v[160:161], v[18:19], v[152:153] op_sel:[0,1,0] op_sel_hi:[1,1,1]
    v_pk_fma_f32 v[154:155], v[162:163], v[18:19], v[154:155] op_sel:[0,1,0] op_sel_hi:[1,1,1]
    v_pk_fma_f32 v[156:157], v[164:165], v[18:19], v[156:157] op_sel:[0,1,0] op_sel_hi:[1,1,1]
    v_pk_fma_f32 v[158:159], v[166:167], v[18:19], v[158:159] op_sel:[0,1,0] op_sel_hi:[1,1,1]
    v_lshlrev_b32 v160, 16, v58
    v_and_b32 v161, 0xffff0000, v58
    v_lshlrev_b32 v162, 16, v59
    v_and_b32 v163, 0xffff0000, v59
    v_lshlrev_b32 v164, 16, v60
    v_and_b32 v165, 0xffff0000, v60
    v_lshlrev_b32 v166, 16, v61
    v_and_b32 v167, 0xffff0000, v61
    v_pk_fma_f32 v[152:153], v[160:161], v[20:21], v[152:153] op_sel_hi:[1,0,1]
    v_pk_fma_f32 v[154:155], v[162:163], v[20:21], v[154:155] op_sel_hi:[1,0,1]
    v_pk_fma_f32 v[156:157], v[164:165], v[20:21], v[156:157] op_sel_hi:[1,0,1]
    v_pk_fma_f32 v[158:159], v[166:167], v[20:21], v[158:159] op_sel_hi:[1,0,1]
    v_lshlrev_b32 v160, 16, v62
    v_and_b32 v161, 0xffff0000, v62
    v_lshlrev_b32 v162, 16, v63
    v_and_b32 v163, 0xffff0000, v63
    v_lshlrev_b32 v164, 16, v64
    v_and_b32 v165, 0xffff0000, v64
    v_lshlrev_b32 v166, 16, v65
    v_and_b32 v167, 0xffff0000, v65
    v_pk_fma_f32 v[152:153], v[160:161], v[20:21], v[152:153] op_sel:[0,1,0] op_sel_hi:[1,1,1]
    v_pk_fma_f32 v[154:155], v[162:163], v[20:21], v[154:155] op_sel:[0,1,0] op_sel_hi:[1,1,1]
    v_pk_fma_f32 v[156:157], v[164:165], v[20:21], v[156:157] op_sel:[0,1,0] op_sel_hi:[1,1,1]
    v_pk_fma_f32 v[158:159], v[166:167], v[20:21], v[158:159] op_sel:[0,1,0] op_sel_hi:[1,1,1]
    s_waitcnt vmcnt(0)
    buffer_load_dwordx4 v[82:85], v6, s[48:51], s61 offen offset:0 nt
    buffer_load_dwordx4 v[86:89], v6, s[48:51], s61 offen offset:1024 nt
    buffer_load_dwordx4 v[90:93], v6, s[48:51], s61 offen offset:2048 nt
    buffer_load_dwordx4 v[94:97], v6, s[48:51], s61 offen offset:3072 nt
    s_add_u32 s61, s61, 45056
    v_lshlrev_b32 v160, 16, v66
    v_and_b32 v161, 0xffff0000, v66
    v_lshlrev_b32 v162, 16, v67
    v_and_b32 v163, 0xffff0000, v67
    v_lshlrev_b32 v164, 16, v68
    v_and_b32 v165, 0xffff0000, v68
    v_lshlrev_b32 v166, 16, v69
    v_and_b32 v167, 0xffff0000, v69
    v_pk_fma_f32 v[152:153], v[160:161], v[22:23], v[152:153] op_sel_hi:[1,0,1]
    v_pk_fma_f32 v[154:155], v[162:163], v[22:23], v[154:155] op_sel_hi:[1,0,1]
    v_pk_fma_f32 v[156:157], v[164:165], v[22:23], v[156:157] op_sel_hi:[1,0,1]
    v_pk_fma_f32 v[158:159], v[166:167], v[22:23], v[158:159] op_sel_hi:[1,0,1]
    v_lshlrev_b32 v160, 16, v70
    v_and_b32 v161, 0xffff0000, v70
    v_lshlrev_b32 v162, 16, v71
    v_and_b32 v163, 0xffff0000, v71
    v_lshlrev_b32 v164, 16, v72
    v_and_b32 v165, 0xffff0000, v72
    v_lshlrev_b32 v166, 16, v73
    v_and_b32 v167, 0xffff0000, v73
    v_pk_fma_f32 v[152:153], v[160:161], v[22:23], v[152:153] op_sel:[0,1,0] op_sel_hi:[1,1,1]
    v_pk_fma_f32 v[154:155], v[162:163], v[22:23], v[154:155] op_sel:[0,1,0] op_sel_hi:[1,1,1]
    v_pk_fma_f32 v[156:157], v[164:165], v[22:23], v[156:157] op_sel:[0,1,0] op_sel_hi:[1,1,1]
    v_pk_fma_f32 v[158:159], v[166:167], v[22:23], v[158:159] op_sel:[0,1,0] op_sel_hi:[1,1,1]
    v_lshlrev_b32 v160, 16, v74
    v_and_b32 v161, 0xffff0000, v74
    v_lshlrev_b32 v162, 16, v75
    v_and_b32 v163, 0xffff0000, v75
    v_lshlrev_b32 v164, 16, v76
    v_and_b32 v165, 0xffff0000, v76
    v_lshlrev_b32 v166, 16, v77
    v_and_b32 v167, 0xffff0000, v77
    v_pk_fma_f32 v[152:153], v[160:161], v[24:25], v[152:153] op_sel_hi:[1,0,1]
    v_pk_fma_f32 v[154:155], v[162:163], v[24:25], v[154:155] op_sel_hi:[1,0,1]
    v_pk_fma_f32 v[156:157], v[164:165], v[24:25], v[156:157] op_sel_hi:[1,0,1]
    v_pk_fma_f32 v[158:159], v[166:167], v[24:25], v[158:159] op_sel_hi:[1,0,1]
    v_lshlrev_b32 v160, 16, v78
    v_and_b32 v161, 0xffff0000, v78
    v_lshlrev_b32 v162, 16, v79
    v_and_b32 v163, 0xffff0000, v79
    v_lshlrev_b32 v164, 16, v80
    v_and_b32 v165, 0xffff0000, v80
    v_lshlrev_b32 v166, 16, v81
    v_and_b32 v167, 0xffff0000, v81
    v_pk_fma_f32 v[152:153], v[160:161], v[24:25], v[152:153] op_sel:[0,1,0] op_sel_hi:[1,1,1]
    v_pk_fma_f32 v[154:155], v[162:163], v[24:25], v[154:155] op_sel:[0,1,0] op_sel_hi:[1,1,1]
    v_pk_fma_f32 v[156:157], v[164:165], v[24:25], v[156:157] op_sel:[0,1,0] op_sel_hi:[1,1,1]
    v_pk_fma_f32 v[158:159], v[166:167], v[24:25], v[158:159] op_sel:[0,1,0] op_sel_hi:[1,1,1]
    s_waitcnt vmcnt(0)
    buffer_load_dwordx4 v[98:101], v6, s[48:51], s61 offen offset:0 nt
    buffer_load_dwordx4 v[102:105], v6, s[48:51], s61 offen offset:1024 nt
    buffer_load_dwordx4 v[106:109], v6, s[48:51], s61 offen offset:2048 nt
    buffer_load_dwordx4 v[110:113], v6, s[48:51], s61 offen offset:3072 nt
    s_add_u32 s61, s61, 45056
    v_lshlrev_b32 v160, 16, v82
    v_and_b32 v161, 0xffff0000, v82
    v_lshlrev_b32 v162, 16, v83
    v_and_b32 v163, 0xffff0000, v83
    v_lshlrev_b32 v164, 16, v84
    v_and_b32 v165, 0xffff0000, v84
    v_lshlrev_b32 v166, 16, v85
    v_and_b32 v167, 0xffff0000, v85
    v_pk_fma_f32 v[152:153], v[160:161], v[26:27], v[152:153] op_sel_hi:[1,0,1]
    v_pk_fma_f32 v[154:155], v[162:163], v[26:27], v[154:155] op_sel_hi:[1,0,1]
    v_pk_fma_f32 v[156:157], v[164:165], v[26:27], v[156:157] op_sel_hi:[1,0,1]
    s_branch LC_AR
.p2align 12
LT_AR2:
    s_branch LR_AR2
LC_AR:
    v_pk_fma_f32 v[158:159], v[166:167], v[26:27], v[158:159] op_sel_hi:[1,0,1]
    v_lshlrev_b32 v160, 16, v86
    v_and_b32 v161, 0xffff0000, v86
    v_lshlrev_b32 v162, 16, v87
    v_and_b32 v163, 0xffff0000, v87
    v_lshlrev_b32 v164, 16, v88
    v_and_b32 v165, 0xffff0000, v88
    v_lshlrev_b32 v166, 16, v89
    v_and_b32 v167, 0xffff0000, v89
    v_pk_fma_f32 v[152:153], v[160:161], v[26:27], v[152:153] op_sel:[0,1,0] op_sel_hi:[1,1,1]
    v_pk_fma_f32 v[154:155], v[162:163], v[26:27], v[154:155] op_sel:[0,1,0] op_sel_hi:[1,1,1]
    v_pk_fma_f32 v[156:157], v[164:165], v[26:27], v[156:157] op_sel:[0,1,0] op_sel_hi:[1,1,1]
    v_pk_fma_f32 v[158:159], v[166:167], v[26:27], v[158:159] op_sel:[0,1,0] op_sel_hi:[1,1,1]
    v_lshlrev_b32 v160, 16, v90
    v_and_b32 v161, 0xffff0000, v90
    v_lshlrev_b32 v162, 16, v91
    v_and_b32 v163, 0xffff0000, v91
    v_lshlrev_b32 v164, 16, v92
    v_and_b32 v165, 0xffff0000, v92
    v_lshlrev_b32 v166, 16, v93
    v_and_b32 v167, 0xffff0000, v93
    v_pk_fma_f32 v[152:153], v[160:161], v[28:29], v[152:153] op_sel_hi:[1,0,1]
    v_pk_fma_f32 v[154:155], v[162:163], v[28:29], v[154:155] op_sel_hi:[1,0,1]
    v_pk_fma_f32 v[156:157], v[164:165], v[28:29], v[156:157] op_sel_hi:[1,0,1]
    v_pk_fma_f32 v[158:159], v[166:167], v[28:29], v[158:159] op_sel_hi:[1,0,1]
    v_lshlrev_b32 v160, 16, v94
    v_and_b32 v161, 0xffff0000, v94
    v_lshlrev_b32 v162, 16, v95
    v_and_b32 v163, 0xffff0000, v95
    v_lshlrev_b32 v164, 16, v96
    v_and_b32 v165, 0xffff0000, v96
    v_lshlrev_b32 v166, 16, v97
    v_and_b32 v167, 0xffff0000, v97
    v_pk_fma_f32 v[152:153], v[160:161], v[28:29], v[152:153] op_sel:[0,1,0] op_sel_hi:[1,1,1]
    v_pk_fma_f32 v[154:155], v[162:163], v[28:29], v[154:155] op_sel:[0,1,0] op_sel_hi:[1,1,1]
    v_pk_fma_f32 v[156:157], v[164:165], v[28:29], v[156:157] op_sel:[0,1,0] op_sel_hi:[1,1,1]
    v_pk_fma_f32 v[158:159], v[166:167], v[28:29], v[158:159] op_sel:[0,1,0] op_sel_hi:[1,1,1]
    s_cmp_eq_u32 s62, 0
    s_cbranch_scc1 AL_13
    s_waitcnt vmcnt(3)
    v_lshlrev_b32 v160, 16, v98
    v_and_b32 v161, 0xffff0000, v98
    v_lshlrev_b32 v162, 16, v99
    v_and_b32 v163, 0xffff0000, v99
    v_lshlrev_b32 v164, 16, v100
    v_and_b32 v165, 0xffff0000, v100
    v_lshlrev_b32 v166, 16, v101
    v_and_b32 v167, 0xffff0000, v101
    v_pk_fma_f32 v[152:153], v[160:161], v[30:31], v[152:153] op_sel_hi:[1,0,1]
    v_pk_fma_f32 v[154:155], v[162:163], v[30:31], v[154:155] op_sel_hi:[1,0,1]
    v_pk_fma_f32 v[156:157], v[164:165], v[30:31], v[156:157] op_sel_hi:[1,0,1]
    v_pk_fma_f32 v[158:159], v[166:167], v[30:31], v[158:159] op_sel_hi:[1,0,1]
    s_waitcnt vmcnt(2)
    v_lshlrev_b32 v160, 16, v102
    v_and_b32 v161, 0xffff0000, v102
    v_lshlrev_b32 v162, 16, v103
    v_and_b32 v163, 0xffff0000, v103
    v_lshlrev_b32 v164, 16, v104
    v_and_b32 v165, 0xffff0000, v104
    v_lshlrev_b32 v166, 16, v105
    v_and_b32 v167, 0xffff0000, v105
    v_pk_fma_f32 v[152:153], v[160:161], v[30:31], v[152:153] op_sel:[0,1,0] op_sel_hi:[1,1,1]
    v_pk_fma_f32 v[154:155], v[162:163], v[30:31], v[154:155] op_sel:[0,1,0] op_sel_hi:[1,1,1]
    v_pk_fma_f32 v[156:157], v[164:165], v[30:31], v[156:157] op_sel:[0,1,0] op_sel_hi:[1,1,1]
    v_pk_fma_f32 v[158:159], v[166:167], v[30:31], v[158:159] op_sel:[0,1,0] op_sel_hi:[1,1,1]
    s_waitcnt vmcnt(1)
    v_lshlrev_b32 v160, 16, v106
    v_and_b32 v161, 0xffff0000, v106
    v_lshlrev_b32 v162, 16, v107
    v_and_b32 v163, 0xffff0000, v107
    v_lshlrev_b32 v164, 16, v108
    v_and_b32 v165, 0xffff0000, v108
    v_lshlrev_b32 v166, 16, v109
    v_and_b32 v167, 0xffff0000, v109
    v_pk_fma_f32 v[152:153], v[160:161], v[32:33], v[152:153] op_sel_hi:[1,0,1]
    v_pk_fma_f32 v[154:155], v[162:163], v[32:33], v[154:155] op_sel_hi:[1,0,1]
    v_pk_fma_f32 v[156:157], v[164:165], v[32:33], v[156:157] op_sel_hi:[1,0,1]
    v_pk_fma_f32 v[158:159], v[166:167], v[32:33], v[158:159] op_sel_hi:[1,0,1]
    s_waitcnt vmcnt(0)
    v_lshlrev_b32 v160, 16, v110
    v_and_b32 v161, 0xffff0000, v110
    v_lshlrev_b32 v162, 16, v111
    v_and_b32 v163, 0xffff0000, v111
    v_lshlrev_b32 v164, 16, v112
    v_and_b32 v165, 0xffff0000, v112
    v_lshlrev_b32 v166, 16, v113
    v_and_b32 v167, 0xffff0000, v113
    v_pk_fma_f32 v[152:153], v[160:161], v[32:33], v[152:153] op_sel:[0,1,0] op_sel_hi:[1,1,1]
    v_pk_fma_f32 v[154:155], v[162:163], v[32:33], v[154:155] op_sel:[0,1,0] op_sel_hi:[1,1,1]
    v_pk_fma_f32 v[156:157], v[164:165], v[32:33], v[156:157] op_sel:[0,1,0] op_sel_hi:[1,1,1]
    v_pk_fma_f32 v[158:159], v[166:167], v[32:33], v[158:159] op_sel:[0,1,0] op_sel_hi:[1,1,1]
    s_branch L_AFIN
AL_13:
    s_waitcnt vmcnt(0)
    buffer_load_dwordx4 v[114:117], v6, s[48:51], s63 offen offset:0 nt
    buffer_load_dwordx4 v[118:121], v6, s[48:51], s63 offen offset:1024 nt
    buffer_load_dwordx4 v[122:125], v6, s[48:51], s63 offen offset:2048 nt
    buffer_load_dwordx4 v[126:129], v6, s[48:51], s63 offen offset:3072 nt
    buffer_load_dwordx4 v[130:133], v6, s[48:51], s65 offen offset:0 nt
    buffer_load_dwordx4 v[134:137], v6, s[48:51], s65 offen offset:1024 nt
    v_lshlrev_b32 v160, 16, v98
    v_and_b32 v161, 0xffff0000, v98
    v_lshlrev_b32 v162, 16, v99
    v_and_b32 v163, 0xffff0000, v99
    v_lshlrev_b32 v164, 16, v100
    v_and_b32 v165, 0xffff0000, v100
    v_lshlrev_b32 v166, 16, v101
    v_and_b32 v167, 0xffff0000, v101
    v_pk_fma_f32 v[152:153], v[160:161], v[30:31], v[152:153] op_sel_hi:[1,0,1]
    v_pk_fma_f32 v[154:155], v[162:163], v[30:31], v[154:155] op_sel_hi:[1,0,1]
    v_pk_fma_f32 v[156:157], v[164:165], v[30:31], v[156:157] op_sel_hi:[1,0,1]
    v_pk_fma_f32 v[158:159], v[166:167], v[30:31], v[158:159] op_sel_hi:[1,0,1]
    v_lshlrev_b32 v160, 16, v102
    v_and_b32 v161, 0xffff0000, v102
    v_lshlrev_b32 v162, 16, v103
    v_and_b32 v163, 0xffff0000, v103
    v_lshlrev_b32 v164, 16, v104
    v_and_b32 v165, 0xffff0000, v104
    v_lshlrev_b32 v166, 16, v105
    v_and_b32 v167, 0xffff0000, v105
    v_pk_fma_f32 v[152:153], v[160:161], v[30:31], v[152:153] op_sel:[0,1,0] op_sel_hi:[1,1,1]
    v_pk_fma_f32 v[154:155], v[162:163], v[30:31], v[154:155] op_sel:[0,1,0] op_sel_hi:[1,1,1]
    v_pk_fma_f32 v[156:157], v[164:165], v[30:31], v[156:157] op_sel:[0,1,0] op_sel_hi:[1,1,1]
    v_pk_fma_f32 v[158:159], v[166:167], v[30:31], v[158:159] op_sel:[0,1,0] op_sel_hi:[1,1,1]
    v_lshlrev_b32 v160, 16, v106
    v_and_b32 v161, 0xffff0000, v106
    v_lshlrev_b32 v162, 16, v107
    v_and_b32 v163, 0xffff0000, v107
    v_lshlrev_b32 v164, 16, v108
    v_and_b32 v165, 0xffff0000, v108
    v_lshlrev_b32 v166, 16, v109
    v_and_b32 v167, 0xffff0000, v109
    v_pk_fma_f32 v[152:153], v[160:161], v[32:33], v[152:153] op_sel_hi:[1,0,1]
    v_pk_fma_f32 v[154:155], v[162:163], v[32:33], v[154:155] op_sel_hi:[1,0,1]
    v_pk_fma_f32 v[156:157], v[164:165], v[32:33], v[156:157] op_sel_hi:[1,0,1]
    v_pk_fma_f32 v[158:159], v[166:167], v[32:33], v[158:159] op_sel_hi:[1,0,1]
    v_lshlrev_b32 v160, 16, v110
    v_and_b32 v161, 0xffff0000, v110
    v_lshlrev_b32 v162, 16, v111
    v_and_b32 v163, 0xffff0000, v111
    v_lshlrev_b32 v164, 16, v112
    v_and_b32 v165, 0xffff0000, v112
    v_lshlrev_b32 v166, 16, v113
    v_and_b32 v167, 0xffff0000, v113
    v_pk_fma_f32 v[152:153], v[160:161], v[32:33], v[152:153] op_sel:[0,1,0] op_sel_hi:[1,1,1]
    v_pk_fma_f32 v[154:155], v[162:163], v[32:33], v[154:155] op_sel:[0,1,0] op_sel_hi:[1,1,1]
    v_pk_fma_f32 v[156:157], v[164:165], v[32:33], v[156:157] op_sel:[0,1,0] op_sel_hi:[1,1,1]
    v_pk_fma_f32 v[158:159], v[166:167], v[32:33], v[158:159] op_sel:[0,1,0] op_sel_hi:[1,1,1]
    s_waitcnt vmcnt(5)
    v_lshlrev_b32 v160, 16, v114
    v_and_b32 v161, 0xffff0000, v114
    v_lshlrev_b32 v162, 16, v115
    v_and_b32 v163, 0xffff0000, v115
    v_lshlrev_b32 v164, 16, v116
    v_and_b32 v165, 0xffff0000, v116
    v_lshlrev_b32 v166, 16, v117
    v_and_b32 v167, 0xffff0000, v117
    v_pk_fma_f32 v[152:153], v[160:161], v[8:9], v[152:153] op_sel_hi:[1,0,1]
    v_pk_fma_f32 v[154:155], v[162:163], v[8:9], v[154:155] op_sel_hi:[1,0,1]
    v_pk_fma_f32 v[156:157], v[164:165], v[8:9], v[156:157] op_sel_hi:[1,0,1]
    v_pk_fma_f32 v[158:159], v[166:167], v[8:9], v[158:159] op_sel_hi:[1,0,1]
    s_waitcnt vmcnt(4)
    v_lshlrev_b32 v160, 16, v118
    v_and_b32 v161, 0xffff0000, v118
    v_lshlrev_b32 v162, 16, v119
    v_and_b32 v163, 0xffff0000, v119
    v_lshlrev_b32 v164, 16, v120
    v_and_b32 v165, 0xffff0000, v120
    v_lshlrev_b32 v166, 16, v121
    v_and_b32 v167, 0xffff0000, v121
    v_pk_fma_f32 v[152:153], v[160:161], v[8:9], v[152:153] op_sel:[0,1,0] op_sel_hi:[1,1,1]
    v_pk_fma_f32 v[154:155], v[162:163], v[8:9], v[154:155] op_sel:[0,1,0] op_sel_hi:[1,1,1]
    v_pk_fma_f32 v[156:157], v[164:165], v[8:9], v[156:157] op_sel:[0,1,0] op_sel_hi:[1,1,1]
    v_pk_fma_f32 v[158:159], v[166:167], v[8:9], v[158:159] op_sel:[0,1,0] op_sel_hi:[1,1,1]
    s_waitcnt vmcnt(3)
    v_lshlrev_b32 v160, 16, v122
    v_and_b32 v161, 0xffff0000, v122
    v_lshlrev_b32 v162, 16, v123
    v_and_b32 v163, 0xffff0000, v123
    v_lshlrev_b32 v164, 16, v124
    v_and_b32 v165, 0xffff0000, v124
    v_lshlrev_b32 v166, 16, v125
    v_and_b32 v167, 0xffff0000, v125
    v_pk_fma_f32 v[152:153], v[160:161], v[10:11], v[152:153] op_sel_hi:[1,0,1]
    v_pk_fma_f32 v[154:155], v[162:163], v[10:11], v[154:155] op_sel_hi:[1,0,1]
    v_pk_fma_f32 v[156:157], v[164:165], v[10:11], v[156:157] op_sel_hi:[1,0,1]
    v_pk_fma_f32 v[158:159], v[166:167], v[10:11], v[158:159] op_sel_hi:[1,0,1]
    s_waitcnt vmcnt(2)
    v_lshlrev_b32 v160, 16, v126
    v_and_b32 v161, 0xffff0000, v126
    v_lshlrev_b32 v162, 16, v127
    v_and_b32 v163, 0xffff0000, v127
    v_lshlrev_b32 v164, 16, v128
    v_and_b32 v165, 0xffff0000, v128
    v_lshlrev_b32 v166, 16, v129
    v_and_b32 v167, 0xffff0000, v129
    v_pk_fma_f32 v[152:153], v[160:161], v[10:11], v[152:153] op_sel:[0,1,0] op_sel_hi:[1,1,1]
    v_pk_fma_f32 v[154:155], v[162:163], v[10:11], v[154:155] op_sel:[0,1,0] op_sel_hi:[1,1,1]
    v_pk_fma_f32 v[156:157], v[164:165], v[10:11], v[156:157] op_sel:[0,1,0] op_sel_hi:[1,1,1]
    v_pk_fma_f32 v[158:159], v[166:167], v[10:11], v[158:159] op_sel:[0,1,0] op_sel_hi:[1,1,1]
    s_waitcnt vmcnt(1)
    v_lshlrev_b32 v160, 16, v130
    v_and_b32 v161, 0xffff0000, v130
    v_lshlrev_b32 v162, 16, v131
    v_and_b32 v163, 0xffff0000, v131
    v_lshlrev_b32 v164, 16, v132
    v_and_b32 v165, 0xffff0000, v132
    v_lshlrev_b32 v166, 16, v133
    v_and_b32 v167, 0xffff0000, v133
    v_pk_fma_f32 v[152:153], v[160:161], v[12:13], v[152:153] op_sel_hi:[1,0,1]
    v_pk_fma_f32 v[154:155], v[162:163], v[12:13], v[154:155] op_sel_hi:[1,0,1]
    v_pk_fma_f32 v[156:157], v[164:165], v[12:13], v[156:157] op_sel_hi:[1,0,1]
    v_pk_fma_f32 v[158:159], v[166:167], v[12:13], v[158:159] op_sel_hi:[1,0,1]
    s_waitcnt vmcnt(0)
    v_lshlrev_b32 v160, 16, v134
    v_and_b32 v161, 0xffff0000, v134
    v_lshlrev_b32 v162, 16, v135
    v_and_b32 v163, 0xffff0000, v135
    v_lshlrev_b32 v164, 16, v136
    v_and_b32 v165, 0xffff0000, v136
    v_lshlrev_b32 v166, 16, v137
    v_and_b32 v167, 0xffff0000, v137
    v_pk_fma_f32 v[152:153], v[160:161], v[12:13], v[152:153] op_sel:[0,1,0] op_sel_hi:[1,1,1]
    v_pk_fma_f32 v[154:155], v[162:163], v[12:13], v[154:155] op_sel:[0,1,0] op_sel_hi:[1,1,1]
    v_pk_fma_f32 v[156:157], v[164:165], v[12:13], v[156:157] op_sel:[0,1,0] op_sel_hi:[1,1,1]
    v_pk_fma_f32 v[158:159], v[166:167], v[12:13], v[158:159] op_sel:[0,1,0] op_sel_hi:[1,1,1]
L_AFIN:
    s_nop 1
    v_permlane32_swap_b32 v152, v156
    v_permlane32_swap_b32 v153, v157
    v_permlane32_swap_b32 v154, v158
    v_permlane32_swap_b32 v155, v159
    v_add_f32 v152, v152, v156
    v_add_f32 v153, v153, v157
    v_add_f32 v154, v154, v158
    v_add_f32 v155, v155, v159
    s_nop 0
    v_permlane16_swap_b32 v152, v154
    v_permlane16_swap_b32 v153, v155
    v_add_f32 v152, v152, v154
    v_add_f32 v153, v153, v155
    ds_write_b64 v2, v[152:153]
    s_waitcnt lgkmcnt(0)
    s_barrier
    s_endpgm
L_ASVC:
    s_cmp_lg_u32 s3, 11
    s_cbranch_scc1 Z_14
    v_lshlrev_b32 v2, 2, v1
    v_add_u32 v2, 0x24000, v2
    v_mov_b32 v3, 0
    ds_write_b32 v2, v3
Z_14:
    s_waitcnt lgkmcnt(0)
    s_mov_b32 s92, 0x05040100
    s_mov_b32 s93, 0x07060302
    s_mov_b32 s36, s34
    s_and_b32 s37, s35, 0xffff
    s_mov_b32 s38, 0x1000000
    s_mov_b32 s39, 0x20000
    s_mov_b32 s40, s32
    s_and_b32 s41, s33, 0xffff
    s_mov_b32 s42, 0x100
    s_mov_b32 s43, 0x20000
    s_setprio 3
    s_lshr_b32 s60, s5, 2
    s_sub_u32 s60, s60, 4
    s_barrier
    s_lshl_b32 s7, s6, 2
    s_add_u32 s7, s7, s60
    s_lshl_b32 s7, s7, 11
    v_lshl_add_u32 v3, v1, 4, s7
    v_add_u32 v5, 0x40000, v3
    v_add_u32 v3, 0x80000, v3
    s_xor_b32 s7, s6, 2
    s_lshl_b32 s7, s7, 5
    s_add_u32 s7, s7, s60
    s_lshl_b32 s7, s7, 8
    s_add_u32 s7, s7, 0x80000
    v_lshrrev_b32 v6, 4, v1
    v_lshlrev_b32 v6, 11, v6
    v_and_b32 v100, 15, v1
    v_lshl_add_u32 v6, v100, 4, v6
    v_add_u32 v6, s7, v6
    s_sleep 8
    v_mov_b32 v90, 0
    s_mov_b32 s80, 200000
    s_mov_b64 exec, 1
    buffer_load_dwordx2 v[94:95], v90, s[40:43], 0 offen sc1
    s_sleep 16
    buffer_load_dwordx2 v[92:93], v90, s[40:43], 0 offen sc1
    s_mov_b64 exec, -1
    v_mov_b32 v96, 0x24000
    v_mov_b32 v97, 1
    s_waitcnt lgkmcnt(0)
    s_mov_b64 exec, 1
    ds_add_u32 v96, v97
    s_mov_b64 exec, -1
    s_waitcnt vmcnt(1)
    v_readfirstlane_b32 s94, v94
    v_readfirstlane_b32 s95, v95
    s_cmp_lg_u32 s95, 0
    s_cbranch_scc1 NGD_16
    s_branch NG2_17
NG_15:
    s_mov_b64 exec, 1
    buffer_load_dwordx2 v[92:93], v90, s[40:43], 0 offen sc1
    s_mov_b64 exec, -1
NG2_17:
    s_waitcnt vmcnt(0)
    v_readfirstlane_b32 s94, v92
    v_readfirstlane_b32 s95, v93
    s_cmp_lg_u32 s95, 0
    s_cbranch_scc1 NGD_16
    s_sleep 4
    s_sub_u32 s80, s80, 1
    s_cmp_lg_u32 s80, 0
    s_cbranch_scc1 NG_15
NGD_16:
    v_lshlrev_b32 v7, 5, v1
    v_mov_b32 v114, s94
    v_mov_b32 v115, s95
    v_mov_b32 v118, s94
    v_mov_b32 v119, s95
    v_mov_b32 v122, s94
    v_mov_b32 v123, s95
    v_mov_b32 v126, s94
    v_mov_b32 v127, s95
    v_mov_b32 v100, 0x24044
    s_mov_b32 s80, 1600000
LW_18:
    ds_read_b32 v101, v100
    s_waitcnt lgkmcnt(0)
    v_readfirstlane_b32 s79, v101
    s_cmp_ge_u32 s79, 4
    s_cbranch_scc1 LWD_19
    s_sub_u32 s80, s80, 1
    s_cmp_lg_u32 s80, 0
    s_cbranch_scc1 LW_18
LWD_19:
    ds_read_b128 v[16:19], v7 offset:0
    ds_read_b128 v[20:23], v7 offset:16
    ds_read_b128 v[24:27], v7 offset:2048
    ds_read_b128 v[28:31], v7 offset:2064
    ds_read_b128 v[32:35], v7 offset:4096
    ds_read_b128 v[36:39], v7 offset:4112
    ds_read_b128 v[40:43], v7 offset:6144
    ds_read_b128 v[44:47], v7 offset:6160
    s_waitcnt lgkmcnt(0)
    v_add_f32 v16, v16, v32
    v_add_f32 v17, v17, v33
    v_add_f32 v18, v18, v34
    v_add_f32 v19, v19, v35
    v_add_f32 v20, v20, v36
    v_add_f32 v21, v21, v37
    v_add_f32 v22, v22, v38
    v_add_f32 v23, v23, v39
    v_add_f32 v24, v24, v40
    v_add_f32 v25, v25, v41
    v_add_f32 v26, v26, v42
    v_add_f32 v27, v27, v43
    v_add_f32 v28, v28, v44
    v_add_f32 v29, v29, v45
    v_add_f32 v30, v30, v46
    v_add_f32 v31, v31, v47
    v_add_f32 v16, v16, v24
    v_add_f32 v17, v17, v25
    v_add_f32 v18, v18, v26
    v_add_f32 v19, v19, v27
    v_add_f32 v20, v20, v28
    v_add_f32 v21, v21, v29
    v_add_f32 v22, v22, v30
    v_add_f32 v23, v23, v31
    v_cvt_pk_bf16_f32 v112, v16, v17
    v_cvt_pk_bf16_f32 v113, v18, v19
    v_cvt_pk_bf16_f32 v116, v20, v21
    v_cvt_pk_bf16_f32 v117, v22, v23
    buffer_store_dwordx4 v[112:115], v5, s[36:39], 0 offen offset:0
    buffer_store_dwordx4 v[116:119], v5, s[36:39], 0 offen offset:1024
    v_mov_b32 v100, 0x24018
    v_mov_b32 v101, 1
    s_waitcnt lgkmcnt(0)
    s_mov_b64 exec, 1
    ds_add_u32 v100, v101
    s_mov_b64 exec, -1
    v_mov_b32 v100, 0x24040
    s_mov_b32 s80, 1600000
LW_20:
    ds_read_b32 v101, v100
    s_waitcnt lgkmcnt(0)
    v_readfirstlane_b32 s79, v101
    s_cmp_ge_u32 s79, 4
    s_cbranch_scc1 LWD_21
    s_sub_u32 s80, s80, 1
    s_cmp_lg_u32 s80, 0
    s_cbranch_scc1 LW_20
LWD_21:
    ds_read_b128 v[16:19], v7 offset:8192
    ds_read_b128 v[20:23], v7 offset:8208
    ds_read_b128 v[24:27], v7 offset:10240
    ds_read_b128 v[28:31], v7 offset:10256
    ds_read_b128 v[32:35], v7 offset:12288
    ds_read_b128 v[36:39], v7 offset:12304
    ds_read_b128 v[40:43], v7 offset:14336
    ds_read_b128 v[44:47], v7 offset:14352
    s_waitcnt lgkmcnt(0)
    v_add_f32 v16, v16, v32
    v_add_f32 v17, v17, v33
    v_add_f32 v18, v18, v34
    v_add_f32 v19, v19, v35
    v_add_f32 v20, v20, v36
    v_add_f32 v21, v21, v37
    v_add_f32 v22, v22, v38
    v_add_f32 v23, v23, v39
    v_add_f32 v24, v24, v40
    v_add_f32 v25, v25, v41
    v_add_f32 v26, v26, v42
    v_add_f32 v27, v27, v43
    v_add_f32 v28, v28, v44
    v_add_f32 v29, v29, v45
    v_add_f32 v30, v30, v46
    v_add_f32 v31, v31, v47
    v_add_f32 v16, v16, v24
    v_add_f32 v17, v17, v25
    v_add_f32 v18, v18, v26
    v_add_f32 v19, v19, v27
    v_add_f32 v20, v20, v28
    v_add_f32 v21, v21, v29
    v_add_f32 v22, v22, v30
    v_add_f32 v23, v23, v31
    v_cvt_pk_bf16_f32 v120, v16, v17
    v_cvt_pk_bf16_f32 v121, v18, v19
    v_cvt_pk_bf16_f32 v124, v20, v21
    v_cvt_pk_bf16_f32 v125, v22, v23
    buffer_store_dwordx4 v[120:123], v6, s[36:39], 0 offen offset:0
    buffer_store_dwordx4 v[124:127], v6, s[36:39], 0 offen offset:1024
    v_mov_b32 v100, 0x24018
    v_mov_b32 v101, 1
    s_waitcnt lgkmcnt(0)
    s_mov_b64 exec, 1
    ds_add_u32 v100, v101
    s_mov_b64 exec, -1
    v_mov_b32 v110, v5
    v_mov_b32 v111, v6
    s_getreg_b32 s96, hwreg(HW_REG_XCC_ID, 0, 4)
    s_lshl_b32 s7, s4, 5
    s_add_u32 s7, s7, s5
    s_lshl_b32 s7, s7, 4
    s_add_u32 s7, s7, 0xc0000
    v_mov_b32 v100, s7
    v_mov_b32 v102, s96
    v_mov_b32 v103, 0
    v_mov_b32 v104, s94
    v_mov_b32 v105, s95
    s_mov_b64 exec, 1
    buffer_store_dwordx4 v[102:105], v100, s[36:39], 0 offen
    s_mov_b64 exec, -1
    s_sleep 16
    buffer_load_dwordx4 v[32:35], v3, s[36:39], 0 offen offset:0 sc1
    buffer_load_dwordx4 v[36:39], v3, s[36:39], 0 offen offset:1024 sc1
    s_mov_b32 s80, 200000
PS_22:
    s_waitcnt vmcnt(0)
    s_mov_b32 s78, 0
    v_cmp_ne_u64 vcc, s[94:95], v[34:35]
    s_cbranch_vccz PSS_24
    buffer_load_dwordx4 v[32:35], v3, s[36:39], 0 offen offset:0 sc1
    s_mov_b32 s78, 1
PSS_24:
    v_cmp_ne_u64 vcc, s[94:95], v[38:39]
    s_cbranch_vccz PSS_25
    buffer_load_dwordx4 v[36:39], v3, s[36:39], 0 offen offset:1024 sc1
    s_mov_b32 s78, 1
PSS_25:
    s_cmp_eq_u32 s78, 0
    s_cbranch_scc1 PSD_23
    s_sleep 8
    s_cmp_lg_u32 s80, 199984
    s_cbranch_scc1 PSL_26
    buffer_store_dwordx4 v[112:115], v110, s[36:39], 0 offen offset:0 sc1
    buffer_store_dwordx4 v[116:119], v110, s[36:39], 0 offen offset:1024 sc1
    buffer_store_dwordx4 v[120:123], v111, s[36:39], 0 offen offset:0 sc1
    buffer_store_dwordx4 v[124:127], v111, s[36:39], 0 offen offset:1024 sc1
PSL_26:
    s_sub_u32 s80, s80, 1
    s_cmp_lg_u32 s80, 0
    s_cbranch_scc1 PS_22
    s_waitcnt vmcnt(0)
PSD_23:
    v_lshlrev_b32 v16, 16, v32
    v_and_b32 v17, 0xffff0000, v32
    v_lshlrev_b32 v18, 16, v33
    v_and_b32 v19, 0xffff0000, v33
    v_lshlrev_b32 v20, 16, v36
    v_and_b32 v21, 0xffff0000, v36
    v_lshlrev_b32 v22, 16, v37
    v_and_b32 v23, 0xffff0000, v37
    v_mov_b32 v24, v16
    v_mov_b32 v25, v17
    v_mov_b32 v26, v18
    v_mov_b32 v27, v19
    v_mov_b32 v28, v20
    v_mov_b32 v29, v21
    v_mov_b32 v30, v22
    v_mov_b32 v31, v23
    v_permlane32_swap_b32 v16, v24
    v_permlane32_swap_b32 v17, v25
    v_permlane32_swap_b32 v18, v26
    v_permlane32_swap_b32 v19, v27
    v_permlane32_swap_b32 v20, v28
    v_permlane32_swap_b32 v21, v29
    v_permlane32_swap_b32 v22, v30
    v_permlane32_swap_b32 v23, v31
    v_add_f32 v16, v16, v24
    v_add_f32 v17, v17, v25
    v_add_f32 v18, v18, v26
    v_add_f32 v19, v19, v27
    v_add_f32 v20, v20, v28
    v_add_f32 v21, v21, v29
    v_add_f32 v22, v22, v30
    v_add_f32 v23, v23, v31
    v_mov_b32 v24, v16
    v_mov_b32 v25, v17
    v_mov_b32 v26, v18
    v_mov_b32 v27, v19
    v_mov_b32 v28, v20
    v_mov_b32 v29, v21
    v_mov_b32 v30, v22
    v_mov_b32 v31, v23
    v_permlane16_swap_b32 v16, v24
    v_permlane16_swap_b32 v17, v25
    v_permlane16_swap_b32 v18, v26
    v_permlane16_swap_b32 v19, v27
    v_permlane16_swap_b32 v20, v28
    v_permlane16_swap_b32 v21, v29
    v_permlane16_swap_b32 v22, v30
    v_permlane16_swap_b32 v23, v31
    v_add_f32 v16, v16, v24
    v_add_f32 v17, v17, v25
    v_add_f32 v18, v18, v26
    v_add_f32 v19, v19, v27
    v_add_f32 v20, v20, v28
    v_add_f32 v21, v21, v29
    v_add_f32 v22, v22, v30
    v_add_f32 v23, v23, v31
    v_cvt_pk_bf16_f32 v8, v16, v17
    v_cvt_pk_bf16_f32 v9, v18, v19
    v_cvt_pk_bf16_f32 v10, v20, v21
    v_cvt_pk_bf16_f32 v11, v22, v23
    v_and_b32 v100, 15, v1
    v_lshlrev_b32 v100, 4, v100
    v_add_u32 v100, 0x24100, v100
    ds_write_b128 v100, v[8:11]
L_ACUT:
    v_mov_b32 v100, 0x24004
    v_mov_b32 v101, 1
    s_waitcnt lgkmcnt(0)
    s_mov_b64 exec, 1
    ds_add_u32 v100, v101
    s_mov_b64 exec, -1
    v_mov_b32 v100, 0x24008
    s_mov_b32 s80, 1600000
LW_27:
    ds_read_b32 v101, v100
    s_waitcnt lgkmcnt(0)
    v_readfirstlane_b32 s79, v101
    s_cmp_ge_u32 s79, 1
    s_cbranch_scc1 LWD_28
    s_sleep 8
    s_sub_u32 s80, s80, 1
    s_cmp_lg_u32 s80, 0
    s_cbranch_scc1 LW_27
LWD_28:
    v_and_b32 v100, 31, v1
    s_lshl_b32 s7, s4, 9
    s_add_u32 s7, s7, 0xc0000
    v_lshl_add_u32 v100, v100, 4, s7
    buffer_load_dwordx4 v[32:35], v100, s[36:39], 0 offen sc1
    s_waitcnt vmcnt(0)
    v_cmp_ne_u64 vcc, s[94:95], v[34:35]
    v_cmp_ne_u32 s[86:87], s96, v32
    s_or_b32 s97, vcc_lo, s86
    s_and_b32 s97, s97, 0xffff00ff
    s_cbranch_scc0 AF_29
    buffer_store_dwordx4 v[112:115], v110, s[36:39], 0 offen offset:0 sc1
    buffer_store_dwordx4 v[116:119], v110, s[36:39], 0 offen offset:1024 sc1
    buffer_store_dwordx4 v[120:123], v111, s[36:39], 0 offen offset:0 sc1
    buffer_store_dwordx4 v[124:127], v111, s[36:39], 0 offen offset:1024 sc1
AF_29:
    v_mov_b32 v100, 0x24008
    s_mov_b32 s80, 1600000
LW_30:
    ds_read_b32 v101, v100
    s_waitcnt lgkmcnt(0)
    v_readfirstlane_b32 s79, v101
    s_cmp_ge_u32 s79, 11
    s_cbranch_scc1 LWD_31
    s_sleep 2
    s_sub_u32 s80, s80, 1
    s_cmp_lg_u32 s80, 0
    s_cbranch_scc1 LW_30
LWD_31:
    v_mov_b32 v100, 0x24200
    ds_read_b128 v[8:11], v100 offset:0
    ds_read_b128 v[12:15], v100 offset:16
    ds_read_b128 v[16:19], v100 offset:32
    ds_read_b128 v[20:23], v100 offset:48
    ds_read_b128 v[24:27], v100 offset:64
    ds_read_b128 v[28:31], v100 offset:80
    s_waitcnt lgkmcnt(0)
    v_max3_f32 v100, v8, v10, v12
    v_max3_f32 v100, v100, v14, v16
    v_max3_f32 v100, v100, v18, v20
    v_max3_f32 v100, v100, v22, v24
    v_max3_f32 v100, v100, v26, v28
    v_sub_f32 v8, v8, v100
    v_sub_f32 v10, v10, v100
    v_sub_f32 v12, v12, v100
    v_sub_f32 v14, v14, v100
    v_sub_f32 v16, v16, v100
    v_sub_f32 v18, v18, v100
    v_sub_f32 v20, v20, v100
    v_sub_f32 v22, v22, v100
    v_sub_f32 v24, v24, v100
    v_sub_f32 v26, v26, v100
    v_sub_f32 v28, v28, v100
    v_exp_f32 v8, v8
    v_exp_f32 v10, v10
    v_exp_f32 v12, v12
    v_exp_f32 v14, v14
    v_exp_f32 v16, v16
    v_exp_f32 v18, v18
    v_exp_f32 v20, v20
    v_exp_f32 v22, v22
    v_exp_f32 v24, v24
    v_exp_f32 v26, v26
    v_exp_f32 v28, v28
    v_mul_f32 v101, v8, v9
    v_fmac_f32 v101, v10, v11
    v_fmac_f32 v101, v12, v13
    v_fmac_f32 v101, v14, v15
    v_fmac_f32 v101, v16, v17
    v_fmac_f32 v101, v18, v19
    v_fmac_f32 v101, v20, v21
    v_fmac_f32 v101, v22, v23
    v_fmac_f32 v101, v24, v25
    v_fmac_f32 v101, v26, v27
    v_fmac_f32 v101, v28, v29
    v_rcp_f32 v101, v101
    s_nop 0
    v_mul_f32 v8, v8, v101
    v_mul_f32 v10, v10, v101
    v_mul_f32 v12, v12, v101
    v_mul_f32 v14, v14, v101
    v_mul_f32 v16, v16, v101
    v_mul_f32 v18, v18, v101
    v_mul_f32 v20, v20, v101
    v_mul_f32 v22, v22, v101
    v_mul_f32 v24, v24, v101
    v_mul_f32 v26, v26, v101
    v_mul_f32 v28, v28, v101
    v_and_b32 v100, 15, v1
    v_bfe_u32 v101, v1, 4, 1
    v_lshlrev_b32 v3, 5, v100
    v_lshl_add_u32 v3, v101, 4, v3
    v_add_u32 v3, 0x25000, v3
    s_lshl_b32 s7, s6, 3
    s_add_u32 s7, s7, s60
    s_lshl_b32 s7, s7, 8
    s_add_u32 s7, s7, 0xd0000
    v_lshlrev_b32 v2, 4, v100
    v_lshl_add_u32 v2, v101, 10, v2
    v_add_u32 v2, s7, v2
    v_mov_b32 v6, s94
    v_mov_b32 v7, s95
    s_barrier
    ds_read_b128 v[40:43], v3 offset:0
    ds_read_b128 v[44:47], v3 offset:512
    ds_read_b128 v[48:51], v3 offset:1024
    ds_read_b128 v[52:55], v3 offset:1536
    ds_read_b128 v[56:59], v3 offset:2048
    ds_read_b128 v[60:63], v3 offset:2560
    ds_read_b128 v[64:67], v3 offset:3072
    ds_read_b128 v[68:71], v3 offset:3584
    ds_read_b128 v[72:75], v3 offset:4096
    ds_read_b128 v[76:79], v3 offset:4608
    ds_read_b128 v[80:83], v3 offset:5120
    s_waitcnt lgkmcnt(10)
    v_pk_mul_f32 v[32:33], v[40:41], v[8:9] op_sel_hi:[1,0]
    v_pk_mul_f32 v[34:35], v[42:43], v[8:9] op_sel_hi:[1,0]
    s_waitcnt lgkmcnt(9)
    v_pk_mul_f32 v[36:37], v[44:45], v[10:11] op_sel_hi:[1,0]
    v_pk_mul_f32 v[38:39], v[46:47], v[10:11] op_sel_hi:[1,0]
    s_waitcnt lgkmcnt(8)
    v_pk_fma_f32 v[32:33], v[48:49], v[12:13], v[32:33] op_sel_hi:[1,0,1]
    v_pk_fma_f32 v[34:35], v[50:51], v[12:13], v[34:35] op_sel_hi:[1,0,1]
    s_waitcnt lgkmcnt(7)
    v_pk_fma_f32 v[36:37], v[52:53], v[14:15], v[36:37] op_sel_hi:[1,0,1]
    v_pk_fma_f32 v[38:39], v[54:55], v[14:15], v[38:39] op_sel_hi:[1,0,1]
    s_waitcnt lgkmcnt(6)
    v_pk_fma_f32 v[32:33], v[56:57], v[16:17], v[32:33] op_sel_hi:[1,0,1]
    v_pk_fma_f32 v[34:35], v[58:59], v[16:17], v[34:35] op_sel_hi:[1,0,1]
    s_waitcnt lgkmcnt(5)
    v_pk_fma_f32 v[36:37], v[60:61], v[18:19], v[36:37] op_sel_hi:[1,0,1]
    v_pk_fma_f32 v[38:39], v[62:63], v[18:19], v[38:39] op_sel_hi:[1,0,1]
    s_waitcnt lgkmcnt(4)
    v_pk_fma_f32 v[32:33], v[64:65], v[20:21], v[32:33] op_sel_hi:[1,0,1]
    v_pk_fma_f32 v[34:35], v[66:67], v[20:21], v[34:35] op_sel_hi:[1,0,1]
    s_waitcnt lgkmcnt(3)
    v_pk_fma_f32 v[36:37], v[68:69], v[22:23], v[36:37] op_sel_hi:[1,0,1]
    v_pk_fma_f32 v[38:39], v[70:71], v[22:23], v[38:39] op_sel_hi:[1,0,1]
    s_waitcnt lgkmcnt(2)
    v_pk_fma_f32 v[32:33], v[72:73], v[24:25], v[32:33] op_sel_hi:[1,0,1]
    v_pk_fma_f32 v[34:35], v[74:75], v[24:25], v[34:35] op_sel_hi:[1,0,1]
    s_waitcnt lgkmcnt(1)
    v_pk_fma_f32 v[36:37], v[76:77], v[26:27], v[36:37] op_sel_hi:[1,0,1]
    v_pk_fma_f32 v[38:39], v[78:79], v[26:27], v[38:39] op_sel_hi:[1,0,1]
    s_waitcnt lgkmcnt(0)
    v_pk_fma_f32 v[32:33], v[80:81], v[28:29], v[32:33] op_sel_hi:[1,0,1]
    v_pk_fma_f32 v[34:35], v[82:83], v[28:29], v[34:35] op_sel_hi:[1,0,1]
    v_pk_add_f32 v[32:33], v[32:33], v[36:37]
    v_pk_add_f32 v[34:35], v[34:35], v[38:39]
    v_cvt_pk_bf16_f32 v4, v32, v33
    v_cvt_pk_bf16_f32 v5, v34, v35
    s_mov_b64 exec, 0xffffffff
    buffer_store_dwordx4 v[4:7], v2, s[36:39], 0 offen
    s_cmp_eq_u32 s97, 0
    s_cbranch_scc1 AF_32
    buffer_store_dwordx4 v[4:7], v2, s[36:39], 0 offen sc1
AF_32:
    s_mov_b64 exec, -1
    s_endpgm
.p2align 12
L_W:
    s_waitcnt lgkmcnt(0)
    s_mov_b32 s92, 0x05040100
    s_mov_b32 s93, 0x07060302
    s_mov_b32 s36, s34
    s_and_b32 s37, s35, 0xffff
    s_mov_b32 s38, 0x1000000
    s_mov_b32 s39, 0x20000
    s_mov_b32 s40, s32
    s_and_b32 s41, s33, 0xffff
    s_mov_b32 s42, 0x100
    s_mov_b32 s43, 0x20000
    s_barrier
    s_cmp_eq_u32 s3, 0
    s_cbranch_scc1 LT_U1
LR_U1:
    s_cmp_eq_u32 s3, 1
    s_cbranch_scc1 LT_W2R
LR_W2R:
    s_cmp_ge_u32 s5, 4
    s_cbranch_scc1 L_END
    v_mov_b32 v160, 0x24048
    s_mov_b32 s80, 1600000
LW_33:
    ds_read_b32 v161, v160
    s_waitcnt lgkmcnt(0)
    v_readfirstlane_b32 s79, v161
    s_cmp_ge_u32 s79, 4
    s_cbranch_scc1 LWD_34
    s_sleep 4
    s_sub_u32 s80, s80, 1
    s_cmp_lg_u32 s80, 0
    s_cbranch_scc1 LW_33
LWD_34:
    s_branch L_U1
L_W1:
    s_waitcnt lgkmcnt(0)
    s_mov_b32 s92, 0x05040100
    s_mov_b32 s93, 0x07060302
    s_mov_b32 s36, s34
    s_and_b32 s37, s35, 0xffff
    s_mov_b32 s38, 0x1000000
    s_mov_b32 s39, 0x20000
    s_mov_b32 s40, s32
    s_and_b32 s41, s33, 0xffff
    s_mov_b32 s42, 0x100
    s_mov_b32 s43, 0x20000
    s_setprio 3
    s_barrier
    s_cmp_lg_u32 s3, 4
    s_cbranch_scc1 W4_35
    s_sleep 8
    v_mov_b32 v152, 0
    s_mov_b32 s80, 200000
    s_mov_b64 exec, 1
    buffer_load_dwordx2 v[156:157], v152, s[40:43], 0 offen sc1
    s_sleep 16
    buffer_load_dwordx2 v[154:155], v152, s[40:43], 0 offen sc1
    s_mov_b64 exec, -1
    s_waitcnt vmcnt(1)
    v_readfirstlane_b32 s94, v156
    v_readfirstlane_b32 s95, v157
    s_cmp_lg_u32 s95, 0
    s_cbranch_scc1 NGD_37
    s_branch NG2_38
NG_36:
    s_mov_b64 exec, 1
    buffer_load_dwordx2 v[154:155], v152, s[40:43], 0 offen sc1
    s_mov_b64 exec, -1
NG2_38:
    s_waitcnt vmcnt(0)
    v_readfirstlane_b32 s94, v154
    v_readfirstlane_b32 s95, v155
    s_cmp_lg_u32 s95, 0
    s_cbranch_scc1 NGD_37
    s_sleep 4
    s_sub_u32 s80, s80, 1
    s_cmp_lg_u32 s80, 0
    s_cbranch_scc1 NG_36
NGD_37:
    v_mov_b32 v160, 0x24050
    v_mov_b32 v162, s94
    v_mov_b32 v163, s95
    ds_write_b64 v160, v[162:163]
    v_mov_b32 v160, 0x2404c
    v_mov_b32 v161, 1
    s_waitcnt lgkmcnt(0)
    s_mov_b64 exec, 1
    ds_add_u32 v160, v161
    s_mov_b64 exec, -1
    s_getreg_b32 s96, hwreg(HW_REG_XCC_ID, 0, 4)
    s_lshl_b32 s7, s4, 5
    s_add_u32 s7, s7, s5
    s_lshl_b32 s7, s7, 4
    s_add_u32 s7, s7, 0xc0000
    v_mov_b32 v160, s7
    v_mov_b32 v162, s96
    v_mov_b32 v163, 0
    v_mov_b32 v164, s94
    v_mov_b32 v165, s95
    s_mov_b64 exec, 1
    buffer_store_dwordx4 v[162:165], v160, s[36:39], 0 offen
    s_mov_b64 exec, -1
W4_35:
    s_sub_u32 s62, s3, 4
    s_lshl_b32 s61, s4, 2
    s_add_u32 s61, s61, s62
    v_lshrrev_b32 v162, 4, v1
    v_and_b32 v161, 15, v1
    v_lshlrev_b32 v2, 16, v162
    v_lshl_add_u32 v2, v161, 4, v2
    s_lshl_b32 s7, s61, 3
    s_add_u32 s7, s7, s5
    s_lshl_b32 s7, s7, 8
    s_add_u32 s7, s7, 0x0
    v_add_u32 v2, s7, v2
    v_lshlrev_b32 v3, 6, v161
    v_lshl_add_u32 v3, v162, 4, v3
    s_lshl_b32 s7, s61, 13
    s_add_u32 s7, s7, 0x40000
    v_add_u32 v3, s7, v3
    v_xor_b32 v5, v162, v161
    v_lshlrev_b32 v5, 4, v5
    v_lshl_add_u32 v4, v161, 12, v5
    s_lshl_b32 s7, s62, 8
    v_add_u32 v4, s7, v4
    v_mov_b32 v160, 0x2404c
    s_mov_b32 s80, 1600000
LW_39:
    ds_read_b32 v161, v160
    s_waitcnt lgkmcnt(0)
    v_readfirstlane_b32 s79, v161
    s_cmp_ge_u32 s79, 1
    s_cbranch_scc1 LWD_40
    s_sleep 2
    s_sub_u32 s80, s80, 1
    s_cmp_lg_u32 s80, 0
    s_cbranch_scc1 LW_39
LWD_40:
    v_mov_b32 v160, 0x24050
    ds_read_b64 v[162:163], v160
    s_waitcnt lgkmcnt(0)
    v_readfirstlane_b32 s94, v162
    v_readfirstlane_b32 s95, v163
    s_sleep 4
    s_mov_b32 s63, 4096
    buffer_load_dwordx4 v[72:75], v3, s[36:39], 0 offen offset:0 sc1
    buffer_load_dwordx4 v[76:79], v3, s[36:39], 0 offen offset:1024 sc1
    buffer_load_dwordx4 v[80:83], v3, s[36:39], 0 offen offset:2048 sc1
    buffer_load_dwordx4 v[84:87], v3, s[36:39], 0 offen offset:3072 sc1
    buffer_load_dwordx4 v[88:91], v3, s[36:39], s63 offen offset:0 sc1
    buffer_load_dwordx4 v[92:95], v3, s[36:39], s63 offen offset:1024 sc1
    buffer_load_dwordx4 v[96:99], v3, s[36:39], s63 offen offset:2048 sc1
    buffer_load_dwordx4 v[100:103], v3, s[36:39], s63 offen offset:3072 sc1
    v_mov_b32 v160, 0x24014
    s_mov_b32 s80, 1600000
LW_43:
    ds_read_b32 v161, v160
    s_waitcnt lgkmcnt(0)
    v_readfirstlane_b32 s79, v161
    s_cmp_ge_u32 s79, 4
    s_cbranch_scc1 LWD_44
    s_sleep 1
    s_sub_u32 s80, s80, 1
    s_cmp_lg_u32 s80, 0
    s_cbranch_scc1 LW_43
LWD_44:
    v_xor_b32 v160, 0x0, v4
    v_xor_b32 v161, 0x40, v4
    v_xor_b32 v162, 0x80, v4
    v_xor_b32 v163, 0xc0, v4
    ds_read_b128 v[8:11], v160 offset:0
    ds_read_b128 v[12:15], v161 offset:0
    ds_read_b128 v[16:19], v162 offset:0
    ds_read_b128 v[20:23], v163 offset:0
    ds_read_b128 v[24:27], v160 offset:1024
    ds_read_b128 v[28:31], v161 offset:1024
    ds_read_b128 v[32:35], v162 offset:1024
    ds_read_b128 v[36:39], v163 offset:1024
    ds_read_b128 v[40:43], v160 offset:2048
    ds_read_b128 v[44:47], v161 offset:2048
    ds_read_b128 v[48:51], v162 offset:2048
    ds_read_b128 v[52:55], v163 offset:2048
    ds_read_b128 v[56:59], v160 offset:3072
    ds_read_b128 v[60:63], v161 offset:3072
    ds_read_b128 v[64:67], v162 offset:3072
    ds_read_b128 v[68:71], v163 offset:3072
    s_mov_b32 s80, 200000
PS_41:
    s_waitcnt vmcnt(0)
    s_mov_b32 s78, 0
    v_cmp_ne_u64 vcc, s[94:95], v[74:75]
    s_cbranch_vccz PSS_45
    buffer_load_dwordx4 v[72:75], v3, s[36:39], 0 offen offset:0 sc1
    s_mov_b32 s78, 1
PSS_45:
    v_cmp_ne_u64 vcc, s[94:95], v[78:79]
    s_cbranch_vccz PSS_46
    buffer_load_dwordx4 v[76:79], v3, s[36:39], 0 offen offset:1024 sc1
    s_mov_b32 s78, 1
PSS_46:
    v_cmp_ne_u64 vcc, s[94:95], v[82:83]
    s_cbranch_vccz PSS_47
    buffer_load_dwordx4 v[80:83], v3, s[36:39], 0 offen offset:2048 sc1
    s_mov_b32 s78, 1
PSS_47:
    v_cmp_ne_u64 vcc, s[94:95], v[86:87]
    s_cbranch_vccz PSS_48
    buffer_load_dwordx4 v[84:87], v3, s[36:39], 0 offen offset:3072 sc1
    s_mov_b32 s78, 1
PSS_48:
    v_cmp_ne_u64 vcc, s[94:95], v[90:91]
    s_cbranch_vccz PSS_49
    buffer_load_dwordx4 v[88:91], v3, s[36:39], s63 offen offset:0 sc1
    s_mov_b32 s78, 1
PSS_49:
    v_cmp_ne_u64 vcc, s[94:95], v[94:95]
    s_cbranch_vccz PSS_50
    buffer_load_dwordx4 v[92:95], v3, s[36:39], s63 offen offset:1024 sc1
    s_mov_b32 s78, 1
PSS_50:
    v_cmp_ne_u64 vcc, s[94:95], v[98:99]
    s_cbranch_vccz PSS_51
    buffer_load_dwordx4 v[96:99], v3, s[36:39], s63 offen offset:2048 sc1
    s_mov_b32 s78, 1
PSS_51:
    v_cmp_ne_u64 vcc, s[94:95], v[102:103]
    s_cbranch_vccz PSS_52
    buffer_load_dwordx4 v[100:103], v3, s[36:39], s63 offen offset:3072 sc1
    s_mov_b32 s78, 1
PSS_52:
    s_cmp_eq_u32 s78, 0
    s_cbranch_scc1 PSD_42
    s_sub_u32 s80, s80, 1
    s_cmp_lg_u32 s80, 0
    s_cbranch_scc1 PS_41
    s_waitcnt vmcnt(0)
PSD_42:
    v_lshlrev_b32 v104, 16, v72
    v_and_b32 v105, 0xffff0000, v72
    v_lshlrev_b32 v106, 16, v73
    v_and_b32 v107, 0xffff0000, v73
    v_lshlrev_b32 v108, 16, v76
    v_and_b32 v109, 0xffff0000, v76
    v_lshlrev_b32 v110, 16, v77
    v_and_b32 v111, 0xffff0000, v77
    v_lshlrev_b32 v120, 16, v80
    v_and_b32 v121, 0xffff0000, v80
    v_lshlrev_b32 v122, 16, v81
    v_and_b32 v123, 0xffff0000, v81
    v_lshlrev_b32 v124, 16, v84
    v_and_b32 v125, 0xffff0000, v84
    v_lshlrev_b32 v126, 16, v85
    v_and_b32 v127, 0xffff0000, v85
    v_add_f32 v104, v104, v120
    v_add_f32 v105, v105, v121
    v_add_f32 v106, v106, v122
    v_add_f32 v107, v107, v123
    v_add_f32 v108, v108, v124
    v_add_f32 v109, v109, v125
    v_add_f32 v110, v110, v126
    v_add_f32 v111, v111, v127
    v_lshlrev_b32 v112, 16, v88
    v_and_b32 v113, 0xffff0000, v88
    v_lshlrev_b32 v114, 16, v89
    v_and_b32 v115, 0xffff0000, v89
    v_lshlrev_b32 v116, 16, v92
    v_and_b32 v117, 0xffff0000, v92
    v_lshlrev_b32 v118, 16, v93
    v_and_b32 v119, 0xffff0000, v93
    v_add_f32 v104, v104, v112
    v_add_f32 v105, v105, v113
    v_add_f32 v106, v106, v114
    v_add_f32 v107, v107, v115
    v_add_f32 v108, v108, v116
    v_add_f32 v109, v109, v117
    v_add_f32 v110, v110, v118
    v_add_f32 v111, v111, v119
    v_lshlrev_b32 v120, 16, v96
    v_and_b32 v121, 0xffff0000, v96
    v_lshlrev_b32 v122, 16, v97
    v_and_b32 v123, 0xffff0000, v97
    v_lshlrev_b32 v124, 16, v100
    v_and_b32 v125, 0xffff0000, v100
    v_lshlrev_b32 v126, 16, v101
    v_and_b32 v127, 0xffff0000, v101
    v_add_f32 v104, v104, v120
    v_add_f32 v105, v105, v121
    v_add_f32 v106, v106, v122
    v_add_f32 v107, v107, v123
    v_add_f32 v108, v108, v124
    v_add_f32 v109, v109, v125
    v_add_f32 v110, v110, v126
    v_add_f32 v111, v111, v127
    v_cvt_pk_bf16_f32 v136, v104, v105
    v_cvt_pk_bf16_f32 v137, v106, v107
    v_cvt_pk_bf16_f32 v138, v108, v109
    v_cvt_pk_bf16_f32 v139, v110, v111
    v_mov_b32_dpp v140, v136 quad_perm:[1,2,3,0] row_mask:0xf bank_mask:0xf
    v_mov_b32_dpp v141, v137 quad_perm:[1,2,3,0] row_mask:0xf bank_mask:0xf
    v_mov_b32_dpp v142, v138 quad_perm:[1,2,3,0] row_mask:0xf bank_mask:0xf
    v_mov_b32_dpp v143, v139 quad_perm:[1,2,3,0] row_mask:0xf bank_mask:0xf
    v_mov_b32_dpp v144, v136 quad_perm:[2,3,0,1] row_mask:0xf bank_mask:0xf
    v_mov_b32_dpp v145, v137 quad_perm:[2,3,0,1] row_mask:0xf bank_mask:0xf
    v_mov_b32_dpp v146, v138 quad_perm:[2,3,0,1] row_mask:0xf bank_mask:0xf
    v_mov_b32_dpp v147, v139 quad_perm:[2,3,0,1] row_mask:0xf bank_mask:0xf
    v_mov_b32_dpp v148, v136 quad_perm:[3,0,1,2] row_mask:0xf bank_mask:0xf
    v_mov_b32_dpp v149, v137 quad_perm:[3,0,1,2] row_mask:0xf bank_mask:0xf
    v_mov_b32_dpp v150, v138 quad_perm:[3,0,1,2] row_mask:0xf bank_mask:0xf
    v_mov_b32_dpp v151, v139 quad_perm:[3,0,1,2] row_mask:0xf bank_mask:0xf
    v_mov_b32 v74, s94
    v_mov_b32 v75, s95
    s_waitcnt lgkmcnt(0)
    v_mfma_f32_16x16x32_bf16 v[104:107], v[136:139], v[8:11], 0
    v_mfma_f32_16x16x32_bf16 v[108:111], v[136:139], v[28:31], 0
    v_mfma_f32_16x16x32_bf16 v[112:115], v[136:139], v[48:51], 0
    v_mfma_f32_16x16x32_bf16 v[116:119], v[136:139], v[68:71], 0
    v_mfma_f32_16x16x32_bf16 v[104:107], v[140:143], v[12:15], v[104:107]
    v_mfma_f32_16x16x32_bf16 v[108:111], v[140:143], v[32:35], v[108:111]
    v_mfma_f32_16x16x32_bf16 v[112:115], v[140:143], v[52:55], v[112:115]
    v_mfma_f32_16x16x32_bf16 v[116:119], v[140:143], v[56:59], v[116:119]
    v_mfma_f32_16x16x32_bf16 v[104:107], v[144:147], v[16:19], v[104:107]
    v_mfma_f32_16x16x32_bf16 v[108:111], v[144:147], v[36:39], v[108:111]
    v_mfma_f32_16x16x32_bf16 v[112:115], v[144:147], v[40:43], v[112:115]
    v_mfma_f32_16x16x32_bf16 v[116:119], v[144:147], v[60:63], v[116:119]
    v_mfma_f32_16x16x32_bf16 v[104:107], v[148:151], v[20:23], v[104:107]
    v_mfma_f32_16x16x32_bf16 v[108:111], v[148:151], v[24:27], v[108:111]
    v_mfma_f32_16x16x32_bf16 v[112:115], v[148:151], v[44:47], v[112:115]
    v_mfma_f32_16x16x32_bf16 v[116:119], v[148:151], v[64:67], v[116:119]
    s_nop 5
    v_cvt_pk_bf16_f32 v72, v104, v109
    s_nop 0
    v_cvt_pk_bf16_f32 v73, v114, v119
    buffer_store_dwordx4 v[72:75], v2, s[36:39], 0 offen sc1
    v_mov_b32 v160, 0x24048
    v_mov_b32 v161, 1
    s_waitcnt lgkmcnt(0)
    s_mov_b64 exec, 1
    ds_add_u32 v160, v161
    s_mov_b64 exec, -1
    s_setprio 0
    s_cmp_ge_u32 s5, 4
    s_cbranch_scc1 L_END
    s_branch L_U1
L_CSVC:
    s_cmp_lg_u32 s3, 11
    s_cbranch_scc1 Z_101
    v_lshlrev_b32 v2, 2, v1
    v_add_u32 v2, 0x24000, v2
    v_mov_b32 v3, 0
    ds_write_b32 v2, v3
Z_101:
    s_waitcnt lgkmcnt(0)
    s_mov_b32 s92, 0x05040100
    s_mov_b32 s93, 0x07060302
    s_mov_b32 s36, s34
    s_and_b32 s37, s35, 0xffff
    s_mov_b32 s38, 0x1000000
    s_mov_b32 s39, 0x20000
    s_mov_b32 s40, s32
    s_and_b32 s41, s33, 0xffff
    s_mov_b32 s42, 0x100
    s_mov_b32 s43, 0x20000
    s_setprio 3
    s_sub_u32 s60, s3, 8
    s_lshl_b32 s64, s4, 3
    s_add_u32 s64, s64, s5
    s_sub_u32 s64, s64, 8
    v_lshlrev_b32 v2, 4, v1
    s_barrier
    s_cmp_eq_u32 s3, 9
    s_cbranch_scc1 LT_CR
LR_CR:
    s_cmp_eq_u32 s3, 10
    s_cbranch_scc1 LT_CR2
LR_CR2:
    s_cmp_lg_u32 s60, 0
    s_cbranch_scc1 C8_102
    s_sleep 24
    v_mov_b32 v160, 0
    s_mov_b32 s80, 200000
NG_103:
    s_mov_b64 exec, 1
    buffer_load_dwordx2 v[162:163], v160, s[40:43], 0 offen sc1
    s_mov_b64 exec, -1
    s_waitcnt vmcnt(0)
    v_readfirstlane_b32 s94, v162
    v_readfirstlane_b32 s95, v163
    s_cmp_lg_u32 s95, 0
    s_cbranch_scc1 NGD_104
    s_sleep 4
    s_sub_u32 s80, s80, 1
    s_cmp_lg_u32 s80, 0
    s_cbranch_scc1 NG_103
NGD_104:
    v_mov_b32 v160, 0x24050
    v_mov_b32 v162, s94
    v_mov_b32 v163, s95
    ds_write_b64 v160, v[162:163]
    v_mov_b32 v160, 0x2404c
    v_mov_b32 v161, 1
    s_waitcnt lgkmcnt(0)
    s_mov_b64 exec, 1
    ds_add_u32 v160, v161
    s_mov_b64 exec, -1
C8_102:
    s_lshr_b32 s7, s64, 4
    s_lshl_b32 s7, s7, 16
    s_lshl_b32 s63, s60, 14
    s_add_u32 s7, s7, s63
    s_add_u32 s7, s7, 0x0
    v_lshl_add_u32 v4, v1, 4, s7
    s_and_b32 s7, s60, 1
    s_lshl_b32 s7, s7, 7
    v_lshlrev_b32 v3, 3, v1
    v_xor_b32 v3, s7, v3
    s_lshl_b32 s7, s60, 13
    s_add_u32 s7, s7, 0x18000
    v_add_u32 v3, s7, v3
    s_mov_b32 s44, s20
    s_and_b32 s45, s21, 0xffff
    s_mov_b32 s46, 0x1000000
    s_mov_b32 s47, 0x20000
    s_lshl_b32 s7, s64, 18
    s_lshl_b32 s65, s60, 10
    s_add_u32 s65, s65, s7
    s_add_u32 s65, s65, 196608
    s_lshl_b32 s7, s60, 6
    v_xor_b32 v12, s7, v2
    v_xor_b32 v13, 16, v12
    v_xor_b32 v14, 32, v12
    v_xor_b32 v15, 48, v12
    v_mov_b32 v160, 0x2404c
    s_mov_b32 s80, 1600000
LW_105:
    ds_read_b32 v161, v160
    s_waitcnt lgkmcnt(0)
    v_readfirstlane_b32 s79, v161
    s_cmp_ge_u32 s79, 1
    s_cbranch_scc1 LWD_106
    s_sleep 4
    s_sub_u32 s80, s80, 1
    s_cmp_lg_u32 s80, 0
    s_cbranch_scc1 LW_105
LWD_106:
    v_mov_b32 v160, 0x24050
    ds_read_b64 v[162:163], v160
    s_waitcnt lgkmcnt(0)
    v_readfirstlane_b32 s94, v162
    v_readfirstlane_b32 s95, v163
    v_mov_b32 v160, 0x24018
    s_mov_b32 s80, 1600000
LW_107:
    ds_read_b32 v161, v160
    s_waitcnt lgkmcnt(0)
    v_readfirstlane_b32 s79, v161
    s_cmp_ge_u32 s79, 8
    s_cbranch_scc1 LWD_108
    s_sleep 2
    s_sub_u32 s80, s80, 1
    s_cmp_lg_u32 s80, 0
    s_cbranch_scc1 LW_107
LWD_108:
    s_sleep 1
    s_mov_b32 s67, 4096
    s_mov_b32 s68, 8192
    s_mov_b32 s69, 12288
    buffer_load_dwordx4 v[96:99], v4, s[36:39], 0 offen offset:0 sc1
    buffer_load_dwordx4 v[100:103], v4, s[36:39], 0 offen offset:1024 sc1
    buffer_load_dwordx4 v[104:107], v4, s[36:39], 0 offen offset:2048 sc1
    buffer_load_dwordx4 v[108:111], v4, s[36:39], 0 offen offset:3072 sc1
    buffer_load_dwordx4 v[112:115], v4, s[36:39], s67 offen offset:0 sc1
    buffer_load_dwordx4 v[116:119], v4, s[36:39], s67 offen offset:1024 sc1
    buffer_load_dwordx4 v[120:123], v4, s[36:39], s67 offen offset:2048 sc1
    buffer_load_dwordx4 v[124:127], v4, s[36:39], s67 offen offset:3072 sc1
    buffer_load_dwordx4 v[128:131], v4, s[36:39], s68 offen offset:0 sc1
    buffer_load_dwordx4 v[132:135], v4, s[36:39], s68 offen offset:1024 sc1
    buffer_load_dwordx4 v[136:139], v4, s[36:39], s68 offen offset:2048 sc1
    buffer_load_dwordx4 v[140:143], v4, s[36:39], s68 offen offset:3072 sc1
    buffer_load_dwordx4 v[144:147], v4, s[36:39], s69 offen offset:0 sc1
    buffer_load_dwordx4 v[148:151], v4, s[36:39], s69 offen offset:1024 sc1
    buffer_load_dwordx4 v[152:155], v4, s[36:39], s69 offen offset:2048 sc1
    buffer_load_dwordx4 v[156:159], v4, s[36:39], s69 offen offset:3072 sc1
    s_mov_b32 s80, 200000
PS_109:
    s_waitcnt vmcnt(0)
    s_mov_b32 s78, 0
    v_cmp_ne_u64 vcc, s[94:95], v[98:99]
    s_cbranch_vccz PSS_111
    buffer_load_dwordx4 v[96:99], v4, s[36:39], 0 offen offset:0 sc1
    s_mov_b32 s78, 1
PSS_111:
    v_cmp_ne_u64 vcc, s[94:95], v[102:103]
    s_cbranch_vccz PSS_112
    buffer_load_dwordx4 v[100:103], v4, s[36:39], 0 offen offset:1024 sc1
    s_mov_b32 s78, 1
PSS_112:
    v_cmp_ne_u64 vcc, s[94:95], v[106:107]
    s_cbranch_vccz PSS_113
    buffer_load_dwordx4 v[104:107], v4, s[36:39], 0 offen offset:2048 sc1
    s_mov_b32 s78, 1
PSS_113:
    v_cmp_ne_u64 vcc, s[94:95], v[110:111]
    s_cbranch_vccz PSS_114
    buffer_load_dwordx4 v[108:111], v4, s[36:39], 0 offen offset:3072 sc1
    s_mov_b32 s78, 1
PSS_114:
    v_cmp_ne_u64 vcc, s[94:95], v[114:115]
    s_cbranch_vccz PSS_115
    buffer_load_dwordx4 v[112:115], v4, s[36:39], s67 offen offset:0 sc1
    s_mov_b32 s78, 1
PSS_115:
    v_cmp_ne_u64 vcc, s[94:95], v[118:119]
    s_cbranch_vccz PSS_116
    buffer_load_dwordx4 v[116:119], v4, s[36:39], s67 offen offset:1024 sc1
    s_mov_b32 s78, 1
PSS_116:
    v_cmp_ne_u64 vcc, s[94:95], v[122:123]
    s_cbranch_vccz PSS_117
    buffer_load_dwordx4 v[120:123], v4, s[36:39], s67 offen offset:2048 sc1
    s_mov_b32 s78, 1
PSS_117:
    v_cmp_ne_u64 vcc, s[94:95], v[126:127]
    s_cbranch_vccz PSS_118
    buffer_load_dwordx4 v[124:127], v4, s[36:39], s67 offen offset:3072 sc1
    s_mov_b32 s78, 1
PSS_118:
    v_cmp_ne_u64 vcc, s[94:95], v[130:131]
    s_cbranch_vccz PSS_119
    buffer_load_dwordx4 v[128:131], v4, s[36:39], s68 offen offset:0 sc1
    s_mov_b32 s78, 1
PSS_119:
    v_cmp_ne_u64 vcc, s[94:95], v[134:135]
    s_cbranch_vccz PSS_120
    buffer_load_dwordx4 v[132:135], v4, s[36:39], s68 offen offset:1024 sc1
    s_mov_b32 s78, 1
PSS_120:
    v_cmp_ne_u64 vcc, s[94:95], v[138:139]
    s_cbranch_vccz PSS_121
    buffer_load_dwordx4 v[136:139], v4, s[36:39], s68 offen offset:2048 sc1
    s_mov_b32 s78, 1
PSS_121:
    v_cmp_ne_u64 vcc, s[94:95], v[142:143]
    s_cbranch_vccz PSS_122
    buffer_load_dwordx4 v[140:143], v4, s[36:39], s68 offen offset:3072 sc1
    s_mov_b32 s78, 1
PSS_122:
    v_cmp_ne_u64 vcc, s[94:95], v[146:147]
    s_cbranch_vccz PSS_123
    buffer_load_dwordx4 v[144:147], v4, s[36:39], s69 offen offset:0 sc1
    s_mov_b32 s78, 1
PSS_123:
    v_cmp_ne_u64 vcc, s[94:95], v[150:151]
    s_cbranch_vccz PSS_124
    buffer_load_dwordx4 v[148:151], v4, s[36:39], s69 offen offset:1024 sc1
    s_mov_b32 s78, 1
PSS_124:
    v_cmp_ne_u64 vcc, s[94:95], v[154:155]
    s_cbranch_vccz PSS_125
    buffer_load_dwordx4 v[152:155], v4, s[36:39], s69 offen offset:2048 sc1
    s_mov_b32 s78, 1
PSS_125:
    v_cmp_ne_u64 vcc, s[94:95], v[158:159]
    s_cbranch_vccz PSS_126
    buffer_load_dwordx4 v[156:159], v4, s[36:39], s69 offen offset:3072 sc1
    s_mov_b32 s78, 1
PSS_126:
    s_cmp_eq_u32 s78, 0
    s_cbranch_scc1 PSD_110
    s_sub_u32 s80, s80, 1
    s_cmp_lg_u32 s80, 0
    s_cbranch_scc1 PS_109
    s_waitcnt vmcnt(0)
PSD_110:
    buffer_load_dwordx4 v[32:35], v12, s[44:47], s65 offen nt
    s_addk_i32 s65, 4096
    buffer_load_dwordx4 v[36:39], v13, s[44:47], s65 offen nt
    s_addk_i32 s65, 4096
    buffer_load_dwordx4 v[40:43], v14, s[44:47], s65 offen nt
    s_addk_i32 s65, 4096
    buffer_load_dwordx4 v[44:47], v15, s[44:47], s65 offen nt
    s_addk_i32 s65, 4096
    buffer_load_dwordx4 v[48:51], v12, s[44:47], s65 offen nt
    s_addk_i32 s65, 4096
    buffer_load_dwordx4 v[52:55], v13, s[44:47], s65 offen nt
    s_addk_i32 s65, 4096
    buffer_load_dwordx4 v[56:59], v14, s[44:47], s65 offen nt
    s_addk_i32 s65, 4096
    buffer_load_dwordx4 v[60:63], v15, s[44:47], s65 offen nt
    s_addk_i32 s65, 4096
    v_xor_b32 v6, 0x0, v3
    ds_write_b64 v6, v[96:97] offset:0
    ds_write_b64 v6, v[100:101] offset:512
    v_xor_b32 v7, 0x10, v3
    ds_write_b64 v7, v[104:105] offset:1024
    ds_write_b64 v7, v[108:109] offset:1536
    v_xor_b32 v6, 0x20, v3
    ds_write_b64 v6, v[112:113] offset:2048
    ds_write_b64 v6, v[116:117] offset:2560
    v_xor_b32 v7, 0x30, v3
    ds_write_b64 v7, v[120:121] offset:3072
    ds_write_b64 v7, v[124:125] offset:3584
    v_xor_b32 v6, 0x40, v3
    ds_write_b64 v6, v[128:129] offset:4096
    ds_write_b64 v6, v[132:133] offset:4608
    v_xor_b32 v7, 0x50, v3
    ds_write_b64 v7, v[136:137] offset:5120
    ds_write_b64 v7, v[140:141] offset:5632
    v_xor_b32 v6, 0x60, v3
    ds_write_b64 v6, v[144:145] offset:6144
    ds_write_b64 v6, v[148:149] offset:6656
    v_xor_b32 v7, 0x70, v3
    ds_write_b64 v7, v[152:153] offset:7168
    ds_write_b64 v7, v[156:157] offset:7680
L_CCUT:
    s_waitcnt lgkmcnt(0)
    s_barrier
    s_setprio 0
    s_barrier
    s_barrier
    buffer_load_dwordx4 v[64:67], v12, s[44:47], s65 offen nt
    s_addk_i32 s65, 4096
    buffer_load_dwordx4 v[68:71], v13, s[44:47], s65 offen nt
    s_addk_i32 s65, 4096
    buffer_load_dwordx4 v[72:75], v14, s[44:47], s65 offen nt
    s_addk_i32 s65, 4096
    buffer_load_dwordx4 v[76:79], v15, s[44:47], s65 offen nt
    s_addk_i32 s65, 4096
    buffer_load_dwordx4 v[80:83], v12, s[44:47], s65 offen nt
    s_addk_i32 s65, 4096
    buffer_load_dwordx4 v[84:87], v13, s[44:47], s65 offen nt
    s_addk_i32 s65, 4096
    buffer_load_dwordx4 v[88:91], v14, s[44:47], s65 offen nt
    s_addk_i32 s65, 4096
    buffer_load_dwordx4 v[92:95], v15, s[44:47], s65 offen nt
    s_addk_i32 s65, 4096
    s_barrier
    s_barrier
    s_barrier
    s_setprio 3
    s_lshl_b32 s7, s60, 10
    v_add_u32 v3, s7, v2
    s_waitcnt vmcnt(15)
    ds_write_b128 v3, v[32:35] offset:0
    s_waitcnt vmcnt(14)
    ds_write_b128 v3, v[36:39] offset:4096
    s_waitcnt vmcnt(13)
    ds_write_b128 v3, v[40:43] offset:8192
    s_waitcnt vmcnt(12)
    ds_write_b128 v3, v[44:47] offset:12288
    s_waitcnt vmcnt(11)
    ds_write_b128 v3, v[48:51] offset:16384
    s_waitcnt vmcnt(10)
    ds_write_b128 v3, v[52:55] offset:20480
    s_waitcnt vmcnt(9)
    ds_write_b128 v3, v[56:59] offset:24576
    s_waitcnt vmcnt(8)
    ds_write_b128 v3, v[60:63] offset:28672
    s_waitcnt vmcnt(7)
    ds_write_b128 v3, v[64:67] offset:32768
    s_waitcnt vmcnt(6)
    ds_write_b128 v3, v[68:71] offset:36864
    s_waitcnt vmcnt(5)
    ds_write_b128 v3, v[72:75] offset:40960
    s_waitcnt vmcnt(4)
    ds_write_b128 v3, v[76:79] offset:45056
    s_waitcnt vmcnt(3)
    ds_write_b128 v3, v[80:83] offset:49152
    s_waitcnt vmcnt(2)
    ds_write_b128 v3, v[84:87] offset:53248
    s_waitcnt vmcnt(1)
    ds_write_b128 v3, v[88:91] offset:57344
    s_waitcnt vmcnt(0)
    ds_write_b128 v3, v[92:95] offset:61440
    s_waitcnt lgkmcnt(0)
    s_endpgm
.p2align 12
LT_U1:
    s_branch LR_U1
L_U1:
    s_mov_b32 s48, s26
    s_and_b32 s49, s27, 0xffff
    s_mov_b32 s50, 0x400000
    s_mov_b32 s51, 0x20000
    v_lshrrev_b32 v162, 4, v1
    v_lshlrev_b32 v2, 16, v162
    v_and_b32 v160, 15, v1
    v_lshl_add_u32 v2, v160, 4, v2
    s_lshl_b32 s7, s6, 8
    v_add_u32 v2, s7, v2
    s_lshl_b32 s70, s3, 19
    s_waitcnt vmcnt(2)
    buffer_load_dwordx4 v[8:11], v2, s[48:51], s70 offen nt
    s_add_u32 s70, s70, 8192
    s_waitcnt vmcnt(2)
    buffer_load_dwordx4 v[12:15], v2, s[48:51], s70 offen nt
    s_add_u32 s70, s70, 8192
    s_waitcnt vmcnt(2)
    buffer_load_dwordx4 v[16:19], v2, s[48:51], s70 offen nt
    s_add_u32 s70, s70, 8192
    s_waitcnt vmcnt(2)
    buffer_load_dwordx4 v[20:23], v2, s[48:51], s70 offen nt
    s_add_u32 s70, s70, 8192
    s_waitcnt vmcnt(2)
    buffer_load_dwordx4 v[24:27], v2, s[48:51], s70 offen nt
    s_add_u32 s70, s70, 8192
    s_waitcnt vmcnt(2)
    buffer_load_dwordx4 v[28:31], v2, s[48:51], s70 offen nt
    s_add_u32 s70, s70, 8192
    s_waitcnt vmcnt(2)
    buffer_load_dwordx4 v[32:35], v2, s[48:51], s70 offen nt
    s_add_u32 s70, s70, 8192
    s_waitcnt vmcnt(2)
    buffer_load_dwordx4 v[36:39], v2, s[48:51], s70 offen nt
    s_add_u32 s70, s70, 204800
    s_waitcnt vmcnt(2)
    buffer_load_dwordx4 v[104:107], v2, s[48:51], s70 offen nt
    s_add_u32 s70, s70, 8192
    s_waitcnt vmcnt(2)
    buffer_load_dwordx4 v[108:111], v2, s[48:51], s70 offen nt
    s_add_u32 s70, s70, 8192
    s_waitcnt vmcnt(2)
    buffer_load_dwordx4 v[112:115], v2, s[48:51], s70 offen nt
    s_add_u32 s70, s70, 8192
    s_waitcnt vmcnt(2)
    buffer_load_dwordx4 v[116:119], v2, s[48:51], s70 offen nt
    s_add_u32 s70, s70, 8192
    s_waitcnt vmcnt(2)
    buffer_load_dwordx4 v[120:123], v2, s[48:51], s70 offen nt
    s_add_u32 s70, s70, 8192
    s_waitcnt vmcnt(2)
    buffer_load_dwordx4 v[124:127], v2, s[48:51], s70 offen nt
    s_add_u32 s70, s70, 8192
    s_waitcnt vmcnt(2)
    buffer_load_dwordx4 v[128:131], v2, s[48:51], s70 offen nt
    s_add_u32 s70, s70, 8192
    s_waitcnt vmcnt(2)
    buffer_load_dwordx4 v[132:135], v2, s[48:51], s70 offen nt
    s_add_u32 s70, s70, 204800
    v_lshlrev_b32 v3, 4, v1
    v_add_u32 v3, 0x24800, v3
    v_lshrrev_b32 v4, 1, v160
    v_lshlrev_b32 v4, 18, v4
    v_lshl_add_u32 v4, v162, 4, v4
    v_and_b32 v163, 1, v1
    v_lshl_add_u32 v4, v163, 6, v4
    v_cmp_eq_u32 s[86:87], 1, v163
    s_lshl_b32 s7, s3, 5
    s_add_u32 s7, s7, s6
    s_lshl_b32 s7, s7, 7
    s_add_u32 s7, s7, 0x500000
    v_add_u32 v4, s7, v4
    s_lshl_b32 s7, s3, 11
    s_add_u32 s7, s7, 0x10000
    v_lshl_add_u32 v5, v1, 5, s7
    v_perm_b32 v40, v12, v8, s92
    v_perm_b32 v41, v20, v16, s92
    v_perm_b32 v42, v28, v24, s92
    v_perm_b32 v43, v36, v32, s92
    v_perm_b32 v44, v12, v8, s93
    v_perm_b32 v45, v20, v16, s93
    v_perm_b32 v46, v28, v24, s93
    v_perm_b32 v47, v36, v32, s93
    v_perm_b32 v48, v13, v9, s92
    v_perm_b32 v49, v21, v17, s92
    v_perm_b32 v50, v29, v25, s92
    v_perm_b32 v51, v37, v33, s92
    v_perm_b32 v52, v13, v9, s93
    v_perm_b32 v53, v21, v17, s93
    v_perm_b32 v54, v29, v25, s93
    v_perm_b32 v55, v37, v33, s93
    v_perm_b32 v56, v14, v10, s92
    v_perm_b32 v57, v22, v18, s92
    v_perm_b32 v58, v30, v26, s92
    v_perm_b32 v59, v38, v34, s92
    v_perm_b32 v60, v14, v10, s93
    v_perm_b32 v61, v22, v18, s93
    v_perm_b32 v62, v30, v26, s93
    v_perm_b32 v63, v38, v34, s93
    v_perm_b32 v64, v15, v11, s92
    v_perm_b32 v65, v23, v19, s92
    v_perm_b32 v66, v31, v27, s92
    v_perm_b32 v67, v39, v35, s92
    v_perm_b32 v68, v15, v11, s93
    v_perm_b32 v69, v23, v19, s93
    v_perm_b32 v70, v31, v27, s93
    v_perm_b32 v71, v39, v35, s93
    s_waitcnt vmcnt(0)
    v_perm_b32 v72, v108, v104, s92
    v_perm_b32 v73, v116, v112, s92
    v_perm_b32 v74, v124, v120, s92
    v_perm_b32 v75, v132, v128, s92
    v_perm_b32 v76, v108, v104, s93
    v_perm_b32 v77, v116, v112, s93
    v_perm_b32 v78, v124, v120, s93
    v_perm_b32 v79, v132, v128, s93
    v_perm_b32 v80, v109, v105, s92
    v_perm_b32 v81, v117, v113, s92
    v_perm_b32 v82, v125, v121, s92
    v_perm_b32 v83, v133, v129, s92
    v_perm_b32 v84, v109, v105, s93
    v_perm_b32 v85, v117, v113, s93
    v_perm_b32 v86, v125, v121, s93
    v_perm_b32 v87, v133, v129, s93
    v_perm_b32 v88, v110, v106, s92
    v_perm_b32 v89, v118, v114, s92
    v_perm_b32 v90, v126, v122, s92
    v_perm_b32 v91, v134, v130, s92
    v_perm_b32 v92, v110, v106, s93
    v_perm_b32 v93, v118, v114, s93
    v_perm_b32 v94, v126, v122, s93
    v_perm_b32 v95, v134, v130, s93
    v_perm_b32 v96, v111, v107, s92
    v_perm_b32 v97, v119, v115, s92
    v_perm_b32 v98, v127, v123, s92
    v_perm_b32 v99, v135, v131, s92
    v_perm_b32 v100, v111, v107, s93
    v_perm_b32 v101, v119, v115, s93
    v_perm_b32 v102, v127, v123, s93
    v_perm_b32 v103, v135, v131, s93
    v_mov_b32 v160, 0x2404c
    s_mov_b32 s80, 1600000
LW_53:
    ds_read_b32 v161, v160
    s_waitcnt lgkmcnt(0)
    v_readfirstlane_b32 s79, v161
    s_cmp_ge_u32 s79, 1
    s_cbranch_scc1 LWD_54
    s_sleep 2
    s_sub_u32 s80, s80, 1
    s_cmp_lg_u32 s80, 0
    s_cbranch_scc1 LW_53
LWD_54:
    v_mov_b32 v160, 0x24050
    ds_read_b64 v[162:163], v160
    s_waitcnt lgkmcnt(0)
    v_readfirstlane_b32 s94, v162
    v_readfirstlane_b32 s95, v163
    v_mov_b32 v160, 0x2401c
    s_mov_b32 s80, 1600000
LW_55:
    ds_read_b32 v161, v160
    s_waitcnt lgkmcnt(0)
    v_readfirstlane_b32 s79, v161
    s_cmp_ge_u32 s79, 1
    s_cbranch_scc1 LWD_56
    s_sleep 4
    s_sub_u32 s80, s80, 1
    s_cmp_lg_u32 s80, 0
    s_cbranch_scc1 LW_55
LWD_56:
    s_setprio 3
    s_mov_b64 s[88:89], 0
    s_mov_b32 s80, 1600000
UM_57:
    ds_read_b128 v[136:139], v3
    s_waitcnt lgkmcnt(0)
    v_cmp_ne_u64 vcc, s[94:95], v[138:139]
    s_or_b64 s[90:91], vcc, s[88:89]
    s_and_b32 s7, s90, 0x5555
    s_cbranch_scc1 UMS_59
    s_mov_b32 s70, 0
    buffer_load_dwordx4 v[8:11], v4, s[36:39], s70 offen sc1
    s_or_b32 s88, s88, 0x5555
UMS_59:
    s_and_b32 s7, s90, 0x55550000
    s_cbranch_scc1 UMS_60
    s_mov_b32 s70, 32768
    buffer_load_dwordx4 v[12:15], v4, s[36:39], s70 offen sc1
    s_or_b32 s88, s88, 0x55550000
UMS_60:
    s_and_b32 s7, s91, 0x5555
    s_cbranch_scc1 UMS_61
    s_mov_b32 s70, 65536
    buffer_load_dwordx4 v[16:19], v4, s[36:39], s70 offen sc1
    s_or_b32 s89, s89, 0x5555
UMS_61:
    s_and_b32 s7, s91, 0x55550000
    s_cbranch_scc1 UMS_62
    s_mov_b32 s70, 98304
    buffer_load_dwordx4 v[20:23], v4, s[36:39], s70 offen sc1
    s_or_b32 s89, s89, 0x55550000
UMS_62:
    s_and_b32 s7, s90, 0xaaaa
    s_cbranch_scc1 UMS_63
    s_mov_b32 s70, 131072
    buffer_load_dwordx4 v[24:27], v4, s[36:39], s70 offen sc1
    s_or_b32 s88, s88, 0xaaaa
UMS_63:
    s_and_b32 s7, s90, 0xaaaa0000
    s_cbranch_scc1 UMS_64
    s_mov_b32 s70, 163840
    buffer_load_dwordx4 v[28:31], v4, s[36:39], s70 offen sc1
    s_or_b32 s88, s88, 0xaaaa0000
UMS_64:
    s_and_b32 s7, s91, 0xaaaa
    s_cbranch_scc1 UMS_65
    s_mov_b32 s70, 196608
    buffer_load_dwordx4 v[32:35], v4, s[36:39], s70 offen sc1
    s_or_b32 s89, s89, 0xaaaa
UMS_65:
    s_and_b32 s7, s91, 0xaaaa0000
    s_cbranch_scc1 UMS_66
    s_mov_b32 s70, 229376
    buffer_load_dwordx4 v[36:39], v4, s[36:39], s70 offen sc1
    s_or_b32 s89, s89, 0xaaaa0000
UMS_66:
    s_cbranch_vccz UMD_58
    s_sleep 1
    s_sub_u32 s80, s80, 1
    s_cmp_lg_u32 s80, 0
    s_cbranch_scc1 UM_57
UMD_58:
    v_max_f32_dpp v138, v136, v136 quad_perm:[1,0,3,2] row_mask:0xf bank_mask:0xf
    s_nop 1
    v_max_f32_dpp v138, v138, v138 quad_perm:[2,3,0,1] row_mask:0xf bank_mask:0xf
    v_mov_b32 v139, v138
    s_nop 1
    v_permlane32_swap_b32 v138, v139
    v_max_f32 v138, v138, v139
    v_mov_b32 v139, v138
    s_nop 1
    v_permlane16_swap_b32 v138, v139
    v_max_f32 v138, v138, v139
    v_sub_f32 v136, v136, v138
    v_exp_f32 v136, v136
    s_nop 0
    v_mul_f32 v137, v137, v136
    s_nop 1
    v_add_f32_dpp v137, v137, v137 quad_perm:[1,0,3,2] row_mask:0xf bank_mask:0xf
    s_nop 1
    v_add_f32_dpp v137, v137, v137 quad_perm:[2,3,0,1] row_mask:0xf bank_mask:0xf
    v_mov_b32 v138, v137
    s_nop 1
    v_permlane32_swap_b32 v137, v138
    v_add_f32 v137, v137, v138
    v_mov_b32 v138, v137
    s_nop 1
    v_permlane16_swap_b32 v137, v138
    v_add_f32 v137, v137, v138
    v_rcp_f32 v137, v137
    s_nop 0
    v_mul_f32 v136, v136, v137
    v_mov_b32 v137, v136
    s_nop 1
    v_permlane16_swap_b32 v136, v137
    v_mov_b32 v138, v136
    v_mov_b32 v139, v137
    s_nop 0
    v_permlane32_swap_b32 v136, v138
    v_permlane32_swap_b32 v137, v139
    s_nop 0
    v_mov_b32_dpp v148, v136 quad_perm:[0,0,2,2] row_mask:0xf bank_mask:0xf
    v_mov_b32_dpp v149, v137 quad_perm:[0,0,2,2] row_mask:0xf bank_mask:0xf
    v_mov_b32_dpp v150, v138 quad_perm:[0,0,2,2] row_mask:0xf bank_mask:0xf
    v_mov_b32_dpp v151, v139 quad_perm:[0,0,2,2] row_mask:0xf bank_mask:0xf
    v_mov_b32_dpp v152, v136 quad_perm:[1,1,3,3] row_mask:0xf bank_mask:0xf
    v_mov_b32_dpp v153, v137 quad_perm:[1,1,3,3] row_mask:0xf bank_mask:0xf
    v_mov_b32_dpp v154, v138 quad_perm:[1,1,3,3] row_mask:0xf bank_mask:0xf
    v_mov_b32_dpp v155, v139 quad_perm:[1,1,3,3] row_mask:0xf bank_mask:0xf
    s_waitcnt vmcnt(0)
    v_lshlrev_b32 v104, 16, v8
    v_and_b32 v105, 0xffff0000, v8
    v_lshlrev_b32 v106, 16, v9
    v_and_b32 v107, 0xffff0000, v9
    v_lshlrev_b32 v108, 16, v10
    v_and_b32 v109, 0xffff0000, v10
    v_lshlrev_b32 v110, 16, v11
    v_and_b32 v111, 0xffff0000, v11
    v_mul_f32 v120, v104, v148
    v_mul_f32 v121, v105, v148
    v_mul_f32 v122, v106, v148
    v_mul_f32 v123, v107, v148
    v_mul_f32 v124, v108, v148
    v_mul_f32 v125, v109, v148
    v_mul_f32 v126, v110, v148
    v_mul_f32 v127, v111, v148
    v_lshlrev_b32 v112, 16, v12
    v_and_b32 v113, 0xffff0000, v12
    v_lshlrev_b32 v114, 16, v13
    v_and_b32 v115, 0xffff0000, v13
    v_lshlrev_b32 v116, 16, v14
    v_and_b32 v117, 0xffff0000, v14
    v_lshlrev_b32 v118, 16, v15
    v_and_b32 v119, 0xffff0000, v15
    v_fmac_f32 v120, v112, v149
    v_fmac_f32 v121, v113, v149
    v_fmac_f32 v122, v114, v149
    v_fmac_f32 v123, v115, v149
    v_fmac_f32 v124, v116, v149
    v_fmac_f32 v125, v117, v149
    v_fmac_f32 v126, v118, v149
    v_fmac_f32 v127, v119, v149
    v_lshlrev_b32 v104, 16, v16
    v_and_b32 v105, 0xffff0000, v16
    v_lshlrev_b32 v106, 16, v17
    v_and_b32 v107, 0xffff0000, v17
    v_lshlrev_b32 v108, 16, v18
    v_and_b32 v109, 0xffff0000, v18
    v_lshlrev_b32 v110, 16, v19
    v_and_b32 v111, 0xffff0000, v19
    v_fmac_f32 v120, v104, v150
    v_fmac_f32 v121, v105, v150
    v_fmac_f32 v122, v106, v150
    v_fmac_f32 v123, v107, v150
    v_fmac_f32 v124, v108, v150
    v_fmac_f32 v125, v109, v150
    v_fmac_f32 v126, v110, v150
    v_fmac_f32 v127, v111, v150
    v_lshlrev_b32 v112, 16, v20
    v_and_b32 v113, 0xffff0000, v20
    v_lshlrev_b32 v114, 16, v21
    v_and_b32 v115, 0xffff0000, v21
    v_lshlrev_b32 v116, 16, v22
    v_and_b32 v117, 0xffff0000, v22
    v_lshlrev_b32 v118, 16, v23
    v_and_b32 v119, 0xffff0000, v23
    v_fmac_f32 v120, v112, v151
    v_fmac_f32 v121, v113, v151
    v_fmac_f32 v122, v114, v151
    v_fmac_f32 v123, v115, v151
    v_fmac_f32 v124, v116, v151
    v_fmac_f32 v125, v117, v151
    v_fmac_f32 v126, v118, v151
    v_fmac_f32 v127, v119, v151
    v_lshlrev_b32 v104, 16, v24
    v_and_b32 v105, 0xffff0000, v24
    v_lshlrev_b32 v106, 16, v25
    v_and_b32 v107, 0xffff0000, v25
    v_lshlrev_b32 v108, 16, v26
    v_and_b32 v109, 0xffff0000, v26
    v_lshlrev_b32 v110, 16, v27
    v_and_b32 v111, 0xffff0000, v27
    v_fmac_f32 v120, v104, v152
    v_fmac_f32 v121, v105, v152
    v_fmac_f32 v122, v106, v152
    v_fmac_f32 v123, v107, v152
    v_fmac_f32 v124, v108, v152
    v_fmac_f32 v125, v109, v152
    v_fmac_f32 v126, v110, v152
    v_fmac_f32 v127, v111, v152
    v_lshlrev_b32 v112, 16, v28
    v_and_b32 v113, 0xffff0000, v28
    v_lshlrev_b32 v114, 16, v29
    v_and_b32 v115, 0xffff0000, v29
    v_lshlrev_b32 v116, 16, v30
    v_and_b32 v117, 0xffff0000, v30
    v_lshlrev_b32 v118, 16, v31
    v_and_b32 v119, 0xffff0000, v31
    v_fmac_f32 v120, v112, v153
    v_fmac_f32 v121, v113, v153
    v_fmac_f32 v122, v114, v153
    v_fmac_f32 v123, v115, v153
    v_fmac_f32 v124, v116, v153
    v_fmac_f32 v125, v117, v153
    v_fmac_f32 v126, v118, v153
    v_fmac_f32 v127, v119, v153
    v_lshlrev_b32 v104, 16, v32
    v_and_b32 v105, 0xffff0000, v32
    v_lshlrev_b32 v106, 16, v33
    v_and_b32 v107, 0xffff0000, v33
    v_lshlrev_b32 v108, 16, v34
    v_and_b32 v109, 0xffff0000, v34
    v_lshlrev_b32 v110, 16, v35
    v_and_b32 v111, 0xffff0000, v35
    v_fmac_f32 v120, v104, v154
    v_fmac_f32 v121, v105, v154
    v_fmac_f32 v122, v106, v154
    v_fmac_f32 v123, v107, v154
    v_fmac_f32 v124, v108, v154
    v_fmac_f32 v125, v109, v154
    v_fmac_f32 v126, v110, v154
    v_fmac_f32 v127, v111, v154
    v_lshlrev_b32 v112, 16, v36
    v_and_b32 v113, 0xffff0000, v36
    v_lshlrev_b32 v114, 16, v37
    v_and_b32 v115, 0xffff0000, v37
    v_lshlrev_b32 v116, 16, v38
    v_and_b32 v117, 0xffff0000, v38
    v_lshlrev_b32 v118, 16, v39
    v_and_b32 v119, 0xffff0000, v39
    v_fmac_f32 v120, v112, v155
    v_fmac_f32 v121, v113, v155
    v_fmac_f32 v122, v114, v155
    v_fmac_f32 v123, v115, v155
    v_fmac_f32 v124, v116, v155
    v_fmac_f32 v125, v117, v155
    v_fmac_f32 v126, v118, v155
    v_fmac_f32 v127, v119, v155
    v_cvt_pk_bf16_f32 v128, v120, v121
    v_cvt_pk_bf16_f32 v129, v122, v123
    v_cvt_pk_bf16_f32 v130, v124, v125
    v_cvt_pk_bf16_f32 v131, v126, v127
    v_cndmask_b32 v140, v128, 0, s[86:87]
    v_cndmask_b32 v144, 0, v128, s[86:87]
    v_cndmask_b32 v141, v129, 0, s[86:87]
    v_cndmask_b32 v145, 0, v129, s[86:87]
    v_cndmask_b32 v142, v130, 0, s[86:87]
    v_cndmask_b32 v146, 0, v130, s[86:87]
    v_cndmask_b32 v143, v131, 0, s[86:87]
    v_cndmask_b32 v147, 0, v131, s[86:87]
    s_nop 0
    v_mfma_f32_16x16x32_bf16 v[8:11], v[140:143], v[40:43], 0
    v_mfma_f32_16x16x32_bf16 v[12:15], v[140:143], v[44:47], 0
    v_mfma_f32_16x16x32_bf16 v[16:19], v[140:143], v[48:51], 0
    v_mfma_f32_16x16x32_bf16 v[20:23], v[140:143], v[52:55], 0
    v_mfma_f32_16x16x32_bf16 v[24:27], v[140:143], v[56:59], 0
    v_mfma_f32_16x16x32_bf16 v[28:31], v[140:143], v[60:63], 0
    v_mfma_f32_16x16x32_bf16 v[32:35], v[140:143], v[64:67], 0
    v_mfma_f32_16x16x32_bf16 v[36:39], v[140:143], v[68:71], 0
    v_mfma_f32_16x16x32_bf16 v[8:11], v[144:147], v[72:75], v[8:11]
    v_mfma_f32_16x16x32_bf16 v[12:15], v[144:147], v[76:79], v[12:15]
    v_mfma_f32_16x16x32_bf16 v[16:19], v[144:147], v[80:83], v[16:19]
    v_mfma_f32_16x16x32_bf16 v[20:23], v[144:147], v[84:87], v[20:23]
    v_mfma_f32_16x16x32_bf16 v[24:27], v[144:147], v[88:91], v[24:27]
    v_mfma_f32_16x16x32_bf16 v[28:31], v[144:147], v[92:95], v[28:31]
    v_mfma_f32_16x16x32_bf16 v[32:35], v[144:147], v[96:99], v[32:35]
    v_mfma_f32_16x16x32_bf16 v[36:39], v[144:147], v[100:103], v[36:39]
    s_nop 0
    v_add_f32 v8, v8, v10
    v_add_f32 v9, v9, v11
    v_add_f32 v12, v12, v14
    v_add_f32 v13, v13, v15
    v_add_f32 v16, v16, v18
    v_add_f32 v17, v17, v19
    v_add_f32 v20, v20, v22
    v_add_f32 v21, v21, v23
    v_add_f32 v24, v24, v26
    v_add_f32 v25, v25, v27
    v_add_f32 v28, v28, v30
    v_add_f32 v29, v29, v31
    v_add_f32 v32, v32, v34
    v_add_f32 v33, v33, v35
    v_add_f32 v36, v36, v38
    v_add_f32 v37, v37, v39
    v_add_f32 v104, v8, v9
    v_add_f32 v105, v12, v13
    v_add_f32 v106, v16, v17
    v_add_f32 v107, v20, v21
    v_add_f32 v108, v24, v25
    v_add_f32 v109, v28, v29
    v_add_f32 v110, v32, v33
    v_add_f32 v111, v36, v37
    ds_write_b128 v5, v[104:107]
    ds_write_b128 v5, v[108:111] offset:16
    v_and_b32 v160, 31, v1
    s_lshl_b32 s7, s3, 8
    s_add_u32 s7, s7, 0x10000
    v_lshl_add_u32 v5, v160, 3, s7
    s_lshl_b32 s7, s3, 7
    s_add_u32 s7, s7, 0x24400
    v_lshl_add_u32 v4, v160, 2, s7
    s_waitcnt lgkmcnt(0)
    s_barrier
    ds_read_b64 v[8:9], v5 offset:0
    ds_read_b64 v[10:11], v5 offset:2048
    ds_read_b64 v[12:13], v5 offset:4096
    ds_read_b64 v[14:15], v5 offset:6144
    ds_read_b64 v[16:17], v5 offset:8192
    ds_read_b64 v[18:19], v5 offset:10240
    ds_read_b64 v[20:21], v5 offset:12288
    ds_read_b64 v[22:23], v5 offset:14336
    s_waitcnt lgkmcnt(0)
    v_add_f32 v8, v8, v16
    v_add_f32 v9, v9, v17
    v_add_f32 v10, v10, v18
    v_add_f32 v11, v11, v19
    v_add_f32 v12, v12, v20
    v_add_f32 v13, v13, v21
    v_add_f32 v14, v14, v22
    v_add_f32 v15, v15, v23
    v_add_f32 v8, v8, v12
    v_add_f32 v9, v9, v13
    v_add_f32 v10, v10, v14
    v_add_f32 v11, v11, v15
    v_add_f32 v8, v8, v10
    v_add_f32 v9, v9, v11
    v_cvt_pk_bf16_f32 v8, v8, v9
    ds_write_b32 v4, v8
    s_waitcnt lgkmcnt(0)
    s_barrier
    s_endpgm
.p2align 12
LT_W2R:
    s_branch LR_W2R
L_W2R:
    s_cmp_lt_u32 s5, 4
    s_cselect_b32 s72, s28, s16
    s_cselect_b32 s73, s29, s17
    s_mov_b32 s56, s72
    s_and_b32 s57, s73, 0xffff
    s_mov_b32 s58, 0x400000
    s_mov_b32 s59, 0x20000
    v_lshrrev_b32 v4, 4, v1
    v_lshlrev_b32 v2, 13, v4
    v_and_b32 v4, 15, v1
    v_lshl_add_u32 v2, v4, 4, v2
    s_lshl_b32 s7, s6, 17
    s_lshl_b32 s70, s62, 8
    s_add_u32 s7, s7, s70
    v_add_u32 v2, s7, v2
    v_lshrrev_b32 v3, 4, v1
    v_lshlrev_b32 v3, 16, v3
    v_bfe_u32 v4, v1, 3, 1
    v_lshl_add_u32 v3, v4, 13, v3
    v_and_b32 v4, 7, v1
    v_lshl_add_u32 v3, v4, 4, v3
    s_cmp_lt_u32 s5, 4
    s_cselect_b32 s7, 0x800, 0x0
    s_add_u32 s7, s7, s6
    s_lshl_b32 s7, s7, 7
    s_add_u32 s7, s7, 0x100000
    v_add_u32 v3, s7, v3
    s_lshl_b32 s7, s62, 14
    v_add_u32 v3, s7, v3
    s_waitcnt vmcnt(0)
    v_mov_b32 v4, 0x24014
    v_mov_b32 v5, 1
    s_waitcnt lgkmcnt(0)
    s_mov_b64 exec, 1
    ds_add_u32 v4, v5
    s_mov_b64 exec, -1
    s_mov_b32 s70, 0
    v_mov_b32 v4, 0x24048
    s_mov_b32 s80, 1600000
LW_71:
    ds_read_b32 v5, v4
    s_waitcnt lgkmcnt(0)
    v_readfirstlane_b32 s79, v5
    s_cmp_ge_u32 s79, 4
    s_cbranch_scc1 LWD_72
    s_sleep 4
    s_sub_u32 s80, s80, 1
    s_cmp_lg_u32 s80, 0
    s_cbranch_scc1 LW_71
LWD_72:
    s_cmp_lt_u32 s5, 4
    s_cbranch_scc1 S2U_69
    buffer_load_dwordx4 v[40:43], v2, s[56:59], s70 offen offset:0 nt
    buffer_load_dwordx4 v[44:47], v2, s[56:59], s70 offen offset:1024 nt
    s_waitcnt vmcnt(0)
    buffer_load_dwordx4 v[48:51], v2, s[56:59], s70 offen offset:2048 nt
    buffer_load_dwordx4 v[52:55], v2, s[56:59], s70 offen offset:3072 nt
    s_add_u32 s70, s70, 4096
    s_waitcnt vmcnt(0)
    buffer_load_dwordx4 v[56:59], v2, s[56:59], s70 offen offset:0 nt
    buffer_load_dwordx4 v[60:63], v2, s[56:59], s70 offen offset:1024 nt
    s_waitcnt vmcnt(0)
    buffer_load_dwordx4 v[64:67], v2, s[56:59], s70 offen offset:2048 nt
    buffer_load_dwordx4 v[68:71], v2, s[56:59], s70 offen offset:3072 nt
    s_add_u32 s70, s70, 28672
    s_waitcnt vmcnt(0)
    buffer_load_dwordx4 v[72:75], v2, s[56:59], s70 offen offset:0 nt
    buffer_load_dwordx4 v[76:79], v2, s[56:59], s70 offen offset:1024 nt
    s_waitcnt vmcnt(0)
    buffer_load_dwordx4 v[80:83], v2, s[56:59], s70 offen offset:2048 nt
    buffer_load_dwordx4 v[84:87], v2, s[56:59], s70 offen offset:3072 nt
    s_add_u32 s70, s70, 4096
    s_waitcnt vmcnt(0)
    buffer_load_dwordx4 v[88:91], v2, s[56:59], s70 offen offset:0 nt
    buffer_load_dwordx4 v[92:95], v2, s[56:59], s70 offen offset:1024 nt
    s_waitcnt vmcnt(0)
    buffer_load_dwordx4 v[96:99], v2, s[56:59], s70 offen offset:2048 nt
    buffer_load_dwordx4 v[100:103], v2, s[56:59], s70 offen offset:3072 nt
    s_add_u32 s70, s70, 28672
    s_waitcnt vmcnt(0)
    buffer_load_dwordx4 v[104:107], v2, s[56:59], s70 offen offset:0 nt
    buffer_load_dwordx4 v[108:111], v2, s[56:59], s70 offen offset:1024 nt
    buffer_load_dwordx4 v[112:115], v2, s[56:59], s70 offen offset:2048 nt
    buffer_load_dwordx4 v[116:119], v2, s[56:59], s70 offen offset:3072 nt
    s_add_u32 s70, s70, 4096
    s_waitcnt vmcnt(0)
    buffer_load_dwordx4 v[120:123], v2, s[56:59], s70 offen offset:0 nt
    buffer_load_dwordx4 v[124:127], v2, s[56:59], s70 offen offset:1024 nt
    buffer_load_dwordx4 v[128:131], v2, s[56:59], s70 offen offset:2048 nt
    buffer_load_dwordx4 v[132:135], v2, s[56:59], s70 offen offset:3072 nt
    s_add_u32 s70, s70, 28672
    s_waitcnt vmcnt(0)
    buffer_load_dwordx4 v[136:139], v2, s[56:59], s70 offen offset:0 nt
    buffer_load_dwordx4 v[140:143], v2, s[56:59], s70 offen offset:1024 nt
    buffer_load_dwordx4 v[144:147], v2, s[56:59], s70 offen offset:2048 nt
    buffer_load_dwordx4 v[148:151], v2, s[56:59], s70 offen offset:3072 nt
    s_add_u32 s70, s70, 4096
    s_waitcnt vmcnt(0)
    buffer_load_dwordx4 v[152:155], v2, s[56:59], s70 offen offset:0 nt
    buffer_load_dwordx4 v[156:159], v2, s[56:59], s70 offen offset:1024 nt
    buffer_load_dwordx4 v[160:163], v2, s[56:59], s70 offen offset:2048 nt
    buffer_load_dwordx4 v[164:167], v2, s[56:59], s70 offen offset:3072 nt
    s_add_u32 s70, s70, 28672
    s_waitcnt vmcnt(0)
    s_branch S2J_70
S2U_69:
    buffer_load_dwordx4 v[40:43], v2, s[56:59], s70 offen offset:0 nt
    buffer_load_dwordx4 v[44:47], v2, s[56:59], s70 offen offset:1024 nt
    buffer_load_dwordx4 v[48:51], v2, s[56:59], s70 offen offset:2048 nt
    buffer_load_dwordx4 v[52:55], v2, s[56:59], s70 offen offset:3072 nt
    s_add_u32 s70, s70, 4096
    s_waitcnt vmcnt(2)
    buffer_load_dwordx4 v[56:59], v2, s[56:59], s70 offen offset:0 nt
    buffer_load_dwordx4 v[60:63], v2, s[56:59], s70 offen offset:1024 nt
    buffer_load_dwordx4 v[64:67], v2, s[56:59], s70 offen offset:2048 nt
    buffer_load_dwordx4 v[68:71], v2, s[56:59], s70 offen offset:3072 nt
    s_add_u32 s70, s70, 28672
    s_waitcnt vmcnt(2)
    buffer_load_dwordx4 v[72:75], v2, s[56:59], s70 offen offset:0 nt
    buffer_load_dwordx4 v[76:79], v2, s[56:59], s70 offen offset:1024 nt
    buffer_load_dwordx4 v[80:83], v2, s[56:59], s70 offen offset:2048 nt
    buffer_load_dwordx4 v[84:87], v2, s[56:59], s70 offen offset:3072 nt
    s_add_u32 s70, s70, 4096
    s_waitcnt vmcnt(2)
    buffer_load_dwordx4 v[88:91], v2, s[56:59], s70 offen offset:0 nt
    buffer_load_dwordx4 v[92:95], v2, s[56:59], s70 offen offset:1024 nt
    buffer_load_dwordx4 v[96:99], v2, s[56:59], s70 offen offset:2048 nt
    buffer_load_dwordx4 v[100:103], v2, s[56:59], s70 offen offset:3072 nt
    s_add_u32 s70, s70, 28672
    s_waitcnt vmcnt(2)
    buffer_load_dwordx4 v[104:107], v2, s[56:59], s70 offen offset:0 nt
    buffer_load_dwordx4 v[108:111], v2, s[56:59], s70 offen offset:1024 nt
    buffer_load_dwordx4 v[112:115], v2, s[56:59], s70 offen offset:2048 nt
    buffer_load_dwordx4 v[116:119], v2, s[56:59], s70 offen offset:3072 nt
    s_add_u32 s70, s70, 4096
    s_waitcnt vmcnt(2)
    buffer_load_dwordx4 v[120:123], v2, s[56:59], s70 offen offset:0 nt
    buffer_load_dwordx4 v[124:127], v2, s[56:59], s70 offen offset:1024 nt
    buffer_load_dwordx4 v[128:131], v2, s[56:59], s70 offen offset:2048 nt
    buffer_load_dwordx4 v[132:135], v2, s[56:59], s70 offen offset:3072 nt
    s_add_u32 s70, s70, 28672
    s_waitcnt vmcnt(2)
    buffer_load_dwordx4 v[136:139], v2, s[56:59], s70 offen offset:0 nt
    buffer_load_dwordx4 v[140:143], v2, s[56:59], s70 offen offset:1024 nt
    buffer_load_dwordx4 v[144:147], v2, s[56:59], s70 offen offset:2048 nt
    buffer_load_dwordx4 v[148:151], v2, s[56:59], s70 offen offset:3072 nt
    s_add_u32 s70, s70, 4096
    s_waitcnt vmcnt(2)
    buffer_load_dwordx4 v[152:155], v2, s[56:59], s70 offen offset:0 nt
    buffer_load_dwordx4 v[156:159], v2, s[56:59], s70 offen offset:1024 nt
    buffer_load_dwordx4 v[160:163], v2, s[56:59], s70 offen offset:2048 nt
    buffer_load_dwordx4 v[164:167], v2, s[56:59], s70 offen offset:3072 nt
    s_add_u32 s70, s70, 28672
    s_waitcnt vmcnt(0)
S2J_70:
    v_perm_b32 v8, v44, v40, s92
    v_perm_b32 v9, v52, v48, s92
    v_perm_b32 v10, v60, v56, s92
    v_perm_b32 v11, v68, v64, s92
    v_perm_b32 v12, v44, v40, s93
    v_perm_b32 v13, v52, v48, s93
    v_perm_b32 v14, v60, v56, s93
    v_perm_b32 v15, v68, v64, s93
    v_perm_b32 v16, v45, v41, s92
    v_perm_b32 v17, v53, v49, s92
    v_perm_b32 v18, v61, v57, s92
    v_perm_b32 v19, v69, v65, s92
    v_perm_b32 v20, v45, v41, s93
    v_perm_b32 v21, v53, v49, s93
    v_perm_b32 v22, v61, v57, s93
    v_perm_b32 v23, v69, v65, s93
    v_perm_b32 v24, v46, v42, s92
    v_perm_b32 v25, v54, v50, s92
    v_perm_b32 v26, v62, v58, s92
    v_perm_b32 v27, v70, v66, s92
    v_perm_b32 v28, v46, v42, s93
    v_perm_b32 v29, v54, v50, s93
    v_perm_b32 v30, v62, v58, s93
    v_perm_b32 v31, v70, v66, s93
    v_perm_b32 v32, v47, v43, s92
    v_perm_b32 v33, v55, v51, s92
    v_perm_b32 v34, v63, v59, s92
    v_perm_b32 v35, v71, v67, s92
    v_perm_b32 v36, v47, v43, s93
    v_perm_b32 v37, v55, v51, s93
    v_perm_b32 v38, v63, v59, s93
    v_perm_b32 v39, v71, v67, s93
    v_perm_b32 v40, v76, v72, s92
    v_perm_b32 v41, v84, v80, s92
    v_perm_b32 v42, v92, v88, s92
    v_perm_b32 v43, v100, v96, s92
    v_perm_b32 v44, v76, v72, s93
    v_perm_b32 v45, v84, v80, s93
    v_perm_b32 v46, v92, v88, s93
    v_perm_b32 v47, v100, v96, s93
    v_perm_b32 v48, v77, v73, s92
    v_perm_b32 v49, v85, v81, s92
    v_perm_b32 v50, v93, v89, s92
    v_perm_b32 v51, v101, v97, s92
    v_perm_b32 v52, v77, v73, s93
    v_perm_b32 v53, v85, v81, s93
    v_perm_b32 v54, v93, v89, s93
    v_perm_b32 v55, v101, v97, s93
    v_perm_b32 v56, v78, v74, s92
    v_perm_b32 v57, v86, v82, s92
    v_perm_b32 v58, v94, v90, s92
    v_perm_b32 v59, v102, v98, s92
    v_perm_b32 v60, v78, v74, s93
    v_perm_b32 v61, v86, v82, s93
    v_perm_b32 v62, v94, v90, s93
    v_perm_b32 v63, v102, v98, s93
    v_perm_b32 v64, v79, v75, s92
    v_perm_b32 v65, v87, v83, s92
    v_perm_b32 v66, v95, v91, s92
    v_perm_b32 v67, v103, v99, s92
    v_perm_b32 v68, v79, v75, s93
    v_perm_b32 v69, v87, v83, s93
    v_perm_b32 v70, v95, v91, s93
    v_perm_b32 v71, v103, v99, s93
    v_perm_b32 v72, v108, v104, s92
    v_perm_b32 v73, v116, v112, s92
    v_perm_b32 v74, v124, v120, s92
    v_perm_b32 v75, v132, v128, s92
    v_perm_b32 v76, v108, v104, s93
    v_perm_b32 v77, v116, v112, s93
    v_perm_b32 v78, v124, v120, s93
    v_perm_b32 v79, v132, v128, s93
    v_perm_b32 v80, v109, v105, s92
    v_perm_b32 v81, v117, v113, s92
    v_perm_b32 v82, v125, v121, s92
    v_perm_b32 v83, v133, v129, s92
    v_perm_b32 v84, v109, v105, s93
    v_perm_b32 v85, v117, v113, s93
    v_perm_b32 v86, v125, v121, s93
    v_perm_b32 v87, v133, v129, s93
    v_perm_b32 v88, v110, v106, s92
    v_perm_b32 v89, v118, v114, s92
    v_perm_b32 v90, v126, v122, s92
    v_perm_b32 v91, v134, v130, s92
    v_perm_b32 v92, v110, v106, s93
    v_perm_b32 v93, v118, v114, s93
    v_perm_b32 v94, v126, v122, s93
    v_perm_b32 v95, v134, v130, s93
    v_perm_b32 v96, v111, v107, s92
    v_perm_b32 v97, v119, v115, s92
    v_perm_b32 v98, v127, v123, s92
    v_perm_b32 v99, v135, v131, s92
    v_perm_b32 v100, v111, v107, s93
    v_perm_b32 v101, v119, v115, s93
    v_perm_b32 v102, v127, v123, s93
    v_perm_b32 v103, v135, v131, s93
    v_perm_b32 v104, v140, v136, s92
    v_perm_b32 v105, v148, v144, s92
    v_perm_b32 v106, v156, v152, s92
    v_perm_b32 v107, v164, v160, s92
    v_perm_b32 v108, v140, v136, s93
    v_perm_b32 v109, v148, v144, s93
    v_perm_b32 v110, v156, v152, s93
    v_perm_b32 v111, v164, v160, s93
    v_perm_b32 v112, v141, v137, s92
    v_perm_b32 v113, v149, v145, s92
    v_perm_b32 v114, v157, v153, s92
    v_perm_b32 v115, v165, v161, s92
    v_perm_b32 v116, v141, v137, s93
    v_perm_b32 v117, v149, v145, s93
    v_perm_b32 v118, v157, v153, s93
    v_perm_b32 v119, v165, v161, s93
    v_perm_b32 v120, v142, v138, s92
    v_perm_b32 v121, v150, v146, s92
    v_perm_b32 v122, v158, v154, s92
    v_perm_b32 v123, v166, v162, s92
    v_perm_b32 v124, v142, v138, s93
    v_perm_b32 v125, v150, v146, s93
    v_perm_b32 v126, v158, v154, s93
    v_perm_b32 v127, v166, v162, s93
    v_perm_b32 v128, v143, v139, s92
    v_perm_b32 v129, v151, v147, s92
    v_perm_b32 v130, v159, v155, s92
    v_perm_b32 v131, v167, v163, s92
    v_perm_b32 v132, v143, v139, s93
    v_perm_b32 v133, v151, v147, s93
    v_perm_b32 v134, v159, v155, s93
    v_perm_b32 v135, v167, v163, s93
    v_mov_b32 v160, 0x2404c
    s_mov_b32 s80, 1600000
LW_73:
    ds_read_b32 v161, v160
    s_waitcnt lgkmcnt(0)
    v_readfirstlane_b32 s79, v161
    s_cmp_ge_u32 s79, 1
    s_cbranch_scc1 LWD_74
    s_sleep 2
    s_sub_u32 s80, s80, 1
    s_cmp_lg_u32 s80, 0
    s_cbranch_scc1 LW_73
LWD_74:
    v_mov_b32 v160, 0x24050
    ds_read_b64 v[162:163], v160
    s_waitcnt lgkmcnt(0)
    v_readfirstlane_b32 s94, v162
    v_readfirstlane_b32 s95, v163
    v_bfe_u32 v4, v1, 2, 2
    v_lshlrev_b32 v4, 8, v4
    v_lshrrev_b32 v160, 4, v1
    v_lshl_add_u32 v4, v160, 4, v4
    s_mov_b32 s70, 4096
    s_cmp_ge_u32 s5, 4
    s_cbranch_scc1 S2X_75
    v_add_u32 v4, 0x24400, v4
    s_cmp_lg_u32 s3, 8
    s_cbranch_scc1 U8_77
    v_and_b32 v5, 15, v1
    v_lshl_add_u32 v5, v5, 2, v160
    s_lshl_b32 s7, s6, 4
    s_add_u32 s7, s7, 0xe0000
    v_lshl_add_u32 v5, v5, 9, s7
    v_lshlrev_b32 v6, 4, v1
    v_add_u32 v6, 0x24800, v6
    s_mov_b32 s80, 200000
PO_78:
    buffer_load_dwordx4 v[136:139], v5, s[36:39], 0 offen sc1
PO2_79:
    s_waitcnt vmcnt(0)
    v_cmp_ne_u64 vcc, s[94:95], v[138:139]
    s_cmp_lg_u64 vcc, -1
    s_cbranch_scc1 POD_80
    s_sleep 16
    s_sub_u32 s80, s80, 1
    s_cmp_lg_u32 s80, 0
    s_cbranch_scc1 PO_78
POD_80:
    s_setprio 3
    ds_write_b128 v6, v[136:139]
    v_mov_b32 v160, 0x2401c
    v_mov_b32 v161, 1
    s_waitcnt lgkmcnt(0)
    s_mov_b64 exec, 1
    ds_add_u32 v160, v161
    s_mov_b64 exec, -1
    s_cbranch_vccz U8D_82
    buffer_load_dwordx4 v[136:139], v5, s[36:39], 0 offen sc1
    s_sleep 4
    buffer_load_dwordx4 v[140:143], v5, s[36:39], 0 offen sc1
    s_sleep 4
    s_mov_b32 s80, 200000
U8P_81:
    s_waitcnt vmcnt(1)
    ds_write_b128 v6, v[136:139]
    v_cmp_ne_u64 vcc, s[94:95], v[138:139]
    s_cbranch_vccz U8D_82
    s_waitcnt lgkmcnt(0)
    buffer_load_dwordx4 v[136:139], v5, s[36:39], 0 offen sc1
    s_waitcnt vmcnt(1)
    ds_write_b128 v6, v[140:143]
    v_cmp_ne_u64 vcc, s[94:95], v[142:143]
    s_cbranch_vccz U8D_82
    s_waitcnt lgkmcnt(0)
    buffer_load_dwordx4 v[140:143], v5, s[36:39], 0 offen sc1
    s_sub_u32 s80, s80, 1
    s_cmp_lg_u32 s80, 0
    s_cbranch_scc1 U8P_81
U8D_82:
    s_waitcnt vmcnt(0)
U8_77:
    s_setprio 3
    s_barrier
    s_barrier
    ds_read_b128 v[136:139], v4 offset:0
    ds_read_b128 v[140:143], v4 offset:64
    ds_read_b128 v[144:147], v4 offset:128
    ds_read_b128 v[148:151], v4 offset:192
    s_waitcnt lgkmcnt(0)
    s_branch S2M_76
S2X_75:
    v_and_b32 v160, 3, v1
    v_lshl_add_u32 v4, v160, 6, v4
    s_lshl_b32 s7, s6, 11
    s_add_u32 s7, s7, 0xd0000
    v_add_u32 v4, s7, v4
    s_mov_b32 s80, 200000
PO_83:
    buffer_load_dwordx4 v[152:155], v4, s[36:39], 0 offen offset:0 sc1
PO2_84:
    s_waitcnt vmcnt(0)
    v_cmp_ne_u64 vcc, s[94:95], v[154:155]
    s_cmp_lg_u64 vcc, -1
    s_cbranch_scc1 POD_85
    s_sleep 2
    s_sub_u32 s80, s80, 1
    s_cmp_lg_u32 s80, 0
    s_cbranch_scc1 PO_83
POD_85:
    s_setprio 3
    buffer_load_dwordx4 v[152:155], v4, s[36:39], 0 offen offset:0 sc1
    buffer_load_dwordx4 v[156:159], v4, s[36:39], 0 offen offset:1024 sc1
    s_sleep 4
    buffer_load_dwordx4 v[160:163], v4, s[36:39], 0 offen offset:0 sc1
    buffer_load_dwordx4 v[164:167], v4, s[36:39], 0 offen offset:1024 sc1
    s_sleep 4
    s_mov_b32 s80, 200000
PP_86:
    s_waitcnt vmcnt(2)
    v_cmp_ne_u64 vcc, s[94:95], v[154:155]
    v_cmp_ne_u64 s[84:85], s[94:95], v[158:159]
    s_or_b64 vcc, vcc, s[84:85]
    s_cmp_eq_u64 vcc, 0
    s_cbranch_scc1 PPO_88
    buffer_load_dwordx4 v[152:155], v4, s[36:39], 0 offen offset:0 sc1
    buffer_load_dwordx4 v[156:159], v4, s[36:39], 0 offen offset:1024 sc1
    s_waitcnt vmcnt(2)
    v_cmp_ne_u64 vcc, s[94:95], v[162:163]
    v_cmp_ne_u64 s[84:85], s[94:95], v[166:167]
    s_or_b64 vcc, vcc, s[84:85]
    s_cmp_eq_u64 vcc, 0
    s_cbranch_scc1 PPO_89
    buffer_load_dwordx4 v[160:163], v4, s[36:39], 0 offen offset:0 sc1
    buffer_load_dwordx4 v[164:167], v4, s[36:39], 0 offen offset:1024 sc1
    s_sub_u32 s80, s80, 1
    s_cmp_lg_u32 s80, 0
    s_cbranch_scc1 PP_86
PPO_88:
    v_mov_b32_dpp v136, v152 quad_perm:[0,0,0,0] row_mask:0xf bank_mask:0xf
    v_mov_b32_dpp v137, v153 quad_perm:[0,0,0,0] row_mask:0xf bank_mask:0xf
    v_mov_b32_dpp v138, v156 quad_perm:[0,0,0,0] row_mask:0xf bank_mask:0xf
    v_mov_b32_dpp v139, v157 quad_perm:[0,0,0,0] row_mask:0xf bank_mask:0xf
    v_mov_b32_dpp v140, v152 quad_perm:[1,1,1,1] row_mask:0xf bank_mask:0xf
    v_mov_b32_dpp v141, v153 quad_perm:[1,1,1,1] row_mask:0xf bank_mask:0xf
    v_mov_b32_dpp v142, v156 quad_perm:[1,1,1,1] row_mask:0xf bank_mask:0xf
    v_mov_b32_dpp v143, v157 quad_perm:[1,1,1,1] row_mask:0xf bank_mask:0xf
    v_mov_b32_dpp v144, v152 quad_perm:[2,2,2,2] row_mask:0xf bank_mask:0xf
    v_mov_b32_dpp v145, v153 quad_perm:[2,2,2,2] row_mask:0xf bank_mask:0xf
    v_mov_b32_dpp v146, v156 quad_perm:[2,2,2,2] row_mask:0xf bank_mask:0xf
    v_mov_b32_dpp v147, v157 quad_perm:[2,2,2,2] row_mask:0xf bank_mask:0xf
    v_mov_b32_dpp v148, v152 quad_perm:[3,3,3,3] row_mask:0xf bank_mask:0xf
    v_mov_b32_dpp v149, v153 quad_perm:[3,3,3,3] row_mask:0xf bank_mask:0xf
    v_mov_b32_dpp v150, v156 quad_perm:[3,3,3,3] row_mask:0xf bank_mask:0xf
    v_mov_b32_dpp v151, v157 quad_perm:[3,3,3,3] row_mask:0xf bank_mask:0xf
    s_branch PPD_87
PPO_89:
    v_mov_b32_dpp v136, v160 quad_perm:[0,0,0,0] row_mask:0xf bank_mask:0xf
    v_mov_b32_dpp v137, v161 quad_perm:[0,0,0,0] row_mask:0xf bank_mask:0xf
    v_mov_b32_dpp v138, v164 quad_perm:[0,0,0,0] row_mask:0xf bank_mask:0xf
    v_mov_b32_dpp v139, v165 quad_perm:[0,0,0,0] row_mask:0xf bank_mask:0xf
    v_mov_b32_dpp v140, v160 quad_perm:[1,1,1,1] row_mask:0xf bank_mask:0xf
    v_mov_b32_dpp v141, v161 quad_perm:[1,1,1,1] row_mask:0xf bank_mask:0xf
    v_mov_b32_dpp v142, v164 quad_perm:[1,1,1,1] row_mask:0xf bank_mask:0xf
    v_mov_b32_dpp v143, v165 quad_perm:[1,1,1,1] row_mask:0xf bank_mask:0xf
    v_mov_b32_dpp v144, v160 quad_perm:[2,2,2,2] row_mask:0xf bank_mask:0xf
    v_mov_b32_dpp v145, v161 quad_perm:[2,2,2,2] row_mask:0xf bank_mask:0xf
    v_mov_b32_dpp v146, v164 quad_perm:[2,2,2,2] row_mask:0xf bank_mask:0xf
    v_mov_b32_dpp v147, v165 quad_perm:[2,2,2,2] row_mask:0xf bank_mask:0xf
    v_mov_b32_dpp v148, v160 quad_perm:[3,3,3,3] row_mask:0xf bank_mask:0xf
    v_mov_b32_dpp v149, v161 quad_perm:[3,3,3,3] row_mask:0xf bank_mask:0xf
    v_mov_b32_dpp v150, v164 quad_perm:[3,3,3,3] row_mask:0xf bank_mask:0xf
    v_mov_b32_dpp v151, v165 quad_perm:[3,3,3,3] row_mask:0xf bank_mask:0xf
PPD_87:
S2M_76:
    s_nop 1
    v_mfma_f32_16x16x32_bf16 v[4:7], v[136:139], v[8:11], 0
    v_mfma_f32_16x16x32_bf16 v[4:7], v[140:143], v[40:43], v[4:7]
    v_mfma_f32_16x16x32_bf16 v[4:7], v[144:147], v[72:75], v[4:7]
    v_mfma_f32_16x16x32_bf16 v[4:7], v[148:151], v[104:107], v[4:7]
    v_mfma_f32_16x16x32_bf16 v[8:11], v[136:139], v[12:15], 0
    v_mfma_f32_16x16x32_bf16 v[8:11], v[140:143], v[44:47], v[8:11]
    v_mfma_f32_16x16x32_bf16 v[8:11], v[144:147], v[76:79], v[8:11]
    v_mfma_f32_16x16x32_bf16 v[8:11], v[148:151], v[108:111], v[8:11]
    v_mfma_f32_16x16x32_bf16 v[12:15], v[136:139], v[16:19], 0
    v_mfma_f32_16x16x32_bf16 v[12:15], v[140:143], v[48:51], v[12:15]
    v_mfma_f32_16x16x32_bf16 v[12:15], v[144:147], v[80:83], v[12:15]
    v_mfma_f32_16x16x32_bf16 v[12:15], v[148:151], v[112:115], v[12:15]
    v_mfma_f32_16x16x32_bf16 v[16:19], v[136:139], v[20:23], 0
    v_mfma_f32_16x16x32_bf16 v[16:19], v[140:143], v[52:55], v[16:19]
    v_mfma_f32_16x16x32_bf16 v[16:19], v[144:147], v[84:87], v[16:19]
    v_mfma_f32_16x16x32_bf16 v[16:19], v[148:151], v[116:119], v[16:19]
    v_mfma_f32_16x16x32_bf16 v[20:23], v[136:139], v[24:27], 0
    v_mfma_f32_16x16x32_bf16 v[20:23], v[140:143], v[56:59], v[20:23]
    v_mfma_f32_16x16x32_bf16 v[20:23], v[144:147], v[88:91], v[20:23]
    v_mfma_f32_16x16x32_bf16 v[20:23], v[148:151], v[120:123], v[20:23]
    v_mfma_f32_16x16x32_bf16 v[24:27], v[136:139], v[28:31], 0
    v_mfma_f32_16x16x32_bf16 v[24:27], v[140:143], v[60:63], v[24:27]
    v_mfma_f32_16x16x32_bf16 v[24:27], v[144:147], v[92:95], v[24:27]
    v_mfma_f32_16x16x32_bf16 v[24:27], v[148:151], v[124:127], v[24:27]
    v_mfma_f32_16x16x32_bf16 v[28:31], v[136:139], v[32:35], 0
    v_mfma_f32_16x16x32_bf16 v[28:31], v[140:143], v[64:67], v[28:31]
    v_mfma_f32_16x16x32_bf16 v[28:31], v[144:147], v[96:99], v[28:31]
    v_mfma_f32_16x16x32_bf16 v[28:31], v[148:151], v[128:131], v[28:31]
    v_mfma_f32_16x16x32_bf16 v[32:35], v[136:139], v[36:39], 0
    v_mfma_f32_16x16x32_bf16 v[32:35], v[140:143], v[68:71], v[32:35]
    v_mfma_f32_16x16x32_bf16 v[32:35], v[144:147], v[100:103], v[32:35]
    v_mfma_f32_16x16x32_bf16 v[32:35], v[148:151], v[132:135], v[32:35]
    v_mov_b32 v42, s94
    v_mov_b32 v43, s95
    v_cvt_pk_bf16_f32 v40, v4, v8
    v_cvt_pk_bf16_f32 v41, v12, v16
    buffer_store_dwordx4 v[40:43], v3, s[36:39], 0 offen sc1
    v_mov_b32 v46, s94
    v_mov_b32 v47, s95
    v_cvt_pk_bf16_f32 v44, v20, v24
    v_cvt_pk_bf16_f32 v45, v28, v32
    buffer_store_dwordx4 v[44:47], v3, s[36:39], s70 offen sc1
    s_endpgm
.p2align 12
LT_CR:
    s_branch LR_CR
L_CR:
    v_and_b32 v160, 15, v1
    v_lshlrev_b32 v4, 10, v160
    v_lshrrev_b32 v161, 4, v1
    v_lshl_add_u32 v4, v161, 8, v4
    v_lshl_add_u32 v3, v160, 4, v4
    s_lshl_b32 s7, s65, 14
    s_add_u32 s7, s7, 0x18000
    v_add_u32 v3, s7, v3
    v_and_b32 v162, 3, v1
    v_lshl_add_u32 v4, v162, 6, v4
    v_bfe_u32 v162, v1, 2, 2
    v_lshl_add_u32 v4, v162, 4, v4
    s_lshl_b32 s7, s64, 14
    v_add_u32 v4, s7, v4
    v_add_u32 v2, 0x10000, v4
    s_lshl_b32 s7, s65, 6
    s_add_u32 s7, s7, 0x27200
    v_lshl_add_u32 v5, v160, 2, s7
    s_lshl_b32 s7, s64, 10
    s_lshl_b32 s66, s65, 9
    s_add_u32 s7, s7, s66
    s_add_u32 s7, s7, 0x25200
    v_lshl_add_u32 v6, v160, 5, s7
    v_lshl_add_u32 v6, v161, 3, v6
    v_and_b32 v162, 31, v1
    v_lshlrev_b32 v7, 5, v162
    v_lshrrev_b32 v163, 5, v1
    v_lshl_add_u32 v7, v163, 4, v7
    v_add_u32 v7, 0x25200, v7
    v_lshlrev_b32 v8, 2, v162
    v_add_u32 v8, 0x27e00, v8
    v_bfe_u32 v162, v1, 2, 2
    v_lshl_add_u32 v164, v163, 3, v162
    v_lshlrev_b32 v164, 10, v164
    v_and_b32 v165, 1, v1
    v_lshl_add_u32 v164, v165, 3, v164
    s_lshl_b32 s7, s64, 8
    v_add_u32 v164, s7, v164
    v_bfe_u32 v165, v1, 4, 1
    v_lshlrev_b32 v165, 1, v165
    v_bfe_u32 v160, v1, 1, 1
    v_or_b32 v165, v165, v160
    s_lshl_b32 s7, s65, 3
    v_or_b32 v165, s7, v165
    v_lshlrev_b32 v162, 2, v162
    v_xor_b32 v165, v165, v162
    v_lshlrev_b32 v163, 1, v163
    v_xor_b32 v165, v165, v163
    v_xor_b32 v160, 0, v165
    v_lshl_add_u32 v9, v160, 4, v164
    v_xor_b32 v160, 4, v165
    v_lshl_add_u32 v10, v160, 4, v164
    v_xor_b32 v160, 1, v165
    v_lshl_add_u32 v11, v160, 4, v164
    v_add_u32 v11, 0x1000, v11
    v_xor_b32 v160, 5, v165
    v_lshl_add_u32 v12, v160, 4, v164
    v_add_u32 v12, 0x1000, v12
    v_mov_b32 v13, 0xff800000
    v_mov_b32 v14, 0
    v_cmp_gt_u32 s[86:87], 16, v1
    s_cmp_eq_u32 s64, 0
    s_cselect_b32 s88, 0xffff, 0
    s_mov_b32 s89, 0
    s_barrier
    v_xor_b32 v160, 0x0, v3
    ds_read_b128 v[32:35], v160
    v_xor_b32 v161, 0x10, v3
    ds_read_b128 v[36:39], v161
    v_xor_b32 v160, 0x20, v3
    ds_read_b128 v[40:43], v160
    v_xor_b32 v161, 0x30, v3
    ds_read_b128 v[44:47], v161
    v_xor_b32 v160, 0x40, v3
    ds_read_b128 v[48:51], v160
    v_xor_b32 v161, 0x50, v3
    ds_read_b128 v[52:55], v161
    v_xor_b32 v160, 0x60, v3
    ds_read_b128 v[56:59], v160
    v_xor_b32 v161, 0x70, v3
    ds_read_b128 v[60:63], v161
    v_xor_b32 v160, 0x80, v3
    ds_read_b128 v[64:67], v160
    v_xor_b32 v161, 0x90, v3
    ds_read_b128 v[68:71], v161
    v_xor_b32 v160, 0xa0, v3
    ds_read_b128 v[72:75], v160
    v_xor_b32 v161, 0xb0, v3
    ds_read_b128 v[76:79], v161
    v_xor_b32 v160, 0xc0, v3
    ds_read_b128 v[80:83], v160
    v_xor_b32 v161, 0xd0, v3
    ds_read_b128 v[84:87], v161
    v_xor_b32 v160, 0xe0, v3
    ds_read_b128 v[88:91], v160
    v_xor_b32 v161, 0xf0, v3
    ds_read_b128 v[92:95], v161
    s_lshl_b32 s7, s3, 10
    s_add_u32 s7, s7, 0x18000
    v_lshl_add_u32 v3, v1, 4, s7
    s_waitcnt lgkmcnt(0)
    s_barrier
    ds_write_b128 v3, v[128:131] offset:0
    ds_write_b128 v3, v[132:135] offset:8192
    ds_write_b128 v3, v[136:139] offset:16384
    ds_write_b128 v3, v[140:143] offset:24576
    v_xor_b32 v160, 0x0, v4
    ds_read_b128 v[24:27], v160
    v_xor_b32 v161, 0x10, v4
    ds_read_b128 v[28:31], v161
    v_xor_b32 v162, 0x20, v4
    ds_read_b128 v[164:167], v162
    v_xor_b32 v160, 0x30, v4
    ds_read_b128 v[144:147], v160
    v_xor_b32 v161, 0x40, v4
    ds_read_b128 v[148:151], v161
    v_xor_b32 v162, 0x50, v4
    ds_read_b128 v[152:155], v162
    v_xor_b32 v160, 0x60, v4
    ds_read_b128 v[156:159], v160
    s_waitcnt lgkmcnt(6)
    v_mfma_f32_16x16x32_bf16 v[16:19], v[24:27], v[32:35], 0
    v_xor_b32 v161, 0x70, v4
    ds_read_b128 v[24:27], v161
    s_waitcnt lgkmcnt(6)
    v_mfma_f32_16x16x32_bf16 v[16:19], v[28:31], v[36:39], v[16:19]
    v_xor_b32 v162, 0x80, v4
    ds_read_b128 v[28:31], v162
    s_waitcnt lgkmcnt(6)
    v_mfma_f32_16x16x32_bf16 v[16:19], v[164:167], v[40:43], v[16:19]
    v_xor_b32 v160, 0x90, v4
    ds_read_b128 v[164:167], v160
    s_waitcnt lgkmcnt(6)
    v_mfma_f32_16x16x32_bf16 v[16:19], v[144:147], v[44:47], v[16:19]
    v_xor_b32 v161, 0xa0, v4
    ds_read_b128 v[144:147], v161
    s_waitcnt lgkmcnt(6)
    v_mfma_f32_16x16x32_bf16 v[16:19], v[148:151], v[48:51], v[16:19]
    v_xor_b32 v162, 0xb0, v4
    ds_read_b128 v[148:151], v162
    s_waitcnt lgkmcnt(6)
    v_mfma_f32_16x16x32_bf16 v[16:19], v[152:155], v[52:55], v[16:19]
    v_xor_b32 v160, 0xc0, v4
    ds_read_b128 v[152:155], v160
    s_waitcnt lgkmcnt(6)
    v_mfma_f32_16x16x32_bf16 v[16:19], v[156:159], v[56:59], v[16:19]
    v_xor_b32 v161, 0xd0, v4
    ds_read_b128 v[156:159], v161
    s_waitcnt lgkmcnt(6)
    v_mfma_f32_16x16x32_bf16 v[16:19], v[24:27], v[60:63], v[16:19]
    v_xor_b32 v162, 0xe0, v4
    ds_read_b128 v[24:27], v162
    s_waitcnt lgkmcnt(6)
    v_mfma_f32_16x16x32_bf16 v[16:19], v[28:31], v[64:67], v[16:19]
    v_xor_b32 v160, 0xf0, v4
    ds_read_b128 v[28:31], v160
    s_waitcnt lgkmcnt(6)
    v_mfma_f32_16x16x32_bf16 v[16:19], v[164:167], v[68:71], v[16:19]
    s_waitcnt lgkmcnt(5)
    v_mfma_f32_16x16x32_bf16 v[16:19], v[144:147], v[72:75], v[16:19]
    s_waitcnt lgkmcnt(4)
    v_mfma_f32_16x16x32_bf16 v[16:19], v[148:151], v[76:79], v[16:19]
    s_waitcnt lgkmcnt(3)
    v_mfma_f32_16x16x32_bf16 v[16:19], v[152:155], v[80:83], v[16:19]
    s_waitcnt lgkmcnt(2)
    v_mfma_f32_16x16x32_bf16 v[16:19], v[156:159], v[84:87], v[16:19]
    s_waitcnt lgkmcnt(1)
    v_mfma_f32_16x16x32_bf16 v[16:19], v[24:27], v[88:91], v[16:19]
    s_waitcnt lgkmcnt(0)
    v_mfma_f32_16x16x32_bf16 v[16:19], v[28:31], v[92:95], v[16:19]
    s_waitcnt lgkmcnt(0)
    s_barrier
    v_xor_b32 v160, 0x0, v2
    ds_read_b128 v[24:27], v160
    v_xor_b32 v161, 0x10, v2
    ds_read_b128 v[28:31], v161
    v_xor_b32 v162, 0x20, v2
    ds_read_b128 v[164:167], v162
    v_xor_b32 v160, 0x30, v2
    ds_read_b128 v[144:147], v160
    v_xor_b32 v161, 0x40, v2
    ds_read_b128 v[148:151], v161
    v_xor_b32 v162, 0x50, v2
    ds_read_b128 v[152:155], v162
    v_xor_b32 v160, 0x60, v2
    ds_read_b128 v[156:159], v160
    s_waitcnt lgkmcnt(6)
    v_mfma_f32_16x16x32_bf16 v[20:23], v[24:27], v[32:35], 0
    v_xor_b32 v161, 0x70, v2
    ds_read_b128 v[24:27], v161
    s_waitcnt lgkmcnt(6)
    v_mfma_f32_16x16x32_bf16 v[20:23], v[28:31], v[36:39], v[20:23]
    v_xor_b32 v162, 0x80, v2
    ds_read_b128 v[28:31], v162
    s_waitcnt lgkmcnt(6)
    v_mfma_f32_16x16x32_bf16 v[20:23], v[164:167], v[40:43], v[20:23]
    v_xor_b32 v160, 0x90, v2
    ds_read_b128 v[164:167], v160
    s_waitcnt lgkmcnt(6)
    v_mfma_f32_16x16x32_bf16 v[20:23], v[144:147], v[44:47], v[20:23]
    v_xor_b32 v161, 0xa0, v2
    ds_read_b128 v[144:147], v161
    s_waitcnt lgkmcnt(6)
    v_mfma_f32_16x16x32_bf16 v[20:23], v[148:151], v[48:51], v[20:23]
    v_xor_b32 v162, 0xb0, v2
    ds_read_b128 v[148:151], v162
    s_waitcnt lgkmcnt(6)
    v_mfma_f32_16x16x32_bf16 v[20:23], v[152:155], v[52:55], v[20:23]
    v_xor_b32 v160, 0xc0, v2
    ds_read_b128 v[152:155], v160
    s_waitcnt lgkmcnt(6)
    v_mfma_f32_16x16x32_bf16 v[20:23], v[156:159], v[56:59], v[20:23]
    v_xor_b32 v161, 0xd0, v2
    ds_read_b128 v[156:159], v161
    s_waitcnt lgkmcnt(6)
    v_mfma_f32_16x16x32_bf16 v[20:23], v[24:27], v[60:63], v[20:23]
    v_xor_b32 v162, 0xe0, v2
    ds_read_b128 v[24:27], v162
    s_waitcnt lgkmcnt(6)
    v_mfma_f32_16x16x32_bf16 v[20:23], v[28:31], v[64:67], v[20:23]
    v_xor_b32 v160, 0xf0, v2
    ds_read_b128 v[28:31], v160
    s_waitcnt lgkmcnt(6)
    v_mfma_f32_16x16x32_bf16 v[20:23], v[164:167], v[68:71], v[20:23]
    s_waitcnt lgkmcnt(5)
    v_mfma_f32_16x16x32_bf16 v[20:23], v[144:147], v[72:75], v[20:23]
    s_waitcnt lgkmcnt(4)
    v_mfma_f32_16x16x32_bf16 v[20:23], v[148:151], v[76:79], v[20:23]
    s_waitcnt lgkmcnt(3)
    v_mfma_f32_16x16x32_bf16 v[20:23], v[152:155], v[80:83], v[20:23]
    s_waitcnt lgkmcnt(2)
    v_mfma_f32_16x16x32_bf16 v[20:23], v[156:159], v[84:87], v[20:23]
    s_waitcnt lgkmcnt(1)
    v_mfma_f32_16x16x32_bf16 v[20:23], v[24:27], v[88:91], v[20:23]
    s_waitcnt lgkmcnt(0)
    v_mfma_f32_16x16x32_bf16 v[20:23], v[28:31], v[92:95], v[20:23]
    v_max3_f32 v160, v16, v17, v18
    s_nop 6
    v_max3_f32 v160, v160, v19, v20
    v_max3_f32 v160, v160, v21, v22
    v_max_f32 v160, v160, v23
    v_mov_b32 v161, v160
    s_nop 1
    v_permlane32_swap_b32 v160, v161
    v_max_f32 v160, v160, v161
    v_mov_b32 v161, v160
    s_nop 1
    v_permlane16_swap_b32 v160, v161
    v_max_f32 v160, v160, v161
    s_lshl_b32 s7, s64, 7
    v_add_u32 v161, s7, v5
    s_mov_b64 exec, s[86:87]
    ds_write_b32 v161, v160
    s_mov_b64 exec, -1
    s_waitcnt lgkmcnt(0)
    s_barrier
    ds_read_b32 v160, v5 offset:0
    ds_read_b32 v161, v5 offset:128
    ds_read_b32 v162, v5 offset:256
    ds_read_b32 v163, v5 offset:384
    s_waitcnt lgkmcnt(0)
    v_max3_f32 v160, v160, v161, v162
    v_max_f32 v160, v160, v163
    v_mul_f32 v160, s67, v160
    v_max_f32 v160, v160, v13
    v_sub_f32 v161, v13, v160
    v_exp_f32 v161, v161
    v_mov_b32 v13, v160
    v_fma_f32 v16, v16, s67, -v160
    v_fma_f32 v17, v17, s67, -v160
    v_fma_f32 v18, v18, s67, -v160
    v_fma_f32 v19, v19, s67, -v160
    v_fma_f32 v20, v20, s67, -v160
    v_fma_f32 v21, v21, s67, -v160
    v_fma_f32 v22, v22, s67, -v160
    v_fma_f32 v23, v23, s67, -v160
    v_exp_f32 v16, v16
    v_exp_f32 v17, v17
    v_exp_f32 v18, v18
    v_exp_f32 v19, v19
    v_exp_f32 v20, v20
    v_exp_f32 v21, v21
    v_exp_f32 v22, v22
    v_exp_f32 v23, v23
    v_cvt_pk_bf16_f32 v24, v16, v17
    v_cvt_pk_bf16_f32 v25, v18, v19
    v_cvt_pk_bf16_f32 v26, v20, v21
    v_cvt_pk_bf16_f32 v27, v22, v23
    ds_write_b64 v6, v[24:25]
    ds_write_b64 v6, v[26:27] offset:4096
    v_add_u32 v162, 0xc00, v5
    s_mov_b64 exec, s[88:89]
    ds_write_b32 v162, v161
    s_mov_b64 exec, -1
    v_mul_f32 v14, v14, v161
    v_add_f32 v16, v16, v20
    v_add_f32 v17, v17, v21
    v_add_f32 v18, v18, v22
    v_add_f32 v19, v19, v23
    v_add_f32 v16, v16, v18
    v_add_f32 v17, v17, v19
    v_add_f32 v16, v16, v17
    v_add_f32 v14, v14, v16
    v_lshlrev_b32 v3, 4, v1
    v_xor_b32 v3, s62, v3
    v_xor_b32 v15, 32, v3
    s_lshl_b32 s68, s3, 10
    s_waitcnt lgkmcnt(0)
    s_barrier
    ds_read_b128 v[16:19], v7 offset:0
    ds_read_b64_tr_b16 v[24:25], v9 offset:0
    ds_read_b64_tr_b16 v[26:27], v11 offset:0
    ds_read_b64_tr_b16 v[28:29], v10 offset:0
    ds_read_b64_tr_b16 v[30:31], v12 offset:0
    ds_read_b128 v[20:23], v7 offset:1024
    ds_read_b64_tr_b16 v[160:161], v9 offset:16384
    ds_read_b64_tr_b16 v[162:163], v11 offset:16384
    ds_read_b64_tr_b16 v[164:165], v10 offset:16384
    ds_read_b64_tr_b16 v[166:167], v12 offset:16384
    s_waitcnt lgkmcnt(7)
    v_mfma_f32_32x32x16_bf16 v[128:143], v[24:27], v[16:19], 0
    s_waitcnt lgkmcnt(5)
    v_mfma_f32_32x32x16_bf16 v[144:159], v[28:31], v[16:19], 0
    ds_read_b128 v[16:19], v7 offset:2048
    ds_read_b64_tr_b16 v[24:25], v9 offset:32768
    ds_read_b64_tr_b16 v[26:27], v11 offset:32768
    ds_read_b64_tr_b16 v[28:29], v10 offset:32768
    ds_read_b64_tr_b16 v[30:31], v12 offset:32768
    s_waitcnt lgkmcnt(7)
    v_mfma_f32_32x32x16_bf16 v[128:143], v[160:163], v[20:23], v[128:143]
    s_waitcnt lgkmcnt(5)
    v_mfma_f32_32x32x16_bf16 v[144:159], v[164:167], v[20:23], v[144:159]
    ds_read_b128 v[20:23], v7 offset:3072
    ds_read_b64_tr_b16 v[160:161], v9 offset:49152
    ds_read_b64_tr_b16 v[162:163], v11 offset:49152
    ds_read_b64_tr_b16 v[164:165], v10 offset:49152
    ds_read_b64_tr_b16 v[166:167], v12 offset:49152
    s_waitcnt lgkmcnt(7)
    v_mfma_f32_32x32x16_bf16 v[128:143], v[24:27], v[16:19], v[128:143]
    s_waitcnt lgkmcnt(5)
    v_mfma_f32_32x32x16_bf16 v[144:159], v[28:31], v[16:19], v[144:159]
    v_add_u32 v9, 0x10000, v9
    v_add_u32 v10, 0x10000, v10
    v_add_u32 v11, 0x10000, v11
    v_add_u32 v12, 0x10000, v12
    ds_read_b128 v[16:19], v7 offset:4096
    ds_read_b64_tr_b16 v[24:25], v9 offset:0
    ds_read_b64_tr_b16 v[26:27], v11 offset:0
    ds_read_b64_tr_b16 v[28:29], v10 offset:0
    ds_read_b64_tr_b16 v[30:31], v12 offset:0
    s_waitcnt lgkmcnt(7)
    v_mfma_f32_32x32x16_bf16 v[128:143], v[160:163], v[20:23], v[128:143]
    s_waitcnt lgkmcnt(5)
    v_mfma_f32_32x32x16_bf16 v[144:159], v[164:167], v[20:23], v[144:159]
    s_barrier
    ds_read_b128 v[20:23], v7 offset:5120
    ds_read_b64_tr_b16 v[160:161], v9 offset:16384
    ds_read_b64_tr_b16 v[162:163], v11 offset:16384
    ds_read_b64_tr_b16 v[164:165], v10 offset:16384
    ds_read_b64_tr_b16 v[166:167], v12 offset:16384
    s_waitcnt lgkmcnt(7)
    v_mfma_f32_32x32x16_bf16 v[128:143], v[24:27], v[16:19], v[128:143]
    s_waitcnt lgkmcnt(5)
    v_mfma_f32_32x32x16_bf16 v[144:159], v[28:31], v[16:19], v[144:159]
    ds_read_b128 v[16:19], v7 offset:6144
    ds_read_b64_tr_b16 v[24:25], v9 offset:32768
    ds_read_b64_tr_b16 v[26:27], v11 offset:32768
    ds_read_b64_tr_b16 v[28:29], v10 offset:32768
    ds_read_b64_tr_b16 v[30:31], v12 offset:32768
    s_waitcnt lgkmcnt(7)
    v_mfma_f32_32x32x16_bf16 v[128:143], v[160:163], v[20:23], v[128:143]
    s_waitcnt lgkmcnt(5)
    v_mfma_f32_32x32x16_bf16 v[144:159], v[164:167], v[20:23], v[144:159]
    ds_read_b128 v[20:23], v7 offset:7168
    ds_read_b64_tr_b16 v[160:161], v9 offset:49152
    ds_read_b64_tr_b16 v[162:163], v11 offset:49152
    ds_read_b64_tr_b16 v[164:165], v10 offset:49152
    ds_read_b64_tr_b16 v[166:167], v12 offset:49152
    s_waitcnt lgkmcnt(7)
    v_mfma_f32_32x32x16_bf16 v[128:143], v[24:27], v[16:19], v[128:143]
    s_waitcnt lgkmcnt(5)
    v_mfma_f32_32x32x16_bf16 v[144:159], v[28:31], v[16:19], v[144:159]
    s_waitcnt lgkmcnt(2)
    v_mfma_f32_32x32x16_bf16 v[128:143], v[160:163], v[20:23], v[128:143]
    s_waitcnt lgkmcnt(0)
    v_mfma_f32_32x32x16_bf16 v[144:159], v[164:167], v[20:23], v[144:159]
    v_add_u32 v9, 0xffff0000, v9
    v_add_u32 v10, 0xffff0000, v10
    v_add_u32 v11, 0xffff0000, v11
    v_add_u32 v12, 0xffff0000, v12
    s_lshl_b32 s7, s3, 10
    s_add_u32 s7, s7, 0x10000
    v_lshl_add_u32 v3, v1, 4, s7
    s_waitcnt vmcnt(0)
    s_barrier
    ds_write_b128 v3, v[96:99] offset:0
    ds_write_b128 v3, v[100:103] offset:8192
    ds_write_b128 v3, v[104:107] offset:16384
    ds_write_b128 v3, v[108:111] offset:24576
    ds_write_b128 v3, v[112:115] offset:32768
    ds_write_b128 v3, v[116:119] offset:40960
    ds_write_b128 v3, v[120:123] offset:49152
    ds_write_b128 v3, v[124:127] offset:57344
    s_waitcnt lgkmcnt(4)
    v_xor_b32 v160, 0x0, v4
    ds_read_b128 v[24:27], v160
    v_xor_b32 v161, 0x10, v4
    ds_read_b128 v[28:31], v161
    v_xor_b32 v162, 0x20, v4
    ds_read_b128 v[164:167], v162
    v_xor_b32 v160, 0x30, v4
    ds_read_b128 v[96:99], v160
    v_xor_b32 v161, 0x40, v4
    ds_read_b128 v[100:103], v161
    v_xor_b32 v162, 0x50, v4
    ds_read_b128 v[104:107], v162
    v_xor_b32 v160, 0x60, v4
    ds_read_b128 v[108:111], v160
    s_waitcnt lgkmcnt(6)
    v_mfma_f32_16x16x32_bf16 v[16:19], v[24:27], v[32:35], 0
    v_xor_b32 v161, 0x70, v4
    ds_read_b128 v[24:27], v161
    s_waitcnt lgkmcnt(6)
    v_mfma_f32_16x16x32_bf16 v[16:19], v[28:31], v[36:39], v[16:19]
    v_xor_b32 v162, 0x80, v4
    ds_read_b128 v[28:31], v162
    s_waitcnt lgkmcnt(6)
    v_mfma_f32_16x16x32_bf16 v[16:19], v[164:167], v[40:43], v[16:19]
    v_xor_b32 v160, 0x90, v4
    ds_read_b128 v[164:167], v160
    s_waitcnt lgkmcnt(6)
    v_mfma_f32_16x16x32_bf16 v[16:19], v[96:99], v[44:47], v[16:19]
    v_xor_b32 v161, 0xa0, v4
    ds_read_b128 v[96:99], v161
    s_waitcnt lgkmcnt(6)
    v_mfma_f32_16x16x32_bf16 v[16:19], v[100:103], v[48:51], v[16:19]
    v_xor_b32 v162, 0xb0, v4
    ds_read_b128 v[100:103], v162
    s_waitcnt lgkmcnt(6)
    v_mfma_f32_16x16x32_bf16 v[16:19], v[104:107], v[52:55], v[16:19]
    v_xor_b32 v160, 0xc0, v4
    ds_read_b128 v[104:107], v160
    s_waitcnt lgkmcnt(6)
    v_mfma_f32_16x16x32_bf16 v[16:19], v[108:111], v[56:59], v[16:19]
    v_xor_b32 v161, 0xd0, v4
    ds_read_b128 v[108:111], v161
    s_waitcnt lgkmcnt(6)
    v_mfma_f32_16x16x32_bf16 v[16:19], v[24:27], v[60:63], v[16:19]
    v_xor_b32 v162, 0xe0, v4
    ds_read_b128 v[24:27], v162
    s_waitcnt lgkmcnt(6)
    v_mfma_f32_16x16x32_bf16 v[16:19], v[28:31], v[64:67], v[16:19]
    v_xor_b32 v160, 0xf0, v4
    ds_read_b128 v[28:31], v160
    s_waitcnt lgkmcnt(6)
    v_mfma_f32_16x16x32_bf16 v[16:19], v[164:167], v[68:71], v[16:19]
    s_waitcnt lgkmcnt(5)
    v_mfma_f32_16x16x32_bf16 v[16:19], v[96:99], v[72:75], v[16:19]
    s_waitcnt lgkmcnt(4)
    v_mfma_f32_16x16x32_bf16 v[16:19], v[100:103], v[76:79], v[16:19]
    s_waitcnt lgkmcnt(3)
    v_mfma_f32_16x16x32_bf16 v[16:19], v[104:107], v[80:83], v[16:19]
    s_waitcnt lgkmcnt(2)
    v_mfma_f32_16x16x32_bf16 v[16:19], v[108:111], v[84:87], v[16:19]
    s_waitcnt lgkmcnt(1)
    v_mfma_f32_16x16x32_bf16 v[16:19], v[24:27], v[88:91], v[16:19]
    s_waitcnt lgkmcnt(0)
    v_mfma_f32_16x16x32_bf16 v[16:19], v[28:31], v[92:95], v[16:19]
    s_barrier
    v_xor_b32 v160, 0x0, v2
    ds_read_b128 v[24:27], v160
    v_xor_b32 v161, 0x10, v2
    ds_read_b128 v[28:31], v161
    v_xor_b32 v162, 0x20, v2
    ds_read_b128 v[164:167], v162
    v_xor_b32 v160, 0x30, v2
    ds_read_b128 v[96:99], v160
    v_xor_b32 v161, 0x40, v2
    ds_read_b128 v[100:103], v161
    v_xor_b32 v162, 0x50, v2
    ds_read_b128 v[104:107], v162
    v_xor_b32 v160, 0x60, v2
    ds_read_b128 v[108:111], v160
    s_waitcnt lgkmcnt(6)
    v_mfma_f32_16x16x32_bf16 v[20:23], v[24:27], v[32:35], 0
    v_xor_b32 v161, 0x70, v2
    ds_read_b128 v[24:27], v161
    s_waitcnt lgkmcnt(6)
    v_mfma_f32_16x16x32_bf16 v[20:23], v[28:31], v[36:39], v[20:23]
    v_xor_b32 v162, 0x80, v2
    ds_read_b128 v[28:31], v162
    s_waitcnt lgkmcnt(6)
    v_mfma_f32_16x16x32_bf16 v[20:23], v[164:167], v[40:43], v[20:23]
    v_xor_b32 v160, 0x90, v2
    ds_read_b128 v[164:167], v160
    s_waitcnt lgkmcnt(6)
    v_mfma_f32_16x16x32_bf16 v[20:23], v[96:99], v[44:47], v[20:23]
    v_xor_b32 v161, 0xa0, v2
    ds_read_b128 v[96:99], v161
    s_waitcnt lgkmcnt(6)
    v_mfma_f32_16x16x32_bf16 v[20:23], v[100:103], v[48:51], v[20:23]
    v_xor_b32 v162, 0xb0, v2
    ds_read_b128 v[100:103], v162
    s_waitcnt lgkmcnt(6)
    v_mfma_f32_16x16x32_bf16 v[20:23], v[104:107], v[52:55], v[20:23]
    v_xor_b32 v160, 0xc0, v2
    ds_read_b128 v[104:107], v160
    s_waitcnt lgkmcnt(6)
    v_mfma_f32_16x16x32_bf16 v[20:23], v[108:111], v[56:59], v[20:23]
    v_xor_b32 v161, 0xd0, v2
    ds_read_b128 v[108:111], v161
    s_waitcnt lgkmcnt(6)
    v_mfma_f32_16x16x32_bf16 v[20:23], v[24:27], v[60:63], v[20:23]
    v_xor_b32 v162, 0xe0, v2
    ds_read_b128 v[24:27], v162
    s_waitcnt lgkmcnt(6)
    v_mfma_f32_16x16x32_bf16 v[20:23], v[28:31], v[64:67], v[20:23]
    v_xor_b32 v160, 0xf0, v2
    ds_read_b128 v[28:31], v160
    s_waitcnt lgkmcnt(6)
    v_mfma_f32_16x16x32_bf16 v[20:23], v[164:167], v[68:71], v[20:23]
    s_waitcnt lgkmcnt(5)
    v_mfma_f32_16x16x32_bf16 v[20:23], v[96:99], v[72:75], v[20:23]
    s_waitcnt lgkmcnt(4)
    v_mfma_f32_16x16x32_bf16 v[20:23], v[100:103], v[76:79], v[20:23]
    s_waitcnt lgkmcnt(3)
    v_mfma_f32_16x16x32_bf16 v[20:23], v[104:107], v[80:83], v[20:23]
    s_waitcnt lgkmcnt(2)
    v_mfma_f32_16x16x32_bf16 v[20:23], v[108:111], v[84:87], v[20:23]
    s_waitcnt lgkmcnt(1)
    v_mfma_f32_16x16x32_bf16 v[20:23], v[24:27], v[88:91], v[20:23]
    s_waitcnt lgkmcnt(0)
    v_mfma_f32_16x16x32_bf16 v[20:23], v[28:31], v[92:95], v[20:23]
    v_max3_f32 v160, v16, v17, v18
    s_nop 6
    v_max3_f32 v160, v160, v19, v20
    v_max3_f32 v160, v160, v21, v22
    v_max_f32 v160, v160, v23
    v_mov_b32 v161, v160
    s_nop 1
    v_permlane32_swap_b32 v160, v161
    v_max_f32 v160, v160, v161
    v_mov_b32 v161, v160
    s_nop 1
    v_permlane16_swap_b32 v160, v161
    v_max_f32 v160, v160, v161
    s_lshl_b32 s7, s64, 7
    v_add_u32 v161, s7, v5
    s_mov_b64 exec, s[86:87]
    ds_write_b32 v161, v160
    s_mov_b64 exec, -1
    s_waitcnt lgkmcnt(0)
    s_barrier
    ds_read_b32 v160, v5 offset:0
    ds_read_b32 v161, v5 offset:128
    ds_read_b32 v162, v5 offset:256
    ds_read_b32 v163, v5 offset:384
    s_waitcnt lgkmcnt(0)
    v_max3_f32 v160, v160, v161, v162
    v_max_f32 v160, v160, v163
    v_mul_f32 v160, s67, v160
    v_max_f32 v160, v160, v13
    v_sub_f32 v161, v13, v160
    v_exp_f32 v161, v161
    v_mov_b32 v13, v160
    v_fma_f32 v16, v16, s67, -v160
    v_fma_f32 v17, v17, s67, -v160
    v_fma_f32 v18, v18, s67, -v160
    v_fma_f32 v19, v19, s67, -v160
    v_fma_f32 v20, v20, s67, -v160
    v_fma_f32 v21, v21, s67, -v160
    v_fma_f32 v22, v22, s67, -v160
    v_fma_f32 v23, v23, s67, -v160
    v_exp_f32 v16, v16
    v_exp_f32 v17, v17
    v_exp_f32 v18, v18
    v_exp_f32 v19, v19
    v_exp_f32 v20, v20
    v_exp_f32 v21, v21
    v_exp_f32 v22, v22
    v_exp_f32 v23, v23
    v_cvt_pk_bf16_f32 v24, v16, v17
    v_cvt_pk_bf16_f32 v25, v18, v19
    v_cvt_pk_bf16_f32 v26, v20, v21
    v_cvt_pk_bf16_f32 v27, v22, v23
    ds_write_b64 v6, v[24:25]
    ds_write_b64 v6, v[26:27] offset:4096
    v_add_u32 v162, 0xc00, v5
    s_mov_b64 exec, s[88:89]
    ds_write_b32 v162, v161
    s_mov_b64 exec, -1
    v_mul_f32 v14, v14, v161
    v_add_f32 v16, v16, v20
    v_add_f32 v17, v17, v21
    v_add_f32 v18, v18, v22
    v_add_f32 v19, v19, v23
    v_add_f32 v16, v16, v18
    v_add_f32 v17, v17, v19
    v_add_f32 v16, v16, v17
    v_add_f32 v14, v14, v16
    v_mov_b32 v160, v14
    s_nop 1
    v_permlane32_swap_b32 v14, v160
    v_add_f32 v14, v14, v160
    v_mov_b32 v160, v14
    s_nop 1
    v_permlane16_swap_b32 v14, v160
    v_add_f32 v14, v14, v160
    s_lshl_b32 s7, s64, 7
    s_add_u32 s7, s7, 0x200
    v_add_u32 v161, s7, v5
    v_add_u32 v162, 0xc80, v5
    s_mov_b64 exec, s[86:87]
    ds_write_b32 v161, v14
    s_mov_b64 exec, s[88:89]
    ds_write_b32 v162, v13
    s_mov_b64 exec, -1
    v_and_b32 v160, 31, v1
    v_lshlrev_b32 v98, 7, v160
    v_lshrrev_b32 v161, 5, v1
    v_and_b32 v160, 7, v1
    v_xor_b32 v161, v160, v161
    v_lshl_add_u32 v98, v161, 4, v98
    s_lshl_b32 s7, s3, 12
    v_add_u32 v98, s7, v98
    v_lshl_add_u32 v99, v1, 4, s7
    v_lshrrev_b32 v161, 3, v1
    v_xor_b32 v160, v160, v161
    v_lshlrev_b32 v100, 7, v161
    v_lshl_add_u32 v100, v160, 4, v100
    s_lshl_b32 s69, s60, 15
    s_add_u32 s69, s69, s7
    s_add_u32 s69, s69, 0x500000
    s_waitcnt lgkmcnt(0)
    s_barrier
    ds_read_b32 v15, v8
    ds_read_b128 v[16:19], v7 offset:0
    ds_read_b64_tr_b16 v[24:25], v9 offset:0
    ds_read_b64_tr_b16 v[26:27], v11 offset:0
    ds_read_b64_tr_b16 v[28:29], v10 offset:0
    ds_read_b64_tr_b16 v[30:31], v12 offset:0
    s_waitcnt lgkmcnt(5)
    v_mul_f32 v128, v15, v128
    v_mul_f32 v129, v15, v129
    v_mul_f32 v130, v15, v130
    v_mul_f32 v131, v15, v131
    v_mul_f32 v132, v15, v132
    v_mul_f32 v133, v15, v133
    v_mul_f32 v134, v15, v134
    v_mul_f32 v135, v15, v135
    s_branch LC_CR
.p2align 12
LT_CR2:
    s_branch LR_CR2
LC_CR:
    v_mul_f32 v136, v15, v136
    v_mul_f32 v137, v15, v137
    v_mul_f32 v138, v15, v138
    v_mul_f32 v139, v15, v139
    v_mul_f32 v140, v15, v140
    v_mul_f32 v141, v15, v141
    v_mul_f32 v142, v15, v142
    v_mul_f32 v143, v15, v143
    v_mul_f32 v144, v15, v144
    v_mul_f32 v145, v15, v145
    v_mul_f32 v146, v15, v146
    v_mul_f32 v147, v15, v147
    v_mul_f32 v148, v15, v148
    v_mul_f32 v149, v15, v149
    v_mul_f32 v150, v15, v150
    v_mul_f32 v151, v15, v151
    v_mul_f32 v152, v15, v152
    v_mul_f32 v153, v15, v153
    v_mul_f32 v154, v15, v154
    v_mul_f32 v155, v15, v155
    v_mul_f32 v156, v15, v156
    v_mul_f32 v157, v15, v157
    v_mul_f32 v158, v15, v158
    v_mul_f32 v159, v15, v159
    ds_read_b128 v[20:23], v7 offset:1024
    ds_read_b64_tr_b16 v[160:161], v9 offset:16384
    ds_read_b64_tr_b16 v[162:163], v11 offset:16384
    ds_read_b64_tr_b16 v[164:165], v10 offset:16384
    ds_read_b64_tr_b16 v[166:167], v12 offset:16384
    s_waitcnt lgkmcnt(7)
    v_mfma_f32_32x32x16_bf16 v[128:143], v[24:27], v[16:19], v[128:143]
    s_waitcnt lgkmcnt(5)
    v_mfma_f32_32x32x16_bf16 v[144:159], v[28:31], v[16:19], v[144:159]
    ds_read_b128 v[16:19], v7 offset:2048
    ds_read_b64_tr_b16 v[24:25], v9 offset:32768
    ds_read_b64_tr_b16 v[26:27], v11 offset:32768
    ds_read_b64_tr_b16 v[28:29], v10 offset:32768
    ds_read_b64_tr_b16 v[30:31], v12 offset:32768
    s_waitcnt lgkmcnt(7)
    v_mfma_f32_32x32x16_bf16 v[128:143], v[160:163], v[20:23], v[128:143]
    s_waitcnt lgkmcnt(5)
    v_mfma_f32_32x32x16_bf16 v[144:159], v[164:167], v[20:23], v[144:159]
    ds_read_b128 v[20:23], v7 offset:3072
    ds_read_b64_tr_b16 v[160:161], v9 offset:49152
    ds_read_b64_tr_b16 v[162:163], v11 offset:49152
    ds_read_b64_tr_b16 v[164:165], v10 offset:49152
    ds_read_b64_tr_b16 v[166:167], v12 offset:49152
    s_waitcnt lgkmcnt(7)
    v_mfma_f32_32x32x16_bf16 v[128:143], v[24:27], v[16:19], v[128:143]
    s_waitcnt lgkmcnt(5)
    v_mfma_f32_32x32x16_bf16 v[144:159], v[28:31], v[16:19], v[144:159]
    v_add_u32 v9, 0x10000, v9
    v_add_u32 v10, 0x10000, v10
    v_add_u32 v11, 0x10000, v11
    v_add_u32 v12, 0x10000, v12
    ds_read_b128 v[16:19], v7 offset:4096
    ds_read_b64_tr_b16 v[24:25], v9 offset:0
    ds_read_b64_tr_b16 v[26:27], v11 offset:0
    ds_read_b64_tr_b16 v[28:29], v10 offset:0
    ds_read_b64_tr_b16 v[30:31], v12 offset:0
    s_waitcnt lgkmcnt(7)
    v_mfma_f32_32x32x16_bf16 v[128:143], v[160:163], v[20:23], v[128:143]
    s_waitcnt lgkmcnt(5)
    v_mfma_f32_32x32x16_bf16 v[144:159], v[164:167], v[20:23], v[144:159]
    s_barrier
    ds_read_b128 v[20:23], v7 offset:5120
    ds_read_b64_tr_b16 v[160:161], v9 offset:16384
    ds_read_b64_tr_b16 v[162:163], v11 offset:16384
    ds_read_b64_tr_b16 v[164:165], v10 offset:16384
    ds_read_b64_tr_b16 v[166:167], v12 offset:16384
    s_waitcnt lgkmcnt(7)
    v_mfma_f32_32x32x16_bf16 v[128:143], v[24:27], v[16:19], v[128:143]
    s_waitcnt lgkmcnt(5)
    v_mfma_f32_32x32x16_bf16 v[144:159], v[28:31], v[16:19], v[144:159]
    ds_read_b128 v[16:19], v7 offset:6144
    ds_read_b64_tr_b16 v[24:25], v9 offset:32768
    ds_read_b64_tr_b16 v[26:27], v11 offset:32768
    ds_read_b64_tr_b16 v[28:29], v10 offset:32768
    ds_read_b64_tr_b16 v[30:31], v12 offset:32768
    s_waitcnt lgkmcnt(7)
    v_mfma_f32_32x32x16_bf16 v[128:143], v[160:163], v[20:23], v[128:143]
    s_waitcnt lgkmcnt(5)
    v_mfma_f32_32x32x16_bf16 v[144:159], v[164:167], v[20:23], v[144:159]
    ds_read_b128 v[20:23], v7 offset:7168
    ds_read_b64_tr_b16 v[160:161], v9 offset:49152
    ds_read_b64_tr_b16 v[162:163], v11 offset:49152
    ds_read_b64_tr_b16 v[164:165], v10 offset:49152
    ds_read_b64_tr_b16 v[166:167], v12 offset:49152
    s_waitcnt lgkmcnt(7)
    v_mfma_f32_32x32x16_bf16 v[128:143], v[24:27], v[16:19], v[128:143]
    s_waitcnt lgkmcnt(5)
    v_mfma_f32_32x32x16_bf16 v[144:159], v[28:31], v[16:19], v[144:159]
    s_waitcnt lgkmcnt(2)
    v_mfma_f32_32x32x16_bf16 v[128:143], v[160:163], v[20:23], v[128:143]
    s_waitcnt lgkmcnt(0)
    v_mfma_f32_32x32x16_bf16 v[144:159], v[164:167], v[20:23], v[144:159]
    s_nop 9
    v_permlane32_swap_b32 v128, v132
    v_permlane32_swap_b32 v129, v133
    v_permlane32_swap_b32 v130, v134
    v_permlane32_swap_b32 v131, v135
    v_cvt_pk_bf16_f32 v16, v128, v129
    v_cvt_pk_bf16_f32 v17, v130, v131
    v_cvt_pk_bf16_f32 v18, v132, v133
    v_cvt_pk_bf16_f32 v19, v134, v135
    v_xor_b32 v160, 0x0, v98
    ds_write_b128 v160, v[16:19]
    v_permlane32_swap_b32 v136, v140
    v_permlane32_swap_b32 v137, v141
    v_permlane32_swap_b32 v138, v142
    v_permlane32_swap_b32 v139, v143
    v_cvt_pk_bf16_f32 v20, v136, v137
    v_cvt_pk_bf16_f32 v21, v138, v139
    v_cvt_pk_bf16_f32 v22, v140, v141
    v_cvt_pk_bf16_f32 v23, v142, v143
    v_xor_b32 v161, 0x20, v98
    ds_write_b128 v161, v[20:23]
    v_permlane32_swap_b32 v144, v148
    v_permlane32_swap_b32 v145, v149
    v_permlane32_swap_b32 v146, v150
    v_permlane32_swap_b32 v147, v151
    v_cvt_pk_bf16_f32 v24, v144, v145
    v_cvt_pk_bf16_f32 v25, v146, v147
    v_cvt_pk_bf16_f32 v26, v148, v149
    v_cvt_pk_bf16_f32 v27, v150, v151
    v_xor_b32 v160, 0x40, v98
    ds_write_b128 v160, v[24:27]
    v_permlane32_swap_b32 v152, v156
    v_permlane32_swap_b32 v153, v157
    v_permlane32_swap_b32 v154, v158
    v_permlane32_swap_b32 v155, v159
    v_cvt_pk_bf16_f32 v28, v152, v153
    v_cvt_pk_bf16_f32 v29, v154, v155
    v_cvt_pk_bf16_f32 v30, v156, v157
    v_cvt_pk_bf16_f32 v31, v158, v159
    v_xor_b32 v161, 0x60, v98
    ds_write_b128 v161, v[28:31]
    ds_read_b128 v[32:35], v99 offset:0
    ds_read_b128 v[36:39], v99 offset:1024
    ds_read_b128 v[40:43], v99 offset:2048
    ds_read_b128 v[44:47], v99 offset:3072
    s_waitcnt lgkmcnt(3)
    buffer_store_dwordx4 v[32:35], v100, s[36:39], s69 offen offset:0 sc1
    s_waitcnt lgkmcnt(2)
    buffer_store_dwordx4 v[36:39], v100, s[36:39], s69 offen offset:1024 sc1
    s_waitcnt lgkmcnt(1)
    buffer_store_dwordx4 v[40:43], v100, s[36:39], s69 offen offset:2048 sc1
    s_waitcnt lgkmcnt(0)
    buffer_store_dwordx4 v[44:47], v100, s[36:39], s69 offen offset:3072 sc1
    v_mov_b32 v160, 0x2404c
    s_mov_b32 s80, 1600000
LW_90:
    ds_read_b32 v161, v160
    s_waitcnt lgkmcnt(0)
    v_readfirstlane_b32 s79, v161
    s_cmp_ge_u32 s79, 1
    s_cbranch_scc1 LWD_91
    s_sleep 2
    s_sub_u32 s80, s80, 1
    s_cmp_lg_u32 s80, 0
    s_cbranch_scc1 LW_90
LWD_91:
    v_mov_b32 v160, 0x24050
    ds_read_b64 v[162:163], v160
    s_waitcnt lgkmcnt(0)
    v_readfirstlane_b32 s94, v162
    v_readfirstlane_b32 s95, v163
    v_and_b32 v160, 31, v1
    v_lshlrev_b32 v3, 2, v160
    v_add_u32 v3, 0x27400, v3
    s_lshl_b32 s7, s60, 9
    s_add_u32 s7, s7, 0xe0000
    s_cmp_eq_u32 s3, 0
    s_cselect_b32 s7, s7, 0x40000000
    v_lshl_add_u32 v4, v160, 4, s7
    v_mov_b32 v22, s94
    v_mov_b32 v23, s95
    ds_read_b32 v16, v3 offset:0
    ds_read_b32 v17, v3 offset:128
    ds_read_b32 v18, v3 offset:256
    ds_read_b32 v19, v3 offset:384
    ds_read_b32 v20, v3 offset:2688
    s_waitcnt lgkmcnt(0)
    v_add_f32 v16, v16, v17
    v_add_f32 v18, v18, v19
    v_add_f32 v21, v16, v18
    s_waitcnt vmcnt(0)
    s_barrier
    s_mov_b64 exec, 0xffffffff
    buffer_store_dwordx4 v[20:23], v4, s[36:39], 0 offen sc1
    s_mov_b64 exec, -1
    v_lshlrev_b32 v2, 4, v1
    s_mov_b32 s44, s12
    s_and_b32 s45, s13, 0xffff
    s_mov_b32 s46, 0x8000000
    s_mov_b32 s47, 0x20000
    s_bfe_u32 s7, s5, 0x10002
    s_lshl_b32 s7, s7, 6
    s_add_u32 s7, s7, s6
    s_lshl_b32 s7, s7, 20
    s_lshl_b32 s72, s3, 10
    s_add_u32 s72, s72, s7
    s_add_u32 s72, s72, 1040384
    s_add_u32 s73, s72, 0x2000000
    s_mov_b32 s74, 4
    s_waitcnt vmcnt(0)
    s_barrier
PV_92:
    s_waitcnt vmcnt(1)
    buffer_load_dwordx4 v[8:11], v2, s[44:47], s72 offen
    s_sub_u32 s72, s72, 8192
    s_waitcnt vmcnt(1)
    buffer_load_dwordx4 v[8:11], v2, s[44:47], s73 offen
    s_sub_u32 s73, s73, 8192
    s_sub_u32 s74, s74, 1
    s_cmp_lg_u32 s74, 0
    s_cbranch_scc1 PV_92
    s_mov_b32 s52, s30
    s_and_b32 s53, s31, 0xffff
    s_mov_b32 s54, 0x2000
    s_mov_b32 s55, 0x20000
    s_lshl_b32 s7, s60, 3
    s_add_u32 s7, s7, s3
    s_lshl_b32 s7, s7, 10
    s_add_u32 s7, s7, 0x100000
    v_add_u32 v4, s7, v2
    s_bfe_u32 s7, s60, 0x20003
    s_lshl_b32 s7, s7, 11
    s_lshr_b32 s66, s60, 5
    s_lshl_b32 s66, s66, 10
    s_add_u32 s7, s7, s66
    s_and_b32 s66, s60, 7
    s_lshl_b32 s66, s66, 7
    s_add_u32 s7, s7, s66
    v_and_b32 v5, 7, v1
    v_lshl_add_u32 v5, v5, 4, s7
    v_lshrrev_b32 v6, 4, v1
    v_lshl_add_u32 v5, v6, 2, v5
    s_mov_b32 s90, 0x00ff00ff
    s_mov_b32 s91, 0x00ff00ff
    s_lshl_b32 s7, s3, 10
    s_add_u32 s7, s7, 0x25200
    v_add_u32 v6, s7, v2
    s_mov_b32 s80, 200000
PO_93:
    buffer_load_dwordx4 v[32:35], v4, s[36:39], 0 offen sc1
PO2_94:
    s_waitcnt vmcnt(0)
    v_cmp_ne_u64 vcc, s[94:95], v[34:35]
    s_cmp_lg_u64 vcc, -1
    s_cbranch_scc1 POD_95
    s_sleep 20
    s_sub_u32 s80, s80, 1
    s_cmp_lg_u32 s80, 0
    s_cbranch_scc1 PO_93
POD_95:
    v_lshlrev_b32 v64, 16, v32
    v_and_b32 v65, 0xffff0000, v32
    v_lshlrev_b32 v66, 16, v33
    v_and_b32 v67, 0xffff0000, v33
    s_cbranch_vccz RD_96
    buffer_load_dwordx4 v[32:35], v4, s[36:39], 0 offen sc1
    s_sleep 4
    buffer_load_dwordx4 v[36:39], v4, s[36:39], 0 offen sc1
    s_sleep 4
    s_mov_b32 s80, 200000
PP_97:
    s_waitcnt vmcnt(1)
    v_cmp_ne_u64 vcc, s[94:95], v[34:35]
    s_cmp_eq_u64 vcc, 0
    s_cbranch_scc1 PPO_99
    buffer_load_dwordx4 v[32:35], v4, s[36:39], 0 offen sc1
    s_waitcnt vmcnt(1)
    v_cmp_ne_u64 vcc, s[94:95], v[38:39]
    s_cmp_eq_u64 vcc, 0
    s_cbranch_scc1 PPO_100
    buffer_load_dwordx4 v[36:39], v4, s[36:39], 0 offen sc1
    s_sub_u32 s80, s80, 1
    s_cmp_lg_u32 s80, 0
    s_cbranch_scc1 PP_97
PPO_99:
    v_lshlrev_b32 v64, 16, v32
    v_and_b32 v65, 0xffff0000, v32
    v_lshlrev_b32 v66, 16, v33
    v_and_b32 v67, 0xffff0000, v33
    s_branch PPD_98
PPO_100:
    v_lshlrev_b32 v64, 16, v36
    v_and_b32 v65, 0xffff0000, v36
    v_lshlrev_b32 v66, 16, v37
    v_and_b32 v67, 0xffff0000, v37
PPD_98:
RD_96:
    ds_write_b128 v6, v[64:67]
    s_waitcnt lgkmcnt(0)
    s_barrier
    s_cmp_lg_u32 s3, 0
    s_cbranch_scc1 L_END
    ds_read_b128 v[64:67], v6 offset:0
    ds_read_b128 v[68:71], v6 offset:1024
    ds_read_b128 v[72:75], v6 offset:2048
    ds_read_b128 v[76:79], v6 offset:3072
    ds_read_b128 v[80:83], v6 offset:4096
    ds_read_b128 v[84:87], v6 offset:5120
    ds_read_b128 v[88:91], v6 offset:6144
    ds_read_b128 v[92:95], v6 offset:7168
    s_waitcnt lgkmcnt(4)
    v_pk_add_f32 v[64:65], v[64:65], v[72:73]
    v_pk_add_f32 v[66:67], v[66:67], v[74:75]
    v_pk_add_f32 v[68:69], v[68:69], v[76:77]
    v_pk_add_f32 v[70:71], v[70:71], v[78:79]
    v_pk_add_f32 v[64:65], v[64:65], v[68:69]
    v_pk_add_f32 v[66:67], v[66:67], v[70:71]
    s_waitcnt lgkmcnt(0)
    v_pk_add_f32 v[80:81], v[80:81], v[88:89]
    v_pk_add_f32 v[82:83], v[82:83], v[90:91]
    v_pk_add_f32 v[84:85], v[84:85], v[92:93]
    v_pk_add_f32 v[86:87], v[86:87], v[94:95]
    v_pk_add_f32 v[80:81], v[80:81], v[84:85]
    v_pk_add_f32 v[82:83], v[82:83], v[86:87]
    s_nop 0
    v_permlane32_swap_b32 v64, v80
    v_permlane32_swap_b32 v65, v81
    v_permlane32_swap_b32 v66, v82
    v_permlane32_swap_b32 v67, v83
    v_add_f32 v64, v64, v80
    v_add_f32 v65, v65, v81
    v_add_f32 v66, v66, v82
    v_add_f32 v67, v67, v83
    s_nop 0
    v_permlane16_swap_b32 v64, v66
    v_permlane16_swap_b32 v65, v67
    v_add_f32 v64, v64, v66
    v_add_f32 v65, v65, v67
    s_nop 0
    v_add_f32_dpp v64, v64, v64 row_ror:8 row_mask:0xf bank_mask:0xf
    v_add_f32_dpp v65, v65, v65 row_ror:8 row_mask:0xf bank_mask:0xf
    v_cvt_pk_bf16_f32 v8, v64, v65
    s_mov_b64 exec, s[90:91]
    buffer_store_dword v8, v5, s[52:55], 0 offen
    s_mov_b64 exec, -1
    s_endpgm
L_CODE_END:
.section .rodata,"a"
.p2align 6
.amdhsa_kernel concat_heads__sliding_block_cached__compressed_kv_cla__decode_kernel
  .amdhsa_next_free_vgpr 168
  .amdhsa_next_free_sgpr 102
  .amdhsa_accum_offset 168
  .amdhsa_group_segment_fixed_size 0
  .amdhsa_kernarg_size 112
  .amdhsa_user_sgpr_count 2
  .amdhsa_user_sgpr_kernarg_segment_ptr 1
  .amdhsa_system_sgpr_workgroup_id_x 1
  .amdhsa_float_denorm_mode_32 3
.end_amdhsa_kernel
```
